```python
import torch

def _softmax(x, axis=-1):
    return torch.softmax(x, dim=axis)
def _gelu(x):
    return torch.nn.functional.gelu(x, approximate="tanh")
def _silu(x):
    return torch.nn.functional.silu(x)
def _sigmoid(x):
    return torch.sigmoid(x)
def _layernorm(x, axis=-1, eps=1e-5):
    m = x.mean(dim=axis, keepdim=True)
    v = x.var(dim=axis, keepdim=True, unbiased=False)
    return (x - m) / torch.sqrt(v + eps)
def _scatter_add(tgt, idx, src, axis=0):
    return tgt.clone().index_add_(axis, idx, src)
def _segment_sum(src, seg, n):
    out = torch.zeros((n,) + src.shape[1:], dtype=src.dtype)
    return out.index_add_(0, seg, src)
def _pad(x, pw):
    flat = tuple(v for pair in reversed(pw) for v in pair)
    return torch.nn.functional.pad(x, flat)

kernel_name = 'parallel_sum__compressed_kv_cla__dense_activation_gelu__prompt'

def setup_inputs():

    _w = (lambda a: (lambda t: t.to(torch.bfloat16) if t.is_floating_point() else t)(torch.as_tensor(a)))
    def _A_setup():
        B, H, Sq, Sk, D, M = 1, 32, 2048, 2048, 128, 512
        Dc = 4 * D
        return {
            "x": _w((lambda *s: torch.randn(*s, dtype=torch.bfloat16) * 0.05)(B, Sq, M)),
            "c_kv": _w((lambda *s: torch.randn(*s, dtype=torch.bfloat16) * 0.4)(B, Sk, Dc)),
            "w_q": _w((lambda *s: torch.randn(*s, dtype=torch.bfloat16) * 3.2)(M, H, D) * (M ** -0.5)),
            "w_uk": _w((lambda *s: torch.randn(*s, dtype=torch.bfloat16) * 3.2)(Dc, H, D) * (Dc ** -0.5)),
            "w_uv": _w((lambda *s: torch.randn(*s, dtype=torch.bfloat16) * 0.4)(Dc, H, D) * (Dc ** -0.5)),
            "w_o": _w((lambda *s: torch.randn(*s, dtype=torch.bfloat16) * 0.4)(H, D, M) * ((H * D) ** -0.5)),
        }
    _A_in = _A_setup()

    def _B_setup():
        B, S, D, F = 1, 2048, 512, 1792
        return {
            "x": _w((lambda *s: torch.randn(*s, dtype=torch.bfloat16) * 0.05)(B, S, D)),
            "w1": _w((lambda *s: torch.randn(*s, dtype=torch.bfloat16) * 0.8)(D, F) * (D ** -0.5)),
            "b1": _w((lambda *s: torch.randn(*s, dtype=torch.bfloat16) * 12.8)(F) * 0.01),
            "w2": _w((lambda *s: torch.randn(*s, dtype=torch.bfloat16) * 0.2)(F, D) * (F ** -0.5)),
            "b2": _w((lambda *s: torch.randn(*s, dtype=torch.bfloat16) * 3.2)(D) * 0.01),
        }
    _B_in = _B_setup()

    return {
        "A_x": _A_in["x"],
        "A_c_kv": _A_in["c_kv"],
        "A_w_q": _A_in["w_q"],
        "A_w_uk": _A_in["w_uk"],
        "A_w_uv": _A_in["w_uv"],
        "A_w_o": _A_in["w_o"],
        "B_x": _B_in["x"],
        "B_w1": _B_in["w1"],
        "B_b1": _B_in["b1"],
        "B_w2": _B_in["w2"],
        "B_b2": _B_in["b2"],
    }

def reference(A_x, A_c_kv, A_w_q, A_w_uk, A_w_uv, A_w_o, B_x, B_w1, B_b1, B_w2, B_b2):
    def _A_ref(x, c_kv, w_q, w_uk, w_uv, w_o):
        B, Sq, M = x.shape[0], x.shape[1], x.shape[2]
        Sk = c_kv.shape[1]
        H, D = w_q.shape[1], w_q.shape[2]
        q = torch.einsum("bqm,mhd->bhqd", x, w_q)
        k = torch.einsum("bkc,chd->bhkd", c_kv, w_uk)
        v = torch.einsum("bkc,chd->bhkd", c_kv, w_uv)
        scores = torch.einsum("bhqd,bhkd->bhqk", q, k) * (D ** -0.5)
        off = Sk - Sq
        qi = torch.arange(Sq)[:, None]
        kj = torch.arange(Sk)[None, :]
        cmask = kj <= (qi + off)
        scores = torch.where(cmask[None, None], scores, -1e9)
        p = _softmax(scores, axis=-1)
        ctx = torch.einsum("bhqk,bhkd->bhqd", p, v)
        return torch.einsum("bhqd,hdm->bqm", ctx, w_o)

    def _B_ref(x, w1, b1, w2, b2):
        h = torch.einsum("bsd,df->bsf", x, w1) + b1
        h = _gelu(h)
        return torch.einsum("bsf,fd->bsd", h, w2) + b2

    x = A_x
    xn = _layernorm(x, axis=-1)
    return x + _A_ref(xn, A_c_kv, A_w_q, A_w_uk, A_w_uv, A_w_o) + _B_ref(xn, B_w1, B_b1, B_w2, B_b2)
```

```asm
; @launch grid=(256,1,1) block=(256,1,1) lds=163840
.amdgcn_target "amdgcn-amd-amdhsa--gfx950"
.macro M d,a,b,c
 v_mfma_f32_16x16x32_bf16 \d,\a,\b,\c
.endm
.macro N d,a,b,c
 v_mfma_f32_32x32x16_bf16 \d,\a,\b,\c
.endm
.macro T d,a,o
 ds_read_b64_tr_b16 \d,\a offset:\o
.endm
.macro W n
 s_waitcnt lgkmcnt(\n)
.endm
.text
.globl parallel_sum__compressed_kv_cla__dense_activation_gelu__prompt_kernel
.p2align 8
.type parallel_sum__compressed_kv_cla__dense_activation_gelu__prompt_kernel,@function
parallel_sum__compressed_kv_cla__dense_activation_gelu__prompt_kernel:
 s_cmp_lt_u32 s2,256
 s_cbranch_scc1 F_go
 s_endpgm
F_go:
 s_load_dwordx2 s[60:61],s[0:1],96
 s_load_dwordx2 s[16:17],s[0:1],8
 s_load_dwordx2 s[20:21],s[0:1],24
 s_load_dwordx2 s[4:5],s[0:1],32
 s_load_dwordx2 s[12:13],s[0:1],0
 s_load_dwordx2 s[8:9],s[0:1],104
 s_load_dwordx2 s[24:25],s[0:1],16
 s_load_dwordx2 s[28:29],s[0:1],56
 s_load_dwordx2 s[32:33],s[0:1],64
 s_load_dwordx2 s[44:45],s[0:1],40
 s_load_dwordx2 s[48:49],s[0:1],72
 s_load_dwordx2 s[52:53],s[0:1],80
 s_load_dwordx2 s[56:57],s[0:1],88
 v_and_b32 v188,63,v0
 v_lshrrev_b32 v184,6,v0
 v_mov_b32 v216,0
 v_readfirstlane_b32 s64,v184
 v_mov_b32 v223,1
 s_getreg_b32 s65,hwreg(HW_REG_XCC_ID,0,3)
 s_mov_b32 s62,256
 s_mov_b32 s63,0x20000
 s_lshl_b32 s68,s65,5
 s_add_u32 s68,s68,4
 v_bfe_u32 v184,v188,3,3
 v_and_b32 v185,7,v188
 v_lshlrev_b32 v184,10,v184
 v_lshl_add_u32 v184,v185,7,v184
 v_lshrrev_b32 v185,1,v188
 v_lshlrev_b32 v185,9,v185
 v_and_b32 v186,1,v188
 v_lshl_add_u32 v185,v186,7,v185
 s_lshl_b32 s69,s2,13
 s_lshl_b32 s70,s2,14
 s_cmp_lt_u32 s64,2
 s_cselect_b32 s69,s69,s70
 s_cselect_b64 vcc,-1,0
 s_cselect_b32 s38,1,2
 s_lshl_b32 s38,s38,21
 s_mov_b32 s39,0x20000
 v_cndmask_b32 v184,v185,v184,vcc
 W 0
 s_cmp_eq_u32 s64,0
 s_cbranch_scc0 F_notk
 s_mov_b64 exec,1
 buffer_atomic_add v223,v216,s[60:63],s68 offen sc0 sc1
 s_mov_b64 exec,-1
F_notk:
 s_bitcmp1_b32 s64,0
 s_cselect_b64 s[36:37],s[16:17],s[12:13]
 s_cselect_b64 s[40:41],s[4:5],s[20:21]
 s_cmp_lt_u32 s64,2
 s_cselect_b64 s[36:37],s[36:37],s[40:41]
 buffer_load_dword v221,v184,s[36:39],s69 offen
 v_lshrrev_b32 v185,3,v188
 s_mul_i32 s77,s64,24576
 s_lshl_b32 s71,s64,12
 s_mov_b32 s18,0x200000
 s_mov_b32 s19,0x20000
 s_mov_b32 s22,0x400000
 s_mov_b32 s23,0x20000
 v_and_b32 v186,7,v188
 v_lshrrev_b32 v184,4,v188
 v_xor_b32 v186,v186,v184
 v_lshlrev_b32 v184,10,v185
 v_xor_b32 v185,0,v186
 v_lshl_add_u32 v180,v185,4,v184
 v_xor_b32 v185,4,v186
 v_lshl_add_u32 v181,v185,4,v184
 v_add_u32 v181,7168,v181
 v_xor_b32 v185,0,v186
 v_lshl_add_u32 v182,v185,4,v184
 v_add_u32 v182,14336,v182
 v_xor_b32 v185,4,v186
 v_lshl_add_u32 v183,v185,4,v184
 v_add_u32 v183,21504,v183
 v_lshrrev_b32 v184,3,v188
 v_and_b32 v185,7,v188
 v_and_b32 v186,6,v184
 v_xor_b32 v185,v185,v186
 v_lshlrev_b32 v185,4,v185
 v_and_b32 v186,4,v184
 v_add_u32 v184,v184,v186
 v_mul_u32_u24 v184,8192,v184
 v_add_u32 v184,v184,v185
 v_mov_b32 v233,v184
 v_add_u32 v234,31744,v184
 v_add_u32 v235,129024,v184
 v_add_u32 v236,160768,v184
 v_lshrrev_b32 v184,4,v188
 v_bfe_u32 v185,v188,2,2
 v_and_b32 v186,1,v184
 v_lshl_add_u32 v185,v186,2,v185
 v_lshrrev_b32 v184,1,v184
 v_lshlrev_b32 v184,11,v184
 v_lshl_add_u32 v184,v185,7,v184
 v_and_b32 v186,1,v188
 v_lshl_add_u32 v184,v186,3,v184
 v_bfe_u32 v186,v188,1,1
 v_lshl_add_u32 v184,v186,4,v184
 v_add_u32 v184,98304,v184
 v_and_b32 v185,6,v185
 v_xor_b32 v186,0,v185
 v_lshl_add_u32 v225,v186,4,v184
 v_xor_b32 v186,2,v185
 v_lshl_add_u32 v226,v186,4,v184
 v_xor_b32 v186,4,v185
 v_lshl_add_u32 v227,v186,4,v184
 v_xor_b32 v186,6,v185
 v_lshl_add_u32 v228,v186,4,v184
 v_add_u32 v229,49152,v225
 v_add_u32 v230,49152,v226
 v_add_u32 v231,49152,v227
 v_add_u32 v232,49152,v228
 v_lshrrev_b32 v184,3,v188
 v_and_b32 v185,7,v188
 v_and_b32 v186,6,v184
 v_xor_b32 v185,v185,v186
 v_lshlrev_b32 v185,4,v185
 v_and_b32 v186,4,v184
 v_add_u32 v184,v184,v186
 v_mul_u32_u24 v184,3584,v184
 v_add_u32 v184,v184,v185
 v_mov_b32 v237,v184
 v_add_u32 v238,13312,v184
 v_add_u32 v239,55296,v184
 v_add_u32 v240,68608,v184
 s_cmp_eq_u32 s64,0
 s_cbranch_scc0 F_tk2
 s_mov_b32 s70,7
 s_waitcnt vmcnt(1)
F_tk0:
 v_readfirstlane_b32 s69,v223
 s_nop 0
 s_cmp_lt_u32 s69,32
 s_cbranch_scc1 F_tk1
 s_sub_u32 s70,s70,1
 s_cbranch_scc1 F_tk3
 s_add_u32 s65,s65,1
 s_and_b32 s65,s65,7
 s_lshl_b32 s68,s65,5
 s_add_u32 s68,s68,4
 v_mov_b32 v223,1
 s_mov_b64 exec,1
 buffer_atomic_add v223,v216,s[60:63],s68 offen sc0 sc1
 s_mov_b64 exec,-1
 s_waitcnt vmcnt(0)
 s_branch F_tk0
F_tk1:
 s_lshl_b32 s69,s69,3
 s_add_u32 s2,s69,s65
F_tk3:
 v_mov_b32 v223,s2
 ds_write_b32 v216,v223
 W 0
F_tk2:
 s_barrier
 ds_read_b32 v223,v216
 W 0
 v_readfirstlane_b32 s2,v223
 s_barrier
 s_and_b32 s65,s2,7
 s_lshr_b32 s66,s2,5
 s_bfe_u32 s67,s2,0x20003
 s_and_b32 s79,s66,1
 s_and_b32 s96,s2,1
 s_lshl_b32 s96,s96,2
 s_add_u32 s96,s96,s67
 s_lshl_b32 s75,s96,18
 s_lshl_b32 s68,s64,16
 s_add_u32 s75,s75,s68
 s_lshr_b32 s3,s65,1
 s_lshl_b32 s3,s3,2
 s_lshr_b32 s68,s66,1
 s_add_u32 s3,s3,s68
 s_lshl_b32 s74,s64,18
 s_lshl_b32 s68,s3,9
 s_add_u32 s74,s74,s68
 s_or_b32 s70,s2,s64
 s_cmp_eq_u32 s70,0
 s_cbranch_scc0 F_noep0
 s_mov_b32 s10,0x6100000
 s_mov_b32 s11,0x20000
 s_mov_b32 s68,0x6050000
 buffer_load_dword v218,v216,s[8:11],s68 offen sc1
F_noep0:
 s_add_u32 m0,s77,0
 s_add_u32 s68,s75,0
 buffer_load_dwordx4 v180,s[16:19],s68 offen offset:0 lds
 buffer_load_dwordx4 v181,s[16:19],s68 offen offset:1024 lds
 buffer_load_dwordx4 v182,s[16:19],s68 offen offset:2048 lds
 buffer_load_dwordx4 v183,s[16:19],s68 offen offset:3072 lds
 s_add_u32 m0,s77,4096
 s_add_u32 s68,s75,32768
 buffer_load_dwordx4 v180,s[16:19],s68 offen offset:0 lds
 buffer_load_dwordx4 v181,s[16:19],s68 offen offset:1024 lds
 buffer_load_dwordx4 v182,s[16:19],s68 offen offset:2048 lds
 buffer_load_dwordx4 v183,s[16:19],s68 offen offset:3072 lds
 s_cmp_eq_u32 s79,0
 s_cselect_b64 s[20:21],s[20:21],s[4:5]
 s_add_u32 m0,s71,98304
 s_add_u32 s68,s74,0
 buffer_load_dwordx4 v233,s[20:23],s68 offen offset:0 lds
 buffer_load_dwordx4 v234,s[20:23],s68 offen offset:1024 lds
 buffer_load_dwordx4 v235,s[20:23],s68 offen offset:2048 lds
 buffer_load_dwordx4 v236,s[20:23],s68 offen offset:3072 lds
 s_mov_b32 s14,0x200000
 s_mov_b32 s15,0x20000
 s_lshl_b32 s69,s2,13
 s_lshl_b32 s68,s64,11
 s_add_u32 s69,s69,s68
 v_lshlrev_b32 v224,4,v188
 v_and_b32 v184,32,v188
 v_lshl_add_u32 v184,v184,4,v224
 buffer_load_dwordx4 v[144:147],v184,s[12:15],s69 offen
 buffer_load_dwordx4 v[148:151],v184,s[12:15],s69 offen offset:512
 s_add_u32 m0,s77,8192
 s_add_u32 s68,s75,128
 buffer_load_dwordx4 v180,s[16:19],s68 offen offset:0 lds
 buffer_load_dwordx4 v181,s[16:19],s68 offen offset:1024 lds
 buffer_load_dwordx4 v182,s[16:19],s68 offen offset:2048 lds
 buffer_load_dwordx4 v183,s[16:19],s68 offen offset:3072 lds
 s_add_u32 m0,s77,12288
 s_add_u32 s68,s75,32896
 buffer_load_dwordx4 v180,s[16:19],s68 offen offset:0 lds
 buffer_load_dwordx4 v181,s[16:19],s68 offen offset:1024 lds
 buffer_load_dwordx4 v182,s[16:19],s68 offen offset:2048 lds
 buffer_load_dwordx4 v183,s[16:19],s68 offen offset:3072 lds
 s_mov_b32 s10,0x6100000
 s_mov_b32 s11,0x20000
 s_mov_b32 s26,0x400000
 s_mov_b32 s27,0x20000
 s_mov_b32 s30,0x1c0000
 s_mov_b32 s31,0x20000
 s_mov_b32 s34,0xe00
 s_mov_b32 s35,0x20000
 s_mov_b32 s46,0x400000
 s_mov_b32 s47,0x20000
 s_mov_b32 s50,0x1c0000
 s_mov_b32 s51,0x20000
 s_mov_b32 s54,0x400
 s_mov_b32 s55,0x20000
 s_mov_b32 s58,0x200000
 s_mov_b32 s59,0x20000
 s_lshr_b32 s68,s2,3
 s_lshl_b32 s68,s68,2
 s_add_u32 s97,s68,s64
 v_lshlrev_b32 v169,7,v188
 s_lshl_b32 s68,s97,13
 s_and_b32 s69,s2,1
 s_lshl_b32 s69,s69,20
 s_add_u32 s68,s68,s69
 s_mov_b32 s90,s68
 s_getpc_b64 s[6:7]
F_pc:
 s_lshl_b32 s68,s97,12
 v_lshlrev_b32 v186,6,v188
 v_add_u32 v186,s68,v186
 v_min_u32 v186,F_RA0-F_pc,v186
 v_mov_b32 v168,v186
 s_lshr_b32 s68,s66,1
 s_lshl_b32 s68,s68,2
 s_add_u32 s68,s68,s67
 s_lshl_b32 s68,s68,2
 s_add_u32 s68,s68,s64
 s_lshl_b32 s68,s68,16
 s_lshr_b32 s69,s65,1
 s_lshl_b32 s69,s69,11
 s_add_u32 s99,s68,s69
 v_lshrrev_b32 v222,4,v188
 v_and_b32 v184,15,v188
 v_lshlrev_b32 v170,13,v222
 v_lshl_add_u32 v170,v184,7,v170
 v_lshlrev_b32 v222,3,v222
 s_cmp_eq_u32 s70,0
 s_cbranch_scc0 F_noep
 s_mov_b32 s68,0x6050000
 s_waitcnt vmcnt(22)
 v_add_u32 v218,16,v218
 v_max_u32 v218,1,v218
 buffer_store_dword v218,v216,s[60:63],0 offen sc0 sc1
 buffer_store_dword v218,v216,s[8:11],s68 offen sc0 sc1
F_noep:
 s_lshl_b32 s5,s2,7
 s_add_u32 s5,s5,0x6000000
 s_lshl_b32 s1,s3,3
 s_add_u32 s1,s1,s96
 s_lshl_b32 s1,s1,1
 s_add_u32 s1,s1,s79
 s_lshl_b32 s1,s1,7
 s_add_u32 s1,s1,0x6008000
 s_lshl_b32 s72,s64,10
 s_mov_b32 s78,0x3e0293ee
 s_mov_b32 s88,0xc0135761
 s_lshl_b32 s76,s3,6
 s_lshl_b32 s68,s96,2
 s_add_u32 s76,s76,s68
 s_add_u32 s76,s76,s64
 s_mul_i32 s76,s76,17408
 s_mul_i32 s68,s79,0x1200000
 s_add_u32 s76,s76,s68
 s_mov_b32 s91,0
 s_mov_b32 s93,0
 s_mov_b32 s92,s71
 s_mov_b32 s94,s71
 s_lshr_b32 s98,s2,1
 s_mul_i32 s98,s98,17408
 s_and_b32 s68,s2,1
 s_lshl_b32 s68,s68,7
 s_add_u32 s98,s98,s68
 s_add_u32 s98,s98,s71
 s_add_u32 s98,s98,0x2400000
 v_and_b32 v184,31,v188
 v_lshrrev_b32 v185,5,v188
 v_lshlrev_b32 v152,7,v184
 v_lshl_add_u32 v152,v185,4,v152
 v_lshl_add_u32 v152,s64,5,v152
 v_add_u32 v152,90112,v152
 v_lshl_add_u32 v157,s64,11,v224
 v_add_u32 v157,90112,v157
 v_lshlrev_b32 v158,10,v185
 v_bfe_u32 v184,v188,3,2
 v_lshl_add_u32 v158,v184,8,v158
 v_and_b32 v184,7,v188
 v_lshl_add_u32 v158,v184,4,v158
 v_and_b32 v184,15,v188
 v_bfe_u32 v185,v188,2,1
 v_bfe_u32 v186,v188,3,1
 v_xor_b32 v185,v185,v186
 v_mul_u32_u24 v185,12,v185
 v_mul_lo_u32 v185,v185,s79
 v_xor_b32 v184,v184,v185
 v_lshrrev_b32 v185,1,v184
 v_lshrrev_b32 v186,4,v188
 v_xor_b32 v185,v185,v186
 v_lshlrev_b32 v184,7,v184
 v_add_u32 v184,s77,v184
 v_lshl_add_u32 v178,v185,4,v184
 v_xor_b32 v185,4,v185
 v_lshl_add_u32 v179,v185,4,v184
 v_add_u32 v241,17408,v224
 v_mov_b32 v242,0xbdd2d3e8
 s_add_u32 m0,s77,16384
 s_add_u32 s68,s75,256
 buffer_load_dwordx4 v180,s[16:19],s68 offen offset:0 lds
 buffer_load_dwordx4 v181,s[16:19],s68 offen offset:1024 lds
 buffer_load_dwordx4 v182,s[16:19],s68 offen offset:2048 lds
 buffer_load_dwordx4 v183,s[16:19],s68 offen offset:3072 lds
 s_add_u32 m0,s77,20480
 s_add_u32 s68,s75,33024
 buffer_load_dwordx4 v180,s[16:19],s68 offen offset:0 lds
 buffer_load_dwordx4 v181,s[16:19],s68 offen offset:1024 lds
 buffer_load_dwordx4 v182,s[16:19],s68 offen offset:2048 lds
 buffer_load_dwordx4 v183,s[16:19],s68 offen offset:3072 lds
 s_cmp_eq_u32 s79,0
 s_cbranch_scc0 F_V
 s_waitcnt vmcnt(22)
 ds_read_b128 a[0:3],v178 offset:0
 ds_read_b128 a[64:67],v178 offset:2048
 ds_read_b128 a[128:131],v178 offset:4096
 ds_read_b128 a[192:195],v178 offset:6144
 ds_read_b128 a[4:7],v179 offset:0
 ds_read_b128 a[68:71],v179 offset:2048
 ds_read_b128 a[132:135],v179 offset:4096
 ds_read_b128 a[196:199],v179 offset:6144
 s_waitcnt vmcnt(18)
 s_barrier
 T v[192:193],v225,0
 T v[194:195],v225,1024
 T v[196:197],v226,0
 T v[198:199],v226,1024
 T v[200:201],v227,0
 T v[202:203],v227,1024
 T v[204:205],v228,0
 T v[206:207],v228,1024
 W 6
 M v[0:3],v[192:195],a[0:3],0
 T v[208:209],v225,4096
 T v[210:211],v225,5120
 M v[4:7],v[192:195],a[64:67],0
 s_add_u32 m0,s71,114688
 s_add_u32 s68,s74,1048576
 buffer_load_dwordx4 v233,s[20:23],s68 offen offset:0 lds
 M v[8:11],v[192:195],a[128:131],0
 buffer_load_dwordx4 v234,s[20:23],s68 offen offset:1024 lds
 s_waitcnt vmcnt(19)
 v_lshlrev_b32 v128,16,v144
 M v[12:15],v[192:195],a[192:195],0
 W 6
 v_and_b32 v129,0xffff0000,v144
 v_lshlrev_b32 v130,16,v145
 M v[16:19],v[196:199],a[0:3],0
 T v[212:213],v226,4096
 T v[214:215],v226,5120
 M v[20:23],v[196:199],a[64:67],0
 buffer_load_dwordx4 v235,s[20:23],s68 offen offset:2048 lds
 v_and_b32 v131,0xffff0000,v145
 M v[24:27],v[196:199],a[128:131],0
 buffer_load_dwordx4 v236,s[20:23],s68 offen offset:3072 lds
 v_lshlrev_b32 v132,16,v146
 M v[28:31],v[196:199],a[192:195],0
 W 6
 v_and_b32 v133,0xffff0000,v146
 v_lshlrev_b32 v134,16,v147
 M v[32:35],v[200:203],a[0:3],0
 T v[192:193],v227,4096
 T v[194:195],v227,5120
 M v[36:39],v[200:203],a[64:67],0
 s_waitcnt vmcnt(12)
 s_add_u32 m0,s71,131072
 s_add_u32 s68,s74,2097152
 buffer_load_dwordx4 v233,s[20:23],s68 offen offset:0 lds
 M v[40:43],v[200:203],a[128:131],0
 ds_read_b128 a[8:11],v178 offset:8192
 ds_read_b128 a[72:75],v178 offset:10240
 buffer_load_dwordx4 v234,s[20:23],s68 offen offset:1024 lds
 M v[44:47],v[200:203],a[192:195],0
 W 8
 v_and_b32 v135,0xffff0000,v147
 v_lshlrev_b32 v136,16,v148
 M v[48:51],v[204:207],a[0:3],0
 T v[196:197],v228,4096
 T v[198:199],v228,5120
 M v[52:55],v[204:207],a[64:67],0
 buffer_load_dwordx4 v235,s[20:23],s68 offen offset:2048 lds
 v_and_b32 v137,0xffff0000,v148
 M v[56:59],v[204:207],a[128:131],0
 ds_read_b128 a[136:139],v178 offset:12288
 ds_read_b128 a[200:203],v178 offset:14336
 buffer_load_dwordx4 v236,s[20:23],s68 offen offset:3072 lds
 M v[60:63],v[204:207],a[192:195],0
 W 10
 v_lshlrev_b32 v138,16,v149
 v_and_b32 v139,0xffff0000,v149
 M v[0:3],v[208:211],a[4:7],v[0:3]
 T v[200:201],v225,8192
 T v[202:203],v225,9216
 M v[4:7],v[208:211],a[68:71],v[4:7]
 s_add_u32 m0,s71,147456
 s_add_u32 s68,s74,128
 buffer_load_dwordx4 v233,s[20:23],s68 offen offset:0 lds
 M v[8:11],v[208:211],a[132:135],v[8:11]
 ds_read_b128 a[12:15],v179 offset:8192
 ds_read_b128 a[76:79],v179 offset:10240
 buffer_load_dwordx4 v234,s[20:23],s68 offen offset:1024 lds
 M v[12:15],v[208:211],a[196:199],v[12:15]
 W 12
 v_lshlrev_b32 v140,16,v150
 v_and_b32 v141,0xffff0000,v150
 M v[16:19],v[212:215],a[4:7],v[16:19]
 T v[204:205],v226,8192
 T v[206:207],v226,9216
 M v[20:23],v[212:215],a[68:71],v[20:23]
 buffer_load_dwordx4 v235,s[20:23],s68 offen offset:2048 lds
 M v[24:27],v[212:215],a[132:135],v[24:27]
 ds_read_b128 a[140:143],v179 offset:12288
 ds_read_b128 a[204:207],v179 offset:14336
 buffer_load_dwordx4 v236,s[20:23],s68 offen offset:3072 lds
 M v[28:31],v[212:215],a[196:199],v[28:31]
 W 14
 v_lshlrev_b32 v142,16,v151
 v_and_b32 v143,0xffff0000,v151
 M v[32:35],v[192:195],a[4:7],v[32:35]
 T v[208:209],v227,8192
 T v[210:211],v227,9216
 M v[36:39],v[192:195],a[68:71],v[36:39]
 s_add_u32 m0,s77,0
 s_add_u32 s68,s75,384
 buffer_load_dwordx4 v180,s[16:19],s68 offen offset:0 lds
 M v[40:43],v[192:195],a[132:135],v[40:43]
 buffer_load_dwordx4 v181,s[16:19],s68 offen offset:1024 lds
 v_add_f32 v153,v128,v129
 M v[44:47],v[192:195],a[196:199],v[44:47]
 W 12
 v_add_f32 v153,v153,v130
 v_add_f32 v153,v153,v131
 M v[48:51],v[196:199],a[4:7],v[48:51]
 T v[212:213],v228,8192
 T v[214:215],v228,9216
 M v[52:55],v[196:199],a[68:71],v[52:55]
 buffer_load_dwordx4 v182,s[16:19],s68 offen offset:2048 lds
 v_add_f32 v153,v153,v132
 M v[56:59],v[196:199],a[132:135],v[56:59]
 buffer_load_dwordx4 v183,s[16:19],s68 offen offset:3072 lds
 v_add_f32 v153,v153,v133
 M v[60:63],v[196:199],a[196:199],v[60:63]
 W 10
 v_add_f32 v153,v153,v134
 v_add_f32 v153,v153,v135
 M v[0:3],v[200:203],a[8:11],v[0:3]
 T v[192:193],v225,12288
 T v[194:195],v225,13312
 M v[4:7],v[200:203],a[72:75],v[4:7]
 s_add_u32 m0,s77,4096
 s_add_u32 s68,s75,33152
 buffer_load_dwordx4 v180,s[16:19],s68 offen offset:0 lds
 M v[8:11],v[200:203],a[136:139],v[8:11]
 buffer_load_dwordx4 v181,s[16:19],s68 offen offset:1024 lds
 v_add_f32 v153,v153,v136
 M v[12:15],v[200:203],a[200:203],v[12:15]
 W 8
 v_add_f32 v153,v153,v137
 v_add_f32 v153,v153,v138
 M v[16:19],v[204:207],a[8:11],v[16:19]
 T v[196:197],v226,12288
 T v[198:199],v226,13312
 M v[20:23],v[204:207],a[72:75],v[20:23]
 buffer_load_dwordx4 v182,s[16:19],s68 offen offset:2048 lds
 v_add_f32 v153,v153,v139
 M v[24:27],v[204:207],a[136:139],v[24:27]
 buffer_load_dwordx4 v183,s[16:19],s68 offen offset:3072 lds
 v_add_f32 v153,v153,v140
 M v[28:31],v[204:207],a[200:203],v[28:31]
 W 6
 v_add_f32 v153,v153,v141
 v_add_f32 v153,v153,v142
 M v[32:35],v[208:211],a[8:11],v[32:35]
 T v[200:201],v227,12288
 T v[202:203],v227,13312
 M v[36:39],v[208:211],a[72:75],v[36:39]
 s_waitcnt vmcnt(20)
 s_add_u32 m0,s77,8192
 s_add_u32 s68,s75,512
 buffer_load_dwordx4 v180,s[16:19],s68 offen offset:0 lds
 M v[40:43],v[208:211],a[136:139],v[40:43]
 ds_read_b128 a[16:19],v178 offset:16384
 ds_read_b128 a[80:83],v178 offset:18432
 buffer_load_dwordx4 v181,s[16:19],s68 offen offset:1024 lds
 M v[44:47],v[208:211],a[200:203],v[44:47]
 W 8
 v_add_f32 v153,v153,v143
 s_nop 1
 v_add_f32_dpp v153,v153,v153 quad_perm:[1,0,3,2] row_mask:0xf bank_mask:0xf
 M v[48:51],v[212:215],a[8:11],v[48:51]
 T v[204:205],v228,12288
 T v[206:207],v228,13312
 M v[52:55],v[212:215],a[72:75],v[52:55]
 v_add_u32 v225,0x4000,v225
 v_add_u32 v226,0x4000,v226
 buffer_load_dwordx4 v182,s[16:19],s68 offen offset:2048 lds
 M v[56:59],v[212:215],a[136:139],v[56:59]
 v_add_u32 v227,0x4000,v227
 v_add_u32 v228,0x4000,v228
 ds_read_b128 a[144:147],v178 offset:20480
 ds_read_b128 a[208:211],v178 offset:22528
 buffer_load_dwordx4 v183,s[16:19],s68 offen offset:3072 lds
 M v[60:63],v[212:215],a[200:203],v[60:63]
 W 10
 s_waitcnt vmcnt(20)
 s_barrier
 v_add_f32_dpp v153,v153,v153 quad_perm:[2,3,0,1] row_mask:0xf bank_mask:0xf
 M v[0:3],v[192:195],a[12:15],v[0:3]
 T v[208:209],v225,0
 T v[210:211],v225,1024
 M v[4:7],v[192:195],a[76:79],v[4:7]
 s_add_u32 m0,s77,12288
 s_add_u32 s68,s75,33280
 buffer_load_dwordx4 v180,s[16:19],s68 offen offset:0 lds
 M v[8:11],v[192:195],a[140:143],v[8:11]
 ds_read_b128 a[20:23],v179 offset:16384
 ds_read_b128 a[84:87],v179 offset:18432
 buffer_load_dwordx4 v181,s[16:19],s68 offen offset:1024 lds
 M v[12:15],v[192:195],a[204:207],v[12:15]
 W 12
 v_add_f32_dpp v153,v153,v153 row_half_mirror row_mask:0xf bank_mask:0xf
 s_nop 1
 v_add_f32_dpp v153,v153,v153 row_mirror row_mask:0xf bank_mask:0xf
 M v[16:19],v[196:199],a[12:15],v[16:19]
 T v[212:213],v226,0
 T v[214:215],v226,1024
 M v[20:23],v[196:199],a[76:79],v[20:23]
 buffer_load_dwordx4 v182,s[16:19],s68 offen offset:2048 lds
 v_mov_b32 v154,v153
 M v[24:27],v[196:199],a[140:143],v[24:27]
 ds_read_b128 a[148:151],v179 offset:20480
 ds_read_b128 a[212:215],v179 offset:22528
 buffer_load_dwordx4 v183,s[16:19],s68 offen offset:3072 lds
 M v[28:31],v[196:199],a[204:207],v[28:31]
 W 14
 v_permlane16_swap_b32 v153,v154
 M v[32:35],v[200:203],a[12:15],v[32:35]
 T v[192:193],v227,0
 T v[194:195],v227,1024
 M v[36:39],v[200:203],a[76:79],v[36:39]
 global_load_dword v221,v168,s[6:7]
 v_add_f32 v153,v153,v154
 M v[40:43],v[200:203],a[140:143],v[40:43]
 v_mul_f32 v153,0x3b000000,v153
 v_cvt_pk_bf16_f32 v155,v153,v153
 M v[44:47],v[200:203],a[204:207],v[44:47]
 W 12
 v_and_b32 v155,0xffff0000,v155
 v_sub_f32 v154,v128,v153
 M v[48:51],v[204:207],a[12:15],v[48:51]
 T v[196:197],v228,0
 T v[198:199],v228,1024
 M v[52:55],v[204:207],a[76:79],v[52:55]
 v_mul_f32 v156,v154,v154
 v_sub_f32 v154,v129,v153
 M v[56:59],v[204:207],a[140:143],v[56:59]
 v_fmac_f32 v156,v154,v154
 v_sub_f32 v154,v130,v153
 M v[60:63],v[204:207],a[204:207],v[60:63]
 W 10
 v_fmac_f32 v156,v154,v154
 v_sub_f32 v154,v131,v153
 M v[0:3],v[208:211],a[16:19],v[0:3]
 T v[200:201],v225,4096
 T v[202:203],v225,5120
 M v[4:7],v[208:211],a[80:83],v[4:7]
 v_lshlrev_b32 v253,1,v224
 v_fmac_f32 v156,v154,v154
 v_sub_f32 v154,v132,v153
 M v[8:11],v[208:211],a[144:147],v[8:11]
 v_fmac_f32 v156,v154,v154
 v_sub_f32 v154,v133,v153
 M v[12:15],v[208:211],a[208:211],v[12:15]
 W 8
 v_fmac_f32 v156,v154,v154
 v_sub_f32 v154,v134,v153
 M v[16:19],v[212:215],a[16:19],v[16:19]
 T v[204:205],v226,4096
 T v[206:207],v226,5120
 M v[20:23],v[212:215],a[80:83],v[20:23]
 s_mul_i32 s68,s2,7168
 s_mul_i32 s69,s64,1792
 s_add_u32 s68,s68,s69
 buffer_load_dword v221,v253,s[28:31],s68 offen
 M v[24:27],v[212:215],a[144:147],v[24:27]
 v_fmac_f32 v156,v154,v154
 v_sub_f32 v154,v135,v153
 M v[28:31],v[212:215],a[208:211],v[28:31]
 W 6
 v_fmac_f32 v156,v154,v154
 v_sub_f32 v154,v136,v153
 M v[32:35],v[192:195],a[16:19],v[32:35]
 T v[208:209],v227,4096
 T v[210:211],v227,5120
 M v[36:39],v[192:195],a[80:83],v[36:39]
 s_waitcnt vmcnt(10)
 s_add_u32 m0,s77,16384
 s_add_u32 s68,s75,640
 buffer_load_dwordx4 v180,s[16:19],s68 offen offset:0 lds
 M v[40:43],v[192:195],a[144:147],v[40:43]
 ds_read_b128 a[24:27],v178 offset:0
 ds_read_b128 a[88:91],v178 offset:2048
 M v[44:47],v[192:195],a[208:211],v[44:47]
 W 8
 v_fmac_f32 v156,v154,v154
 v_sub_f32 v154,v137,v153
 M v[48:51],v[196:199],a[16:19],v[48:51]
 T v[212:213],v228,4096
 T v[214:215],v228,5120
 M v[52:55],v[196:199],a[80:83],v[52:55]
 buffer_load_dwordx4 v181,s[16:19],s68 offen offset:1024 lds
 v_fmac_f32 v156,v154,v154
 M v[56:59],v[196:199],a[144:147],v[56:59]
 ds_read_b128 a[152:155],v178 offset:4096
 ds_read_b128 a[216:219],v178 offset:6144
 M v[60:63],v[196:199],a[208:211],v[60:63]
 W 10
 v_sub_f32 v154,v138,v153
 v_fmac_f32 v156,v154,v154
 M v[0:3],v[200:203],a[20:23],v[0:3]
 T v[192:193],v225,8192
 T v[194:195],v225,9216
 M v[4:7],v[200:203],a[84:87],v[4:7]
 buffer_load_dwordx4 v182,s[16:19],s68 offen offset:2048 lds
 v_sub_f32 v154,v139,v153
 M v[8:11],v[200:203],a[148:151],v[8:11]
 ds_read_b128 a[28:31],v179 offset:0
 ds_read_b128 a[92:95],v179 offset:2048
 M v[12:15],v[200:203],a[212:215],v[12:15]
 W 12
 v_fmac_f32 v156,v154,v154
 v_sub_f32 v154,v140,v153
 M v[16:19],v[204:207],a[20:23],v[16:19]
 T v[196:197],v226,8192
 T v[198:199],v226,9216
 M v[20:23],v[204:207],a[84:87],v[20:23]
 buffer_load_dwordx4 v183,s[16:19],s68 offen offset:3072 lds
 v_fmac_f32 v156,v154,v154
 M v[24:27],v[204:207],a[148:151],v[24:27]
 ds_read_b128 a[156:159],v179 offset:4096
 ds_read_b128 a[220:223],v179 offset:6144
 M v[28:31],v[204:207],a[212:215],v[28:31]
 W 14
 v_sub_f32 v154,v141,v153
 v_fmac_f32 v156,v154,v154
 M v[32:35],v[208:211],a[20:23],v[32:35]
 T v[200:201],v227,8192
 T v[202:203],v227,9216
 M v[36:39],v[208:211],a[84:87],v[36:39]
 s_add_u32 m0,s77,20480
 s_add_u32 s68,s75,33408
 buffer_load_dwordx4 v180,s[16:19],s68 offen offset:0 lds
 M v[40:43],v[208:211],a[148:151],v[40:43]
 v_sub_f32 v154,v142,v153
 v_fmac_f32 v156,v154,v154
 M v[44:47],v[208:211],a[212:215],v[44:47]
 W 12
 v_sub_f32 v154,v143,v153
 v_fmac_f32 v156,v154,v154
 M v[48:51],v[212:215],a[20:23],v[48:51]
 T v[204:205],v228,8192
 T v[206:207],v228,9216
 M v[52:55],v[212:215],a[84:87],v[52:55]
 buffer_load_dwordx4 v181,s[16:19],s68 offen offset:1024 lds
 v_add_f32_dpp v156,v156,v156 quad_perm:[1,0,3,2] row_mask:0xf bank_mask:0xf
 M v[56:59],v[212:215],a[148:151],v[56:59]
 s_nop 0
 v_add_f32_dpp v156,v156,v156 quad_perm:[2,3,0,1] row_mask:0xf bank_mask:0xf
 s_nop 1
 v_add_f32_dpp v156,v156,v156 row_half_mirror row_mask:0xf bank_mask:0xf
 M v[60:63],v[212:215],a[212:215],v[60:63]
 W 10
 v_add_f32_dpp v156,v156,v156 row_mirror row_mask:0xf bank_mask:0xf
 v_mov_b32 v154,v156
 M v[0:3],v[192:195],a[24:27],v[0:3]
 T v[208:209],v225,12288
 T v[210:211],v225,13312
 M v[4:7],v[192:195],a[88:91],v[4:7]
 buffer_load_dwordx4 v182,s[16:19],s68 offen offset:2048 lds
 M v[8:11],v[192:195],a[152:155],v[8:11]
 v_permlane16_swap_b32 v156,v154
 M v[12:15],v[192:195],a[216:219],v[12:15]
 W 8
 v_add_f32 v156,v156,v154
 v_mul_f32 v156,0x3b000000,v156
 M v[16:19],v[196:199],a[24:27],v[16:19]
 T v[212:213],v226,12288
 T v[214:215],v226,13312
 M v[20:23],v[196:199],a[88:91],v[20:23]
 buffer_load_dwordx4 v183,s[16:19],s68 offen offset:3072 lds
 v_cvt_pk_bf16_f32 v156,v156,v156
 M v[24:27],v[196:199],a[152:155],v[24:27]
 v_and_b32 v156,0xffff0000,v156
 v_add_f32 v156,0x3727c5ac,v156
 M v[28:31],v[196:199],a[216:219],v[28:31]
 W 6
 v_cvt_pk_bf16_f32 v156,v156,v156
 v_and_b32 v156,0xffff0000,v156
 M v[32:35],v[200:203],a[24:27],v[32:35]
 T v[192:193],v227,12288
 T v[194:195],v227,13312
 M v[36:39],v[200:203],a[88:91],v[36:39]
 s_waitcnt vmcnt(10)
 v_sqrt_f32 v156,v156
 M v[40:43],v[200:203],a[152:155],v[40:43]
 ds_read_b128 a[32:35],v178 offset:8192
 ds_read_b128 a[96:99],v178 offset:10240
 M v[44:47],v[200:203],a[216:219],v[44:47]
 W 8
 v_cvt_pk_bf16_f32 v156,v156,v156
 v_and_b32 v156,0xffff0000,v156
 M v[48:51],v[204:207],a[24:27],v[48:51]
 T v[196:197],v228,12288
 T v[198:199],v228,13312
 M v[52:55],v[204:207],a[88:91],v[52:55]
 v_add_u32 v225,0x4000,v225
 v_add_u32 v226,0x4000,v226
 M v[56:59],v[204:207],a[152:155],v[56:59]
 v_add_u32 v227,0x4000,v227
 v_add_u32 v228,0x4000,v228
 ds_read_b128 a[160:163],v178 offset:12288
 ds_read_b128 a[224:227],v178 offset:14336
 M v[60:63],v[204:207],a[216:219],v[60:63]
 W 10
 s_barrier
 M v[0:3],v[208:211],a[28:31],v[0:3]
 T v[200:201],v225,0
 T v[202:203],v225,1024
 M v[4:7],v[208:211],a[92:95],v[4:7]
 s_add_u32 m0,s71,98304
 s_add_u32 s68,s74,3145728
 buffer_load_dwordx4 v233,s[20:23],s68 offen offset:0 lds
 M v[8:11],v[208:211],a[156:159],v[8:11]
 ds_read_b128 a[36:39],v179 offset:8192
 ds_read_b128 a[100:103],v179 offset:10240
 M v[12:15],v[208:211],a[220:223],v[12:15]
 W 12
 v_rcp_f32 v156,v156
 M v[16:19],v[212:215],a[28:31],v[16:19]
 T v[204:205],v226,0
 T v[206:207],v226,1024
 M v[20:23],v[212:215],a[92:95],v[20:23]
 buffer_load_dwordx4 v234,s[20:23],s68 offen offset:1024 lds
 v_sub_f32 v128,v128,v155
 M v[24:27],v[212:215],a[156:159],v[24:27]
 ds_read_b128 a[164:167],v179 offset:12288
 ds_read_b128 a[228:231],v179 offset:14336
 M v[28:31],v[212:215],a[220:223],v[28:31]
 W 14
 v_sub_f32 v129,v129,v155
 v_cvt_pk_bf16_f32 v154,v128,v129
 M v[32:35],v[192:195],a[28:31],v[32:35]
 T v[208:209],v227,0
 T v[210:211],v227,1024
 M v[36:39],v[192:195],a[92:95],v[36:39]
 buffer_load_dwordx4 v235,s[20:23],s68 offen offset:2048 lds
 v_lshlrev_b32 v128,16,v154
 M v[40:43],v[192:195],a[156:159],v[40:43]
 v_and_b32 v129,0xffff0000,v154
 v_mul_f32 v128,v128,v156
 M v[44:47],v[192:195],a[220:223],v[44:47]
 W 12
 v_mul_f32 v129,v129,v156
 v_cvt_pk_bf16_f32 v144,v128,v129
 M v[48:51],v[196:199],a[28:31],v[48:51]
 T v[212:213],v228,0
 T v[214:215],v228,1024
 M v[52:55],v[196:199],a[92:95],v[52:55]
 buffer_load_dwordx4 v236,s[20:23],s68 offen offset:3072 lds
 v_sub_f32 v130,v130,v155
 M v[56:59],v[196:199],a[156:159],v[56:59]
 v_sub_f32 v131,v131,v155
 v_cvt_pk_bf16_f32 v154,v130,v131
 M v[60:63],v[196:199],a[220:223],v[60:63]
 W 10
 v_lshlrev_b32 v130,16,v154
 v_and_b32 v131,0xffff0000,v154
 M v[0:3],v[200:203],a[32:35],v[0:3]
 T v[192:193],v229,0
 T v[194:195],v229,1024
 M v[4:7],v[200:203],a[96:99],v[4:7]
 s_add_u32 m0,s77,0
 s_add_u32 s68,s75,768
 buffer_load_dwordx4 v180,s[16:19],s68 offen offset:0 lds
 M v[8:11],v[200:203],a[160:163],v[8:11]
 v_mul_f32 v130,v130,v156
 v_mul_f32 v131,v131,v156
 M v[12:15],v[200:203],a[224:227],v[12:15]
 W 8
 v_cvt_pk_bf16_f32 v145,v130,v131
 v_sub_f32 v132,v132,v155
 M v[16:19],v[204:207],a[32:35],v[16:19]
 T v[196:197],v230,0
 T v[198:199],v230,1024
 M v[20:23],v[204:207],a[96:99],v[20:23]
 buffer_load_dwordx4 v181,s[16:19],s68 offen offset:1024 lds
 v_sub_f32 v133,v133,v155
 M v[24:27],v[204:207],a[160:163],v[24:27]
 v_cvt_pk_bf16_f32 v154,v132,v133
 v_lshlrev_b32 v132,16,v154
 M v[28:31],v[204:207],a[224:227],v[28:31]
 W 6
 v_and_b32 v133,0xffff0000,v154
 v_mul_f32 v132,v132,v156
 M v[32:35],v[208:211],a[32:35],v[32:35]
 T v[200:201],v231,0
 T v[202:203],v231,1024
 M v[36:39],v[208:211],a[96:99],v[36:39]
 buffer_load_dwordx4 v182,s[16:19],s68 offen offset:2048 lds
 v_mul_f32 v133,v133,v156
 M v[40:43],v[208:211],a[160:163],v[40:43]
 v_cvt_pk_bf16_f32 v146,v132,v133
 v_sub_f32 v134,v134,v155
 M v[44:47],v[208:211],a[224:227],v[44:47]
 W 6
 v_sub_f32 v135,v135,v155
 v_cvt_pk_bf16_f32 v154,v134,v135
 M v[48:51],v[212:215],a[32:35],v[48:51]
 T v[204:205],v232,0
 T v[206:207],v232,1024
 M v[52:55],v[212:215],a[96:99],v[52:55]
 buffer_load_dwordx4 v183,s[16:19],s68 offen offset:3072 lds
 v_lshlrev_b32 v134,16,v154
 M v[56:59],v[212:215],a[160:163],v[56:59]
 v_and_b32 v135,0xffff0000,v154
 v_mul_f32 v134,v134,v156
 M v[60:63],v[212:215],a[224:227],v[60:63]
 W 6
 v_mul_f32 v135,v135,v156
 v_cvt_pk_bf16_f32 v147,v134,v135
 M v[64:67],v[192:195],a[0:3],0
 T v[208:209],v225,4096
 T v[210:211],v225,5120
 M v[68:71],v[192:195],a[64:67],0
 s_add_u32 m0,s77,4096
 s_add_u32 s68,s75,33536
 buffer_load_dwordx4 v180,s[16:19],s68 offen offset:0 lds
 M v[72:75],v[192:195],a[128:131],0
 v_sub_f32 v136,v136,v155
 v_sub_f32 v137,v137,v155
 M v[76:79],v[192:195],a[192:195],0
 W 6
 v_cvt_pk_bf16_f32 v154,v136,v137
 v_lshlrev_b32 v136,16,v154
 M v[80:83],v[196:199],a[0:3],0
 T v[212:213],v226,4096
 T v[214:215],v226,5120
 M v[84:87],v[196:199],a[64:67],0
 buffer_load_dwordx4 v181,s[16:19],s68 offen offset:1024 lds
 v_and_b32 v137,0xffff0000,v154
 M v[88:91],v[196:199],a[128:131],0
 v_mul_f32 v136,v136,v156
 v_mul_f32 v137,v137,v156
 M v[92:95],v[196:199],a[192:195],0
 W 6
 v_cvt_pk_bf16_f32 v148,v136,v137
 v_sub_f32 v138,v138,v155
 M v[96:99],v[200:203],a[0:3],0
 T v[192:193],v227,4096
 T v[194:195],v227,5120
 M v[100:103],v[200:203],a[64:67],0
 s_waitcnt vmcnt(10)
 buffer_load_dwordx4 v182,s[16:19],s68 offen offset:2048 lds
 v_sub_f32 v139,v139,v155
 M v[104:107],v[200:203],a[128:131],0
 ds_read_b128 a[40:43],v178 offset:16384
 ds_read_b128 a[104:107],v178 offset:18432
 M v[108:111],v[200:203],a[192:195],0
 W 8
 v_cvt_pk_bf16_f32 v154,v138,v139
 v_lshlrev_b32 v138,16,v154
 M v[112:115],v[204:207],a[0:3],0
 T v[196:197],v228,4096
 T v[198:199],v228,5120
 M v[116:119],v[204:207],a[64:67],0
 buffer_load_dwordx4 v183,s[16:19],s68 offen offset:3072 lds
 v_and_b32 v139,0xffff0000,v154
 M v[120:123],v[204:207],a[128:131],0
 ds_read_b128 a[168:171],v178 offset:20480
 ds_read_b128 a[232:235],v178 offset:22528
 M v[124:127],v[204:207],a[192:195],0
 W 10
 s_barrier
 v_mul_f32 v138,v138,v156
 M v[0:3],v[208:211],a[36:39],v[0:3]
 T v[200:201],v229,4096
 T v[202:203],v229,5120
 M v[4:7],v[208:211],a[100:103],v[4:7]
 s_add_u32 m0,s71,114688
 s_add_u32 s68,s74,1048704
 buffer_load_dwordx4 v233,s[20:23],s68 offen offset:0 lds
 M v[8:11],v[208:211],a[164:167],v[8:11]
 ds_read_b128 a[44:47],v179 offset:16384
 ds_read_b128 a[108:111],v179 offset:18432
 M v[12:15],v[208:211],a[228:231],v[12:15]
 W 12
 v_mul_f32 v139,v139,v156
 v_cvt_pk_bf16_f32 v149,v138,v139
 M v[16:19],v[212:215],a[36:39],v[16:19]
 T v[204:205],v230,4096
 T v[206:207],v230,5120
 M v[20:23],v[212:215],a[100:103],v[20:23]
 buffer_load_dwordx4 v234,s[20:23],s68 offen offset:1024 lds
 M v[24:27],v[212:215],a[164:167],v[24:27]
 ds_read_b128 a[172:175],v179 offset:20480
 ds_read_b128 a[236:239],v179 offset:22528
 M v[28:31],v[212:215],a[228:231],v[28:31]
 W 14
 v_sub_f32 v140,v140,v155
 v_sub_f32 v141,v141,v155
 M v[32:35],v[192:195],a[36:39],v[32:35]
 T v[208:209],v231,4096
 T v[210:211],v231,5120
 M v[36:39],v[192:195],a[100:103],v[36:39]
 buffer_load_dwordx4 v235,s[20:23],s68 offen offset:2048 lds
 v_cvt_pk_bf16_f32 v154,v140,v141
 M v[40:43],v[192:195],a[164:167],v[40:43]
 v_lshlrev_b32 v140,16,v154
 v_and_b32 v141,0xffff0000,v154
 M v[44:47],v[192:195],a[228:231],v[44:47]
 W 12
 v_mul_f32 v140,v140,v156
 v_mul_f32 v141,v141,v156
 M v[48:51],v[196:199],a[36:39],v[48:51]
 T v[212:213],v232,4096
 T v[214:215],v232,5120
 M v[52:55],v[196:199],a[100:103],v[52:55]
 buffer_load_dwordx4 v236,s[20:23],s68 offen offset:3072 lds
 v_cvt_pk_bf16_f32 v150,v140,v141
 M v[56:59],v[196:199],a[164:167],v[56:59]
 v_sub_f32 v142,v142,v155
 v_sub_f32 v143,v143,v155
 M v[60:63],v[196:199],a[228:231],v[60:63]
 W 10
 v_cvt_pk_bf16_f32 v154,v142,v143
 v_lshlrev_b32 v142,16,v154
 M v[64:67],v[200:203],a[4:7],v[64:67]
 T v[192:193],v225,8192
 T v[194:195],v225,9216
 M v[68:71],v[200:203],a[68:71],v[68:71]
 s_add_u32 m0,s77,8192
 s_add_u32 s68,s75,896
 buffer_load_dwordx4 v180,s[16:19],s68 offen offset:0 lds
 M v[72:75],v[200:203],a[132:135],v[72:75]
 v_and_b32 v143,0xffff0000,v154
 v_mul_f32 v142,v142,v156
 M v[76:79],v[200:203],a[196:199],v[76:79]
 W 8
 v_mul_f32 v143,v143,v156
 v_cvt_pk_bf16_f32 v151,v142,v143
 M v[80:83],v[204:207],a[4:7],v[80:83]
 T v[196:197],v226,8192
 T v[198:199],v226,9216
 M v[84:87],v[204:207],a[68:71],v[84:87]
 buffer_load_dwordx4 v181,s[16:19],s68 offen offset:1024 lds
 M v[88:91],v[204:207],a[132:135],v[88:91]
 M v[92:95],v[204:207],a[196:199],v[92:95]
 W 6
 M v[96:99],v[208:211],a[4:7],v[96:99]
 T v[200:201],v227,8192
 T v[202:203],v227,9216
 M v[100:103],v[208:211],a[68:71],v[100:103]
 buffer_load_dwordx4 v182,s[16:19],s68 offen offset:2048 lds
 M v[104:107],v[208:211],a[132:135],v[104:107]
 M v[108:111],v[208:211],a[196:199],v[108:111]
 W 6
 M v[112:115],v[212:215],a[4:7],v[112:115]
 T v[204:205],v228,8192
 T v[206:207],v228,9216
 M v[116:119],v[212:215],a[68:71],v[116:119]
 buffer_load_dwordx4 v183,s[16:19],s68 offen offset:3072 lds
 M v[120:123],v[212:215],a[132:135],v[120:123]
 M v[124:127],v[212:215],a[196:199],v[124:127]
 W 6
 M v[0:3],v[192:195],a[40:43],v[0:3]
 T v[208:209],v229,8192
 T v[210:211],v229,9216
 M v[4:7],v[192:195],a[104:107],v[4:7]
 s_add_u32 m0,s77,12288
 s_add_u32 s68,s75,33664
 buffer_load_dwordx4 v180,s[16:19],s68 offen offset:0 lds
 M v[8:11],v[192:195],a[168:171],v[8:11]
 M v[12:15],v[192:195],a[232:235],v[12:15]
 W 6
 M v[16:19],v[196:199],a[40:43],v[16:19]
 T v[212:213],v230,8192
 T v[214:215],v230,9216
 M v[20:23],v[196:199],a[104:107],v[20:23]
 buffer_load_dwordx4 v181,s[16:19],s68 offen offset:1024 lds
 M v[24:27],v[196:199],a[168:171],v[24:27]
 M v[28:31],v[196:199],a[232:235],v[28:31]
 W 6
 M v[32:35],v[200:203],a[40:43],v[32:35]
 T v[192:193],v231,8192
 T v[194:195],v231,9216
 M v[36:39],v[200:203],a[104:107],v[36:39]
 s_waitcnt vmcnt(10)
 buffer_load_dwordx4 v182,s[16:19],s68 offen offset:2048 lds
 M v[40:43],v[200:203],a[168:171],v[40:43]
 ds_read_b128 a[48:51],v178 offset:0
 ds_read_b128 a[112:115],v178 offset:2048
 M v[44:47],v[200:203],a[232:235],v[44:47]
 W 8
 M v[48:51],v[204:207],a[40:43],v[48:51]
 T v[196:197],v232,8192
 T v[198:199],v232,9216
 M v[52:55],v[204:207],a[104:107],v[52:55]
 buffer_load_dwordx4 v183,s[16:19],s68 offen offset:3072 lds
 M v[56:59],v[204:207],a[168:171],v[56:59]
 ds_read_b128 a[176:179],v178 offset:4096
 ds_read_b128 a[240:243],v178 offset:6144
 M v[60:63],v[204:207],a[232:235],v[60:63]
 W 10
 M v[64:67],v[208:211],a[8:11],v[64:67]
 T v[200:201],v225,12288
 T v[202:203],v225,13312
 M v[68:71],v[208:211],a[72:75],v[68:71]
 v_lshrrev_b32 v170,7,v224
 v_lshlrev_b32 v170,13,v170
 buffer_load_dword v217,v216,s[60:63],0 offen sc1
 M v[72:75],v[208:211],a[136:139],v[72:75]
 ds_read_b128 a[52:55],v179 offset:0
 ds_read_b128 a[116:119],v179 offset:2048
 v_bfe_u32 v171,v224,5,2
 v_lshl_add_u32 v170,v171,9,v170
 M v[76:79],v[208:211],a[200:203],v[76:79]
 W 12
 v_bfe_u32 v171,v224,4,1
 v_lshl_add_u32 v170,v171,7,v170
 M v[80:83],v[212:215],a[8:11],v[80:83]
 T v[204:205],v226,12288
 T v[206:207],v226,13312
 M v[84:87],v[212:215],a[72:75],v[84:87]
 buffer_load_dword v221,v170,s[20:23],s99 offen offset:256
 M v[88:91],v[212:215],a[136:139],v[88:91]
 ds_read_b128 a[180:183],v179 offset:4096
 ds_read_b128 a[244:247],v179 offset:6144
 M v[92:95],v[212:215],a[200:203],v[92:95]
 W 14
 M v[96:99],v[192:195],a[8:11],v[96:99]
 T v[208:209],v227,12288
 T v[210:211],v227,13312
 M v[100:103],v[192:195],a[72:75],v[100:103]
 M v[104:107],v[192:195],a[136:139],v[104:107]
 M v[108:111],v[192:195],a[200:203],v[108:111]
 W 12
 M v[112:115],v[196:199],a[8:11],v[112:115]
 T v[212:213],v228,12288
 T v[214:215],v228,13312
 M v[116:119],v[196:199],a[72:75],v[116:119]
 M v[120:123],v[196:199],a[136:139],v[120:123]
 M v[124:127],v[196:199],a[200:203],v[124:127]
 W 10
 M v[0:3],v[200:203],a[44:47],v[0:3]
 T v[192:193],v229,12288
 T v[194:195],v229,13312
 M v[4:7],v[200:203],a[108:111],v[4:7]
 M v[8:11],v[200:203],a[172:175],v[8:11]
 M v[12:15],v[200:203],a[236:239],v[12:15]
 W 8
 M v[16:19],v[204:207],a[44:47],v[16:19]
 T v[196:197],v230,12288
 T v[198:199],v230,13312
 M v[20:23],v[204:207],a[108:111],v[20:23]
 M v[24:27],v[204:207],a[172:175],v[24:27]
 M v[28:31],v[204:207],a[236:239],v[28:31]
 W 6
 M v[32:35],v[208:211],a[44:47],v[32:35]
 T v[200:201],v231,12288
 T v[202:203],v231,13312
 M v[36:39],v[208:211],a[108:111],v[36:39]
 M v[40:43],v[208:211],a[172:175],v[40:43]
 M v[44:47],v[208:211],a[236:239],v[44:47]
 W 6
 M v[48:51],v[212:215],a[44:47],v[48:51]
 T v[204:205],v232,12288
 T v[206:207],v232,13312
 M v[52:55],v[212:215],a[108:111],v[52:55]
 v_add_u32 v225,0xffff8000,v225
 v_add_u32 v226,0xffff8000,v226
 M v[56:59],v[212:215],a[172:175],v[56:59]
 v_add_u32 v227,0xffff8000,v227
 v_add_u32 v228,0xffff8000,v228
 M v[60:63],v[212:215],a[236:239],v[60:63]
 W 6
 s_waitcnt vmcnt(10)
 s_barrier
 M v[64:67],v[192:195],a[12:15],v[64:67]
 T v[208:209],v225,0
 T v[210:211],v225,1024
 M v[68:71],v[192:195],a[76:79],v[68:71]
 s_add_u32 m0,s71,131072
 s_add_u32 s68,s74,2097280
 buffer_load_dwordx4 v233,s[20:23],s68 offen offset:0 lds
 M v[72:75],v[192:195],a[140:143],v[72:75]
 ds_write_b128 v152,v[144:147]
 ds_write_b128 v152,v[148:151] offset:4096
 M v[76:79],v[192:195],a[204:207],v[76:79]
 W 8
 M v[80:83],v[196:199],a[12:15],v[80:83]
 T v[212:213],v226,0
 T v[214:215],v226,1024
 M v[84:87],v[196:199],a[76:79],v[84:87]
 buffer_load_dwordx4 v234,s[20:23],s68 offen offset:1024 lds
 M v[88:91],v[196:199],a[140:143],v[88:91]
 M v[92:95],v[196:199],a[204:207],v[92:95]
 W 8
 M v[96:99],v[200:203],a[12:15],v[96:99]
 T v[192:193],v227,0
 T v[194:195],v227,1024
 M v[100:103],v[200:203],a[76:79],v[100:103]
 s_waitcnt vmcnt(4)
 buffer_load_dwordx4 v235,s[20:23],s68 offen offset:2048 lds
 M v[104:107],v[200:203],a[140:143],v[104:107]
 ds_read_b128 a[56:59],v178 offset:8192
 ds_read_b128 a[120:123],v178 offset:10240
 M v[108:111],v[200:203],a[204:207],v[108:111]
 W 10
 M v[112:115],v[204:207],a[12:15],v[112:115]
 T v[196:197],v228,0
 T v[198:199],v228,1024
 M v[116:119],v[204:207],a[76:79],v[116:119]
 v_add_u32 v229,0xffff8000,v229
 v_add_u32 v230,0xffff8000,v230
 buffer_load_dwordx4 v236,s[20:23],s68 offen offset:3072 lds
 M v[120:123],v[204:207],a[140:143],v[120:123]
 v_add_u32 v231,0xffff8000,v231
 v_add_u32 v232,0xffff8000,v232
 ds_read_b128 a[184:187],v178 offset:12288
 ds_read_b128 a[248:251],v178 offset:14336
 M v[124:127],v[204:207],a[204:207],v[124:127]
 W 12
 M v[0:3],v[208:211],a[48:51],v[0:3]
 T v[200:201],v229,0
 T v[202:203],v229,1024
 M v[4:7],v[208:211],a[112:115],v[4:7]
 M v[8:11],v[208:211],a[176:179],v[8:11]
 ds_read_b128 a[60:63],v179 offset:8192
 ds_read_b128 a[124:127],v179 offset:10240
 M v[12:15],v[208:211],a[240:243],v[12:15]
 W 12
 M v[16:19],v[212:215],a[48:51],v[16:19]
 T v[204:205],v230,0
 T v[206:207],v230,1024
 M v[20:23],v[212:215],a[112:115],v[20:23]
 M v[24:27],v[212:215],a[176:179],v[24:27]
 ds_read_b128 a[188:191],v179 offset:12288
 ds_read_b128 a[252:255],v179 offset:14336
 M v[28:31],v[212:215],a[240:243],v[28:31]
 W 14
 M v[32:35],v[192:195],a[48:51],v[32:35]
 T v[208:209],v231,0
 T v[210:211],v231,1024
 M v[36:39],v[192:195],a[112:115],v[36:39]
 s_and_b32 s65,s2,7
 s_lshr_b32 s66,s2,5
 M v[40:43],v[192:195],a[176:179],v[40:43]
 s_bfe_u32 s67,s2,0x20003
 s_lshr_b32 s97,s2,3
 M v[44:47],v[192:195],a[240:243],v[44:47]
 W 12
 s_lshl_b32 s97,s97,2
 s_add_u32 s97,s97,s64
 M v[48:51],v[196:199],a[48:51],v[48:51]
 T v[212:213],v232,0
 T v[214:215],v232,1024
 M v[52:55],v[196:199],a[112:115],v[52:55]
 v_lshrrev_b32 v252,4,v224
 s_lshl_b32 s3,s65,2
 M v[56:59],v[196:199],a[176:179],v[56:59]
 s_add_u32 s3,s3,s67
 s_lshl_b32 s4,s67,1
 M v[60:63],v[196:199],a[240:243],v[60:63]
 W 10
 s_min_u32 s4,s4,5
 s_mul_i32 s90,s65,7
 M v[64:67],v[200:203],a[16:19],v[64:67]
 T v[192:193],v225,4096
 T v[194:195],v225,5120
 M v[68:71],v[200:203],a[80:83],v[68:71]
 s_add_u32 s4,s4,s90
 s_lshl_b32 s82,s66,3
 M v[72:75],v[200:203],a[144:147],v[72:75]
 s_lshl_b32 s90,s64,1
 s_add_u32 s82,s82,s90
 M v[76:79],v[200:203],a[208:211],v[76:79]
 W 8
 s_sub_u32 s83,15,s66
 s_lshl_b32 s83,s83,3
 M v[80:83],v[204:207],a[16:19],v[80:83]
 T v[196:197],v226,4096
 T v[198:199],v226,5120
 M v[84:87],v[204:207],a[80:83],v[84:87]
 s_add_u32 s83,s83,s90
 s_mul_i32 s86,s82,56
 M v[88:91],v[204:207],a[144:147],v[88:91]
 s_add_u32 s86,s86,s4
 s_lshl_b32 s86,s86,10
 M v[92:95],v[204:207],a[208:211],v[92:95]
 W 6
 s_add_u32 s86,s86,0x2700000
 s_mul_i32 s87,s83,56
 M v[96:99],v[208:211],a[16:19],v[96:99]
 T v[200:201],v227,4096
 T v[202:203],v227,5120
 M v[100:103],v[208:211],a[80:83],v[100:103]
 s_add_u32 s87,s87,s4
 s_lshl_b32 s87,s87,10
 M v[104:107],v[208:211],a[144:147],v[104:107]
 s_add_u32 s87,s87,0x2700000
 s_lshl_b32 s90,s3,12
 M v[108:111],v[208:211],a[208:211],v[108:111]
 W 6
 s_add_u32 s90,s90,0x3000000
 s_lshl_b32 s95,s82,17
 M v[112:115],v[212:215],a[16:19],v[112:115]
 T v[204:205],v228,4096
 T v[206:207],v228,5120
 M v[116:119],v[212:215],a[80:83],v[116:119]
 s_add_u32 s95,s95,s90
 s_mul_i32 s82,s82,17408
 M v[120:123],v[212:215],a[144:147],v[120:123]
 s_add_u32 s82,s82,0x2400000
 s_lshl_b32 s96,s83,17
 M v[124:127],v[212:215],a[208:211],v[124:127]
 W 6
 W 0
 s_barrier
 M v[0:3],v[192:195],a[52:55],v[0:3]
 T v[208:209],v229,4096
 T v[210:211],v229,5120
 M v[4:7],v[192:195],a[116:119],v[4:7]
 s_add_u32 m0,s71,0
 s_add_u32 s68,s74,256
 buffer_load_dwordx4 v233,s[20:23],s68 offen offset:0 lds
 M v[8:11],v[192:195],a[180:183],v[8:11]
 ds_read_b128 v[160:163],v157
 ds_read_b128 v[164:167],v157 offset:1024
 M v[12:15],v[192:195],a[244:247],v[12:15]
 s_add_u32 s96,s96,s90
 s_mul_i32 s83,s83,17408
 M v[16:19],v[196:199],a[52:55],v[16:19]
 T v[212:213],v230,4096
 T v[214:215],v230,5120
 M v[20:23],v[196:199],a[116:119],v[20:23]
 buffer_load_dwordx4 v234,s[20:23],s68 offen offset:1024 lds
 s_add_u32 s83,s83,0x2400000
 M v[24:27],v[196:199],a[180:183],v[24:27]
 s_lshl_b32 s81,s64,18
 s_lshl_b32 s90,s3,8
 M v[28:31],v[196:199],a[244:247],v[28:31]
 s_add_u32 s81,s81,s90
 s_lshl_b32 s89,s4,6
 M v[32:35],v[200:203],a[52:55],v[32:35]
 T v[192:193],v231,4096
 T v[194:195],v231,5120
 M v[36:39],v[200:203],a[116:119],v[36:39]
 buffer_load_dwordx4 v235,s[20:23],s68 offen offset:2048 lds
 s_mul_i32 s80,s64,114688
 M v[40:43],v[200:203],a[180:183],v[40:43]
 s_add_u32 s80,s80,s89
 s_mul_i32 s90,s3,557056
 M v[44:47],v[200:203],a[244:247],v[44:47]
 s_add_u32 s36,s8,s90
 s_addc_u32 s37,s9,0
 M v[48:51],v[204:207],a[52:55],v[48:51]
 T v[196:197],v232,4096
 T v[198:199],v232,5120
 M v[52:55],v[204:207],a[116:119],v[52:55]
 buffer_load_dwordx4 v236,s[20:23],s68 offen offset:3072 lds
 M v[56:59],v[204:207],a[180:183],v[56:59]
 s_add_u32 s40,s36,0x1200000
 s_addc_u32 s41,s37,0
 M v[60:63],v[204:207],a[244:247],v[60:63]
 W 8
 s_sub_u32 s90,16,s66
 s_mul_i32 s38,s90,34816
 M v[64:67],v[208:211],a[20:23],v[64:67]
 T v[200:201],v225,8192
 T v[202:203],v225,9216
 M v[68:71],v[208:211],a[84:87],v[68:71]
 s_add_u32 m0,s71,16384
 s_add_u32 s68,s74,3145856
 buffer_load_dwordx4 v233,s[20:23],s68 offen offset:0 lds
 M v[72:75],v[208:211],a[148:151],v[72:75]
 s_mov_b32 s42,s38
 s_mov_b32 s39,0x20000
 M v[76:79],v[208:211],a[212:215],v[76:79]
 W 6
 s_mov_b32 s43,0x20000
 s_lshl_b32 s73,s66,3
 M v[80:83],v[212:215],a[20:23],v[80:83]
 T v[204:205],v226,8192
 T v[206:207],v226,9216
 M v[84:87],v[212:215],a[84:87],v[84:87]
 buffer_load_dwordx4 v234,s[20:23],s68 offen offset:1024 lds
 s_add_u32 s73,s73,s65
 M v[88:91],v[212:215],a[148:151],v[88:91]
 s_lshl_b32 s73,s73,2
 s_add_u32 s73,s73,s64
 M v[92:95],v[212:215],a[212:215],v[92:95]
 W 6
 s_lshl_b32 s73,s73,2
 s_add_u32 s73,s73,s67
 M v[96:99],v[192:195],a[20:23],v[96:99]
 T v[208:209],v227,8192
 T v[210:211],v227,9216
 M v[100:103],v[192:195],a[84:87],v[100:103]
 buffer_load_dwordx4 v235,s[20:23],s68 offen offset:2048 lds
 s_lshl_b32 s73,s73,7
 M v[104:107],v[192:195],a[148:151],v[104:107]
 s_add_u32 s73,s73,0x6010000
 v_bfe_u32 v253,v252,2,1
 M v[108:111],v[192:195],a[212:215],v[108:111]
 W 6
 s_lshl_b32 s90,s66,12
 s_sub_u32 s90,30720,s90
 M v[112:115],v[196:199],a[20:23],v[112:115]
 T v[212:213],v228,8192
 T v[214:215],v228,9216
 M v[116:119],v[196:199],a[84:87],v[116:119]
 buffer_load_dwordx4 v236,s[20:23],s68 offen offset:3072 lds
 v_mul_lo_u32 v219,v253,s90
 M v[120:123],v[196:199],a[148:151],v[120:123]
 v_and_b32 v253,3,v252
 v_lshl_add_u32 v219,v253,7,v219
 M v[124:127],v[196:199],a[212:215],v[124:127]
 W 6
 s_lshl_b32 s90,s66,11
 s_lshl_b32 s70,s64,9
 M v[0:3],v[200:203],a[56:59],v[0:3]
 T v[192:193],v229,8192
 T v[194:195],v229,9216
 M v[4:7],v[200:203],a[120:123],v[4:7]
 s_add_u32 m0,s71,32768
 s_add_u32 s68,s74,1048832
 buffer_load_dwordx4 v233,s[20:23],s68 offen offset:0 lds
 M v[8:11],v[200:203],a[184:187],v[8:11]
 s_add_u32 s90,s90,s70
 s_add_u32 s90,s90,0x6000000
 M v[12:15],v[200:203],a[248:251],v[12:15]
 W 6
 v_add_u32 v219,s90,v219
 s_lshl_b32 s90,s65,1
 M v[16:19],v[204:207],a[56:59],v[16:19]
 T v[196:197],v230,8192
 T v[198:199],v230,9216
 M v[20:23],v[204:207],a[120:123],v[20:23]
 buffer_load_dwordx4 v234,s[20:23],s68 offen offset:1024 lds
 s_lshr_b32 s70,s67,1
 M v[24:27],v[204:207],a[184:187],v[24:27]
 s_add_u32 s90,s90,s70
 s_lshl_b32 s90,s90,11
 M v[28:31],v[204:207],a[248:251],v[28:31]
 W 6
 s_add_u32 s0,s90,0x6008000
 v_and_b32 v253,1,v252
 M v[32:35],v[208:211],a[56:59],v[32:35]
 T v[200:201],v231,8192
 T v[202:203],v231,9216
 M v[36:39],v[208:211],a[120:123],v[36:39]
 buffer_load_dwordx4 v235,s[20:23],s68 offen offset:2048 lds
 v_lshlrev_b32 v220,7,v253
 M v[40:43],v[208:211],a[184:187],v[40:43]
 M v[44:47],v[208:211],a[248:251],v[44:47]
 W 6
 M v[48:51],v[212:215],a[56:59],v[48:51]
 T v[204:205],v232,8192
 T v[206:207],v232,9216
 M v[52:55],v[212:215],a[120:123],v[52:55]
 buffer_load_dwordx4 v236,s[20:23],s68 offen offset:3072 lds
 M v[56:59],v[212:215],a[184:187],v[56:59]
 M v[60:63],v[212:215],a[248:251],v[60:63]
 W 6
 M v[64:67],v[192:195],a[24:27],v[64:67]
 T v[208:209],v225,12288
 T v[210:211],v225,13312
 M v[68:71],v[192:195],a[88:91],v[68:71]
 s_add_u32 m0,s71,49152
 s_add_u32 s68,s74,2097408
 buffer_load_dwordx4 v233,s[20:23],s68 offen offset:0 lds
 M v[72:75],v[192:195],a[152:155],v[72:75]
 M v[76:79],v[192:195],a[216:219],v[76:79]
 W 6
 M v[80:83],v[196:199],a[24:27],v[80:83]
 T v[212:213],v226,12288
 T v[214:215],v226,13312
 M v[84:87],v[196:199],a[88:91],v[84:87]
 buffer_load_dwordx4 v234,s[20:23],s68 offen offset:1024 lds
 M v[88:91],v[196:199],a[152:155],v[88:91]
 M v[92:95],v[196:199],a[216:219],v[92:95]
 W 6
 M v[96:99],v[200:203],a[24:27],v[96:99]
 T v[192:193],v227,12288
 T v[194:195],v227,13312
 M v[100:103],v[200:203],a[88:91],v[100:103]
 buffer_load_dwordx4 v235,s[20:23],s68 offen offset:2048 lds
 M v[104:107],v[200:203],a[152:155],v[104:107]
 M v[108:111],v[200:203],a[216:219],v[108:111]
 W 6
 M v[112:115],v[204:207],a[24:27],v[112:115]
 T v[196:197],v228,12288
 T v[198:199],v228,13312
 M v[116:119],v[204:207],a[88:91],v[116:119]
 buffer_load_dwordx4 v236,s[20:23],s68 offen offset:3072 lds
 M v[120:123],v[204:207],a[152:155],v[120:123]
 M v[124:127],v[204:207],a[216:219],v[124:127]
 W 6
 M v[0:3],v[208:211],a[60:63],v[0:3]
 T v[200:201],v229,12288
 T v[202:203],v229,13312
 M v[4:7],v[208:211],a[124:127],v[4:7]
 s_add_u32 m0,s71,65536
 s_add_u32 s68,s74,384
 buffer_load_dwordx4 v233,s[20:23],s68 offen offset:0 lds
 M v[8:11],v[208:211],a[188:191],v[8:11]
 M v[12:15],v[208:211],a[252:255],v[12:15]
 W 6
 M v[16:19],v[212:215],a[60:63],v[16:19]
 T v[204:205],v230,12288
 T v[206:207],v230,13312
 M v[20:23],v[212:215],a[124:127],v[20:23]
 buffer_load_dwordx4 v234,s[20:23],s68 offen offset:1024 lds
 M v[24:27],v[212:215],a[188:191],v[24:27]
 M v[28:31],v[212:215],a[252:255],v[28:31]
 W 6
 M v[32:35],v[192:195],a[60:63],v[32:35]
 T v[208:209],v231,12288
 T v[210:211],v231,13312
 M v[36:39],v[192:195],a[124:127],v[36:39]
 buffer_load_dwordx4 v235,s[20:23],s68 offen offset:2048 lds
 M v[40:43],v[192:195],a[188:191],v[40:43]
 M v[44:47],v[192:195],a[252:255],v[44:47]
 W 6
 M v[48:51],v[196:199],a[60:63],v[48:51]
 T v[212:213],v232,12288
 T v[214:215],v232,13312
 M v[52:55],v[196:199],a[124:127],v[52:55]
 v_add_u32 v229,0x4000,v229
 v_add_u32 v230,0x4000,v230
 buffer_load_dwordx4 v236,s[20:23],s68 offen offset:3072 lds
 M v[56:59],v[196:199],a[188:191],v[56:59]
 v_add_u32 v231,0x4000,v231
 v_add_u32 v232,0x4000,v232
 M v[60:63],v[196:199],a[252:255],v[60:63]
 W 6
 s_waitcnt vmcnt(16)
 s_barrier
 M v[64:67],v[200:203],a[28:31],v[64:67]
 T v[192:193],v229,0
 T v[194:195],v229,1024
 M v[68:71],v[200:203],a[92:95],v[68:71]
 buffer_store_dwordx4 v[160:163],v158,s[8:11],s98 offen sc0 sc1
 M v[72:75],v[200:203],a[156:159],v[72:75]
 M v[76:79],v[200:203],a[220:223],v[76:79]
 W 6
 M v[80:83],v[204:207],a[28:31],v[80:83]
 T v[196:197],v230,0
 T v[198:199],v230,1024
 M v[84:87],v[204:207],a[92:95],v[84:87]
 buffer_store_dwordx4 v[164:167],v158,s[8:11],s98 offen offset:2048 sc0 sc1
 M v[88:91],v[204:207],a[156:159],v[88:91]
 M v[92:95],v[204:207],a[220:223],v[92:95]
 W 6
 M v[96:99],v[208:211],a[28:31],v[96:99]
 T v[200:201],v231,0
 T v[202:203],v231,1024
 M v[100:103],v[208:211],a[92:95],v[100:103]
 s_add_u32 m0,s71,81920
 s_add_u32 s68,s74,3145984
 buffer_load_dwordx4 v233,s[20:23],s68 offen offset:0 lds
 M v[104:107],v[208:211],a[156:159],v[104:107]
 M v[108:111],v[208:211],a[220:223],v[108:111]
 W 6
 M v[112:115],v[212:215],a[28:31],v[112:115]
 T v[204:205],v232,0
 T v[206:207],v232,1024
 M v[116:119],v[212:215],a[92:95],v[116:119]
 v_add_u32 v225,0xfffe8000,v225
 v_add_u32 v226,0xfffe8000,v226
 buffer_load_dwordx4 v234,s[20:23],s68 offen offset:1024 lds
 M v[120:123],v[212:215],a[156:159],v[120:123]
 v_add_u32 v227,0xfffe8000,v227
 v_add_u32 v228,0xfffe8000,v228
 M v[124:127],v[212:215],a[220:223],v[124:127]
 W 6
 M v[64:67],v[192:195],a[32:35],v[64:67]
 T v[208:209],v225,0
 T v[210:211],v225,1024
 M v[68:71],v[192:195],a[96:99],v[68:71]
 buffer_load_dwordx4 v235,s[20:23],s68 offen offset:2048 lds
 M v[72:75],v[192:195],a[160:163],v[72:75]
 M v[76:79],v[192:195],a[224:227],v[76:79]
 W 6
 M v[80:83],v[196:199],a[32:35],v[80:83]
 T v[212:213],v226,0
 T v[214:215],v226,1024
 M v[84:87],v[196:199],a[96:99],v[84:87]
 buffer_load_dwordx4 v236,s[20:23],s68 offen offset:3072 lds
 M v[88:91],v[196:199],a[160:163],v[88:91]
 M v[92:95],v[196:199],a[224:227],v[92:95]
 W 6
 M v[96:99],v[200:203],a[32:35],v[96:99]
 T v[192:193],v227,0
 T v[194:195],v227,1024
 M v[100:103],v[200:203],a[96:99],v[100:103]
 s_add_u32 m0,s71,147456
 s_add_u32 s68,s74,1048960
 buffer_load_dwordx4 v233,s[20:23],s68 offen offset:0 lds
 M v[104:107],v[200:203],a[160:163],v[104:107]
 v_mul_f32 v56,s78,v56
 v_mul_f32 v57,s78,v57
 M v[108:111],v[200:203],a[224:227],v[108:111]
 W 6
 v_mul_f32 v58,s78,v58
 v_mul_f32 v59,s78,v59
 M v[112:115],v[204:207],a[32:35],v[112:115]
 T v[196:197],v228,0
 T v[198:199],v228,1024
 M v[116:119],v[204:207],a[96:99],v[116:119]
 buffer_load_dwordx4 v234,s[20:23],s68 offen offset:1024 lds
 v_mul_f32 v60,s78,v60
 M v[120:123],v[204:207],a[160:163],v[120:123]
 v_mul_f32 v61,s78,v61
 v_mul_f32 v62,s78,v62
 M v[124:127],v[204:207],a[224:227],v[124:127]
 W 6
 v_mul_f32 v63,s78,v63
 v_cvt_pk_bf16_f32 v244,v56,v57
 M v[128:131],v[208:211],a[0:3],0
 T v[200:201],v229,4096
 T v[202:203],v229,5120
 M v[132:135],v[208:211],a[64:67],0
 buffer_load_dwordx4 v235,s[20:23],s68 offen offset:2048 lds
 v_cvt_pk_bf16_f32 v246,v60,v61
 M v[136:139],v[208:211],a[128:131],0
 v_cvt_pk_bf16_f32 v245,v58,v59
 v_cvt_pk_bf16_f32 v247,v62,v63
 M v[140:143],v[208:211],a[192:195],0
 W 6
 s_add_u32 s90,s76,8192
 M v[144:147],v[212:215],a[0:3],0
 T v[204:205],v230,4096
 T v[206:207],v230,5120
 M v[148:151],v[212:215],a[64:67],0
 buffer_load_dwordx4 v236,s[20:23],s68 offen offset:3072 lds
 M v[152:155],v[212:215],a[128:131],0
 v_permlane16_swap_b32 v244,v246
 M v[156:159],v[212:215],a[192:195],0
 W 6
 v_permlane16_swap_b32 v245,v247
 M v[160:163],v[192:195],a[0:3],0
 T v[208:209],v231,4096
 T v[210:211],v231,5120
 M v[164:167],v[192:195],a[64:67],0
 buffer_store_dwordx4 v[244:247],v224,s[8:11],s90 offen offset:3072 sc0 sc1
 M v[168:171],v[192:195],a[128:131],0
 M v[172:175],v[192:195],a[192:195],0
 W 6
 M v[176:179],v[196:199],a[0:3],0
 T v[212:213],v232,4096
 T v[214:215],v232,5120
 M v[180:183],v[196:199],a[64:67],0
 M v[184:187],v[196:199],a[128:131],0
 M v[188:191],v[196:199],a[192:195],0
 W 6
 M v[64:67],v[200:203],a[36:39],v[64:67]
 T v[192:193],v225,4096
 T v[194:195],v225,5120
 M v[68:71],v[200:203],a[100:103],v[68:71]
 M v[72:75],v[200:203],a[164:167],v[72:75]
 M v[76:79],v[200:203],a[228:231],v[76:79]
 W 6
 M v[80:83],v[204:207],a[36:39],v[80:83]
 T v[196:197],v226,4096
 T v[198:199],v226,5120
 M v[84:87],v[204:207],a[100:103],v[84:87]
 v_mul_f32 v24,s78,v24
 v_mul_f32 v25,s78,v25
 M v[88:91],v[204:207],a[164:167],v[88:91]
 v_mul_f32 v26,s78,v26
 v_mul_f32 v27,s78,v27
 M v[92:95],v[204:207],a[228:231],v[92:95]
 W 6
 v_mul_f32 v28,s78,v28
 v_mul_f32 v29,s78,v29
 M v[96:99],v[208:211],a[36:39],v[96:99]
 T v[200:201],v227,4096
 T v[202:203],v227,5120
 M v[100:103],v[208:211],a[100:103],v[100:103]
 v_mul_f32 v30,s78,v30
 v_mul_f32 v31,s78,v31
 M v[104:107],v[208:211],a[164:167],v[104:107]
 v_cvt_pk_bf16_f32 v248,v24,v25
 v_cvt_pk_bf16_f32 v250,v28,v29
 M v[108:111],v[208:211],a[228:231],v[108:111]
 W 6
 v_cvt_pk_bf16_f32 v249,v26,v27
 v_cvt_pk_bf16_f32 v251,v30,v31
 M v[112:115],v[212:215],a[36:39],v[112:115]
 T v[204:205],v228,4096
 T v[206:207],v228,5120
 M v[116:119],v[212:215],a[100:103],v[116:119]
 s_add_u32 s90,s76,8192
 M v[120:123],v[212:215],a[164:167],v[120:123]
 v_permlane16_swap_b32 v248,v250
 M v[124:127],v[212:215],a[228:231],v[124:127]
 W 6
 v_permlane16_swap_b32 v249,v251
 M v[128:131],v[192:195],a[4:7],v[128:131]
 T v[208:209],v229,8192
 T v[210:211],v229,9216
 M v[132:135],v[192:195],a[68:71],v[132:135]
 buffer_store_dwordx4 v[248:251],v224,s[8:11],s90 offen offset:1024 sc0 sc1
 M v[136:139],v[192:195],a[132:135],v[136:139]
 M v[140:143],v[192:195],a[196:199],v[140:143]
 W 6
 M v[144:147],v[196:199],a[4:7],v[144:147]
 T v[212:213],v230,8192
 T v[214:215],v230,9216
 M v[148:151],v[196:199],a[68:71],v[148:151]
 M v[152:155],v[196:199],a[132:135],v[152:155]
 M v[156:159],v[196:199],a[196:199],v[156:159]
 W 6
 M v[160:163],v[200:203],a[4:7],v[160:163]
 T v[192:193],v231,8192
 T v[194:195],v231,9216
 M v[164:167],v[200:203],a[68:71],v[164:167]
 M v[168:171],v[200:203],a[132:135],v[168:171]
 v_cmp_eq_u32 vcc,0,v217
 s_cbranch_vccz PL_ok1
 s_mov_b32 s69,0x100000
PL_sp1:
 s_sleep 2
 buffer_load_dword v217,v216,s[60:63],0 offen sc1
 s_waitcnt vmcnt(0)
 v_cmp_eq_u32 vcc,0,v217
 s_cbranch_vccz PL_ok1
 s_sub_u32 s69,s69,1
 s_cbranch_scc0 PL_sp1
PL_ok1:
 v_readfirstlane_b32 s62,v217
 M v[172:175],v[200:203],a[196:199],v[172:175]
 W 6
 M v[176:179],v[204:207],a[4:7],v[176:179]
 T v[196:197],v232,8192
 T v[198:199],v232,9216
 M v[180:183],v[204:207],a[68:71],v[180:183]
 M v[184:187],v[204:207],a[132:135],v[184:187]
 M v[188:191],v[204:207],a[196:199],v[188:191]
 W 6
 M v[64:67],v[208:211],a[40:43],v[64:67]
 T v[200:201],v225,8192
 T v[202:203],v225,9216
 M v[68:71],v[208:211],a[104:107],v[68:71]
 v_mul_f32 v0,s78,v0
 v_mul_f32 v1,s78,v1
 M v[72:75],v[208:211],a[168:171],v[72:75]
 v_mul_f32 v2,s78,v2
 v_mul_f32 v3,s78,v3
 M v[76:79],v[208:211],a[232:235],v[76:79]
 W 6
 v_mul_f32 v4,s78,v4
 v_mul_f32 v5,s78,v5
 M v[80:83],v[212:215],a[40:43],v[80:83]
 T v[204:205],v226,8192
 T v[206:207],v226,9216
 M v[84:87],v[212:215],a[104:107],v[84:87]
 v_mul_f32 v6,s78,v6
 v_mul_f32 v7,s78,v7
 M v[88:91],v[212:215],a[168:171],v[88:91]
 v_cvt_pk_bf16_f32 v244,v0,v1
 v_cvt_pk_bf16_f32 v246,v4,v5
 M v[92:95],v[212:215],a[232:235],v[92:95]
 W 6
 v_cvt_pk_bf16_f32 v245,v2,v3
 v_cvt_pk_bf16_f32 v247,v6,v7
 M v[96:99],v[192:195],a[40:43],v[96:99]
 T v[208:209],v227,8192
 T v[210:211],v227,9216
 M v[100:103],v[192:195],a[104:107],v[100:103]
 s_add_u32 s90,s76,0
 M v[104:107],v[192:195],a[168:171],v[104:107]
 v_permlane16_swap_b32 v244,v246
 M v[108:111],v[192:195],a[232:235],v[108:111]
 W 6
 v_permlane16_swap_b32 v245,v247
 M v[112:115],v[196:199],a[40:43],v[112:115]
 T v[212:213],v228,8192
 T v[214:215],v228,9216
 M v[116:119],v[196:199],a[104:107],v[116:119]
 buffer_store_dwordx4 v[244:247],v224,s[8:11],s90 offen offset:0 sc0 sc1
 M v[120:123],v[196:199],a[168:171],v[120:123]
 M v[124:127],v[196:199],a[232:235],v[124:127]
 W 6
 M v[128:131],v[200:203],a[8:11],v[128:131]
 T v[192:193],v229,12288
 T v[194:195],v229,13312
 M v[132:135],v[200:203],a[72:75],v[132:135]
 M v[136:139],v[200:203],a[136:139],v[136:139]
 M v[140:143],v[200:203],a[200:203],v[140:143]
 W 6
 M v[144:147],v[204:207],a[8:11],v[144:147]
 T v[196:197],v230,12288
 T v[198:199],v230,13312
 M v[148:151],v[204:207],a[72:75],v[148:151]
 M v[152:155],v[204:207],a[136:139],v[152:155]
 M v[156:159],v[204:207],a[200:203],v[156:159]
 W 6
 M v[160:163],v[208:211],a[8:11],v[160:163]
 T v[200:201],v231,12288
 T v[202:203],v231,13312
 M v[164:167],v[208:211],a[72:75],v[164:167]
 M v[168:171],v[208:211],a[136:139],v[168:171]
 M v[172:175],v[208:211],a[200:203],v[172:175]
 W 6
 M v[176:179],v[212:215],a[8:11],v[176:179]
 T v[204:205],v232,12288
 T v[206:207],v232,13312
 M v[180:183],v[212:215],a[72:75],v[180:183]
 v_mul_f32 v16,s78,v16
 v_mul_f32 v17,s78,v17
 M v[184:187],v[212:215],a[136:139],v[184:187]
 v_mul_f32 v18,s78,v18
 v_mul_f32 v19,s78,v19
 M v[188:191],v[212:215],a[200:203],v[188:191]
 W 6
 v_mul_f32 v20,s78,v20
 v_mul_f32 v21,s78,v21
 M v[64:67],v[192:195],a[44:47],v[64:67]
 T v[208:209],v225,12288
 T v[210:211],v225,13312
 M v[68:71],v[192:195],a[108:111],v[68:71]
 v_mul_f32 v22,s78,v22
 v_mul_f32 v23,s78,v23
 M v[72:75],v[192:195],a[172:175],v[72:75]
 v_cvt_pk_bf16_f32 v248,v16,v17
 v_cvt_pk_bf16_f32 v250,v20,v21
 M v[76:79],v[192:195],a[236:239],v[76:79]
 W 6
 v_cvt_pk_bf16_f32 v249,v18,v19
 v_cvt_pk_bf16_f32 v251,v22,v23
 M v[80:83],v[196:199],a[44:47],v[80:83]
 T v[212:213],v226,12288
 T v[214:215],v226,13312
 M v[84:87],v[196:199],a[108:111],v[84:87]
 buffer_load_dword v221,v222,s[32:35],s89 offen
 s_add_u32 s90,s76,0
 M v[88:91],v[196:199],a[172:175],v[88:91]
 v_permlane16_swap_b32 v248,v250
 M v[92:95],v[196:199],a[236:239],v[92:95]
 W 6
 v_permlane16_swap_b32 v249,v251
 M v[96:99],v[200:203],a[44:47],v[96:99]
 T v[192:193],v227,12288
 T v[194:195],v227,13312
 M v[100:103],v[200:203],a[108:111],v[100:103]
 buffer_store_dwordx4 v[248:251],v224,s[8:11],s90 offen offset:1024 sc0 sc1
 M v[104:107],v[200:203],a[172:175],v[104:107]
 M v[108:111],v[200:203],a[236:239],v[108:111]
 W 6
 M v[112:115],v[204:207],a[44:47],v[112:115]
 T v[196:197],v228,12288
 T v[198:199],v228,13312
 M v[116:119],v[204:207],a[108:111],v[116:119]
 v_add_u32 v229,0xfffe4000,v229
 v_add_u32 v230,0xfffe4000,v230
 M v[120:123],v[204:207],a[172:175],v[120:123]
 v_add_u32 v231,0xfffe4000,v231
 v_add_u32 v232,0xfffe4000,v232
 M v[124:127],v[204:207],a[236:239],v[124:127]
 W 6
 s_waitcnt vmcnt(13)
 s_barrier
 M v[128:131],v[208:211],a[12:15],v[128:131]
 T v[200:201],v229,0
 T v[202:203],v229,1024
 M v[132:135],v[208:211],a[76:79],v[132:135]
 v_mov_b32 v218,s62
 v_add_u32 v218,1,v218
 buffer_store_dword v218,v216,s[8:11],s5 offen sc0 sc1
 s_add_u32 m0,s71,98304
 s_add_u32 s68,s74,2097536
 buffer_load_dwordx4 v233,s[20:23],s68 offen offset:0 lds
 M v[136:139],v[208:211],a[140:143],v[136:139]
 M v[140:143],v[208:211],a[204:207],v[140:143]
 W 6
 M v[144:147],v[212:215],a[12:15],v[144:147]
 T v[204:205],v230,0
 T v[206:207],v230,1024
 M v[148:151],v[212:215],a[76:79],v[148:151]
 buffer_load_dwordx4 v234,s[20:23],s68 offen offset:1024 lds
 M v[152:155],v[212:215],a[140:143],v[152:155]
 M v[156:159],v[212:215],a[204:207],v[156:159]
 W 6
 M v[160:163],v[192:195],a[12:15],v[160:163]
 T v[208:209],v231,0
 T v[210:211],v231,1024
 M v[164:167],v[192:195],a[76:79],v[164:167]
 buffer_load_dwordx4 v235,s[20:23],s68 offen offset:2048 lds
 v_mul_f32 v32,s78,v32
 M v[168:171],v[192:195],a[140:143],v[168:171]
 v_mul_f32 v33,s78,v33
 v_mul_f32 v34,s78,v34
 M v[172:175],v[192:195],a[204:207],v[172:175]
 W 6
 v_mul_f32 v35,s78,v35
 v_mul_f32 v36,s78,v36
 M v[176:179],v[196:199],a[12:15],v[176:179]
 T v[212:213],v232,0
 T v[214:215],v232,1024
 M v[180:183],v[196:199],a[76:79],v[180:183]
 v_add_u32 v225,0x8000,v225
 v_add_u32 v226,0x8000,v226
 buffer_load_dwordx4 v236,s[20:23],s68 offen offset:3072 lds
 M v[184:187],v[196:199],a[140:143],v[184:187]
 v_add_u32 v227,0x8000,v227
 v_add_u32 v228,0x8000,v228
 v_mul_f32 v37,s78,v37
 M v[188:191],v[196:199],a[204:207],v[188:191]
 W 6
 v_mul_f32 v38,s78,v38
 v_mul_f32 v39,s78,v39
 M v[64:67],v[200:203],a[48:51],v[64:67]
 T v[192:193],v225,0
 T v[194:195],v225,1024
 M v[68:71],v[200:203],a[112:115],v[68:71]
 s_add_u32 m0,s71,114688
 s_add_u32 s68,s80,0
 buffer_load_dwordx4 v237,s[28:31],s68 offen offset:0 lds
 M v[72:75],v[200:203],a[176:179],v[72:75]
 v_cvt_pk_bf16_f32 v244,v32,v33
 v_cvt_pk_bf16_f32 v246,v36,v37
 M v[76:79],v[200:203],a[240:243],v[76:79]
 W 6
 v_cvt_pk_bf16_f32 v245,v34,v35
 v_cvt_pk_bf16_f32 v247,v38,v39
 M v[80:83],v[204:207],a[48:51],v[80:83]
 T v[196:197],v226,0
 T v[198:199],v226,1024
 M v[84:87],v[204:207],a[112:115],v[84:87]
 buffer_load_dwordx4 v238,s[28:31],s68 offen offset:1024 lds
 s_add_u32 s90,s76,0
 M v[88:91],v[204:207],a[176:179],v[88:91]
 v_permlane16_swap_b32 v244,v246
 M v[92:95],v[204:207],a[240:243],v[92:95]
 W 6
 v_permlane16_swap_b32 v245,v247
 M v[96:99],v[208:211],a[48:51],v[96:99]
 T v[200:201],v227,0
 T v[202:203],v227,1024
 M v[100:103],v[208:211],a[112:115],v[100:103]
 v_bfe_u32 v252,v224,4,4
 v_lshlrev_b32 v253,10,v222
 buffer_load_dwordx4 v239,s[28:31],s68 offen offset:2048 lds
 M v[104:107],v[208:211],a[176:179],v[104:107]
 v_lshl_add_u32 v252,v252,6,v253
 buffer_store_dwordx4 v[244:247],v224,s[8:11],s90 offen offset:2048 sc0 sc1
 M v[108:111],v[208:211],a[240:243],v[108:111]
 W 6
 M v[112:115],v[212:215],a[48:51],v[112:115]
 T v[204:205],v228,0
 T v[206:207],v228,1024
 M v[116:119],v[212:215],a[112:115],v[116:119]
 buffer_load_dwordx4 v240,s[28:31],s68 offen offset:3072 lds
 M v[120:123],v[212:215],a[176:179],v[120:123]
 M v[124:127],v[212:215],a[240:243],v[124:127]
 W 6
 M v[128:131],v[192:195],a[16:19],v[128:131]
 T v[208:209],v229,4096
 T v[210:211],v229,5120
 M v[132:135],v[192:195],a[80:83],v[132:135]
 s_lshl_b32 s68,s97,15
 s_lshl_b32 s69,s65,10
 s_add_u32 s68,s68,s69
 buffer_load_dword v221,v252,s[24:27],s68 offen
 M v[136:139],v[192:195],a[144:147],v[136:139]
 M v[140:143],v[192:195],a[208:211],v[140:143]
 W 6
 M v[144:147],v[196:199],a[16:19],v[144:147]
 T v[212:213],v230,4096
 T v[214:215],v230,5120
 M v[148:151],v[196:199],a[80:83],v[148:151]
 v_mul_f32 v48,s78,v48
 v_mul_f32 v49,s78,v49
 M v[152:155],v[196:199],a[144:147],v[152:155]
 v_mul_f32 v50,s78,v50
 v_mul_f32 v51,s78,v51
 M v[156:159],v[196:199],a[208:211],v[156:159]
 W 6
 v_mul_f32 v52,s78,v52
 v_mul_f32 v53,s78,v53
 M v[160:163],v[200:203],a[16:19],v[160:163]
 T v[192:193],v231,4096
 T v[194:195],v231,5120
 M v[164:167],v[200:203],a[80:83],v[164:167]
 v_mul_f32 v54,s78,v54
 v_mul_f32 v55,s78,v55
 M v[168:171],v[200:203],a[144:147],v[168:171]
 v_cvt_pk_bf16_f32 v248,v48,v49
 v_cvt_pk_bf16_f32 v250,v52,v53
 M v[172:175],v[200:203],a[208:211],v[172:175]
 W 6
 v_cvt_pk_bf16_f32 v249,v50,v51
 v_cvt_pk_bf16_f32 v251,v54,v55
 M v[176:179],v[204:207],a[16:19],v[176:179]
 T v[196:197],v232,4096
 T v[198:199],v232,5120
 M v[180:183],v[204:207],a[80:83],v[180:183]
 s_add_u32 s90,s76,0
 M v[184:187],v[204:207],a[144:147],v[184:187]
 v_permlane16_swap_b32 v248,v250
 M v[188:191],v[204:207],a[208:211],v[188:191]
 W 6
 v_permlane16_swap_b32 v249,v251
 M v[64:67],v[208:211],a[52:55],v[64:67]
 T v[200:201],v225,4096
 T v[202:203],v225,5120
 M v[68:71],v[208:211],a[116:119],v[68:71]
 buffer_store_dwordx4 v[248:251],v224,s[8:11],s90 offen offset:3072 sc0 sc1
 M v[72:75],v[208:211],a[180:183],v[72:75]
 M v[76:79],v[208:211],a[244:247],v[76:79]
 W 6
 M v[80:83],v[212:215],a[52:55],v[80:83]
 T v[204:205],v226,4096
 T v[206:207],v226,5120
 M v[84:87],v[212:215],a[116:119],v[84:87]
 M v[88:91],v[212:215],a[180:183],v[88:91]
 M v[92:95],v[212:215],a[244:247],v[92:95]
 W 6
 M v[96:99],v[192:195],a[52:55],v[96:99]
 T v[208:209],v227,4096
 T v[210:211],v227,5120
 M v[100:103],v[192:195],a[116:119],v[100:103]
 M v[104:107],v[192:195],a[180:183],v[104:107]
 M v[108:111],v[192:195],a[244:247],v[108:111]
 W 6
 M v[112:115],v[196:199],a[52:55],v[112:115]
 T v[212:213],v228,4096
 T v[214:215],v228,5120
 M v[116:119],v[196:199],a[116:119],v[116:119]
 M v[120:123],v[196:199],a[180:183],v[120:123]
 M v[124:127],v[196:199],a[244:247],v[124:127]
 W 6
 M v[128:131],v[200:203],a[20:23],v[128:131]
 T v[192:193],v229,8192
 T v[194:195],v229,9216
 M v[132:135],v[200:203],a[84:87],v[132:135]
 v_mul_f32 v8,s78,v8
 v_mul_f32 v9,s78,v9
 M v[136:139],v[200:203],a[148:151],v[136:139]
 v_mul_f32 v10,s78,v10
 v_mul_f32 v11,s78,v11
 M v[140:143],v[200:203],a[212:215],v[140:143]
 W 6
 v_mul_f32 v12,s78,v12
 v_mul_f32 v13,s78,v13
 M v[144:147],v[204:207],a[20:23],v[144:147]
 T v[196:197],v230,8192
 T v[198:199],v230,9216
 M v[148:151],v[204:207],a[84:87],v[148:151]
 v_mul_f32 v14,s78,v14
 v_mul_f32 v15,s78,v15
 M v[152:155],v[204:207],a[148:151],v[152:155]
 v_cvt_pk_bf16_f32 v244,v8,v9
 v_cvt_pk_bf16_f32 v246,v12,v13
 M v[156:159],v[204:207],a[212:215],v[156:159]
 W 6
 v_cvt_pk_bf16_f32 v245,v10,v11
 v_cvt_pk_bf16_f32 v247,v14,v15
 M v[160:163],v[208:211],a[20:23],v[160:163]
 T v[200:201],v231,8192
 T v[202:203],v231,9216
 M v[164:167],v[208:211],a[84:87],v[164:167]
 s_add_u32 s90,s76,8192
 M v[168:171],v[208:211],a[148:151],v[168:171]
 v_permlane16_swap_b32 v244,v246
 M v[172:175],v[208:211],a[212:215],v[172:175]
 W 6
 v_permlane16_swap_b32 v245,v247
 M v[176:179],v[212:215],a[20:23],v[176:179]
 T v[204:205],v232,8192
 T v[206:207],v232,9216
 M v[180:183],v[212:215],a[84:87],v[180:183]
 buffer_store_dwordx4 v[244:247],v224,s[8:11],s90 offen offset:0 sc0 sc1
 M v[184:187],v[212:215],a[148:151],v[184:187]
 M v[188:191],v[212:215],a[212:215],v[188:191]
 W 6
 M v[64:67],v[192:195],a[56:59],v[64:67]
 T v[208:209],v225,8192
 T v[210:211],v225,9216
 M v[68:71],v[192:195],a[120:123],v[68:71]
 M v[72:75],v[192:195],a[184:187],v[72:75]
 M v[76:79],v[192:195],a[248:251],v[76:79]
 W 6
 M v[80:83],v[196:199],a[56:59],v[80:83]
 T v[212:213],v226,8192
 T v[214:215],v226,9216
 M v[84:87],v[196:199],a[120:123],v[84:87]
 M v[88:91],v[196:199],a[184:187],v[88:91]
 M v[92:95],v[196:199],a[248:251],v[92:95]
 W 6
 M v[96:99],v[200:203],a[56:59],v[96:99]
 T v[192:193],v227,8192
 T v[194:195],v227,9216
 M v[100:103],v[200:203],a[120:123],v[100:103]
 M v[104:107],v[200:203],a[184:187],v[104:107]
 M v[108:111],v[200:203],a[248:251],v[108:111]
 W 6
 M v[112:115],v[204:207],a[56:59],v[112:115]
 T v[196:197],v228,8192
 T v[198:199],v228,9216
 M v[116:119],v[204:207],a[120:123],v[116:119]
 v_mul_f32 v40,s78,v40
 v_mul_f32 v41,s78,v41
 M v[120:123],v[204:207],a[184:187],v[120:123]
 v_mul_f32 v42,s78,v42
 v_mul_f32 v43,s78,v43
 M v[124:127],v[204:207],a[248:251],v[124:127]
 W 6
 v_mul_f32 v44,s78,v44
 v_mul_f32 v45,s78,v45
 M v[128:131],v[208:211],a[24:27],v[128:131]
 T v[200:201],v229,12288
 T v[202:203],v229,13312
 M v[132:135],v[208:211],a[88:91],v[132:135]
 v_mul_f32 v46,s78,v46
 v_mul_f32 v47,s78,v47
 M v[136:139],v[208:211],a[152:155],v[136:139]
 v_cvt_pk_bf16_f32 v248,v40,v41
 v_cvt_pk_bf16_f32 v250,v44,v45
 M v[140:143],v[208:211],a[216:219],v[140:143]
 W 6
 v_cvt_pk_bf16_f32 v249,v42,v43
 v_cvt_pk_bf16_f32 v251,v46,v47
 M v[144:147],v[212:215],a[24:27],v[144:147]
 T v[204:205],v230,12288
 T v[206:207],v230,13312
 M v[148:151],v[212:215],a[88:91],v[148:151]
 s_add_u32 s90,s76,8192
 M v[152:155],v[212:215],a[152:155],v[152:155]
 v_permlane16_swap_b32 v248,v250
 M v[156:159],v[212:215],a[216:219],v[156:159]
 W 6
 v_permlane16_swap_b32 v249,v251
 M v[160:163],v[192:195],a[24:27],v[160:163]
 T v[208:209],v231,12288
 T v[210:211],v231,13312
 M v[164:167],v[192:195],a[88:91],v[164:167]
 buffer_load_dword v217,v219,s[8:11],0 offen sc1
 buffer_store_dwordx4 v[248:251],v224,s[8:11],s90 offen offset:2048 sc0 sc1
 M v[168:171],v[192:195],a[152:155],v[168:171]
 M v[172:175],v[192:195],a[216:219],v[172:175]
 W 6
 M v[176:179],v[196:199],a[24:27],v[176:179]
 T v[212:213],v232,12288
 T v[214:215],v232,13312
 M v[180:183],v[196:199],a[88:91],v[180:183]
 M v[184:187],v[196:199],a[152:155],v[184:187]
 M v[188:191],v[196:199],a[216:219],v[188:191]
 W 6
 M v[64:67],v[200:203],a[60:63],v[64:67]
 T v[192:193],v225,12288
 T v[194:195],v225,13312
 M v[68:71],v[200:203],a[124:127],v[68:71]
 M v[72:75],v[200:203],a[188:191],v[72:75]
 M v[76:79],v[200:203],a[252:255],v[76:79]
 W 6
 M v[80:83],v[204:207],a[60:63],v[80:83]
 T v[196:197],v226,12288
 T v[198:199],v226,13312
 M v[84:87],v[204:207],a[124:127],v[84:87]
 M v[88:91],v[204:207],a[188:191],v[88:91]
 M v[92:95],v[204:207],a[252:255],v[92:95]
 W 6
 M v[96:99],v[208:211],a[60:63],v[96:99]
 T v[200:201],v227,12288
 T v[202:203],v227,13312
 M v[100:103],v[208:211],a[124:127],v[100:103]
 M v[104:107],v[208:211],a[188:191],v[104:107]
 M v[108:111],v[208:211],a[252:255],v[108:111]
 W 6
 M v[112:115],v[212:215],a[60:63],v[112:115]
 T v[204:205],v228,12288
 T v[206:207],v228,13312
 M v[116:119],v[212:215],a[124:127],v[116:119]
 v_add_u32 v225,0x4000,v225
 v_add_u32 v226,0x4000,v226
 M v[120:123],v[212:215],a[188:191],v[120:123]
 v_add_u32 v227,0x4000,v227
 v_add_u32 v228,0x4000,v228
 M v[124:127],v[212:215],a[252:255],v[124:127]
 W 6
 s_barrier
 M v[128:131],v[192:195],a[28:31],v[128:131]
 T v[208:209],v225,0
 T v[210:211],v225,1024
 M v[132:135],v[192:195],a[92:95],v[132:135]
 s_add_u32 m0,s71,131072
 s_add_u32 s68,s74,3146112
 buffer_load_dwordx4 v233,s[20:23],s68 offen offset:0 lds
 M v[136:139],v[192:195],a[156:159],v[136:139]
 M v[140:143],v[192:195],a[220:223],v[140:143]
 W 6
 M v[144:147],v[196:199],a[28:31],v[144:147]
 T v[212:213],v226,0
 T v[214:215],v226,1024
 M v[148:151],v[196:199],a[92:95],v[148:151]
 buffer_load_dwordx4 v234,s[20:23],s68 offen offset:1024 lds
 M v[152:155],v[196:199],a[156:159],v[152:155]
 M v[156:159],v[196:199],a[220:223],v[156:159]
 W 6
 M v[160:163],v[200:203],a[28:31],v[160:163]
 T v[192:193],v227,0
 T v[194:195],v227,1024
 M v[164:167],v[200:203],a[92:95],v[164:167]
 buffer_load_dwordx4 v235,s[20:23],s68 offen offset:2048 lds
 M v[168:171],v[200:203],a[156:159],v[168:171]
 M v[172:175],v[200:203],a[220:223],v[172:175]
 W 6
 M v[176:179],v[204:207],a[28:31],v[176:179]
 T v[196:197],v228,0
 T v[198:199],v228,1024
 M v[180:183],v[204:207],a[92:95],v[180:183]
 v_add_u32 v229,0xc000,v229
 v_add_u32 v230,0xc000,v230
 buffer_load_dwordx4 v236,s[20:23],s68 offen offset:3072 lds
 M v[184:187],v[204:207],a[156:159],v[184:187]
 v_add_u32 v231,0xc000,v231
 v_add_u32 v232,0xc000,v232
 M v[188:191],v[204:207],a[220:223],v[188:191]
 W 6
 M v[128:131],v[208:211],a[32:35],v[128:131]
 T v[200:201],v229,0
 T v[202:203],v229,1024
 M v[132:135],v[208:211],a[96:99],v[132:135]
 s_add_u32 m0,s71,0
 s_add_u32 s68,s80,458752
 buffer_load_dwordx4 v237,s[28:31],s68 offen offset:0 lds
 M v[136:139],v[208:211],a[160:163],v[136:139]
 M v[140:143],v[208:211],a[224:227],v[140:143]
 W 6
 M v[144:147],v[212:215],a[32:35],v[144:147]
 T v[204:205],v230,0
 T v[206:207],v230,1024
 M v[148:151],v[212:215],a[96:99],v[148:151]
 buffer_load_dwordx4 v238,s[28:31],s68 offen offset:1024 lds
 M v[152:155],v[212:215],a[160:163],v[152:155]
 M v[156:159],v[212:215],a[224:227],v[156:159]
 W 6
 M v[160:163],v[192:195],a[32:35],v[160:163]
 T v[208:209],v231,0
 T v[210:211],v231,1024
 M v[164:167],v[192:195],a[96:99],v[164:167]
 buffer_load_dwordx4 v239,s[28:31],s68 offen offset:2048 lds
 v_mul_f32 v120,s78,v120
 M v[168:171],v[192:195],a[160:163],v[168:171]
 v_mul_f32 v121,s78,v121
 v_mul_f32 v122,s78,v122
 M v[172:175],v[192:195],a[224:227],v[172:175]
 W 6
 v_mul_f32 v123,s78,v123
 v_mul_f32 v124,s78,v124
 M v[176:179],v[196:199],a[32:35],v[176:179]
 T v[212:213],v232,0
 T v[214:215],v232,1024
 M v[180:183],v[196:199],a[96:99],v[180:183]
 buffer_load_dwordx4 v240,s[28:31],s68 offen offset:3072 lds
 v_mul_f32 v125,s78,v125
 M v[184:187],v[196:199],a[160:163],v[184:187]
 v_mul_f32 v126,s78,v126
 v_mul_f32 v127,s78,v127
 M v[188:191],v[196:199],a[224:227],v[188:191]
 W 6
 v_cvt_pk_bf16_f32 v244,v120,v121
 v_cvt_pk_bf16_f32 v246,v124,v125
 M v[0:3],v[200:203],a[0:3],0
 T v[192:193],v225,4096
 T v[194:195],v225,5120
 M v[4:7],v[200:203],a[64:67],0
 v_cvt_pk_bf16_f32 v245,v122,v123
 v_cvt_pk_bf16_f32 v247,v126,v127
 M v[8:11],v[200:203],a[128:131],0
 s_add_u32 s90,s76,12288
 M v[12:15],v[200:203],a[192:195],0
 W 6
 v_permlane16_swap_b32 v244,v246
 M v[16:19],v[204:207],a[0:3],0
 T v[196:197],v226,4096
 T v[198:199],v226,5120
 M v[20:23],v[204:207],a[64:67],0
 v_permlane16_swap_b32 v245,v247
 M v[24:27],v[204:207],a[128:131],0
 buffer_store_dwordx4 v[244:247],v224,s[8:11],s90 offen offset:3072 sc0 sc1
 M v[28:31],v[204:207],a[192:195],0
 W 6
 M v[32:35],v[208:211],a[0:3],0
 T v[200:201],v227,4096
 T v[202:203],v227,5120
 M v[36:39],v[208:211],a[64:67],0
 M v[40:43],v[208:211],a[128:131],0
 M v[44:47],v[208:211],a[192:195],0
 W 6
 M v[48:51],v[212:215],a[0:3],0
 T v[204:205],v228,4096
 T v[206:207],v228,5120
 M v[52:55],v[212:215],a[64:67],0
 v_mul_f32 v88,s78,v88
 v_mul_f32 v89,s78,v89
 M v[56:59],v[212:215],a[128:131],0
 s_add_u32 s70,s62,1
 s_waitcnt vmcnt(10)
 v_subrev_u32 v217,s70,v217
 v_cmp_le_u32 vcc,8,v217
 s_cbranch_vccz PL_ok2
 s_mov_b32 s69,0x100000
PL_sp2:
 s_sleep 2
 buffer_load_dword v217,v219,s[8:11],0 offen sc1
 s_waitcnt vmcnt(0)
 v_subrev_u32 v217,s70,v217
 v_cmp_le_u32 vcc,8,v217
 s_cbranch_vccz PL_ok2
 s_sub_u32 s69,s69,1
 s_cbranch_scc0 PL_sp2
PL_ok2:
 M v[60:63],v[212:215],a[192:195],0
 W 6
 v_mul_f32 v90,s78,v90
 v_mul_f32 v91,s78,v91
 M v[128:131],v[192:195],a[36:39],v[128:131]
 T v[208:209],v229,4096
 T v[210:211],v229,5120
 M v[132:135],v[192:195],a[100:103],v[132:135]
 s_add_u32 s84,s82,0
 s_add_u32 s85,s83,0
 buffer_load_dwordx4 a[0:3],v224,s[8:11],s84 offen offset:0 sc1
 M v[136:139],v[192:195],a[164:167],v[136:139]
 v_mul_f32 v92,s78,v92
 v_mul_f32 v93,s78,v93
 M v[140:143],v[192:195],a[228:231],v[140:143]
 W 6
 v_mul_f32 v94,s78,v94
 v_mul_f32 v95,s78,v95
 M v[144:147],v[196:199],a[36:39],v[144:147]
 T v[212:213],v230,4096
 T v[214:215],v230,5120
 M v[148:151],v[196:199],a[100:103],v[148:151]
 buffer_load_dwordx4 a[64:67],v241,s[8:11],s84 offen offset:0 sc1
 v_cvt_pk_bf16_f32 v248,v88,v89
 M v[152:155],v[196:199],a[164:167],v[152:155]
 v_cvt_pk_bf16_f32 v250,v92,v93
 v_cvt_pk_bf16_f32 v249,v90,v91
 M v[156:159],v[196:199],a[228:231],v[156:159]
 W 6
 v_cvt_pk_bf16_f32 v251,v94,v95
 s_add_u32 s90,s76,12288
 M v[160:163],v[200:203],a[36:39],v[160:163]
 T v[192:193],v231,4096
 T v[194:195],v231,5120
 M v[164:167],v[200:203],a[100:103],v[164:167]
 buffer_load_dwordx4 a[128:131],v224,s[8:11],s85 offen offset:0 sc1
 M v[168:171],v[200:203],a[164:167],v[168:171]
 v_permlane16_swap_b32 v248,v250
 M v[172:175],v[200:203],a[228:231],v[172:175]
 W 6
 v_permlane16_swap_b32 v249,v251
 M v[176:179],v[204:207],a[36:39],v[176:179]
 T v[196:197],v232,4096
 T v[198:199],v232,5120
 M v[180:183],v[204:207],a[100:103],v[180:183]
 buffer_load_dwordx4 a[192:195],v241,s[8:11],s85 offen offset:0 sc1
 buffer_store_dwordx4 v[248:251],v224,s[8:11],s90 offen offset:1024 sc0 sc1
 M v[184:187],v[204:207],a[164:167],v[184:187]
 buffer_load_dwordx2 v[120:121],v222,s[32:35],s89 offen offset:0
 buffer_load_dwordx2 v[122:123],v222,s[32:35],s89 offen offset:32
 M v[188:191],v[204:207],a[228:231],v[188:191]
 W 6
 buffer_load_dwordx2 v[124:125],v222,s[32:35],s89 offen offset:64
 buffer_load_dwordx2 v[126:127],v222,s[32:35],s89 offen offset:96
 M v[0:3],v[208:211],a[4:7],v[0:3]
 T v[200:201],v225,8192
 T v[202:203],v225,9216
 M v[4:7],v[208:211],a[68:71],v[4:7]
 v_mul_f32 v64,s78,v64
 v_mul_f32 v65,s78,v65
 M v[8:11],v[208:211],a[132:135],v[8:11]
 v_mul_f32 v66,s78,v66
 v_mul_f32 v67,s78,v67
 M v[12:15],v[208:211],a[196:199],v[12:15]
 W 6
 v_mul_f32 v68,s78,v68
 v_mul_f32 v69,s78,v69
 M v[16:19],v[212:215],a[4:7],v[16:19]
 T v[204:205],v226,8192
 T v[206:207],v226,9216
 M v[20:23],v[212:215],a[68:71],v[20:23]
 v_mul_f32 v70,s78,v70
 v_mul_f32 v71,s78,v71
 M v[24:27],v[212:215],a[132:135],v[24:27]
 v_cvt_pk_bf16_f32 v244,v64,v65
 v_cvt_pk_bf16_f32 v246,v68,v69
 M v[28:31],v[212:215],a[196:199],v[28:31]
 W 6
 v_cvt_pk_bf16_f32 v245,v66,v67
 v_cvt_pk_bf16_f32 v247,v70,v71
 M v[32:35],v[192:195],a[4:7],v[32:35]
 T v[208:209],v227,8192
 T v[210:211],v227,9216
 M v[36:39],v[192:195],a[68:71],v[36:39]
 s_add_u32 s90,s76,4096
 M v[40:43],v[192:195],a[132:135],v[40:43]
 v_permlane16_swap_b32 v244,v246
 M v[44:47],v[192:195],a[196:199],v[44:47]
 W 6
 v_permlane16_swap_b32 v245,v247
 M v[48:51],v[196:199],a[4:7],v[48:51]
 T v[212:213],v228,8192
 T v[214:215],v228,9216
 M v[52:55],v[196:199],a[68:71],v[52:55]
 buffer_store_dwordx4 v[244:247],v224,s[8:11],s90 offen offset:0 sc0 sc1
 M v[56:59],v[196:199],a[132:135],v[56:59]
 M v[60:63],v[196:199],a[196:199],v[60:63]
 W 6
 M v[128:131],v[200:203],a[40:43],v[128:131]
 T v[192:193],v229,8192
 T v[194:195],v229,9216
 M v[132:135],v[200:203],a[104:107],v[132:135]
 buffer_load_dwordx4 a[4:7],v224,s[8:11],s84 offen offset:1024 sc1
 M v[136:139],v[200:203],a[168:171],v[136:139]
 M v[140:143],v[200:203],a[232:235],v[140:143]
 W 6
 M v[144:147],v[204:207],a[40:43],v[144:147]
 T v[196:197],v230,8192
 T v[198:199],v230,9216
 M v[148:151],v[204:207],a[104:107],v[148:151]
 buffer_load_dwordx4 a[68:71],v241,s[8:11],s84 offen offset:1024 sc1
 v_mul_f32 v80,s78,v80
 M v[152:155],v[204:207],a[168:171],v[152:155]
 v_mul_f32 v81,s78,v81
 v_mul_f32 v82,s78,v82
 M v[156:159],v[204:207],a[232:235],v[156:159]
 W 6
 v_mul_f32 v83,s78,v83
 v_mul_f32 v84,s78,v84
 M v[160:163],v[208:211],a[40:43],v[160:163]
 T v[200:201],v231,8192
 T v[202:203],v231,9216
 M v[164:167],v[208:211],a[104:107],v[164:167]
 buffer_load_dwordx4 a[132:135],v224,s[8:11],s85 offen offset:1024 sc1
 v_mul_f32 v85,s78,v85
 M v[168:171],v[208:211],a[168:171],v[168:171]
 v_mul_f32 v86,s78,v86
 v_mul_f32 v87,s78,v87
 M v[172:175],v[208:211],a[232:235],v[172:175]
 W 6
 v_cvt_pk_bf16_f32 v248,v80,v81
 v_cvt_pk_bf16_f32 v250,v84,v85
 M v[176:179],v[212:215],a[40:43],v[176:179]
 T v[204:205],v232,8192
 T v[206:207],v232,9216
 M v[180:183],v[212:215],a[104:107],v[180:183]
 buffer_load_dwordx4 a[196:199],v241,s[8:11],s85 offen offset:1024 sc1
 v_cvt_pk_bf16_f32 v249,v82,v83
 M v[184:187],v[212:215],a[168:171],v[184:187]
 v_cvt_pk_bf16_f32 v251,v86,v87
 s_add_u32 s90,s76,4096
 M v[188:191],v[212:215],a[232:235],v[188:191]
 W 6
 v_permlane16_swap_b32 v248,v250
 M v[0:3],v[192:195],a[8:11],v[0:3]
 T v[208:209],v225,12288
 T v[210:211],v225,13312
 M v[4:7],v[192:195],a[72:75],v[4:7]
 v_permlane16_swap_b32 v249,v251
 M v[8:11],v[192:195],a[136:139],v[8:11]
 buffer_store_dwordx4 v[248:251],v224,s[8:11],s90 offen offset:1024 sc0 sc1
 M v[12:15],v[192:195],a[200:203],v[12:15]
 W 6
 M v[16:19],v[196:199],a[8:11],v[16:19]
 T v[212:213],v226,12288
 T v[214:215],v226,13312
 M v[20:23],v[196:199],a[72:75],v[20:23]
 M v[24:27],v[196:199],a[136:139],v[24:27]
 M v[28:31],v[196:199],a[200:203],v[28:31]
 W 6
 M v[32:35],v[200:203],a[8:11],v[32:35]
 T v[192:193],v227,12288
 T v[194:195],v227,13312
 M v[36:39],v[200:203],a[72:75],v[36:39]
 v_mul_f32 v96,s78,v96
 v_mul_f32 v97,s78,v97
 M v[40:43],v[200:203],a[136:139],v[40:43]
 v_mul_f32 v98,s78,v98
 v_mul_f32 v99,s78,v99
 M v[44:47],v[200:203],a[200:203],v[44:47]
 W 6
 v_mul_f32 v100,s78,v100
 v_mul_f32 v101,s78,v101
 M v[48:51],v[204:207],a[8:11],v[48:51]
 T v[196:197],v228,12288
 T v[198:199],v228,13312
 M v[52:55],v[204:207],a[72:75],v[52:55]
 v_mul_f32 v102,s78,v102
 v_mul_f32 v103,s78,v103
 M v[56:59],v[204:207],a[136:139],v[56:59]
 v_cvt_pk_bf16_f32 v244,v96,v97
 v_cvt_pk_bf16_f32 v246,v100,v101
 M v[60:63],v[204:207],a[200:203],v[60:63]
 W 6
 v_cvt_pk_bf16_f32 v245,v98,v99
 v_cvt_pk_bf16_f32 v247,v102,v103
 M v[128:131],v[208:211],a[44:47],v[128:131]
 T v[200:201],v229,12288
 T v[202:203],v229,13312
 M v[132:135],v[208:211],a[108:111],v[132:135]
 buffer_load_dwordx4 a[8:11],v224,s[8:11],s84 offen offset:2048 sc1
 s_add_u32 s90,s76,4096
 M v[136:139],v[208:211],a[172:175],v[136:139]
 v_permlane16_swap_b32 v244,v246
 M v[140:143],v[208:211],a[236:239],v[140:143]
 W 6
 v_permlane16_swap_b32 v245,v247
 M v[144:147],v[212:215],a[44:47],v[144:147]
 T v[204:205],v230,12288
 T v[206:207],v230,13312
 M v[148:151],v[212:215],a[108:111],v[148:151]
 buffer_load_dwordx4 a[72:75],v241,s[8:11],s84 offen offset:2048 sc1
 buffer_store_dwordx4 v[244:247],v224,s[8:11],s90 offen offset:2048 sc0 sc1
 M v[152:155],v[212:215],a[172:175],v[152:155]
 M v[156:159],v[212:215],a[236:239],v[156:159]
 W 6
 M v[160:163],v[192:195],a[44:47],v[160:163]
 T v[208:209],v231,12288
 T v[210:211],v231,13312
 M v[164:167],v[192:195],a[108:111],v[164:167]
 buffer_load_dwordx4 a[136:139],v224,s[8:11],s85 offen offset:2048 sc1
 M v[168:171],v[192:195],a[172:175],v[168:171]
 M v[172:175],v[192:195],a[236:239],v[172:175]
 W 6
 M v[176:179],v[196:199],a[44:47],v[176:179]
 T v[212:213],v232,12288
 T v[214:215],v232,13312
 M v[180:183],v[196:199],a[108:111],v[180:183]
 v_add_u32 v225,0x8000,v225
 v_add_u32 v226,0x8000,v226
 buffer_load_dwordx4 a[200:203],v241,s[8:11],s85 offen offset:2048 sc1
 M v[184:187],v[196:199],a[172:175],v[184:187]
 v_add_u32 v227,0x8000,v227
 v_add_u32 v228,0x8000,v228
 v_mul_f32 v112,s78,v112
 M v[188:191],v[196:199],a[236:239],v[188:191]
 W 6
 s_barrier
 v_mul_f32 v113,s78,v113
 M v[0:3],v[200:203],a[12:15],v[0:3]
 T v[192:193],v225,0
 T v[194:195],v225,1024
 M v[4:7],v[200:203],a[76:79],v[4:7]
 s_add_u32 m0,s71,16384
 s_add_u32 s68,s80,917504
 buffer_load_dwordx4 v237,s[28:31],s68 offen offset:0 lds
 M v[8:11],v[200:203],a[140:143],v[8:11]
 v_mul_f32 v114,s78,v114
 v_mul_f32 v115,s78,v115
 M v[12:15],v[200:203],a[204:207],v[12:15]
 W 6
 v_mul_f32 v116,s78,v116
 v_mul_f32 v117,s78,v117
 M v[16:19],v[204:207],a[12:15],v[16:19]
 T v[196:197],v226,0
 T v[198:199],v226,1024
 M v[20:23],v[204:207],a[76:79],v[20:23]
 buffer_load_dwordx4 v238,s[28:31],s68 offen offset:1024 lds
 v_mul_f32 v118,s78,v118
 M v[24:27],v[204:207],a[140:143],v[24:27]
 v_mul_f32 v119,s78,v119
 v_cvt_pk_bf16_f32 v248,v112,v113
 M v[28:31],v[204:207],a[204:207],v[28:31]
 W 6
 v_cvt_pk_bf16_f32 v250,v116,v117
 v_cvt_pk_bf16_f32 v249,v114,v115
 M v[32:35],v[208:211],a[12:15],v[32:35]
 T v[200:201],v227,0
 T v[202:203],v227,1024
 M v[36:39],v[208:211],a[76:79],v[36:39]
 buffer_load_dwordx4 v239,s[28:31],s68 offen offset:2048 lds
 v_cvt_pk_bf16_f32 v251,v118,v119
 M v[40:43],v[208:211],a[140:143],v[40:43]
 s_add_u32 s90,s76,4096
 M v[44:47],v[208:211],a[204:207],v[44:47]
 W 6
 v_permlane16_swap_b32 v248,v250
 M v[48:51],v[212:215],a[12:15],v[48:51]
 T v[204:205],v228,0
 T v[206:207],v228,1024
 M v[52:55],v[212:215],a[76:79],v[52:55]
 v_add_u32 v229,0x14000,v229
 v_add_u32 v230,0x14000,v230
 buffer_load_dwordx4 v240,s[28:31],s68 offen offset:3072 lds
 M v[56:59],v[212:215],a[140:143],v[56:59]
 v_add_u32 v231,0x14000,v231
 v_add_u32 v232,0x14000,v232
 M v[60:63],v[212:215],a[204:207],v[60:63]
 W 6
 v_permlane16_swap_b32 v249,v251
 M v[128:131],v[192:195],a[48:51],v[128:131]
 T v[208:209],v229,0
 T v[210:211],v229,1024
 M v[132:135],v[192:195],a[112:115],v[132:135]
 s_add_u32 m0,s71,32768
 s_add_u32 s68,s80,1376256
 buffer_load_dwordx4 v237,s[28:31],s68 offen offset:0 lds
 M v[136:139],v[192:195],a[176:179],v[136:139]
 buffer_store_dwordx4 v[248:251],v224,s[8:11],s90 offen offset:3072 sc0 sc1
 v_mul_f32 v72,s78,v72
 M v[140:143],v[192:195],a[240:243],v[140:143]
 W 6
 v_mul_f32 v73,s78,v73
 v_mul_f32 v74,s78,v74
 M v[144:147],v[196:199],a[48:51],v[144:147]
 T v[212:213],v230,0
 T v[214:215],v230,1024
 M v[148:151],v[196:199],a[112:115],v[148:151]
 buffer_load_dwordx4 v238,s[28:31],s68 offen offset:1024 lds
 v_mul_f32 v75,s78,v75
 M v[152:155],v[196:199],a[176:179],v[152:155]
 v_mul_f32 v76,s78,v76
 v_mul_f32 v77,s78,v77
 M v[156:159],v[196:199],a[240:243],v[156:159]
 W 6
 v_mul_f32 v78,s78,v78
 v_mul_f32 v79,s78,v79
 M v[160:163],v[200:203],a[48:51],v[160:163]
 T v[192:193],v231,0
 T v[194:195],v231,1024
 M v[164:167],v[200:203],a[112:115],v[164:167]
 buffer_load_dwordx4 v239,s[28:31],s68 offen offset:2048 lds
 v_cvt_pk_bf16_f32 v244,v72,v73
 M v[168:171],v[200:203],a[176:179],v[168:171]
 v_cvt_pk_bf16_f32 v246,v76,v77
 v_cvt_pk_bf16_f32 v245,v74,v75
 M v[172:175],v[200:203],a[240:243],v[172:175]
 W 6
 v_cvt_pk_bf16_f32 v247,v78,v79
 s_add_u32 s90,s76,12288
 M v[176:179],v[204:207],a[48:51],v[176:179]
 T v[196:197],v232,0
 T v[198:199],v232,1024
 M v[180:183],v[204:207],a[112:115],v[180:183]
 buffer_load_dwordx4 v240,s[28:31],s68 offen offset:3072 lds
 M v[184:187],v[204:207],a[176:179],v[184:187]
 v_permlane16_swap_b32 v244,v246
 M v[188:191],v[204:207],a[240:243],v[188:191]
 W 6
 v_permlane16_swap_b32 v245,v247
 M v[0:3],v[208:211],a[16:19],v[0:3]
 T v[200:201],v225,4096
 T v[202:203],v225,5120
 M v[4:7],v[208:211],a[80:83],v[4:7]
 buffer_load_dwordx4 a[12:15],v224,s[8:11],s84 offen offset:3072 sc1
 buffer_store_dwordx4 v[244:247],v224,s[8:11],s90 offen offset:0 sc0 sc1
 M v[8:11],v[208:211],a[144:147],v[8:11]
 M v[12:15],v[208:211],a[208:211],v[12:15]
 W 6
 M v[16:19],v[212:215],a[16:19],v[16:19]
 T v[204:205],v226,4096
 T v[206:207],v226,5120
 M v[20:23],v[212:215],a[80:83],v[20:23]
 buffer_load_dwordx4 a[76:79],v241,s[8:11],s84 offen offset:3072 sc1
 v_mul_f32 v104,s78,v104
 M v[24:27],v[212:215],a[144:147],v[24:27]
 v_mul_f32 v105,s78,v105
 v_mul_f32 v106,s78,v106
 M v[28:31],v[212:215],a[208:211],v[28:31]
 W 6
 v_mul_f32 v107,s78,v107
 v_mul_f32 v108,s78,v108
 M v[32:35],v[192:195],a[16:19],v[32:35]
 T v[208:209],v227,4096
 T v[210:211],v227,5120
 M v[36:39],v[192:195],a[80:83],v[36:39]
 buffer_load_dwordx4 a[140:143],v224,s[8:11],s85 offen offset:3072 sc1
 v_mul_f32 v109,s78,v109
 M v[40:43],v[192:195],a[144:147],v[40:43]
 v_mul_f32 v110,s78,v110
 v_mul_f32 v111,s78,v111
 M v[44:47],v[192:195],a[208:211],v[44:47]
 W 6
 v_cvt_pk_bf16_f32 v248,v104,v105
 v_cvt_pk_bf16_f32 v250,v108,v109
 M v[48:51],v[196:199],a[16:19],v[48:51]
 T v[212:213],v228,4096
 T v[214:215],v228,5120
 M v[52:55],v[196:199],a[80:83],v[52:55]
 buffer_load_dwordx4 a[204:207],v241,s[8:11],s85 offen offset:3072 sc1
 v_cvt_pk_bf16_f32 v249,v106,v107
 M v[56:59],v[196:199],a[144:147],v[56:59]
 v_cvt_pk_bf16_f32 v251,v110,v111
 s_add_u32 s90,s76,12288
 M v[60:63],v[196:199],a[208:211],v[60:63]
 W 6
 v_permlane16_swap_b32 v248,v250
 M v[128:131],v[200:203],a[52:55],v[128:131]
 T v[192:193],v229,4096
 T v[194:195],v229,5120
 M v[132:135],v[200:203],a[116:119],v[132:135]
 s_add_u32 s84,s82,4096
 s_add_u32 s85,s83,4096
 buffer_load_dwordx4 a[16:19],v224,s[8:11],s84 offen offset:0 sc1
 M v[136:139],v[200:203],a[180:183],v[136:139]
 v_permlane16_swap_b32 v249,v251
 M v[140:143],v[200:203],a[244:247],v[140:143]
 W 6
 buffer_store_dwordx4 v[248:251],v224,s[8:11],s90 offen offset:2048 sc0 sc1
 M v[144:147],v[204:207],a[52:55],v[144:147]
 T v[196:197],v230,4096
 T v[198:199],v230,5120
 M v[148:151],v[204:207],a[116:119],v[148:151]
 buffer_load_dwordx4 a[80:83],v241,s[8:11],s84 offen offset:0 sc1
 M v[152:155],v[204:207],a[180:183],v[152:155]
 M v[156:159],v[204:207],a[244:247],v[156:159]
 W 6
 M v[160:163],v[208:211],a[52:55],v[160:163]
 T v[200:201],v231,4096
 T v[202:203],v231,5120
 M v[164:167],v[208:211],a[116:119],v[164:167]
 buffer_load_dwordx4 a[144:147],v224,s[8:11],s85 offen offset:0 sc1
 M v[168:171],v[208:211],a[180:183],v[168:171]
 M v[172:175],v[208:211],a[244:247],v[172:175]
 W 6
 M v[176:179],v[212:215],a[52:55],v[176:179]
 T v[204:205],v232,4096
 T v[206:207],v232,5120
 M v[180:183],v[212:215],a[116:119],v[180:183]
 buffer_load_dwordx4 a[208:211],v241,s[8:11],s85 offen offset:0 sc1
 M v[184:187],v[212:215],a[180:183],v[184:187]
 M v[188:191],v[212:215],a[244:247],v[188:191]
 W 6
 M v[0:3],v[192:195],a[20:23],v[0:3]
 T v[208:209],v225,8192
 T v[210:211],v225,9216
 M v[4:7],v[192:195],a[84:87],v[4:7]
 M v[8:11],v[192:195],a[148:151],v[8:11]
 M v[12:15],v[192:195],a[212:215],v[12:15]
 W 6
 M v[16:19],v[196:199],a[20:23],v[16:19]
 T v[212:213],v226,8192
 T v[214:215],v226,9216
 M v[20:23],v[196:199],a[84:87],v[20:23]
 M v[24:27],v[196:199],a[148:151],v[24:27]
 M v[28:31],v[196:199],a[212:215],v[28:31]
 W 6
 M v[32:35],v[200:203],a[20:23],v[32:35]
 T v[192:193],v227,8192
 T v[194:195],v227,9216
 M v[36:39],v[200:203],a[84:87],v[36:39]
 s_waitcnt vmcnt(33)
 v_lshlrev_b32 v64,16,v120
 v_and_b32 v65,0xffff0000,v120
 M v[40:43],v[200:203],a[148:151],v[40:43]
 v_lshlrev_b32 v66,16,v121
 v_and_b32 v67,0xffff0000,v121
 M v[44:47],v[200:203],a[212:215],v[44:47]
 W 6
 v_lshlrev_b32 v68,16,v120
 v_and_b32 v69,0xffff0000,v120
 M v[48:51],v[204:207],a[20:23],v[48:51]
 T v[196:197],v228,8192
 T v[198:199],v228,9216
 M v[52:55],v[204:207],a[84:87],v[52:55]
 v_lshlrev_b32 v70,16,v121
 v_and_b32 v71,0xffff0000,v121
 M v[56:59],v[204:207],a[148:151],v[56:59]
 v_lshlrev_b32 v72,16,v120
 v_and_b32 v73,0xffff0000,v120
 M v[60:63],v[204:207],a[212:215],v[60:63]
 W 6
 v_lshlrev_b32 v74,16,v121
 v_and_b32 v75,0xffff0000,v121
 M v[128:131],v[208:211],a[56:59],v[128:131]
 T v[200:201],v229,8192
 T v[202:203],v229,9216
 M v[132:135],v[208:211],a[120:123],v[132:135]
 buffer_load_dwordx4 a[20:23],v224,s[8:11],s84 offen offset:1024 sc1
 v_lshlrev_b32 v76,16,v120
 M v[136:139],v[208:211],a[184:187],v[136:139]
 v_and_b32 v77,0xffff0000,v120
 v_lshlrev_b32 v78,16,v121
 M v[140:143],v[208:211],a[248:251],v[140:143]
 W 6
 v_and_b32 v79,0xffff0000,v121
 s_waitcnt vmcnt(33)
 v_lshlrev_b32 v80,16,v122
 M v[144:147],v[212:215],a[56:59],v[144:147]
 T v[204:205],v230,8192
 T v[206:207],v230,9216
 M v[148:151],v[212:215],a[120:123],v[148:151]
 buffer_load_dwordx4 a[84:87],v241,s[8:11],s84 offen offset:1024 sc1
 v_and_b32 v81,0xffff0000,v122
 M v[152:155],v[212:215],a[184:187],v[152:155]
 v_lshlrev_b32 v82,16,v123
 v_and_b32 v83,0xffff0000,v123
 M v[156:159],v[212:215],a[248:251],v[156:159]
 W 6
 v_lshlrev_b32 v84,16,v122
 v_and_b32 v85,0xffff0000,v122
 M v[160:163],v[192:195],a[56:59],v[160:163]
 T v[208:209],v231,8192
 T v[210:211],v231,9216
 M v[164:167],v[192:195],a[120:123],v[164:167]
 buffer_load_dwordx4 a[148:151],v224,s[8:11],s85 offen offset:1024 sc1
 v_lshlrev_b32 v86,16,v123
 M v[168:171],v[192:195],a[184:187],v[168:171]
 v_and_b32 v87,0xffff0000,v123
 v_lshlrev_b32 v88,16,v122
 M v[172:175],v[192:195],a[248:251],v[172:175]
 W 6
 v_and_b32 v89,0xffff0000,v122
 v_lshlrev_b32 v90,16,v123
 M v[176:179],v[196:199],a[56:59],v[176:179]
 T v[212:213],v232,8192
 T v[214:215],v232,9216
 M v[180:183],v[196:199],a[120:123],v[180:183]
 buffer_load_dwordx4 a[212:215],v241,s[8:11],s85 offen offset:1024 sc1
 v_and_b32 v91,0xffff0000,v123
 M v[184:187],v[196:199],a[184:187],v[184:187]
 v_lshlrev_b32 v92,16,v122
 v_and_b32 v93,0xffff0000,v122
 M v[188:191],v[196:199],a[248:251],v[188:191]
 W 6
 v_lshlrev_b32 v94,16,v123
 v_and_b32 v95,0xffff0000,v123
 M v[0:3],v[200:203],a[24:27],v[0:3]
 T v[192:193],v225,12288
 T v[194:195],v225,13312
 M v[4:7],v[200:203],a[88:91],v[4:7]
 s_waitcnt vmcnt(35)
 v_lshlrev_b32 v96,16,v124
 v_and_b32 v97,0xffff0000,v124
 M v[8:11],v[200:203],a[152:155],v[8:11]
 v_lshlrev_b32 v98,16,v125
 v_and_b32 v99,0xffff0000,v125
 M v[12:15],v[200:203],a[216:219],v[12:15]
 W 6
 v_lshlrev_b32 v100,16,v124
 v_and_b32 v101,0xffff0000,v124
 M v[16:19],v[204:207],a[24:27],v[16:19]
 T v[196:197],v226,12288
 T v[198:199],v226,13312
 M v[20:23],v[204:207],a[88:91],v[20:23]
 v_lshlrev_b32 v102,16,v125
 v_and_b32 v103,0xffff0000,v125
 M v[24:27],v[204:207],a[152:155],v[24:27]
 v_lshlrev_b32 v104,16,v124
 v_and_b32 v105,0xffff0000,v124
 M v[28:31],v[204:207],a[216:219],v[28:31]
 W 6
 v_lshlrev_b32 v106,16,v125
 v_and_b32 v107,0xffff0000,v125
 M v[32:35],v[208:211],a[24:27],v[32:35]
 T v[200:201],v227,12288
 T v[202:203],v227,13312
 M v[36:39],v[208:211],a[88:91],v[36:39]
 v_lshlrev_b32 v108,16,v124
 v_and_b32 v109,0xffff0000,v124
 M v[40:43],v[208:211],a[152:155],v[40:43]
 v_lshlrev_b32 v110,16,v125
 v_and_b32 v111,0xffff0000,v125
 M v[44:47],v[208:211],a[216:219],v[44:47]
 W 6
 s_waitcnt vmcnt(34)
 v_lshlrev_b32 v112,16,v126
 v_and_b32 v113,0xffff0000,v126
 M v[48:51],v[212:215],a[24:27],v[48:51]
 T v[204:205],v228,12288
 T v[206:207],v228,13312
 M v[52:55],v[212:215],a[88:91],v[52:55]
 v_lshlrev_b32 v114,16,v127
 v_and_b32 v115,0xffff0000,v127
 M v[56:59],v[212:215],a[152:155],v[56:59]
 v_mov_b32 v116,v112
 v_mov_b32 v117,v113
 M v[60:63],v[212:215],a[216:219],v[60:63]
 W 6
 v_mov_b32 v118,v114
 v_mov_b32 v119,v115
 M v[128:131],v[192:195],a[60:63],v[128:131]
 T v[208:209],v229,12288
 T v[210:211],v229,13312
 M v[132:135],v[192:195],a[124:127],v[132:135]
 buffer_load_dwordx4 a[24:27],v224,s[8:11],s84 offen offset:2048 sc1
 v_mov_b32 v120,v112
 M v[136:139],v[192:195],a[188:191],v[136:139]
 v_mov_b32 v121,v113
 v_mov_b32 v122,v114
 M v[140:143],v[192:195],a[252:255],v[140:143]
 W 6
 v_mov_b32 v123,v115
 v_mov_b32 v124,v112
 M v[144:147],v[196:199],a[60:63],v[144:147]
 T v[212:213],v230,12288
 T v[214:215],v230,13312
 M v[148:151],v[196:199],a[124:127],v[148:151]
 buffer_load_dwordx4 a[88:91],v241,s[8:11],s84 offen offset:2048 sc1
 v_mov_b32 v125,v113
 M v[152:155],v[196:199],a[188:191],v[152:155]
 v_mov_b32 v126,v114
 v_mov_b32 v127,v115
 M v[156:159],v[196:199],a[252:255],v[156:159]
 W 6
 M v[160:163],v[200:203],a[60:63],v[160:163]
 T v[192:193],v231,12288
 T v[194:195],v231,13312
 M v[164:167],v[200:203],a[124:127],v[164:167]
 buffer_load_dwordx4 a[152:155],v224,s[8:11],s85 offen offset:2048 sc1
 M v[168:171],v[200:203],a[188:191],v[168:171]
 M v[172:175],v[200:203],a[252:255],v[172:175]
 W 6
 M v[176:179],v[204:207],a[60:63],v[176:179]
 T v[196:197],v232,12288
 T v[198:199],v232,13312
 M v[180:183],v[204:207],a[124:127],v[180:183]
 v_add_u32 v229,0xffff4000,v229
 v_add_u32 v230,0xffff4000,v230
 buffer_load_dwordx4 a[216:219],v241,s[8:11],s85 offen offset:2048 sc1
 M v[184:187],v[204:207],a[188:191],v[184:187]
 v_add_u32 v231,0xffff4000,v231
 v_add_u32 v232,0xffff4000,v232
 M v[188:191],v[204:207],a[252:255],v[188:191]
 W 6
 s_barrier
 M v[0:3],v[208:211],a[28:31],v[0:3]
 T v[200:201],v229,0
 T v[202:203],v229,1024
 M v[4:7],v[208:211],a[92:95],v[4:7]
 s_add_u32 m0,s71,49152
 s_add_u32 s68,s81,0
 buffer_load_dwordx4 v233,s[24:27],s68 offen offset:0 lds
 M v[8:11],v[208:211],a[156:159],v[8:11]
 M v[12:15],v[208:211],a[220:223],v[12:15]
 W 6
 M v[16:19],v[212:215],a[28:31],v[16:19]
 T v[204:205],v230,0
 T v[206:207],v230,1024
 M v[20:23],v[212:215],a[92:95],v[20:23]
 buffer_load_dwordx4 v234,s[24:27],s68 offen offset:1024 lds
 M v[24:27],v[212:215],a[156:159],v[24:27]
 M v[28:31],v[212:215],a[220:223],v[28:31]
 W 6
 M v[32:35],v[192:195],a[28:31],v[32:35]
 T v[208:209],v231,0
 T v[210:211],v231,1024
 M v[36:39],v[192:195],a[92:95],v[36:39]
 buffer_load_dwordx4 v235,s[24:27],s68 offen offset:2048 lds
 M v[40:43],v[192:195],a[156:159],v[40:43]
 M v[44:47],v[192:195],a[220:223],v[44:47]
 W 6
 M v[48:51],v[196:199],a[28:31],v[48:51]
 T v[212:213],v232,0
 T v[214:215],v232,1024
 M v[52:55],v[196:199],a[92:95],v[52:55]
 v_add_u32 v225,0x8000,v225
 v_add_u32 v226,0x8000,v226
 buffer_load_dwordx4 v236,s[24:27],s68 offen offset:3072 lds
 M v[56:59],v[196:199],a[156:159],v[56:59]
 v_add_u32 v227,0x8000,v227
 v_add_u32 v228,0x8000,v228
 M v[60:63],v[196:199],a[220:223],v[60:63]
 W 6
 M v[0:3],v[200:203],a[32:35],v[0:3]
 T v[192:193],v225,0
 T v[194:195],v225,1024
 M v[4:7],v[200:203],a[96:99],v[4:7]
 s_add_u32 m0,s71,65536
 s_add_u32 s68,s81,1048576
 buffer_load_dwordx4 v233,s[24:27],s68 offen offset:0 lds
 M v[8:11],v[200:203],a[160:163],v[8:11]
 M v[12:15],v[200:203],a[224:227],v[12:15]
 W 6
 M v[16:19],v[204:207],a[32:35],v[16:19]
 T v[196:197],v226,0
 T v[198:199],v226,1024
 M v[20:23],v[204:207],a[96:99],v[20:23]
 buffer_load_dwordx4 v234,s[24:27],s68 offen offset:1024 lds
 M v[24:27],v[204:207],a[160:163],v[24:27]
 M v[28:31],v[204:207],a[224:227],v[28:31]
 W 6
 M v[32:35],v[208:211],a[32:35],v[32:35]
 T v[200:201],v227,0
 T v[202:203],v227,1024
 M v[36:39],v[208:211],a[96:99],v[36:39]
 buffer_load_dwordx4 v235,s[24:27],s68 offen offset:2048 lds
 v_mul_f32 v184,s78,v184
 M v[40:43],v[208:211],a[160:163],v[40:43]
 v_mul_f32 v185,s78,v185
 v_mul_f32 v186,s78,v186
 M v[44:47],v[208:211],a[224:227],v[44:47]
 W 6
 v_mul_f32 v187,s78,v187
 v_mul_f32 v188,s78,v188
 M v[48:51],v[212:215],a[32:35],v[48:51]
 T v[204:205],v228,0
 T v[206:207],v228,1024
 M v[52:55],v[212:215],a[96:99],v[52:55]
 buffer_load_dwordx4 v236,s[24:27],s68 offen offset:3072 lds
 v_mul_f32 v189,s78,v189
 M v[56:59],v[212:215],a[160:163],v[56:59]
 v_mul_f32 v190,s78,v190
 v_mul_f32 v191,s78,v191
 M v[60:63],v[212:215],a[224:227],v[60:63]
 W 6
 v_cvt_pk_bf16_f32 v244,v184,v185
 v_cvt_pk_bf16_f32 v246,v188,v189
 M v[64:67],v[192:195],a[0:3],v[64:67]
 T v[208:209],v229,4096
 T v[210:211],v229,5120
 M v[68:71],v[192:195],a[64:67],v[68:71]
 buffer_load_dwordx4 a[28:31],v224,s[8:11],s84 offen offset:3072 sc1
 v_cvt_pk_bf16_f32 v245,v186,v187
 M v[72:75],v[192:195],a[128:131],v[72:75]
 v_cvt_pk_bf16_f32 v247,v190,v191
 s_add_u32 s90,s76,565248
 M v[76:79],v[192:195],a[192:195],v[76:79]
 W 6
 v_permlane16_swap_b32 v244,v246
 M v[80:83],v[196:199],a[0:3],v[80:83]
 T v[212:213],v230,4096
 T v[214:215],v230,5120
 M v[84:87],v[196:199],a[64:67],v[84:87]
 buffer_load_dwordx4 a[92:95],v241,s[8:11],s84 offen offset:3072 sc1
 M v[88:91],v[196:199],a[128:131],v[88:91]
 v_permlane16_swap_b32 v245,v247
 M v[92:95],v[196:199],a[192:195],v[92:95]
 W 6
 buffer_store_dwordx4 v[244:247],v224,s[8:11],s90 offen offset:3072 sc0 sc1
 M v[96:99],v[200:203],a[0:3],v[96:99]
 T v[192:193],v231,4096
 T v[194:195],v231,5120
 M v[100:103],v[200:203],a[64:67],v[100:103]
 buffer_load_dwordx4 a[156:159],v224,s[8:11],s85 offen offset:3072 sc1
 M v[104:107],v[200:203],a[128:131],v[104:107]
 M v[108:111],v[200:203],a[192:195],v[108:111]
 W 6
 M v[112:115],v[204:207],a[0:3],v[112:115]
 T v[196:197],v232,4096
 T v[198:199],v232,5120
 M v[116:119],v[204:207],a[64:67],v[116:119]
 buffer_load_dwordx4 a[220:223],v241,s[8:11],s85 offen offset:3072 sc1
 M v[120:123],v[204:207],a[128:131],v[120:123]
 M v[124:127],v[204:207],a[192:195],v[124:127]
 W 6
 M v[0:3],v[208:211],a[36:39],v[0:3]
 T v[200:201],v225,4096
 T v[202:203],v225,5120
 M v[4:7],v[208:211],a[100:103],v[4:7]
 s_add_u32 s84,s82,8192
 s_add_u32 s85,s83,8192
 buffer_load_dwordx4 a[32:35],v224,s[8:11],s84 offen offset:0 sc1
 M v[8:11],v[208:211],a[164:167],v[8:11]
 M v[12:15],v[208:211],a[228:231],v[12:15]
 W 6
 M v[16:19],v[212:215],a[36:39],v[16:19]
 T v[204:205],v226,4096
 T v[206:207],v226,5120
 M v[20:23],v[212:215],a[100:103],v[20:23]
 buffer_load_dwordx4 a[96:99],v241,s[8:11],s84 offen offset:0 sc1
 v_mul_f32 v152,s78,v152
 M v[24:27],v[212:215],a[164:167],v[24:27]
 v_mul_f32 v153,s78,v153
 v_mul_f32 v154,s78,v154
 M v[28:31],v[212:215],a[228:231],v[28:31]
 W 6
 v_mul_f32 v155,s78,v155
 v_mul_f32 v156,s78,v156
 M v[32:35],v[192:195],a[36:39],v[32:35]
 T v[208:209],v227,4096
 T v[210:211],v227,5120
 M v[36:39],v[192:195],a[100:103],v[36:39]
 buffer_load_dwordx4 a[160:163],v224,s[8:11],s85 offen offset:0 sc1
 v_mul_f32 v157,s78,v157
 M v[40:43],v[192:195],a[164:167],v[40:43]
 v_mul_f32 v158,s78,v158
 v_mul_f32 v159,s78,v159
 M v[44:47],v[192:195],a[228:231],v[44:47]
 W 6
 v_cvt_pk_bf16_f32 v248,v152,v153
 v_cvt_pk_bf16_f32 v250,v156,v157
 M v[48:51],v[196:199],a[36:39],v[48:51]
 T v[212:213],v228,4096
 T v[214:215],v228,5120
 M v[52:55],v[196:199],a[100:103],v[52:55]
 buffer_load_dwordx4 a[224:227],v241,s[8:11],s85 offen offset:0 sc1
 v_cvt_pk_bf16_f32 v249,v154,v155
 M v[56:59],v[196:199],a[164:167],v[56:59]
 v_cvt_pk_bf16_f32 v251,v158,v159
 s_add_u32 s90,s76,565248
 M v[60:63],v[196:199],a[228:231],v[60:63]
 W 6
 v_permlane16_swap_b32 v248,v250
 s_waitcnt vmcnt(53)
 M v[64:67],v[200:203],a[4:7],v[64:67]
 T v[192:193],v229,8192
 T v[194:195],v229,9216
 s_waitcnt vmcnt(52)
 M v[68:71],v[200:203],a[68:71],v[68:71]
 buffer_load_dwordx4 a[36:39],v224,s[8:11],s84 offen offset:1024 sc1
 s_waitcnt vmcnt(52)
 M v[72:75],v[200:203],a[132:135],v[72:75]
 v_permlane16_swap_b32 v249,v251
 s_waitcnt vmcnt(51)
 M v[76:79],v[200:203],a[196:199],v[76:79]
 W 6
 buffer_store_dwordx4 v[248:251],v224,s[8:11],s90 offen offset:1024 sc0 sc1
 M v[80:83],v[204:207],a[4:7],v[80:83]
 T v[196:197],v230,8192
 T v[198:199],v230,9216
 M v[84:87],v[204:207],a[68:71],v[84:87]
 buffer_load_dwordx4 a[100:103],v241,s[8:11],s84 offen offset:1024 sc1
 M v[88:91],v[204:207],a[132:135],v[88:91]
 M v[92:95],v[204:207],a[196:199],v[92:95]
 W 6
 M v[96:99],v[208:211],a[4:7],v[96:99]
 T v[200:201],v231,8192
 T v[202:203],v231,9216
 M v[100:103],v[208:211],a[68:71],v[100:103]
 buffer_load_dwordx4 a[164:167],v224,s[8:11],s85 offen offset:1024 sc1
 M v[104:107],v[208:211],a[132:135],v[104:107]
 M v[108:111],v[208:211],a[196:199],v[108:111]
 W 6
 M v[112:115],v[212:215],a[4:7],v[112:115]
 T v[204:205],v232,8192
 T v[206:207],v232,9216
 M v[116:119],v[212:215],a[68:71],v[116:119]
 buffer_load_dwordx4 a[228:231],v241,s[8:11],s85 offen offset:1024 sc1
 M v[120:123],v[212:215],a[132:135],v[120:123]
 M v[124:127],v[212:215],a[196:199],v[124:127]
 W 6
 M v[0:3],v[192:195],a[40:43],v[0:3]
 T v[208:209],v225,8192
 T v[210:211],v225,9216
 M v[4:7],v[192:195],a[104:107],v[4:7]
 v_mul_f32 v128,s78,v128
 v_mul_f32 v129,s78,v129
 M v[8:11],v[192:195],a[168:171],v[8:11]
 v_mul_f32 v130,s78,v130
 v_mul_f32 v131,s78,v131
 M v[12:15],v[192:195],a[232:235],v[12:15]
 W 6
 v_mul_f32 v132,s78,v132
 v_mul_f32 v133,s78,v133
 M v[16:19],v[196:199],a[40:43],v[16:19]
 T v[212:213],v226,8192
 T v[214:215],v226,9216
 M v[20:23],v[196:199],a[104:107],v[20:23]
 v_mul_f32 v134,s78,v134
 v_mul_f32 v135,s78,v135
 M v[24:27],v[196:199],a[168:171],v[24:27]
 v_cvt_pk_bf16_f32 v244,v128,v129
 v_cvt_pk_bf16_f32 v246,v132,v133
 M v[28:31],v[196:199],a[232:235],v[28:31]
 W 6
 v_cvt_pk_bf16_f32 v245,v130,v131
 v_cvt_pk_bf16_f32 v247,v134,v135
 M v[32:35],v[200:203],a[40:43],v[32:35]
 T v[192:193],v227,8192
 T v[194:195],v227,9216
 M v[36:39],v[200:203],a[104:107],v[36:39]
 s_add_u32 s90,s76,557056
 M v[40:43],v[200:203],a[168:171],v[40:43]
 v_permlane16_swap_b32 v244,v246
 M v[44:47],v[200:203],a[232:235],v[44:47]
 W 6
 v_permlane16_swap_b32 v245,v247
 M v[48:51],v[204:207],a[40:43],v[48:51]
 T v[196:197],v228,8192
 T v[198:199],v228,9216
 M v[52:55],v[204:207],a[104:107],v[52:55]
 buffer_store_dwordx4 v[244:247],v224,s[8:11],s90 offen offset:0 sc0 sc1
 M v[56:59],v[204:207],a[168:171],v[56:59]
 M v[60:63],v[204:207],a[232:235],v[60:63]
 W 6
 s_waitcnt vmcnt(54)
 M v[64:67],v[208:211],a[8:11],v[64:67]
 T v[200:201],v229,12288
 T v[202:203],v229,13312
 s_waitcnt vmcnt(53)
 M v[68:71],v[208:211],a[72:75],v[68:71]
 buffer_load_dwordx4 a[40:43],v224,s[8:11],s84 offen offset:2048 sc1
 s_waitcnt vmcnt(52)
 M v[72:75],v[208:211],a[136:139],v[72:75]
 s_waitcnt vmcnt(51)
 M v[76:79],v[208:211],a[200:203],v[76:79]
 W 6
 M v[80:83],v[212:215],a[8:11],v[80:83]
 T v[204:205],v230,12288
 T v[206:207],v230,13312
 M v[84:87],v[212:215],a[72:75],v[84:87]
 buffer_load_dwordx4 a[104:107],v241,s[8:11],s84 offen offset:2048 sc1
 M v[88:91],v[212:215],a[136:139],v[88:91]
 M v[92:95],v[212:215],a[200:203],v[92:95]
 W 6
 M v[96:99],v[192:195],a[8:11],v[96:99]
 T v[208:209],v231,12288
 T v[210:211],v231,13312
 M v[100:103],v[192:195],a[72:75],v[100:103]
 buffer_load_dwordx4 a[168:171],v224,s[8:11],s85 offen offset:2048 sc1
 M v[104:107],v[192:195],a[136:139],v[104:107]
 M v[108:111],v[192:195],a[200:203],v[108:111]
 W 6
 M v[112:115],v[196:199],a[8:11],v[112:115]
 T v[212:213],v232,12288
 T v[214:215],v232,13312
 M v[116:119],v[196:199],a[72:75],v[116:119]
 buffer_load_dwordx4 a[232:235],v241,s[8:11],s85 offen offset:2048 sc1
 v_mul_f32 v144,s78,v144
 M v[120:123],v[196:199],a[136:139],v[120:123]
 v_mul_f32 v145,s78,v145
 v_mul_f32 v146,s78,v146
 M v[124:127],v[196:199],a[200:203],v[124:127]
 W 6
 v_mul_f32 v147,s78,v147
 v_mul_f32 v148,s78,v148
 M v[0:3],v[200:203],a[44:47],v[0:3]
 T v[192:193],v225,12288
 T v[194:195],v225,13312
 M v[4:7],v[200:203],a[108:111],v[4:7]
 v_mul_f32 v149,s78,v149
 v_mul_f32 v150,s78,v150
 M v[8:11],v[200:203],a[172:175],v[8:11]
 v_mul_f32 v151,s78,v151
 v_cvt_pk_bf16_f32 v248,v144,v145
 M v[12:15],v[200:203],a[236:239],v[12:15]
 W 6
 v_cvt_pk_bf16_f32 v250,v148,v149
 v_cvt_pk_bf16_f32 v249,v146,v147
 M v[16:19],v[204:207],a[44:47],v[16:19]
 T v[196:197],v226,12288
 T v[198:199],v226,13312
 M v[20:23],v[204:207],a[108:111],v[20:23]
 v_cvt_pk_bf16_f32 v251,v150,v151
 s_add_u32 s90,s76,557056
 M v[24:27],v[204:207],a[172:175],v[24:27]
 v_permlane16_swap_b32 v248,v250
 M v[28:31],v[204:207],a[236:239],v[28:31]
 W 6
 v_permlane16_swap_b32 v249,v251
 M v[32:35],v[208:211],a[44:47],v[32:35]
 T v[200:201],v227,12288
 T v[202:203],v227,13312
 M v[36:39],v[208:211],a[108:111],v[36:39]
 buffer_store_dwordx4 v[248:251],v224,s[8:11],s90 offen offset:1024 sc0 sc1
 M v[40:43],v[208:211],a[172:175],v[40:43]
 M v[44:47],v[208:211],a[236:239],v[44:47]
 W 6
 M v[48:51],v[212:215],a[44:47],v[48:51]
 T v[204:205],v228,12288
 T v[206:207],v228,13312
 M v[52:55],v[212:215],a[108:111],v[52:55]
 v_add_u32 v229,0x8000,v229
 v_add_u32 v230,0x8000,v230
 M v[56:59],v[212:215],a[172:175],v[56:59]
 v_add_u32 v231,0x8000,v231
 v_add_u32 v232,0x8000,v232
 M v[60:63],v[212:215],a[236:239],v[60:63]
 W 6
 s_barrier
 s_waitcnt vmcnt(45)
 M v[64:67],v[192:195],a[12:15],v[64:67]
 T v[208:209],v229,0
 T v[210:211],v229,1024
 s_waitcnt vmcnt(43)
 M v[68:71],v[192:195],a[76:79],v[68:71]
 s_add_u32 m0,s71,81920
 s_add_u32 s68,s81,2097152
 buffer_load_dwordx4 v233,s[24:27],s68 offen offset:0 lds
 s_waitcnt vmcnt(43)
 M v[72:75],v[192:195],a[140:143],v[72:75]
 s_waitcnt vmcnt(42)
 M v[76:79],v[192:195],a[204:207],v[76:79]
 W 6
 M v[80:83],v[196:199],a[12:15],v[80:83]
 T v[212:213],v230,0
 T v[214:215],v230,1024
 M v[84:87],v[196:199],a[76:79],v[84:87]
 buffer_load_dwordx4 v234,s[24:27],s68 offen offset:1024 lds
 M v[88:91],v[196:199],a[140:143],v[88:91]
 M v[92:95],v[196:199],a[204:207],v[92:95]
 W 6
 M v[96:99],v[200:203],a[12:15],v[96:99]
 T v[192:193],v231,0
 T v[194:195],v231,1024
 M v[100:103],v[200:203],a[76:79],v[100:103]
 buffer_load_dwordx4 v235,s[24:27],s68 offen offset:2048 lds
 v_mul_f32 v160,s78,v160
 M v[104:107],v[200:203],a[140:143],v[104:107]
 v_mul_f32 v161,s78,v161
 v_mul_f32 v162,s78,v162
 M v[108:111],v[200:203],a[204:207],v[108:111]
 W 6
 v_mul_f32 v163,s78,v163
 v_mul_f32 v164,s78,v164
 M v[112:115],v[204:207],a[12:15],v[112:115]
 T v[196:197],v232,0
 T v[198:199],v232,1024
 M v[116:119],v[204:207],a[76:79],v[116:119]
 v_add_u32 v225,0xfffe4000,v225
 v_add_u32 v226,0xfffe4000,v226
 buffer_load_dwordx4 v236,s[24:27],s68 offen offset:3072 lds
 M v[120:123],v[204:207],a[140:143],v[120:123]
 v_add_u32 v227,0xfffe4000,v227
 v_add_u32 v228,0xfffe4000,v228
 v_mul_f32 v165,s78,v165
 M v[124:127],v[204:207],a[204:207],v[124:127]
 W 6
 v_mul_f32 v166,s78,v166
 v_mul_f32 v167,s78,v167
 M v[0:3],v[208:211],a[48:51],v[0:3]
 T v[200:201],v225,0
 T v[202:203],v225,1024
 M v[4:7],v[208:211],a[112:115],v[4:7]
 s_add_u32 m0,s71,98304
 s_add_u32 s68,s81,3145728
 buffer_load_dwordx4 v233,s[24:27],s68 offen offset:0 lds
 M v[8:11],v[208:211],a[176:179],v[8:11]
 v_cvt_pk_bf16_f32 v244,v160,v161
 v_cvt_pk_bf16_f32 v246,v164,v165
 M v[12:15],v[208:211],a[240:243],v[12:15]
 W 6
 v_cvt_pk_bf16_f32 v245,v162,v163
 v_cvt_pk_bf16_f32 v247,v166,v167
 M v[16:19],v[212:215],a[48:51],v[16:19]
 T v[204:205],v226,0
 T v[206:207],v226,1024
 M v[20:23],v[212:215],a[112:115],v[20:23]
 buffer_load_dwordx4 v234,s[24:27],s68 offen offset:1024 lds
 s_add_u32 s90,s76,557056
 M v[24:27],v[212:215],a[176:179],v[24:27]
 v_permlane16_swap_b32 v244,v246
 M v[28:31],v[212:215],a[240:243],v[28:31]
 W 6
 v_permlane16_swap_b32 v245,v247
 M v[32:35],v[192:195],a[48:51],v[32:35]
 T v[208:209],v227,0
 T v[210:211],v227,1024
 M v[36:39],v[192:195],a[112:115],v[36:39]
 buffer_load_dwordx4 v235,s[24:27],s68 offen offset:2048 lds
 buffer_store_dwordx4 v[244:247],v224,s[8:11],s90 offen offset:2048 sc0 sc1
 M v[40:43],v[192:195],a[176:179],v[40:43]
 M v[44:47],v[192:195],a[240:243],v[44:47]
 W 6
 M v[48:51],v[196:199],a[48:51],v[48:51]
 T v[212:213],v228,0
 T v[214:215],v228,1024
 M v[52:55],v[196:199],a[112:115],v[52:55]
 buffer_load_dwordx4 v236,s[24:27],s68 offen offset:3072 lds
 M v[56:59],v[196:199],a[176:179],v[56:59]
 M v[60:63],v[196:199],a[240:243],v[60:63]
 W 6
 s_waitcnt vmcnt(49)
 M v[64:67],v[200:203],a[16:19],v[64:67]
 T v[192:193],v229,4096
 T v[194:195],v229,5120
 s_waitcnt vmcnt(47)
 M v[68:71],v[200:203],a[80:83],v[68:71]
 buffer_load_dwordx4 a[44:47],v224,s[8:11],s84 offen offset:3072 sc1
 s_waitcnt vmcnt(47)
 M v[72:75],v[200:203],a[144:147],v[72:75]
 s_waitcnt vmcnt(46)
 M v[76:79],v[200:203],a[208:211],v[76:79]
 W 6
 M v[80:83],v[204:207],a[16:19],v[80:83]
 T v[196:197],v230,4096
 T v[198:199],v230,5120
 M v[84:87],v[204:207],a[80:83],v[84:87]
 buffer_load_dwordx4 a[108:111],v241,s[8:11],s84 offen offset:3072 sc1
 v_mul_f32 v176,s78,v176
 M v[88:91],v[204:207],a[144:147],v[88:91]
 v_mul_f32 v177,s78,v177
 v_mul_f32 v178,s78,v178
 M v[92:95],v[204:207],a[208:211],v[92:95]
 W 6
 v_mul_f32 v179,s78,v179
 v_mul_f32 v180,s78,v180
 M v[96:99],v[208:211],a[16:19],v[96:99]
 T v[200:201],v231,4096
 T v[202:203],v231,5120
 M v[100:103],v[208:211],a[80:83],v[100:103]
 buffer_load_dwordx4 a[172:175],v224,s[8:11],s85 offen offset:3072 sc1
 v_mul_f32 v181,s78,v181
 M v[104:107],v[208:211],a[144:147],v[104:107]
 v_mul_f32 v182,s78,v182
 v_mul_f32 v183,s78,v183
 M v[108:111],v[208:211],a[208:211],v[108:111]
 W 6
 v_cvt_pk_bf16_f32 v248,v176,v177
 v_cvt_pk_bf16_f32 v250,v180,v181
 M v[112:115],v[212:215],a[16:19],v[112:115]
 T v[204:205],v232,4096
 T v[206:207],v232,5120
 M v[116:119],v[212:215],a[80:83],v[116:119]
 buffer_load_dwordx4 a[236:239],v241,s[8:11],s85 offen offset:3072 sc1
 v_cvt_pk_bf16_f32 v249,v178,v179
 M v[120:123],v[212:215],a[144:147],v[120:123]
 v_cvt_pk_bf16_f32 v251,v182,v183
 s_add_u32 s90,s76,557056
 M v[124:127],v[212:215],a[208:211],v[124:127]
 W 6
 v_permlane16_swap_b32 v248,v250
 M v[0:3],v[192:195],a[52:55],v[0:3]
 T v[208:209],v225,4096
 T v[210:211],v225,5120
 M v[4:7],v[192:195],a[116:119],v[4:7]
 s_add_u32 s84,s82,12288
 s_add_u32 s85,s83,12288
 buffer_load_dwordx4 a[48:51],v224,s[8:11],s84 offen offset:0 sc1
 M v[8:11],v[192:195],a[180:183],v[8:11]
 v_permlane16_swap_b32 v249,v251
 M v[12:15],v[192:195],a[244:247],v[12:15]
 W 6
 buffer_store_dwordx4 v[248:251],v224,s[8:11],s90 offen offset:3072 sc0 sc1
 M v[16:19],v[196:199],a[52:55],v[16:19]
 T v[212:213],v226,4096
 T v[214:215],v226,5120
 M v[20:23],v[196:199],a[116:119],v[20:23]
 buffer_load_dwordx4 a[112:115],v241,s[8:11],s84 offen offset:0 sc1
 M v[24:27],v[196:199],a[180:183],v[24:27]
 M v[28:31],v[196:199],a[244:247],v[28:31]
 W 6
 M v[32:35],v[200:203],a[52:55],v[32:35]
 T v[192:193],v227,4096
 T v[194:195],v227,5120
 M v[36:39],v[200:203],a[116:119],v[36:39]
 buffer_load_dwordx4 a[176:179],v224,s[8:11],s85 offen offset:0 sc1
 M v[40:43],v[200:203],a[180:183],v[40:43]
 M v[44:47],v[200:203],a[244:247],v[44:47]
 W 6
 M v[48:51],v[204:207],a[52:55],v[48:51]
 T v[196:197],v228,4096
 T v[198:199],v228,5120
 M v[52:55],v[204:207],a[116:119],v[52:55]
 buffer_load_dwordx4 a[240:243],v241,s[8:11],s85 offen offset:0 sc1
 M v[56:59],v[204:207],a[180:183],v[56:59]
 M v[60:63],v[204:207],a[244:247],v[60:63]
 W 6
 s_waitcnt vmcnt(53)
 M v[64:67],v[208:211],a[20:23],v[64:67]
 T v[200:201],v229,8192
 T v[202:203],v229,9216
 s_waitcnt vmcnt(52)
 M v[68:71],v[208:211],a[84:87],v[68:71]
 buffer_load_dwordx4 a[52:55],v224,s[8:11],s84 offen offset:1024 sc1
 v_mul_f32 v136,s78,v136
 s_waitcnt vmcnt(52)
 M v[72:75],v[208:211],a[148:151],v[72:75]
 v_mul_f32 v137,s78,v137
 v_mul_f32 v138,s78,v138
 s_waitcnt vmcnt(51)
 M v[76:79],v[208:211],a[212:215],v[76:79]
 W 6
 v_mul_f32 v139,s78,v139
 v_mul_f32 v140,s78,v140
 M v[80:83],v[212:215],a[20:23],v[80:83]
 T v[204:205],v230,8192
 T v[206:207],v230,9216
 M v[84:87],v[212:215],a[84:87],v[84:87]
 buffer_load_dwordx4 a[116:119],v241,s[8:11],s84 offen offset:1024 sc1
 v_mul_f32 v141,s78,v141
 M v[88:91],v[212:215],a[148:151],v[88:91]
 v_mul_f32 v142,s78,v142
 v_mul_f32 v143,s78,v143
 M v[92:95],v[212:215],a[212:215],v[92:95]
 W 6
 v_cvt_pk_bf16_f32 v244,v136,v137
 v_cvt_pk_bf16_f32 v246,v140,v141
 M v[96:99],v[192:195],a[20:23],v[96:99]
 T v[208:209],v231,8192
 T v[210:211],v231,9216
 M v[100:103],v[192:195],a[84:87],v[100:103]
 buffer_load_dwordx4 a[180:183],v224,s[8:11],s85 offen offset:1024 sc1
 v_cvt_pk_bf16_f32 v245,v138,v139
 M v[104:107],v[192:195],a[148:151],v[104:107]
 v_cvt_pk_bf16_f32 v247,v142,v143
 s_add_u32 s90,s76,565248
 M v[108:111],v[192:195],a[212:215],v[108:111]
 W 6
 v_permlane16_swap_b32 v244,v246
 M v[112:115],v[196:199],a[20:23],v[112:115]
 T v[212:213],v232,8192
 T v[214:215],v232,9216
 M v[116:119],v[196:199],a[84:87],v[116:119]
 buffer_load_dwordx4 a[244:247],v241,s[8:11],s85 offen offset:1024 sc1
 M v[120:123],v[196:199],a[148:151],v[120:123]
 v_permlane16_swap_b32 v245,v247
 M v[124:127],v[196:199],a[212:215],v[124:127]
 W 6
 buffer_store_dwordx4 v[244:247],v224,s[8:11],s90 offen offset:0 sc0 sc1
 M v[0:3],v[200:203],a[56:59],v[0:3]
 T v[192:193],v225,8192
 T v[194:195],v225,9216
 M v[4:7],v[200:203],a[120:123],v[4:7]
 M v[8:11],v[200:203],a[184:187],v[8:11]
 M v[12:15],v[200:203],a[248:251],v[12:15]
 W 6
 M v[16:19],v[204:207],a[56:59],v[16:19]
 T v[196:197],v226,8192
 T v[198:199],v226,9216
 M v[20:23],v[204:207],a[120:123],v[20:23]
 M v[24:27],v[204:207],a[184:187],v[24:27]
 M v[28:31],v[204:207],a[248:251],v[28:31]
 W 6
 M v[32:35],v[208:211],a[56:59],v[32:35]
 T v[200:201],v227,8192
 T v[202:203],v227,9216
 M v[36:39],v[208:211],a[120:123],v[36:39]
 M v[40:43],v[208:211],a[184:187],v[40:43]
 M v[44:47],v[208:211],a[248:251],v[44:47]
 W 6
 M v[48:51],v[212:215],a[56:59],v[48:51]
 T v[204:205],v228,8192
 T v[206:207],v228,9216
 M v[52:55],v[212:215],a[120:123],v[52:55]
 v_mul_f32 v168,s78,v168
 v_mul_f32 v169,s78,v169
 M v[56:59],v[212:215],a[184:187],v[56:59]
 v_mul_f32 v170,s78,v170
 v_mul_f32 v171,s78,v171
 M v[60:63],v[212:215],a[248:251],v[60:63]
 W 6
 v_mul_f32 v172,s78,v172
 v_mul_f32 v173,s78,v173
 s_waitcnt vmcnt(54)
 M v[64:67],v[192:195],a[24:27],v[64:67]
 T v[208:209],v229,12288
 T v[210:211],v229,13312
 s_waitcnt vmcnt(53)
 M v[68:71],v[192:195],a[88:91],v[68:71]
 buffer_load_dwordx4 a[56:59],v224,s[8:11],s84 offen offset:2048 sc1
 v_mul_f32 v174,s78,v174
 s_waitcnt vmcnt(53)
 M v[72:75],v[192:195],a[152:155],v[72:75]
 v_mul_f32 v175,s78,v175
 v_cvt_pk_bf16_f32 v248,v168,v169
 s_waitcnt vmcnt(52)
 M v[76:79],v[192:195],a[216:219],v[76:79]
 W 6
 v_cvt_pk_bf16_f32 v250,v172,v173
 v_cvt_pk_bf16_f32 v249,v170,v171
 M v[80:83],v[196:199],a[24:27],v[80:83]
 T v[212:213],v230,12288
 T v[214:215],v230,13312
 M v[84:87],v[196:199],a[88:91],v[84:87]
 buffer_load_dwordx4 a[120:123],v241,s[8:11],s84 offen offset:2048 sc1
 v_cvt_pk_bf16_f32 v251,v174,v175
 M v[88:91],v[196:199],a[152:155],v[88:91]
 s_add_u32 s90,s76,565248
 M v[92:95],v[196:199],a[216:219],v[92:95]
 W 6
 v_permlane16_swap_b32 v248,v250
 M v[96:99],v[200:203],a[24:27],v[96:99]
 T v[192:193],v231,12288
 T v[194:195],v231,13312
 M v[100:103],v[200:203],a[88:91],v[100:103]
 buffer_load_dwordx4 a[184:187],v224,s[8:11],s85 offen offset:2048 sc1
 M v[104:107],v[200:203],a[152:155],v[104:107]
 v_permlane16_swap_b32 v249,v251
 M v[108:111],v[200:203],a[216:219],v[108:111]
 W 6
 buffer_store_dwordx4 v[248:251],v224,s[8:11],s90 offen offset:2048 sc0 sc1
 M v[112:115],v[204:207],a[24:27],v[112:115]
 T v[196:197],v232,12288
 T v[198:199],v232,13312
 M v[116:119],v[204:207],a[88:91],v[116:119]
 buffer_load_dwordx4 a[248:251],v241,s[8:11],s85 offen offset:2048 sc1
 M v[120:123],v[204:207],a[152:155],v[120:123]
 M v[124:127],v[204:207],a[216:219],v[124:127]
 W 6
 M v[0:3],v[208:211],a[60:63],v[0:3]
 T v[200:201],v225,12288
 T v[202:203],v225,13312
 M v[4:7],v[208:211],a[124:127],v[4:7]
 M v[8:11],v[208:211],a[188:191],v[8:11]
 M v[12:15],v[208:211],a[252:255],v[12:15]
 W 6
 M v[16:19],v[212:215],a[60:63],v[16:19]
 T v[204:205],v226,12288
 T v[206:207],v226,13312
 M v[20:23],v[212:215],a[124:127],v[20:23]
 M v[24:27],v[212:215],a[188:191],v[24:27]
 M v[28:31],v[212:215],a[252:255],v[28:31]
 W 6
 M v[32:35],v[192:195],a[60:63],v[32:35]
 T v[208:209],v227,12288
 T v[210:211],v227,13312
 M v[36:39],v[192:195],a[124:127],v[36:39]
 M v[40:43],v[192:195],a[188:191],v[40:43]
 M v[44:47],v[192:195],a[252:255],v[44:47]
 W 6
 M v[48:51],v[196:199],a[60:63],v[48:51]
 T v[212:213],v228,12288
 T v[214:215],v228,13312
 M v[52:55],v[196:199],a[124:127],v[52:55]
 v_add_u32 v225,0x4000,v225
 v_add_u32 v226,0x4000,v226
 M v[56:59],v[196:199],a[188:191],v[56:59]
 v_add_u32 v227,0x4000,v227
 v_add_u32 v228,0x4000,v228
 M v[60:63],v[196:199],a[252:255],v[60:63]
 W 6
 s_barrier
 s_waitcnt vmcnt(47)
 M v[64:67],v[200:203],a[28:31],v[64:67]
 T v[192:193],v225,0
 T v[194:195],v225,1024
 s_waitcnt vmcnt(46)
 M v[68:71],v[200:203],a[92:95],v[68:71]
 s_add_u32 m0,s71,147456
 s_add_u32 s68,s81,128
 buffer_load_dwordx4 v233,s[24:27],s68 offen offset:0 lds
 s_waitcnt vmcnt(45)
 M v[72:75],v[200:203],a[156:159],v[72:75]
 s_waitcnt vmcnt(44)
 M v[76:79],v[200:203],a[220:223],v[76:79]
 W 6
 M v[80:83],v[204:207],a[28:31],v[80:83]
 T v[196:197],v226,0
 T v[198:199],v226,1024
 M v[84:87],v[204:207],a[92:95],v[84:87]
 buffer_load_dwordx4 v234,s[24:27],s68 offen offset:1024 lds
 M v[88:91],v[204:207],a[156:159],v[88:91]
 M v[92:95],v[204:207],a[220:223],v[92:95]
 W 6
 M v[96:99],v[208:211],a[28:31],v[96:99]
 T v[200:201],v227,0
 T v[202:203],v227,1024
 M v[100:103],v[208:211],a[92:95],v[100:103]
 buffer_load_dwordx4 v235,s[24:27],s68 offen offset:2048 lds
 v_mul_f32 v56,s78,v56
 M v[104:107],v[208:211],a[156:159],v[104:107]
 v_mul_f32 v57,s78,v57
 v_mul_f32 v58,s78,v58
 M v[108:111],v[208:211],a[220:223],v[108:111]
 W 6
 v_mul_f32 v59,s78,v59
 v_mul_f32 v60,s78,v60
 M v[112:115],v[212:215],a[28:31],v[112:115]
 T v[204:205],v228,0
 T v[206:207],v228,1024
 M v[116:119],v[212:215],a[92:95],v[116:119]
 buffer_load_dwordx4 v236,s[24:27],s68 offen offset:3072 lds
 v_mul_f32 v61,s78,v61
 M v[120:123],v[212:215],a[156:159],v[120:123]
 v_mul_f32 v62,s78,v62
 v_mul_f32 v63,s78,v63
 M v[124:127],v[212:215],a[220:223],v[124:127]
 W 6
 v_cvt_pk_bf16_f32 v244,v56,v57
 v_cvt_pk_bf16_f32 v246,v60,v61
 s_waitcnt vmcnt(46)
 M v[64:67],v[192:195],a[32:35],v[64:67]
 T v[208:209],v225,4096
 T v[210:211],v225,5120
 s_waitcnt vmcnt(45)
 M v[68:71],v[192:195],a[96:99],v[68:71]
 s_add_u32 m0,s71,114688
 s_add_u32 s68,s81,1048704
 buffer_load_dwordx4 v233,s[24:27],s68 offen offset:0 lds
 s_waitcnt vmcnt(45)
 M v[72:75],v[192:195],a[160:163],v[72:75]
 v_cvt_pk_bf16_f32 v245,v58,v59
 v_cvt_pk_bf16_f32 v247,v62,v63
 s_waitcnt vmcnt(44)
 M v[76:79],v[192:195],a[224:227],v[76:79]
 W 6
 s_add_u32 s90,s76,569344
 M v[80:83],v[196:199],a[32:35],v[80:83]
 T v[212:213],v226,4096
 T v[214:215],v226,5120
 M v[84:87],v[196:199],a[96:99],v[84:87]
 buffer_load_dwordx4 v234,s[24:27],s68 offen offset:1024 lds
 M v[88:91],v[196:199],a[160:163],v[88:91]
 v_permlane16_swap_b32 v244,v246
 M v[92:95],v[196:199],a[224:227],v[92:95]
 W 6
 v_permlane16_swap_b32 v245,v247
 M v[96:99],v[200:203],a[32:35],v[96:99]
 T v[192:193],v227,4096
 T v[194:195],v227,5120
 M v[100:103],v[200:203],a[96:99],v[100:103]
 buffer_load_dwordx4 v235,s[24:27],s68 offen offset:2048 lds
 buffer_store_dwordx4 v[244:247],v224,s[8:11],s90 offen offset:3072 sc0 sc1
 M v[104:107],v[200:203],a[160:163],v[104:107]
 v_mul_f32 v24,s78,v24
 v_mul_f32 v25,s78,v25
 M v[108:111],v[200:203],a[224:227],v[108:111]
 W 6
 v_mul_f32 v26,s78,v26
 v_mul_f32 v27,s78,v27
 M v[112:115],v[204:207],a[32:35],v[112:115]
 T v[196:197],v228,4096
 T v[198:199],v228,5120
 M v[116:119],v[204:207],a[96:99],v[116:119]
 buffer_load_dwordx4 v236,s[24:27],s68 offen offset:3072 lds
 v_mul_f32 v28,s78,v28
 M v[120:123],v[204:207],a[160:163],v[120:123]
 v_mul_f32 v29,s78,v29
 v_mul_f32 v30,s78,v30
 M v[124:127],v[204:207],a[224:227],v[124:127]
 W 6
 v_mul_f32 v31,s78,v31
 v_cvt_pk_bf16_f32 v248,v24,v25
 s_waitcnt vmcnt(47)
 M v[64:67],v[208:211],a[36:39],v[64:67]
 T v[200:201],v225,8192
 T v[202:203],v225,9216
 s_waitcnt vmcnt(45)
 M v[68:71],v[208:211],a[100:103],v[68:71]
 buffer_load_dwordx4 a[60:63],v224,s[8:11],s84 offen offset:3072 sc1
 v_cvt_pk_bf16_f32 v250,v28,v29
 s_waitcnt vmcnt(45)
 M v[72:75],v[208:211],a[164:167],v[72:75]
 v_cvt_pk_bf16_f32 v249,v26,v27
 v_cvt_pk_bf16_f32 v251,v30,v31
 s_waitcnt vmcnt(44)
 M v[76:79],v[208:211],a[228:231],v[76:79]
 W 6
 s_add_u32 s90,s76,569344
 M v[80:83],v[212:215],a[36:39],v[80:83]
 T v[204:205],v226,8192
 T v[206:207],v226,9216
 M v[84:87],v[212:215],a[100:103],v[84:87]
 buffer_load_dwordx4 a[124:127],v241,s[8:11],s84 offen offset:3072 sc1
 M v[88:91],v[212:215],a[164:167],v[88:91]
 v_permlane16_swap_b32 v248,v250
 M v[92:95],v[212:215],a[228:231],v[92:95]
 W 6
 v_permlane16_swap_b32 v249,v251
 M v[96:99],v[192:195],a[36:39],v[96:99]
 T v[208:209],v227,8192
 T v[210:211],v227,9216
 M v[100:103],v[192:195],a[100:103],v[100:103]
 buffer_load_dwordx4 a[188:191],v224,s[8:11],s85 offen offset:3072 sc1
 buffer_store_dwordx4 v[248:251],v224,s[8:11],s90 offen offset:1024 sc0 sc1
 M v[104:107],v[192:195],a[164:167],v[104:107]
 v_mul_f32 v0,s78,v0
 v_mul_f32 v1,s78,v1
 M v[108:111],v[192:195],a[228:231],v[108:111]
 W 6
 v_mul_f32 v2,s78,v2
 v_mul_f32 v3,s78,v3
 M v[112:115],v[196:199],a[36:39],v[112:115]
 T v[212:213],v228,8192
 T v[214:215],v228,9216
 M v[116:119],v[196:199],a[100:103],v[116:119]
 buffer_load_dwordx4 a[252:255],v241,s[8:11],s85 offen offset:3072 sc1
 v_mul_f32 v4,s78,v4
 M v[120:123],v[196:199],a[164:167],v[120:123]
 v_mul_f32 v5,s78,v5
 v_mul_f32 v6,s78,v6
 M v[124:127],v[196:199],a[228:231],v[124:127]
 W 6
 v_mul_f32 v7,s78,v7
 v_cvt_pk_bf16_f32 v244,v0,v1
 s_waitcnt vmcnt(46)
 M v[64:67],v[200:203],a[40:43],v[64:67]
 T v[192:193],v225,12288
 T v[194:195],v225,13312
 s_waitcnt vmcnt(45)
 M v[68:71],v[200:203],a[104:107],v[68:71]
 v_cvt_pk_bf16_f32 v246,v4,v5
 v_cvt_pk_bf16_f32 v245,v2,v3
 s_waitcnt vmcnt(44)
 M v[72:75],v[200:203],a[168:171],v[72:75]
 v_cvt_pk_bf16_f32 v247,v6,v7
 s_add_u32 s90,s76,561152
 s_waitcnt vmcnt(43)
 M v[76:79],v[200:203],a[232:235],v[76:79]
 W 6
 v_permlane16_swap_b32 v244,v246
 M v[80:83],v[204:207],a[40:43],v[80:83]
 T v[196:197],v226,12288
 T v[198:199],v226,13312
 M v[84:87],v[204:207],a[104:107],v[84:87]
 v_permlane16_swap_b32 v245,v247
 M v[88:91],v[204:207],a[168:171],v[88:91]
 buffer_store_dwordx4 v[244:247],v224,s[8:11],s90 offen offset:0 sc0 sc1
 v_mul_f32 v16,s78,v16
 M v[92:95],v[204:207],a[232:235],v[92:95]
 W 6
 v_mul_f32 v17,s78,v17
 v_mul_f32 v18,s78,v18
 M v[96:99],v[208:211],a[40:43],v[96:99]
 T v[200:201],v227,12288
 T v[202:203],v227,13312
 M v[100:103],v[208:211],a[104:107],v[100:103]
 v_mul_f32 v19,s78,v19
 v_mul_f32 v20,s78,v20
 M v[104:107],v[208:211],a[168:171],v[104:107]
 v_mul_f32 v21,s78,v21
 v_mul_f32 v22,s78,v22
 M v[108:111],v[208:211],a[232:235],v[108:111]
 W 6
 v_mul_f32 v23,s78,v23
 v_cvt_pk_bf16_f32 v248,v16,v17
 M v[112:115],v[212:215],a[40:43],v[112:115]
 T v[204:205],v228,12288
 T v[206:207],v228,13312
 M v[116:119],v[212:215],a[104:107],v[116:119]
 v_add_u32 v225,0x4000,v225
 v_add_u32 v226,0x4000,v226
 v_cvt_pk_bf16_f32 v250,v20,v21
 M v[120:123],v[212:215],a[168:171],v[120:123]
 v_add_u32 v227,0x4000,v227
 v_add_u32 v228,0x4000,v228
 v_cvt_pk_bf16_f32 v249,v18,v19
 M v[124:127],v[212:215],a[232:235],v[124:127]
 W 6
 v_cvt_pk_bf16_f32 v251,v22,v23
 s_add_u32 s90,s76,561152
 s_waitcnt vmcnt(33)
 M v[64:67],v[192:195],a[44:47],v[64:67]
 T v[208:209],v225,0
 T v[210:211],v225,1024
 s_waitcnt vmcnt(32)
 M v[68:71],v[192:195],a[108:111],v[68:71]
 v_permlane16_swap_b32 v248,v250
 s_waitcnt vmcnt(31)
 M v[72:75],v[192:195],a[172:175],v[72:75]
 v_permlane16_swap_b32 v249,v251
 s_waitcnt vmcnt(30)
 M v[76:79],v[192:195],a[236:239],v[76:79]
 W 6
 buffer_store_dwordx4 v[248:251],v224,s[8:11],s90 offen offset:1024 sc0 sc1
 v_mul_f32 v32,s78,v32
 M v[80:83],v[196:199],a[44:47],v[80:83]
 T v[212:213],v226,0
 T v[214:215],v226,1024
 M v[84:87],v[196:199],a[108:111],v[84:87]
 v_mul_f32 v33,s78,v33
 v_mul_f32 v34,s78,v34
 M v[88:91],v[196:199],a[172:175],v[88:91]
 v_mul_f32 v35,s78,v35
 v_mul_f32 v36,s78,v36
 M v[92:95],v[196:199],a[236:239],v[92:95]
 W 6
 v_mul_f32 v37,s78,v37
 v_mul_f32 v38,s78,v38
 M v[96:99],v[200:203],a[44:47],v[96:99]
 T v[192:193],v227,0
 T v[194:195],v227,1024
 M v[100:103],v[200:203],a[108:111],v[100:103]
 v_mul_f32 v39,s78,v39
 v_cvt_pk_bf16_f32 v244,v32,v33
 M v[104:107],v[200:203],a[172:175],v[104:107]
 v_cvt_pk_bf16_f32 v246,v36,v37
 v_cvt_pk_bf16_f32 v245,v34,v35
 M v[108:111],v[200:203],a[236:239],v[108:111]
 W 6
 v_cvt_pk_bf16_f32 v247,v38,v39
 s_add_u32 s90,s76,561152
 M v[112:115],v[204:207],a[44:47],v[112:115]
 T v[196:197],v228,0
 T v[198:199],v228,1024
 M v[116:119],v[204:207],a[108:111],v[116:119]
 v_permlane16_swap_b32 v244,v246
 M v[120:123],v[204:207],a[172:175],v[120:123]
 v_permlane16_swap_b32 v245,v247
 M v[124:127],v[204:207],a[236:239],v[124:127]
 W 6
 buffer_store_dwordx4 v[244:247],v224,s[8:11],s90 offen offset:2048 sc0 sc1
 v_mul_f32 v48,s78,v48
 s_waitcnt vmcnt(31)
 M v[64:67],v[208:211],a[48:51],v[64:67]
 T v[200:201],v225,4096
 T v[202:203],v225,5120
 s_waitcnt vmcnt(29)
 M v[68:71],v[208:211],a[112:115],v[68:71]
 v_mul_f32 v49,s78,v49
 v_mul_f32 v50,s78,v50
 s_waitcnt vmcnt(28)
 M v[72:75],v[208:211],a[176:179],v[72:75]
 v_mul_f32 v51,s78,v51
 v_mul_f32 v52,s78,v52
 s_waitcnt vmcnt(27)
 M v[76:79],v[208:211],a[240:243],v[76:79]
 W 6
 v_mul_f32 v53,s78,v53
 v_mul_f32 v54,s78,v54
 M v[80:83],v[212:215],a[48:51],v[80:83]
 T v[204:205],v226,4096
 T v[206:207],v226,5120
 M v[84:87],v[212:215],a[112:115],v[84:87]
 v_mul_f32 v55,s78,v55
 v_cvt_pk_bf16_f32 v248,v48,v49
 M v[88:91],v[212:215],a[176:179],v[88:91]
 v_cvt_pk_bf16_f32 v250,v52,v53
 v_cvt_pk_bf16_f32 v249,v50,v51
 M v[92:95],v[212:215],a[240:243],v[92:95]
 W 6
 v_cvt_pk_bf16_f32 v251,v54,v55
 s_add_u32 s90,s76,561152
 M v[96:99],v[192:195],a[48:51],v[96:99]
 T v[208:209],v227,4096
 T v[210:211],v227,5120
 M v[100:103],v[192:195],a[112:115],v[100:103]
 v_permlane16_swap_b32 v248,v250
 M v[104:107],v[192:195],a[176:179],v[104:107]
 v_permlane16_swap_b32 v249,v251
 M v[108:111],v[192:195],a[240:243],v[108:111]
 W 6
 buffer_store_dwordx4 v[248:251],v224,s[8:11],s90 offen offset:3072 sc0 sc1
 v_mul_f32 v8,s78,v8
 M v[112:115],v[196:199],a[48:51],v[112:115]
 T v[212:213],v228,4096
 T v[214:215],v228,5120
 M v[116:119],v[196:199],a[112:115],v[116:119]
 v_mul_f32 v9,s78,v9
 v_mul_f32 v10,s78,v10
 M v[120:123],v[196:199],a[176:179],v[120:123]
 v_mul_f32 v11,s78,v11
 v_mul_f32 v12,s78,v12
 M v[124:127],v[196:199],a[240:243],v[124:127]
 W 6
 v_mul_f32 v13,s78,v13
 v_mul_f32 v14,s78,v14
 s_waitcnt vmcnt(27)
 M v[64:67],v[200:203],a[52:55],v[64:67]
 T v[192:193],v225,8192
 T v[194:195],v225,9216
 s_waitcnt vmcnt(26)
 M v[68:71],v[200:203],a[116:119],v[68:71]
 v_mul_f32 v15,s78,v15
 v_cvt_pk_bf16_f32 v244,v8,v9
 s_waitcnt vmcnt(25)
 M v[72:75],v[200:203],a[180:183],v[72:75]
 v_cvt_pk_bf16_f32 v246,v12,v13
 v_cvt_pk_bf16_f32 v245,v10,v11
 s_waitcnt vmcnt(24)
 M v[76:79],v[200:203],a[244:247],v[76:79]
 W 6
 v_cvt_pk_bf16_f32 v247,v14,v15
 s_add_u32 s90,s76,569344
 M v[80:83],v[204:207],a[52:55],v[80:83]
 T v[196:197],v226,8192
 T v[198:199],v226,9216
 M v[84:87],v[204:207],a[116:119],v[84:87]
 v_permlane16_swap_b32 v244,v246
 M v[88:91],v[204:207],a[180:183],v[88:91]
 v_permlane16_swap_b32 v245,v247
 M v[92:95],v[204:207],a[244:247],v[92:95]
 W 6
 buffer_store_dwordx4 v[244:247],v224,s[8:11],s90 offen offset:0 sc0 sc1
 v_mul_f32 v40,s78,v40
 M v[96:99],v[208:211],a[52:55],v[96:99]
 T v[200:201],v227,8192
 T v[202:203],v227,9216
 M v[100:103],v[208:211],a[116:119],v[100:103]
 v_mul_f32 v41,s78,v41
 v_mul_f32 v42,s78,v42
 M v[104:107],v[208:211],a[180:183],v[104:107]
 v_mul_f32 v43,s78,v43
 v_mul_f32 v44,s78,v44
 M v[108:111],v[208:211],a[244:247],v[108:111]
 W 6
 v_mul_f32 v45,s78,v45
 v_mul_f32 v46,s78,v46
 M v[112:115],v[212:215],a[52:55],v[112:115]
 T v[204:205],v228,8192
 T v[206:207],v228,9216
 M v[116:119],v[212:215],a[116:119],v[116:119]
 v_mul_f32 v47,s78,v47
 v_cvt_pk_bf16_f32 v248,v40,v41
 M v[120:123],v[212:215],a[180:183],v[120:123]
 v_cvt_pk_bf16_f32 v250,v44,v45
 v_cvt_pk_bf16_f32 v249,v42,v43
 M v[124:127],v[212:215],a[244:247],v[124:127]
 W 6
 v_cvt_pk_bf16_f32 v251,v46,v47
 s_add_u32 s90,s76,569344
 s_waitcnt vmcnt(23)
 M v[64:67],v[192:195],a[56:59],v[64:67]
 T v[208:209],v225,12288
 T v[210:211],v225,13312
 s_waitcnt vmcnt(22)
 M v[68:71],v[192:195],a[120:123],v[68:71]
 v_permlane16_swap_b32 v248,v250
 s_waitcnt vmcnt(21)
 M v[72:75],v[192:195],a[184:187],v[72:75]
 v_permlane16_swap_b32 v249,v251
 s_waitcnt vmcnt(19)
 M v[76:79],v[192:195],a[248:251],v[76:79]
 W 6
 buffer_store_dwordx4 v[248:251],v224,s[8:11],s90 offen offset:2048 sc0 sc1
 M v[80:83],v[196:199],a[56:59],v[80:83]
 T v[212:213],v226,12288
 T v[214:215],v226,13312
 M v[84:87],v[196:199],a[120:123],v[84:87]
 M v[88:91],v[196:199],a[184:187],v[88:91]
 M v[92:95],v[196:199],a[248:251],v[92:95]
 W 6
 M v[96:99],v[200:203],a[56:59],v[96:99]
 T v[192:193],v227,12288
 T v[194:195],v227,13312
 M v[100:103],v[200:203],a[120:123],v[100:103]
 M v[104:107],v[200:203],a[184:187],v[104:107]
 M v[108:111],v[200:203],a[248:251],v[108:111]
 W 6
 M v[112:115],v[204:207],a[56:59],v[112:115]
 T v[196:197],v228,12288
 T v[198:199],v228,13312
 M v[116:119],v[204:207],a[120:123],v[116:119]
 v_add_u32 v229,0xfffec000,v229
 v_add_u32 v230,0xfffec000,v230
 M v[120:123],v[204:207],a[184:187],v[120:123]
 v_add_u32 v231,0xfffec000,v231
 v_add_u32 v232,0xfffec000,v232
 M v[124:127],v[204:207],a[248:251],v[124:127]
 W 6
 s_barrier
 s_waitcnt vmcnt(10)
 M v[64:67],v[208:211],a[60:63],v[64:67]
 T v[200:201],v229,0
 T v[202:203],v229,1024
 s_waitcnt vmcnt(9)
 M v[68:71],v[208:211],a[124:127],v[68:71]
 s_add_u32 m0,s71,131072
 s_add_u32 s68,s81,2097280
 buffer_load_dwordx4 v233,s[24:27],s68 offen offset:0 lds
 s_waitcnt vmcnt(9)
 M v[72:75],v[208:211],a[188:191],v[72:75]
 s_waitcnt vmcnt(7)
 M v[76:79],v[208:211],a[252:255],v[76:79]
 W 6
 M v[80:83],v[212:215],a[60:63],v[80:83]
 T v[204:205],v230,0
 T v[206:207],v230,1024
 M v[84:87],v[212:215],a[124:127],v[84:87]
 buffer_load_dwordx4 v234,s[24:27],s68 offen offset:1024 lds
 M v[88:91],v[212:215],a[188:191],v[88:91]
 M v[92:95],v[212:215],a[252:255],v[92:95]
 W 6
 M v[96:99],v[192:195],a[60:63],v[96:99]
 T v[208:209],v231,0
 T v[210:211],v231,1024
 M v[100:103],v[192:195],a[124:127],v[100:103]
 buffer_load_dwordx4 v235,s[24:27],s68 offen offset:2048 lds
 M v[104:107],v[192:195],a[188:191],v[104:107]
 M v[108:111],v[192:195],a[252:255],v[108:111]
 W 6
 M v[112:115],v[196:199],a[60:63],v[112:115]
 T v[212:213],v232,0
 T v[214:215],v232,1024
 M v[116:119],v[196:199],a[124:127],v[116:119]
 buffer_load_dwordx4 v236,s[24:27],s68 offen offset:3072 lds
 M v[120:123],v[196:199],a[188:191],v[120:123]
 M v[124:127],v[196:199],a[252:255],v[124:127]
 W 6
 M v[0:3],v[200:203],a[0:3],0
 T v[192:193],v229,4096
 T v[194:195],v229,5120
 M v[4:7],v[200:203],a[64:67],0
 M v[8:11],v[200:203],a[128:131],0
 M v[12:15],v[200:203],a[192:195],0
 W 6
 M v[16:19],v[204:207],a[0:3],0
 T v[196:197],v230,4096
 T v[198:199],v230,5120
 M v[20:23],v[204:207],a[64:67],0
 M v[24:27],v[204:207],a[128:131],0
 M v[28:31],v[204:207],a[192:195],0
 W 6
 M v[32:35],v[208:211],a[0:3],0
 T v[200:201],v231,4096
 T v[202:203],v231,5120
 M v[36:39],v[208:211],a[64:67],0
 v_mul_f32 v237,v64,v64
 v_mul_f32 v238,v65,v65
 M v[40:43],v[208:211],a[128:131],0
 v_mul_f32 v239,v66,v66
 v_mul_f32 v240,v67,v67
 M v[44:47],v[208:211],a[192:195],0
 W 6
 v_fma_f32 v237,v237,v242,s88
 v_fma_f32 v238,v238,v242,s88
 M v[48:51],v[212:215],a[0:3],0
 T v[204:205],v232,4096
 T v[206:207],v232,5120
 M v[52:55],v[212:215],a[64:67],0
 v_fma_f32 v239,v239,v242,s88
 v_fma_f32 v240,v240,v242,s88
 M v[56:59],v[212:215],a[128:131],0
 v_mul_f32 v237,v237,v64
 v_mul_f32 v238,v238,v65
 M v[60:63],v[212:215],a[192:195],0
 W 6
 v_mul_f32 v239,v239,v66
 v_mul_f32 v240,v240,v67
 M v[0:3],v[192:195],a[4:7],v[0:3]
 T v[208:209],v229,8192
 T v[210:211],v229,9216
 M v[4:7],v[192:195],a[68:71],v[4:7]
 v_exp_f32 v237,v237
 M v[8:11],v[192:195],a[132:135],v[8:11]
 v_exp_f32 v238,v238
 M v[12:15],v[192:195],a[196:199],v[12:15]
 W 6
 v_exp_f32 v239,v239
 M v[16:19],v[196:199],a[4:7],v[16:19]
 T v[212:213],v230,8192
 T v[214:215],v230,9216
 M v[20:23],v[196:199],a[68:71],v[20:23]
 v_exp_f32 v240,v240
 M v[24:27],v[196:199],a[132:135],v[24:27]
 v_add_f32 v237,1.0,v237
 v_add_f32 v238,1.0,v238
 M v[28:31],v[196:199],a[196:199],v[28:31]
 W 6
 v_add_f32 v239,1.0,v239
 v_add_f32 v240,1.0,v240
 M v[32:35],v[200:203],a[4:7],v[32:35]
 T v[192:193],v231,8192
 T v[194:195],v231,9216
 M v[36:39],v[200:203],a[68:71],v[36:39]
 v_rcp_f32 v237,v237
 M v[40:43],v[200:203],a[132:135],v[40:43]
 v_rcp_f32 v238,v238
 M v[44:47],v[200:203],a[196:199],v[44:47]
 W 6
 v_rcp_f32 v239,v239
 M v[48:51],v[204:207],a[4:7],v[48:51]
 T v[196:197],v232,8192
 T v[198:199],v232,9216
 M v[52:55],v[204:207],a[68:71],v[52:55]
 v_rcp_f32 v240,v240
 M v[56:59],v[204:207],a[132:135],v[56:59]
 v_mul_f32 v237,v237,v64
 v_mul_f32 v238,v238,v65
 M v[60:63],v[204:207],a[196:199],v[60:63]
 W 6
 v_mul_f32 v239,v239,v66
 v_mul_f32 v240,v240,v67
 M v[0:3],v[208:211],a[8:11],v[0:3]
 T v[200:201],v229,12288
 T v[202:203],v229,13312
 M v[4:7],v[208:211],a[72:75],v[4:7]
 v_cvt_pk_bf16_f32 v244,v237,v238
 v_cvt_pk_bf16_f32 v245,v239,v240
 M v[8:11],v[208:211],a[136:139],v[8:11]
 v_mul_f32 v237,v80,v80
 v_mul_f32 v238,v81,v81
 M v[12:15],v[208:211],a[200:203],v[12:15]
 W 6
 v_mul_f32 v239,v82,v82
 v_mul_f32 v240,v83,v83
 M v[16:19],v[212:215],a[8:11],v[16:19]
 T v[204:205],v230,12288
 T v[206:207],v230,13312
 M v[20:23],v[212:215],a[72:75],v[20:23]
 v_fma_f32 v237,v237,v242,s88
 v_fma_f32 v238,v238,v242,s88
 M v[24:27],v[212:215],a[136:139],v[24:27]
 v_fma_f32 v239,v239,v242,s88
 v_fma_f32 v240,v240,v242,s88
 M v[28:31],v[212:215],a[200:203],v[28:31]
 W 6
 v_mul_f32 v237,v237,v80
 v_mul_f32 v238,v238,v81
 M v[32:35],v[192:195],a[8:11],v[32:35]
 T v[208:209],v231,12288
 T v[210:211],v231,13312
 M v[36:39],v[192:195],a[72:75],v[36:39]
 v_mul_f32 v239,v239,v82
 v_mul_f32 v240,v240,v83
 M v[40:43],v[192:195],a[136:139],v[40:43]
 v_exp_f32 v237,v237
 M v[44:47],v[192:195],a[200:203],v[44:47]
 W 6
 v_exp_f32 v238,v238
 M v[48:51],v[196:199],a[8:11],v[48:51]
 T v[212:213],v232,12288
 T v[214:215],v232,13312
 M v[52:55],v[196:199],a[72:75],v[52:55]
 v_add_u32 v229,0x4000,v229
 v_add_u32 v230,0x4000,v230
 M v[56:59],v[196:199],a[136:139],v[56:59]
 v_add_u32 v231,0x4000,v231
 v_add_u32 v232,0x4000,v232
 M v[60:63],v[196:199],a[200:203],v[60:63]
 W 6
 v_exp_f32 v239,v239
 M v[0:3],v[200:203],a[12:15],v[0:3]
 T v[192:193],v229,0
 T v[194:195],v229,1024
 M v[4:7],v[200:203],a[76:79],v[4:7]
 v_exp_f32 v240,v240
 M v[8:11],v[200:203],a[140:143],v[8:11]
 v_add_f32 v237,1.0,v237
 v_add_f32 v238,1.0,v238
 M v[12:15],v[200:203],a[204:207],v[12:15]
 W 6
 v_add_f32 v239,1.0,v239
 v_add_f32 v240,1.0,v240
 M v[16:19],v[204:207],a[12:15],v[16:19]
 T v[196:197],v230,0
 T v[198:199],v230,1024
 M v[20:23],v[204:207],a[76:79],v[20:23]
 v_rcp_f32 v237,v237
 M v[24:27],v[204:207],a[140:143],v[24:27]
 v_rcp_f32 v238,v238
 M v[28:31],v[204:207],a[204:207],v[28:31]
 W 6
 v_rcp_f32 v239,v239
 M v[32:35],v[208:211],a[12:15],v[32:35]
 T v[200:201],v231,0
 T v[202:203],v231,1024
 M v[36:39],v[208:211],a[76:79],v[36:39]
 v_rcp_f32 v240,v240
 M v[40:43],v[208:211],a[140:143],v[40:43]
 v_mul_f32 v237,v237,v80
 v_mul_f32 v238,v238,v81
 M v[44:47],v[208:211],a[204:207],v[44:47]
 W 6
 v_mul_f32 v239,v239,v82
 v_mul_f32 v240,v240,v83
 M v[48:51],v[212:215],a[12:15],v[48:51]
 T v[204:205],v232,0
 T v[206:207],v232,1024
 M v[52:55],v[212:215],a[76:79],v[52:55]
 v_cvt_pk_bf16_f32 v246,v237,v238
 v_cvt_pk_bf16_f32 v247,v239,v240
 M v[56:59],v[212:215],a[140:143],v[56:59]
 s_add_u32 s90,s86,0
 buffer_store_dwordx4 v[244:247],v224,s[8:11],s90 offen offset:0 sc0 sc1
 M v[60:63],v[212:215],a[204:207],v[60:63]
 W 6
 v_mul_f32 v237,v96,v96
 v_mul_f32 v238,v97,v97
 s_branch F_J
F_V:
 s_waitcnt vmcnt(22)
 ds_read_b128 a[0:3],v178 offset:0
 ds_read_b128 a[64:67],v178 offset:2048
 ds_read_b128 a[128:131],v178 offset:4096
 ds_read_b128 a[192:195],v178 offset:6144
 ds_read_b128 a[4:7],v179 offset:0
 ds_read_b128 a[68:71],v179 offset:2048
 ds_read_b128 a[132:135],v179 offset:4096
 ds_read_b128 a[196:199],v179 offset:6144
 s_waitcnt vmcnt(18)
 s_barrier
 T v[192:193],v225,0
 T v[194:195],v225,1024
 T v[196:197],v226,0
 T v[198:199],v226,1024
 T v[200:201],v227,0
 T v[202:203],v227,1024
 T v[204:205],v228,0
 T v[206:207],v228,1024
 W 6
 M v[0:3],a[0:3],v[192:195],0
 T v[208:209],v225,4096
 T v[210:211],v225,5120
 M v[4:7],a[64:67],v[192:195],0
 s_add_u32 m0,s71,114688
 s_add_u32 s68,s74,1048576
 buffer_load_dwordx4 v233,s[20:23],s68 offen offset:0 lds
 M v[8:11],a[128:131],v[192:195],0
 buffer_load_dwordx4 v234,s[20:23],s68 offen offset:1024 lds
 s_waitcnt vmcnt(19)
 v_lshlrev_b32 v128,16,v144
 M v[12:15],a[192:195],v[192:195],0
 W 6
 v_and_b32 v129,0xffff0000,v144
 v_lshlrev_b32 v130,16,v145
 M v[16:19],a[0:3],v[196:199],0
 T v[212:213],v226,4096
 T v[214:215],v226,5120
 M v[20:23],a[64:67],v[196:199],0
 buffer_load_dwordx4 v235,s[20:23],s68 offen offset:2048 lds
 v_and_b32 v131,0xffff0000,v145
 M v[24:27],a[128:131],v[196:199],0
 buffer_load_dwordx4 v236,s[20:23],s68 offen offset:3072 lds
 v_lshlrev_b32 v132,16,v146
 M v[28:31],a[192:195],v[196:199],0
 W 6
 v_and_b32 v133,0xffff0000,v146
 v_lshlrev_b32 v134,16,v147
 M v[32:35],a[0:3],v[200:203],0
 T v[192:193],v227,4096
 T v[194:195],v227,5120
 M v[36:39],a[64:67],v[200:203],0
 s_waitcnt vmcnt(12)
 s_add_u32 m0,s71,131072
 s_add_u32 s68,s74,2097152
 buffer_load_dwordx4 v233,s[20:23],s68 offen offset:0 lds
 M v[40:43],a[128:131],v[200:203],0
 ds_read_b128 a[8:11],v178 offset:8192
 ds_read_b128 a[72:75],v178 offset:10240
 buffer_load_dwordx4 v234,s[20:23],s68 offen offset:1024 lds
 M v[44:47],a[192:195],v[200:203],0
 W 8
 v_and_b32 v135,0xffff0000,v147
 v_lshlrev_b32 v136,16,v148
 M v[48:51],a[0:3],v[204:207],0
 T v[196:197],v228,4096
 T v[198:199],v228,5120
 M v[52:55],a[64:67],v[204:207],0
 buffer_load_dwordx4 v235,s[20:23],s68 offen offset:2048 lds
 v_and_b32 v137,0xffff0000,v148
 M v[56:59],a[128:131],v[204:207],0
 ds_read_b128 a[136:139],v178 offset:12288
 ds_read_b128 a[200:203],v178 offset:14336
 buffer_load_dwordx4 v236,s[20:23],s68 offen offset:3072 lds
 M v[60:63],a[192:195],v[204:207],0
 W 10
 v_lshlrev_b32 v138,16,v149
 v_and_b32 v139,0xffff0000,v149
 M v[0:3],a[4:7],v[208:211],v[0:3]
 T v[200:201],v225,8192
 T v[202:203],v225,9216
 M v[4:7],a[68:71],v[208:211],v[4:7]
 s_add_u32 m0,s71,147456
 s_add_u32 s68,s74,128
 buffer_load_dwordx4 v233,s[20:23],s68 offen offset:0 lds
 M v[8:11],a[132:135],v[208:211],v[8:11]
 ds_read_b128 a[12:15],v179 offset:8192
 ds_read_b128 a[76:79],v179 offset:10240
 buffer_load_dwordx4 v234,s[20:23],s68 offen offset:1024 lds
 M v[12:15],a[196:199],v[208:211],v[12:15]
 W 12
 v_lshlrev_b32 v140,16,v150
 v_and_b32 v141,0xffff0000,v150
 M v[16:19],a[4:7],v[212:215],v[16:19]
 T v[204:205],v226,8192
 T v[206:207],v226,9216
 M v[20:23],a[68:71],v[212:215],v[20:23]
 buffer_load_dwordx4 v235,s[20:23],s68 offen offset:2048 lds
 M v[24:27],a[132:135],v[212:215],v[24:27]
 ds_read_b128 a[140:143],v179 offset:12288
 ds_read_b128 a[204:207],v179 offset:14336
 buffer_load_dwordx4 v236,s[20:23],s68 offen offset:3072 lds
 M v[28:31],a[196:199],v[212:215],v[28:31]
 W 14
 v_lshlrev_b32 v142,16,v151
 v_and_b32 v143,0xffff0000,v151
 M v[32:35],a[4:7],v[192:195],v[32:35]
 T v[208:209],v227,8192
 T v[210:211],v227,9216
 M v[36:39],a[68:71],v[192:195],v[36:39]
 s_add_u32 m0,s77,0
 s_add_u32 s68,s75,384
 buffer_load_dwordx4 v180,s[16:19],s68 offen offset:0 lds
 M v[40:43],a[132:135],v[192:195],v[40:43]
 buffer_load_dwordx4 v181,s[16:19],s68 offen offset:1024 lds
 v_add_f32 v153,v128,v129
 M v[44:47],a[196:199],v[192:195],v[44:47]
 W 12
 v_add_f32 v153,v153,v130
 v_add_f32 v153,v153,v131
 M v[48:51],a[4:7],v[196:199],v[48:51]
 T v[212:213],v228,8192
 T v[214:215],v228,9216
 M v[52:55],a[68:71],v[196:199],v[52:55]
 buffer_load_dwordx4 v182,s[16:19],s68 offen offset:2048 lds
 v_add_f32 v153,v153,v132
 M v[56:59],a[132:135],v[196:199],v[56:59]
 buffer_load_dwordx4 v183,s[16:19],s68 offen offset:3072 lds
 v_add_f32 v153,v153,v133
 M v[60:63],a[196:199],v[196:199],v[60:63]
 W 10
 v_add_f32 v153,v153,v134
 v_add_f32 v153,v153,v135
 M v[0:3],a[8:11],v[200:203],v[0:3]
 T v[192:193],v225,12288
 T v[194:195],v225,13312
 M v[4:7],a[72:75],v[200:203],v[4:7]
 s_add_u32 m0,s77,4096
 s_add_u32 s68,s75,33152
 buffer_load_dwordx4 v180,s[16:19],s68 offen offset:0 lds
 M v[8:11],a[136:139],v[200:203],v[8:11]
 buffer_load_dwordx4 v181,s[16:19],s68 offen offset:1024 lds
 v_add_f32 v153,v153,v136
 M v[12:15],a[200:203],v[200:203],v[12:15]
 W 8
 v_add_f32 v153,v153,v137
 v_add_f32 v153,v153,v138
 M v[16:19],a[8:11],v[204:207],v[16:19]
 T v[196:197],v226,12288
 T v[198:199],v226,13312
 M v[20:23],a[72:75],v[204:207],v[20:23]
 buffer_load_dwordx4 v182,s[16:19],s68 offen offset:2048 lds
 v_add_f32 v153,v153,v139
 M v[24:27],a[136:139],v[204:207],v[24:27]
 buffer_load_dwordx4 v183,s[16:19],s68 offen offset:3072 lds
 v_add_f32 v153,v153,v140
 M v[28:31],a[200:203],v[204:207],v[28:31]
 W 6
 v_add_f32 v153,v153,v141
 v_add_f32 v153,v153,v142
 M v[32:35],a[8:11],v[208:211],v[32:35]
 T v[200:201],v227,12288
 T v[202:203],v227,13312
 M v[36:39],a[72:75],v[208:211],v[36:39]
 s_waitcnt vmcnt(20)
 s_add_u32 m0,s77,8192
 s_add_u32 s68,s75,512
 buffer_load_dwordx4 v180,s[16:19],s68 offen offset:0 lds
 M v[40:43],a[136:139],v[208:211],v[40:43]
 ds_read_b128 a[16:19],v178 offset:16384
 ds_read_b128 a[80:83],v178 offset:18432
 buffer_load_dwordx4 v181,s[16:19],s68 offen offset:1024 lds
 M v[44:47],a[200:203],v[208:211],v[44:47]
 W 8
 v_add_f32 v153,v153,v143
 s_nop 1
 v_add_f32_dpp v153,v153,v153 quad_perm:[1,0,3,2] row_mask:0xf bank_mask:0xf
 M v[48:51],a[8:11],v[212:215],v[48:51]
 T v[204:205],v228,12288
 T v[206:207],v228,13312
 M v[52:55],a[72:75],v[212:215],v[52:55]
 v_add_u32 v225,0x4000,v225
 v_add_u32 v226,0x4000,v226
 buffer_load_dwordx4 v182,s[16:19],s68 offen offset:2048 lds
 M v[56:59],a[136:139],v[212:215],v[56:59]
 v_add_u32 v227,0x4000,v227
 v_add_u32 v228,0x4000,v228
 ds_read_b128 a[144:147],v178 offset:20480
 ds_read_b128 a[208:211],v178 offset:22528
 buffer_load_dwordx4 v183,s[16:19],s68 offen offset:3072 lds
 M v[60:63],a[200:203],v[212:215],v[60:63]
 W 10
 s_waitcnt vmcnt(20)
 s_barrier
 v_add_f32_dpp v153,v153,v153 quad_perm:[2,3,0,1] row_mask:0xf bank_mask:0xf
 M v[0:3],a[12:15],v[192:195],v[0:3]
 T v[208:209],v225,0
 T v[210:211],v225,1024
 M v[4:7],a[76:79],v[192:195],v[4:7]
 s_add_u32 m0,s77,12288
 s_add_u32 s68,s75,33280
 buffer_load_dwordx4 v180,s[16:19],s68 offen offset:0 lds
 M v[8:11],a[140:143],v[192:195],v[8:11]
 ds_read_b128 a[20:23],v179 offset:16384
 ds_read_b128 a[84:87],v179 offset:18432
 buffer_load_dwordx4 v181,s[16:19],s68 offen offset:1024 lds
 M v[12:15],a[204:207],v[192:195],v[12:15]
 W 12
 v_add_f32_dpp v153,v153,v153 row_half_mirror row_mask:0xf bank_mask:0xf
 s_nop 1
 v_add_f32_dpp v153,v153,v153 row_mirror row_mask:0xf bank_mask:0xf
 M v[16:19],a[12:15],v[196:199],v[16:19]
 T v[212:213],v226,0
 T v[214:215],v226,1024
 M v[20:23],a[76:79],v[196:199],v[20:23]
 buffer_load_dwordx4 v182,s[16:19],s68 offen offset:2048 lds
 v_mov_b32 v154,v153
 M v[24:27],a[140:143],v[196:199],v[24:27]
 ds_read_b128 a[148:151],v179 offset:20480
 ds_read_b128 a[212:215],v179 offset:22528
 buffer_load_dwordx4 v183,s[16:19],s68 offen offset:3072 lds
 M v[28:31],a[204:207],v[196:199],v[28:31]
 W 14
 v_permlane16_swap_b32 v153,v154
 M v[32:35],a[12:15],v[200:203],v[32:35]
 T v[192:193],v227,0
 T v[194:195],v227,1024
 M v[36:39],a[76:79],v[200:203],v[36:39]
 global_load_dword v221,v168,s[6:7]
 v_add_f32 v153,v153,v154
 M v[40:43],a[140:143],v[200:203],v[40:43]
 v_mul_f32 v153,0x3b000000,v153
 v_cvt_pk_bf16_f32 v155,v153,v153
 M v[44:47],a[204:207],v[200:203],v[44:47]
 W 12
 v_and_b32 v155,0xffff0000,v155
 v_sub_f32 v154,v128,v153
 M v[48:51],a[12:15],v[204:207],v[48:51]
 T v[196:197],v228,0
 T v[198:199],v228,1024
 M v[52:55],a[76:79],v[204:207],v[52:55]
 v_mul_f32 v156,v154,v154
 v_sub_f32 v154,v129,v153
 M v[56:59],a[140:143],v[204:207],v[56:59]
 v_fmac_f32 v156,v154,v154
 v_sub_f32 v154,v130,v153
 M v[60:63],a[204:207],v[204:207],v[60:63]
 W 10
 v_fmac_f32 v156,v154,v154
 v_sub_f32 v154,v131,v153
 M v[0:3],a[16:19],v[208:211],v[0:3]
 T v[200:201],v225,4096
 T v[202:203],v225,5120
 M v[4:7],a[80:83],v[208:211],v[4:7]
 v_lshlrev_b32 v253,1,v224
 v_fmac_f32 v156,v154,v154
 v_sub_f32 v154,v132,v153
 M v[8:11],a[144:147],v[208:211],v[8:11]
 v_fmac_f32 v156,v154,v154
 v_sub_f32 v154,v133,v153
 M v[12:15],a[208:211],v[208:211],v[12:15]
 W 8
 v_fmac_f32 v156,v154,v154
 v_sub_f32 v154,v134,v153
 M v[16:19],a[16:19],v[212:215],v[16:19]
 T v[204:205],v226,4096
 T v[206:207],v226,5120
 M v[20:23],a[80:83],v[212:215],v[20:23]
 s_mul_i32 s68,s2,7168
 s_mul_i32 s69,s64,1792
 s_add_u32 s68,s68,s69
 buffer_load_dword v221,v253,s[28:31],s68 offen
 M v[24:27],a[144:147],v[212:215],v[24:27]
 v_fmac_f32 v156,v154,v154
 v_sub_f32 v154,v135,v153
 M v[28:31],a[208:211],v[212:215],v[28:31]
 W 6
 v_fmac_f32 v156,v154,v154
 v_sub_f32 v154,v136,v153
 M v[32:35],a[16:19],v[192:195],v[32:35]
 T v[208:209],v227,4096
 T v[210:211],v227,5120
 M v[36:39],a[80:83],v[192:195],v[36:39]
 s_waitcnt vmcnt(10)
 s_add_u32 m0,s77,16384
 s_add_u32 s68,s75,640
 buffer_load_dwordx4 v180,s[16:19],s68 offen offset:0 lds
 M v[40:43],a[144:147],v[192:195],v[40:43]
 ds_read_b128 a[24:27],v178 offset:0
 ds_read_b128 a[88:91],v178 offset:2048
 M v[44:47],a[208:211],v[192:195],v[44:47]
 W 8
 v_fmac_f32 v156,v154,v154
 v_sub_f32 v154,v137,v153
 M v[48:51],a[16:19],v[196:199],v[48:51]
 T v[212:213],v228,4096
 T v[214:215],v228,5120
 M v[52:55],a[80:83],v[196:199],v[52:55]
 buffer_load_dwordx4 v181,s[16:19],s68 offen offset:1024 lds
 v_fmac_f32 v156,v154,v154
 M v[56:59],a[144:147],v[196:199],v[56:59]
 ds_read_b128 a[152:155],v178 offset:4096
 ds_read_b128 a[216:219],v178 offset:6144
 M v[60:63],a[208:211],v[196:199],v[60:63]
 W 10
 v_sub_f32 v154,v138,v153
 v_fmac_f32 v156,v154,v154
 M v[0:3],a[20:23],v[200:203],v[0:3]
 T v[192:193],v225,8192
 T v[194:195],v225,9216
 M v[4:7],a[84:87],v[200:203],v[4:7]
 buffer_load_dwordx4 v182,s[16:19],s68 offen offset:2048 lds
 v_sub_f32 v154,v139,v153
 M v[8:11],a[148:151],v[200:203],v[8:11]
 ds_read_b128 a[28:31],v179 offset:0
 ds_read_b128 a[92:95],v179 offset:2048
 M v[12:15],a[212:215],v[200:203],v[12:15]
 W 12
 v_fmac_f32 v156,v154,v154
 v_sub_f32 v154,v140,v153
 M v[16:19],a[20:23],v[204:207],v[16:19]
 T v[196:197],v226,8192
 T v[198:199],v226,9216
 M v[20:23],a[84:87],v[204:207],v[20:23]
 buffer_load_dwordx4 v183,s[16:19],s68 offen offset:3072 lds
 v_fmac_f32 v156,v154,v154
 M v[24:27],a[148:151],v[204:207],v[24:27]
 ds_read_b128 a[156:159],v179 offset:4096
 ds_read_b128 a[220:223],v179 offset:6144
 M v[28:31],a[212:215],v[204:207],v[28:31]
 W 14
 v_sub_f32 v154,v141,v153
 v_fmac_f32 v156,v154,v154
 M v[32:35],a[20:23],v[208:211],v[32:35]
 T v[200:201],v227,8192
 T v[202:203],v227,9216
 M v[36:39],a[84:87],v[208:211],v[36:39]
 s_add_u32 m0,s77,20480
 s_add_u32 s68,s75,33408
 buffer_load_dwordx4 v180,s[16:19],s68 offen offset:0 lds
 M v[40:43],a[148:151],v[208:211],v[40:43]
 v_sub_f32 v154,v142,v153
 v_fmac_f32 v156,v154,v154
 M v[44:47],a[212:215],v[208:211],v[44:47]
 W 12
 v_sub_f32 v154,v143,v153
 v_fmac_f32 v156,v154,v154
 M v[48:51],a[20:23],v[212:215],v[48:51]
 T v[204:205],v228,8192
 T v[206:207],v228,9216
 M v[52:55],a[84:87],v[212:215],v[52:55]
 buffer_load_dwordx4 v181,s[16:19],s68 offen offset:1024 lds
 v_add_f32_dpp v156,v156,v156 quad_perm:[1,0,3,2] row_mask:0xf bank_mask:0xf
 M v[56:59],a[148:151],v[212:215],v[56:59]
 s_nop 0
 v_add_f32_dpp v156,v156,v156 quad_perm:[2,3,0,1] row_mask:0xf bank_mask:0xf
 s_nop 1
 v_add_f32_dpp v156,v156,v156 row_half_mirror row_mask:0xf bank_mask:0xf
 M v[60:63],a[212:215],v[212:215],v[60:63]
 W 10
 v_add_f32_dpp v156,v156,v156 row_mirror row_mask:0xf bank_mask:0xf
 v_mov_b32 v154,v156
 M v[0:3],a[24:27],v[192:195],v[0:3]
 T v[208:209],v225,12288
 T v[210:211],v225,13312
 M v[4:7],a[88:91],v[192:195],v[4:7]
 buffer_load_dwordx4 v182,s[16:19],s68 offen offset:2048 lds
 M v[8:11],a[152:155],v[192:195],v[8:11]
 v_permlane16_swap_b32 v156,v154
 M v[12:15],a[216:219],v[192:195],v[12:15]
 W 8
 v_add_f32 v156,v156,v154
 v_mul_f32 v156,0x3b000000,v156
 M v[16:19],a[24:27],v[196:199],v[16:19]
 T v[212:213],v226,12288
 T v[214:215],v226,13312
 M v[20:23],a[88:91],v[196:199],v[20:23]
 buffer_load_dwordx4 v183,s[16:19],s68 offen offset:3072 lds
 v_cvt_pk_bf16_f32 v156,v156,v156
 M v[24:27],a[152:155],v[196:199],v[24:27]
 v_and_b32 v156,0xffff0000,v156
 v_add_f32 v156,0x3727c5ac,v156
 M v[28:31],a[216:219],v[196:199],v[28:31]
 W 6
 v_cvt_pk_bf16_f32 v156,v156,v156
 v_and_b32 v156,0xffff0000,v156
 M v[32:35],a[24:27],v[200:203],v[32:35]
 T v[192:193],v227,12288
 T v[194:195],v227,13312
 M v[36:39],a[88:91],v[200:203],v[36:39]
 s_waitcnt vmcnt(10)
 v_sqrt_f32 v156,v156
 M v[40:43],a[152:155],v[200:203],v[40:43]
 ds_read_b128 a[32:35],v178 offset:8192
 ds_read_b128 a[96:99],v178 offset:10240
 M v[44:47],a[216:219],v[200:203],v[44:47]
 W 8
 v_cvt_pk_bf16_f32 v156,v156,v156
 v_and_b32 v156,0xffff0000,v156
 M v[48:51],a[24:27],v[204:207],v[48:51]
 T v[196:197],v228,12288
 T v[198:199],v228,13312
 M v[52:55],a[88:91],v[204:207],v[52:55]
 v_add_u32 v225,0x4000,v225
 v_add_u32 v226,0x4000,v226
 M v[56:59],a[152:155],v[204:207],v[56:59]
 v_add_u32 v227,0x4000,v227
 v_add_u32 v228,0x4000,v228
 ds_read_b128 a[160:163],v178 offset:12288
 ds_read_b128 a[224:227],v178 offset:14336
 M v[60:63],a[216:219],v[204:207],v[60:63]
 W 10
 s_barrier
 M v[0:3],a[28:31],v[208:211],v[0:3]
 T v[200:201],v225,0
 T v[202:203],v225,1024
 M v[4:7],a[92:95],v[208:211],v[4:7]
 s_add_u32 m0,s71,98304
 s_add_u32 s68,s74,3145728
 buffer_load_dwordx4 v233,s[20:23],s68 offen offset:0 lds
 M v[8:11],a[156:159],v[208:211],v[8:11]
 ds_read_b128 a[36:39],v179 offset:8192
 ds_read_b128 a[100:103],v179 offset:10240
 M v[12:15],a[220:223],v[208:211],v[12:15]
 W 12
 v_rcp_f32 v156,v156
 M v[16:19],a[28:31],v[212:215],v[16:19]
 T v[204:205],v226,0
 T v[206:207],v226,1024
 M v[20:23],a[92:95],v[212:215],v[20:23]
 buffer_load_dwordx4 v234,s[20:23],s68 offen offset:1024 lds
 v_sub_f32 v128,v128,v155
 M v[24:27],a[156:159],v[212:215],v[24:27]
 ds_read_b128 a[164:167],v179 offset:12288
 ds_read_b128 a[228:231],v179 offset:14336
 M v[28:31],a[220:223],v[212:215],v[28:31]
 W 14
 v_sub_f32 v129,v129,v155
 v_cvt_pk_bf16_f32 v154,v128,v129
 M v[32:35],a[28:31],v[192:195],v[32:35]
 T v[208:209],v227,0
 T v[210:211],v227,1024
 M v[36:39],a[92:95],v[192:195],v[36:39]
 buffer_load_dwordx4 v235,s[20:23],s68 offen offset:2048 lds
 v_lshlrev_b32 v128,16,v154
 M v[40:43],a[156:159],v[192:195],v[40:43]
 v_and_b32 v129,0xffff0000,v154
 v_mul_f32 v128,v128,v156
 M v[44:47],a[220:223],v[192:195],v[44:47]
 W 12
 v_mul_f32 v129,v129,v156
 v_cvt_pk_bf16_f32 v144,v128,v129
 M v[48:51],a[28:31],v[196:199],v[48:51]
 T v[212:213],v228,0
 T v[214:215],v228,1024
 M v[52:55],a[92:95],v[196:199],v[52:55]
 buffer_load_dwordx4 v236,s[20:23],s68 offen offset:3072 lds
 v_sub_f32 v130,v130,v155
 M v[56:59],a[156:159],v[196:199],v[56:59]
 v_sub_f32 v131,v131,v155
 v_cvt_pk_bf16_f32 v154,v130,v131
 M v[60:63],a[220:223],v[196:199],v[60:63]
 W 10
 v_lshlrev_b32 v130,16,v154
 v_and_b32 v131,0xffff0000,v154
 M v[0:3],a[32:35],v[200:203],v[0:3]
 T v[192:193],v229,0
 T v[194:195],v229,1024
 M v[4:7],a[96:99],v[200:203],v[4:7]
 s_add_u32 m0,s77,0
 s_add_u32 s68,s75,768
 buffer_load_dwordx4 v180,s[16:19],s68 offen offset:0 lds
 M v[8:11],a[160:163],v[200:203],v[8:11]
 v_mul_f32 v130,v130,v156
 v_mul_f32 v131,v131,v156
 M v[12:15],a[224:227],v[200:203],v[12:15]
 W 8
 v_cvt_pk_bf16_f32 v145,v130,v131
 v_sub_f32 v132,v132,v155
 M v[16:19],a[32:35],v[204:207],v[16:19]
 T v[196:197],v230,0
 T v[198:199],v230,1024
 M v[20:23],a[96:99],v[204:207],v[20:23]
 buffer_load_dwordx4 v181,s[16:19],s68 offen offset:1024 lds
 v_sub_f32 v133,v133,v155
 M v[24:27],a[160:163],v[204:207],v[24:27]
 v_cvt_pk_bf16_f32 v154,v132,v133
 v_lshlrev_b32 v132,16,v154
 M v[28:31],a[224:227],v[204:207],v[28:31]
 W 6
 v_and_b32 v133,0xffff0000,v154
 v_mul_f32 v132,v132,v156
 M v[32:35],a[32:35],v[208:211],v[32:35]
 T v[200:201],v231,0
 T v[202:203],v231,1024
 M v[36:39],a[96:99],v[208:211],v[36:39]
 buffer_load_dwordx4 v182,s[16:19],s68 offen offset:2048 lds
 v_mul_f32 v133,v133,v156
 M v[40:43],a[160:163],v[208:211],v[40:43]
 v_cvt_pk_bf16_f32 v146,v132,v133
 v_sub_f32 v134,v134,v155
 M v[44:47],a[224:227],v[208:211],v[44:47]
 W 6
 v_sub_f32 v135,v135,v155
 v_cvt_pk_bf16_f32 v154,v134,v135
 M v[48:51],a[32:35],v[212:215],v[48:51]
 T v[204:205],v232,0
 T v[206:207],v232,1024
 M v[52:55],a[96:99],v[212:215],v[52:55]
 buffer_load_dwordx4 v183,s[16:19],s68 offen offset:3072 lds
 v_lshlrev_b32 v134,16,v154
 M v[56:59],a[160:163],v[212:215],v[56:59]
 v_and_b32 v135,0xffff0000,v154
 v_mul_f32 v134,v134,v156
 M v[60:63],a[224:227],v[212:215],v[60:63]
 W 6
 v_mul_f32 v135,v135,v156
 v_cvt_pk_bf16_f32 v147,v134,v135
 M v[64:67],a[0:3],v[192:195],0
 T v[208:209],v225,4096
 T v[210:211],v225,5120
 M v[68:71],a[64:67],v[192:195],0
 s_add_u32 m0,s77,4096
 s_add_u32 s68,s75,33536
 buffer_load_dwordx4 v180,s[16:19],s68 offen offset:0 lds
 M v[72:75],a[128:131],v[192:195],0
 v_sub_f32 v136,v136,v155
 v_sub_f32 v137,v137,v155
 M v[76:79],a[192:195],v[192:195],0
 W 6
 v_cvt_pk_bf16_f32 v154,v136,v137
 v_lshlrev_b32 v136,16,v154
 M v[80:83],a[0:3],v[196:199],0
 T v[212:213],v226,4096
 T v[214:215],v226,5120
 M v[84:87],a[64:67],v[196:199],0
 buffer_load_dwordx4 v181,s[16:19],s68 offen offset:1024 lds
 v_and_b32 v137,0xffff0000,v154
 M v[88:91],a[128:131],v[196:199],0
 v_mul_f32 v136,v136,v156
 v_mul_f32 v137,v137,v156
 M v[92:95],a[192:195],v[196:199],0
 W 6
 v_cvt_pk_bf16_f32 v148,v136,v137
 v_sub_f32 v138,v138,v155
 M v[96:99],a[0:3],v[200:203],0
 T v[192:193],v227,4096
 T v[194:195],v227,5120
 M v[100:103],a[64:67],v[200:203],0
 s_waitcnt vmcnt(10)
 buffer_load_dwordx4 v182,s[16:19],s68 offen offset:2048 lds
 v_sub_f32 v139,v139,v155
 M v[104:107],a[128:131],v[200:203],0
 ds_read_b128 a[40:43],v178 offset:16384
 ds_read_b128 a[104:107],v178 offset:18432
 M v[108:111],a[192:195],v[200:203],0
 W 8
 v_cvt_pk_bf16_f32 v154,v138,v139
 v_lshlrev_b32 v138,16,v154
 M v[112:115],a[0:3],v[204:207],0
 T v[196:197],v228,4096
 T v[198:199],v228,5120
 M v[116:119],a[64:67],v[204:207],0
 buffer_load_dwordx4 v183,s[16:19],s68 offen offset:3072 lds
 v_and_b32 v139,0xffff0000,v154
 M v[120:123],a[128:131],v[204:207],0
 ds_read_b128 a[168:171],v178 offset:20480
 ds_read_b128 a[232:235],v178 offset:22528
 M v[124:127],a[192:195],v[204:207],0
 W 10
 s_barrier
 v_mul_f32 v138,v138,v156
 M v[0:3],a[36:39],v[208:211],v[0:3]
 T v[200:201],v229,4096
 T v[202:203],v229,5120
 M v[4:7],a[100:103],v[208:211],v[4:7]
 s_add_u32 m0,s71,114688
 s_add_u32 s68,s74,1048704
 buffer_load_dwordx4 v233,s[20:23],s68 offen offset:0 lds
 M v[8:11],a[164:167],v[208:211],v[8:11]
 ds_read_b128 a[44:47],v179 offset:16384
 ds_read_b128 a[108:111],v179 offset:18432
 M v[12:15],a[228:231],v[208:211],v[12:15]
 W 12
 v_mul_f32 v139,v139,v156
 v_cvt_pk_bf16_f32 v149,v138,v139
 M v[16:19],a[36:39],v[212:215],v[16:19]
 T v[204:205],v230,4096
 T v[206:207],v230,5120
 M v[20:23],a[100:103],v[212:215],v[20:23]
 buffer_load_dwordx4 v234,s[20:23],s68 offen offset:1024 lds
 M v[24:27],a[164:167],v[212:215],v[24:27]
 ds_read_b128 a[172:175],v179 offset:20480
 ds_read_b128 a[236:239],v179 offset:22528
 M v[28:31],a[228:231],v[212:215],v[28:31]
 W 14
 v_sub_f32 v140,v140,v155
 v_sub_f32 v141,v141,v155
 M v[32:35],a[36:39],v[192:195],v[32:35]
 T v[208:209],v231,4096
 T v[210:211],v231,5120
 M v[36:39],a[100:103],v[192:195],v[36:39]
 buffer_load_dwordx4 v235,s[20:23],s68 offen offset:2048 lds
 v_cvt_pk_bf16_f32 v154,v140,v141
 M v[40:43],a[164:167],v[192:195],v[40:43]
 v_lshlrev_b32 v140,16,v154
 v_and_b32 v141,0xffff0000,v154
 M v[44:47],a[228:231],v[192:195],v[44:47]
 W 12
 v_mul_f32 v140,v140,v156
 v_mul_f32 v141,v141,v156
 M v[48:51],a[36:39],v[196:199],v[48:51]
 T v[212:213],v232,4096
 T v[214:215],v232,5120
 M v[52:55],a[100:103],v[196:199],v[52:55]
 buffer_load_dwordx4 v236,s[20:23],s68 offen offset:3072 lds
 v_cvt_pk_bf16_f32 v150,v140,v141
 M v[56:59],a[164:167],v[196:199],v[56:59]
 v_sub_f32 v142,v142,v155
 v_sub_f32 v143,v143,v155
 M v[60:63],a[228:231],v[196:199],v[60:63]
 W 10
 v_cvt_pk_bf16_f32 v154,v142,v143
 v_lshlrev_b32 v142,16,v154
 M v[64:67],a[4:7],v[200:203],v[64:67]
 T v[192:193],v225,8192
 T v[194:195],v225,9216
 M v[68:71],a[68:71],v[200:203],v[68:71]
 s_add_u32 m0,s77,8192
 s_add_u32 s68,s75,896
 buffer_load_dwordx4 v180,s[16:19],s68 offen offset:0 lds
 M v[72:75],a[132:135],v[200:203],v[72:75]
 v_and_b32 v143,0xffff0000,v154
 v_mul_f32 v142,v142,v156
 M v[76:79],a[196:199],v[200:203],v[76:79]
 W 8
 v_mul_f32 v143,v143,v156
 v_cvt_pk_bf16_f32 v151,v142,v143
 M v[80:83],a[4:7],v[204:207],v[80:83]
 T v[196:197],v226,8192
 T v[198:199],v226,9216
 M v[84:87],a[68:71],v[204:207],v[84:87]
 buffer_load_dwordx4 v181,s[16:19],s68 offen offset:1024 lds
 M v[88:91],a[132:135],v[204:207],v[88:91]
 M v[92:95],a[196:199],v[204:207],v[92:95]
 W 6
 M v[96:99],a[4:7],v[208:211],v[96:99]
 T v[200:201],v227,8192
 T v[202:203],v227,9216
 M v[100:103],a[68:71],v[208:211],v[100:103]
 buffer_load_dwordx4 v182,s[16:19],s68 offen offset:2048 lds
 M v[104:107],a[132:135],v[208:211],v[104:107]
 M v[108:111],a[196:199],v[208:211],v[108:111]
 W 6
 M v[112:115],a[4:7],v[212:215],v[112:115]
 T v[204:205],v228,8192
 T v[206:207],v228,9216
 M v[116:119],a[68:71],v[212:215],v[116:119]
 buffer_load_dwordx4 v183,s[16:19],s68 offen offset:3072 lds
 M v[120:123],a[132:135],v[212:215],v[120:123]
 M v[124:127],a[196:199],v[212:215],v[124:127]
 W 6
 M v[0:3],a[40:43],v[192:195],v[0:3]
 T v[208:209],v229,8192
 T v[210:211],v229,9216
 M v[4:7],a[104:107],v[192:195],v[4:7]
 s_add_u32 m0,s77,12288
 s_add_u32 s68,s75,33664
 buffer_load_dwordx4 v180,s[16:19],s68 offen offset:0 lds
 M v[8:11],a[168:171],v[192:195],v[8:11]
 M v[12:15],a[232:235],v[192:195],v[12:15]
 W 6
 M v[16:19],a[40:43],v[196:199],v[16:19]
 T v[212:213],v230,8192
 T v[214:215],v230,9216
 M v[20:23],a[104:107],v[196:199],v[20:23]
 buffer_load_dwordx4 v181,s[16:19],s68 offen offset:1024 lds
 M v[24:27],a[168:171],v[196:199],v[24:27]
 M v[28:31],a[232:235],v[196:199],v[28:31]
 W 6
 M v[32:35],a[40:43],v[200:203],v[32:35]
 T v[192:193],v231,8192
 T v[194:195],v231,9216
 M v[36:39],a[104:107],v[200:203],v[36:39]
 s_waitcnt vmcnt(10)
 buffer_load_dwordx4 v182,s[16:19],s68 offen offset:2048 lds
 M v[40:43],a[168:171],v[200:203],v[40:43]
 ds_read_b128 a[48:51],v178 offset:0
 ds_read_b128 a[112:115],v178 offset:2048
 M v[44:47],a[232:235],v[200:203],v[44:47]
 W 8
 M v[48:51],a[40:43],v[204:207],v[48:51]
 T v[196:197],v232,8192
 T v[198:199],v232,9216
 M v[52:55],a[104:107],v[204:207],v[52:55]
 buffer_load_dwordx4 v183,s[16:19],s68 offen offset:3072 lds
 M v[56:59],a[168:171],v[204:207],v[56:59]
 ds_read_b128 a[176:179],v178 offset:4096
 ds_read_b128 a[240:243],v178 offset:6144
 M v[60:63],a[232:235],v[204:207],v[60:63]
 W 10
 M v[64:67],a[8:11],v[208:211],v[64:67]
 T v[200:201],v225,12288
 T v[202:203],v225,13312
 M v[68:71],a[72:75],v[208:211],v[68:71]
 v_lshrrev_b32 v170,7,v224
 v_lshlrev_b32 v170,13,v170
 buffer_load_dword v217,v216,s[60:63],0 offen sc1
 M v[72:75],a[136:139],v[208:211],v[72:75]
 ds_read_b128 a[52:55],v179 offset:0
 ds_read_b128 a[116:119],v179 offset:2048
 v_bfe_u32 v171,v224,5,2
 v_lshl_add_u32 v170,v171,9,v170
 M v[76:79],a[200:203],v[208:211],v[76:79]
 W 12
 v_bfe_u32 v171,v224,4,1
 v_lshl_add_u32 v170,v171,7,v170
 M v[80:83],a[8:11],v[212:215],v[80:83]
 T v[204:205],v226,12288
 T v[206:207],v226,13312
 M v[84:87],a[72:75],v[212:215],v[84:87]
 buffer_load_dword v221,v170,s[20:23],s99 offen offset:256
 M v[88:91],a[136:139],v[212:215],v[88:91]
 ds_read_b128 a[180:183],v179 offset:4096
 ds_read_b128 a[244:247],v179 offset:6144
 M v[92:95],a[200:203],v[212:215],v[92:95]
 W 14
 M v[96:99],a[8:11],v[192:195],v[96:99]
 T v[208:209],v227,12288
 T v[210:211],v227,13312
 M v[100:103],a[72:75],v[192:195],v[100:103]
 M v[104:107],a[136:139],v[192:195],v[104:107]
 M v[108:111],a[200:203],v[192:195],v[108:111]
 W 12
 M v[112:115],a[8:11],v[196:199],v[112:115]
 T v[212:213],v228,12288
 T v[214:215],v228,13312
 M v[116:119],a[72:75],v[196:199],v[116:119]
 M v[120:123],a[136:139],v[196:199],v[120:123]
 M v[124:127],a[200:203],v[196:199],v[124:127]
 W 10
 M v[0:3],a[44:47],v[200:203],v[0:3]
 T v[192:193],v229,12288
 T v[194:195],v229,13312
 M v[4:7],a[108:111],v[200:203],v[4:7]
 M v[8:11],a[172:175],v[200:203],v[8:11]
 M v[12:15],a[236:239],v[200:203],v[12:15]
 W 8
 M v[16:19],a[44:47],v[204:207],v[16:19]
 T v[196:197],v230,12288
 T v[198:199],v230,13312
 M v[20:23],a[108:111],v[204:207],v[20:23]
 M v[24:27],a[172:175],v[204:207],v[24:27]
 M v[28:31],a[236:239],v[204:207],v[28:31]
 W 6
 M v[32:35],a[44:47],v[208:211],v[32:35]
 T v[200:201],v231,12288
 T v[202:203],v231,13312
 M v[36:39],a[108:111],v[208:211],v[36:39]
 M v[40:43],a[172:175],v[208:211],v[40:43]
 M v[44:47],a[236:239],v[208:211],v[44:47]
 W 6
 M v[48:51],a[44:47],v[212:215],v[48:51]
 T v[204:205],v232,12288
 T v[206:207],v232,13312
 M v[52:55],a[108:111],v[212:215],v[52:55]
 v_add_u32 v225,0xffff8000,v225
 v_add_u32 v226,0xffff8000,v226
 M v[56:59],a[172:175],v[212:215],v[56:59]
 v_add_u32 v227,0xffff8000,v227
 v_add_u32 v228,0xffff8000,v228
 M v[60:63],a[236:239],v[212:215],v[60:63]
 W 6
 s_waitcnt vmcnt(10)
 s_barrier
 M v[64:67],a[12:15],v[192:195],v[64:67]
 T v[208:209],v225,0
 T v[210:211],v225,1024
 M v[68:71],a[76:79],v[192:195],v[68:71]
 s_add_u32 m0,s71,131072
 s_add_u32 s68,s74,2097280
 buffer_load_dwordx4 v233,s[20:23],s68 offen offset:0 lds
 M v[72:75],a[140:143],v[192:195],v[72:75]
 ds_write_b128 v152,v[144:147]
 ds_write_b128 v152,v[148:151] offset:4096
 M v[76:79],a[204:207],v[192:195],v[76:79]
 W 8
 M v[80:83],a[12:15],v[196:199],v[80:83]
 T v[212:213],v226,0
 T v[214:215],v226,1024
 M v[84:87],a[76:79],v[196:199],v[84:87]
 buffer_load_dwordx4 v234,s[20:23],s68 offen offset:1024 lds
 M v[88:91],a[140:143],v[196:199],v[88:91]
 M v[92:95],a[204:207],v[196:199],v[92:95]
 W 8
 M v[96:99],a[12:15],v[200:203],v[96:99]
 T v[192:193],v227,0
 T v[194:195],v227,1024
 M v[100:103],a[76:79],v[200:203],v[100:103]
 s_waitcnt vmcnt(4)
 buffer_load_dwordx4 v235,s[20:23],s68 offen offset:2048 lds
 M v[104:107],a[140:143],v[200:203],v[104:107]
 ds_read_b128 a[56:59],v178 offset:8192
 ds_read_b128 a[120:123],v178 offset:10240
 M v[108:111],a[204:207],v[200:203],v[108:111]
 W 10
 M v[112:115],a[12:15],v[204:207],v[112:115]
 T v[196:197],v228,0
 T v[198:199],v228,1024
 M v[116:119],a[76:79],v[204:207],v[116:119]
 v_add_u32 v229,0xffff8000,v229
 v_add_u32 v230,0xffff8000,v230
 buffer_load_dwordx4 v236,s[20:23],s68 offen offset:3072 lds
 M v[120:123],a[140:143],v[204:207],v[120:123]
 v_add_u32 v231,0xffff8000,v231
 v_add_u32 v232,0xffff8000,v232
 ds_read_b128 a[184:187],v178 offset:12288
 ds_read_b128 a[248:251],v178 offset:14336
 M v[124:127],a[204:207],v[204:207],v[124:127]
 W 12
 M v[0:3],a[48:51],v[208:211],v[0:3]
 T v[200:201],v229,0
 T v[202:203],v229,1024
 M v[4:7],a[112:115],v[208:211],v[4:7]
 M v[8:11],a[176:179],v[208:211],v[8:11]
 ds_read_b128 a[60:63],v179 offset:8192
 ds_read_b128 a[124:127],v179 offset:10240
 M v[12:15],a[240:243],v[208:211],v[12:15]
 W 12
 M v[16:19],a[48:51],v[212:215],v[16:19]
 T v[204:205],v230,0
 T v[206:207],v230,1024
 M v[20:23],a[112:115],v[212:215],v[20:23]
 M v[24:27],a[176:179],v[212:215],v[24:27]
 ds_read_b128 a[188:191],v179 offset:12288
 ds_read_b128 a[252:255],v179 offset:14336
 M v[28:31],a[240:243],v[212:215],v[28:31]
 W 14
 M v[32:35],a[48:51],v[192:195],v[32:35]
 T v[208:209],v231,0
 T v[210:211],v231,1024
 M v[36:39],a[112:115],v[192:195],v[36:39]
 s_and_b32 s65,s2,7
 s_lshr_b32 s66,s2,5
 M v[40:43],a[176:179],v[192:195],v[40:43]
 s_bfe_u32 s67,s2,0x20003
 s_lshr_b32 s97,s2,3
 M v[44:47],a[240:243],v[192:195],v[44:47]
 W 12
 s_lshl_b32 s97,s97,2
 s_add_u32 s97,s97,s64
 M v[48:51],a[48:51],v[196:199],v[48:51]
 T v[212:213],v232,0
 T v[214:215],v232,1024
 M v[52:55],a[112:115],v[196:199],v[52:55]
 v_lshrrev_b32 v252,4,v224
 s_lshl_b32 s3,s65,2
 M v[56:59],a[176:179],v[196:199],v[56:59]
 s_add_u32 s3,s3,s67
 s_lshl_b32 s4,s67,1
 M v[60:63],a[240:243],v[196:199],v[60:63]
 W 10
 s_min_u32 s4,s4,5
 s_mul_i32 s90,s65,7
 M v[64:67],a[16:19],v[200:203],v[64:67]
 T v[192:193],v225,4096
 T v[194:195],v225,5120
 M v[68:71],a[80:83],v[200:203],v[68:71]
 s_add_u32 s4,s4,s90
 s_lshl_b32 s82,s66,3
 M v[72:75],a[144:147],v[200:203],v[72:75]
 s_lshl_b32 s90,s64,1
 s_add_u32 s82,s82,s90
 M v[76:79],a[208:211],v[200:203],v[76:79]
 W 8
 s_sub_u32 s83,15,s66
 s_lshl_b32 s83,s83,3
 M v[80:83],a[16:19],v[204:207],v[80:83]
 T v[196:197],v226,4096
 T v[198:199],v226,5120
 M v[84:87],a[80:83],v[204:207],v[84:87]
 s_add_u32 s83,s83,s90
 s_mul_i32 s86,s82,56
 M v[88:91],a[144:147],v[204:207],v[88:91]
 s_add_u32 s86,s86,s4
 s_lshl_b32 s86,s86,10
 M v[92:95],a[208:211],v[204:207],v[92:95]
 W 6
 s_add_u32 s86,s86,0x2700000
 s_mul_i32 s87,s83,56
 M v[96:99],a[16:19],v[208:211],v[96:99]
 T v[200:201],v227,4096
 T v[202:203],v227,5120
 M v[100:103],a[80:83],v[208:211],v[100:103]
 s_add_u32 s87,s87,s4
 s_lshl_b32 s87,s87,10
 M v[104:107],a[144:147],v[208:211],v[104:107]
 s_add_u32 s87,s87,0x2700000
 s_lshl_b32 s90,s3,12
 M v[108:111],a[208:211],v[208:211],v[108:111]
 W 6
 s_add_u32 s90,s90,0x3000000
 s_lshl_b32 s95,s82,17
 M v[112:115],a[16:19],v[212:215],v[112:115]
 T v[204:205],v228,4096
 T v[206:207],v228,5120
 M v[116:119],a[80:83],v[212:215],v[116:119]
 s_add_u32 s95,s95,s90
 s_mul_i32 s82,s82,17408
 M v[120:123],a[144:147],v[212:215],v[120:123]
 s_add_u32 s82,s82,0x2400000
 s_lshl_b32 s96,s83,17
 M v[124:127],a[208:211],v[212:215],v[124:127]
 W 6
 W 0
 s_barrier
 M v[0:3],a[52:55],v[192:195],v[0:3]
 T v[208:209],v229,4096
 T v[210:211],v229,5120
 M v[4:7],a[116:119],v[192:195],v[4:7]
 s_add_u32 m0,s71,0
 s_add_u32 s68,s74,256
 buffer_load_dwordx4 v233,s[20:23],s68 offen offset:0 lds
 M v[8:11],a[180:183],v[192:195],v[8:11]
 ds_read_b128 v[160:163],v157
 ds_read_b128 v[164:167],v157 offset:1024
 M v[12:15],a[244:247],v[192:195],v[12:15]
 s_add_u32 s96,s96,s90
 s_mul_i32 s83,s83,17408
 M v[16:19],a[52:55],v[196:199],v[16:19]
 T v[212:213],v230,4096
 T v[214:215],v230,5120
 M v[20:23],a[116:119],v[196:199],v[20:23]
 buffer_load_dwordx4 v234,s[20:23],s68 offen offset:1024 lds
 s_add_u32 s83,s83,0x2400000
 M v[24:27],a[180:183],v[196:199],v[24:27]
 s_lshl_b32 s81,s64,18
 s_lshl_b32 s90,s3,8
 M v[28:31],a[244:247],v[196:199],v[28:31]
 s_add_u32 s81,s81,s90
 s_lshl_b32 s89,s4,6
 M v[32:35],a[52:55],v[200:203],v[32:35]
 T v[192:193],v231,4096
 T v[194:195],v231,5120
 M v[36:39],a[116:119],v[200:203],v[36:39]
 buffer_load_dwordx4 v235,s[20:23],s68 offen offset:2048 lds
 s_mul_i32 s80,s64,114688
 M v[40:43],a[180:183],v[200:203],v[40:43]
 s_add_u32 s80,s80,s89
 s_mul_i32 s90,s3,557056
 M v[44:47],a[244:247],v[200:203],v[44:47]
 s_add_u32 s36,s8,s90
 s_addc_u32 s37,s9,0
 M v[48:51],a[52:55],v[204:207],v[48:51]
 T v[196:197],v232,4096
 T v[198:199],v232,5120
 M v[52:55],a[116:119],v[204:207],v[52:55]
 buffer_load_dwordx4 v236,s[20:23],s68 offen offset:3072 lds
 M v[56:59],a[180:183],v[204:207],v[56:59]
 s_add_u32 s40,s36,0x1200000
 s_addc_u32 s41,s37,0
 M v[60:63],a[244:247],v[204:207],v[60:63]
 W 8
 s_sub_u32 s90,16,s66
 s_mul_i32 s38,s90,34816
 M v[64:67],a[20:23],v[208:211],v[64:67]
 T v[200:201],v225,8192
 T v[202:203],v225,9216
 M v[68:71],a[84:87],v[208:211],v[68:71]
 s_add_u32 m0,s71,16384
 s_add_u32 s68,s74,3145856
 buffer_load_dwordx4 v233,s[20:23],s68 offen offset:0 lds
 M v[72:75],a[148:151],v[208:211],v[72:75]
 s_mov_b32 s42,s38
 s_mov_b32 s39,0x20000
 M v[76:79],a[212:215],v[208:211],v[76:79]
 W 6
 s_mov_b32 s43,0x20000
 s_lshl_b32 s73,s66,3
 M v[80:83],a[20:23],v[212:215],v[80:83]
 T v[204:205],v226,8192
 T v[206:207],v226,9216
 M v[84:87],a[84:87],v[212:215],v[84:87]
 buffer_load_dwordx4 v234,s[20:23],s68 offen offset:1024 lds
 s_add_u32 s73,s73,s65
 M v[88:91],a[148:151],v[212:215],v[88:91]
 s_lshl_b32 s73,s73,2
 s_add_u32 s73,s73,s64
 M v[92:95],a[212:215],v[212:215],v[92:95]
 W 6
 s_lshl_b32 s73,s73,2
 s_add_u32 s73,s73,s67
 M v[96:99],a[20:23],v[192:195],v[96:99]
 T v[208:209],v227,8192
 T v[210:211],v227,9216
 M v[100:103],a[84:87],v[192:195],v[100:103]
 buffer_load_dwordx4 v235,s[20:23],s68 offen offset:2048 lds
 s_lshl_b32 s73,s73,7
 M v[104:107],a[148:151],v[192:195],v[104:107]
 s_add_u32 s73,s73,0x6010000
 v_bfe_u32 v253,v252,2,1
 M v[108:111],a[212:215],v[192:195],v[108:111]
 W 6
 s_lshl_b32 s90,s66,12
 s_sub_u32 s90,30720,s90
 M v[112:115],a[20:23],v[196:199],v[112:115]
 T v[212:213],v228,8192
 T v[214:215],v228,9216
 M v[116:119],a[84:87],v[196:199],v[116:119]
 buffer_load_dwordx4 v236,s[20:23],s68 offen offset:3072 lds
 v_mul_lo_u32 v219,v253,s90
 M v[120:123],a[148:151],v[196:199],v[120:123]
 v_and_b32 v253,3,v252
 v_lshl_add_u32 v219,v253,7,v219
 M v[124:127],a[212:215],v[196:199],v[124:127]
 W 6
 s_lshl_b32 s90,s66,11
 s_lshl_b32 s70,s64,9
 M v[0:3],a[56:59],v[200:203],v[0:3]
 T v[192:193],v229,8192
 T v[194:195],v229,9216
 M v[4:7],a[120:123],v[200:203],v[4:7]
 s_add_u32 m0,s71,32768
 s_add_u32 s68,s74,1048832
 buffer_load_dwordx4 v233,s[20:23],s68 offen offset:0 lds
 M v[8:11],a[184:187],v[200:203],v[8:11]
 s_add_u32 s90,s90,s70
 s_add_u32 s90,s90,0x6000000
 M v[12:15],a[248:251],v[200:203],v[12:15]
 W 6
 v_add_u32 v219,s90,v219
 s_lshl_b32 s90,s65,1
 M v[16:19],a[56:59],v[204:207],v[16:19]
 T v[196:197],v230,8192
 T v[198:199],v230,9216
 M v[20:23],a[120:123],v[204:207],v[20:23]
 buffer_load_dwordx4 v234,s[20:23],s68 offen offset:1024 lds
 s_lshr_b32 s70,s67,1
 M v[24:27],a[184:187],v[204:207],v[24:27]
 s_add_u32 s90,s90,s70
 s_lshl_b32 s90,s90,11
 M v[28:31],a[248:251],v[204:207],v[28:31]
 W 6
 s_add_u32 s0,s90,0x6008000
 v_and_b32 v253,1,v252
 M v[32:35],a[56:59],v[208:211],v[32:35]
 T v[200:201],v231,8192
 T v[202:203],v231,9216
 M v[36:39],a[120:123],v[208:211],v[36:39]
 buffer_load_dwordx4 v235,s[20:23],s68 offen offset:2048 lds
 v_lshlrev_b32 v220,7,v253
 M v[40:43],a[184:187],v[208:211],v[40:43]
 M v[44:47],a[248:251],v[208:211],v[44:47]
 W 6
 M v[48:51],a[56:59],v[212:215],v[48:51]
 T v[204:205],v232,8192
 T v[206:207],v232,9216
 M v[52:55],a[120:123],v[212:215],v[52:55]
 buffer_load_dwordx4 v236,s[20:23],s68 offen offset:3072 lds
 M v[56:59],a[184:187],v[212:215],v[56:59]
 M v[60:63],a[248:251],v[212:215],v[60:63]
 W 6
 M v[64:67],a[24:27],v[192:195],v[64:67]
 T v[208:209],v225,12288
 T v[210:211],v225,13312
 M v[68:71],a[88:91],v[192:195],v[68:71]
 s_add_u32 m0,s71,49152
 s_add_u32 s68,s74,2097408
 buffer_load_dwordx4 v233,s[20:23],s68 offen offset:0 lds
 M v[72:75],a[152:155],v[192:195],v[72:75]
 M v[76:79],a[216:219],v[192:195],v[76:79]
 W 6
 M v[80:83],a[24:27],v[196:199],v[80:83]
 T v[212:213],v226,12288
 T v[214:215],v226,13312
 M v[84:87],a[88:91],v[196:199],v[84:87]
 buffer_load_dwordx4 v234,s[20:23],s68 offen offset:1024 lds
 M v[88:91],a[152:155],v[196:199],v[88:91]
 M v[92:95],a[216:219],v[196:199],v[92:95]
 W 6
 M v[96:99],a[24:27],v[200:203],v[96:99]
 T v[192:193],v227,12288
 T v[194:195],v227,13312
 M v[100:103],a[88:91],v[200:203],v[100:103]
 buffer_load_dwordx4 v235,s[20:23],s68 offen offset:2048 lds
 M v[104:107],a[152:155],v[200:203],v[104:107]
 M v[108:111],a[216:219],v[200:203],v[108:111]
 W 6
 M v[112:115],a[24:27],v[204:207],v[112:115]
 T v[196:197],v228,12288
 T v[198:199],v228,13312
 M v[116:119],a[88:91],v[204:207],v[116:119]
 buffer_load_dwordx4 v236,s[20:23],s68 offen offset:3072 lds
 M v[120:123],a[152:155],v[204:207],v[120:123]
 M v[124:127],a[216:219],v[204:207],v[124:127]
 W 6
 M v[0:3],a[60:63],v[208:211],v[0:3]
 T v[200:201],v229,12288
 T v[202:203],v229,13312
 M v[4:7],a[124:127],v[208:211],v[4:7]
 s_add_u32 m0,s71,65536
 s_add_u32 s68,s74,384
 buffer_load_dwordx4 v233,s[20:23],s68 offen offset:0 lds
 M v[8:11],a[188:191],v[208:211],v[8:11]
 M v[12:15],a[252:255],v[208:211],v[12:15]
 W 6
 M v[16:19],a[60:63],v[212:215],v[16:19]
 T v[204:205],v230,12288
 T v[206:207],v230,13312
 M v[20:23],a[124:127],v[212:215],v[20:23]
 buffer_load_dwordx4 v234,s[20:23],s68 offen offset:1024 lds
 M v[24:27],a[188:191],v[212:215],v[24:27]
 M v[28:31],a[252:255],v[212:215],v[28:31]
 W 6
 M v[32:35],a[60:63],v[192:195],v[32:35]
 T v[208:209],v231,12288
 T v[210:211],v231,13312
 M v[36:39],a[124:127],v[192:195],v[36:39]
 buffer_load_dwordx4 v235,s[20:23],s68 offen offset:2048 lds
 M v[40:43],a[188:191],v[192:195],v[40:43]
 M v[44:47],a[252:255],v[192:195],v[44:47]
 W 6
 M v[48:51],a[60:63],v[196:199],v[48:51]
 T v[212:213],v232,12288
 T v[214:215],v232,13312
 M v[52:55],a[124:127],v[196:199],v[52:55]
 v_add_u32 v229,0x4000,v229
 v_add_u32 v230,0x4000,v230
 buffer_load_dwordx4 v236,s[20:23],s68 offen offset:3072 lds
 M v[56:59],a[188:191],v[196:199],v[56:59]
 v_add_u32 v231,0x4000,v231
 v_add_u32 v232,0x4000,v232
 M v[60:63],a[252:255],v[196:199],v[60:63]
 W 6
 s_waitcnt vmcnt(16)
 s_barrier
 M v[64:67],a[28:31],v[200:203],v[64:67]
 T v[192:193],v229,0
 T v[194:195],v229,1024
 M v[68:71],a[92:95],v[200:203],v[68:71]
 buffer_store_dwordx4 v[160:163],v158,s[8:11],s98 offen sc0 sc1
 M v[72:75],a[156:159],v[200:203],v[72:75]
 M v[76:79],a[220:223],v[200:203],v[76:79]
 W 6
 M v[80:83],a[28:31],v[204:207],v[80:83]
 T v[196:197],v230,0
 T v[198:199],v230,1024
 M v[84:87],a[92:95],v[204:207],v[84:87]
 buffer_store_dwordx4 v[164:167],v158,s[8:11],s98 offen offset:2048 sc0 sc1
 M v[88:91],a[156:159],v[204:207],v[88:91]
 M v[92:95],a[220:223],v[204:207],v[92:95]
 W 6
 M v[96:99],a[28:31],v[208:211],v[96:99]
 T v[200:201],v231,0
 T v[202:203],v231,1024
 M v[100:103],a[92:95],v[208:211],v[100:103]
 s_add_u32 m0,s71,81920
 s_add_u32 s68,s74,3145984
 buffer_load_dwordx4 v233,s[20:23],s68 offen offset:0 lds
 M v[104:107],a[156:159],v[208:211],v[104:107]
 M v[108:111],a[220:223],v[208:211],v[108:111]
 W 6
 M v[112:115],a[28:31],v[212:215],v[112:115]
 T v[204:205],v232,0
 T v[206:207],v232,1024
 M v[116:119],a[92:95],v[212:215],v[116:119]
 v_add_u32 v225,0xfffe8000,v225
 v_add_u32 v226,0xfffe8000,v226
 buffer_load_dwordx4 v234,s[20:23],s68 offen offset:1024 lds
 M v[120:123],a[156:159],v[212:215],v[120:123]
 v_add_u32 v227,0xfffe8000,v227
 v_add_u32 v228,0xfffe8000,v228
 M v[124:127],a[220:223],v[212:215],v[124:127]
 W 6
 M v[64:67],a[32:35],v[192:195],v[64:67]
 T v[208:209],v225,0
 T v[210:211],v225,1024
 M v[68:71],a[96:99],v[192:195],v[68:71]
 buffer_load_dwordx4 v235,s[20:23],s68 offen offset:2048 lds
 M v[72:75],a[160:163],v[192:195],v[72:75]
 M v[76:79],a[224:227],v[192:195],v[76:79]
 W 6
 M v[80:83],a[32:35],v[196:199],v[80:83]
 T v[212:213],v226,0
 T v[214:215],v226,1024
 M v[84:87],a[96:99],v[196:199],v[84:87]
 buffer_load_dwordx4 v236,s[20:23],s68 offen offset:3072 lds
 M v[88:91],a[160:163],v[196:199],v[88:91]
 M v[92:95],a[224:227],v[196:199],v[92:95]
 W 6
 M v[96:99],a[32:35],v[200:203],v[96:99]
 T v[192:193],v227,0
 T v[194:195],v227,1024
 M v[100:103],a[96:99],v[200:203],v[100:103]
 s_add_u32 m0,s71,147456
 s_add_u32 s68,s74,1048960
 buffer_load_dwordx4 v233,s[20:23],s68 offen offset:0 lds
 M v[104:107],a[160:163],v[200:203],v[104:107]
 M v[108:111],a[224:227],v[200:203],v[108:111]
 W 6
 M v[112:115],a[32:35],v[204:207],v[112:115]
 T v[196:197],v228,0
 T v[198:199],v228,1024
 M v[116:119],a[96:99],v[204:207],v[116:119]
 buffer_load_dwordx4 v234,s[20:23],s68 offen offset:1024 lds
 M v[120:123],a[160:163],v[204:207],v[120:123]
 M v[124:127],a[224:227],v[204:207],v[124:127]
 W 6
 v_cvt_pk_bf16_f32 v244,v44,v45
 M v[128:131],a[0:3],v[208:211],0
 T v[200:201],v229,4096
 T v[202:203],v229,5120
 M v[132:135],a[64:67],v[208:211],0
 buffer_load_dwordx4 v235,s[20:23],s68 offen offset:2048 lds
 v_cvt_pk_bf16_f32 v246,v60,v61
 M v[136:139],a[128:131],v[208:211],0
 v_cvt_pk_bf16_f32 v245,v46,v47
 v_cvt_pk_bf16_f32 v247,v62,v63
 M v[140:143],a[192:195],v[208:211],0
 W 6
 s_add_u32 s90,s76,12288
 M v[144:147],a[0:3],v[212:215],0
 T v[204:205],v230,4096
 T v[206:207],v230,5120
 M v[148:151],a[64:67],v[212:215],0
 buffer_load_dwordx4 v236,s[20:23],s68 offen offset:3072 lds
 M v[152:155],a[128:131],v[212:215],0
 v_permlane16_swap_b32 v244,v246
 M v[156:159],a[192:195],v[212:215],0
 W 6
 v_permlane16_swap_b32 v245,v247
 M v[160:163],a[0:3],v[192:195],0
 T v[208:209],v231,4096
 T v[210:211],v231,5120
 M v[164:167],a[64:67],v[192:195],0
 buffer_store_dwordx4 v[244:247],v224,s[8:11],s90 offen offset:1024 sc0 sc1
 M v[168:171],a[128:131],v[192:195],0
 M v[172:175],a[192:195],v[192:195],0
 W 6
 M v[176:179],a[0:3],v[196:199],0
 T v[212:213],v232,4096
 T v[214:215],v232,5120
 M v[180:183],a[64:67],v[196:199],0
 M v[184:187],a[128:131],v[196:199],0
 M v[188:191],a[192:195],v[196:199],0
 W 6
 M v[64:67],a[36:39],v[200:203],v[64:67]
 T v[192:193],v225,4096
 T v[194:195],v225,5120
 M v[68:71],a[100:103],v[200:203],v[68:71]
 M v[72:75],a[164:167],v[200:203],v[72:75]
 M v[76:79],a[228:231],v[200:203],v[76:79]
 W 6
 M v[80:83],a[36:39],v[204:207],v[80:83]
 T v[196:197],v226,4096
 T v[198:199],v226,5120
 M v[84:87],a[100:103],v[204:207],v[84:87]
 M v[88:91],a[164:167],v[204:207],v[88:91]
 M v[92:95],a[228:231],v[204:207],v[92:95]
 W 6
 M v[96:99],a[36:39],v[208:211],v[96:99]
 T v[200:201],v227,4096
 T v[202:203],v227,5120
 M v[100:103],a[100:103],v[208:211],v[100:103]
 M v[104:107],a[164:167],v[208:211],v[104:107]
 v_cvt_pk_bf16_f32 v248,v40,v41
 v_cvt_pk_bf16_f32 v250,v56,v57
 M v[108:111],a[228:231],v[208:211],v[108:111]
 W 6
 v_cvt_pk_bf16_f32 v249,v42,v43
 v_cvt_pk_bf16_f32 v251,v58,v59
 M v[112:115],a[36:39],v[212:215],v[112:115]
 T v[204:205],v228,4096
 T v[206:207],v228,5120
 M v[116:119],a[100:103],v[212:215],v[116:119]
 s_add_u32 s90,s76,8192
 M v[120:123],a[164:167],v[212:215],v[120:123]
 v_permlane16_swap_b32 v248,v250
 M v[124:127],a[228:231],v[212:215],v[124:127]
 W 6
 v_permlane16_swap_b32 v249,v251
 M v[128:131],a[4:7],v[192:195],v[128:131]
 T v[208:209],v229,8192
 T v[210:211],v229,9216
 M v[132:135],a[68:71],v[192:195],v[132:135]
 buffer_store_dwordx4 v[248:251],v224,s[8:11],s90 offen offset:1024 sc0 sc1
 M v[136:139],a[132:135],v[192:195],v[136:139]
 M v[140:143],a[196:199],v[192:195],v[140:143]
 W 6
 M v[144:147],a[4:7],v[196:199],v[144:147]
 T v[212:213],v230,8192
 T v[214:215],v230,9216
 M v[148:151],a[68:71],v[196:199],v[148:151]
 M v[152:155],a[132:135],v[196:199],v[152:155]
 M v[156:159],a[196:199],v[196:199],v[156:159]
 W 6
 M v[160:163],a[4:7],v[200:203],v[160:163]
 T v[192:193],v231,8192
 T v[194:195],v231,9216
 M v[164:167],a[68:71],v[200:203],v[164:167]
 M v[168:171],a[132:135],v[200:203],v[168:171]
 v_cmp_eq_u32 vcc,0,v217
 s_cbranch_vccz PL_ok4
 s_mov_b32 s69,0x100000
PL_sp4:
 s_sleep 2
 buffer_load_dword v217,v216,s[60:63],0 offen sc1
 s_waitcnt vmcnt(0)
 v_cmp_eq_u32 vcc,0,v217
 s_cbranch_vccz PL_ok4
 s_sub_u32 s69,s69,1
 s_cbranch_scc0 PL_sp4
PL_ok4:
 v_readfirstlane_b32 s62,v217
 M v[172:175],a[196:199],v[200:203],v[172:175]
 W 6
 M v[176:179],a[4:7],v[204:207],v[176:179]
 T v[196:197],v232,8192
 T v[198:199],v232,9216
 M v[180:183],a[68:71],v[204:207],v[180:183]
 M v[184:187],a[132:135],v[204:207],v[184:187]
 M v[188:191],a[196:199],v[204:207],v[188:191]
 W 6
 M v[64:67],a[40:43],v[208:211],v[64:67]
 T v[200:201],v225,8192
 T v[202:203],v225,9216
 M v[68:71],a[104:107],v[208:211],v[68:71]
 M v[72:75],a[168:171],v[208:211],v[72:75]
 M v[76:79],a[232:235],v[208:211],v[76:79]
 W 6
 M v[80:83],a[40:43],v[212:215],v[80:83]
 T v[204:205],v226,8192
 T v[206:207],v226,9216
 M v[84:87],a[104:107],v[212:215],v[84:87]
 M v[88:91],a[168:171],v[212:215],v[88:91]
 v_cvt_pk_bf16_f32 v244,v0,v1
 v_cvt_pk_bf16_f32 v246,v16,v17
 M v[92:95],a[232:235],v[212:215],v[92:95]
 W 6
 v_cvt_pk_bf16_f32 v245,v2,v3
 v_cvt_pk_bf16_f32 v247,v18,v19
 M v[96:99],a[40:43],v[192:195],v[96:99]
 T v[208:209],v227,8192
 T v[210:211],v227,9216
 M v[100:103],a[104:107],v[192:195],v[100:103]
 s_add_u32 s90,s76,0
 M v[104:107],a[168:171],v[192:195],v[104:107]
 v_permlane16_swap_b32 v244,v246
 M v[108:111],a[232:235],v[192:195],v[108:111]
 W 6
 v_permlane16_swap_b32 v245,v247
 M v[112:115],a[40:43],v[196:199],v[112:115]
 T v[212:213],v228,8192
 T v[214:215],v228,9216
 M v[116:119],a[104:107],v[196:199],v[116:119]
 buffer_store_dwordx4 v[244:247],v224,s[8:11],s90 offen offset:0 sc0 sc1
 M v[120:123],a[168:171],v[196:199],v[120:123]
 M v[124:127],a[232:235],v[196:199],v[124:127]
 W 6
 M v[128:131],a[8:11],v[200:203],v[128:131]
 T v[192:193],v229,12288
 T v[194:195],v229,13312
 M v[132:135],a[72:75],v[200:203],v[132:135]
 M v[136:139],a[136:139],v[200:203],v[136:139]
 M v[140:143],a[200:203],v[200:203],v[140:143]
 W 6
 M v[144:147],a[8:11],v[204:207],v[144:147]
 T v[196:197],v230,12288
 T v[198:199],v230,13312
 M v[148:151],a[72:75],v[204:207],v[148:151]
 M v[152:155],a[136:139],v[204:207],v[152:155]
 M v[156:159],a[200:203],v[204:207],v[156:159]
 W 6
 M v[160:163],a[8:11],v[208:211],v[160:163]
 T v[200:201],v231,12288
 T v[202:203],v231,13312
 M v[164:167],a[72:75],v[208:211],v[164:167]
 M v[168:171],a[136:139],v[208:211],v[168:171]
 M v[172:175],a[200:203],v[208:211],v[172:175]
 W 6
 M v[176:179],a[8:11],v[212:215],v[176:179]
 T v[204:205],v232,12288
 T v[206:207],v232,13312
 M v[180:183],a[72:75],v[212:215],v[180:183]
 M v[184:187],a[136:139],v[212:215],v[184:187]
 M v[188:191],a[200:203],v[212:215],v[188:191]
 W 6
 M v[64:67],a[44:47],v[192:195],v[64:67]
 T v[208:209],v225,12288
 T v[210:211],v225,13312
 M v[68:71],a[108:111],v[192:195],v[68:71]
 M v[72:75],a[172:175],v[192:195],v[72:75]
 v_cvt_pk_bf16_f32 v248,v32,v33
 v_cvt_pk_bf16_f32 v250,v48,v49
 M v[76:79],a[236:239],v[192:195],v[76:79]
 W 6
 v_cvt_pk_bf16_f32 v249,v34,v35
 v_cvt_pk_bf16_f32 v251,v50,v51
 M v[80:83],a[44:47],v[196:199],v[80:83]
 T v[212:213],v226,12288
 T v[214:215],v226,13312
 M v[84:87],a[108:111],v[196:199],v[84:87]
 buffer_load_dword v221,v222,s[32:35],s89 offen
 s_add_u32 s90,s76,0
 M v[88:91],a[172:175],v[196:199],v[88:91]
 v_permlane16_swap_b32 v248,v250
 M v[92:95],a[236:239],v[196:199],v[92:95]
 W 6
 v_permlane16_swap_b32 v249,v251
 M v[96:99],a[44:47],v[200:203],v[96:99]
 T v[192:193],v227,12288
 T v[194:195],v227,13312
 M v[100:103],a[108:111],v[200:203],v[100:103]
 buffer_store_dwordx4 v[248:251],v224,s[8:11],s90 offen offset:1024 sc0 sc1
 M v[104:107],a[172:175],v[200:203],v[104:107]
 M v[108:111],a[236:239],v[200:203],v[108:111]
 W 6
 M v[112:115],a[44:47],v[204:207],v[112:115]
 T v[196:197],v228,12288
 T v[198:199],v228,13312
 M v[116:119],a[108:111],v[204:207],v[116:119]
 v_add_u32 v229,0xfffe4000,v229
 v_add_u32 v230,0xfffe4000,v230
 M v[120:123],a[172:175],v[204:207],v[120:123]
 v_add_u32 v231,0xfffe4000,v231
 v_add_u32 v232,0xfffe4000,v232
 M v[124:127],a[236:239],v[204:207],v[124:127]
 W 6
 s_waitcnt vmcnt(13)
 s_barrier
 M v[128:131],a[12:15],v[208:211],v[128:131]
 T v[200:201],v229,0
 T v[202:203],v229,1024
 M v[132:135],a[76:79],v[208:211],v[132:135]
 v_mov_b32 v218,s62
 v_add_u32 v218,1,v218
 buffer_store_dword v218,v216,s[8:11],s5 offen sc0 sc1
 s_add_u32 m0,s71,98304
 s_add_u32 s68,s74,2097536
 buffer_load_dwordx4 v233,s[20:23],s68 offen offset:0 lds
 M v[136:139],a[140:143],v[208:211],v[136:139]
 M v[140:143],a[204:207],v[208:211],v[140:143]
 W 6
 M v[144:147],a[12:15],v[212:215],v[144:147]
 T v[204:205],v230,0
 T v[206:207],v230,1024
 M v[148:151],a[76:79],v[212:215],v[148:151]
 buffer_load_dwordx4 v234,s[20:23],s68 offen offset:1024 lds
 M v[152:155],a[140:143],v[212:215],v[152:155]
 M v[156:159],a[204:207],v[212:215],v[156:159]
 W 6
 M v[160:163],a[12:15],v[192:195],v[160:163]
 T v[208:209],v231,0
 T v[210:211],v231,1024
 M v[164:167],a[76:79],v[192:195],v[164:167]
 buffer_load_dwordx4 v235,s[20:23],s68 offen offset:2048 lds
 M v[168:171],a[140:143],v[192:195],v[168:171]
 M v[172:175],a[204:207],v[192:195],v[172:175]
 W 6
 M v[176:179],a[12:15],v[196:199],v[176:179]
 T v[212:213],v232,0
 T v[214:215],v232,1024
 M v[180:183],a[76:79],v[196:199],v[180:183]
 v_add_u32 v225,0x8000,v225
 v_add_u32 v226,0x8000,v226
 buffer_load_dwordx4 v236,s[20:23],s68 offen offset:3072 lds
 M v[184:187],a[140:143],v[196:199],v[184:187]
 v_add_u32 v227,0x8000,v227
 v_add_u32 v228,0x8000,v228
 M v[188:191],a[204:207],v[196:199],v[188:191]
 W 6
 M v[64:67],a[48:51],v[200:203],v[64:67]
 T v[192:193],v225,0
 T v[194:195],v225,1024
 M v[68:71],a[112:115],v[200:203],v[68:71]
 s_add_u32 m0,s71,114688
 s_add_u32 s68,s80,0
 buffer_load_dwordx4 v237,s[28:31],s68 offen offset:0 lds
 M v[72:75],a[176:179],v[200:203],v[72:75]
 v_cvt_pk_bf16_f32 v244,v4,v5
 v_cvt_pk_bf16_f32 v246,v20,v21
 M v[76:79],a[240:243],v[200:203],v[76:79]
 W 6
 v_cvt_pk_bf16_f32 v245,v6,v7
 v_cvt_pk_bf16_f32 v247,v22,v23
 M v[80:83],a[48:51],v[204:207],v[80:83]
 T v[196:197],v226,0
 T v[198:199],v226,1024
 M v[84:87],a[112:115],v[204:207],v[84:87]
 buffer_load_dwordx4 v238,s[28:31],s68 offen offset:1024 lds
 s_add_u32 s90,s76,4096
 M v[88:91],a[176:179],v[204:207],v[88:91]
 v_permlane16_swap_b32 v244,v246
 M v[92:95],a[240:243],v[204:207],v[92:95]
 W 6
 v_permlane16_swap_b32 v245,v247
 M v[96:99],a[48:51],v[208:211],v[96:99]
 T v[200:201],v227,0
 T v[202:203],v227,1024
 M v[100:103],a[112:115],v[208:211],v[100:103]
 v_bfe_u32 v252,v224,4,4
 v_lshlrev_b32 v253,10,v222
 buffer_load_dwordx4 v239,s[28:31],s68 offen offset:2048 lds
 M v[104:107],a[176:179],v[208:211],v[104:107]
 v_lshl_add_u32 v252,v252,6,v253
 buffer_store_dwordx4 v[244:247],v224,s[8:11],s90 offen offset:0 sc0 sc1
 M v[108:111],a[240:243],v[208:211],v[108:111]
 W 6
 M v[112:115],a[48:51],v[212:215],v[112:115]
 T v[204:205],v228,0
 T v[206:207],v228,1024
 M v[116:119],a[112:115],v[212:215],v[116:119]
 buffer_load_dwordx4 v240,s[28:31],s68 offen offset:3072 lds
 M v[120:123],a[176:179],v[212:215],v[120:123]
 M v[124:127],a[240:243],v[212:215],v[124:127]
 W 6
 M v[128:131],a[16:19],v[192:195],v[128:131]
 T v[208:209],v229,4096
 T v[210:211],v229,5120
 M v[132:135],a[80:83],v[192:195],v[132:135]
 s_lshl_b32 s68,s97,15
 s_lshl_b32 s69,s65,10
 s_add_u32 s68,s68,s69
 buffer_load_dword v221,v252,s[24:27],s68 offen
 M v[136:139],a[144:147],v[192:195],v[136:139]
 M v[140:143],a[208:211],v[192:195],v[140:143]
 W 6
 M v[144:147],a[16:19],v[196:199],v[144:147]
 T v[212:213],v230,4096
 T v[214:215],v230,5120
 M v[148:151],a[80:83],v[196:199],v[148:151]
 M v[152:155],a[144:147],v[196:199],v[152:155]
 M v[156:159],a[208:211],v[196:199],v[156:159]
 W 6
 M v[160:163],a[16:19],v[200:203],v[160:163]
 T v[192:193],v231,4096
 T v[194:195],v231,5120
 M v[164:167],a[80:83],v[200:203],v[164:167]
 M v[168:171],a[144:147],v[200:203],v[168:171]
 v_cvt_pk_bf16_f32 v248,v36,v37
 v_cvt_pk_bf16_f32 v250,v52,v53
 M v[172:175],a[208:211],v[200:203],v[172:175]
 W 6
 v_cvt_pk_bf16_f32 v249,v38,v39
 v_cvt_pk_bf16_f32 v251,v54,v55
 M v[176:179],a[16:19],v[204:207],v[176:179]
 T v[196:197],v232,4096
 T v[198:199],v232,5120
 M v[180:183],a[80:83],v[204:207],v[180:183]
 s_add_u32 s90,s76,4096
 M v[184:187],a[144:147],v[204:207],v[184:187]
 v_permlane16_swap_b32 v248,v250
 M v[188:191],a[208:211],v[204:207],v[188:191]
 W 6
 v_permlane16_swap_b32 v249,v251
 M v[64:67],a[52:55],v[208:211],v[64:67]
 T v[200:201],v225,4096
 T v[202:203],v225,5120
 M v[68:71],a[116:119],v[208:211],v[68:71]
 buffer_store_dwordx4 v[248:251],v224,s[8:11],s90 offen offset:1024 sc0 sc1
 M v[72:75],a[180:183],v[208:211],v[72:75]
 M v[76:79],a[244:247],v[208:211],v[76:79]
 W 6
 M v[80:83],a[52:55],v[212:215],v[80:83]
 T v[204:205],v226,4096
 T v[206:207],v226,5120
 M v[84:87],a[116:119],v[212:215],v[84:87]
 M v[88:91],a[180:183],v[212:215],v[88:91]
 M v[92:95],a[244:247],v[212:215],v[92:95]
 W 6
 M v[96:99],a[52:55],v[192:195],v[96:99]
 T v[208:209],v227,4096
 T v[210:211],v227,5120
 M v[100:103],a[116:119],v[192:195],v[100:103]
 M v[104:107],a[180:183],v[192:195],v[104:107]
 M v[108:111],a[244:247],v[192:195],v[108:111]
 W 6
 M v[112:115],a[52:55],v[196:199],v[112:115]
 T v[212:213],v228,4096
 T v[214:215],v228,5120
 M v[116:119],a[116:119],v[196:199],v[116:119]
 M v[120:123],a[180:183],v[196:199],v[120:123]
 M v[124:127],a[244:247],v[196:199],v[124:127]
 W 6
 M v[128:131],a[20:23],v[200:203],v[128:131]
 T v[192:193],v229,8192
 T v[194:195],v229,9216
 M v[132:135],a[84:87],v[200:203],v[132:135]
 M v[136:139],a[148:151],v[200:203],v[136:139]
 M v[140:143],a[212:215],v[200:203],v[140:143]
 W 6
 M v[144:147],a[20:23],v[204:207],v[144:147]
 T v[196:197],v230,8192
 T v[198:199],v230,9216
 M v[148:151],a[84:87],v[204:207],v[148:151]
 M v[152:155],a[148:151],v[204:207],v[152:155]
 v_cvt_pk_bf16_f32 v244,v8,v9
 v_cvt_pk_bf16_f32 v246,v24,v25
 M v[156:159],a[212:215],v[204:207],v[156:159]
 W 6
 v_cvt_pk_bf16_f32 v245,v10,v11
 v_cvt_pk_bf16_f32 v247,v26,v27
 M v[160:163],a[20:23],v[208:211],v[160:163]
 T v[200:201],v231,8192
 T v[202:203],v231,9216
 M v[164:167],a[84:87],v[208:211],v[164:167]
 s_add_u32 s90,s76,8192
 M v[168:171],a[148:151],v[208:211],v[168:171]
 v_permlane16_swap_b32 v244,v246
 M v[172:175],a[212:215],v[208:211],v[172:175]
 W 6
 v_permlane16_swap_b32 v245,v247
 M v[176:179],a[20:23],v[212:215],v[176:179]
 T v[204:205],v232,8192
 T v[206:207],v232,9216
 M v[180:183],a[84:87],v[212:215],v[180:183]
 buffer_store_dwordx4 v[244:247],v224,s[8:11],s90 offen offset:0 sc0 sc1
 M v[184:187],a[148:151],v[212:215],v[184:187]
 M v[188:191],a[212:215],v[212:215],v[188:191]
 W 6
 M v[64:67],a[56:59],v[192:195],v[64:67]
 T v[208:209],v225,8192
 T v[210:211],v225,9216
 M v[68:71],a[120:123],v[192:195],v[68:71]
 M v[72:75],a[184:187],v[192:195],v[72:75]
 M v[76:79],a[248:251],v[192:195],v[76:79]
 W 6
 M v[80:83],a[56:59],v[196:199],v[80:83]
 T v[212:213],v226,8192
 T v[214:215],v226,9216
 M v[84:87],a[120:123],v[196:199],v[84:87]
 M v[88:91],a[184:187],v[196:199],v[88:91]
 M v[92:95],a[248:251],v[196:199],v[92:95]
 W 6
 M v[96:99],a[56:59],v[200:203],v[96:99]
 T v[192:193],v227,8192
 T v[194:195],v227,9216
 M v[100:103],a[120:123],v[200:203],v[100:103]
 M v[104:107],a[184:187],v[200:203],v[104:107]
 M v[108:111],a[248:251],v[200:203],v[108:111]
 W 6
 M v[112:115],a[56:59],v[204:207],v[112:115]
 T v[196:197],v228,8192
 T v[198:199],v228,9216
 M v[116:119],a[120:123],v[204:207],v[116:119]
 M v[120:123],a[184:187],v[204:207],v[120:123]
 M v[124:127],a[248:251],v[204:207],v[124:127]
 W 6
 M v[128:131],a[24:27],v[208:211],v[128:131]
 T v[200:201],v229,12288
 T v[202:203],v229,13312
 M v[132:135],a[88:91],v[208:211],v[132:135]
 M v[136:139],a[152:155],v[208:211],v[136:139]
 v_cvt_pk_bf16_f32 v248,v12,v13
 v_cvt_pk_bf16_f32 v250,v28,v29
 M v[140:143],a[216:219],v[208:211],v[140:143]
 W 6
 v_cvt_pk_bf16_f32 v249,v14,v15
 v_cvt_pk_bf16_f32 v251,v30,v31
 M v[144:147],a[24:27],v[212:215],v[144:147]
 T v[204:205],v230,12288
 T v[206:207],v230,13312
 M v[148:151],a[88:91],v[212:215],v[148:151]
 s_add_u32 s90,s76,12288
 M v[152:155],a[152:155],v[212:215],v[152:155]
 v_permlane16_swap_b32 v248,v250
 M v[156:159],a[216:219],v[212:215],v[156:159]
 W 6
 v_permlane16_swap_b32 v249,v251
 M v[160:163],a[24:27],v[192:195],v[160:163]
 T v[208:209],v231,12288
 T v[210:211],v231,13312
 M v[164:167],a[88:91],v[192:195],v[164:167]
 buffer_load_dword v217,v219,s[8:11],0 offen sc1
 buffer_store_dwordx4 v[248:251],v224,s[8:11],s90 offen offset:0 sc0 sc1
 M v[168:171],a[152:155],v[192:195],v[168:171]
 M v[172:175],a[216:219],v[192:195],v[172:175]
 W 6
 M v[176:179],a[24:27],v[196:199],v[176:179]
 T v[212:213],v232,12288
 T v[214:215],v232,13312
 M v[180:183],a[88:91],v[196:199],v[180:183]
 M v[184:187],a[152:155],v[196:199],v[184:187]
 M v[188:191],a[216:219],v[196:199],v[188:191]
 W 6
 M v[64:67],a[60:63],v[200:203],v[64:67]
 T v[192:193],v225,12288
 T v[194:195],v225,13312
 M v[68:71],a[124:127],v[200:203],v[68:71]
 M v[72:75],a[188:191],v[200:203],v[72:75]
 M v[76:79],a[252:255],v[200:203],v[76:79]
 W 6
 M v[80:83],a[60:63],v[204:207],v[80:83]
 T v[196:197],v226,12288
 T v[198:199],v226,13312
 M v[84:87],a[124:127],v[204:207],v[84:87]
 M v[88:91],a[188:191],v[204:207],v[88:91]
 M v[92:95],a[252:255],v[204:207],v[92:95]
 W 6
 M v[96:99],a[60:63],v[208:211],v[96:99]
 T v[200:201],v227,12288
 T v[202:203],v227,13312
 M v[100:103],a[124:127],v[208:211],v[100:103]
 M v[104:107],a[188:191],v[208:211],v[104:107]
 M v[108:111],a[252:255],v[208:211],v[108:111]
 W 6
 M v[112:115],a[60:63],v[212:215],v[112:115]
 T v[204:205],v228,12288
 T v[206:207],v228,13312
 M v[116:119],a[124:127],v[212:215],v[116:119]
 v_add_u32 v225,0x4000,v225
 v_add_u32 v226,0x4000,v226
 M v[120:123],a[188:191],v[212:215],v[120:123]
 v_add_u32 v227,0x4000,v227
 v_add_u32 v228,0x4000,v228
 M v[124:127],a[252:255],v[212:215],v[124:127]
 W 6
 s_barrier
 M v[128:131],a[28:31],v[192:195],v[128:131]
 T v[208:209],v225,0
 T v[210:211],v225,1024
 M v[132:135],a[92:95],v[192:195],v[132:135]
 s_add_u32 m0,s71,131072
 s_add_u32 s68,s74,3146112
 buffer_load_dwordx4 v233,s[20:23],s68 offen offset:0 lds
 M v[136:139],a[156:159],v[192:195],v[136:139]
 M v[140:143],a[220:223],v[192:195],v[140:143]
 W 6
 M v[144:147],a[28:31],v[196:199],v[144:147]
 T v[212:213],v226,0
 T v[214:215],v226,1024
 M v[148:151],a[92:95],v[196:199],v[148:151]
 buffer_load_dwordx4 v234,s[20:23],s68 offen offset:1024 lds
 M v[152:155],a[156:159],v[196:199],v[152:155]
 M v[156:159],a[220:223],v[196:199],v[156:159]
 W 6
 M v[160:163],a[28:31],v[200:203],v[160:163]
 T v[192:193],v227,0
 T v[194:195],v227,1024
 M v[164:167],a[92:95],v[200:203],v[164:167]
 buffer_load_dwordx4 v235,s[20:23],s68 offen offset:2048 lds
 M v[168:171],a[156:159],v[200:203],v[168:171]
 M v[172:175],a[220:223],v[200:203],v[172:175]
 W 6
 M v[176:179],a[28:31],v[204:207],v[176:179]
 T v[196:197],v228,0
 T v[198:199],v228,1024
 M v[180:183],a[92:95],v[204:207],v[180:183]
 v_add_u32 v229,0xc000,v229
 v_add_u32 v230,0xc000,v230
 buffer_load_dwordx4 v236,s[20:23],s68 offen offset:3072 lds
 M v[184:187],a[156:159],v[204:207],v[184:187]
 v_add_u32 v231,0xc000,v231
 v_add_u32 v232,0xc000,v232
 M v[188:191],a[220:223],v[204:207],v[188:191]
 W 6
 M v[128:131],a[32:35],v[208:211],v[128:131]
 T v[200:201],v229,0
 T v[202:203],v229,1024
 M v[132:135],a[96:99],v[208:211],v[132:135]
 s_add_u32 m0,s71,0
 s_add_u32 s68,s80,458752
 buffer_load_dwordx4 v237,s[28:31],s68 offen offset:0 lds
 M v[136:139],a[160:163],v[208:211],v[136:139]
 M v[140:143],a[224:227],v[208:211],v[140:143]
 W 6
 M v[144:147],a[32:35],v[212:215],v[144:147]
 T v[204:205],v230,0
 T v[206:207],v230,1024
 M v[148:151],a[96:99],v[212:215],v[148:151]
 buffer_load_dwordx4 v238,s[28:31],s68 offen offset:1024 lds
 M v[152:155],a[160:163],v[212:215],v[152:155]
 M v[156:159],a[224:227],v[212:215],v[156:159]
 W 6
 M v[160:163],a[32:35],v[192:195],v[160:163]
 T v[208:209],v231,0
 T v[210:211],v231,1024
 M v[164:167],a[96:99],v[192:195],v[164:167]
 buffer_load_dwordx4 v239,s[28:31],s68 offen offset:2048 lds
 M v[168:171],a[160:163],v[192:195],v[168:171]
 M v[172:175],a[224:227],v[192:195],v[172:175]
 W 6
 M v[176:179],a[32:35],v[196:199],v[176:179]
 T v[212:213],v232,0
 T v[214:215],v232,1024
 M v[180:183],a[96:99],v[196:199],v[180:183]
 buffer_load_dwordx4 v240,s[28:31],s68 offen offset:3072 lds
 M v[184:187],a[160:163],v[196:199],v[184:187]
 M v[188:191],a[224:227],v[196:199],v[188:191]
 W 6
 v_cvt_pk_bf16_f32 v244,v108,v109
 v_cvt_pk_bf16_f32 v246,v124,v125
 M v[0:3],a[0:3],v[200:203],0
 T v[192:193],v225,4096
 T v[194:195],v225,5120
 M v[4:7],a[64:67],v[200:203],0
 v_cvt_pk_bf16_f32 v245,v110,v111
 v_cvt_pk_bf16_f32 v247,v126,v127
 M v[8:11],a[128:131],v[200:203],0
 s_add_u32 s90,s76,12288
 M v[12:15],a[192:195],v[200:203],0
 W 6
 v_permlane16_swap_b32 v244,v246
 M v[16:19],a[0:3],v[204:207],0
 T v[196:197],v226,4096
 T v[198:199],v226,5120
 M v[20:23],a[64:67],v[204:207],0
 v_permlane16_swap_b32 v245,v247
 M v[24:27],a[128:131],v[204:207],0
 buffer_store_dwordx4 v[244:247],v224,s[8:11],s90 offen offset:3072 sc0 sc1
 M v[28:31],a[192:195],v[204:207],0
 W 6
 M v[32:35],a[0:3],v[208:211],0
 T v[200:201],v227,4096
 T v[202:203],v227,5120
 M v[36:39],a[64:67],v[208:211],0
 M v[40:43],a[128:131],v[208:211],0
 M v[44:47],a[192:195],v[208:211],0
 W 6
 M v[48:51],a[0:3],v[212:215],0
 T v[204:205],v228,4096
 T v[206:207],v228,5120
 M v[52:55],a[64:67],v[212:215],0
 M v[56:59],a[128:131],v[212:215],0
 s_add_u32 s70,s62,1
 s_waitcnt vmcnt(10)
 v_subrev_u32 v217,s70,v217
 v_cmp_le_u32 vcc,8,v217
 s_cbranch_vccz PL_ok5
 s_mov_b32 s69,0x100000
PL_sp5:
 s_sleep 2
 buffer_load_dword v217,v219,s[8:11],0 offen sc1
 s_waitcnt vmcnt(0)
 v_subrev_u32 v217,s70,v217
 v_cmp_le_u32 vcc,8,v217
 s_cbranch_vccz PL_ok5
 s_sub_u32 s69,s69,1
 s_cbranch_scc0 PL_sp5
PL_ok5:
 M v[60:63],a[192:195],v[212:215],0
 W 6
 M v[128:131],a[36:39],v[192:195],v[128:131]
 T v[208:209],v229,4096
 T v[210:211],v229,5120
 M v[132:135],a[100:103],v[192:195],v[132:135]
 s_add_u32 s84,s82,0
 s_add_u32 s85,s83,0
 buffer_load_dwordx4 a[0:3],v224,s[8:11],s84 offen offset:0 sc1
 M v[136:139],a[164:167],v[192:195],v[136:139]
 M v[140:143],a[228:231],v[192:195],v[140:143]
 W 6
 M v[144:147],a[36:39],v[196:199],v[144:147]
 T v[212:213],v230,4096
 T v[214:215],v230,5120
 M v[148:151],a[100:103],v[196:199],v[148:151]
 buffer_load_dwordx4 a[64:67],v241,s[8:11],s84 offen offset:0 sc1
 v_cvt_pk_bf16_f32 v248,v104,v105
 M v[152:155],a[164:167],v[196:199],v[152:155]
 v_cvt_pk_bf16_f32 v250,v120,v121
 v_cvt_pk_bf16_f32 v249,v106,v107
 M v[156:159],a[228:231],v[196:199],v[156:159]
 W 6
 v_cvt_pk_bf16_f32 v251,v122,v123
 s_add_u32 s90,s76,8192
 M v[160:163],a[36:39],v[200:203],v[160:163]
 T v[192:193],v231,4096
 T v[194:195],v231,5120
 M v[164:167],a[100:103],v[200:203],v[164:167]
 buffer_load_dwordx4 a[128:131],v224,s[8:11],s85 offen offset:0 sc1
 M v[168:171],a[164:167],v[200:203],v[168:171]
 v_permlane16_swap_b32 v248,v250
 M v[172:175],a[228:231],v[200:203],v[172:175]
 W 6
 v_permlane16_swap_b32 v249,v251
 M v[176:179],a[36:39],v[204:207],v[176:179]
 T v[196:197],v232,4096
 T v[198:199],v232,5120
 M v[180:183],a[100:103],v[204:207],v[180:183]
 buffer_load_dwordx4 a[192:195],v241,s[8:11],s85 offen offset:0 sc1
 buffer_store_dwordx4 v[248:251],v224,s[8:11],s90 offen offset:3072 sc0 sc1
 M v[184:187],a[164:167],v[204:207],v[184:187]
 buffer_load_dwordx2 v[120:121],v222,s[32:35],s89 offen offset:0
 buffer_load_dwordx2 v[122:123],v222,s[32:35],s89 offen offset:32
 M v[188:191],a[228:231],v[204:207],v[188:191]
 W 6
 buffer_load_dwordx2 v[124:125],v222,s[32:35],s89 offen offset:64
 buffer_load_dwordx2 v[126:127],v222,s[32:35],s89 offen offset:96
 M v[0:3],a[4:7],v[208:211],v[0:3]
 T v[200:201],v225,8192
 T v[202:203],v225,9216
 M v[4:7],a[68:71],v[208:211],v[4:7]
 M v[8:11],a[132:135],v[208:211],v[8:11]
 M v[12:15],a[196:199],v[208:211],v[12:15]
 W 6
 M v[16:19],a[4:7],v[212:215],v[16:19]
 T v[204:205],v226,8192
 T v[206:207],v226,9216
 M v[20:23],a[68:71],v[212:215],v[20:23]
 M v[24:27],a[132:135],v[212:215],v[24:27]
 v_cvt_pk_bf16_f32 v244,v64,v65
 v_cvt_pk_bf16_f32 v246,v80,v81
 M v[28:31],a[196:199],v[212:215],v[28:31]
 W 6
 v_cvt_pk_bf16_f32 v245,v66,v67
 v_cvt_pk_bf16_f32 v247,v82,v83
 M v[32:35],a[4:7],v[192:195],v[32:35]
 T v[208:209],v227,8192
 T v[210:211],v227,9216
 M v[36:39],a[68:71],v[192:195],v[36:39]
 s_add_u32 s90,s76,0
 M v[40:43],a[132:135],v[192:195],v[40:43]
 v_permlane16_swap_b32 v244,v246
 M v[44:47],a[196:199],v[192:195],v[44:47]
 W 6
 v_permlane16_swap_b32 v245,v247
 M v[48:51],a[4:7],v[196:199],v[48:51]
 T v[212:213],v228,8192
 T v[214:215],v228,9216
 M v[52:55],a[68:71],v[196:199],v[52:55]
 buffer_store_dwordx4 v[244:247],v224,s[8:11],s90 offen offset:2048 sc0 sc1
 M v[56:59],a[132:135],v[196:199],v[56:59]
 M v[60:63],a[196:199],v[196:199],v[60:63]
 W 6
 M v[128:131],a[40:43],v[200:203],v[128:131]
 T v[192:193],v229,8192
 T v[194:195],v229,9216
 M v[132:135],a[104:107],v[200:203],v[132:135]
 buffer_load_dwordx4 a[4:7],v224,s[8:11],s84 offen offset:1024 sc1
 M v[136:139],a[168:171],v[200:203],v[136:139]
 M v[140:143],a[232:235],v[200:203],v[140:143]
 W 6
 M v[144:147],a[40:43],v[204:207],v[144:147]
 T v[196:197],v230,8192
 T v[198:199],v230,9216
 M v[148:151],a[104:107],v[204:207],v[148:151]
 buffer_load_dwordx4 a[68:71],v241,s[8:11],s84 offen offset:1024 sc1
 M v[152:155],a[168:171],v[204:207],v[152:155]
 M v[156:159],a[232:235],v[204:207],v[156:159]
 W 6
 M v[160:163],a[40:43],v[208:211],v[160:163]
 T v[200:201],v231,8192
 T v[202:203],v231,9216
 M v[164:167],a[104:107],v[208:211],v[164:167]
 buffer_load_dwordx4 a[132:135],v224,s[8:11],s85 offen offset:1024 sc1
 M v[168:171],a[168:171],v[208:211],v[168:171]
 M v[172:175],a[232:235],v[208:211],v[172:175]
 W 6
 v_cvt_pk_bf16_f32 v248,v96,v97
 v_cvt_pk_bf16_f32 v250,v112,v113
 M v[176:179],a[40:43],v[212:215],v[176:179]
 T v[204:205],v232,8192
 T v[206:207],v232,9216
 M v[180:183],a[104:107],v[212:215],v[180:183]
 buffer_load_dwordx4 a[196:199],v241,s[8:11],s85 offen offset:1024 sc1
 v_cvt_pk_bf16_f32 v249,v98,v99
 M v[184:187],a[168:171],v[212:215],v[184:187]
 v_cvt_pk_bf16_f32 v251,v114,v115
 s_add_u32 s90,s76,0
 M v[188:191],a[232:235],v[212:215],v[188:191]
 W 6
 v_permlane16_swap_b32 v248,v250
 M v[0:3],a[8:11],v[192:195],v[0:3]
 T v[208:209],v225,12288
 T v[210:211],v225,13312
 M v[4:7],a[72:75],v[192:195],v[4:7]
 v_permlane16_swap_b32 v249,v251
 M v[8:11],a[136:139],v[192:195],v[8:11]
 buffer_store_dwordx4 v[248:251],v224,s[8:11],s90 offen offset:3072 sc0 sc1
 M v[12:15],a[200:203],v[192:195],v[12:15]
 W 6
 M v[16:19],a[8:11],v[196:199],v[16:19]
 T v[212:213],v226,12288
 T v[214:215],v226,13312
 M v[20:23],a[72:75],v[196:199],v[20:23]
 M v[24:27],a[136:139],v[196:199],v[24:27]
 M v[28:31],a[200:203],v[196:199],v[28:31]
 W 6
 M v[32:35],a[8:11],v[200:203],v[32:35]
 T v[192:193],v227,12288
 T v[194:195],v227,13312
 M v[36:39],a[72:75],v[200:203],v[36:39]
 M v[40:43],a[136:139],v[200:203],v[40:43]
 M v[44:47],a[200:203],v[200:203],v[44:47]
 W 6
 M v[48:51],a[8:11],v[204:207],v[48:51]
 T v[196:197],v228,12288
 T v[198:199],v228,13312
 M v[52:55],a[72:75],v[204:207],v[52:55]
 M v[56:59],a[136:139],v[204:207],v[56:59]
 v_cvt_pk_bf16_f32 v244,v68,v69
 v_cvt_pk_bf16_f32 v246,v84,v85
 M v[60:63],a[200:203],v[204:207],v[60:63]
 W 6
 v_cvt_pk_bf16_f32 v245,v70,v71
 v_cvt_pk_bf16_f32 v247,v86,v87
 M v[128:131],a[44:47],v[208:211],v[128:131]
 T v[200:201],v229,12288
 T v[202:203],v229,13312
 M v[132:135],a[108:111],v[208:211],v[132:135]
 buffer_load_dwordx4 a[8:11],v224,s[8:11],s84 offen offset:2048 sc1
 s_add_u32 s90,s76,4096
 M v[136:139],a[172:175],v[208:211],v[136:139]
 v_permlane16_swap_b32 v244,v246
 M v[140:143],a[236:239],v[208:211],v[140:143]
 W 6
 v_permlane16_swap_b32 v245,v247
 M v[144:147],a[44:47],v[212:215],v[144:147]
 T v[204:205],v230,12288
 T v[206:207],v230,13312
 M v[148:151],a[108:111],v[212:215],v[148:151]
 buffer_load_dwordx4 a[72:75],v241,s[8:11],s84 offen offset:2048 sc1
 buffer_store_dwordx4 v[244:247],v224,s[8:11],s90 offen offset:2048 sc0 sc1
 M v[152:155],a[172:175],v[212:215],v[152:155]
 M v[156:159],a[236:239],v[212:215],v[156:159]
 W 6
 M v[160:163],a[44:47],v[192:195],v[160:163]
 T v[208:209],v231,12288
 T v[210:211],v231,13312
 M v[164:167],a[108:111],v[192:195],v[164:167]
 buffer_load_dwordx4 a[136:139],v224,s[8:11],s85 offen offset:2048 sc1
 M v[168:171],a[172:175],v[192:195],v[168:171]
 M v[172:175],a[236:239],v[192:195],v[172:175]
 W 6
 M v[176:179],a[44:47],v[196:199],v[176:179]
 T v[212:213],v232,12288
 T v[214:215],v232,13312
 M v[180:183],a[108:111],v[196:199],v[180:183]
 v_add_u32 v225,0x8000,v225
 v_add_u32 v226,0x8000,v226
 buffer_load_dwordx4 a[200:203],v241,s[8:11],s85 offen offset:2048 sc1
 M v[184:187],a[172:175],v[196:199],v[184:187]
 v_add_u32 v227,0x8000,v227
 v_add_u32 v228,0x8000,v228
 M v[188:191],a[236:239],v[196:199],v[188:191]
 W 6
 s_barrier
 M v[0:3],a[12:15],v[200:203],v[0:3]
 T v[192:193],v225,0
 T v[194:195],v225,1024
 M v[4:7],a[76:79],v[200:203],v[4:7]
 s_add_u32 m0,s71,16384
 s_add_u32 s68,s80,917504
 buffer_load_dwordx4 v237,s[28:31],s68 offen offset:0 lds
 M v[8:11],a[140:143],v[200:203],v[8:11]
 M v[12:15],a[204:207],v[200:203],v[12:15]
 W 6
 M v[16:19],a[12:15],v[204:207],v[16:19]
 T v[196:197],v226,0
 T v[198:199],v226,1024
 M v[20:23],a[76:79],v[204:207],v[20:23]
 buffer_load_dwordx4 v238,s[28:31],s68 offen offset:1024 lds
 M v[24:27],a[140:143],v[204:207],v[24:27]
 v_cvt_pk_bf16_f32 v248,v100,v101
 M v[28:31],a[204:207],v[204:207],v[28:31]
 W 6
 v_cvt_pk_bf16_f32 v250,v116,v117
 v_cvt_pk_bf16_f32 v249,v102,v103
 M v[32:35],a[12:15],v[208:211],v[32:35]
 T v[200:201],v227,0
 T v[202:203],v227,1024
 M v[36:39],a[76:79],v[208:211],v[36:39]
 buffer_load_dwordx4 v239,s[28:31],s68 offen offset:2048 lds
 v_cvt_pk_bf16_f32 v251,v118,v119
 M v[40:43],a[140:143],v[208:211],v[40:43]
 s_add_u32 s90,s76,4096
 M v[44:47],a[204:207],v[208:211],v[44:47]
 W 6
 v_permlane16_swap_b32 v248,v250
 M v[48:51],a[12:15],v[212:215],v[48:51]
 T v[204:205],v228,0
 T v[206:207],v228,1024
 M v[52:55],a[76:79],v[212:215],v[52:55]
 v_add_u32 v229,0x14000,v229
 v_add_u32 v230,0x14000,v230
 buffer_load_dwordx4 v240,s[28:31],s68 offen offset:3072 lds
 M v[56:59],a[140:143],v[212:215],v[56:59]
 v_add_u32 v231,0x14000,v231
 v_add_u32 v232,0x14000,v232
 M v[60:63],a[204:207],v[212:215],v[60:63]
 W 6
 v_permlane16_swap_b32 v249,v251
 M v[128:131],a[48:51],v[192:195],v[128:131]
 T v[208:209],v229,0
 T v[210:211],v229,1024
 M v[132:135],a[112:115],v[192:195],v[132:135]
 s_add_u32 m0,s71,32768
 s_add_u32 s68,s80,1376256
 buffer_load_dwordx4 v237,s[28:31],s68 offen offset:0 lds
 M v[136:139],a[176:179],v[192:195],v[136:139]
 buffer_store_dwordx4 v[248:251],v224,s[8:11],s90 offen offset:3072 sc0 sc1
 M v[140:143],a[240:243],v[192:195],v[140:143]
 W 6
 M v[144:147],a[48:51],v[196:199],v[144:147]
 T v[212:213],v230,0
 T v[214:215],v230,1024
 M v[148:151],a[112:115],v[196:199],v[148:151]
 buffer_load_dwordx4 v238,s[28:31],s68 offen offset:1024 lds
 M v[152:155],a[176:179],v[196:199],v[152:155]
 M v[156:159],a[240:243],v[196:199],v[156:159]
 W 6
 M v[160:163],a[48:51],v[200:203],v[160:163]
 T v[192:193],v231,0
 T v[194:195],v231,1024
 M v[164:167],a[112:115],v[200:203],v[164:167]
 buffer_load_dwordx4 v239,s[28:31],s68 offen offset:2048 lds
 v_cvt_pk_bf16_f32 v244,v72,v73
 M v[168:171],a[176:179],v[200:203],v[168:171]
 v_cvt_pk_bf16_f32 v246,v88,v89
 v_cvt_pk_bf16_f32 v245,v74,v75
 M v[172:175],a[240:243],v[200:203],v[172:175]
 W 6
 v_cvt_pk_bf16_f32 v247,v90,v91
 s_add_u32 s90,s76,8192
 M v[176:179],a[48:51],v[204:207],v[176:179]
 T v[196:197],v232,0
 T v[198:199],v232,1024
 M v[180:183],a[112:115],v[204:207],v[180:183]
 buffer_load_dwordx4 v240,s[28:31],s68 offen offset:3072 lds
 M v[184:187],a[176:179],v[204:207],v[184:187]
 v_permlane16_swap_b32 v244,v246
 M v[188:191],a[240:243],v[204:207],v[188:191]
 W 6
 v_permlane16_swap_b32 v245,v247
 M v[0:3],a[16:19],v[208:211],v[0:3]
 T v[200:201],v225,4096
 T v[202:203],v225,5120
 M v[4:7],a[80:83],v[208:211],v[4:7]
 buffer_load_dwordx4 a[12:15],v224,s[8:11],s84 offen offset:3072 sc1
 buffer_store_dwordx4 v[244:247],v224,s[8:11],s90 offen offset:2048 sc0 sc1
 M v[8:11],a[144:147],v[208:211],v[8:11]
 M v[12:15],a[208:211],v[208:211],v[12:15]
 W 6
 M v[16:19],a[16:19],v[212:215],v[16:19]
 T v[204:205],v226,4096
 T v[206:207],v226,5120
 M v[20:23],a[80:83],v[212:215],v[20:23]
 buffer_load_dwordx4 a[76:79],v241,s[8:11],s84 offen offset:3072 sc1
 M v[24:27],a[144:147],v[212:215],v[24:27]
 M v[28:31],a[208:211],v[212:215],v[28:31]
 W 6
 M v[32:35],a[16:19],v[192:195],v[32:35]
 T v[208:209],v227,4096
 T v[210:211],v227,5120
 M v[36:39],a[80:83],v[192:195],v[36:39]
 buffer_load_dwordx4 a[140:143],v224,s[8:11],s85 offen offset:3072 sc1
 M v[40:43],a[144:147],v[192:195],v[40:43]
 M v[44:47],a[208:211],v[192:195],v[44:47]
 W 6
 v_cvt_pk_bf16_f32 v248,v76,v77
 v_cvt_pk_bf16_f32 v250,v92,v93
 M v[48:51],a[16:19],v[196:199],v[48:51]
 T v[212:213],v228,4096
 T v[214:215],v228,5120
 M v[52:55],a[80:83],v[196:199],v[52:55]
 buffer_load_dwordx4 a[204:207],v241,s[8:11],s85 offen offset:3072 sc1
 v_cvt_pk_bf16_f32 v249,v78,v79
 M v[56:59],a[144:147],v[196:199],v[56:59]
 v_cvt_pk_bf16_f32 v251,v94,v95
 s_add_u32 s90,s76,12288
 M v[60:63],a[208:211],v[196:199],v[60:63]
 W 6
 v_permlane16_swap_b32 v248,v250
 M v[128:131],a[52:55],v[200:203],v[128:131]
 T v[192:193],v229,4096
 T v[194:195],v229,5120
 M v[132:135],a[116:119],v[200:203],v[132:135]
 s_add_u32 s84,s82,4096
 s_add_u32 s85,s83,4096
 buffer_load_dwordx4 a[16:19],v224,s[8:11],s84 offen offset:0 sc1
 M v[136:139],a[180:183],v[200:203],v[136:139]
 v_permlane16_swap_b32 v249,v251
 M v[140:143],a[244:247],v[200:203],v[140:143]
 W 6
 buffer_store_dwordx4 v[248:251],v224,s[8:11],s90 offen offset:2048 sc0 sc1
 M v[144:147],a[52:55],v[204:207],v[144:147]
 T v[196:197],v230,4096
 T v[198:199],v230,5120
 M v[148:151],a[116:119],v[204:207],v[148:151]
 buffer_load_dwordx4 a[80:83],v241,s[8:11],s84 offen offset:0 sc1
 M v[152:155],a[180:183],v[204:207],v[152:155]
 M v[156:159],a[244:247],v[204:207],v[156:159]
 W 6
 M v[160:163],a[52:55],v[208:211],v[160:163]
 T v[200:201],v231,4096
 T v[202:203],v231,5120
 M v[164:167],a[116:119],v[208:211],v[164:167]
 buffer_load_dwordx4 a[144:147],v224,s[8:11],s85 offen offset:0 sc1
 M v[168:171],a[180:183],v[208:211],v[168:171]
 M v[172:175],a[244:247],v[208:211],v[172:175]
 W 6
 M v[176:179],a[52:55],v[212:215],v[176:179]
 T v[204:205],v232,4096
 T v[206:207],v232,5120
 M v[180:183],a[116:119],v[212:215],v[180:183]
 buffer_load_dwordx4 a[208:211],v241,s[8:11],s85 offen offset:0 sc1
 M v[184:187],a[180:183],v[212:215],v[184:187]
 M v[188:191],a[244:247],v[212:215],v[188:191]
 W 6
 M v[0:3],a[20:23],v[192:195],v[0:3]
 T v[208:209],v225,8192
 T v[210:211],v225,9216
 M v[4:7],a[84:87],v[192:195],v[4:7]
 M v[8:11],a[148:151],v[192:195],v[8:11]
 M v[12:15],a[212:215],v[192:195],v[12:15]
 W 6
 M v[16:19],a[20:23],v[196:199],v[16:19]
 T v[212:213],v226,8192
 T v[214:215],v226,9216
 M v[20:23],a[84:87],v[196:199],v[20:23]
 M v[24:27],a[148:151],v[196:199],v[24:27]
 M v[28:31],a[212:215],v[196:199],v[28:31]
 W 6
 M v[32:35],a[20:23],v[200:203],v[32:35]
 T v[192:193],v227,8192
 T v[194:195],v227,9216
 M v[36:39],a[84:87],v[200:203],v[36:39]
 s_waitcnt vmcnt(33)
 v_lshlrev_b32 v64,16,v120
 v_and_b32 v65,0xffff0000,v120
 M v[40:43],a[148:151],v[200:203],v[40:43]
 v_lshlrev_b32 v66,16,v121
 v_and_b32 v67,0xffff0000,v121
 M v[44:47],a[212:215],v[200:203],v[44:47]
 W 6
 v_lshlrev_b32 v68,16,v120
 v_and_b32 v69,0xffff0000,v120
 M v[48:51],a[20:23],v[204:207],v[48:51]
 T v[196:197],v228,8192
 T v[198:199],v228,9216
 M v[52:55],a[84:87],v[204:207],v[52:55]
 v_lshlrev_b32 v70,16,v121
 v_and_b32 v71,0xffff0000,v121
 M v[56:59],a[148:151],v[204:207],v[56:59]
 v_lshlrev_b32 v72,16,v120
 v_and_b32 v73,0xffff0000,v120
 M v[60:63],a[212:215],v[204:207],v[60:63]
 W 6
 v_lshlrev_b32 v74,16,v121
 v_and_b32 v75,0xffff0000,v121
 M v[128:131],a[56:59],v[208:211],v[128:131]
 T v[200:201],v229,8192
 T v[202:203],v229,9216
 M v[132:135],a[120:123],v[208:211],v[132:135]
 buffer_load_dwordx4 a[20:23],v224,s[8:11],s84 offen offset:1024 sc1
 v_lshlrev_b32 v76,16,v120
 M v[136:139],a[184:187],v[208:211],v[136:139]
 v_and_b32 v77,0xffff0000,v120
 v_lshlrev_b32 v78,16,v121
 M v[140:143],a[248:251],v[208:211],v[140:143]
 W 6
 v_and_b32 v79,0xffff0000,v121
 s_waitcnt vmcnt(33)
 v_lshlrev_b32 v80,16,v122
 M v[144:147],a[56:59],v[212:215],v[144:147]
 T v[204:205],v230,8192
 T v[206:207],v230,9216
 M v[148:151],a[120:123],v[212:215],v[148:151]
 buffer_load_dwordx4 a[84:87],v241,s[8:11],s84 offen offset:1024 sc1
 v_and_b32 v81,0xffff0000,v122
 M v[152:155],a[184:187],v[212:215],v[152:155]
 v_lshlrev_b32 v82,16,v123
 v_and_b32 v83,0xffff0000,v123
 M v[156:159],a[248:251],v[212:215],v[156:159]
 W 6
 v_lshlrev_b32 v84,16,v122
 v_and_b32 v85,0xffff0000,v122
 M v[160:163],a[56:59],v[192:195],v[160:163]
 T v[208:209],v231,8192
 T v[210:211],v231,9216
 M v[164:167],a[120:123],v[192:195],v[164:167]
 buffer_load_dwordx4 a[148:151],v224,s[8:11],s85 offen offset:1024 sc1
 v_lshlrev_b32 v86,16,v123
 M v[168:171],a[184:187],v[192:195],v[168:171]
 v_and_b32 v87,0xffff0000,v123
 v_lshlrev_b32 v88,16,v122
 M v[172:175],a[248:251],v[192:195],v[172:175]
 W 6
 v_and_b32 v89,0xffff0000,v122
 v_lshlrev_b32 v90,16,v123
 M v[176:179],a[56:59],v[196:199],v[176:179]
 T v[212:213],v232,8192
 T v[214:215],v232,9216
 M v[180:183],a[120:123],v[196:199],v[180:183]
 buffer_load_dwordx4 a[212:215],v241,s[8:11],s85 offen offset:1024 sc1
 v_and_b32 v91,0xffff0000,v123
 M v[184:187],a[184:187],v[196:199],v[184:187]
 v_lshlrev_b32 v92,16,v122
 v_and_b32 v93,0xffff0000,v122
 M v[188:191],a[248:251],v[196:199],v[188:191]
 W 6
 v_lshlrev_b32 v94,16,v123
 v_and_b32 v95,0xffff0000,v123
 M v[0:3],a[24:27],v[200:203],v[0:3]
 T v[192:193],v225,12288
 T v[194:195],v225,13312
 M v[4:7],a[88:91],v[200:203],v[4:7]
 s_waitcnt vmcnt(35)
 v_lshlrev_b32 v96,16,v124
 v_and_b32 v97,0xffff0000,v124
 M v[8:11],a[152:155],v[200:203],v[8:11]
 v_lshlrev_b32 v98,16,v125
 v_and_b32 v99,0xffff0000,v125
 M v[12:15],a[216:219],v[200:203],v[12:15]
 W 6
 v_lshlrev_b32 v100,16,v124
 v_and_b32 v101,0xffff0000,v124
 M v[16:19],a[24:27],v[204:207],v[16:19]
 T v[196:197],v226,12288
 T v[198:199],v226,13312
 M v[20:23],a[88:91],v[204:207],v[20:23]
 v_lshlrev_b32 v102,16,v125
 v_and_b32 v103,0xffff0000,v125
 M v[24:27],a[152:155],v[204:207],v[24:27]
 v_lshlrev_b32 v104,16,v124
 v_and_b32 v105,0xffff0000,v124
 M v[28:31],a[216:219],v[204:207],v[28:31]
 W 6
 v_lshlrev_b32 v106,16,v125
 v_and_b32 v107,0xffff0000,v125
 M v[32:35],a[24:27],v[208:211],v[32:35]
 T v[200:201],v227,12288
 T v[202:203],v227,13312
 M v[36:39],a[88:91],v[208:211],v[36:39]
 v_lshlrev_b32 v108,16,v124
 v_and_b32 v109,0xffff0000,v124
 M v[40:43],a[152:155],v[208:211],v[40:43]
 v_lshlrev_b32 v110,16,v125
 v_and_b32 v111,0xffff0000,v125
 M v[44:47],a[216:219],v[208:211],v[44:47]
 W 6
 s_waitcnt vmcnt(34)
 v_lshlrev_b32 v112,16,v126
 v_and_b32 v113,0xffff0000,v126
 M v[48:51],a[24:27],v[212:215],v[48:51]
 T v[204:205],v228,12288
 T v[206:207],v228,13312
 M v[52:55],a[88:91],v[212:215],v[52:55]
 v_lshlrev_b32 v114,16,v127
 v_and_b32 v115,0xffff0000,v127
 M v[56:59],a[152:155],v[212:215],v[56:59]
 v_mov_b32 v116,v112
 v_mov_b32 v117,v113
 M v[60:63],a[216:219],v[212:215],v[60:63]
 W 6
 v_mov_b32 v118,v114
 v_mov_b32 v119,v115
 M v[128:131],a[60:63],v[192:195],v[128:131]
 T v[208:209],v229,12288
 T v[210:211],v229,13312
 M v[132:135],a[124:127],v[192:195],v[132:135]
 buffer_load_dwordx4 a[24:27],v224,s[8:11],s84 offen offset:2048 sc1
 v_mov_b32 v120,v112
 M v[136:139],a[188:191],v[192:195],v[136:139]
 v_mov_b32 v121,v113
 v_mov_b32 v122,v114
 M v[140:143],a[252:255],v[192:195],v[140:143]
 W 6
 v_mov_b32 v123,v115
 v_mov_b32 v124,v112
 M v[144:147],a[60:63],v[196:199],v[144:147]
 T v[212:213],v230,12288
 T v[214:215],v230,13312
 M v[148:151],a[124:127],v[196:199],v[148:151]
 buffer_load_dwordx4 a[88:91],v241,s[8:11],s84 offen offset:2048 sc1
 v_mov_b32 v125,v113
 M v[152:155],a[188:191],v[196:199],v[152:155]
 v_mov_b32 v126,v114
 v_mov_b32 v127,v115
 M v[156:159],a[252:255],v[196:199],v[156:159]
 W 6
 M v[160:163],a[60:63],v[200:203],v[160:163]
 T v[192:193],v231,12288
 T v[194:195],v231,13312
 M v[164:167],a[124:127],v[200:203],v[164:167]
 buffer_load_dwordx4 a[152:155],v224,s[8:11],s85 offen offset:2048 sc1
 M v[168:171],a[188:191],v[200:203],v[168:171]
 M v[172:175],a[252:255],v[200:203],v[172:175]
 W 6
 M v[176:179],a[60:63],v[204:207],v[176:179]
 T v[196:197],v232,12288
 T v[198:199],v232,13312
 M v[180:183],a[124:127],v[204:207],v[180:183]
 v_add_u32 v229,0xffff4000,v229
 v_add_u32 v230,0xffff4000,v230
 buffer_load_dwordx4 a[216:219],v241,s[8:11],s85 offen offset:2048 sc1
 M v[184:187],a[188:191],v[204:207],v[184:187]
 v_add_u32 v231,0xffff4000,v231
 v_add_u32 v232,0xffff4000,v232
 M v[188:191],a[252:255],v[204:207],v[188:191]
 W 6
 s_barrier
 M v[0:3],a[28:31],v[208:211],v[0:3]
 T v[200:201],v229,0
 T v[202:203],v229,1024
 M v[4:7],a[92:95],v[208:211],v[4:7]
 s_add_u32 m0,s71,49152
 s_add_u32 s68,s81,0
 buffer_load_dwordx4 v233,s[24:27],s68 offen offset:0 lds
 M v[8:11],a[156:159],v[208:211],v[8:11]
 M v[12:15],a[220:223],v[208:211],v[12:15]
 W 6
 M v[16:19],a[28:31],v[212:215],v[16:19]
 T v[204:205],v230,0
 T v[206:207],v230,1024
 M v[20:23],a[92:95],v[212:215],v[20:23]
 buffer_load_dwordx4 v234,s[24:27],s68 offen offset:1024 lds
 M v[24:27],a[156:159],v[212:215],v[24:27]
 M v[28:31],a[220:223],v[212:215],v[28:31]
 W 6
 M v[32:35],a[28:31],v[192:195],v[32:35]
 T v[208:209],v231,0
 T v[210:211],v231,1024
 M v[36:39],a[92:95],v[192:195],v[36:39]
 buffer_load_dwordx4 v235,s[24:27],s68 offen offset:2048 lds
 M v[40:43],a[156:159],v[192:195],v[40:43]
 M v[44:47],a[220:223],v[192:195],v[44:47]
 W 6
 M v[48:51],a[28:31],v[196:199],v[48:51]
 T v[212:213],v232,0
 T v[214:215],v232,1024
 M v[52:55],a[92:95],v[196:199],v[52:55]
 v_add_u32 v225,0x8000,v225
 v_add_u32 v226,0x8000,v226
 buffer_load_dwordx4 v236,s[24:27],s68 offen offset:3072 lds
 M v[56:59],a[156:159],v[196:199],v[56:59]
 v_add_u32 v227,0x8000,v227
 v_add_u32 v228,0x8000,v228
 M v[60:63],a[220:223],v[196:199],v[60:63]
 W 6
 M v[0:3],a[32:35],v[200:203],v[0:3]
 T v[192:193],v225,0
 T v[194:195],v225,1024
 M v[4:7],a[96:99],v[200:203],v[4:7]
 s_add_u32 m0,s71,65536
 s_add_u32 s68,s81,1048576
 buffer_load_dwordx4 v233,s[24:27],s68 offen offset:0 lds
 M v[8:11],a[160:163],v[200:203],v[8:11]
 M v[12:15],a[224:227],v[200:203],v[12:15]
 W 6
 M v[16:19],a[32:35],v[204:207],v[16:19]
 T v[196:197],v226,0
 T v[198:199],v226,1024
 M v[20:23],a[96:99],v[204:207],v[20:23]
 buffer_load_dwordx4 v234,s[24:27],s68 offen offset:1024 lds
 M v[24:27],a[160:163],v[204:207],v[24:27]
 M v[28:31],a[224:227],v[204:207],v[28:31]
 W 6
 M v[32:35],a[32:35],v[208:211],v[32:35]
 T v[200:201],v227,0
 T v[202:203],v227,1024
 M v[36:39],a[96:99],v[208:211],v[36:39]
 buffer_load_dwordx4 v235,s[24:27],s68 offen offset:2048 lds
 M v[40:43],a[160:163],v[208:211],v[40:43]
 M v[44:47],a[224:227],v[208:211],v[44:47]
 W 6
 M v[48:51],a[32:35],v[212:215],v[48:51]
 T v[204:205],v228,0
 T v[206:207],v228,1024
 M v[52:55],a[96:99],v[212:215],v[52:55]
 buffer_load_dwordx4 v236,s[24:27],s68 offen offset:3072 lds
 M v[56:59],a[160:163],v[212:215],v[56:59]
 M v[60:63],a[224:227],v[212:215],v[60:63]
 W 6
 v_cvt_pk_bf16_f32 v244,v172,v173
 v_cvt_pk_bf16_f32 v246,v188,v189
 M v[64:67],v[192:195],a[0:3],v[64:67]
 T v[208:209],v229,4096
 T v[210:211],v229,5120
 M v[68:71],v[192:195],a[64:67],v[68:71]
 buffer_load_dwordx4 a[28:31],v224,s[8:11],s84 offen offset:3072 sc1
 v_cvt_pk_bf16_f32 v245,v174,v175
 M v[72:75],v[192:195],a[128:131],v[72:75]
 v_cvt_pk_bf16_f32 v247,v190,v191
 s_add_u32 s90,s76,569344
 M v[76:79],v[192:195],a[192:195],v[76:79]
 W 6
 v_permlane16_swap_b32 v244,v246
 M v[80:83],v[196:199],a[0:3],v[80:83]
 T v[212:213],v230,4096
 T v[214:215],v230,5120
 M v[84:87],v[196:199],a[64:67],v[84:87]
 buffer_load_dwordx4 a[92:95],v241,s[8:11],s84 offen offset:3072 sc1
 M v[88:91],v[196:199],a[128:131],v[88:91]
 v_permlane16_swap_b32 v245,v247
 M v[92:95],v[196:199],a[192:195],v[92:95]
 W 6
 buffer_store_dwordx4 v[244:247],v224,s[8:11],s90 offen offset:1024 sc0 sc1
 M v[96:99],v[200:203],a[0:3],v[96:99]
 T v[192:193],v231,4096
 T v[194:195],v231,5120
 M v[100:103],v[200:203],a[64:67],v[100:103]
 buffer_load_dwordx4 a[156:159],v224,s[8:11],s85 offen offset:3072 sc1
 M v[104:107],v[200:203],a[128:131],v[104:107]
 M v[108:111],v[200:203],a[192:195],v[108:111]
 W 6
 M v[112:115],v[204:207],a[0:3],v[112:115]
 T v[196:197],v232,4096
 T v[198:199],v232,5120
 M v[116:119],v[204:207],a[64:67],v[116:119]
 buffer_load_dwordx4 a[220:223],v241,s[8:11],s85 offen offset:3072 sc1
 M v[120:123],v[204:207],a[128:131],v[120:123]
 M v[124:127],v[204:207],a[192:195],v[124:127]
 W 6
 M v[0:3],a[36:39],v[208:211],v[0:3]
 T v[200:201],v225,4096
 T v[202:203],v225,5120
 M v[4:7],a[100:103],v[208:211],v[4:7]
 s_add_u32 s84,s82,8192
 s_add_u32 s85,s83,8192
 buffer_load_dwordx4 a[32:35],v224,s[8:11],s84 offen offset:0 sc1
 M v[8:11],a[164:167],v[208:211],v[8:11]
 M v[12:15],a[228:231],v[208:211],v[12:15]
 W 6
 M v[16:19],a[36:39],v[212:215],v[16:19]
 T v[204:205],v226,4096
 T v[206:207],v226,5120
 M v[20:23],a[100:103],v[212:215],v[20:23]
 buffer_load_dwordx4 a[96:99],v241,s[8:11],s84 offen offset:0 sc1
 M v[24:27],a[164:167],v[212:215],v[24:27]
 M v[28:31],a[228:231],v[212:215],v[28:31]
 W 6
 M v[32:35],a[36:39],v[192:195],v[32:35]
 T v[208:209],v227,4096
 T v[210:211],v227,5120
 M v[36:39],a[100:103],v[192:195],v[36:39]
 buffer_load_dwordx4 a[160:163],v224,s[8:11],s85 offen offset:0 sc1
 M v[40:43],a[164:167],v[192:195],v[40:43]
 M v[44:47],a[228:231],v[192:195],v[44:47]
 W 6
 v_cvt_pk_bf16_f32 v248,v168,v169
 v_cvt_pk_bf16_f32 v250,v184,v185
 M v[48:51],a[36:39],v[196:199],v[48:51]
 T v[212:213],v228,4096
 T v[214:215],v228,5120
 M v[52:55],a[100:103],v[196:199],v[52:55]
 buffer_load_dwordx4 a[224:227],v241,s[8:11],s85 offen offset:0 sc1
 v_cvt_pk_bf16_f32 v249,v170,v171
 M v[56:59],a[164:167],v[196:199],v[56:59]
 v_cvt_pk_bf16_f32 v251,v186,v187
 s_add_u32 s90,s76,565248
 M v[60:63],a[228:231],v[196:199],v[60:63]
 W 6
 v_permlane16_swap_b32 v248,v250
 s_waitcnt vmcnt(53)
 M v[64:67],v[200:203],a[4:7],v[64:67]
 T v[192:193],v229,8192
 T v[194:195],v229,9216
 s_waitcnt vmcnt(52)
 M v[68:71],v[200:203],a[68:71],v[68:71]
 buffer_load_dwordx4 a[36:39],v224,s[8:11],s84 offen offset:1024 sc1
 s_waitcnt vmcnt(52)
 M v[72:75],v[200:203],a[132:135],v[72:75]
 v_permlane16_swap_b32 v249,v251
 s_waitcnt vmcnt(51)
 M v[76:79],v[200:203],a[196:199],v[76:79]
 W 6
 buffer_store_dwordx4 v[248:251],v224,s[8:11],s90 offen offset:1024 sc0 sc1
 M v[80:83],v[204:207],a[4:7],v[80:83]
 T v[196:197],v230,8192
 T v[198:199],v230,9216
 M v[84:87],v[204:207],a[68:71],v[84:87]
 buffer_load_dwordx4 a[100:103],v241,s[8:11],s84 offen offset:1024 sc1
 M v[88:91],v[204:207],a[132:135],v[88:91]
 M v[92:95],v[204:207],a[196:199],v[92:95]
 W 6
 M v[96:99],v[208:211],a[4:7],v[96:99]
 T v[200:201],v231,8192
 T v[202:203],v231,9216
 M v[100:103],v[208:211],a[68:71],v[100:103]
 buffer_load_dwordx4 a[164:167],v224,s[8:11],s85 offen offset:1024 sc1
 M v[104:107],v[208:211],a[132:135],v[104:107]
 M v[108:111],v[208:211],a[196:199],v[108:111]
 W 6
 M v[112:115],v[212:215],a[4:7],v[112:115]
 T v[204:205],v232,8192
 T v[206:207],v232,9216
 M v[116:119],v[212:215],a[68:71],v[116:119]
 buffer_load_dwordx4 a[228:231],v241,s[8:11],s85 offen offset:1024 sc1
 M v[120:123],v[212:215],a[132:135],v[120:123]
 M v[124:127],v[212:215],a[196:199],v[124:127]
 W 6
 M v[0:3],a[40:43],v[192:195],v[0:3]
 T v[208:209],v225,8192
 T v[210:211],v225,9216
 M v[4:7],a[104:107],v[192:195],v[4:7]
 M v[8:11],a[168:171],v[192:195],v[8:11]
 M v[12:15],a[232:235],v[192:195],v[12:15]
 W 6
 M v[16:19],a[40:43],v[196:199],v[16:19]
 T v[212:213],v226,8192
 T v[214:215],v226,9216
 M v[20:23],a[104:107],v[196:199],v[20:23]
 M v[24:27],a[168:171],v[196:199],v[24:27]
 v_cvt_pk_bf16_f32 v244,v128,v129
 v_cvt_pk_bf16_f32 v246,v144,v145
 M v[28:31],a[232:235],v[196:199],v[28:31]
 W 6
 v_cvt_pk_bf16_f32 v245,v130,v131
 v_cvt_pk_bf16_f32 v247,v146,v147
 M v[32:35],a[40:43],v[200:203],v[32:35]
 T v[192:193],v227,8192
 T v[194:195],v227,9216
 M v[36:39],a[104:107],v[200:203],v[36:39]
 s_add_u32 s90,s76,557056
 M v[40:43],a[168:171],v[200:203],v[40:43]
 v_permlane16_swap_b32 v244,v246
 M v[44:47],a[232:235],v[200:203],v[44:47]
 W 6
 v_permlane16_swap_b32 v245,v247
 M v[48:51],a[40:43],v[204:207],v[48:51]
 T v[196:197],v228,8192
 T v[198:199],v228,9216
 M v[52:55],a[104:107],v[204:207],v[52:55]
 buffer_store_dwordx4 v[244:247],v224,s[8:11],s90 offen offset:0 sc0 sc1
 M v[56:59],a[168:171],v[204:207],v[56:59]
 M v[60:63],a[232:235],v[204:207],v[60:63]
 W 6
 s_waitcnt vmcnt(54)
 M v[64:67],v[208:211],a[8:11],v[64:67]
 T v[200:201],v229,12288
 T v[202:203],v229,13312
 s_waitcnt vmcnt(53)
 M v[68:71],v[208:211],a[72:75],v[68:71]
 buffer_load_dwordx4 a[40:43],v224,s[8:11],s84 offen offset:2048 sc1
 s_waitcnt vmcnt(52)
 M v[72:75],v[208:211],a[136:139],v[72:75]
 s_waitcnt vmcnt(51)
 M v[76:79],v[208:211],a[200:203],v[76:79]
 W 6
 M v[80:83],v[212:215],a[8:11],v[80:83]
 T v[204:205],v230,12288
 T v[206:207],v230,13312
 M v[84:87],v[212:215],a[72:75],v[84:87]
 buffer_load_dwordx4 a[104:107],v241,s[8:11],s84 offen offset:2048 sc1
 M v[88:91],v[212:215],a[136:139],v[88:91]
 M v[92:95],v[212:215],a[200:203],v[92:95]
 W 6
 M v[96:99],v[192:195],a[8:11],v[96:99]
 T v[208:209],v231,12288
 T v[210:211],v231,13312
 M v[100:103],v[192:195],a[72:75],v[100:103]
 buffer_load_dwordx4 a[168:171],v224,s[8:11],s85 offen offset:2048 sc1
 M v[104:107],v[192:195],a[136:139],v[104:107]
 M v[108:111],v[192:195],a[200:203],v[108:111]
 W 6
 M v[112:115],v[196:199],a[8:11],v[112:115]
 T v[212:213],v232,12288
 T v[214:215],v232,13312
 M v[116:119],v[196:199],a[72:75],v[116:119]
 buffer_load_dwordx4 a[232:235],v241,s[8:11],s85 offen offset:2048 sc1
 M v[120:123],v[196:199],a[136:139],v[120:123]
 M v[124:127],v[196:199],a[200:203],v[124:127]
 W 6
 M v[0:3],a[44:47],v[200:203],v[0:3]
 T v[192:193],v225,12288
 T v[194:195],v225,13312
 M v[4:7],a[108:111],v[200:203],v[4:7]
 M v[8:11],a[172:175],v[200:203],v[8:11]
 v_cvt_pk_bf16_f32 v248,v160,v161
 M v[12:15],a[236:239],v[200:203],v[12:15]
 W 6
 v_cvt_pk_bf16_f32 v250,v176,v177
 v_cvt_pk_bf16_f32 v249,v162,v163
 M v[16:19],a[44:47],v[204:207],v[16:19]
 T v[196:197],v226,12288
 T v[198:199],v226,13312
 M v[20:23],a[108:111],v[204:207],v[20:23]
 v_cvt_pk_bf16_f32 v251,v178,v179
 s_add_u32 s90,s76,557056
 M v[24:27],a[172:175],v[204:207],v[24:27]
 v_permlane16_swap_b32 v248,v250
 M v[28:31],a[236:239],v[204:207],v[28:31]
 W 6
 v_permlane16_swap_b32 v249,v251
 M v[32:35],a[44:47],v[208:211],v[32:35]
 T v[200:201],v227,12288
 T v[202:203],v227,13312
 M v[36:39],a[108:111],v[208:211],v[36:39]
 buffer_store_dwordx4 v[248:251],v224,s[8:11],s90 offen offset:1024 sc0 sc1
 M v[40:43],a[172:175],v[208:211],v[40:43]
 M v[44:47],a[236:239],v[208:211],v[44:47]
 W 6
 M v[48:51],a[44:47],v[212:215],v[48:51]
 T v[204:205],v228,12288
 T v[206:207],v228,13312
 M v[52:55],a[108:111],v[212:215],v[52:55]
 v_add_u32 v229,0x8000,v229
 v_add_u32 v230,0x8000,v230
 M v[56:59],a[172:175],v[212:215],v[56:59]
 v_add_u32 v231,0x8000,v231
 v_add_u32 v232,0x8000,v232
 M v[60:63],a[236:239],v[212:215],v[60:63]
 W 6
 s_barrier
 s_waitcnt vmcnt(45)
 M v[64:67],v[192:195],a[12:15],v[64:67]
 T v[208:209],v229,0
 T v[210:211],v229,1024
 s_waitcnt vmcnt(43)
 M v[68:71],v[192:195],a[76:79],v[68:71]
 s_add_u32 m0,s71,81920
 s_add_u32 s68,s81,2097152
 buffer_load_dwordx4 v233,s[24:27],s68 offen offset:0 lds
 s_waitcnt vmcnt(43)
 M v[72:75],v[192:195],a[140:143],v[72:75]
 s_waitcnt vmcnt(42)
 M v[76:79],v[192:195],a[204:207],v[76:79]
 W 6
 M v[80:83],v[196:199],a[12:15],v[80:83]
 T v[212:213],v230,0
 T v[214:215],v230,1024
 M v[84:87],v[196:199],a[76:79],v[84:87]
 buffer_load_dwordx4 v234,s[24:27],s68 offen offset:1024 lds
 M v[88:91],v[196:199],a[140:143],v[88:91]
 M v[92:95],v[196:199],a[204:207],v[92:95]
 W 6
 M v[96:99],v[200:203],a[12:15],v[96:99]
 T v[192:193],v231,0
 T v[194:195],v231,1024
 M v[100:103],v[200:203],a[76:79],v[100:103]
 buffer_load_dwordx4 v235,s[24:27],s68 offen offset:2048 lds
 M v[104:107],v[200:203],a[140:143],v[104:107]
 M v[108:111],v[200:203],a[204:207],v[108:111]
 W 6
 M v[112:115],v[204:207],a[12:15],v[112:115]
 T v[196:197],v232,0
 T v[198:199],v232,1024
 M v[116:119],v[204:207],a[76:79],v[116:119]
 v_add_u32 v225,0xfffe4000,v225
 v_add_u32 v226,0xfffe4000,v226
 buffer_load_dwordx4 v236,s[24:27],s68 offen offset:3072 lds
 M v[120:123],v[204:207],a[140:143],v[120:123]
 v_add_u32 v227,0xfffe4000,v227
 v_add_u32 v228,0xfffe4000,v228
 M v[124:127],v[204:207],a[204:207],v[124:127]
 W 6
 M v[0:3],a[48:51],v[208:211],v[0:3]
 T v[200:201],v225,0
 T v[202:203],v225,1024
 M v[4:7],a[112:115],v[208:211],v[4:7]
 s_add_u32 m0,s71,98304
 s_add_u32 s68,s81,3145728
 buffer_load_dwordx4 v233,s[24:27],s68 offen offset:0 lds
 M v[8:11],a[176:179],v[208:211],v[8:11]
 v_cvt_pk_bf16_f32 v244,v132,v133
 v_cvt_pk_bf16_f32 v246,v148,v149
 M v[12:15],a[240:243],v[208:211],v[12:15]
 W 6
 v_cvt_pk_bf16_f32 v245,v134,v135
 v_cvt_pk_bf16_f32 v247,v150,v151
 M v[16:19],a[48:51],v[212:215],v[16:19]
 T v[204:205],v226,0
 T v[206:207],v226,1024
 M v[20:23],a[112:115],v[212:215],v[20:23]
 buffer_load_dwordx4 v234,s[24:27],s68 offen offset:1024 lds
 s_add_u32 s90,s76,561152
 M v[24:27],a[176:179],v[212:215],v[24:27]
 v_permlane16_swap_b32 v244,v246
 M v[28:31],a[240:243],v[212:215],v[28:31]
 W 6
 v_permlane16_swap_b32 v245,v247
 M v[32:35],a[48:51],v[192:195],v[32:35]
 T v[208:209],v227,0
 T v[210:211],v227,1024
 M v[36:39],a[112:115],v[192:195],v[36:39]
 buffer_load_dwordx4 v235,s[24:27],s68 offen offset:2048 lds
 buffer_store_dwordx4 v[244:247],v224,s[8:11],s90 offen offset:0 sc0 sc1
 M v[40:43],a[176:179],v[192:195],v[40:43]
 M v[44:47],a[240:243],v[192:195],v[44:47]
 W 6
 M v[48:51],a[48:51],v[196:199],v[48:51]
 T v[212:213],v228,0
 T v[214:215],v228,1024
 M v[52:55],a[112:115],v[196:199],v[52:55]
 buffer_load_dwordx4 v236,s[24:27],s68 offen offset:3072 lds
 M v[56:59],a[176:179],v[196:199],v[56:59]
 M v[60:63],a[240:243],v[196:199],v[60:63]
 W 6
 s_waitcnt vmcnt(49)
 M v[64:67],v[200:203],a[16:19],v[64:67]
 T v[192:193],v229,4096
 T v[194:195],v229,5120
 s_waitcnt vmcnt(47)
 M v[68:71],v[200:203],a[80:83],v[68:71]
 buffer_load_dwordx4 a[44:47],v224,s[8:11],s84 offen offset:3072 sc1
 s_waitcnt vmcnt(47)
 M v[72:75],v[200:203],a[144:147],v[72:75]
 s_waitcnt vmcnt(46)
 M v[76:79],v[200:203],a[208:211],v[76:79]
 W 6
 M v[80:83],v[204:207],a[16:19],v[80:83]
 T v[196:197],v230,4096
 T v[198:199],v230,5120
 M v[84:87],v[204:207],a[80:83],v[84:87]
 buffer_load_dwordx4 a[108:111],v241,s[8:11],s84 offen offset:3072 sc1
 M v[88:91],v[204:207],a[144:147],v[88:91]
 M v[92:95],v[204:207],a[208:211],v[92:95]
 W 6
 M v[96:99],v[208:211],a[16:19],v[96:99]
 T v[200:201],v231,4096
 T v[202:203],v231,5120
 M v[100:103],v[208:211],a[80:83],v[100:103]
 buffer_load_dwordx4 a[172:175],v224,s[8:11],s85 offen offset:3072 sc1
 M v[104:107],v[208:211],a[144:147],v[104:107]
 M v[108:111],v[208:211],a[208:211],v[108:111]
 W 6
 v_cvt_pk_bf16_f32 v248,v164,v165
 v_cvt_pk_bf16_f32 v250,v180,v181
 M v[112:115],v[212:215],a[16:19],v[112:115]
 T v[204:205],v232,4096
 T v[206:207],v232,5120
 M v[116:119],v[212:215],a[80:83],v[116:119]
 buffer_load_dwordx4 a[236:239],v241,s[8:11],s85 offen offset:3072 sc1
 v_cvt_pk_bf16_f32 v249,v166,v167
 M v[120:123],v[212:215],a[144:147],v[120:123]
 v_cvt_pk_bf16_f32 v251,v182,v183
 s_add_u32 s90,s76,561152
 M v[124:127],v[212:215],a[208:211],v[124:127]
 W 6
 v_permlane16_swap_b32 v248,v250
 M v[0:3],a[52:55],v[192:195],v[0:3]
 T v[208:209],v225,4096
 T v[210:211],v225,5120
 M v[4:7],a[116:119],v[192:195],v[4:7]
 s_add_u32 s84,s82,12288
 s_add_u32 s85,s83,12288
 buffer_load_dwordx4 a[48:51],v224,s[8:11],s84 offen offset:0 sc1
 M v[8:11],a[180:183],v[192:195],v[8:11]
 v_permlane16_swap_b32 v249,v251
 M v[12:15],a[244:247],v[192:195],v[12:15]
 W 6
 buffer_store_dwordx4 v[248:251],v224,s[8:11],s90 offen offset:1024 sc0 sc1
 M v[16:19],a[52:55],v[196:199],v[16:19]
 T v[212:213],v226,4096
 T v[214:215],v226,5120
 M v[20:23],a[116:119],v[196:199],v[20:23]
 buffer_load_dwordx4 a[112:115],v241,s[8:11],s84 offen offset:0 sc1
 M v[24:27],a[180:183],v[196:199],v[24:27]
 M v[28:31],a[244:247],v[196:199],v[28:31]
 W 6
 M v[32:35],a[52:55],v[200:203],v[32:35]
 T v[192:193],v227,4096
 T v[194:195],v227,5120
 M v[36:39],a[116:119],v[200:203],v[36:39]
 buffer_load_dwordx4 a[176:179],v224,s[8:11],s85 offen offset:0 sc1
 M v[40:43],a[180:183],v[200:203],v[40:43]
 M v[44:47],a[244:247],v[200:203],v[44:47]
 W 6
 M v[48:51],a[52:55],v[204:207],v[48:51]
 T v[196:197],v228,4096
 T v[198:199],v228,5120
 M v[52:55],a[116:119],v[204:207],v[52:55]
 buffer_load_dwordx4 a[240:243],v241,s[8:11],s85 offen offset:0 sc1
 M v[56:59],a[180:183],v[204:207],v[56:59]
 M v[60:63],a[244:247],v[204:207],v[60:63]
 W 6
 s_waitcnt vmcnt(53)
 M v[64:67],v[208:211],a[20:23],v[64:67]
 T v[200:201],v229,8192
 T v[202:203],v229,9216
 s_waitcnt vmcnt(52)
 M v[68:71],v[208:211],a[84:87],v[68:71]
 buffer_load_dwordx4 a[52:55],v224,s[8:11],s84 offen offset:1024 sc1
 s_waitcnt vmcnt(52)
 M v[72:75],v[208:211],a[148:151],v[72:75]
 s_waitcnt vmcnt(51)
 M v[76:79],v[208:211],a[212:215],v[76:79]
 W 6
 M v[80:83],v[212:215],a[20:23],v[80:83]
 T v[204:205],v230,8192
 T v[206:207],v230,9216
 M v[84:87],v[212:215],a[84:87],v[84:87]
 buffer_load_dwordx4 a[116:119],v241,s[8:11],s84 offen offset:1024 sc1
 M v[88:91],v[212:215],a[148:151],v[88:91]
 M v[92:95],v[212:215],a[212:215],v[92:95]
 W 6
 v_cvt_pk_bf16_f32 v244,v136,v137
 v_cvt_pk_bf16_f32 v246,v152,v153
 M v[96:99],v[192:195],a[20:23],v[96:99]
 T v[208:209],v231,8192
 T v[210:211],v231,9216
 M v[100:103],v[192:195],a[84:87],v[100:103]
 buffer_load_dwordx4 a[180:183],v224,s[8:11],s85 offen offset:1024 sc1
 v_cvt_pk_bf16_f32 v245,v138,v139
 M v[104:107],v[192:195],a[148:151],v[104:107]
 v_cvt_pk_bf16_f32 v247,v154,v155
 s_add_u32 s90,s76,565248
 M v[108:111],v[192:195],a[212:215],v[108:111]
 W 6
 v_permlane16_swap_b32 v244,v246
 M v[112:115],v[196:199],a[20:23],v[112:115]
 T v[212:213],v232,8192
 T v[214:215],v232,9216
 M v[116:119],v[196:199],a[84:87],v[116:119]
 buffer_load_dwordx4 a[244:247],v241,s[8:11],s85 offen offset:1024 sc1
 M v[120:123],v[196:199],a[148:151],v[120:123]
 v_permlane16_swap_b32 v245,v247
 M v[124:127],v[196:199],a[212:215],v[124:127]
 W 6
 buffer_store_dwordx4 v[244:247],v224,s[8:11],s90 offen offset:0 sc0 sc1
 M v[0:3],a[56:59],v[200:203],v[0:3]
 T v[192:193],v225,8192
 T v[194:195],v225,9216
 M v[4:7],a[120:123],v[200:203],v[4:7]
 M v[8:11],a[184:187],v[200:203],v[8:11]
 M v[12:15],a[248:251],v[200:203],v[12:15]
 W 6
 M v[16:19],a[56:59],v[204:207],v[16:19]
 T v[196:197],v226,8192
 T v[198:199],v226,9216
 M v[20:23],a[120:123],v[204:207],v[20:23]
 M v[24:27],a[184:187],v[204:207],v[24:27]
 M v[28:31],a[248:251],v[204:207],v[28:31]
 W 6
 M v[32:35],a[56:59],v[208:211],v[32:35]
 T v[200:201],v227,8192
 T v[202:203],v227,9216
 M v[36:39],a[120:123],v[208:211],v[36:39]
 M v[40:43],a[184:187],v[208:211],v[40:43]
 M v[44:47],a[248:251],v[208:211],v[44:47]
 W 6
 M v[48:51],a[56:59],v[212:215],v[48:51]
 T v[204:205],v228,8192
 T v[206:207],v228,9216
 M v[52:55],a[120:123],v[212:215],v[52:55]
 M v[56:59],a[184:187],v[212:215],v[56:59]
 M v[60:63],a[248:251],v[212:215],v[60:63]
 W 6
 s_waitcnt vmcnt(54)
 M v[64:67],v[192:195],a[24:27],v[64:67]
 T v[208:209],v229,12288
 T v[210:211],v229,13312
 s_waitcnt vmcnt(53)
 M v[68:71],v[192:195],a[88:91],v[68:71]
 buffer_load_dwordx4 a[56:59],v224,s[8:11],s84 offen offset:2048 sc1
 s_waitcnt vmcnt(53)
 M v[72:75],v[192:195],a[152:155],v[72:75]
 v_cvt_pk_bf16_f32 v248,v140,v141
 s_waitcnt vmcnt(52)
 M v[76:79],v[192:195],a[216:219],v[76:79]
 W 6
 v_cvt_pk_bf16_f32 v250,v156,v157
 v_cvt_pk_bf16_f32 v249,v142,v143
 M v[80:83],v[196:199],a[24:27],v[80:83]
 T v[212:213],v230,12288
 T v[214:215],v230,13312
 M v[84:87],v[196:199],a[88:91],v[84:87]
 buffer_load_dwordx4 a[120:123],v241,s[8:11],s84 offen offset:2048 sc1
 v_cvt_pk_bf16_f32 v251,v158,v159
 M v[88:91],v[196:199],a[152:155],v[88:91]
 s_add_u32 s90,s76,569344
 M v[92:95],v[196:199],a[216:219],v[92:95]
 W 6
 v_permlane16_swap_b32 v248,v250
 M v[96:99],v[200:203],a[24:27],v[96:99]
 T v[192:193],v231,12288
 T v[194:195],v231,13312
 M v[100:103],v[200:203],a[88:91],v[100:103]
 buffer_load_dwordx4 a[184:187],v224,s[8:11],s85 offen offset:2048 sc1
 M v[104:107],v[200:203],a[152:155],v[104:107]
 v_permlane16_swap_b32 v249,v251
 M v[108:111],v[200:203],a[216:219],v[108:111]
 W 6
 buffer_store_dwordx4 v[248:251],v224,s[8:11],s90 offen offset:0 sc0 sc1
 M v[112:115],v[204:207],a[24:27],v[112:115]
 T v[196:197],v232,12288
 T v[198:199],v232,13312
 M v[116:119],v[204:207],a[88:91],v[116:119]
 buffer_load_dwordx4 a[248:251],v241,s[8:11],s85 offen offset:2048 sc1
 M v[120:123],v[204:207],a[152:155],v[120:123]
 M v[124:127],v[204:207],a[216:219],v[124:127]
 W 6
 M v[0:3],a[60:63],v[208:211],v[0:3]
 T v[200:201],v225,12288
 T v[202:203],v225,13312
 M v[4:7],a[124:127],v[208:211],v[4:7]
 M v[8:11],a[188:191],v[208:211],v[8:11]
 M v[12:15],a[252:255],v[208:211],v[12:15]
 W 6
 M v[16:19],a[60:63],v[212:215],v[16:19]
 T v[204:205],v226,12288
 T v[206:207],v226,13312
 M v[20:23],a[124:127],v[212:215],v[20:23]
 M v[24:27],a[188:191],v[212:215],v[24:27]
 M v[28:31],a[252:255],v[212:215],v[28:31]
 W 6
 M v[32:35],a[60:63],v[192:195],v[32:35]
 T v[208:209],v227,12288
 T v[210:211],v227,13312
 M v[36:39],a[124:127],v[192:195],v[36:39]
 M v[40:43],a[188:191],v[192:195],v[40:43]
 M v[44:47],a[252:255],v[192:195],v[44:47]
 W 6
 M v[48:51],a[60:63],v[196:199],v[48:51]
 T v[212:213],v228,12288
 T v[214:215],v228,13312
 M v[52:55],a[124:127],v[196:199],v[52:55]
 v_add_u32 v225,0x4000,v225
 v_add_u32 v226,0x4000,v226
 M v[56:59],a[188:191],v[196:199],v[56:59]
 v_add_u32 v227,0x4000,v227
 v_add_u32 v228,0x4000,v228
 M v[60:63],a[252:255],v[196:199],v[60:63]
 W 6
 s_barrier
 s_waitcnt vmcnt(47)
 M v[64:67],v[200:203],a[28:31],v[64:67]
 T v[192:193],v225,0
 T v[194:195],v225,1024
 s_waitcnt vmcnt(46)
 M v[68:71],v[200:203],a[92:95],v[68:71]
 s_add_u32 m0,s71,147456
 s_add_u32 s68,s81,128
 buffer_load_dwordx4 v233,s[24:27],s68 offen offset:0 lds
 s_waitcnt vmcnt(45)
 M v[72:75],v[200:203],a[156:159],v[72:75]
 s_waitcnt vmcnt(44)
 M v[76:79],v[200:203],a[220:223],v[76:79]
 W 6
 M v[80:83],v[204:207],a[28:31],v[80:83]
 T v[196:197],v226,0
 T v[198:199],v226,1024
 M v[84:87],v[204:207],a[92:95],v[84:87]
 buffer_load_dwordx4 v234,s[24:27],s68 offen offset:1024 lds
 M v[88:91],v[204:207],a[156:159],v[88:91]
 M v[92:95],v[204:207],a[220:223],v[92:95]
 W 6
 M v[96:99],v[208:211],a[28:31],v[96:99]
 T v[200:201],v227,0
 T v[202:203],v227,1024
 M v[100:103],v[208:211],a[92:95],v[100:103]
 buffer_load_dwordx4 v235,s[24:27],s68 offen offset:2048 lds
 M v[104:107],v[208:211],a[156:159],v[104:107]
 M v[108:111],v[208:211],a[220:223],v[108:111]
 W 6
 M v[112:115],v[212:215],a[28:31],v[112:115]
 T v[204:205],v228,0
 T v[206:207],v228,1024
 M v[116:119],v[212:215],a[92:95],v[116:119]
 buffer_load_dwordx4 v236,s[24:27],s68 offen offset:3072 lds
 M v[120:123],v[212:215],a[156:159],v[120:123]
 M v[124:127],v[212:215],a[220:223],v[124:127]
 W 6
 v_cvt_pk_bf16_f32 v244,v44,v45
 v_cvt_pk_bf16_f32 v246,v60,v61
 s_waitcnt vmcnt(46)
 M v[64:67],v[192:195],a[32:35],v[64:67]
 T v[208:209],v225,4096
 T v[210:211],v225,5120
 s_waitcnt vmcnt(45)
 M v[68:71],v[192:195],a[96:99],v[68:71]
 s_add_u32 m0,s71,114688
 s_add_u32 s68,s81,1048704
 buffer_load_dwordx4 v233,s[24:27],s68 offen offset:0 lds
 s_waitcnt vmcnt(45)
 M v[72:75],v[192:195],a[160:163],v[72:75]
 v_cvt_pk_bf16_f32 v245,v46,v47
 v_cvt_pk_bf16_f32 v247,v62,v63
 s_waitcnt vmcnt(44)
 M v[76:79],v[192:195],a[224:227],v[76:79]
 W 6
 s_add_u32 s90,s76,569344
 M v[80:83],v[196:199],a[32:35],v[80:83]
 T v[212:213],v226,4096
 T v[214:215],v226,5120
 M v[84:87],v[196:199],a[96:99],v[84:87]
 buffer_load_dwordx4 v234,s[24:27],s68 offen offset:1024 lds
 M v[88:91],v[196:199],a[160:163],v[88:91]
 v_permlane16_swap_b32 v244,v246
 M v[92:95],v[196:199],a[224:227],v[92:95]
 W 6
 v_permlane16_swap_b32 v245,v247
 M v[96:99],v[200:203],a[32:35],v[96:99]
 T v[192:193],v227,4096
 T v[194:195],v227,5120
 M v[100:103],v[200:203],a[96:99],v[100:103]
 buffer_load_dwordx4 v235,s[24:27],s68 offen offset:2048 lds
 buffer_store_dwordx4 v[244:247],v224,s[8:11],s90 offen offset:3072 sc0 sc1
 M v[104:107],v[200:203],a[160:163],v[104:107]
 M v[108:111],v[200:203],a[224:227],v[108:111]
 W 6
 M v[112:115],v[204:207],a[32:35],v[112:115]
 T v[196:197],v228,4096
 T v[198:199],v228,5120
 M v[116:119],v[204:207],a[96:99],v[116:119]
 buffer_load_dwordx4 v236,s[24:27],s68 offen offset:3072 lds
 M v[120:123],v[204:207],a[160:163],v[120:123]
 M v[124:127],v[204:207],a[224:227],v[124:127]
 W 6
 v_cvt_pk_bf16_f32 v248,v40,v41
 s_waitcnt vmcnt(47)
 M v[64:67],v[208:211],a[36:39],v[64:67]
 T v[200:201],v225,8192
 T v[202:203],v225,9216
 s_waitcnt vmcnt(45)
 M v[68:71],v[208:211],a[100:103],v[68:71]
 buffer_load_dwordx4 a[60:63],v224,s[8:11],s84 offen offset:3072 sc1
 v_cvt_pk_bf16_f32 v250,v56,v57
 s_waitcnt vmcnt(45)
 M v[72:75],v[208:211],a[164:167],v[72:75]
 v_cvt_pk_bf16_f32 v249,v42,v43
 v_cvt_pk_bf16_f32 v251,v58,v59
 s_waitcnt vmcnt(44)
 M v[76:79],v[208:211],a[228:231],v[76:79]
 W 6
 s_add_u32 s90,s76,565248
 M v[80:83],v[212:215],a[36:39],v[80:83]
 T v[204:205],v226,8192
 T v[206:207],v226,9216
 M v[84:87],v[212:215],a[100:103],v[84:87]
 buffer_load_dwordx4 a[124:127],v241,s[8:11],s84 offen offset:3072 sc1
 M v[88:91],v[212:215],a[164:167],v[88:91]
 v_permlane16_swap_b32 v248,v250
 M v[92:95],v[212:215],a[228:231],v[92:95]
 W 6
 v_permlane16_swap_b32 v249,v251
 M v[96:99],v[192:195],a[36:39],v[96:99]
 T v[208:209],v227,8192
 T v[210:211],v227,9216
 M v[100:103],v[192:195],a[100:103],v[100:103]
 buffer_load_dwordx4 a[188:191],v224,s[8:11],s85 offen offset:3072 sc1
 buffer_store_dwordx4 v[248:251],v224,s[8:11],s90 offen offset:3072 sc0 sc1
 M v[104:107],v[192:195],a[164:167],v[104:107]
 M v[108:111],v[192:195],a[228:231],v[108:111]
 W 6
 M v[112:115],v[196:199],a[36:39],v[112:115]
 T v[212:213],v228,8192
 T v[214:215],v228,9216
 M v[116:119],v[196:199],a[100:103],v[116:119]
 buffer_load_dwordx4 a[252:255],v241,s[8:11],s85 offen offset:3072 sc1
 M v[120:123],v[196:199],a[164:167],v[120:123]
 M v[124:127],v[196:199],a[228:231],v[124:127]
 W 6
 v_cvt_pk_bf16_f32 v244,v0,v1
 s_waitcnt vmcnt(46)
 M v[64:67],v[200:203],a[40:43],v[64:67]
 T v[192:193],v225,12288
 T v[194:195],v225,13312
 s_waitcnt vmcnt(45)
 M v[68:71],v[200:203],a[104:107],v[68:71]
 v_cvt_pk_bf16_f32 v246,v16,v17
 v_cvt_pk_bf16_f32 v245,v2,v3
 s_waitcnt vmcnt(44)
 M v[72:75],v[200:203],a[168:171],v[72:75]
 v_cvt_pk_bf16_f32 v247,v18,v19
 s_add_u32 s90,s76,557056
 s_waitcnt vmcnt(43)
 M v[76:79],v[200:203],a[232:235],v[76:79]
 W 6
 v_permlane16_swap_b32 v244,v246
 M v[80:83],v[204:207],a[40:43],v[80:83]
 T v[196:197],v226,12288
 T v[198:199],v226,13312
 M v[84:87],v[204:207],a[104:107],v[84:87]
 v_permlane16_swap_b32 v245,v247
 M v[88:91],v[204:207],a[168:171],v[88:91]
 buffer_store_dwordx4 v[244:247],v224,s[8:11],s90 offen offset:2048 sc0 sc1
 M v[92:95],v[204:207],a[232:235],v[92:95]
 W 6
 M v[96:99],v[208:211],a[40:43],v[96:99]
 T v[200:201],v227,12288
 T v[202:203],v227,13312
 M v[100:103],v[208:211],a[104:107],v[100:103]
 M v[104:107],v[208:211],a[168:171],v[104:107]
 M v[108:111],v[208:211],a[232:235],v[108:111]
 W 6
 v_cvt_pk_bf16_f32 v248,v32,v33
 M v[112:115],v[212:215],a[40:43],v[112:115]
 T v[204:205],v228,12288
 T v[206:207],v228,13312
 M v[116:119],v[212:215],a[104:107],v[116:119]
 v_add_u32 v225,0x4000,v225
 v_add_u32 v226,0x4000,v226
 v_cvt_pk_bf16_f32 v250,v48,v49
 M v[120:123],v[212:215],a[168:171],v[120:123]
 v_add_u32 v227,0x4000,v227
 v_add_u32 v228,0x4000,v228
 v_cvt_pk_bf16_f32 v249,v34,v35
 M v[124:127],v[212:215],a[232:235],v[124:127]
 W 6
 v_cvt_pk_bf16_f32 v251,v50,v51
 s_add_u32 s90,s76,557056
 s_waitcnt vmcnt(33)
 M v[64:67],v[192:195],a[44:47],v[64:67]
 T v[208:209],v225,0
 T v[210:211],v225,1024
 s_waitcnt vmcnt(32)
 M v[68:71],v[192:195],a[108:111],v[68:71]
 v_permlane16_swap_b32 v248,v250
 s_waitcnt vmcnt(31)
 M v[72:75],v[192:195],a[172:175],v[72:75]
 v_permlane16_swap_b32 v249,v251
 s_waitcnt vmcnt(30)
 M v[76:79],v[192:195],a[236:239],v[76:79]
 W 6
 buffer_store_dwordx4 v[248:251],v224,s[8:11],s90 offen offset:3072 sc0 sc1
 M v[80:83],v[196:199],a[44:47],v[80:83]
 T v[212:213],v226,0
 T v[214:215],v226,1024
 M v[84:87],v[196:199],a[108:111],v[84:87]
 M v[88:91],v[196:199],a[172:175],v[88:91]
 M v[92:95],v[196:199],a[236:239],v[92:95]
 W 6
 M v[96:99],v[200:203],a[44:47],v[96:99]
 T v[192:193],v227,0
 T v[194:195],v227,1024
 M v[100:103],v[200:203],a[108:111],v[100:103]
 v_cvt_pk_bf16_f32 v244,v4,v5
 M v[104:107],v[200:203],a[172:175],v[104:107]
 v_cvt_pk_bf16_f32 v246,v20,v21
 v_cvt_pk_bf16_f32 v245,v6,v7
 M v[108:111],v[200:203],a[236:239],v[108:111]
 W 6
 v_cvt_pk_bf16_f32 v247,v22,v23
 s_add_u32 s90,s76,561152
 M v[112:115],v[204:207],a[44:47],v[112:115]
 T v[196:197],v228,0
 T v[198:199],v228,1024
 M v[116:119],v[204:207],a[108:111],v[116:119]
 v_permlane16_swap_b32 v244,v246
 M v[120:123],v[204:207],a[172:175],v[120:123]
 v_permlane16_swap_b32 v245,v247
 M v[124:127],v[204:207],a[236:239],v[124:127]
 W 6
 buffer_store_dwordx4 v[244:247],v224,s[8:11],s90 offen offset:2048 sc0 sc1
 s_waitcnt vmcnt(31)
 M v[64:67],v[208:211],a[48:51],v[64:67]
 T v[200:201],v225,4096
 T v[202:203],v225,5120
 s_waitcnt vmcnt(29)
 M v[68:71],v[208:211],a[112:115],v[68:71]
 s_waitcnt vmcnt(28)
 M v[72:75],v[208:211],a[176:179],v[72:75]
 s_waitcnt vmcnt(27)
 M v[76:79],v[208:211],a[240:243],v[76:79]
 W 6
 M v[80:83],v[212:215],a[48:51],v[80:83]
 T v[204:205],v226,4096
 T v[206:207],v226,5120
 M v[84:87],v[212:215],a[112:115],v[84:87]
 v_cvt_pk_bf16_f32 v248,v36,v37
 M v[88:91],v[212:215],a[176:179],v[88:91]
 v_cvt_pk_bf16_f32 v250,v52,v53
 v_cvt_pk_bf16_f32 v249,v38,v39
 M v[92:95],v[212:215],a[240:243],v[92:95]
 W 6
 v_cvt_pk_bf16_f32 v251,v54,v55
 s_add_u32 s90,s76,561152
 M v[96:99],v[192:195],a[48:51],v[96:99]
 T v[208:209],v227,4096
 T v[210:211],v227,5120
 M v[100:103],v[192:195],a[112:115],v[100:103]
 v_permlane16_swap_b32 v248,v250
 M v[104:107],v[192:195],a[176:179],v[104:107]
 v_permlane16_swap_b32 v249,v251
 M v[108:111],v[192:195],a[240:243],v[108:111]
 W 6
 buffer_store_dwordx4 v[248:251],v224,s[8:11],s90 offen offset:3072 sc0 sc1
 M v[112:115],v[196:199],a[48:51],v[112:115]
 T v[212:213],v228,4096
 T v[214:215],v228,5120
 M v[116:119],v[196:199],a[112:115],v[116:119]
 M v[120:123],v[196:199],a[176:179],v[120:123]
 M v[124:127],v[196:199],a[240:243],v[124:127]
 W 6
 s_waitcnt vmcnt(27)
 M v[64:67],v[200:203],a[52:55],v[64:67]
 T v[192:193],v225,8192
 T v[194:195],v225,9216
 s_waitcnt vmcnt(26)
 M v[68:71],v[200:203],a[116:119],v[68:71]
 v_cvt_pk_bf16_f32 v244,v8,v9
 s_waitcnt vmcnt(25)
 M v[72:75],v[200:203],a[180:183],v[72:75]
 v_cvt_pk_bf16_f32 v246,v24,v25
 v_cvt_pk_bf16_f32 v245,v10,v11
 s_waitcnt vmcnt(24)
 M v[76:79],v[200:203],a[244:247],v[76:79]
 W 6
 v_cvt_pk_bf16_f32 v247,v26,v27
 s_add_u32 s90,s76,565248
 M v[80:83],v[204:207],a[52:55],v[80:83]
 T v[196:197],v226,8192
 T v[198:199],v226,9216
 M v[84:87],v[204:207],a[116:119],v[84:87]
 v_permlane16_swap_b32 v244,v246
 M v[88:91],v[204:207],a[180:183],v[88:91]
 v_permlane16_swap_b32 v245,v247
 M v[92:95],v[204:207],a[244:247],v[92:95]
 W 6
 buffer_store_dwordx4 v[244:247],v224,s[8:11],s90 offen offset:2048 sc0 sc1
 M v[96:99],v[208:211],a[52:55],v[96:99]
 T v[200:201],v227,8192
 T v[202:203],v227,9216
 M v[100:103],v[208:211],a[116:119],v[100:103]
 M v[104:107],v[208:211],a[180:183],v[104:107]
 M v[108:111],v[208:211],a[244:247],v[108:111]
 W 6
 M v[112:115],v[212:215],a[52:55],v[112:115]
 T v[204:205],v228,8192
 T v[206:207],v228,9216
 M v[116:119],v[212:215],a[116:119],v[116:119]
 v_cvt_pk_bf16_f32 v248,v12,v13
 M v[120:123],v[212:215],a[180:183],v[120:123]
 v_cvt_pk_bf16_f32 v250,v28,v29
 v_cvt_pk_bf16_f32 v249,v14,v15
 M v[124:127],v[212:215],a[244:247],v[124:127]
 W 6
 v_cvt_pk_bf16_f32 v251,v30,v31
 s_add_u32 s90,s76,569344
 s_waitcnt vmcnt(23)
 M v[64:67],v[192:195],a[56:59],v[64:67]
 T v[208:209],v225,12288
 T v[210:211],v225,13312
 s_waitcnt vmcnt(22)
 M v[68:71],v[192:195],a[120:123],v[68:71]
 v_permlane16_swap_b32 v248,v250
 s_waitcnt vmcnt(21)
 M v[72:75],v[192:195],a[184:187],v[72:75]
 v_permlane16_swap_b32 v249,v251
 s_waitcnt vmcnt(19)
 M v[76:79],v[192:195],a[248:251],v[76:79]
 W 6
 buffer_store_dwordx4 v[248:251],v224,s[8:11],s90 offen offset:2048 sc0 sc1
 M v[80:83],v[196:199],a[56:59],v[80:83]
 T v[212:213],v226,12288
 T v[214:215],v226,13312
 M v[84:87],v[196:199],a[120:123],v[84:87]
 M v[88:91],v[196:199],a[184:187],v[88:91]
 M v[92:95],v[196:199],a[248:251],v[92:95]
 W 6
 M v[96:99],v[200:203],a[56:59],v[96:99]
 T v[192:193],v227,12288
 T v[194:195],v227,13312
 M v[100:103],v[200:203],a[120:123],v[100:103]
 M v[104:107],v[200:203],a[184:187],v[104:107]
 M v[108:111],v[200:203],a[248:251],v[108:111]
 W 6
 M v[112:115],v[204:207],a[56:59],v[112:115]
 T v[196:197],v228,12288
 T v[198:199],v228,13312
 M v[116:119],v[204:207],a[120:123],v[116:119]
 v_add_u32 v229,0xfffec000,v229
 v_add_u32 v230,0xfffec000,v230
 M v[120:123],v[204:207],a[184:187],v[120:123]
 v_add_u32 v231,0xfffec000,v231
 v_add_u32 v232,0xfffec000,v232
 M v[124:127],v[204:207],a[248:251],v[124:127]
 W 6
 s_barrier
 s_waitcnt vmcnt(10)
 M v[64:67],v[208:211],a[60:63],v[64:67]
 T v[200:201],v229,0
 T v[202:203],v229,1024
 s_waitcnt vmcnt(9)
 M v[68:71],v[208:211],a[124:127],v[68:71]
 s_add_u32 m0,s71,131072
 s_add_u32 s68,s81,2097280
 buffer_load_dwordx4 v233,s[24:27],s68 offen offset:0 lds
 s_waitcnt vmcnt(9)
 M v[72:75],v[208:211],a[188:191],v[72:75]
 s_waitcnt vmcnt(7)
 M v[76:79],v[208:211],a[252:255],v[76:79]
 W 6
 M v[80:83],v[212:215],a[60:63],v[80:83]
 T v[204:205],v230,0
 T v[206:207],v230,1024
 M v[84:87],v[212:215],a[124:127],v[84:87]
 buffer_load_dwordx4 v234,s[24:27],s68 offen offset:1024 lds
 M v[88:91],v[212:215],a[188:191],v[88:91]
 M v[92:95],v[212:215],a[252:255],v[92:95]
 W 6
 M v[96:99],v[192:195],a[60:63],v[96:99]
 T v[208:209],v231,0
 T v[210:211],v231,1024
 M v[100:103],v[192:195],a[124:127],v[100:103]
 buffer_load_dwordx4 v235,s[24:27],s68 offen offset:2048 lds
 M v[104:107],v[192:195],a[188:191],v[104:107]
 M v[108:111],v[192:195],a[252:255],v[108:111]
 W 6
 M v[112:115],v[196:199],a[60:63],v[112:115]
 T v[212:213],v232,0
 T v[214:215],v232,1024
 M v[116:119],v[196:199],a[124:127],v[116:119]
 buffer_load_dwordx4 v236,s[24:27],s68 offen offset:3072 lds
 M v[120:123],v[196:199],a[188:191],v[120:123]
 M v[124:127],v[196:199],a[252:255],v[124:127]
 W 6
 M v[0:3],v[200:203],a[0:3],0
 T v[192:193],v229,4096
 T v[194:195],v229,5120
 M v[4:7],v[200:203],a[64:67],0
 M v[8:11],v[200:203],a[128:131],0
 M v[12:15],v[200:203],a[192:195],0
 W 6
 M v[16:19],v[204:207],a[0:3],0
 T v[196:197],v230,4096
 T v[198:199],v230,5120
 M v[20:23],v[204:207],a[64:67],0
 M v[24:27],v[204:207],a[128:131],0
 M v[28:31],v[204:207],a[192:195],0
 W 6
 M v[32:35],v[208:211],a[0:3],0
 T v[200:201],v231,4096
 T v[202:203],v231,5120
 M v[36:39],v[208:211],a[64:67],0
 v_mul_f32 v237,v64,v64
 v_mul_f32 v238,v65,v65
 M v[40:43],v[208:211],a[128:131],0
 v_mul_f32 v239,v66,v66
 v_mul_f32 v240,v67,v67
 M v[44:47],v[208:211],a[192:195],0
 W 6
 v_fma_f32 v237,v237,v242,s88
 v_fma_f32 v238,v238,v242,s88
 M v[48:51],v[212:215],a[0:3],0
 T v[204:205],v232,4096
 T v[206:207],v232,5120
 M v[52:55],v[212:215],a[64:67],0
 v_fma_f32 v239,v239,v242,s88
 v_fma_f32 v240,v240,v242,s88
 M v[56:59],v[212:215],a[128:131],0
 v_mul_f32 v237,v237,v64
 v_mul_f32 v238,v238,v65
 M v[60:63],v[212:215],a[192:195],0
 W 6
 v_mul_f32 v239,v239,v66
 v_mul_f32 v240,v240,v67
 M v[0:3],v[192:195],a[4:7],v[0:3]
 T v[208:209],v229,8192
 T v[210:211],v229,9216
 M v[4:7],v[192:195],a[68:71],v[4:7]
 v_exp_f32 v237,v237
 M v[8:11],v[192:195],a[132:135],v[8:11]
 v_exp_f32 v238,v238
 M v[12:15],v[192:195],a[196:199],v[12:15]
 W 6
 v_exp_f32 v239,v239
 M v[16:19],v[196:199],a[4:7],v[16:19]
 T v[212:213],v230,8192
 T v[214:215],v230,9216
 M v[20:23],v[196:199],a[68:71],v[20:23]
 v_exp_f32 v240,v240
 M v[24:27],v[196:199],a[132:135],v[24:27]
 v_add_f32 v237,1.0,v237
 v_add_f32 v238,1.0,v238
 M v[28:31],v[196:199],a[196:199],v[28:31]
 W 6
 v_add_f32 v239,1.0,v239
 v_add_f32 v240,1.0,v240
 M v[32:35],v[200:203],a[4:7],v[32:35]
 T v[192:193],v231,8192
 T v[194:195],v231,9216
 M v[36:39],v[200:203],a[68:71],v[36:39]
 v_rcp_f32 v237,v237
 M v[40:43],v[200:203],a[132:135],v[40:43]
 v_rcp_f32 v238,v238
 M v[44:47],v[200:203],a[196:199],v[44:47]
 W 6
 v_rcp_f32 v239,v239
 M v[48:51],v[204:207],a[4:7],v[48:51]
 T v[196:197],v232,8192
 T v[198:199],v232,9216
 M v[52:55],v[204:207],a[68:71],v[52:55]
 v_rcp_f32 v240,v240
 M v[56:59],v[204:207],a[132:135],v[56:59]
 v_mul_f32 v237,v237,v64
 v_mul_f32 v238,v238,v65
 M v[60:63],v[204:207],a[196:199],v[60:63]
 W 6
 v_mul_f32 v239,v239,v66
 v_mul_f32 v240,v240,v67
 M v[0:3],v[208:211],a[8:11],v[0:3]
 T v[200:201],v229,12288
 T v[202:203],v229,13312
 M v[4:7],v[208:211],a[72:75],v[4:7]
 v_cvt_pk_bf16_f32 v244,v237,v238
 v_cvt_pk_bf16_f32 v245,v239,v240
 M v[8:11],v[208:211],a[136:139],v[8:11]
 v_mul_f32 v237,v80,v80
 v_mul_f32 v238,v81,v81
 M v[12:15],v[208:211],a[200:203],v[12:15]
 W 6
 v_mul_f32 v239,v82,v82
 v_mul_f32 v240,v83,v83
 M v[16:19],v[212:215],a[8:11],v[16:19]
 T v[204:205],v230,12288
 T v[206:207],v230,13312
 M v[20:23],v[212:215],a[72:75],v[20:23]
 v_fma_f32 v237,v237,v242,s88
 v_fma_f32 v238,v238,v242,s88
 M v[24:27],v[212:215],a[136:139],v[24:27]
 v_fma_f32 v239,v239,v242,s88
 v_fma_f32 v240,v240,v242,s88
 M v[28:31],v[212:215],a[200:203],v[28:31]
 W 6
 v_mul_f32 v237,v237,v80
 v_mul_f32 v238,v238,v81
 M v[32:35],v[192:195],a[8:11],v[32:35]
 T v[208:209],v231,12288
 T v[210:211],v231,13312
 M v[36:39],v[192:195],a[72:75],v[36:39]
 v_mul_f32 v239,v239,v82
 v_mul_f32 v240,v240,v83
 M v[40:43],v[192:195],a[136:139],v[40:43]
 v_exp_f32 v237,v237
 M v[44:47],v[192:195],a[200:203],v[44:47]
 W 6
 v_exp_f32 v238,v238
 M v[48:51],v[196:199],a[8:11],v[48:51]
 T v[212:213],v232,12288
 T v[214:215],v232,13312
 M v[52:55],v[196:199],a[72:75],v[52:55]
 v_add_u32 v229,0x4000,v229
 v_add_u32 v230,0x4000,v230
 M v[56:59],v[196:199],a[136:139],v[56:59]
 v_add_u32 v231,0x4000,v231
 v_add_u32 v232,0x4000,v232
 M v[60:63],v[196:199],a[200:203],v[60:63]
 W 6
 v_exp_f32 v239,v239
 M v[0:3],v[200:203],a[12:15],v[0:3]
 T v[192:193],v229,0
 T v[194:195],v229,1024
 M v[4:7],v[200:203],a[76:79],v[4:7]
 v_exp_f32 v240,v240
 M v[8:11],v[200:203],a[140:143],v[8:11]
 v_add_f32 v237,1.0,v237
 v_add_f32 v238,1.0,v238
 M v[12:15],v[200:203],a[204:207],v[12:15]
 W 6
 v_add_f32 v239,1.0,v239
 v_add_f32 v240,1.0,v240
 M v[16:19],v[204:207],a[12:15],v[16:19]
 T v[196:197],v230,0
 T v[198:199],v230,1024
 M v[20:23],v[204:207],a[76:79],v[20:23]
 v_rcp_f32 v237,v237
 M v[24:27],v[204:207],a[140:143],v[24:27]
 v_rcp_f32 v238,v238
 M v[28:31],v[204:207],a[204:207],v[28:31]
 W 6
 v_rcp_f32 v239,v239
 M v[32:35],v[208:211],a[12:15],v[32:35]
 T v[200:201],v231,0
 T v[202:203],v231,1024
 M v[36:39],v[208:211],a[76:79],v[36:39]
 v_rcp_f32 v240,v240
 M v[40:43],v[208:211],a[140:143],v[40:43]
 v_mul_f32 v237,v237,v80
 v_mul_f32 v238,v238,v81
 M v[44:47],v[208:211],a[204:207],v[44:47]
 W 6
 v_mul_f32 v239,v239,v82
 v_mul_f32 v240,v240,v83
 M v[48:51],v[212:215],a[12:15],v[48:51]
 T v[204:205],v232,0
 T v[206:207],v232,1024
 M v[52:55],v[212:215],a[76:79],v[52:55]
 v_cvt_pk_bf16_f32 v246,v237,v238
 v_cvt_pk_bf16_f32 v247,v239,v240
 M v[56:59],v[212:215],a[140:143],v[56:59]
 s_add_u32 s90,s86,0
 buffer_store_dwordx4 v[244:247],v224,s[8:11],s90 offen offset:0 sc0 sc1
 M v[60:63],v[212:215],a[204:207],v[60:63]
 W 6
 v_mul_f32 v237,v96,v96
 v_mul_f32 v238,v97,v97
F_J:
 M v[0:3],v[192:195],a[16:19],v[0:3]
 T v[208:209],v229,4096
 T v[210:211],v229,5120
 M v[4:7],v[192:195],a[80:83],v[4:7]
 v_mul_f32 v239,v98,v98
 v_mul_f32 v240,v99,v99
 M v[8:11],v[192:195],a[144:147],v[8:11]
 v_fma_f32 v237,v237,v242,s88
 v_fma_f32 v238,v238,v242,s88
 M v[12:15],v[192:195],a[208:211],v[12:15]
 W 6
 v_fma_f32 v239,v239,v242,s88
 v_fma_f32 v240,v240,v242,s88
 M v[16:19],v[196:199],a[16:19],v[16:19]
 T v[212:213],v230,4096
 T v[214:215],v230,5120
 M v[20:23],v[196:199],a[80:83],v[20:23]
 v_mul_f32 v237,v237,v96
 v_mul_f32 v238,v238,v97
 M v[24:27],v[196:199],a[144:147],v[24:27]
 v_mul_f32 v239,v239,v98
 v_mul_f32 v240,v240,v99
 M v[28:31],v[196:199],a[208:211],v[28:31]
 W 6
 v_exp_f32 v237,v237
 M v[32:35],v[200:203],a[16:19],v[32:35]
 T v[192:193],v231,4096
 T v[194:195],v231,5120
 M v[36:39],v[200:203],a[80:83],v[36:39]
 v_exp_f32 v238,v238
 M v[40:43],v[200:203],a[144:147],v[40:43]
 v_exp_f32 v239,v239
 M v[44:47],v[200:203],a[208:211],v[44:47]
 W 6
 v_exp_f32 v240,v240
 M v[48:51],v[204:207],a[16:19],v[48:51]
 T v[196:197],v232,4096
 T v[198:199],v232,5120
 M v[52:55],v[204:207],a[80:83],v[52:55]
 v_add_f32 v237,1.0,v237
 v_add_f32 v238,1.0,v238
 M v[56:59],v[204:207],a[144:147],v[56:59]
 v_add_f32 v239,1.0,v239
 v_add_f32 v240,1.0,v240
 M v[60:63],v[204:207],a[208:211],v[60:63]
 W 6
 v_rcp_f32 v237,v237
 M v[0:3],v[208:211],a[20:23],v[0:3]
 T v[200:201],v229,8192
 T v[202:203],v229,9216
 M v[4:7],v[208:211],a[84:87],v[4:7]
 v_rcp_f32 v238,v238
 M v[8:11],v[208:211],a[148:151],v[8:11]
 v_rcp_f32 v239,v239
 M v[12:15],v[208:211],a[212:215],v[12:15]
 W 6
 v_rcp_f32 v240,v240
 M v[16:19],v[212:215],a[20:23],v[16:19]
 T v[204:205],v230,8192
 T v[206:207],v230,9216
 M v[20:23],v[212:215],a[84:87],v[20:23]
 v_mul_f32 v237,v237,v96
 v_mul_f32 v238,v238,v97
 M v[24:27],v[212:215],a[148:151],v[24:27]
 v_mul_f32 v239,v239,v98
 v_mul_f32 v240,v240,v99
 M v[28:31],v[212:215],a[212:215],v[28:31]
 W 6
 v_cvt_pk_bf16_f32 v248,v237,v238
 v_cvt_pk_bf16_f32 v249,v239,v240
 M v[32:35],v[192:195],a[20:23],v[32:35]
 T v[208:209],v231,8192
 T v[210:211],v231,9216
 M v[36:39],v[192:195],a[84:87],v[36:39]
 v_mul_f32 v237,v112,v112
 v_mul_f32 v238,v113,v113
 M v[40:43],v[192:195],a[148:151],v[40:43]
 v_mul_f32 v239,v114,v114
 v_mul_f32 v240,v115,v115
 M v[44:47],v[192:195],a[212:215],v[44:47]
 W 6
 v_fma_f32 v237,v237,v242,s88
 v_fma_f32 v238,v238,v242,s88
 M v[48:51],v[196:199],a[20:23],v[48:51]
 T v[212:213],v232,8192
 T v[214:215],v232,9216
 M v[52:55],v[196:199],a[84:87],v[52:55]
 v_fma_f32 v239,v239,v242,s88
 v_fma_f32 v240,v240,v242,s88
 M v[56:59],v[196:199],a[148:151],v[56:59]
 v_mul_f32 v237,v237,v112
 v_mul_f32 v238,v238,v113
 M v[60:63],v[196:199],a[212:215],v[60:63]
 W 6
 v_mul_f32 v239,v239,v114
 v_mul_f32 v240,v240,v115
 M v[0:3],v[200:203],a[24:27],v[0:3]
 T v[192:193],v229,12288
 T v[194:195],v229,13312
 M v[4:7],v[200:203],a[88:91],v[4:7]
 v_exp_f32 v237,v237
 M v[8:11],v[200:203],a[152:155],v[8:11]
 v_exp_f32 v238,v238
 M v[12:15],v[200:203],a[216:219],v[12:15]
 W 6
 v_exp_f32 v239,v239
 M v[16:19],v[204:207],a[24:27],v[16:19]
 T v[196:197],v230,12288
 T v[198:199],v230,13312
 M v[20:23],v[204:207],a[88:91],v[20:23]
 v_exp_f32 v240,v240
 M v[24:27],v[204:207],a[152:155],v[24:27]
 v_add_f32 v237,1.0,v237
 v_add_f32 v238,1.0,v238
 M v[28:31],v[204:207],a[216:219],v[28:31]
 W 6
 v_add_f32 v239,1.0,v239
 v_add_f32 v240,1.0,v240
 M v[32:35],v[208:211],a[24:27],v[32:35]
 T v[200:201],v231,12288
 T v[202:203],v231,13312
 M v[36:39],v[208:211],a[88:91],v[36:39]
 v_rcp_f32 v237,v237
 M v[40:43],v[208:211],a[152:155],v[40:43]
 v_rcp_f32 v238,v238
 M v[44:47],v[208:211],a[216:219],v[44:47]
 W 6
 v_rcp_f32 v239,v239
 M v[48:51],v[212:215],a[24:27],v[48:51]
 T v[204:205],v232,12288
 T v[206:207],v232,13312
 M v[52:55],v[212:215],a[88:91],v[52:55]
 v_add_u32 v229,0x4000,v229
 v_add_u32 v230,0x4000,v230
 M v[56:59],v[212:215],a[152:155],v[56:59]
 v_add_u32 v231,0x4000,v231
 v_add_u32 v232,0x4000,v232
 M v[60:63],v[212:215],a[216:219],v[60:63]
 W 6
 s_waitcnt vmcnt(5)
 s_barrier
 M v[0:3],v[192:195],a[28:31],v[0:3]
 T v[208:209],v229,0
 T v[210:211],v229,1024
 M v[4:7],v[192:195],a[92:95],v[4:7]
 v_mov_b32 v218,s62
 v_add_u32 v218,1,v218
 buffer_store_dword v218,v216,s[8:11],s1 offen sc0 sc1
 s_add_u32 m0,s71,49152
 s_add_u32 s68,s81,3145856
 buffer_load_dwordx4 v233,s[24:27],s68 offen offset:0 lds
 M v[8:11],v[192:195],a[156:159],v[8:11]
 v_rcp_f32 v240,v240
 M v[12:15],v[192:195],a[220:223],v[12:15]
 W 6
 v_mul_f32 v237,v237,v112
 v_mul_f32 v238,v238,v113
 M v[16:19],v[196:199],a[28:31],v[16:19]
 T v[212:213],v230,0
 T v[214:215],v230,1024
 M v[20:23],v[196:199],a[92:95],v[20:23]
 buffer_load_dwordx4 v234,s[24:27],s68 offen offset:1024 lds
 v_mul_f32 v239,v239,v114
 M v[24:27],v[196:199],a[156:159],v[24:27]
 v_mul_f32 v240,v240,v115
 v_cvt_pk_bf16_f32 v250,v237,v238
 M v[28:31],v[196:199],a[220:223],v[28:31]
 W 6
 v_cvt_pk_bf16_f32 v251,v239,v240
 s_add_u32 s90,s86,0
 M v[32:35],v[200:203],a[28:31],v[32:35]
 T v[192:193],v231,0
 T v[194:195],v231,1024
 M v[36:39],v[200:203],a[92:95],v[36:39]
 buffer_load_dwordx4 v235,s[24:27],s68 offen offset:2048 lds
 buffer_store_dwordx4 v[248:251],v224,s[8:11],s90 offen offset:1024 sc0 sc1
 M v[40:43],v[200:203],a[156:159],v[40:43]
 v_mul_f32 v237,v68,v68
 v_mul_f32 v238,v69,v69
 M v[44:47],v[200:203],a[220:223],v[44:47]
 W 6
 v_mul_f32 v239,v70,v70
 v_mul_f32 v240,v71,v71
 M v[48:51],v[204:207],a[28:31],v[48:51]
 T v[196:197],v232,0
 T v[198:199],v232,1024
 M v[52:55],v[204:207],a[92:95],v[52:55]
 buffer_load_dwordx4 v236,s[24:27],s68 offen offset:3072 lds
 v_fma_f32 v237,v237,v242,s88
 M v[56:59],v[204:207],a[156:159],v[56:59]
 v_fma_f32 v238,v238,v242,s88
 v_fma_f32 v239,v239,v242,s88
 M v[60:63],v[204:207],a[220:223],v[60:63]
 W 6
 v_fma_f32 v240,v240,v242,s88
 v_mul_f32 v237,v237,v68
 M v[0:3],v[208:211],a[32:35],v[0:3]
 T v[200:201],v229,4096
 T v[202:203],v229,5120
 M v[4:7],v[208:211],a[96:99],v[4:7]
 v_lshlrev_b32 v252,3,v224
 v_lshl_add_u32 v252,s64,13,v252
 v_mul_f32 v238,v238,v69
 M v[8:11],v[208:211],a[160:163],v[8:11]
 v_add_u32 v252,F_AAe-F_pc+0,v252
 v_min_u32 v252,F_Bend-F_pc,v252
 v_mul_f32 v239,v239,v70
 M v[12:15],v[208:211],a[224:227],v[12:15]
 W 6
 v_mul_f32 v240,v240,v71
 M v[16:19],v[212:215],a[32:35],v[16:19]
 T v[204:205],v230,4096
 T v[206:207],v230,5120
 M v[20:23],v[212:215],a[96:99],v[20:23]
 global_load_dword v221,v252,s[6:7]
 M v[24:27],v[212:215],a[160:163],v[24:27]
 v_exp_f32 v237,v237
 M v[28:31],v[212:215],a[224:227],v[28:31]
 W 6
 v_exp_f32 v238,v238
 M v[32:35],v[192:195],a[32:35],v[32:35]
 T v[208:209],v231,4096
 T v[210:211],v231,5120
 M v[36:39],v[192:195],a[96:99],v[36:39]
 v_exp_f32 v239,v239
 M v[40:43],v[192:195],a[160:163],v[40:43]
 v_exp_f32 v240,v240
 M v[44:47],v[192:195],a[224:227],v[44:47]
 W 6
 v_add_f32 v237,1.0,v237
 v_add_f32 v238,1.0,v238
 M v[48:51],v[196:199],a[32:35],v[48:51]
 T v[212:213],v232,4096
 T v[214:215],v232,5120
 M v[52:55],v[196:199],a[96:99],v[52:55]
 v_add_f32 v239,1.0,v239
 v_add_f32 v240,1.0,v240
 M v[56:59],v[196:199],a[160:163],v[56:59]
 v_rcp_f32 v237,v237
 M v[60:63],v[196:199],a[224:227],v[60:63]
 W 6
 v_rcp_f32 v238,v238
 M v[0:3],v[200:203],a[36:39],v[0:3]
 T v[192:193],v229,8192
 T v[194:195],v229,9216
 M v[4:7],v[200:203],a[100:103],v[4:7]
 v_rcp_f32 v239,v239
 M v[8:11],v[200:203],a[164:167],v[8:11]
 v_rcp_f32 v240,v240
 M v[12:15],v[200:203],a[228:231],v[12:15]
 W 6
 v_mul_f32 v237,v237,v68
 v_mul_f32 v238,v238,v69
 M v[16:19],v[204:207],a[36:39],v[16:19]
 T v[196:197],v230,8192
 T v[198:199],v230,9216
 M v[20:23],v[204:207],a[100:103],v[20:23]
 v_mul_f32 v239,v239,v70
 v_mul_f32 v240,v240,v71
 M v[24:27],v[204:207],a[164:167],v[24:27]
 v_cvt_pk_bf16_f32 v244,v237,v238
 v_cvt_pk_bf16_f32 v245,v239,v240
 M v[28:31],v[204:207],a[228:231],v[28:31]
 W 6
 v_mul_f32 v237,v84,v84
 v_mul_f32 v238,v85,v85
 M v[32:35],v[208:211],a[36:39],v[32:35]
 T v[200:201],v231,8192
 T v[202:203],v231,9216
 M v[36:39],v[208:211],a[100:103],v[36:39]
 v_mul_f32 v239,v86,v86
 v_mul_f32 v240,v87,v87
 M v[40:43],v[208:211],a[164:167],v[40:43]
 v_fma_f32 v237,v237,v242,s88
 v_fma_f32 v238,v238,v242,s88
 M v[44:47],v[208:211],a[228:231],v[44:47]
 W 6
 v_fma_f32 v239,v239,v242,s88
 v_fma_f32 v240,v240,v242,s88
 M v[48:51],v[212:215],a[36:39],v[48:51]
 T v[204:205],v232,8192
 T v[206:207],v232,9216
 M v[52:55],v[212:215],a[100:103],v[52:55]
 v_mul_f32 v237,v237,v84
 v_mul_f32 v238,v238,v85
 M v[56:59],v[212:215],a[164:167],v[56:59]
 v_mul_f32 v239,v239,v86
 v_mul_f32 v240,v240,v87
 M v[60:63],v[212:215],a[228:231],v[60:63]
 W 6
 v_exp_f32 v237,v237
 M v[0:3],v[192:195],a[40:43],v[0:3]
 T v[208:209],v229,12288
 T v[210:211],v229,13312
 M v[4:7],v[192:195],a[104:107],v[4:7]
 v_exp_f32 v238,v238
 M v[8:11],v[192:195],a[168:171],v[8:11]
 v_exp_f32 v239,v239
 M v[12:15],v[192:195],a[232:235],v[12:15]
 W 6
 v_exp_f32 v240,v240
 M v[16:19],v[196:199],a[40:43],v[16:19]
 T v[212:213],v230,12288
 T v[214:215],v230,13312
 M v[20:23],v[196:199],a[104:107],v[20:23]
 v_add_f32 v237,1.0,v237
 v_add_f32 v238,1.0,v238
 M v[24:27],v[196:199],a[168:171],v[24:27]
 v_add_f32 v239,1.0,v239
 v_add_f32 v240,1.0,v240
 M v[28:31],v[196:199],a[232:235],v[28:31]
 W 6
 v_rcp_f32 v237,v237
 M v[32:35],v[200:203],a[40:43],v[32:35]
 T v[192:193],v231,12288
 T v[194:195],v231,13312
 M v[36:39],v[200:203],a[104:107],v[36:39]
 v_rcp_f32 v238,v238
 M v[40:43],v[200:203],a[168:171],v[40:43]
 v_rcp_f32 v239,v239
 M v[44:47],v[200:203],a[232:235],v[44:47]
 W 6
 v_rcp_f32 v240,v240
 M v[48:51],v[204:207],a[40:43],v[48:51]
 T v[196:197],v232,12288
 T v[198:199],v232,13312
 M v[52:55],v[204:207],a[104:107],v[52:55]
 v_add_u32 v229,0x4000,v229
 v_add_u32 v230,0x4000,v230
 v_mul_f32 v237,v237,v84
 M v[56:59],v[204:207],a[168:171],v[56:59]
 v_add_u32 v231,0x4000,v231
 v_add_u32 v232,0x4000,v232
 v_mul_f32 v238,v238,v85
 M v[60:63],v[204:207],a[232:235],v[60:63]
 W 6
 v_mul_f32 v239,v239,v86
 v_mul_f32 v240,v240,v87
 M v[0:3],v[208:211],a[44:47],v[0:3]
 T v[200:201],v229,0
 T v[202:203],v229,1024
 M v[4:7],v[208:211],a[108:111],v[4:7]
 v_cvt_pk_bf16_f32 v246,v237,v238
 v_cvt_pk_bf16_f32 v247,v239,v240
 M v[8:11],v[208:211],a[172:175],v[8:11]
 s_add_u32 s90,s86,57344
 buffer_store_dwordx4 v[244:247],v224,s[8:11],s90 offen offset:0 sc0 sc1
 M v[12:15],v[208:211],a[236:239],v[12:15]
 W 6
 v_mul_f32 v237,v100,v100
 v_mul_f32 v238,v101,v101
 M v[16:19],v[212:215],a[44:47],v[16:19]
 T v[204:205],v230,0
 T v[206:207],v230,1024
 M v[20:23],v[212:215],a[108:111],v[20:23]
 v_mul_f32 v239,v102,v102
 v_mul_f32 v240,v103,v103
 M v[24:27],v[212:215],a[172:175],v[24:27]
 v_fma_f32 v237,v237,v242,s88
 v_fma_f32 v238,v238,v242,s88
 M v[28:31],v[212:215],a[236:239],v[28:31]
 W 6
 v_fma_f32 v239,v239,v242,s88
 v_fma_f32 v240,v240,v242,s88
 M v[32:35],v[192:195],a[44:47],v[32:35]
 T v[208:209],v231,0
 T v[210:211],v231,1024
 M v[36:39],v[192:195],a[108:111],v[36:39]
 v_mul_f32 v237,v237,v100
 v_mul_f32 v238,v238,v101
 M v[40:43],v[192:195],a[172:175],v[40:43]
 v_mul_f32 v239,v239,v102
 v_mul_f32 v240,v240,v103
 M v[44:47],v[192:195],a[236:239],v[44:47]
 W 6
 v_exp_f32 v237,v237
 M v[48:51],v[196:199],a[44:47],v[48:51]
 T v[212:213],v232,0
 T v[214:215],v232,1024
 M v[52:55],v[196:199],a[108:111],v[52:55]
 v_exp_f32 v238,v238
 M v[56:59],v[196:199],a[172:175],v[56:59]
 v_exp_f32 v239,v239
 M v[60:63],v[196:199],a[236:239],v[60:63]
 W 6
 v_exp_f32 v240,v240
 M v[0:3],v[200:203],a[48:51],v[0:3]
 T v[192:193],v229,4096
 T v[194:195],v229,5120
 M v[4:7],v[200:203],a[112:115],v[4:7]
 v_lshlrev_b32 v253,3,v224
 v_lshl_add_u32 v253,s64,13,v253
 v_add_f32 v237,1.0,v237
 M v[8:11],v[200:203],a[176:179],v[8:11]
 v_add_u32 v253,F_AAe-F_pc+32768,v253
 v_min_u32 v253,F_Bend-F_pc,v253
 v_add_f32 v238,1.0,v238
 M v[12:15],v[200:203],a[240:243],v[12:15]
 W 6
 v_add_f32 v239,1.0,v239
 v_add_f32 v240,1.0,v240
 M v[16:19],v[204:207],a[48:51],v[16:19]
 T v[196:197],v230,4096
 T v[198:199],v230,5120
 M v[20:23],v[204:207],a[112:115],v[20:23]
 global_load_dword v221,v253,s[6:7]
 M v[24:27],v[204:207],a[176:179],v[24:27]
 v_rcp_f32 v237,v237
 M v[28:31],v[204:207],a[240:243],v[28:31]
 W 6
 v_rcp_f32 v238,v238
 M v[32:35],v[208:211],a[48:51],v[32:35]
 T v[200:201],v231,4096
 T v[202:203],v231,5120
 M v[36:39],v[208:211],a[112:115],v[36:39]
 v_rcp_f32 v239,v239
 M v[40:43],v[208:211],a[176:179],v[40:43]
 v_rcp_f32 v240,v240
 M v[44:47],v[208:211],a[240:243],v[44:47]
 W 6
 v_mul_f32 v237,v237,v100
 v_mul_f32 v238,v238,v101
 M v[48:51],v[212:215],a[48:51],v[48:51]
 T v[204:205],v232,4096
 T v[206:207],v232,5120
 M v[52:55],v[212:215],a[112:115],v[52:55]
 v_mul_f32 v239,v239,v102
 v_mul_f32 v240,v240,v103
 M v[56:59],v[212:215],a[176:179],v[56:59]
 v_cvt_pk_bf16_f32 v248,v237,v238
 v_cvt_pk_bf16_f32 v249,v239,v240
 M v[60:63],v[212:215],a[240:243],v[60:63]
 W 6
 v_mul_f32 v237,v116,v116
 v_mul_f32 v238,v117,v117
 M v[0:3],v[192:195],a[52:55],v[0:3]
 T v[208:209],v229,8192
 T v[210:211],v229,9216
 M v[4:7],v[192:195],a[116:119],v[4:7]
 v_mul_f32 v239,v118,v118
 v_mul_f32 v240,v119,v119
 M v[8:11],v[192:195],a[180:183],v[8:11]
 v_fma_f32 v237,v237,v242,s88
 v_fma_f32 v238,v238,v242,s88
 M v[12:15],v[192:195],a[244:247],v[12:15]
 W 6
 v_fma_f32 v239,v239,v242,s88
 v_fma_f32 v240,v240,v242,s88
 M v[16:19],v[196:199],a[52:55],v[16:19]
 T v[212:213],v230,8192
 T v[214:215],v230,9216
 M v[20:23],v[196:199],a[116:119],v[20:23]
 v_mul_f32 v237,v237,v116
 v_mul_f32 v238,v238,v117
 M v[24:27],v[196:199],a[180:183],v[24:27]
 v_mul_f32 v239,v239,v118
 v_mul_f32 v240,v240,v119
 M v[28:31],v[196:199],a[244:247],v[28:31]
 W 6
 v_exp_f32 v237,v237
 M v[32:35],v[200:203],a[52:55],v[32:35]
 T v[192:193],v231,8192
 T v[194:195],v231,9216
 M v[36:39],v[200:203],a[116:119],v[36:39]
 v_exp_f32 v238,v238
 M v[40:43],v[200:203],a[180:183],v[40:43]
 v_exp_f32 v239,v239
 M v[44:47],v[200:203],a[244:247],v[44:47]
 W 6
 v_exp_f32 v240,v240
 M v[48:51],v[204:207],a[52:55],v[48:51]
 T v[196:197],v232,8192
 T v[198:199],v232,9216
 M v[52:55],v[204:207],a[116:119],v[52:55]
 v_add_f32 v237,1.0,v237
 v_add_f32 v238,1.0,v238
 M v[56:59],v[204:207],a[180:183],v[56:59]
 v_add_f32 v239,1.0,v239
 v_add_f32 v240,1.0,v240
 M v[60:63],v[204:207],a[244:247],v[60:63]
 W 6
 v_rcp_f32 v237,v237
 M v[0:3],v[208:211],a[56:59],v[0:3]
 T v[200:201],v229,12288
 T v[202:203],v229,13312
 M v[4:7],v[208:211],a[120:123],v[4:7]
 v_rcp_f32 v238,v238
 M v[8:11],v[208:211],a[184:187],v[8:11]
 v_rcp_f32 v239,v239
 M v[12:15],v[208:211],a[248:251],v[12:15]
 W 6
 v_rcp_f32 v240,v240
 M v[16:19],v[212:215],a[56:59],v[16:19]
 T v[204:205],v230,12288
 T v[206:207],v230,13312
 M v[20:23],v[212:215],a[120:123],v[20:23]
 v_mul_f32 v237,v237,v116
 v_mul_f32 v238,v238,v117
 M v[24:27],v[212:215],a[184:187],v[24:27]
 v_mul_f32 v239,v239,v118
 v_mul_f32 v240,v240,v119
 M v[28:31],v[212:215],a[248:251],v[28:31]
 W 6
 v_cvt_pk_bf16_f32 v250,v237,v238
 v_cvt_pk_bf16_f32 v251,v239,v240
 M v[32:35],v[192:195],a[56:59],v[32:35]
 T v[208:209],v231,12288
 T v[210:211],v231,13312
 M v[36:39],v[192:195],a[120:123],v[36:39]
 s_add_u32 s90,s86,57344
 buffer_store_dwordx4 v[248:251],v224,s[8:11],s90 offen offset:1024 sc0 sc1
 M v[40:43],v[192:195],a[184:187],v[40:43]
 v_mul_f32 v237,v72,v72
 v_mul_f32 v238,v73,v73
 M v[44:47],v[192:195],a[248:251],v[44:47]
 W 6
 v_mul_f32 v239,v74,v74
 v_mul_f32 v240,v75,v75
 M v[48:51],v[196:199],a[56:59],v[48:51]
 T v[212:213],v232,12288
 T v[214:215],v232,13312
 M v[52:55],v[196:199],a[120:123],v[52:55]
 v_add_u32 v225,0x1c000,v225
 v_add_u32 v226,0x1c000,v226
 v_fma_f32 v237,v237,v242,s88
 M v[56:59],v[196:199],a[184:187],v[56:59]
 v_add_u32 v227,0x1c000,v227
 v_add_u32 v228,0x1c000,v228
 v_fma_f32 v238,v238,v242,s88
 M v[60:63],v[196:199],a[248:251],v[60:63]
 W 6
 s_barrier
 v_fma_f32 v239,v239,v242,s88
 M v[0:3],v[200:203],a[60:63],v[0:3]
 T v[192:193],v225,0
 T v[194:195],v225,1024
 M v[4:7],v[200:203],a[124:127],v[4:7]
 v_fma_f32 v240,v240,v242,s88
 v_mul_f32 v237,v237,v72
 M v[8:11],v[200:203],a[188:191],v[8:11]
 v_mul_f32 v238,v238,v73
 v_mul_f32 v239,v239,v74
 M v[12:15],v[200:203],a[252:255],v[12:15]
 W 6
 v_mul_f32 v240,v240,v75
 M v[16:19],v[204:207],a[60:63],v[16:19]
 T v[196:197],v226,0
 T v[198:199],v226,1024
 M v[20:23],v[204:207],a[124:127],v[20:23]
 v_exp_f32 v237,v237
 M v[24:27],v[204:207],a[188:191],v[24:27]
 v_exp_f32 v238,v238
 M v[28:31],v[204:207],a[252:255],v[28:31]
 W 6
 v_exp_f32 v239,v239
 M v[32:35],v[208:211],a[60:63],v[32:35]
 T v[200:201],v227,0
 T v[202:203],v227,1024
 M v[36:39],v[208:211],a[124:127],v[36:39]
 v_exp_f32 v240,v240
 M v[40:43],v[208:211],a[188:191],v[40:43]
 v_add_f32 v237,1.0,v237
 v_add_f32 v238,1.0,v238
 M v[44:47],v[208:211],a[252:255],v[44:47]
 W 6
 v_add_f32 v239,1.0,v239
 v_add_f32 v240,1.0,v240
 M v[48:51],v[212:215],a[60:63],v[48:51]
 T v[204:205],v228,0
 T v[206:207],v228,1024
 M v[52:55],v[212:215],a[124:127],v[52:55]
 v_rcp_f32 v237,v237
 M v[56:59],v[212:215],a[188:191],v[56:59]
 v_rcp_f32 v238,v238
 M v[60:63],v[212:215],a[252:255],v[60:63]
 W 6
 v_rcp_f32 v239,v239
 M v[128:131],v[192:195],a[0:3],0
 T v[208:209],v225,4096
 T v[210:211],v225,5120
 M v[132:135],v[192:195],a[64:67],0
 v_lshlrev_b32 v252,3,v224
 v_lshl_add_u32 v252,s64,13,v252
 M v[136:139],v[192:195],a[128:131],0
 v_add_u32 v252,F_AAe-F_pc+65536,v252
 v_min_u32 v252,F_Bend-F_pc,v252
 M v[140:143],v[192:195],a[192:195],0
 W 6
 v_rcp_f32 v240,v240
 M v[144:147],v[196:199],a[0:3],0
 T v[212:213],v226,4096
 T v[214:215],v226,5120
 M v[148:151],v[196:199],a[64:67],0
 global_load_dword v221,v252,s[6:7]
 v_mul_f32 v237,v237,v72
 M v[152:155],v[196:199],a[128:131],0
 v_mul_f32 v238,v238,v73
 v_mul_f32 v239,v239,v74
 M v[156:159],v[196:199],a[192:195],0
 W 6
 v_mul_f32 v240,v240,v75
 v_cvt_pk_bf16_f32 v244,v237,v238
 M v[160:163],v[200:203],a[0:3],0
 T v[192:193],v227,4096
 T v[194:195],v227,5120
 M v[164:167],v[200:203],a[64:67],0
 v_cvt_pk_bf16_f32 v245,v239,v240
 v_mul_f32 v237,v88,v88
 M v[168:171],v[200:203],a[128:131],0
 v_mul_f32 v238,v89,v89
 v_mul_f32 v239,v90,v90
 M v[172:175],v[200:203],a[192:195],0
 W 6
 v_mul_f32 v240,v91,v91
 v_fma_f32 v237,v237,v242,s88
 M v[176:179],v[204:207],a[0:3],0
 T v[196:197],v228,4096
 T v[198:199],v228,5120
 M v[180:183],v[204:207],a[64:67],0
 v_fma_f32 v238,v238,v242,s88
 v_fma_f32 v239,v239,v242,s88
 M v[184:187],v[204:207],a[128:131],0
 v_fma_f32 v240,v240,v242,s88
 v_mul_f32 v237,v237,v88
 M v[188:191],v[204:207],a[192:195],0
 W 6
 v_mul_f32 v238,v238,v89
 v_mul_f32 v239,v239,v90
 M v[128:131],v[208:211],a[4:7],v[128:131]
 T v[200:201],v225,8192
 T v[202:203],v225,9216
 M v[132:135],v[208:211],a[68:71],v[132:135]
 v_mul_f32 v240,v240,v91
 M v[136:139],v[208:211],a[132:135],v[136:139]
 v_exp_f32 v237,v237
 M v[140:143],v[208:211],a[196:199],v[140:143]
 W 6
 v_exp_f32 v238,v238
 M v[144:147],v[212:215],a[4:7],v[144:147]
 T v[204:205],v226,8192
 T v[206:207],v226,9216
 M v[148:151],v[212:215],a[68:71],v[148:151]
 v_exp_f32 v239,v239
 M v[152:155],v[212:215],a[132:135],v[152:155]
 v_exp_f32 v240,v240
 M v[156:159],v[212:215],a[196:199],v[156:159]
 W 6
 v_add_f32 v237,1.0,v237
 v_add_f32 v238,1.0,v238
 M v[160:163],v[192:195],a[4:7],v[160:163]
 T v[208:209],v227,8192
 T v[210:211],v227,9216
 M v[164:167],v[192:195],a[68:71],v[164:167]
 v_add_f32 v239,1.0,v239
 v_add_f32 v240,1.0,v240
 M v[168:171],v[192:195],a[132:135],v[168:171]
 v_rcp_f32 v237,v237
 M v[172:175],v[192:195],a[196:199],v[172:175]
 W 6
 v_rcp_f32 v238,v238
 M v[176:179],v[196:199],a[4:7],v[176:179]
 T v[212:213],v228,8192
 T v[214:215],v228,9216
 M v[180:183],v[196:199],a[68:71],v[180:183]
 v_rcp_f32 v239,v239
 M v[184:187],v[196:199],a[132:135],v[184:187]
 v_rcp_f32 v240,v240
 M v[188:191],v[196:199],a[196:199],v[188:191]
 W 6
 v_mul_f32 v237,v237,v88
 v_mul_f32 v238,v238,v89
 M v[128:131],v[200:203],a[8:11],v[128:131]
 T v[192:193],v225,12288
 T v[194:195],v225,13312
 M v[132:135],v[200:203],a[72:75],v[132:135]
 v_mul_f32 v239,v239,v90
 v_mul_f32 v240,v240,v91
 M v[136:139],v[200:203],a[136:139],v[136:139]
 v_cvt_pk_bf16_f32 v246,v237,v238
 v_cvt_pk_bf16_f32 v247,v239,v240
 M v[140:143],v[200:203],a[200:203],v[140:143]
 W 6
 s_add_u32 s90,s87,0
 buffer_store_dwordx4 v[244:247],v224,s[8:11],s90 offen offset:0 sc0 sc1
 M v[144:147],v[204:207],a[8:11],v[144:147]
 T v[196:197],v226,12288
 T v[198:199],v226,13312
 M v[148:151],v[204:207],a[72:75],v[148:151]
 v_mul_f32 v237,v104,v104
 v_mul_f32 v238,v105,v105
 M v[152:155],v[204:207],a[136:139],v[152:155]
 v_mul_f32 v239,v106,v106
 v_mul_f32 v240,v107,v107
 M v[156:159],v[204:207],a[200:203],v[156:159]
 W 6
 v_fma_f32 v237,v237,v242,s88
 v_fma_f32 v238,v238,v242,s88
 M v[160:163],v[208:211],a[8:11],v[160:163]
 T v[200:201],v227,12288
 T v[202:203],v227,13312
 M v[164:167],v[208:211],a[72:75],v[164:167]
 v_fma_f32 v239,v239,v242,s88
 v_fma_f32 v240,v240,v242,s88
 M v[168:171],v[208:211],a[136:139],v[168:171]
 v_mul_f32 v237,v237,v104
 v_mul_f32 v238,v238,v105
 M v[172:175],v[208:211],a[200:203],v[172:175]
 W 6
 v_mul_f32 v239,v239,v106
 v_mul_f32 v240,v240,v107
 M v[176:179],v[212:215],a[8:11],v[176:179]
 T v[204:205],v228,12288
 T v[206:207],v228,13312
 M v[180:183],v[212:215],a[72:75],v[180:183]
 v_add_u32 v225,0xffff8000,v225
 v_add_u32 v226,0xffff8000,v226
 M v[184:187],v[212:215],a[136:139],v[184:187]
 v_add_u32 v227,0xffff8000,v227
 v_add_u32 v228,0xffff8000,v228
 M v[188:191],v[212:215],a[200:203],v[188:191]
 W 6
 v_exp_f32 v237,v237
 M v[128:131],v[192:195],a[12:15],v[128:131]
 T v[208:209],v225,0
 T v[210:211],v225,1024
 M v[132:135],v[192:195],a[76:79],v[132:135]
 v_exp_f32 v238,v238
 M v[136:139],v[192:195],a[140:143],v[136:139]
 v_exp_f32 v239,v239
 M v[140:143],v[192:195],a[204:207],v[140:143]
 W 6
 v_exp_f32 v240,v240
 M v[144:147],v[196:199],a[12:15],v[144:147]
 T v[212:213],v226,0
 T v[214:215],v226,1024
 M v[148:151],v[196:199],a[76:79],v[148:151]
 v_add_f32 v237,1.0,v237
 v_add_f32 v238,1.0,v238
 M v[152:155],v[196:199],a[140:143],v[152:155]
 v_add_f32 v239,1.0,v239
 v_add_f32 v240,1.0,v240
 M v[156:159],v[196:199],a[204:207],v[156:159]
 W 6
 v_rcp_f32 v237,v237
 M v[160:163],v[200:203],a[12:15],v[160:163]
 T v[192:193],v227,0
 T v[194:195],v227,1024
 M v[164:167],v[200:203],a[76:79],v[164:167]
 buffer_load_dword v217,v220,s[8:11],s0 offen sc1
 M v[168:171],v[200:203],a[140:143],v[168:171]
 v_rcp_f32 v238,v238
 M v[172:175],v[200:203],a[204:207],v[172:175]
 W 6
 v_rcp_f32 v239,v239
 M v[176:179],v[204:207],a[12:15],v[176:179]
 T v[196:197],v228,0
 T v[198:199],v228,1024
 M v[180:183],v[204:207],a[76:79],v[180:183]
 v_rcp_f32 v240,v240
 M v[184:187],v[204:207],a[140:143],v[184:187]
 v_mul_f32 v237,v237,v104
 v_mul_f32 v238,v238,v105
 M v[188:191],v[204:207],a[204:207],v[188:191]
 W 6
 v_mul_f32 v239,v239,v106
 v_mul_f32 v240,v240,v107
 M v[128:131],v[208:211],a[16:19],v[128:131]
 T v[200:201],v225,4096
 T v[202:203],v225,5120
 M v[132:135],v[208:211],a[80:83],v[132:135]
 v_cvt_pk_bf16_f32 v248,v237,v238
 v_cvt_pk_bf16_f32 v249,v239,v240
 M v[136:139],v[208:211],a[144:147],v[136:139]
 v_mul_f32 v237,v120,v120
 v_mul_f32 v238,v121,v121
 M v[140:143],v[208:211],a[208:211],v[140:143]
 W 6
 v_mul_f32 v239,v122,v122
 v_mul_f32 v240,v123,v123
 M v[144:147],v[212:215],a[16:19],v[144:147]
 T v[204:205],v226,4096
 T v[206:207],v226,5120
 M v[148:151],v[212:215],a[80:83],v[148:151]
 v_fma_f32 v237,v237,v242,s88
 v_fma_f32 v238,v238,v242,s88
 M v[152:155],v[212:215],a[144:147],v[152:155]
 v_fma_f32 v239,v239,v242,s88
 v_fma_f32 v240,v240,v242,s88
 M v[156:159],v[212:215],a[208:211],v[156:159]
 W 6
 v_mul_f32 v237,v237,v120
 v_mul_f32 v238,v238,v121
 M v[160:163],v[192:195],a[16:19],v[160:163]
 T v[208:209],v227,4096
 T v[210:211],v227,5120
 M v[164:167],v[192:195],a[80:83],v[164:167]
 v_mul_f32 v239,v239,v122
 v_mul_f32 v240,v240,v123
 M v[168:171],v[192:195],a[144:147],v[168:171]
 v_exp_f32 v237,v237
 M v[172:175],v[192:195],a[208:211],v[172:175]
 W 6
 v_exp_f32 v238,v238
 M v[176:179],v[196:199],a[16:19],v[176:179]
 T v[212:213],v228,4096
 T v[214:215],v228,5120
 M v[180:183],v[196:199],a[80:83],v[180:183]
 v_exp_f32 v239,v239
 M v[184:187],v[196:199],a[144:147],v[184:187]
 v_exp_f32 v240,v240
 M v[188:191],v[196:199],a[208:211],v[188:191]
 W 6
 v_add_f32 v237,1.0,v237
 v_add_f32 v238,1.0,v238
 M v[128:131],v[200:203],a[20:23],v[128:131]
 T v[192:193],v225,8192
 T v[194:195],v225,9216
 M v[132:135],v[200:203],a[84:87],v[132:135]
 v_add_f32 v239,1.0,v239
 v_add_f32 v240,1.0,v240
 M v[136:139],v[200:203],a[148:151],v[136:139]
 v_rcp_f32 v237,v237
 M v[140:143],v[200:203],a[212:215],v[140:143]
 W 6
 v_rcp_f32 v238,v238
 M v[144:147],v[204:207],a[20:23],v[144:147]
 T v[196:197],v226,8192
 T v[198:199],v226,9216
 M v[148:151],v[204:207],a[84:87],v[148:151]
 v_rcp_f32 v239,v239
 M v[152:155],v[204:207],a[148:151],v[152:155]
 v_rcp_f32 v240,v240
 M v[156:159],v[204:207],a[212:215],v[156:159]
 W 6
 v_mul_f32 v237,v237,v120
 v_mul_f32 v238,v238,v121
 M v[160:163],v[208:211],a[20:23],v[160:163]
 T v[200:201],v227,8192
 T v[202:203],v227,9216
 M v[164:167],v[208:211],a[84:87],v[164:167]
 v_mul_f32 v239,v239,v122
 v_mul_f32 v240,v240,v123
 M v[168:171],v[208:211],a[148:151],v[168:171]
 v_cvt_pk_bf16_f32 v250,v237,v238
 v_cvt_pk_bf16_f32 v251,v239,v240
 M v[172:175],v[208:211],a[212:215],v[172:175]
 W 6
 s_add_u32 s90,s87,0
 buffer_store_dwordx4 v[248:251],v224,s[8:11],s90 offen offset:1024 sc0 sc1
 M v[176:179],v[212:215],a[20:23],v[176:179]
 T v[204:205],v228,8192
 T v[206:207],v228,9216
 M v[180:183],v[212:215],a[84:87],v[180:183]
 v_mul_f32 v237,v76,v76
 v_mul_f32 v238,v77,v77
 M v[184:187],v[212:215],a[148:151],v[184:187]
 v_mul_f32 v239,v78,v78
 v_mul_f32 v240,v79,v79
 M v[188:191],v[212:215],a[212:215],v[188:191]
 W 6
 v_fma_f32 v237,v237,v242,s88
 v_fma_f32 v238,v238,v242,s88
 M v[128:131],v[192:195],a[24:27],v[128:131]
 T v[208:209],v225,12288
 T v[210:211],v225,13312
 M v[132:135],v[192:195],a[88:91],v[132:135]
 v_fma_f32 v239,v239,v242,s88
 v_fma_f32 v240,v240,v242,s88
 M v[136:139],v[192:195],a[152:155],v[136:139]
 v_mul_f32 v237,v237,v76
 v_mul_f32 v238,v238,v77
 M v[140:143],v[192:195],a[216:219],v[140:143]
 W 6
 v_mul_f32 v239,v239,v78
 v_mul_f32 v240,v240,v79
 M v[144:147],v[196:199],a[24:27],v[144:147]
 T v[212:213],v226,12288
 T v[214:215],v226,13312
 M v[148:151],v[196:199],a[88:91],v[148:151]
 v_exp_f32 v237,v237
 M v[152:155],v[196:199],a[152:155],v[152:155]
 v_exp_f32 v238,v238
 M v[156:159],v[196:199],a[216:219],v[156:159]
 W 6
 v_exp_f32 v239,v239
 M v[160:163],v[200:203],a[24:27],v[160:163]
 T v[192:193],v227,12288
 T v[194:195],v227,13312
 M v[164:167],v[200:203],a[88:91],v[164:167]
 v_exp_f32 v240,v240
 M v[168:171],v[200:203],a[152:155],v[168:171]
 v_add_f32 v237,1.0,v237
 v_add_f32 v238,1.0,v238
 M v[172:175],v[200:203],a[216:219],v[172:175]
 W 6
 v_add_f32 v239,1.0,v239
 v_add_f32 v240,1.0,v240
 M v[176:179],v[204:207],a[24:27],v[176:179]
 T v[196:197],v228,12288
 T v[198:199],v228,13312
 M v[180:183],v[204:207],a[88:91],v[180:183]
 v_add_u32 v225,0x4000,v225
 v_add_u32 v226,0x4000,v226
 M v[184:187],v[204:207],a[152:155],v[184:187]
 v_add_u32 v227,0x4000,v227
 v_add_u32 v228,0x4000,v228
 M v[188:191],v[204:207],a[216:219],v[188:191]
 W 6
 s_waitcnt vmcnt(8)
 s_barrier
 M v[128:131],v[208:211],a[28:31],v[128:131]
 T v[200:201],v225,0
 T v[202:203],v225,1024
 M v[132:135],v[208:211],a[92:95],v[132:135]
 s_add_u32 s70,s62,1
 s_waitcnt vmcnt(1)
 v_subrev_u32 v217,s70,v217
 v_cmp_le_u32 vcc,8,v217
 s_cbranch_vccz PL_ok3
 s_mov_b32 s69,0x100000
PL_sp3:
 s_sleep 2
 buffer_load_dword v217,v220,s[8:11],s0 offen sc1
 s_waitcnt vmcnt(0)
 v_subrev_u32 v217,s70,v217
 v_cmp_le_u32 vcc,8,v217
 s_cbranch_vccz PL_ok3
 s_sub_u32 s69,s69,1
 s_cbranch_scc0 PL_sp3
PL_ok3:
 v_add_u32 v243,s71,v224
 M v[136:139],v[208:211],a[156:159],v[136:139]
 v_rcp_f32 v237,v237
 M v[140:143],v[208:211],a[220:223],v[140:143]
 W 6
 v_rcp_f32 v238,v238
 M v[144:147],v[212:215],a[28:31],v[144:147]
 T v[204:205],v226,0
 T v[206:207],v226,1024
 M v[148:151],v[212:215],a[92:95],v[148:151]
 s_mov_b32 m0,s92
 s_mov_b32 s69,s91
 s_add_u32 s91,s91,17408
 s_add_u32 s92,s92,0x4000
 s_and_b32 s92,s92,0xffff
 buffer_load_dwordx4 v243,s[36:39],s69 offen offset:0 sc1 lds
 M v[152:155],v[212:215],a[156:159],v[152:155]
 v_rcp_f32 v239,v239
 M v[156:159],v[212:215],a[220:223],v[156:159]
 W 6
 v_rcp_f32 v240,v240
 M v[160:163],v[192:195],a[28:31],v[160:163]
 T v[208:209],v227,0
 T v[210:211],v227,1024
 M v[164:167],v[192:195],a[92:95],v[164:167]
 buffer_load_dwordx4 v243,s[36:39],s69 offen offset:1024 sc1 lds
 v_mul_f32 v237,v237,v76
 M v[168:171],v[192:195],a[156:159],v[168:171]
 v_mul_f32 v238,v238,v77
 v_mul_f32 v239,v239,v78
 M v[172:175],v[192:195],a[220:223],v[172:175]
 W 6
 v_mul_f32 v240,v240,v79
 v_cvt_pk_bf16_f32 v244,v237,v238
 M v[176:179],v[196:199],a[28:31],v[176:179]
 T v[212:213],v228,0
 T v[214:215],v228,1024
 M v[180:183],v[196:199],a[92:95],v[180:183]
 buffer_load_dwordx4 v243,s[36:39],s69 offen offset:2048 sc1 lds
 v_cvt_pk_bf16_f32 v245,v239,v240
 M v[184:187],v[196:199],a[156:159],v[184:187]
 v_mul_f32 v237,v92,v92
 v_mul_f32 v238,v93,v93
 M v[188:191],v[196:199],a[220:223],v[188:191]
 W 6
 v_mul_f32 v239,v94,v94
 v_mul_f32 v240,v95,v95
 M v[128:131],v[200:203],a[32:35],v[128:131]
 T v[192:193],v225,4096
 T v[194:195],v225,5120
 M v[132:135],v[200:203],a[96:99],v[132:135]
 buffer_load_dwordx4 v243,s[36:39],s69 offen offset:3072 sc1 lds
 v_fma_f32 v237,v237,v242,s88
 M v[136:139],v[200:203],a[160:163],v[136:139]
 v_fma_f32 v238,v238,v242,s88
 v_fma_f32 v239,v239,v242,s88
 M v[140:143],v[200:203],a[224:227],v[140:143]
 W 6
 v_fma_f32 v240,v240,v242,s88
 v_mul_f32 v237,v237,v92
 M v[144:147],v[204:207],a[32:35],v[144:147]
 T v[196:197],v226,4096
 T v[198:199],v226,5120
 M v[148:151],v[204:207],a[96:99],v[148:151]
 v_mul_f32 v238,v238,v93
 v_mul_f32 v239,v239,v94
 M v[152:155],v[204:207],a[160:163],v[152:155]
 v_mul_f32 v240,v240,v95
 M v[156:159],v[204:207],a[224:227],v[156:159]
 W 6
 v_exp_f32 v237,v237
 M v[160:163],v[208:211],a[32:35],v[160:163]
 T v[200:201],v227,4096
 T v[202:203],v227,5120
 M v[164:167],v[208:211],a[96:99],v[164:167]
 v_exp_f32 v238,v238
 M v[168:171],v[208:211],a[160:163],v[168:171]
 v_exp_f32 v239,v239
 M v[172:175],v[208:211],a[224:227],v[172:175]
 W 6
 v_exp_f32 v240,v240
 M v[176:179],v[212:215],a[32:35],v[176:179]
 T v[204:205],v228,4096
 T v[206:207],v228,5120
 M v[180:183],v[212:215],a[96:99],v[180:183]
 s_add_u32 m0,s94,0x10000
 s_mov_b32 s69,s93
 s_add_u32 s93,s93,17408
 s_add_u32 s94,s94,0x4000
 s_and_b32 s94,s94,0xffff
 buffer_load_dwordx4 v243,s[40:43],s69 offen offset:0 sc1 lds
 M v[184:187],v[212:215],a[160:163],v[184:187]
 v_add_f32 v237,1.0,v237
 v_add_f32 v238,1.0,v238
 M v[188:191],v[212:215],a[224:227],v[188:191]
 W 6
 v_add_f32 v239,1.0,v239
 v_add_f32 v240,1.0,v240
 M v[128:131],v[192:195],a[36:39],v[128:131]
 T v[208:209],v225,8192
 T v[210:211],v225,9216
 M v[132:135],v[192:195],a[100:103],v[132:135]
 buffer_load_dwordx4 v243,s[40:43],s69 offen offset:1024 sc1 lds
 M v[136:139],v[192:195],a[164:167],v[136:139]
 v_rcp_f32 v237,v237
 M v[140:143],v[192:195],a[228:231],v[140:143]
 W 6
 v_rcp_f32 v238,v238
 M v[144:147],v[196:199],a[36:39],v[144:147]
 T v[212:213],v226,8192
 T v[214:215],v226,9216
 M v[148:151],v[196:199],a[100:103],v[148:151]
 buffer_load_dwordx4 v243,s[40:43],s69 offen offset:2048 sc1 lds
 M v[152:155],v[196:199],a[164:167],v[152:155]
 v_rcp_f32 v239,v239
 M v[156:159],v[196:199],a[228:231],v[156:159]
 W 6
 v_rcp_f32 v240,v240
 M v[160:163],v[200:203],a[36:39],v[160:163]
 T v[192:193],v227,8192
 T v[194:195],v227,9216
 M v[164:167],v[200:203],a[100:103],v[164:167]
 buffer_load_dwordx4 v243,s[40:43],s69 offen offset:3072 sc1 lds
 v_mul_f32 v237,v237,v92
 M v[168:171],v[200:203],a[164:167],v[168:171]
 v_mul_f32 v238,v238,v93
 v_mul_f32 v239,v239,v94
 M v[172:175],v[200:203],a[228:231],v[172:175]
 W 6
 v_mul_f32 v240,v240,v95
 v_cvt_pk_bf16_f32 v246,v237,v238
 M v[176:179],v[204:207],a[36:39],v[176:179]
 T v[196:197],v228,8192
 T v[198:199],v228,9216
 M v[180:183],v[204:207],a[100:103],v[180:183]
 v_cvt_pk_bf16_f32 v247,v239,v240
 s_add_u32 s90,s87,57344
 M v[184:187],v[204:207],a[164:167],v[184:187]
 buffer_store_dwordx4 v[244:247],v224,s[8:11],s90 offen offset:0 sc0 sc1
 v_mul_f32 v237,v108,v108
 M v[188:191],v[204:207],a[228:231],v[188:191]
 W 6
 v_mul_f32 v238,v109,v109
 v_mul_f32 v239,v110,v110
 M v[128:131],v[208:211],a[40:43],v[128:131]
 T v[200:201],v225,12288
 T v[202:203],v225,13312
 M v[132:135],v[208:211],a[104:107],v[132:135]
 v_mul_f32 v240,v111,v111
 v_fma_f32 v237,v237,v242,s88
 M v[136:139],v[208:211],a[168:171],v[136:139]
 v_fma_f32 v238,v238,v242,s88
 v_fma_f32 v239,v239,v242,s88
 M v[140:143],v[208:211],a[232:235],v[140:143]
 W 6
 v_fma_f32 v240,v240,v242,s88
 v_mul_f32 v237,v237,v108
 M v[144:147],v[212:215],a[40:43],v[144:147]
 T v[204:205],v226,12288
 T v[206:207],v226,13312
 M v[148:151],v[212:215],a[104:107],v[148:151]
 s_mov_b32 m0,s92
 s_mov_b32 s69,s91
 s_add_u32 s91,s91,17408
 s_add_u32 s92,s92,0x4000
 s_and_b32 s92,s92,0xffff
 buffer_load_dwordx4 v243,s[36:39],s69 offen offset:0 sc1 lds
 M v[152:155],v[212:215],a[168:171],v[152:155]
 v_mul_f32 v238,v238,v109
 v_mul_f32 v239,v239,v110
 M v[156:159],v[212:215],a[232:235],v[156:159]
 W 6
 v_mul_f32 v240,v240,v111
 M v[160:163],v[192:195],a[40:43],v[160:163]
 T v[208:209],v227,12288
 T v[210:211],v227,13312
 M v[164:167],v[192:195],a[104:107],v[164:167]
 buffer_load_dwordx4 v243,s[36:39],s69 offen offset:1024 sc1 lds
 M v[168:171],v[192:195],a[168:171],v[168:171]
 v_exp_f32 v237,v237
 M v[172:175],v[192:195],a[232:235],v[172:175]
 W 6
 v_exp_f32 v238,v238
 M v[176:179],v[196:199],a[40:43],v[176:179]
 T v[212:213],v228,12288
 T v[214:215],v228,13312
 M v[180:183],v[196:199],a[104:107],v[180:183]
 v_add_u32 v225,0xfffec000,v225
 v_add_u32 v226,0xfffec000,v226
 buffer_load_dwordx4 v243,s[36:39],s69 offen offset:2048 sc1 lds
 M v[184:187],v[196:199],a[168:171],v[184:187]
 v_add_u32 v227,0xfffec000,v227
 v_add_u32 v228,0xfffec000,v228
 M v[188:191],v[196:199],a[232:235],v[188:191]
 W 6
 v_exp_f32 v239,v239
 M v[128:131],v[200:203],a[44:47],v[128:131]
 T v[192:193],v225,0
 T v[194:195],v225,1024
 M v[132:135],v[200:203],a[108:111],v[132:135]
 buffer_load_dwordx4 v243,s[36:39],s69 offen offset:3072 sc1 lds
 M v[136:139],v[200:203],a[172:175],v[136:139]
 v_exp_f32 v240,v240
 M v[140:143],v[200:203],a[236:239],v[140:143]
 W 6
 v_add_f32 v237,1.0,v237
 v_add_f32 v238,1.0,v238
 M v[144:147],v[204:207],a[44:47],v[144:147]
 T v[196:197],v226,0
 T v[198:199],v226,1024
 M v[148:151],v[204:207],a[108:111],v[148:151]
 v_add_f32 v239,1.0,v239
 v_add_f32 v240,1.0,v240
 M v[152:155],v[204:207],a[172:175],v[152:155]
 v_rcp_f32 v237,v237
 M v[156:159],v[204:207],a[236:239],v[156:159]
 W 6
 v_rcp_f32 v238,v238
 M v[160:163],v[208:211],a[44:47],v[160:163]
 T v[200:201],v227,0
 T v[202:203],v227,1024
 M v[164:167],v[208:211],a[108:111],v[164:167]
 v_rcp_f32 v239,v239
 M v[168:171],v[208:211],a[172:175],v[168:171]
 v_rcp_f32 v240,v240
 M v[172:175],v[208:211],a[236:239],v[172:175]
 W 6
 v_mul_f32 v237,v237,v108
 v_mul_f32 v238,v238,v109
 M v[176:179],v[212:215],a[44:47],v[176:179]
 T v[204:205],v228,0
 T v[206:207],v228,1024
 M v[180:183],v[212:215],a[108:111],v[180:183]
 s_mov_b32 m0,s92
 s_mov_b32 s69,s91
 s_add_u32 s91,s91,17408
 s_add_u32 s92,s92,0x4000
 s_and_b32 s92,s92,0xffff
 buffer_load_dwordx4 v243,s[36:39],s69 offen offset:0 sc1 lds
 M v[184:187],v[212:215],a[172:175],v[184:187]
 v_mul_f32 v239,v239,v110
 v_mul_f32 v240,v240,v111
 M v[188:191],v[212:215],a[236:239],v[188:191]
 W 6
 v_cvt_pk_bf16_f32 v248,v237,v238
 v_cvt_pk_bf16_f32 v249,v239,v240
 M v[128:131],v[192:195],a[48:51],v[128:131]
 T v[208:209],v225,4096
 T v[210:211],v225,5120
 M v[132:135],v[192:195],a[112:115],v[132:135]
 buffer_load_dwordx4 v243,s[36:39],s69 offen offset:1024 sc1 lds
 v_mul_f32 v237,v124,v124
 M v[136:139],v[192:195],a[176:179],v[136:139]
 v_mul_f32 v238,v125,v125
 v_mul_f32 v239,v126,v126
 M v[140:143],v[192:195],a[240:243],v[140:143]
 W 6
 v_mul_f32 v240,v127,v127
 v_fma_f32 v237,v237,v242,s88
 M v[144:147],v[196:199],a[48:51],v[144:147]
 T v[212:213],v226,4096
 T v[214:215],v226,5120
 M v[148:151],v[196:199],a[112:115],v[148:151]
 buffer_load_dwordx4 v243,s[36:39],s69 offen offset:2048 sc1 lds
 v_fma_f32 v238,v238,v242,s88
 M v[152:155],v[196:199],a[176:179],v[152:155]
 v_fma_f32 v239,v239,v242,s88
 v_fma_f32 v240,v240,v242,s88
 M v[156:159],v[196:199],a[240:243],v[156:159]
 W 6
 v_mul_f32 v237,v237,v124
 v_mul_f32 v238,v238,v125
 M v[160:163],v[200:203],a[48:51],v[160:163]
 T v[192:193],v227,4096
 T v[194:195],v227,5120
 M v[164:167],v[200:203],a[112:115],v[164:167]
 buffer_load_dwordx4 v243,s[36:39],s69 offen offset:3072 sc1 lds
 v_mul_f32 v239,v239,v126
 M v[168:171],v[200:203],a[176:179],v[168:171]
 v_mul_f32 v240,v240,v127
 M v[172:175],v[200:203],a[240:243],v[172:175]
 W 6
 v_exp_f32 v237,v237
 M v[176:179],v[204:207],a[48:51],v[176:179]
 T v[196:197],v228,4096
 T v[198:199],v228,5120
 M v[180:183],v[204:207],a[112:115],v[180:183]
 v_exp_f32 v238,v238
 M v[184:187],v[204:207],a[176:179],v[184:187]
 v_exp_f32 v239,v239
 M v[188:191],v[204:207],a[240:243],v[188:191]
 W 6
 v_exp_f32 v240,v240
 M v[128:131],v[208:211],a[52:55],v[128:131]
 T v[200:201],v225,8192
 T v[202:203],v225,9216
 M v[132:135],v[208:211],a[116:119],v[132:135]
 v_add_f32 v237,1.0,v237
 v_add_f32 v238,1.0,v238
 M v[136:139],v[208:211],a[180:183],v[136:139]
 v_add_f32 v239,1.0,v239
 v_add_f32 v240,1.0,v240
 M v[140:143],v[208:211],a[244:247],v[140:143]
 W 6
 v_rcp_f32 v237,v237
 M v[144:147],v[212:215],a[52:55],v[144:147]
 T v[204:205],v226,8192
 T v[206:207],v226,9216
 M v[148:151],v[212:215],a[116:119],v[148:151]
 s_add_u32 m0,s94,0x10000
 s_mov_b32 s69,s93
 s_add_u32 s93,s93,17408
 s_add_u32 s94,s94,0x4000
 s_and_b32 s94,s94,0xffff
 buffer_load_dwordx4 v243,s[40:43],s69 offen offset:0 sc1 lds
 M v[152:155],v[212:215],a[180:183],v[152:155]
 v_rcp_f32 v238,v238
 M v[156:159],v[212:215],a[244:247],v[156:159]
 W 6
 v_rcp_f32 v239,v239
 M v[160:163],v[192:195],a[52:55],v[160:163]
 T v[208:209],v227,8192
 T v[210:211],v227,9216
 M v[164:167],v[192:195],a[116:119],v[164:167]
 buffer_load_dwordx4 v243,s[40:43],s69 offen offset:1024 sc1 lds
 M v[168:171],v[192:195],a[180:183],v[168:171]
 v_rcp_f32 v240,v240
 M v[172:175],v[192:195],a[244:247],v[172:175]
 W 6
 v_mul_f32 v237,v237,v124
 v_mul_f32 v238,v238,v125
 M v[176:179],v[196:199],a[52:55],v[176:179]
 T v[212:213],v228,8192
 T v[214:215],v228,9216
 M v[180:183],v[196:199],a[116:119],v[180:183]
 buffer_load_dwordx4 v243,s[40:43],s69 offen offset:2048 sc1 lds
 v_mul_f32 v239,v239,v126
 M v[184:187],v[196:199],a[180:183],v[184:187]
 v_mul_f32 v240,v240,v127
 v_cvt_pk_bf16_f32 v250,v237,v238
 M v[188:191],v[196:199],a[244:247],v[188:191]
 W 6
 v_cvt_pk_bf16_f32 v251,v239,v240
 s_add_u32 s90,s87,57344
 M v[128:131],v[200:203],a[56:59],v[128:131]
 T v[192:193],v225,12288
 T v[194:195],v225,13312
 M v[132:135],v[200:203],a[120:123],v[132:135]
 buffer_load_dwordx4 v243,s[40:43],s69 offen offset:3072 sc1 lds
 buffer_store_dwordx4 v[248:251],v224,s[8:11],s90 offen offset:1024 sc0 sc1
 M v[136:139],v[200:203],a[184:187],v[136:139]
 v_cvt_pk_bf16_f32 v244,v0,v1
 v_cvt_pk_bf16_f32 v246,v4,v5
 M v[140:143],v[200:203],a[248:251],v[140:143]
 W 6
 v_cvt_pk_bf16_f32 v245,v2,v3
 v_cvt_pk_bf16_f32 v247,v6,v7
 M v[144:147],v[204:207],a[56:59],v[144:147]
 T v[196:197],v226,12288
 T v[198:199],v226,13312
 M v[148:151],v[204:207],a[120:123],v[148:151]
 v_permlane16_swap_b32 v244,v246
 M v[152:155],v[204:207],a[184:187],v[152:155]
 v_permlane16_swap_b32 v245,v247
 M v[156:159],v[204:207],a[248:251],v[156:159]
 W 6
 v_accvgpr_write_b32 a128,v244
 v_accvgpr_write_b32 a129,v245
 M v[160:163],v[208:211],a[56:59],v[160:163]
 T v[200:201],v227,12288
 T v[202:203],v227,13312
 M v[164:167],v[208:211],a[120:123],v[164:167]
 v_accvgpr_write_b32 a130,v246
 v_accvgpr_write_b32 a131,v247
 M v[168:171],v[208:211],a[184:187],v[168:171]
 v_cvt_pk_bf16_f32 v248,v16,v17
 v_cvt_pk_bf16_f32 v250,v20,v21
 M v[172:175],v[208:211],a[248:251],v[172:175]
 W 6
 v_cvt_pk_bf16_f32 v249,v18,v19
 v_cvt_pk_bf16_f32 v251,v22,v23
 M v[176:179],v[212:215],a[56:59],v[176:179]
 T v[204:205],v228,12288
 T v[206:207],v228,13312
 M v[180:183],v[212:215],a[120:123],v[180:183]
 v_permlane16_swap_b32 v248,v250
 M v[184:187],v[212:215],a[184:187],v[184:187]
 v_permlane16_swap_b32 v249,v251
 M v[188:191],v[212:215],a[248:251],v[188:191]
 W 6
 v_accvgpr_write_b32 a132,v248
 v_accvgpr_write_b32 a133,v249
 M v[128:131],v[192:195],a[60:63],v[128:131]
 v_accvgpr_write_b32 a134,v250
 v_accvgpr_write_b32 a135,v251
 M v[132:135],v[192:195],a[124:127],v[132:135]
 v_cvt_pk_bf16_f32 v244,v32,v33
 v_cvt_pk_bf16_f32 v246,v36,v37
 M v[136:139],v[192:195],a[188:191],v[136:139]
 v_cvt_pk_bf16_f32 v245,v34,v35
 v_cvt_pk_bf16_f32 v247,v38,v39
 M v[140:143],v[192:195],a[252:255],v[140:143]
 W 4
 v_permlane16_swap_b32 v244,v246
 M v[144:147],v[196:199],a[60:63],v[144:147]
 v_permlane16_swap_b32 v245,v247
 M v[148:151],v[196:199],a[124:127],v[148:151]
 v_accvgpr_write_b32 a136,v244
 v_accvgpr_write_b32 a137,v245
 M v[152:155],v[196:199],a[188:191],v[152:155]
 v_accvgpr_write_b32 a138,v246
 v_accvgpr_write_b32 a139,v247
 M v[156:159],v[196:199],a[252:255],v[156:159]
 W 2
 v_cvt_pk_bf16_f32 v248,v48,v49
 v_cvt_pk_bf16_f32 v250,v52,v53
 M v[160:163],v[200:203],a[60:63],v[160:163]
 v_cvt_pk_bf16_f32 v249,v50,v51
 v_cvt_pk_bf16_f32 v251,v54,v55
 M v[164:167],v[200:203],a[124:127],v[164:167]
 v_permlane16_swap_b32 v248,v250
 M v[168:171],v[200:203],a[188:191],v[168:171]
 v_permlane16_swap_b32 v249,v251
 M v[172:175],v[200:203],a[252:255],v[172:175]
 W 0
 v_accvgpr_write_b32 a140,v248
 v_accvgpr_write_b32 a141,v249
 M v[176:179],v[204:207],a[60:63],v[176:179]
 v_accvgpr_write_b32 a142,v250
 v_accvgpr_write_b32 a143,v251
 M v[180:183],v[204:207],a[124:127],v[180:183]
 v_cvt_pk_bf16_f32 v244,v8,v9
 v_cvt_pk_bf16_f32 v246,v12,v13
 M v[184:187],v[204:207],a[188:191],v[184:187]
 v_cvt_pk_bf16_f32 v245,v10,v11
 v_cvt_pk_bf16_f32 v247,v14,v15
 M v[188:191],v[204:207],a[252:255],v[188:191]
 v_permlane16_swap_b32 v244,v246
 v_permlane16_swap_b32 v245,v247
 v_accvgpr_write_b32 a160,v244
 v_accvgpr_write_b32 a161,v245
 v_accvgpr_write_b32 a162,v246
 v_accvgpr_write_b32 a163,v247
 v_cvt_pk_bf16_f32 v248,v24,v25
 v_cvt_pk_bf16_f32 v250,v28,v29
 v_cvt_pk_bf16_f32 v249,v26,v27
 v_cvt_pk_bf16_f32 v251,v30,v31
 v_permlane16_swap_b32 v248,v250
 s_nop 0
 v_permlane16_swap_b32 v249,v251
 v_accvgpr_write_b32 a164,v248
 v_accvgpr_write_b32 a165,v249
 v_accvgpr_write_b32 a166,v250
 v_accvgpr_write_b32 a167,v251
 v_cvt_pk_bf16_f32 v244,v40,v41
 v_cvt_pk_bf16_f32 v246,v44,v45
 v_cvt_pk_bf16_f32 v245,v42,v43
 v_cvt_pk_bf16_f32 v247,v46,v47
 v_permlane16_swap_b32 v244,v246
 s_nop 0
 v_permlane16_swap_b32 v245,v247
 v_accvgpr_write_b32 a168,v244
 v_accvgpr_write_b32 a169,v245
 v_accvgpr_write_b32 a170,v246
 v_accvgpr_write_b32 a171,v247
 v_cvt_pk_bf16_f32 v248,v56,v57
 v_cvt_pk_bf16_f32 v250,v60,v61
 v_cvt_pk_bf16_f32 v249,v58,v59
 v_cvt_pk_bf16_f32 v251,v62,v63
 v_permlane16_swap_b32 v248,v250
 s_nop 0
 v_permlane16_swap_b32 v249,v251
 v_accvgpr_write_b32 a172,v248
 v_accvgpr_write_b32 a173,v249
 v_accvgpr_write_b32 a174,v250
 v_accvgpr_write_b32 a175,v251
 W 0
 s_waitcnt vmcnt(9)
 s_barrier
 v_mov_b32 v192,v224
 ds_read_b128 a[192:195],v192 offset:0
 ds_read_b128 a[224:227],v192 offset:8192
 ds_read_b128 a[196:199],v192 offset:1024
 ds_read_b128 a[228:231],v192 offset:9216
 ds_read_b128 a[200:203],v192 offset:2048
 ds_read_b128 a[232:235],v192 offset:10240
 ds_read_b128 a[204:207],v192 offset:3072
 ds_read_b128 a[236:239],v192 offset:11264
 v_bfe_u32 v209,v224,4,4
 v_lshlrev_b32 v209,7,v209
 W 7
 N v[0:15],a[192:195],a[128:131],0
 ds_read_b128 a[208:211],v192 offset:4096
 v_cvt_pk_bf16_f32 v244,v128,v129
 v_cvt_pk_bf16_f32 v246,v132,v133
 v_cvt_pk_bf16_f32 v245,v130,v131
 v_cvt_pk_bf16_f32 v247,v134,v135
 N v[16:31],a[192:195],a[160:163],0
 s_mov_b32 m0,s92
 s_mov_b32 s69,s91
 s_add_u32 s91,s91,17408
 s_add_u32 s92,s92,0x4000
 s_and_b32 s92,s92,0xffff
 buffer_load_dwordx4 v243,s[36:39],s69 offen offset:0 sc1 lds
 v_permlane16_swap_b32 v244,v246
 W 7
 N v[32:47],a[224:227],a[128:131],0
 ds_read_b128 a[240:243],v192 offset:12288
 v_permlane16_swap_b32 v245,v247
 v_accvgpr_write_b32 a144,v244
 v_accvgpr_write_b32 a145,v245
 v_accvgpr_write_b32 a146,v246
 N v[48:63],a[224:227],a[160:163],0
 buffer_load_dwordx4 v243,s[36:39],s69 offen offset:1024 sc1 lds
 v_accvgpr_write_b32 a147,v247
 v_cvt_pk_bf16_f32 v244,v136,v137
 v_cvt_pk_bf16_f32 v246,v140,v141
 v_cvt_pk_bf16_f32 v245,v138,v139
 v_cvt_pk_bf16_f32 v247,v142,v143
 W 7
 N v[0:15],a[196:199],a[132:135],v[0:15]
 ds_read_b128 a[212:215],v192 offset:5120
 v_permlane16_swap_b32 v244,v246
 v_permlane16_swap_b32 v245,v247
 v_accvgpr_write_b32 a176,v244
 N v[16:31],a[196:199],a[164:167],v[16:31]
 buffer_load_dwordx4 v243,s[36:39],s69 offen offset:2048 sc1 lds
 v_accvgpr_write_b32 a177,v245
 v_accvgpr_write_b32 a178,v246
 v_accvgpr_write_b32 a179,v247
 v_cvt_pk_bf16_f32 v248,v144,v145
 v_cvt_pk_bf16_f32 v250,v148,v149
 W 7
 N v[32:47],a[228:231],a[132:135],v[32:47]
 ds_read_b128 a[244:247],v192 offset:13312
 v_cvt_pk_bf16_f32 v249,v146,v147
 v_cvt_pk_bf16_f32 v251,v150,v151
 v_permlane16_swap_b32 v248,v250
 N v[48:63],a[228:231],a[164:167],v[48:63]
 buffer_load_dwordx4 v243,s[36:39],s69 offen offset:3072 sc1 lds
 v_permlane16_swap_b32 v249,v251
 v_accvgpr_write_b32 a148,v248
 v_accvgpr_write_b32 a149,v249
 v_accvgpr_write_b32 a150,v250
 W 7
 N v[0:15],a[200:203],a[136:139],v[0:15]
 ds_read_b128 a[216:219],v192 offset:6144
 v_accvgpr_write_b32 a151,v251
 v_cvt_pk_bf16_f32 v248,v152,v153
 v_cvt_pk_bf16_f32 v250,v156,v157
 v_cvt_pk_bf16_f32 v249,v154,v155
 v_cvt_pk_bf16_f32 v251,v158,v159
 N v[16:31],a[200:203],a[168:171],v[16:31]
 s_add_u32 m0,s94,0x10000
 s_mov_b32 s69,s93
 s_add_u32 s93,s93,17408
 s_add_u32 s94,s94,0x4000
 s_and_b32 s94,s94,0xffff
 buffer_load_dwordx4 v243,s[40:43],s69 offen offset:0 sc1 lds
 v_permlane16_swap_b32 v248,v250
 W 7
 N v[32:47],a[232:235],a[136:139],v[32:47]
 ds_read_b128 a[248:251],v192 offset:14336
 v_permlane16_swap_b32 v249,v251
 v_accvgpr_write_b32 a180,v248
 v_accvgpr_write_b32 a181,v249
 v_accvgpr_write_b32 a182,v250
 N v[48:63],a[232:235],a[168:171],v[48:63]
 buffer_load_dwordx4 v243,s[40:43],s69 offen offset:1024 sc1 lds
 v_accvgpr_write_b32 a183,v251
 v_cvt_pk_bf16_f32 v244,v160,v161
 v_cvt_pk_bf16_f32 v246,v164,v165
 v_cvt_pk_bf16_f32 v245,v162,v163
 v_cvt_pk_bf16_f32 v247,v166,v167
 W 7
 N v[0:15],a[204:207],a[140:143],v[0:15]
 ds_read_b128 a[220:223],v192 offset:7168
 v_permlane16_swap_b32 v244,v246
 v_permlane16_swap_b32 v245,v247
 v_accvgpr_write_b32 a152,v244
 N v[16:31],a[204:207],a[172:175],v[16:31]
 buffer_load_dwordx4 v243,s[40:43],s69 offen offset:2048 sc1 lds
 v_accvgpr_write_b32 a153,v245
 v_accvgpr_write_b32 a154,v246
 v_accvgpr_write_b32 a155,v247
 v_cvt_pk_bf16_f32 v244,v168,v169
 v_cvt_pk_bf16_f32 v246,v172,v173
 W 7
 N v[32:47],a[236:239],a[140:143],v[32:47]
 ds_read_b128 a[252:255],v192 offset:15360
 v_cvt_pk_bf16_f32 v245,v170,v171
 v_cvt_pk_bf16_f32 v247,v174,v175
 v_permlane16_swap_b32 v244,v246
 N v[48:63],a[236:239],a[172:175],v[48:63]
 buffer_load_dwordx4 v243,s[40:43],s69 offen offset:3072 sc1 lds
 v_permlane16_swap_b32 v245,v247
 v_accvgpr_write_b32 a184,v244
 v_accvgpr_write_b32 a185,v245
 v_accvgpr_write_b32 a186,v246
 W 7
 N v[0:15],a[208:211],a[144:147],v[0:15]
 v_accvgpr_write_b32 a187,v247
 v_cvt_pk_bf16_f32 v248,v176,v177
 v_cvt_pk_bf16_f32 v250,v180,v181
 v_cvt_pk_bf16_f32 v249,v178,v179
 v_cvt_pk_bf16_f32 v251,v182,v183
 N v[16:31],a[208:211],a[176:179],v[16:31]
 buffer_load_dword v207,v209,s[8:11],s0 offen sc1
 v_permlane16_swap_b32 v248,v250
 v_permlane16_swap_b32 v249,v251
 v_accvgpr_write_b32 a156,v248
 W 6
 N v[32:47],a[240:243],a[144:147],v[32:47]
 v_accvgpr_write_b32 a157,v249
 v_accvgpr_write_b32 a158,v250
 v_accvgpr_write_b32 a159,v251
 v_cvt_pk_bf16_f32 v248,v184,v185
 v_cvt_pk_bf16_f32 v250,v188,v189
 N v[48:63],a[240:243],a[176:179],v[48:63]
 v_cvt_pk_bf16_f32 v249,v186,v187
 v_cvt_pk_bf16_f32 v251,v190,v191
 v_permlane16_swap_b32 v248,v250
 W 5
 N v[0:15],a[212:215],a[148:151],v[0:15]
 v_permlane16_swap_b32 v249,v251
 v_accvgpr_write_b32 a188,v248
 v_accvgpr_write_b32 a189,v249
 v_accvgpr_write_b32 a190,v250
 N v[16:31],a[212:215],a[180:183],v[16:31]
 v_accvgpr_write_b32 a191,v251
 W 4
 N v[32:47],a[244:247],a[148:151],v[32:47]
 v_add_u32 v194,0x10000,v224
 v_lshrrev_b32 v248,4,v224
 s_mov_b32 s75,0
 s_mov_b32 s78,0x4e800000
 s_lshl_b32 s80,s66,8
 N v[48:63],a[244:247],a[180:183],v[48:63]
 s_sub_u32 s80,1792,s80
 v_and_b32 v249,31,v248
 v_lshrrev_b32 v250,5,v248
 v_lshl_add_u32 v204,s64,5,v249
 v_lshlrev_b32 v250,2,v250
 W 3
 N v[0:15],a[216:219],a[152:155],v[0:15]
 v_sub_u32 v204,v204,v250
 v_mov_b32 v205,0xff800000
 s_mov_b32 s76,0x8000
 s_mov_b32 s77,0
 v_mov_b32 v196,0
 N v[16:31],a[216:219],a[184:187],v[16:31]
 v_mov_b32 v198,0
 v_mov_b32 v244,0
 v_mov_b32 v245,0
 v_mov_b32 v246,0
 v_mov_b32 v247,0
 W 2
 N v[32:47],a[248:251],a[152:155],v[32:47]
 v_mov_b32 v210,0
 v_mov_b32 v211,s62
 s_and_b32 s74,s73,0xfffffe00
 v_bfe_u32 v249,v224,4,2
 v_lshlrev_b32 v249,7,v249
 N v[48:63],a[248:251],a[184:187],v[48:63]
 v_add_u32 v208,s74,v249
 s_lshl_b32 s74,s64,13
 s_lshl_b32 s79,s67,8
 s_add_u32 s74,s74,s79
 s_and_b32 s79,s65,1
 W 1
 N v[0:15],a[220:223],a[156:159],v[0:15]
 s_mul_i32 s79,s79,3
 s_mul_i32 s3,s65,7
 s_add_u32 s3,s3,s79
 s_lshl_b32 s3,s3,15
 s_add_u32 s3,s3,s74
 N v[16:31],a[220:223],a[188:191],v[16:31]
 v_lshrrev_b32 v249,3,v248
 v_and_b32 v250,7,v248
 v_and_b32 v251,6,v249
 v_xor_b32 v250,v250,v251
 v_lshlrev_b32 v250,4,v250
 W 0
 N v[32:47],a[252:255],a[156:159],v[32:47]
 v_mul_u32_u24 v249,1024,v249
 v_add_u32 v249,v249,v250
 v_mov_b32 v220,v249
 N v[48:63],a[252:255],a[188:191],v[48:63]
 v_add_u32 v192,0x4000,v224
 ds_read_b128 a[192:195],v192 offset:0
 ds_read_b128 a[196:199],v192 offset:1024
 ds_read_b128 a[200:203],v192 offset:2048
 ds_read_b128 a[204:207],v192 offset:3072
 ds_read_b128 a[208:211],v192 offset:4096
 ds_read_b128 a[212:215],v192 offset:5120
 ds_read_b128 a[216:219],v192 offset:6144
 ds_read_b128 a[220:223],v192 offset:7168
 v_lshlrev_b32 v250,2,v224
 v_lshlrev_b32 v251,1,v224
 s_lshl_b32 s68,s2,14
 s_add_u32 s68,s68,s71
 buffer_load_dword v252,v250,s[44:47],s68 offen
 s_mul_i32 s68,s2,7168
 s_mul_i32 s69,s64,1792
 s_add_u32 s68,s68,s69
 buffer_load_dword v252,v251,s[48:51],s68 offen
 s_cmp_lg_u32 s66,0
 s_cbranch_scc1 F_nomask
 s_nop 7
 v_cmp_le_i32 s[84:85],0,v204
 v_cmp_le_i32 s[86:87],1,v204
 v_cmp_le_i32 s[88:89],2,v204
 v_cmp_le_i32 s[98:99],3,v204
 v_cndmask_b32 v0,v205,v0,s[84:85]
 v_cndmask_b32 v1,v205,v1,s[86:87]
 v_cndmask_b32 v2,v205,v2,s[88:89]
 v_cndmask_b32 v3,v205,v3,s[98:99]
 v_cmp_le_i32 s[84:85],8,v204
 v_cmp_le_i32 s[86:87],9,v204
 v_cmp_le_i32 s[88:89],10,v204
 v_cmp_le_i32 s[98:99],11,v204
 v_cndmask_b32 v4,v205,v4,s[84:85]
 v_cndmask_b32 v5,v205,v5,s[86:87]
 v_cndmask_b32 v6,v205,v6,s[88:89]
 v_cndmask_b32 v7,v205,v7,s[98:99]
 v_cmp_le_i32 s[84:85],16,v204
 v_cmp_le_i32 s[86:87],17,v204
 v_cmp_le_i32 s[88:89],18,v204
 v_cmp_le_i32 s[98:99],19,v204
 v_cndmask_b32 v8,v205,v8,s[84:85]
 v_cndmask_b32 v9,v205,v9,s[86:87]
 v_cndmask_b32 v10,v205,v10,s[88:89]
 v_cndmask_b32 v11,v205,v11,s[98:99]
 v_cmp_le_i32 s[84:85],24,v204
 v_cmp_le_i32 s[86:87],25,v204
 v_cmp_le_i32 s[88:89],26,v204
 v_cmp_le_i32 s[98:99],27,v204
 v_cndmask_b32 v12,v205,v12,s[84:85]
 v_cndmask_b32 v13,v205,v13,s[86:87]
 v_cndmask_b32 v14,v205,v14,s[88:89]
 v_cndmask_b32 v15,v205,v15,s[98:99]
 v_subrev_u32 v206,32,v204
 v_cmp_le_i32 s[84:85],0,v206
 v_cmp_le_i32 s[86:87],1,v206
 v_cmp_le_i32 s[88:89],2,v206
 v_cmp_le_i32 s[98:99],3,v206
 v_cndmask_b32 v32,v205,v32,s[84:85]
 v_cndmask_b32 v33,v205,v33,s[86:87]
 v_cndmask_b32 v34,v205,v34,s[88:89]
 v_cndmask_b32 v35,v205,v35,s[98:99]
 v_cmp_le_i32 s[84:85],8,v206
 v_cmp_le_i32 s[86:87],9,v206
 v_cmp_le_i32 s[88:89],10,v206
 v_cmp_le_i32 s[98:99],11,v206
 v_cndmask_b32 v36,v205,v36,s[84:85]
 v_cndmask_b32 v37,v205,v37,s[86:87]
 v_cndmask_b32 v38,v205,v38,s[88:89]
 v_cndmask_b32 v39,v205,v39,s[98:99]
 v_cmp_le_i32 s[84:85],16,v206
 v_cmp_le_i32 s[86:87],17,v206
 v_cmp_le_i32 s[88:89],18,v206
 v_cmp_le_i32 s[98:99],19,v206
 v_cndmask_b32 v40,v205,v40,s[84:85]
 v_cndmask_b32 v41,v205,v41,s[86:87]
 v_cndmask_b32 v42,v205,v42,s[88:89]
 v_cndmask_b32 v43,v205,v43,s[98:99]
 v_cmp_le_i32 s[84:85],24,v206
 v_cmp_le_i32 s[86:87],25,v206
 v_cmp_le_i32 s[88:89],26,v206
 v_cmp_le_i32 s[98:99],27,v206
 v_cndmask_b32 v44,v205,v44,s[84:85]
 v_cndmask_b32 v45,v205,v45,s[86:87]
 v_cndmask_b32 v46,v205,v46,s[88:89]
 v_cndmask_b32 v47,v205,v47,s[98:99]
F_nomask:
 N a[0:15],v[244:247],v[244:247],0
 v_max3_f32 v200,v0,v1,v2
 v_max3_f32 v200,v200,v3,v4
 v_max3_f32 v200,v200,v5,v6
 v_max3_f32 v200,v200,v7,v8
 v_max3_f32 v200,v200,v9,v10
 v_max3_f32 v200,v200,v11,v12
 v_max3_f32 v200,v200,v13,v14
 N a[16:31],v[244:247],v[244:247],0
 v_max_f32 v200,v200,v15
 v_max3_f32 v200,v200,v32,v33
 v_max3_f32 v200,v200,v34,v35
 v_max3_f32 v200,v200,v36,v37
 v_max3_f32 v200,v200,v38,v39
 v_max3_f32 v200,v200,v40,v41
 v_max3_f32 v200,v200,v42,v43
 N a[32:47],v[244:247],v[244:247],0
 v_max3_f32 v200,v200,v44,v45
 v_max3_f32 v200,v200,v46,v47
 v_max3_f32 v201,v16,v17,v18
 v_max3_f32 v201,v201,v19,v20
 v_max3_f32 v201,v201,v21,v22
 v_max3_f32 v201,v201,v23,v24
 v_max3_f32 v201,v201,v25,v26
 N a[48:63],v[244:247],v[244:247],0
 v_max3_f32 v201,v201,v27,v28
 v_max3_f32 v201,v201,v29,v30
 v_max_f32 v201,v201,v31
 v_max3_f32 v201,v201,v48,v49
 v_max3_f32 v201,v201,v50,v51
 v_max3_f32 v201,v201,v52,v53
 v_max3_f32 v201,v201,v54,v55
 N a[64:79],v[244:247],v[244:247],0
 v_max3_f32 v201,v201,v56,v57
 v_max3_f32 v201,v201,v58,v59
 v_max3_f32 v201,v201,v60,v61
 v_max3_f32 v201,v201,v62,v63
 v_mov_b32 v206,v200
 v_mov_b32 v202,v201
 s_nop 0
 N a[80:95],v[244:247],v[244:247],0
 v_permlane32_swap_b32 v200,v206
 v_permlane32_swap_b32 v201,v202
 v_max_f32 v200,v200,v206
 v_max_f32 v201,v201,v202
 v_sub_f32 v128,0,v200
 N a[96:111],v[244:247],v[244:247],0
 v_sub_f32 v129,0,v200
 v_sub_f32 v130,0,v200
 v_sub_f32 v131,0,v200
 v_sub_f32 v132,0,v200
 v_sub_f32 v133,0,v200
 v_sub_f32 v134,0,v200
 v_sub_f32 v135,0,v200
 N a[112:127],v[244:247],v[244:247],0
 v_sub_f32 v136,0,v200
 v_sub_f32 v137,0,v200
 v_sub_f32 v138,0,v200
 v_sub_f32 v139,0,v200
 v_sub_f32 v140,0,v200
 v_sub_f32 v141,0,v200
 v_sub_f32 v142,0,v200
 v_sub_f32 v143,0,v200
 v_sub_f32 v0,v0,v200
 v_sub_f32 v1,v1,v200
 v_sub_f32 v2,v2,v200
 v_sub_f32 v3,v3,v200
 v_sub_f32 v4,v4,v200
 v_sub_f32 v5,v5,v200
 v_sub_f32 v6,v6,v200
 v_sub_f32 v7,v7,v200
 v_sub_f32 v8,v8,v200
 v_sub_f32 v9,v9,v200
 v_sub_f32 v10,v10,v200
 v_sub_f32 v11,v11,v200
 v_sub_f32 v12,v12,v200
 v_sub_f32 v13,v13,v200
 v_sub_f32 v14,v14,v200
 v_sub_f32 v15,v15,v200
 v_sub_f32 v32,v32,v200
 v_sub_f32 v33,v33,v200
 v_sub_f32 v34,v34,v200
 v_sub_f32 v35,v35,v200
 v_sub_f32 v36,v36,v200
 v_sub_f32 v37,v37,v200
 v_sub_f32 v38,v38,v200
 v_sub_f32 v39,v39,v200
 v_sub_f32 v40,v40,v200
 v_sub_f32 v41,v41,v200
 v_sub_f32 v42,v42,v200
 v_sub_f32 v43,v43,v200
 v_sub_f32 v44,v44,v200
 v_sub_f32 v45,v45,v200
 v_sub_f32 v46,v46,v200
 v_sub_f32 v47,v47,v200
 v_sub_f32 v144,0,v201
 v_sub_f32 v145,0,v201
 v_sub_f32 v146,0,v201
 v_sub_f32 v147,0,v201
 v_sub_f32 v148,0,v201
 v_sub_f32 v149,0,v201
 v_sub_f32 v150,0,v201
 v_sub_f32 v151,0,v201
 v_sub_f32 v152,0,v201
 v_sub_f32 v153,0,v201
 v_sub_f32 v154,0,v201
 v_sub_f32 v155,0,v201
 v_sub_f32 v156,0,v201
 v_sub_f32 v157,0,v201
 v_sub_f32 v158,0,v201
 v_sub_f32 v159,0,v201
 v_sub_f32 v16,v16,v201
 v_sub_f32 v17,v17,v201
 v_sub_f32 v18,v18,v201
 v_sub_f32 v19,v19,v201
 v_sub_f32 v20,v20,v201
 v_sub_f32 v21,v21,v201
 v_sub_f32 v22,v22,v201
 v_sub_f32 v23,v23,v201
 v_sub_f32 v24,v24,v201
 v_sub_f32 v25,v25,v201
 v_sub_f32 v26,v26,v201
 v_sub_f32 v27,v27,v201
 v_sub_f32 v28,v28,v201
 v_sub_f32 v29,v29,v201
 v_sub_f32 v30,v30,v201
 v_sub_f32 v31,v31,v201
 v_sub_f32 v48,v48,v201
 v_sub_f32 v49,v49,v201
 v_sub_f32 v50,v50,v201
 v_sub_f32 v51,v51,v201
 v_sub_f32 v52,v52,v201
 v_sub_f32 v53,v53,v201
 v_sub_f32 v54,v54,v201
 v_sub_f32 v55,v55,v201
 v_sub_f32 v56,v56,v201
 v_sub_f32 v57,v57,v201
 v_sub_f32 v58,v58,v201
 v_sub_f32 v59,v59,v201
 v_sub_f32 v60,v60,v201
 v_sub_f32 v61,v61,v201
 v_sub_f32 v62,v62,v201
 v_sub_f32 v63,v63,v201
 v_exp_f32 v0,v0
 v_exp_f32 v1,v1
 v_exp_f32 v2,v2
 v_add_f32 v197,v0,v1
 v_exp_f32 v3,v3
 v_cvt_pk_bf16_f32 v0,v0,v1
 v_exp_f32 v4,v4
 v_add_f32 v197,v197,v2
 v_exp_f32 v5,v5
 v_cvt_pk_bf16_f32 v1,v2,v3
 v_add_f32 v197,v197,v3
 v_exp_f32 v6,v6
 v_add_f32 v197,v197,v4
 v_exp_f32 v7,v7
 v_cvt_pk_bf16_f32 v2,v4,v5
 v_add_f32 v197,v197,v5
 v_exp_f32 v8,v8
 v_add_f32 v197,v197,v6
 v_exp_f32 v9,v9
 v_cvt_pk_bf16_f32 v3,v6,v7
 v_add_f32 v197,v197,v7
 v_exp_f32 v10,v10
 v_add_f32 v197,v197,v8
 v_exp_f32 v11,v11
 v_add_f32 v197,v197,v9
 v_cvt_pk_bf16_f32 v8,v8,v9
 v_exp_f32 v12,v12
 v_add_f32 v197,v197,v10
 v_exp_f32 v13,v13
 v_cvt_pk_bf16_f32 v9,v10,v11
 v_add_f32 v197,v197,v11
 v_exp_f32 v14,v14
 v_add_f32 v197,v197,v12
 v_exp_f32 v15,v15
 v_cvt_pk_bf16_f32 v10,v12,v13
 v_add_f32 v197,v197,v13
 v_add_f32 v197,v197,v14
 v_cvt_pk_bf16_f32 v11,v14,v15
 v_add_f32 v197,v197,v15
 v_exp_f32 v16,v16
 v_exp_f32 v17,v17
 v_exp_f32 v18,v18
 v_add_f32 v199,v16,v17
 v_exp_f32 v19,v19
 v_cvt_pk_bf16_f32 v16,v16,v17
 v_exp_f32 v20,v20
 v_add_f32 v199,v199,v18
 v_exp_f32 v21,v21
 v_cvt_pk_bf16_f32 v17,v18,v19
 v_add_f32 v199,v199,v19
 v_exp_f32 v22,v22
 v_add_f32 v199,v199,v20
 v_exp_f32 v23,v23
 v_cvt_pk_bf16_f32 v18,v20,v21
 v_add_f32 v199,v199,v21
 v_exp_f32 v24,v24
 v_add_f32 v199,v199,v22
 v_exp_f32 v25,v25
 v_cvt_pk_bf16_f32 v19,v22,v23
 v_add_f32 v199,v199,v23
 v_exp_f32 v26,v26
 v_add_f32 v199,v199,v24
 v_exp_f32 v27,v27
 v_add_f32 v199,v199,v25
 v_cvt_pk_bf16_f32 v24,v24,v25
 v_exp_f32 v28,v28
 v_add_f32 v199,v199,v26
 v_exp_f32 v29,v29
 v_cvt_pk_bf16_f32 v25,v26,v27
 v_add_f32 v199,v199,v27
 v_exp_f32 v30,v30
 v_add_f32 v199,v199,v28
 v_exp_f32 v31,v31
 v_cvt_pk_bf16_f32 v26,v28,v29
 v_add_f32 v199,v199,v29
 v_add_f32 v199,v199,v30
 v_cvt_pk_bf16_f32 v27,v30,v31
 v_add_f32 v199,v199,v31
 s_add_u32 s63,s62,1
 s_waitcnt vmcnt(2)
 v_subrev_u32 v207,s63,v207
 v_cmp_le_u32 vcc,8,v207
 s_cbranch_vccz PL_ok7
 s_mov_b32 s69,0x100000
PL_sp7:
 s_sleep 2
 buffer_load_dword v207,v209,s[8:11],s0 offen sc1
 s_waitcnt vmcnt(0)
 v_subrev_u32 v207,s63,v207
 v_cmp_le_u32 vcc,8,v207
 s_cbranch_vccz PL_ok7
 s_sub_u32 s69,s69,1
 s_cbranch_scc0 PL_sp7
PL_ok7:
 s_sub_u32 s74,s66,1
 s_cbranch_scc1 F_AAme
.p2align 3
F_AAe:
 W 7
 N v[64:79],a[192:195],a[128:131],v[128:143]
 v_exp_f32 v32,v32
 v_exp_f32 v33,v33
 v_exp_f32 v34,v34
 N v[80:95],a[192:195],a[160:163],v[144:159]
 s_mov_b32 m0,s92
 s_mov_b32 s69,s91
 s_add_u32 s91,s91,17408
 s_add_u32 s92,s92,0x4000
 s_and_b32 s92,s92,0xffff
 buffer_load_dwordx4 v243,s[36:39],s69 offen offset:0 sc1 lds
 W 6
 N v[64:79],a[196:199],a[132:135],v[64:79]
 v_add_f32 v197,v197,v32
 v_exp_f32 v35,v35
 v_add_f32 v197,v197,v33
 v_cvt_pk_bf16_f32 v32,v32,v33
 N v[80:95],a[196:199],a[164:167],v[80:95]
 W 4
 v_exp_f32 v36,v36
 v_add_f32 v197,v197,v34
 v_exp_f32 v37,v37
 v_cvt_pk_bf16_f32 v33,v34,v35
 N v[64:79],a[200:203],a[136:139],v[64:79]
 v_add_f32 v197,v197,v35
 v_exp_f32 v38,v38
 v_add_f32 v197,v197,v36
 v_exp_f32 v39,v39
 N v[80:95],a[200:203],a[168:171],v[80:95]
 buffer_load_dwordx4 v243,s[36:39],s69 offen offset:1024 sc1 lds
 v_cvt_pk_bf16_f32 v34,v36,v37
 v_add_f32 v197,v197,v37
 v_exp_f32 v40,v40
 v_add_f32 v197,v197,v38
 N v[64:79],a[204:207],a[140:143],v[64:79]
 v_exp_f32 v41,v41
 v_cvt_pk_bf16_f32 v35,v38,v39
 v_add_f32 v197,v197,v39
 v_exp_f32 v42,v42
 N v[80:95],a[204:207],a[172:175],v[80:95]
 W 2
 v_add_f32 v197,v197,v40
 v_exp_f32 v43,v43
 v_add_f32 v197,v197,v41
 v_cvt_pk_bf16_f32 v40,v40,v41
 N v[64:79],a[208:211],a[144:147],v[64:79]
 ds_read_b128 a[224:227],v192 offset:8192
 ds_read_b128 a[228:231],v192 offset:9216
 v_exp_f32 v44,v44
 v_add_f32 v197,v197,v42
 N v[80:95],a[208:211],a[176:179],v[80:95]
 buffer_load_dwordx4 v243,s[36:39],s69 offen offset:2048 sc1 lds
 v_exp_f32 v45,v45
 v_cvt_pk_bf16_f32 v41,v42,v43
 v_add_f32 v197,v197,v43
 N v[64:79],a[212:215],a[148:151],v[64:79]
 v_exp_f32 v46,v46
 v_add_f32 v197,v197,v44
 v_exp_f32 v47,v47
 v_cvt_pk_bf16_f32 v42,v44,v45
 N v[80:95],a[212:215],a[180:183],v[80:95]
 W 2
 v_add_f32 v197,v197,v45
 v_add_f32 v197,v197,v46
 v_cvt_pk_bf16_f32 v43,v46,v47
 v_add_f32 v197,v197,v47
 v_exp_f32 v48,v48
 N v[64:79],a[216:219],a[152:155],v[64:79]
 ds_read_b128 a[232:235],v192 offset:10240
 ds_read_b128 a[236:239],v192 offset:11264
 v_exp_f32 v49,v49
 v_exp_f32 v50,v50
 N v[80:95],a[216:219],a[184:187],v[80:95]
 buffer_load_dwordx4 v243,s[36:39],s69 offen offset:3072 sc1 lds
 v_add_f32 v199,v199,v48
 v_exp_f32 v51,v51
 v_add_f32 v199,v199,v49
 v_cvt_pk_bf16_f32 v48,v48,v49
 N v[64:79],a[220:223],a[156:159],v[64:79]
 v_exp_f32 v52,v52
 v_add_f32 v199,v199,v50
 v_exp_f32 v53,v53
 v_cvt_pk_bf16_f32 v49,v50,v51
 N v[80:95],a[220:223],a[188:191],v[80:95]
 W 2
 v_add_f32 v199,v199,v51
 v_exp_f32 v54,v54
 v_add_f32 v199,v199,v52
 v_exp_f32 v55,v55
 N v[96:111],a[224:227],a[128:131],v[128:143]
 ds_read_b128 a[240:243],v192 offset:12288
 ds_read_b128 a[244:247],v192 offset:13312
 v_cvt_pk_bf16_f32 v50,v52,v53
 v_add_f32 v199,v199,v53
 v_exp_f32 v56,v56
 N v[112:127],a[224:227],a[160:163],v[144:159]
 s_add_u32 m0,s94,0x10000
 s_mov_b32 s69,s93
 s_add_u32 s93,s93,17408
 s_add_u32 s94,s94,0x4000
 s_and_b32 s94,s94,0xffff
 buffer_load_dwordx4 v243,s[40:43],s69 offen offset:0 sc1 lds
 N v[96:111],a[228:231],a[132:135],v[96:111]
 v_add_f32 v199,v199,v54
 v_exp_f32 v57,v57
 v_cvt_pk_bf16_f32 v51,v54,v55
 v_add_f32 v199,v199,v55
 N v[112:127],a[228:231],a[164:167],v[112:127]
 W 2
 v_exp_f32 v58,v58
 v_add_f32 v199,v199,v56
 v_exp_f32 v59,v59
 v_add_f32 v199,v199,v57
 N v[96:111],a[232:235],a[136:139],v[96:111]
 ds_read_b128 a[248:251],v192 offset:14336
 ds_read_b128 a[252:255],v192 offset:15360
 v_cvt_pk_bf16_f32 v56,v56,v57
 v_exp_f32 v60,v60
 v_add_f32 v199,v199,v58
 N v[112:127],a[232:235],a[168:171],v[112:127]
 v_add_u32 v193,s77,v194
 s_add_u32 s77,s77,16384
 s_and_b32 s77,s77,0xffff
 buffer_load_dwordx4 v243,s[40:43],s69 offen offset:1024 sc1 lds
 v_exp_f32 v61,v61
 N v[96:111],a[236:239],a[140:143],v[96:111]
 v_cvt_pk_bf16_f32 v57,v58,v59
 v_add_f32 v199,v199,v59
 v_exp_f32 v62,v62
 v_add_f32 v199,v199,v60
 N v[112:127],a[236:239],a[172:175],v[112:127]
 W 2
 v_exp_f32 v63,v63
 v_cvt_pk_bf16_f32 v58,v60,v61
 v_add_f32 v199,v199,v61
 v_add_f32 v199,v199,v62
 v_cvt_pk_bf16_f32 v59,v62,v63
 N v[96:111],a[240:243],a[144:147],v[96:111]
 ds_read_b128 a[192:195],v193 offset:0
 ds_read_b128 a[196:199],v193 offset:1024
 v_add_f32 v199,v199,v63
 v_max_f32 v200,v197,v199
 N v[112:127],a[240:243],a[176:179],v[112:127]
 buffer_load_dwordx4 v243,s[40:43],s69 offen offset:2048 sc1 lds
 N v[96:111],a[244:247],a[148:151],v[96:111]
 N v[112:127],a[244:247],a[180:183],v[112:127]
 W 2
 N v[96:111],a[248:251],a[152:155],v[96:111]
 ds_read_b128 a[200:203],v193 offset:2048
 ds_read_b128 a[204:207],v193 offset:3072
 N v[112:127],a[248:251],a[184:187],v[112:127]
 buffer_load_dwordx4 v243,s[40:43],s69 offen offset:3072 sc1 lds
 N v[96:111],a[252:255],a[156:159],v[96:111]
 N v[112:127],a[252:255],a[188:191],v[112:127]
 W 2
 v_cmp_lt_f32 vcc,s78,v200
 s_cbranch_vccz F_c1
 s_call_b64 s[82:83],F_XAA0
F_c1:
 v_add_f32 v196,v196,v197
 v_add_f32 v198,v198,v199
 s_add_u32 s75,s75,64
 N a[0:15],a[192:195],v[0:3],a[0:15]
 ds_read_b128 a[208:211],v193 offset:4096
 ds_read_b128 a[212:215],v193 offset:5120
 v_exp_f32 v64,v64
 v_exp_f32 v65,v65
 N a[64:79],a[192:195],v[16:19],a[64:79]
 v_exp_f32 v66,v66
 v_add_f32 v197,v64,v65
 v_exp_f32 v67,v67
 v_cvt_pk_bf16_f32 v64,v64,v65
 N a[16:31],a[196:199],v[0:3],a[16:31]
 v_exp_f32 v68,v68
 v_add_f32 v197,v197,v66
 v_exp_f32 v69,v69
 v_cvt_pk_bf16_f32 v65,v66,v67
 N a[80:95],a[196:199],v[16:19],a[80:95]
 W 2
 v_add_f32 v197,v197,v67
 v_exp_f32 v70,v70
 v_add_f32 v197,v197,v68
 v_exp_f32 v71,v71
 N a[32:47],a[200:203],v[0:3],a[32:47]
 ds_read_b128 a[216:219],v193 offset:6144
 ds_read_b128 a[220:223],v193 offset:7168
 v_cvt_pk_bf16_f32 v66,v68,v69
 v_add_f32 v197,v197,v69
 v_exp_f32 v72,v72
 N a[96:111],a[200:203],v[16:19],a[96:111]
 v_add_f32 v197,v197,v70
 v_exp_f32 v73,v73
 v_cvt_pk_bf16_f32 v67,v70,v71
 v_add_f32 v197,v197,v71
 N a[48:63],a[204:207],v[0:3],a[48:63]
 v_exp_f32 v74,v74
 v_add_f32 v197,v197,v72
 v_exp_f32 v75,v75
 v_add_f32 v197,v197,v73
 N a[112:127],a[204:207],v[16:19],a[112:127]
 W 2
 v_cvt_pk_bf16_f32 v72,v72,v73
 v_exp_f32 v76,v76
 v_add_f32 v197,v197,v74
 v_exp_f32 v77,v77
 N a[0:15],a[208:211],v[8:11],a[0:15]
 ds_read_b128 a[224:227],v193 offset:8192
 ds_read_b128 a[228:231],v193 offset:9216
 v_cvt_pk_bf16_f32 v73,v74,v75
 v_add_f32 v197,v197,v75
 v_exp_f32 v78,v78
 N a[64:79],a[208:211],v[24:27],a[64:79]
 v_add_f32 v197,v197,v76
 v_exp_f32 v79,v79
 v_cvt_pk_bf16_f32 v74,v76,v77
 v_add_f32 v197,v197,v77
 v_add_f32 v197,v197,v78
 N a[16:31],a[212:215],v[8:11],a[16:31]
 v_cvt_pk_bf16_f32 v75,v78,v79
 v_add_f32 v197,v197,v79
 v_exp_f32 v80,v80
 v_exp_f32 v81,v81
 N a[80:95],a[212:215],v[24:27],a[80:95]
 W 2
 v_exp_f32 v82,v82
 v_add_f32 v199,v80,v81
 v_exp_f32 v83,v83
 v_cvt_pk_bf16_f32 v80,v80,v81
 N a[32:47],a[216:219],v[8:11],a[32:47]
 ds_read_b128 a[232:235],v193 offset:10240
 ds_read_b128 a[236:239],v193 offset:11264
 v_exp_f32 v84,v84
 v_add_f32 v199,v199,v82
 N a[96:111],a[216:219],v[24:27],a[96:111]
 v_exp_f32 v85,v85
 v_cvt_pk_bf16_f32 v81,v82,v83
 v_add_f32 v199,v199,v83
 v_exp_f32 v86,v86
 N a[48:63],a[220:223],v[8:11],a[48:63]
 v_add_f32 v199,v199,v84
 v_exp_f32 v87,v87
 v_cvt_pk_bf16_f32 v82,v84,v85
 v_add_f32 v199,v199,v85
 N a[112:127],a[220:223],v[24:27],a[112:127]
 W 2
 v_exp_f32 v88,v88
 v_add_f32 v199,v199,v86
 v_exp_f32 v89,v89
 v_cvt_pk_bf16_f32 v83,v86,v87
 N a[0:15],a[224:227],v[32:35],a[0:15]
 ds_read_b128 a[240:243],v193 offset:12288
 ds_read_b128 a[244:247],v193 offset:13312
 v_add_f32 v199,v199,v87
 v_exp_f32 v90,v90
 v_add_f32 v199,v199,v88
 N a[64:79],a[224:227],v[48:51],a[64:79]
 v_exp_f32 v91,v91
 v_add_f32 v199,v199,v89
 v_cvt_pk_bf16_f32 v88,v88,v89
 v_exp_f32 v92,v92
 N a[16:31],a[228:231],v[32:35],a[16:31]
 v_add_f32 v199,v199,v90
 v_exp_f32 v93,v93
 v_cvt_pk_bf16_f32 v89,v90,v91
 v_add_f32 v199,v199,v91
 N a[80:95],a[228:231],v[48:51],a[80:95]
 W 2
 v_exp_f32 v94,v94
 v_add_f32 v199,v199,v92
 v_exp_f32 v95,v95
 v_cvt_pk_bf16_f32 v90,v92,v93
 N a[32:47],a[232:235],v[32:35],a[32:47]
 ds_read_b128 a[248:251],v193 offset:14336
 ds_read_b128 a[252:255],v193 offset:15360
 v_add_f32 v199,v199,v93
 v_add_f32 v199,v199,v94
 v_cvt_pk_bf16_f32 v91,v94,v95
 v_add_f32 v199,v199,v95
 N a[96:111],a[232:235],v[48:51],a[96:111]
 N a[48:63],a[236:239],v[32:35],a[48:63]
 v_add_u32 v192,s76,v224
 s_add_u32 s76,s76,16384
 s_and_b32 s76,s76,0xffff
 N a[112:127],a[236:239],v[48:51],a[112:127]
 W 2
 s_waitcnt vmcnt(16) lgkmcnt(0)
 s_barrier
 N a[0:15],a[240:243],v[40:43],a[0:15]
 ds_read_b128 a[192:195],v192 offset:0
 ds_read_b128 a[196:199],v192 offset:1024
 N a[64:79],a[240:243],v[56:59],a[64:79]
 ds_read_b128 a[200:203],v192 offset:2048
 ds_read_b128 a[204:207],v192 offset:3072
 N a[16:31],a[244:247],v[40:43],a[16:31]
 N a[80:95],a[244:247],v[56:59],a[80:95]
 ds_read_b128 a[208:211],v192 offset:4096
 ds_read_b128 a[212:215],v192 offset:5120
 N a[32:47],a[248:251],v[40:43],a[32:47]
 N a[96:111],a[248:251],v[56:59],a[96:111]
 ds_read_b128 a[216:219],v192 offset:6144
 ds_read_b128 a[220:223],v192 offset:7168
 N a[48:63],a[252:255],v[40:43],a[48:63]
 N a[112:127],a[252:255],v[56:59],a[112:127]
 s_sub_u32 s74, s74, 1
 s_cbranch_scc1 F_AAmo
 W 7
 N v[0:15],a[192:195],a[128:131],v[128:143]
 v_exp_f32 v96,v96
 v_exp_f32 v97,v97
 v_exp_f32 v98,v98
 N v[16:31],a[192:195],a[160:163],v[144:159]
 s_mov_b32 m0,s92
 s_mov_b32 s69,s91
 s_add_u32 s91,s91,17408
 s_add_u32 s92,s92,0x4000
 s_and_b32 s92,s92,0xffff
 buffer_load_dwordx4 v243,s[36:39],s69 offen offset:0 sc1 lds
 W 6
 N v[0:15],a[196:199],a[132:135],v[0:15]
 v_add_f32 v197,v197,v96
 v_exp_f32 v99,v99
 v_add_f32 v197,v197,v97
 v_cvt_pk_bf16_f32 v96,v96,v97
 N v[16:31],a[196:199],a[164:167],v[16:31]
 W 4
 v_exp_f32 v100,v100
 v_add_f32 v197,v197,v98
 v_exp_f32 v101,v101
 v_cvt_pk_bf16_f32 v97,v98,v99
 N v[0:15],a[200:203],a[136:139],v[0:15]
 v_add_f32 v197,v197,v99
 v_exp_f32 v102,v102
 v_add_f32 v197,v197,v100
 v_exp_f32 v103,v103
 N v[16:31],a[200:203],a[168:171],v[16:31]
 buffer_load_dwordx4 v243,s[36:39],s69 offen offset:1024 sc1 lds
 v_cvt_pk_bf16_f32 v98,v100,v101
 v_add_f32 v197,v197,v101
 v_exp_f32 v104,v104
 v_add_f32 v197,v197,v102
 N v[0:15],a[204:207],a[140:143],v[0:15]
 v_exp_f32 v105,v105
 v_cvt_pk_bf16_f32 v99,v102,v103
 v_add_f32 v197,v197,v103
 v_exp_f32 v106,v106
 N v[16:31],a[204:207],a[172:175],v[16:31]
 W 2
 v_add_f32 v197,v197,v104
 v_exp_f32 v107,v107
 v_add_f32 v197,v197,v105
 v_cvt_pk_bf16_f32 v104,v104,v105
 N v[0:15],a[208:211],a[144:147],v[0:15]
 ds_read_b128 a[224:227],v192 offset:8192
 ds_read_b128 a[228:231],v192 offset:9216
 v_exp_f32 v108,v108
 v_add_f32 v197,v197,v106
 N v[16:31],a[208:211],a[176:179],v[16:31]
 buffer_load_dwordx4 v243,s[36:39],s69 offen offset:2048 sc1 lds
 v_exp_f32 v109,v109
 v_cvt_pk_bf16_f32 v105,v106,v107
 v_add_f32 v197,v197,v107
 N v[0:15],a[212:215],a[148:151],v[0:15]
 v_exp_f32 v110,v110
 v_add_f32 v197,v197,v108
 v_exp_f32 v111,v111
 v_cvt_pk_bf16_f32 v106,v108,v109
 N v[16:31],a[212:215],a[180:183],v[16:31]
 W 2
 v_add_f32 v197,v197,v109
 v_add_f32 v197,v197,v110
 v_cvt_pk_bf16_f32 v107,v110,v111
 v_add_f32 v197,v197,v111
 v_exp_f32 v112,v112
 N v[0:15],a[216:219],a[152:155],v[0:15]
 ds_read_b128 a[232:235],v192 offset:10240
 ds_read_b128 a[236:239],v192 offset:11264
 v_exp_f32 v113,v113
 v_exp_f32 v114,v114
 N v[16:31],a[216:219],a[184:187],v[16:31]
 buffer_load_dwordx4 v243,s[36:39],s69 offen offset:3072 sc1 lds
 v_add_f32 v199,v199,v112
 v_exp_f32 v115,v115
 v_add_f32 v199,v199,v113
 v_cvt_pk_bf16_f32 v112,v112,v113
 N v[0:15],a[220:223],a[156:159],v[0:15]
 v_exp_f32 v116,v116
 v_add_f32 v199,v199,v114
 v_exp_f32 v117,v117
 v_cvt_pk_bf16_f32 v113,v114,v115
 N v[16:31],a[220:223],a[188:191],v[16:31]
 W 2
 v_add_f32 v199,v199,v115
 v_exp_f32 v118,v118
 v_add_f32 v199,v199,v116
 v_exp_f32 v119,v119
 N v[32:47],a[224:227],a[128:131],v[128:143]
 ds_read_b128 a[240:243],v192 offset:12288
 ds_read_b128 a[244:247],v192 offset:13312
 v_cvt_pk_bf16_f32 v114,v116,v117
 v_add_f32 v199,v199,v117
 v_exp_f32 v120,v120
 N v[48:63],a[224:227],a[160:163],v[144:159]
 s_add_u32 m0,s94,0x10000
 s_mov_b32 s69,s93
 s_add_u32 s93,s93,17408
 s_add_u32 s94,s94,0x4000
 s_and_b32 s94,s94,0xffff
 buffer_load_dwordx4 v243,s[40:43],s69 offen offset:0 sc1 lds
 N v[32:47],a[228:231],a[132:135],v[32:47]
 v_add_f32 v199,v199,v118
 v_exp_f32 v121,v121
 v_cvt_pk_bf16_f32 v115,v118,v119
 v_add_f32 v199,v199,v119
 N v[48:63],a[228:231],a[164:167],v[48:63]
 W 2
 v_exp_f32 v122,v122
 v_add_f32 v199,v199,v120
 v_exp_f32 v123,v123
 v_add_f32 v199,v199,v121
 N v[32:47],a[232:235],a[136:139],v[32:47]
 ds_read_b128 a[248:251],v192 offset:14336
 ds_read_b128 a[252:255],v192 offset:15360
 v_cvt_pk_bf16_f32 v120,v120,v121
 v_exp_f32 v124,v124
 v_add_f32 v199,v199,v122
 N v[48:63],a[232:235],a[168:171],v[48:63]
 v_add_u32 v193,s77,v194
 s_add_u32 s77,s77,16384
 s_and_b32 s77,s77,0xffff
 buffer_load_dwordx4 v243,s[40:43],s69 offen offset:1024 sc1 lds
 v_exp_f32 v125,v125
 N v[32:47],a[236:239],a[140:143],v[32:47]
 v_cvt_pk_bf16_f32 v121,v122,v123
 v_add_f32 v199,v199,v123
 v_exp_f32 v126,v126
 v_add_f32 v199,v199,v124
 N v[48:63],a[236:239],a[172:175],v[48:63]
 W 2
 v_exp_f32 v127,v127
 v_cvt_pk_bf16_f32 v122,v124,v125
 v_add_f32 v199,v199,v125
 v_add_f32 v199,v199,v126
 v_cvt_pk_bf16_f32 v123,v126,v127
 N v[32:47],a[240:243],a[144:147],v[32:47]
 ds_read_b128 a[192:195],v193 offset:0
 ds_read_b128 a[196:199],v193 offset:1024
 v_add_f32 v199,v199,v127
 v_max_f32 v200,v197,v199
 N v[48:63],a[240:243],a[176:179],v[48:63]
 buffer_load_dwordx4 v243,s[40:43],s69 offen offset:2048 sc1 lds
 N v[32:47],a[244:247],a[148:151],v[32:47]
 N v[48:63],a[244:247],a[180:183],v[48:63]
 W 2
 N v[32:47],a[248:251],a[152:155],v[32:47]
 ds_read_b128 a[200:203],v193 offset:2048
 ds_read_b128 a[204:207],v193 offset:3072
 N v[48:63],a[248:251],a[184:187],v[48:63]
 buffer_load_dwordx4 v243,s[40:43],s69 offen offset:3072 sc1 lds
 N v[32:47],a[252:255],a[156:159],v[32:47]
 N v[48:63],a[252:255],a[188:191],v[48:63]
 W 2
 v_cmp_lt_f32 vcc,s78,v200
 s_cbranch_vccz F_c2
 s_call_b64 s[82:83],F_XAA1
F_c2:
 v_add_f32 v196,v196,v197
 v_add_f32 v198,v198,v199
 s_add_u32 s75,s75,64
 N a[0:15],a[192:195],v[64:67],a[0:15]
 ds_read_b128 a[208:211],v193 offset:4096
 ds_read_b128 a[212:215],v193 offset:5120
 v_exp_f32 v0,v0
 v_exp_f32 v1,v1
 N a[64:79],a[192:195],v[80:83],a[64:79]
 v_exp_f32 v2,v2
 v_add_f32 v197,v0,v1
 v_exp_f32 v3,v3
 v_cvt_pk_bf16_f32 v0,v0,v1
 N a[16:31],a[196:199],v[64:67],a[16:31]
 v_exp_f32 v4,v4
 v_add_f32 v197,v197,v2
 v_exp_f32 v5,v5
 v_cvt_pk_bf16_f32 v1,v2,v3
 N a[80:95],a[196:199],v[80:83],a[80:95]
 W 2
 v_add_f32 v197,v197,v3
 v_exp_f32 v6,v6
 v_add_f32 v197,v197,v4
 v_exp_f32 v7,v7
 N a[32:47],a[200:203],v[64:67],a[32:47]
 ds_read_b128 a[216:219],v193 offset:6144
 ds_read_b128 a[220:223],v193 offset:7168
 v_cvt_pk_bf16_f32 v2,v4,v5
 v_add_f32 v197,v197,v5
 v_exp_f32 v8,v8
 N a[96:111],a[200:203],v[80:83],a[96:111]
 v_add_f32 v197,v197,v6
 v_exp_f32 v9,v9
 v_cvt_pk_bf16_f32 v3,v6,v7
 v_add_f32 v197,v197,v7
 N a[48:63],a[204:207],v[64:67],a[48:63]
 v_exp_f32 v10,v10
 v_add_f32 v197,v197,v8
 v_exp_f32 v11,v11
 v_add_f32 v197,v197,v9
 N a[112:127],a[204:207],v[80:83],a[112:127]
 W 2
 v_cvt_pk_bf16_f32 v8,v8,v9
 v_exp_f32 v12,v12
 v_add_f32 v197,v197,v10
 v_exp_f32 v13,v13
 N a[0:15],a[208:211],v[72:75],a[0:15]
 ds_read_b128 a[224:227],v193 offset:8192
 ds_read_b128 a[228:231],v193 offset:9216
 v_cvt_pk_bf16_f32 v9,v10,v11
 v_add_f32 v197,v197,v11
 v_exp_f32 v14,v14
 N a[64:79],a[208:211],v[88:91],a[64:79]
 v_add_f32 v197,v197,v12
 v_exp_f32 v15,v15
 v_cvt_pk_bf16_f32 v10,v12,v13
 v_add_f32 v197,v197,v13
 v_add_f32 v197,v197,v14
 N a[16:31],a[212:215],v[72:75],a[16:31]
 v_cvt_pk_bf16_f32 v11,v14,v15
 v_add_f32 v197,v197,v15
 v_exp_f32 v16,v16
 v_exp_f32 v17,v17
 N a[80:95],a[212:215],v[88:91],a[80:95]
 W 2
 v_exp_f32 v18,v18
 v_add_f32 v199,v16,v17
 v_exp_f32 v19,v19
 v_cvt_pk_bf16_f32 v16,v16,v17
 N a[32:47],a[216:219],v[72:75],a[32:47]
 ds_read_b128 a[232:235],v193 offset:10240
 ds_read_b128 a[236:239],v193 offset:11264
 v_exp_f32 v20,v20
 v_add_f32 v199,v199,v18
 N a[96:111],a[216:219],v[88:91],a[96:111]
 v_exp_f32 v21,v21
 v_cvt_pk_bf16_f32 v17,v18,v19
 v_add_f32 v199,v199,v19
 v_exp_f32 v22,v22
 N a[48:63],a[220:223],v[72:75],a[48:63]
 v_add_f32 v199,v199,v20
 v_exp_f32 v23,v23
 v_cvt_pk_bf16_f32 v18,v20,v21
 v_add_f32 v199,v199,v21
 N a[112:127],a[220:223],v[88:91],a[112:127]
 W 2
 v_exp_f32 v24,v24
 v_add_f32 v199,v199,v22
 v_exp_f32 v25,v25
 v_cvt_pk_bf16_f32 v19,v22,v23
 N a[0:15],a[224:227],v[96:99],a[0:15]
 ds_read_b128 a[240:243],v193 offset:12288
 ds_read_b128 a[244:247],v193 offset:13312
 v_add_f32 v199,v199,v23
 v_exp_f32 v26,v26
 v_add_f32 v199,v199,v24
 N a[64:79],a[224:227],v[112:115],a[64:79]
 v_exp_f32 v27,v27
 v_add_f32 v199,v199,v25
 v_cvt_pk_bf16_f32 v24,v24,v25
 v_exp_f32 v28,v28
 N a[16:31],a[228:231],v[96:99],a[16:31]
 v_add_f32 v199,v199,v26
 v_exp_f32 v29,v29
 v_cvt_pk_bf16_f32 v25,v26,v27
 v_add_f32 v199,v199,v27
 N a[80:95],a[228:231],v[112:115],a[80:95]
 W 2
 v_exp_f32 v30,v30
 v_add_f32 v199,v199,v28
 v_exp_f32 v31,v31
 v_cvt_pk_bf16_f32 v26,v28,v29
 N a[32:47],a[232:235],v[96:99],a[32:47]
 ds_read_b128 a[248:251],v193 offset:14336
 ds_read_b128 a[252:255],v193 offset:15360
 v_add_f32 v199,v199,v29
 v_add_f32 v199,v199,v30
 v_cvt_pk_bf16_f32 v27,v30,v31
 v_add_f32 v199,v199,v31
 N a[96:111],a[232:235],v[112:115],a[96:111]
 N a[48:63],a[236:239],v[96:99],a[48:63]
 v_add_u32 v192,s76,v224
 s_add_u32 s76,s76,16384
 s_and_b32 s76,s76,0xffff
 N a[112:127],a[236:239],v[112:115],a[112:127]
 W 2
 s_waitcnt vmcnt(16) lgkmcnt(0)
 s_barrier
 N a[0:15],a[240:243],v[104:107],a[0:15]
 ds_read_b128 a[192:195],v192 offset:0
 ds_read_b128 a[196:199],v192 offset:1024
 N a[64:79],a[240:243],v[120:123],a[64:79]
 ds_read_b128 a[200:203],v192 offset:2048
 ds_read_b128 a[204:207],v192 offset:3072
 N a[16:31],a[244:247],v[104:107],a[16:31]
 N a[80:95],a[244:247],v[120:123],a[80:95]
 ds_read_b128 a[208:211],v192 offset:4096
 ds_read_b128 a[212:215],v192 offset:5120
 N a[32:47],a[248:251],v[104:107],a[32:47]
 N a[96:111],a[248:251],v[120:123],a[96:111]
 ds_read_b128 a[216:219],v192 offset:6144
 ds_read_b128 a[220:223],v192 offset:7168
 N a[48:63],a[252:255],v[104:107],a[48:63]
 N a[112:127],a[252:255],v[120:123],a[112:127]
 s_branch F_AAe
F_AAme:
 s_cmp_eq_u32 s64, 0
 s_cbranch_scc1 F_AAme0
 s_cmp_eq_u32 s64, 1
 s_cbranch_scc1 F_AAme1
 s_cmp_eq_u32 s64, 2
 s_cbranch_scc1 F_AAme2
 s_branch F_AAme3
F_AAmo:
 s_cmp_eq_u32 s64, 0
 s_cbranch_scc1 F_AAmo0
 s_cmp_eq_u32 s64, 1
 s_cbranch_scc1 F_AAmo1
 s_cmp_eq_u32 s64, 2
 s_cbranch_scc1 F_AAmo2
 s_branch F_AAmo3
F_AAmo0:
 W 7
 N v[0:15],a[192:195],a[128:131],v[128:143]
 v_exp_f32 v96,v96
 v_exp_f32 v97,v97
 v_exp_f32 v98,v98
 N v[16:31],a[192:195],a[160:163],v[144:159]
 s_mov_b32 m0,s92
 s_mov_b32 s69,s91
 s_add_u32 s91,s91,17408
 s_add_u32 s92,s92,0x4000
 s_and_b32 s92,s92,0xffff
 buffer_load_dwordx4 v243,s[36:39],s69 offen offset:0 sc1 lds
 W 6
 N v[0:15],a[196:199],a[132:135],v[0:15]
 v_add_f32 v197,v197,v96
 v_exp_f32 v99,v99
 v_add_f32 v197,v197,v97
 v_cvt_pk_bf16_f32 v96,v96,v97
 N v[16:31],a[196:199],a[164:167],v[16:31]
 W 4
 v_exp_f32 v100,v100
 v_add_f32 v197,v197,v98
 v_exp_f32 v101,v101
 v_cvt_pk_bf16_f32 v97,v98,v99
 N v[0:15],a[200:203],a[136:139],v[0:15]
 v_add_f32 v197,v197,v99
 v_exp_f32 v102,v102
 v_add_f32 v197,v197,v100
 v_exp_f32 v103,v103
 N v[16:31],a[200:203],a[168:171],v[16:31]
 buffer_load_dwordx4 v243,s[36:39],s69 offen offset:1024 sc1 lds
 v_cvt_pk_bf16_f32 v98,v100,v101
 v_add_f32 v197,v197,v101
 v_exp_f32 v104,v104
 v_add_f32 v197,v197,v102
 N v[0:15],a[204:207],a[140:143],v[0:15]
 v_exp_f32 v105,v105
 v_cvt_pk_bf16_f32 v99,v102,v103
 v_add_f32 v197,v197,v103
 v_exp_f32 v106,v106
 N v[16:31],a[204:207],a[172:175],v[16:31]
 W 2
 v_add_f32 v197,v197,v104
 v_exp_f32 v107,v107
 v_add_f32 v197,v197,v105
 v_cvt_pk_bf16_f32 v104,v104,v105
 N v[0:15],a[208:211],a[144:147],v[0:15]
 ds_read_b128 a[224:227],v192 offset:8192
 ds_read_b128 a[228:231],v192 offset:9216
 v_exp_f32 v108,v108
 v_add_f32 v197,v197,v106
 N v[16:31],a[208:211],a[176:179],v[16:31]
 buffer_load_dwordx4 v243,s[36:39],s69 offen offset:2048 sc1 lds
 v_exp_f32 v109,v109
 v_cvt_pk_bf16_f32 v105,v106,v107
 v_add_f32 v197,v197,v107
 N v[0:15],a[212:215],a[148:151],v[0:15]
 v_exp_f32 v110,v110
 v_add_f32 v197,v197,v108
 v_exp_f32 v111,v111
 v_cvt_pk_bf16_f32 v106,v108,v109
 N v[16:31],a[212:215],a[180:183],v[16:31]
 W 2
 v_add_f32 v197,v197,v109
 v_add_f32 v197,v197,v110
 v_cvt_pk_bf16_f32 v107,v110,v111
 v_add_f32 v197,v197,v111
 v_exp_f32 v112,v112
 N v[0:15],a[216:219],a[152:155],v[0:15]
 ds_read_b128 a[232:235],v192 offset:10240
 ds_read_b128 a[236:239],v192 offset:11264
 v_exp_f32 v113,v113
 v_exp_f32 v114,v114
 N v[16:31],a[216:219],a[184:187],v[16:31]
 buffer_load_dwordx4 v243,s[36:39],s69 offen offset:3072 sc1 lds
 v_add_f32 v199,v199,v112
 v_exp_f32 v115,v115
 v_add_f32 v199,v199,v113
 v_cvt_pk_bf16_f32 v112,v112,v113
 N v[0:15],a[220:223],a[156:159],v[0:15]
 v_exp_f32 v116,v116
 v_add_f32 v199,v199,v114
 v_exp_f32 v117,v117
 v_cvt_pk_bf16_f32 v113,v114,v115
 N v[16:31],a[220:223],a[188:191],v[16:31]
 W 2
 v_add_f32 v199,v199,v115
 v_exp_f32 v118,v118
 v_add_f32 v199,v199,v116
 v_exp_f32 v119,v119
 ds_read_b128 a[240:243],v192 offset:12288
 ds_read_b128 a[244:247],v192 offset:13312
 v_cvt_pk_bf16_f32 v114,v116,v117
 v_add_f32 v199,v199,v117
 v_exp_f32 v120,v120
 N v[48:63],a[224:227],a[160:163],v[144:159]
 s_add_u32 m0,s94,0x10000
 s_mov_b32 s69,s93
 s_add_u32 s93,s93,17408
 s_add_u32 s94,s94,0x4000
 s_and_b32 s94,s94,0xffff
 buffer_load_dwordx4 v243,s[40:43],s69 offen offset:0 sc1 lds
 v_add_f32 v199,v199,v118
 v_exp_f32 v121,v121
 v_cvt_pk_bf16_f32 v115,v118,v119
 v_add_f32 v199,v199,v119
 N v[48:63],a[228:231],a[164:167],v[48:63]
 W 2
 v_exp_f32 v122,v122
 v_add_f32 v199,v199,v120
 v_exp_f32 v123,v123
 v_add_f32 v199,v199,v121
 ds_read_b128 a[248:251],v192 offset:14336
 ds_read_b128 a[252:255],v192 offset:15360
 v_cvt_pk_bf16_f32 v120,v120,v121
 v_exp_f32 v124,v124
 v_add_f32 v199,v199,v122
 N v[48:63],a[232:235],a[168:171],v[48:63]
 v_add_u32 v193,s77,v194
 s_add_u32 s77,s77,16384
 s_and_b32 s77,s77,0xffff
 buffer_load_dwordx4 v243,s[40:43],s69 offen offset:1024 sc1 lds
 v_exp_f32 v125,v125
 v_cvt_pk_bf16_f32 v121,v122,v123
 v_add_f32 v199,v199,v123
 v_exp_f32 v126,v126
 v_add_f32 v199,v199,v124
 N v[48:63],a[236:239],a[172:175],v[48:63]
 W 2
 v_exp_f32 v127,v127
 v_cvt_pk_bf16_f32 v122,v124,v125
 v_add_f32 v199,v199,v125
 v_add_f32 v199,v199,v126
 v_cvt_pk_bf16_f32 v123,v126,v127
 ds_read_b128 a[192:195],v193 offset:0
 ds_read_b128 a[196:199],v193 offset:1024
 v_add_f32 v199,v199,v127
 v_cmp_le_i32 s[84:85],0,v204
 v_cmp_le_i32 s[86:87],1,v204
 v_cmp_le_i32 s[88:89],2,v204
 N v[48:63],a[240:243],a[176:179],v[48:63]
 buffer_load_dwordx4 v243,s[40:43],s69 offen offset:2048 sc1 lds
 v_cmp_le_i32 s[98:99],3,v204
 v_cndmask_b32 v0,v205,v0,s[84:85]
 v_cndmask_b32 v1,v205,v1,s[86:87]
 v_cndmask_b32 v2,v205,v2,s[88:89]
 v_cndmask_b32 v3,v205,v3,s[98:99]
 v_cmp_le_i32 s[84:85],8,v204
 v_cmp_le_i32 s[86:87],9,v204
 v_cmp_le_i32 s[88:89],10,v204
 v_cmp_le_i32 s[98:99],11,v204
 v_cndmask_b32 v4,v205,v4,s[84:85]
 v_cndmask_b32 v5,v205,v5,s[86:87]
 N v[48:63],a[244:247],a[180:183],v[48:63]
 W 2
 v_cndmask_b32 v6,v205,v6,s[88:89]
 v_cndmask_b32 v7,v205,v7,s[98:99]
 v_cmp_le_i32 s[84:85],16,v204
 v_cmp_le_i32 s[86:87],17,v204
 v_cmp_le_i32 s[88:89],18,v204
 v_cmp_le_i32 s[98:99],19,v204
 ds_read_b128 a[200:203],v193 offset:2048
 ds_read_b128 a[204:207],v193 offset:3072
 v_cndmask_b32 v8,v205,v8,s[84:85]
 v_cndmask_b32 v9,v205,v9,s[86:87]
 v_cndmask_b32 v10,v205,v10,s[88:89]
 v_cndmask_b32 v11,v205,v11,s[98:99]
 N v[48:63],a[248:251],a[184:187],v[48:63]
 buffer_load_dwordx4 v243,s[40:43],s69 offen offset:3072 sc1 lds
 v_cmp_le_i32 s[84:85],24,v204
 v_cmp_le_i32 s[86:87],25,v204
 v_cmp_le_i32 s[88:89],26,v204
 v_cmp_le_i32 s[98:99],27,v204
 v_cndmask_b32 v12,v205,v12,s[84:85]
 v_cndmask_b32 v13,v205,v13,s[86:87]
 v_cndmask_b32 v14,v205,v14,s[88:89]
 v_cndmask_b32 v15,v205,v15,s[98:99]
 v_max_f32 v200,v197,v199
 N v[48:63],a[252:255],a[188:191],v[48:63]
 W 2
 v_cmp_lt_f32 vcc,s78,v200
 s_cbranch_vccz F_c15
 s_call_b64 s[82:83],F_XAA1
F_c15:
 v_add_f32 v196,v196,v197
 v_add_f32 v198,v198,v199
 s_add_u32 s75,s75,64
 N a[0:15],a[192:195],v[64:67],a[0:15]
 ds_read_b128 a[208:211],v193 offset:4096
 ds_read_b128 a[212:215],v193 offset:5120
 v_exp_f32 v0,v0
 v_exp_f32 v1,v1
 N a[64:79],a[192:195],v[80:83],a[64:79]
 v_exp_f32 v2,v2
 v_add_f32 v197,v0,v1
 v_exp_f32 v3,v3
 v_cvt_pk_bf16_f32 v0,v0,v1
 N a[16:31],a[196:199],v[64:67],a[16:31]
 v_exp_f32 v4,v4
 v_add_f32 v197,v197,v2
 v_exp_f32 v5,v5
 v_cvt_pk_bf16_f32 v1,v2,v3
 N a[80:95],a[196:199],v[80:83],a[80:95]
 W 2
 v_add_f32 v197,v197,v3
 v_exp_f32 v6,v6
 v_add_f32 v197,v197,v4
 v_exp_f32 v7,v7
 N a[32:47],a[200:203],v[64:67],a[32:47]
 ds_read_b128 a[216:219],v193 offset:6144
 ds_read_b128 a[220:223],v193 offset:7168
 v_cvt_pk_bf16_f32 v2,v4,v5
 v_add_f32 v197,v197,v5
 v_exp_f32 v8,v8
 N a[96:111],a[200:203],v[80:83],a[96:111]
 v_add_f32 v197,v197,v6
 v_exp_f32 v9,v9
 v_cvt_pk_bf16_f32 v3,v6,v7
 v_add_f32 v197,v197,v7
 N a[48:63],a[204:207],v[64:67],a[48:63]
 v_exp_f32 v10,v10
 v_add_f32 v197,v197,v8
 v_exp_f32 v11,v11
 v_add_f32 v197,v197,v9
 N a[112:127],a[204:207],v[80:83],a[112:127]
 W 2
 v_cvt_pk_bf16_f32 v8,v8,v9
 v_exp_f32 v12,v12
 v_add_f32 v197,v197,v10
 v_exp_f32 v13,v13
 N a[0:15],a[208:211],v[72:75],a[0:15]
 ds_read_b128 a[224:227],v193 offset:8192
 ds_read_b128 a[228:231],v193 offset:9216
 v_cvt_pk_bf16_f32 v9,v10,v11
 v_add_f32 v197,v197,v11
 v_exp_f32 v14,v14
 N a[64:79],a[208:211],v[88:91],a[64:79]
 v_add_f32 v197,v197,v12
 v_exp_f32 v15,v15
 v_cvt_pk_bf16_f32 v10,v12,v13
 v_add_f32 v197,v197,v13
 v_add_f32 v197,v197,v14
 N a[16:31],a[212:215],v[72:75],a[16:31]
 v_cvt_pk_bf16_f32 v11,v14,v15
 v_add_f32 v197,v197,v15
 v_exp_f32 v16,v16
 v_exp_f32 v17,v17
 N a[80:95],a[212:215],v[88:91],a[80:95]
 W 2
 v_exp_f32 v18,v18
 v_add_f32 v199,v16,v17
 v_exp_f32 v19,v19
 v_cvt_pk_bf16_f32 v16,v16,v17
 N a[32:47],a[216:219],v[72:75],a[32:47]
 ds_read_b128 a[232:235],v193 offset:10240
 ds_read_b128 a[236:239],v193 offset:11264
 v_exp_f32 v20,v20
 v_add_f32 v199,v199,v18
 N a[96:111],a[216:219],v[88:91],a[96:111]
 v_exp_f32 v21,v21
 v_cvt_pk_bf16_f32 v17,v18,v19
 v_add_f32 v199,v199,v19
 v_exp_f32 v22,v22
 N a[48:63],a[220:223],v[72:75],a[48:63]
 v_add_f32 v199,v199,v20
 v_exp_f32 v23,v23
 v_cvt_pk_bf16_f32 v18,v20,v21
 v_add_f32 v199,v199,v21
 N a[112:127],a[220:223],v[88:91],a[112:127]
 W 2
 v_exp_f32 v24,v24
 v_add_f32 v199,v199,v22
 v_exp_f32 v25,v25
 v_cvt_pk_bf16_f32 v19,v22,v23
 N a[0:15],a[224:227],v[96:99],a[0:15]
 ds_read_b128 a[240:243],v193 offset:12288
 ds_read_b128 a[244:247],v193 offset:13312
 v_add_f32 v199,v199,v23
 v_exp_f32 v26,v26
 v_add_f32 v199,v199,v24
 N a[64:79],a[224:227],v[112:115],a[64:79]
 v_exp_f32 v27,v27
 v_add_f32 v199,v199,v25
 v_cvt_pk_bf16_f32 v24,v24,v25
 v_exp_f32 v28,v28
 N a[16:31],a[228:231],v[96:99],a[16:31]
 v_add_f32 v199,v199,v26
 v_exp_f32 v29,v29
 v_cvt_pk_bf16_f32 v25,v26,v27
 v_add_f32 v199,v199,v27
 N a[80:95],a[228:231],v[112:115],a[80:95]
 W 2
 v_exp_f32 v30,v30
 v_add_f32 v199,v199,v28
 v_exp_f32 v31,v31
 v_cvt_pk_bf16_f32 v26,v28,v29
 N a[32:47],a[232:235],v[96:99],a[32:47]
 ds_read_b128 a[248:251],v193 offset:14336
 ds_read_b128 a[252:255],v193 offset:15360
 v_add_f32 v199,v199,v29
 v_add_f32 v199,v199,v30
 v_cvt_pk_bf16_f32 v27,v30,v31
 v_add_f32 v199,v199,v31
 N a[96:111],a[232:235],v[112:115],a[96:111]
 N a[48:63],a[236:239],v[96:99],a[48:63]
 v_add_u32 v192,s76,v224
 s_add_u32 s76,s76,16384
 s_and_b32 s76,s76,0xffff
 N a[112:127],a[236:239],v[112:115],a[112:127]
 W 2
 s_waitcnt vmcnt(16) lgkmcnt(0)
 s_barrier
 N a[0:15],a[240:243],v[104:107],a[0:15]
 ds_read_b128 a[192:195],v192 offset:0
 ds_read_b128 a[196:199],v192 offset:1024
 N a[64:79],a[240:243],v[120:123],a[64:79]
 ds_read_b128 a[200:203],v192 offset:2048
 ds_read_b128 a[204:207],v192 offset:3072
 N a[16:31],a[244:247],v[104:107],a[16:31]
 N a[80:95],a[244:247],v[120:123],a[80:95]
 ds_read_b128 a[208:211],v192 offset:4096
 ds_read_b128 a[212:215],v192 offset:5120
 N a[32:47],a[248:251],v[104:107],a[32:47]
 N a[96:111],a[248:251],v[120:123],a[96:111]
 ds_read_b128 a[216:219],v192 offset:6144
 ds_read_b128 a[220:223],v192 offset:7168
 N a[48:63],a[252:255],v[104:107],a[48:63]
 N a[112:127],a[252:255],v[120:123],a[112:127]
F_AAme0:
 v_exp_f32 v48,v48
 v_exp_f32 v49,v49
 v_exp_f32 v50,v50
 W 7
 N v[80:95],a[192:195],a[160:163],v[144:159]
 s_mov_b32 m0,s92
 s_mov_b32 s69,s91
 s_add_u32 s91,s91,17408
 s_add_u32 s92,s92,0x4000
 s_and_b32 s92,s92,0xffff
 buffer_load_dwordx4 v243,s[36:39],s69 offen offset:0 sc1 lds
 v_add_f32 v199,v199,v48
 v_exp_f32 v51,v51
 v_add_f32 v199,v199,v49
 v_cvt_pk_bf16_f32 v48,v48,v49
 W 6
 N v[80:95],a[196:199],a[164:167],v[80:95]
 W 4
 v_exp_f32 v52,v52
 v_add_f32 v199,v199,v50
 v_exp_f32 v53,v53
 v_cvt_pk_bf16_f32 v49,v50,v51
 buffer_load_dwordx4 v243,s[36:39],s69 offen offset:1024 sc1 lds
 v_add_f32 v199,v199,v51
 v_exp_f32 v54,v54
 v_add_f32 v199,v199,v52
 N v[80:95],a[200:203],a[168:171],v[80:95]
 v_exp_f32 v55,v55
 v_cvt_pk_bf16_f32 v50,v52,v53
 v_add_f32 v199,v199,v53
 v_exp_f32 v56,v56
 v_add_f32 v199,v199,v54
 v_exp_f32 v57,v57
 v_cvt_pk_bf16_f32 v51,v54,v55
 v_add_f32 v199,v199,v55
 N v[80:95],a[204:207],a[172:175],v[80:95]
 W 2
 buffer_load_dwordx4 v243,s[36:39],s69 offen offset:2048 sc1 lds
 v_exp_f32 v58,v58
 v_add_f32 v199,v199,v56
 ds_read_b128 a[224:227],v192 offset:8192
 ds_read_b128 a[228:231],v192 offset:9216
 v_exp_f32 v59,v59
 v_add_f32 v199,v199,v57
 v_cvt_pk_bf16_f32 v56,v56,v57
 N v[80:95],a[208:211],a[176:179],v[80:95]
 v_exp_f32 v60,v60
 v_add_f32 v199,v199,v58
 v_exp_f32 v61,v61
 v_cvt_pk_bf16_f32 v57,v58,v59
 buffer_load_dwordx4 v243,s[36:39],s69 offen offset:3072 sc1 lds
 v_add_f32 v199,v199,v59
 v_exp_f32 v62,v62
 v_add_f32 v199,v199,v60
 N v[80:95],a[212:215],a[180:183],v[80:95]
 W 2
 v_exp_f32 v63,v63
 v_cvt_pk_bf16_f32 v58,v60,v61
 v_add_f32 v199,v199,v61
 v_add_f32 v199,v199,v62
 v_cvt_pk_bf16_f32 v59,v62,v63
 ds_read_b128 a[232:235],v192 offset:10240
 ds_read_b128 a[236:239],v192 offset:11264
 v_add_f32 v199,v199,v63
 v_max_f32 v200,v197,v199
 N v[80:95],a[216:219],a[184:187],v[80:95]
 s_add_u32 m0,s94,0x10000
 s_mov_b32 s69,s93
 s_add_u32 s93,s93,17408
 s_add_u32 s94,s94,0x4000
 s_and_b32 s94,s94,0xffff
 buffer_load_dwordx4 v243,s[40:43],s69 offen offset:0 sc1 lds
 N v[80:95],a[220:223],a[188:191],v[80:95]
 W 2
 ds_read_b128 a[240:243],v192 offset:12288
 ds_read_b128 a[244:247],v192 offset:13312
 buffer_load_dwordx4 v243,s[40:43],s69 offen offset:1024 sc1 lds
 N v[112:127],a[224:227],a[160:163],v[144:159]
 N v[112:127],a[228:231],a[164:167],v[112:127]
 W 2
 buffer_load_dwordx4 v243,s[40:43],s69 offen offset:2048 sc1 lds
 ds_read_b128 a[248:251],v192 offset:14336
 ds_read_b128 a[252:255],v192 offset:15360
 N v[112:127],a[232:235],a[168:171],v[112:127]
 v_add_u32 v193,s77,v194
 s_add_u32 s77,s77,16384
 s_and_b32 s77,s77,0xffff
 buffer_load_dwordx4 v243,s[40:43],s69 offen offset:3072 sc1 lds
 N v[112:127],a[236:239],a[172:175],v[112:127]
 W 2
 ds_read_b128 a[192:195],v193 offset:0
 ds_read_b128 a[196:199],v193 offset:1024
 N v[112:127],a[240:243],a[176:179],v[112:127]
 s_add_u32 m0,s72,131072
 s_add_u32 s68,s3,0
 buffer_load_dwordx4 v220,s[48:51],s68 offen lds
 N v[112:127],a[244:247],a[180:183],v[112:127]
 W 2
 ds_read_b128 a[200:203],v193 offset:2048
 ds_read_b128 a[204:207],v193 offset:3072
 s_add_u32 m0,s72,135168
 s_add_u32 s68,s3,128
 buffer_load_dwordx4 v220,s[48:51],s68 offen lds
 N v[112:127],a[248:251],a[184:187],v[112:127]
 N v[112:127],a[252:255],a[188:191],v[112:127]
 W 2
 s_add_u32 m0,s72,139264
 s_add_u32 s68,s3,32768
 buffer_load_dwordx4 v220,s[48:51],s68 offen lds
 v_cmp_lt_f32 vcc,s78,v200
 s_cbranch_vccz F_c16
 s_call_b64 s[82:83],F_XAA0
F_c16:
 N a[0:15],a[192:195],v[0:3],a[0:15]
 ds_read_b128 a[208:211],v193 offset:4096
 ds_read_b128 a[212:215],v193 offset:5120
 v_add_f32 v196,v196,v197
 v_add_f32 v198,v198,v199
 s_add_u32 s75,s75,64
 N a[64:79],a[192:195],v[16:19],a[64:79]
 v_exp_f32 v80,v80
 v_exp_f32 v81,v81
 v_exp_f32 v82,v82
 N a[16:31],a[196:199],v[0:3],a[16:31]
 s_add_u32 m0,s72,143360
 s_add_u32 s68,s3,32896
 buffer_load_dwordx4 v220,s[48:51],s68 offen lds
 v_add_f32 v199,v80,v81
 v_exp_f32 v83,v83
 N a[80:95],a[196:199],v[16:19],a[80:95]
 W 2
 v_cvt_pk_bf16_f32 v80,v80,v81
 v_exp_f32 v84,v84
 v_add_f32 v199,v199,v82
 v_exp_f32 v85,v85
 N a[32:47],a[200:203],v[0:3],a[32:47]
 ds_read_b128 a[216:219],v193 offset:6144
 ds_read_b128 a[220:223],v193 offset:7168
 v_cvt_pk_bf16_f32 v81,v82,v83
 v_add_f32 v199,v199,v83
 v_exp_f32 v86,v86
 N a[96:111],a[200:203],v[16:19],a[96:111]
 s_add_u32 m0,s72,147456
 s_add_u32 s68,s3,65536
 buffer_load_dwordx4 v220,s[48:51],s68 offen lds
 v_add_f32 v199,v199,v84
 v_exp_f32 v87,v87
 N a[48:63],a[204:207],v[0:3],a[48:63]
 v_cvt_pk_bf16_f32 v82,v84,v85
 v_add_f32 v199,v199,v85
 v_exp_f32 v88,v88
 v_add_f32 v199,v199,v86
 N a[112:127],a[204:207],v[16:19],a[112:127]
 W 2
 v_exp_f32 v89,v89
 v_cvt_pk_bf16_f32 v83,v86,v87
 v_add_f32 v199,v199,v87
 v_exp_f32 v90,v90
 N a[0:15],a[208:211],v[8:11],a[0:15]
 ds_read_b128 a[224:227],v193 offset:8192
 ds_read_b128 a[228:231],v193 offset:9216
 s_add_u32 m0,s72,151552
 s_add_u32 s68,s3,65664
 buffer_load_dwordx4 v220,s[48:51],s68 offen lds
 N a[64:79],a[208:211],v[24:27],a[64:79]
 v_add_f32 v199,v199,v88
 v_exp_f32 v91,v91
 v_add_f32 v199,v199,v89
 v_cvt_pk_bf16_f32 v88,v88,v89
 N a[16:31],a[212:215],v[8:11],a[16:31]
 v_exp_f32 v92,v92
 v_add_f32 v199,v199,v90
 v_exp_f32 v93,v93
 v_cvt_pk_bf16_f32 v89,v90,v91
 N a[80:95],a[212:215],v[24:27],a[80:95]
 W 2
 s_add_u32 m0,s72,155648
 s_add_u32 s68,s3,98304
 buffer_load_dwordx4 v220,s[48:51],s68 offen lds
 v_add_f32 v199,v199,v91
 N a[32:47],a[216:219],v[8:11],a[32:47]
 ds_read_b128 a[232:235],v193 offset:10240
 ds_read_b128 a[236:239],v193 offset:11264
 v_exp_f32 v94,v94
 v_add_f32 v199,v199,v92
 N a[96:111],a[216:219],v[24:27],a[96:111]
 v_exp_f32 v95,v95
 v_cvt_pk_bf16_f32 v90,v92,v93
 v_add_f32 v199,v199,v93
 v_add_f32 v199,v199,v94
 v_cvt_pk_bf16_f32 v91,v94,v95
 N a[48:63],a[220:223],v[8:11],a[48:63]
 s_add_u32 m0,s72,159744
 s_add_u32 s68,s3,98432
 buffer_load_dwordx4 v220,s[48:51],s68 offen lds
 v_add_f32 v199,v199,v95
 N a[112:127],a[220:223],v[24:27],a[112:127]
 W 2
 ds_read_b128 a[240:243],v193 offset:12288
 ds_read_b128 a[244:247],v193 offset:13312
 N a[64:79],a[224:227],v[48:51],a[64:79]
 N a[80:95],a[228:231],v[48:51],a[80:95]
 W 2
 ds_read_b128 a[248:251],v193 offset:14336
 ds_read_b128 a[252:255],v193 offset:15360
 N a[96:111],a[232:235],v[48:51],a[96:111]
 v_add_u32 v192,s76,v224
 s_add_u32 s76,s76,32768
 s_and_b32 s76,s76,0xffff
 N a[112:127],a[236:239],v[48:51],a[112:127]
 W 2
 s_waitcnt vmcnt(16) lgkmcnt(0)
 s_barrier
 ds_read_b128 a[192:195],v192 offset:0
 ds_read_b128 a[196:199],v192 offset:1024
 N a[64:79],a[240:243],v[56:59],a[64:79]
 ds_read_b128 a[200:203],v192 offset:2048
 ds_read_b128 a[204:207],v192 offset:3072
 N a[80:95],a[244:247],v[56:59],a[80:95]
 ds_read_b128 a[208:211],v192 offset:4096
 ds_read_b128 a[212:215],v192 offset:5120
 N a[96:111],a[248:251],v[56:59],a[96:111]
 ds_read_b128 a[216:219],v192 offset:6144
 ds_read_b128 a[220:223],v192 offset:7168
 N a[112:127],a[252:255],v[56:59],a[112:127]
 s_cmp_eq_u32 s66, 7
 s_cbranch_scc1 F_AC0
 W 7
 N v[0:15],a[192:195],a[160:163],v[144:159]
 ds_read_b128 a[224:227],v192 offset:8192
 ds_read_b128 a[228:231],v192 offset:9216
 v_exp_f32 v112,v112
 v_exp_f32 v113,v113
 W 8
 N v[0:15],a[196:199],a[164:167],v[0:15]
 W 6
 s_mov_b32 m0,s92
 s_mov_b32 s69,s91
 s_add_u32 s91,s91,17408
 s_add_u32 s92,s92,0x4000
 s_and_b32 s92,s92,0xffff
 buffer_load_dwordx4 v243,s[36:39],s69 offen offset:0 sc1 lds
 N v[0:15],a[200:203],a[168:171],v[0:15]
 ds_read_b128 a[232:235],v192 offset:10240
 ds_read_b128 a[236:239],v192 offset:11264
 v_exp_f32 v114,v114
 v_add_f32 v199,v199,v112
 N v[0:15],a[204:207],a[172:175],v[0:15]
 W 6
 v_add_u32 v211,1,v211
 buffer_store_dword v211,v210,s[8:11],s73 offen sc0 sc1
 buffer_load_dwordx4 v243,s[36:39],s69 offen offset:1024 sc1 lds
 v_exp_f32 v115,v115
 N v[0:15],a[208:211],a[176:179],v[0:15]
 ds_read_b128 a[240:243],v192 offset:12288
 ds_read_b128 a[244:247],v192 offset:13312
 v_add_f32 v199,v199,v113
 v_cvt_pk_bf16_f32 v112,v112,v113
 v_exp_f32 v116,v116
 N v[0:15],a[212:215],a[180:183],v[0:15]
 W 6
 buffer_load_dwordx4 v243,s[36:39],s69 offen offset:2048 sc1 lds
 v_add_f32 v199,v199,v114
 v_exp_f32 v117,v117
 v_cvt_pk_bf16_f32 v113,v114,v115
 N v[0:15],a[216:219],a[184:187],v[0:15]
 ds_read_b128 a[248:251],v192 offset:14336
 ds_read_b128 a[252:255],v192 offset:15360
 v_add_f32 v199,v199,v115
 v_exp_f32 v118,v118
 v_add_f32 v199,v199,v116
 N v[0:15],a[220:223],a[188:191],v[0:15]
 W 6
 buffer_load_dwordx4 v243,s[36:39],s69 offen offset:3072 sc1 lds
 v_exp_f32 v119,v119
 v_cvt_pk_bf16_f32 v114,v116,v117
 v_add_f32 v199,v199,v117
 N v[16:31],a[224:227],a[160:163],v[144:159]
 ds_read_b128 a[192:195],v192 offset:16384
 ds_read_b128 a[196:199],v192 offset:17408
 v_exp_f32 v120,v120
 v_add_f32 v199,v199,v118
 N v[16:31],a[228:231],a[164:167],v[16:31]
 W 6
 v_exp_f32 v121,v121
 v_cvt_pk_bf16_f32 v115,v118,v119
 v_add_f32 v199,v199,v119
 v_exp_f32 v122,v122
 N v[16:31],a[232:235],a[168:171],v[16:31]
 ds_read_b128 a[200:203],v192 offset:18432
 ds_read_b128 a[204:207],v192 offset:19456
 v_add_f32 v199,v199,v120
 v_exp_f32 v123,v123
 v_add_f32 v199,v199,v121
 N v[16:31],a[236:239],a[172:175],v[16:31]
 W 6
 v_cvt_pk_bf16_f32 v120,v120,v121
 v_exp_f32 v124,v124
 v_add_f32 v199,v199,v122
 v_exp_f32 v125,v125
 N v[16:31],a[240:243],a[176:179],v[16:31]
 ds_read_b128 a[208:211],v192 offset:20480
 ds_read_b128 a[212:215],v192 offset:21504
 v_cvt_pk_bf16_f32 v121,v122,v123
 v_add_f32 v199,v199,v123
 v_exp_f32 v126,v126
 N v[16:31],a[244:247],a[180:183],v[16:31]
 W 6
 v_add_f32 v199,v199,v124
 v_exp_f32 v127,v127
 v_cvt_pk_bf16_f32 v122,v124,v125
 v_add_f32 v199,v199,v125
 v_add_f32 v199,v199,v126
 N v[16:31],a[248:251],a[184:187],v[16:31]
 ds_read_b128 a[216:219],v192 offset:22528
 ds_read_b128 a[220:223],v192 offset:23552
 v_cvt_pk_bf16_f32 v123,v126,v127
 v_add_f32 v199,v199,v127
 N v[16:31],a[252:255],a[188:191],v[16:31]
 W 6
 N v[32:47],a[192:195],a[160:163],v[144:159]
 ds_read_b128 a[224:227],v192 offset:24576
 ds_read_b128 a[228:231],v192 offset:25600
 N v[32:47],a[196:199],a[164:167],v[32:47]
 W 6
 N v[32:47],a[200:203],a[168:171],v[32:47]
 ds_read_b128 a[232:235],v192 offset:26624
 ds_read_b128 a[236:239],v192 offset:27648
 N v[32:47],a[204:207],a[172:175],v[32:47]
 W 6
 N v[32:47],a[208:211],a[176:179],v[32:47]
 ds_read_b128 a[240:243],v192 offset:28672
 ds_read_b128 a[244:247],v192 offset:29696
 N v[32:47],a[212:215],a[180:183],v[32:47]
 W 6
 N v[32:47],a[216:219],a[184:187],v[32:47]
 ds_read_b128 a[248:251],v192 offset:30720
 ds_read_b128 a[252:255],v192 offset:31744
 N v[32:47],a[220:223],a[188:191],v[32:47]
 W 6
 v_add_u32 v193,s77,v194
 s_add_u32 s77,s77,16384
 s_and_b32 s77,s77,0xffff
 N v[48:63],a[224:227],a[160:163],v[144:159]
 N v[48:63],a[228:231],a[164:167],v[48:63]
 W 4
 W 0
 s_barrier
 N v[48:63],a[232:235],a[168:171],v[48:63]
 ds_read_b128 a[192:195],v193 offset:0
 ds_read_b128 a[196:199],v193 offset:1024
 N v[48:63],a[236:239],a[172:175],v[48:63]
 s_add_u32 m0,s92,0x0
 N v[48:63],a[240:243],a[176:179],v[48:63]
 ds_read_b128 a[200:203],v193 offset:2048
 ds_read_b128 a[204:207],v193 offset:3072
 buffer_load_dwordx4 v243,s[36:39],s91 offen offset:0 sc1 lds
 N v[48:63],a[244:247],a[180:183],v[48:63]
 N v[48:63],a[248:251],a[184:187],v[48:63]
 buffer_load_dwordx4 v243,s[36:39],s91 offen offset:1024 sc1 lds
 N v[48:63],a[252:255],a[188:191],v[48:63]
 W 2
 v_cmp_lt_f32 vcc,s78,v199
 s_cbranch_vccz F_c17
 s_call_b64 s[82:83],F_XAB1
F_c17:
 v_add_f32 v198,v198,v199
 s_add_u32 s75,s75,64
 ds_read_b128 a[208:211],v193 offset:4096
 ds_read_b128 a[212:215],v193 offset:5120
 buffer_load_dwordx4 v243,s[36:39],s91 offen offset:2048 sc1 lds
 v_exp_f32 v0,v0
 N a[64:79],a[192:195],v[80:83],a[64:79]
 v_exp_f32 v1,v1
 v_exp_f32 v2,v2
 v_add_f32 v199,v0,v1
 buffer_load_dwordx4 v243,s[36:39],s91 offen offset:3072 sc1 lds
 v_exp_f32 v3,v3
 v_cvt_pk_bf16_f32 v0,v0,v1
 v_exp_f32 v4,v4
 N a[80:95],a[196:199],v[80:83],a[80:95]
 W 2
 v_add_f32 v199,v199,v2
 v_exp_f32 v5,v5
 v_cvt_pk_bf16_f32 v1,v2,v3
 v_add_f32 v199,v199,v3
 ds_read_b128 a[216:219],v193 offset:6144
 ds_read_b128 a[220:223],v193 offset:7168
 s_add_u32 m0,s92,0x4000
 s_add_u32 s69,s91,17408
 s_add_u32 s91,s91,34816
 s_xor_b32 s92,s92,0x8000
 buffer_load_dwordx4 v243,s[36:39],s69 offen offset:0 sc1 lds
 N a[96:111],a[200:203],v[80:83],a[96:111]
 v_exp_f32 v6,v6
 v_add_f32 v199,v199,v4
 v_exp_f32 v7,v7
 v_cvt_pk_bf16_f32 v2,v4,v5
 buffer_load_dwordx4 v243,s[36:39],s69 offen offset:1024 sc1 lds
 v_add_f32 v199,v199,v5
 v_exp_f32 v8,v8
 v_add_f32 v199,v199,v6
 N a[112:127],a[204:207],v[80:83],a[112:127]
 W 2
 v_exp_f32 v9,v9
 v_cvt_pk_bf16_f32 v3,v6,v7
 v_add_f32 v199,v199,v7
 v_exp_f32 v10,v10
 ds_read_b128 a[224:227],v193 offset:8192
 ds_read_b128 a[228:231],v193 offset:9216
 buffer_load_dwordx4 v243,s[36:39],s69 offen offset:2048 sc1 lds
 v_add_f32 v199,v199,v8
 N a[64:79],a[208:211],v[88:91],a[64:79]
 v_exp_f32 v11,v11
 v_add_f32 v199,v199,v9
 v_cvt_pk_bf16_f32 v8,v8,v9
 v_exp_f32 v12,v12
 buffer_load_dwordx4 v243,s[36:39],s69 offen offset:3072 sc1 lds
 v_add_f32 v199,v199,v10
 v_exp_f32 v13,v13
 v_cvt_pk_bf16_f32 v9,v10,v11
 v_add_f32 v199,v199,v11
 N a[80:95],a[212:215],v[88:91],a[80:95]
 W 2
 v_exp_f32 v14,v14
 v_add_f32 v199,v199,v12
 v_exp_f32 v15,v15
 v_cvt_pk_bf16_f32 v10,v12,v13
 ds_read_b128 a[232:235],v193 offset:10240
 ds_read_b128 a[236:239],v193 offset:11264
 v_add_f32 v199,v199,v13
 v_add_f32 v199,v199,v14
 v_cvt_pk_bf16_f32 v11,v14,v15
 v_add_f32 v199,v199,v15
 N a[96:111],a[216:219],v[88:91],a[96:111]
 buffer_load_dword v207,v208,s[8:11],0 offen sc1
 v_exp_f32 v16,v16
 v_exp_f32 v17,v17
 v_exp_f32 v18,v18
 v_add_f32 v199,v199,v16
 v_exp_f32 v19,v19
 v_add_f32 v199,v199,v17
 N a[112:127],a[220:223],v[88:91],a[112:127]
 W 2
 v_cvt_pk_bf16_f32 v16,v16,v17
 v_exp_f32 v20,v20
 v_add_f32 v199,v199,v18
 v_exp_f32 v21,v21
 ds_read_b128 a[240:243],v193 offset:12288
 ds_read_b128 a[244:247],v193 offset:13312
 v_cvt_pk_bf16_f32 v17,v18,v19
 v_add_f32 v199,v199,v19
 v_exp_f32 v22,v22
 N a[64:79],a[224:227],v[112:115],a[64:79]
 v_add_f32 v199,v199,v20
 v_exp_f32 v23,v23
 v_cvt_pk_bf16_f32 v18,v20,v21
 v_add_f32 v199,v199,v21
 v_exp_f32 v24,v24
 v_add_f32 v199,v199,v22
 v_exp_f32 v25,v25
 v_cvt_pk_bf16_f32 v19,v22,v23
 N a[80:95],a[228:231],v[112:115],a[80:95]
 W 2
 v_add_f32 v199,v199,v23
 v_exp_f32 v26,v26
 v_add_f32 v199,v199,v24
 v_exp_f32 v27,v27
 ds_read_b128 a[248:251],v193 offset:14336
 ds_read_b128 a[252:255],v193 offset:15360
 v_add_f32 v199,v199,v25
 v_cvt_pk_bf16_f32 v24,v24,v25
 v_exp_f32 v28,v28
 N a[96:111],a[232:235],v[112:115],a[96:111]
 v_add_f32 v199,v199,v26
 v_exp_f32 v29,v29
 v_cvt_pk_bf16_f32 v25,v26,v27
 v_add_f32 v199,v199,v27
 v_add_u32 v192,s76,v224
 s_add_u32 s76,s76,32768
 s_and_b32 s76,s76,0xffff
 v_exp_f32 v30,v30
 v_add_f32 v199,v199,v28
 N a[112:127],a[236:239],v[112:115],a[112:127]
 W 2
 s_waitcnt vmcnt(8) lgkmcnt(0)
 s_barrier
 v_exp_f32 v31,v31
 v_cvt_pk_bf16_f32 v26,v28,v29
 v_add_f32 v199,v199,v29
 ds_read_b128 a[192:195],v192 offset:0
 ds_read_b128 a[196:199],v192 offset:1024
 v_add_f32 v199,v199,v30
 v_cvt_pk_bf16_f32 v27,v30,v31
 v_add_f32 v199,v199,v31
 N a[64:79],a[240:243],v[120:123],a[64:79]
 ds_read_b128 a[200:203],v192 offset:2048
 ds_read_b128 a[204:207],v192 offset:3072
 N a[80:95],a[244:247],v[120:123],a[80:95]
 ds_read_b128 a[208:211],v192 offset:4096
 ds_read_b128 a[212:215],v192 offset:5120
 N a[96:111],a[248:251],v[120:123],a[96:111]
 ds_read_b128 a[216:219],v192 offset:6144
 ds_read_b128 a[220:223],v192 offset:7168
 N a[112:127],a[252:255],v[120:123],a[112:127]
 s_branch F_FINL
F_AAmo1:
 W 7
 N v[0:15],a[192:195],a[128:131],v[128:143]
 v_exp_f32 v96,v96
 v_exp_f32 v97,v97
 v_exp_f32 v98,v98
 N v[16:31],a[192:195],a[160:163],v[144:159]
 s_mov_b32 m0,s92
 s_mov_b32 s69,s91
 s_add_u32 s91,s91,17408
 s_add_u32 s92,s92,0x4000
 s_and_b32 s92,s92,0xffff
 buffer_load_dwordx4 v243,s[36:39],s69 offen offset:0 sc1 lds
 W 6
 N v[0:15],a[196:199],a[132:135],v[0:15]
 v_add_f32 v197,v197,v96
 v_exp_f32 v99,v99
 v_add_f32 v197,v197,v97
 v_cvt_pk_bf16_f32 v96,v96,v97
 N v[16:31],a[196:199],a[164:167],v[16:31]
 W 4
 v_exp_f32 v100,v100
 v_add_f32 v197,v197,v98
 v_exp_f32 v101,v101
 v_cvt_pk_bf16_f32 v97,v98,v99
 N v[0:15],a[200:203],a[136:139],v[0:15]
 v_add_f32 v197,v197,v99
 v_exp_f32 v102,v102
 v_add_f32 v197,v197,v100
 v_exp_f32 v103,v103
 N v[16:31],a[200:203],a[168:171],v[16:31]
 buffer_load_dwordx4 v243,s[36:39],s69 offen offset:1024 sc1 lds
 v_cvt_pk_bf16_f32 v98,v100,v101
 v_add_f32 v197,v197,v101
 v_exp_f32 v104,v104
 v_add_f32 v197,v197,v102
 N v[0:15],a[204:207],a[140:143],v[0:15]
 v_exp_f32 v105,v105
 v_cvt_pk_bf16_f32 v99,v102,v103
 v_add_f32 v197,v197,v103
 v_exp_f32 v106,v106
 N v[16:31],a[204:207],a[172:175],v[16:31]
 W 2
 v_add_f32 v197,v197,v104
 v_exp_f32 v107,v107
 v_add_f32 v197,v197,v105
 v_cvt_pk_bf16_f32 v104,v104,v105
 N v[0:15],a[208:211],a[144:147],v[0:15]
 ds_read_b128 a[224:227],v192 offset:8192
 ds_read_b128 a[228:231],v192 offset:9216
 v_exp_f32 v108,v108
 v_add_f32 v197,v197,v106
 N v[16:31],a[208:211],a[176:179],v[16:31]
 buffer_load_dwordx4 v243,s[36:39],s69 offen offset:2048 sc1 lds
 v_exp_f32 v109,v109
 v_cvt_pk_bf16_f32 v105,v106,v107
 v_add_f32 v197,v197,v107
 N v[0:15],a[212:215],a[148:151],v[0:15]
 v_exp_f32 v110,v110
 v_add_f32 v197,v197,v108
 v_exp_f32 v111,v111
 v_cvt_pk_bf16_f32 v106,v108,v109
 N v[16:31],a[212:215],a[180:183],v[16:31]
 W 2
 v_add_f32 v197,v197,v109
 v_add_f32 v197,v197,v110
 v_cvt_pk_bf16_f32 v107,v110,v111
 v_add_f32 v197,v197,v111
 v_exp_f32 v112,v112
 N v[0:15],a[216:219],a[152:155],v[0:15]
 ds_read_b128 a[232:235],v192 offset:10240
 ds_read_b128 a[236:239],v192 offset:11264
 v_exp_f32 v113,v113
 v_exp_f32 v114,v114
 N v[16:31],a[216:219],a[184:187],v[16:31]
 buffer_load_dwordx4 v243,s[36:39],s69 offen offset:3072 sc1 lds
 v_add_f32 v199,v199,v112
 v_exp_f32 v115,v115
 v_add_f32 v199,v199,v113
 v_cvt_pk_bf16_f32 v112,v112,v113
 N v[0:15],a[220:223],a[156:159],v[0:15]
 v_exp_f32 v116,v116
 v_add_f32 v199,v199,v114
 v_exp_f32 v117,v117
 v_cvt_pk_bf16_f32 v113,v114,v115
 N v[16:31],a[220:223],a[188:191],v[16:31]
 W 2
 v_add_f32 v199,v199,v115
 v_exp_f32 v118,v118
 v_add_f32 v199,v199,v116
 v_exp_f32 v119,v119
 N v[32:47],a[224:227],a[128:131],v[128:143]
 ds_read_b128 a[240:243],v192 offset:12288
 ds_read_b128 a[244:247],v192 offset:13312
 v_cvt_pk_bf16_f32 v114,v116,v117
 v_add_f32 v199,v199,v117
 v_exp_f32 v120,v120
 N v[48:63],a[224:227],a[160:163],v[144:159]
 s_add_u32 m0,s94,0x10000
 s_mov_b32 s69,s93
 s_add_u32 s93,s93,17408
 s_add_u32 s94,s94,0x4000
 s_and_b32 s94,s94,0xffff
 buffer_load_dwordx4 v243,s[40:43],s69 offen offset:0 sc1 lds
 N v[32:47],a[228:231],a[132:135],v[32:47]
 v_add_f32 v199,v199,v118
 v_exp_f32 v121,v121
 v_cvt_pk_bf16_f32 v115,v118,v119
 v_add_f32 v199,v199,v119
 N v[48:63],a[228:231],a[164:167],v[48:63]
 W 2
 v_exp_f32 v122,v122
 v_add_f32 v199,v199,v120
 v_exp_f32 v123,v123
 v_add_f32 v199,v199,v121
 N v[32:47],a[232:235],a[136:139],v[32:47]
 ds_read_b128 a[248:251],v192 offset:14336
 ds_read_b128 a[252:255],v192 offset:15360
 v_cvt_pk_bf16_f32 v120,v120,v121
 v_exp_f32 v124,v124
 v_add_f32 v199,v199,v122
 N v[48:63],a[232:235],a[168:171],v[48:63]
 v_add_u32 v193,s77,v194
 s_add_u32 s77,s77,16384
 s_and_b32 s77,s77,0xffff
 buffer_load_dwordx4 v243,s[40:43],s69 offen offset:1024 sc1 lds
 v_exp_f32 v125,v125
 N v[32:47],a[236:239],a[140:143],v[32:47]
 v_cvt_pk_bf16_f32 v121,v122,v123
 v_add_f32 v199,v199,v123
 v_exp_f32 v126,v126
 v_add_f32 v199,v199,v124
 N v[48:63],a[236:239],a[172:175],v[48:63]
 W 2
 v_exp_f32 v127,v127
 v_cvt_pk_bf16_f32 v122,v124,v125
 v_add_f32 v199,v199,v125
 v_add_f32 v199,v199,v126
 v_cvt_pk_bf16_f32 v123,v126,v127
 N v[32:47],a[240:243],a[144:147],v[32:47]
 ds_read_b128 a[192:195],v193 offset:0
 ds_read_b128 a[196:199],v193 offset:1024
 v_add_f32 v199,v199,v127
 v_max_f32 v200,v197,v199
 N v[48:63],a[240:243],a[176:179],v[48:63]
 buffer_load_dwordx4 v243,s[40:43],s69 offen offset:2048 sc1 lds
 N v[32:47],a[244:247],a[148:151],v[32:47]
 N v[48:63],a[244:247],a[180:183],v[48:63]
 W 2
 N v[32:47],a[248:251],a[152:155],v[32:47]
 ds_read_b128 a[200:203],v193 offset:2048
 ds_read_b128 a[204:207],v193 offset:3072
 N v[48:63],a[248:251],a[184:187],v[48:63]
 buffer_load_dwordx4 v243,s[40:43],s69 offen offset:3072 sc1 lds
 N v[32:47],a[252:255],a[156:159],v[32:47]
 N v[48:63],a[252:255],a[188:191],v[48:63]
 W 2
 v_cmp_lt_f32 vcc,s78,v200
 s_cbranch_vccz F_c20
 s_call_b64 s[82:83],F_XAA1
F_c20:
 v_add_f32 v196,v196,v197
 v_add_f32 v198,v198,v199
 s_add_u32 s75,s75,64
 N a[0:15],a[192:195],v[64:67],a[0:15]
 ds_read_b128 a[208:211],v193 offset:4096
 ds_read_b128 a[212:215],v193 offset:5120
 v_exp_f32 v0,v0
 v_exp_f32 v1,v1
 N a[64:79],a[192:195],v[80:83],a[64:79]
 v_exp_f32 v2,v2
 v_add_f32 v197,v0,v1
 v_exp_f32 v3,v3
 v_cvt_pk_bf16_f32 v0,v0,v1
 N a[16:31],a[196:199],v[64:67],a[16:31]
 v_exp_f32 v4,v4
 v_add_f32 v197,v197,v2
 v_exp_f32 v5,v5
 v_cvt_pk_bf16_f32 v1,v2,v3
 N a[80:95],a[196:199],v[80:83],a[80:95]
 W 2
 v_add_f32 v197,v197,v3
 v_exp_f32 v6,v6
 v_add_f32 v197,v197,v4
 v_exp_f32 v7,v7
 N a[32:47],a[200:203],v[64:67],a[32:47]
 ds_read_b128 a[216:219],v193 offset:6144
 ds_read_b128 a[220:223],v193 offset:7168
 v_cvt_pk_bf16_f32 v2,v4,v5
 v_add_f32 v197,v197,v5
 v_exp_f32 v8,v8
 N a[96:111],a[200:203],v[80:83],a[96:111]
 v_add_f32 v197,v197,v6
 v_exp_f32 v9,v9
 v_cvt_pk_bf16_f32 v3,v6,v7
 v_add_f32 v197,v197,v7
 N a[48:63],a[204:207],v[64:67],a[48:63]
 v_exp_f32 v10,v10
 v_add_f32 v197,v197,v8
 v_exp_f32 v11,v11
 v_add_f32 v197,v197,v9
 N a[112:127],a[204:207],v[80:83],a[112:127]
 W 2
 v_cvt_pk_bf16_f32 v8,v8,v9
 v_exp_f32 v12,v12
 v_add_f32 v197,v197,v10
 v_exp_f32 v13,v13
 N a[0:15],a[208:211],v[72:75],a[0:15]
 ds_read_b128 a[224:227],v193 offset:8192
 ds_read_b128 a[228:231],v193 offset:9216
 v_cvt_pk_bf16_f32 v9,v10,v11
 v_add_f32 v197,v197,v11
 v_exp_f32 v14,v14
 N a[64:79],a[208:211],v[88:91],a[64:79]
 v_add_f32 v197,v197,v12
 v_exp_f32 v15,v15
 v_cvt_pk_bf16_f32 v10,v12,v13
 v_add_f32 v197,v197,v13
 v_add_f32 v197,v197,v14
 N a[16:31],a[212:215],v[72:75],a[16:31]
 v_cvt_pk_bf16_f32 v11,v14,v15
 v_add_f32 v197,v197,v15
 v_subrev_u32 v206,32,v204
 v_cmp_le_i32 s[84:85],0,v206
 v_cmp_le_i32 s[86:87],1,v206
 v_cmp_le_i32 s[88:89],2,v206
 N a[80:95],a[212:215],v[88:91],a[80:95]
 W 2
 v_cmp_le_i32 s[98:99],3,v206
 v_cndmask_b32 v32,v205,v32,s[84:85]
 v_cndmask_b32 v33,v205,v33,s[86:87]
 v_cndmask_b32 v34,v205,v34,s[88:89]
 v_cndmask_b32 v35,v205,v35,s[98:99]
 v_cmp_le_i32 s[84:85],8,v206
 N a[32:47],a[216:219],v[72:75],a[32:47]
 ds_read_b128 a[232:235],v193 offset:10240
 ds_read_b128 a[236:239],v193 offset:11264
 v_cmp_le_i32 s[86:87],9,v206
 v_cmp_le_i32 s[88:89],10,v206
 v_cmp_le_i32 s[98:99],11,v206
 v_cndmask_b32 v36,v205,v36,s[84:85]
 N a[96:111],a[216:219],v[88:91],a[96:111]
 v_cndmask_b32 v37,v205,v37,s[86:87]
 v_cndmask_b32 v38,v205,v38,s[88:89]
 v_cndmask_b32 v39,v205,v39,s[98:99]
 v_cmp_le_i32 s[84:85],16,v206
 v_cmp_le_i32 s[86:87],17,v206
 v_cmp_le_i32 s[88:89],18,v206
 N a[48:63],a[220:223],v[72:75],a[48:63]
 v_cmp_le_i32 s[98:99],19,v206
 v_cndmask_b32 v40,v205,v40,s[84:85]
 v_cndmask_b32 v41,v205,v41,s[86:87]
 v_cndmask_b32 v42,v205,v42,s[88:89]
 v_cndmask_b32 v43,v205,v43,s[98:99]
 v_cmp_le_i32 s[84:85],24,v206
 N a[112:127],a[220:223],v[88:91],a[112:127]
 W 2
 v_cmp_le_i32 s[86:87],25,v206
 v_cmp_le_i32 s[88:89],26,v206
 v_cmp_le_i32 s[98:99],27,v206
 v_cndmask_b32 v44,v205,v44,s[84:85]
 v_cndmask_b32 v45,v205,v45,s[86:87]
 v_cndmask_b32 v46,v205,v46,s[88:89]
 N a[0:15],a[224:227],v[96:99],a[0:15]
 ds_read_b128 a[240:243],v193 offset:12288
 ds_read_b128 a[244:247],v193 offset:13312
 v_cndmask_b32 v47,v205,v47,s[98:99]
 v_exp_f32 v16,v16
 N a[64:79],a[224:227],v[112:115],a[64:79]
 v_exp_f32 v17,v17
 v_exp_f32 v18,v18
 v_add_f32 v199,v16,v17
 N a[16:31],a[228:231],v[96:99],a[16:31]
 v_exp_f32 v19,v19
 v_cvt_pk_bf16_f32 v16,v16,v17
 v_exp_f32 v20,v20
 v_add_f32 v199,v199,v18
 N a[80:95],a[228:231],v[112:115],a[80:95]
 W 2
 v_exp_f32 v21,v21
 v_cvt_pk_bf16_f32 v17,v18,v19
 v_add_f32 v199,v199,v19
 v_exp_f32 v22,v22
 N a[32:47],a[232:235],v[96:99],a[32:47]
 ds_read_b128 a[248:251],v193 offset:14336
 ds_read_b128 a[252:255],v193 offset:15360
 v_add_f32 v199,v199,v20
 v_exp_f32 v23,v23
 v_cvt_pk_bf16_f32 v18,v20,v21
 N a[96:111],a[232:235],v[112:115],a[96:111]
 v_add_f32 v199,v199,v21
 v_exp_f32 v24,v24
 v_add_f32 v199,v199,v22
 v_exp_f32 v25,v25
 N a[48:63],a[236:239],v[96:99],a[48:63]
 v_add_u32 v192,s76,v224
 s_add_u32 s76,s76,16384
 s_and_b32 s76,s76,0xffff
 v_cvt_pk_bf16_f32 v19,v22,v23
 v_add_f32 v199,v199,v23
 v_exp_f32 v26,v26
 N a[112:127],a[236:239],v[112:115],a[112:127]
 W 2
 s_waitcnt vmcnt(16) lgkmcnt(0)
 s_barrier
 v_add_f32 v199,v199,v24
 v_exp_f32 v27,v27
 v_add_f32 v199,v199,v25
 N a[0:15],a[240:243],v[104:107],a[0:15]
 ds_read_b128 a[192:195],v192 offset:0
 ds_read_b128 a[196:199],v192 offset:1024
 v_cvt_pk_bf16_f32 v24,v24,v25
 v_exp_f32 v28,v28
 v_add_f32 v199,v199,v26
 N a[64:79],a[240:243],v[120:123],a[64:79]
 ds_read_b128 a[200:203],v192 offset:2048
 ds_read_b128 a[204:207],v192 offset:3072
 v_exp_f32 v29,v29
 v_cvt_pk_bf16_f32 v25,v26,v27
 v_add_f32 v199,v199,v27
 N a[16:31],a[244:247],v[104:107],a[16:31]
 v_exp_f32 v30,v30
 v_add_f32 v199,v199,v28
 v_exp_f32 v31,v31
 v_cvt_pk_bf16_f32 v26,v28,v29
 N a[80:95],a[244:247],v[120:123],a[80:95]
 ds_read_b128 a[208:211],v192 offset:4096
 ds_read_b128 a[212:215],v192 offset:5120
 v_add_f32 v199,v199,v29
 v_add_f32 v199,v199,v30
 v_cvt_pk_bf16_f32 v27,v30,v31
 N a[32:47],a[248:251],v[104:107],a[32:47]
 v_add_f32 v199,v199,v31
 N a[96:111],a[248:251],v[120:123],a[96:111]
 ds_read_b128 a[216:219],v192 offset:6144
 ds_read_b128 a[220:223],v192 offset:7168
 N a[48:63],a[252:255],v[104:107],a[48:63]
 N a[112:127],a[252:255],v[120:123],a[112:127]
F_AAme1:
 v_exp_f32 v32,v32
 v_exp_f32 v33,v33
 v_exp_f32 v34,v34
 W 7
 N v[80:95],a[192:195],a[160:163],v[144:159]
 s_mov_b32 m0,s92
 s_mov_b32 s69,s91
 s_add_u32 s91,s91,17408
 s_add_u32 s92,s92,0x4000
 s_and_b32 s92,s92,0xffff
 buffer_load_dwordx4 v243,s[36:39],s69 offen offset:0 sc1 lds
 v_add_f32 v197,v197,v32
 v_exp_f32 v35,v35
 v_add_f32 v197,v197,v33
 v_cvt_pk_bf16_f32 v32,v32,v33
 W 6
 N v[80:95],a[196:199],a[164:167],v[80:95]
 W 4
 v_exp_f32 v36,v36
 v_add_f32 v197,v197,v34
 v_exp_f32 v37,v37
 v_cvt_pk_bf16_f32 v33,v34,v35
 buffer_load_dwordx4 v243,s[36:39],s69 offen offset:1024 sc1 lds
 v_add_f32 v197,v197,v35
 v_exp_f32 v38,v38
 v_add_f32 v197,v197,v36
 N v[80:95],a[200:203],a[168:171],v[80:95]
 v_exp_f32 v39,v39
 v_cvt_pk_bf16_f32 v34,v36,v37
 v_add_f32 v197,v197,v37
 v_exp_f32 v40,v40
 v_add_f32 v197,v197,v38
 v_exp_f32 v41,v41
 v_cvt_pk_bf16_f32 v35,v38,v39
 v_add_f32 v197,v197,v39
 N v[80:95],a[204:207],a[172:175],v[80:95]
 W 2
 buffer_load_dwordx4 v243,s[36:39],s69 offen offset:2048 sc1 lds
 v_exp_f32 v42,v42
 v_add_f32 v197,v197,v40
 ds_read_b128 a[224:227],v192 offset:8192
 ds_read_b128 a[228:231],v192 offset:9216
 v_exp_f32 v43,v43
 v_add_f32 v197,v197,v41
 v_cvt_pk_bf16_f32 v40,v40,v41
 N v[80:95],a[208:211],a[176:179],v[80:95]
 v_exp_f32 v44,v44
 v_add_f32 v197,v197,v42
 v_exp_f32 v45,v45
 v_cvt_pk_bf16_f32 v41,v42,v43
 buffer_load_dwordx4 v243,s[36:39],s69 offen offset:3072 sc1 lds
 v_add_f32 v197,v197,v43
 v_exp_f32 v46,v46
 v_add_f32 v197,v197,v44
 N v[80:95],a[212:215],a[180:183],v[80:95]
 W 2
 v_exp_f32 v47,v47
 v_cvt_pk_bf16_f32 v42,v44,v45
 v_add_f32 v197,v197,v45
 v_add_f32 v197,v197,v46
 v_cvt_pk_bf16_f32 v43,v46,v47
 ds_read_b128 a[232:235],v192 offset:10240
 ds_read_b128 a[236:239],v192 offset:11264
 v_add_f32 v197,v197,v47
 v_exp_f32 v48,v48
 N v[80:95],a[216:219],a[184:187],v[80:95]
 s_add_u32 m0,s94,0x10000
 s_mov_b32 s69,s93
 s_add_u32 s93,s93,17408
 s_add_u32 s94,s94,0x4000
 s_and_b32 s94,s94,0xffff
 buffer_load_dwordx4 v243,s[40:43],s69 offen offset:0 sc1 lds
 v_exp_f32 v49,v49
 v_exp_f32 v50,v50
 v_add_f32 v199,v199,v48
 N v[80:95],a[220:223],a[188:191],v[80:95]
 W 2
 v_exp_f32 v51,v51
 v_add_f32 v199,v199,v49
 v_cvt_pk_bf16_f32 v48,v48,v49
 v_exp_f32 v52,v52
 ds_read_b128 a[240:243],v192 offset:12288
 ds_read_b128 a[244:247],v192 offset:13312
 buffer_load_dwordx4 v243,s[40:43],s69 offen offset:1024 sc1 lds
 v_add_f32 v199,v199,v50
 N v[112:127],a[224:227],a[160:163],v[144:159]
 v_exp_f32 v53,v53
 v_cvt_pk_bf16_f32 v49,v50,v51
 v_add_f32 v199,v199,v51
 v_exp_f32 v54,v54
 v_add_f32 v199,v199,v52
 v_exp_f32 v55,v55
 v_cvt_pk_bf16_f32 v50,v52,v53
 v_add_f32 v199,v199,v53
 N v[112:127],a[228:231],a[164:167],v[112:127]
 W 2
 buffer_load_dwordx4 v243,s[40:43],s69 offen offset:2048 sc1 lds
 v_exp_f32 v56,v56
 v_add_f32 v199,v199,v54
 ds_read_b128 a[248:251],v192 offset:14336
 ds_read_b128 a[252:255],v192 offset:15360
 v_exp_f32 v57,v57
 v_cvt_pk_bf16_f32 v51,v54,v55
 v_add_f32 v199,v199,v55
 N v[112:127],a[232:235],a[168:171],v[112:127]
 v_add_u32 v193,s77,v194
 s_add_u32 s77,s77,16384
 s_and_b32 s77,s77,0xffff
 v_exp_f32 v58,v58
 v_add_f32 v199,v199,v56
 buffer_load_dwordx4 v243,s[40:43],s69 offen offset:3072 sc1 lds
 v_exp_f32 v59,v59
 v_add_f32 v199,v199,v57
 v_cvt_pk_bf16_f32 v56,v56,v57
 N v[112:127],a[236:239],a[172:175],v[112:127]
 W 2
 v_exp_f32 v60,v60
 v_add_f32 v199,v199,v58
 v_exp_f32 v61,v61
 v_cvt_pk_bf16_f32 v57,v58,v59
 ds_read_b128 a[192:195],v193 offset:0
 ds_read_b128 a[196:199],v193 offset:1024
 v_add_f32 v199,v199,v59
 v_exp_f32 v62,v62
 v_add_f32 v199,v199,v60
 N v[112:127],a[240:243],a[176:179],v[112:127]
 s_add_u32 m0,s72,131072
 s_add_u32 s68,s3,0
 buffer_load_dwordx4 v220,s[48:51],s68 offen lds
 v_exp_f32 v63,v63
 v_cvt_pk_bf16_f32 v58,v60,v61
 v_add_f32 v199,v199,v61
 v_add_f32 v199,v199,v62
 v_cvt_pk_bf16_f32 v59,v62,v63
 v_add_f32 v199,v199,v63
 v_max_f32 v200,v197,v199
 N v[112:127],a[244:247],a[180:183],v[112:127]
 W 2
 ds_read_b128 a[200:203],v193 offset:2048
 ds_read_b128 a[204:207],v193 offset:3072
 s_add_u32 m0,s72,135168
 s_add_u32 s68,s3,128
 buffer_load_dwordx4 v220,s[48:51],s68 offen lds
 N v[112:127],a[248:251],a[184:187],v[112:127]
 N v[112:127],a[252:255],a[188:191],v[112:127]
 W 2
 s_add_u32 m0,s72,139264
 s_add_u32 s68,s3,32768
 buffer_load_dwordx4 v220,s[48:51],s68 offen lds
 v_cmp_lt_f32 vcc,s78,v200
 s_cbranch_vccz F_c21
 s_call_b64 s[82:83],F_XAA0
F_c21:
 N a[0:15],a[192:195],v[0:3],a[0:15]
 ds_read_b128 a[208:211],v193 offset:4096
 ds_read_b128 a[212:215],v193 offset:5120
 v_add_f32 v196,v196,v197
 v_add_f32 v198,v198,v199
 s_add_u32 s75,s75,64
 N a[64:79],a[192:195],v[16:19],a[64:79]
 v_exp_f32 v80,v80
 v_exp_f32 v81,v81
 v_exp_f32 v82,v82
 N a[16:31],a[196:199],v[0:3],a[16:31]
 s_add_u32 m0,s72,143360
 s_add_u32 s68,s3,32896
 buffer_load_dwordx4 v220,s[48:51],s68 offen lds
 v_add_f32 v199,v80,v81
 v_exp_f32 v83,v83
 N a[80:95],a[196:199],v[16:19],a[80:95]
 W 2
 v_cvt_pk_bf16_f32 v80,v80,v81
 v_exp_f32 v84,v84
 v_add_f32 v199,v199,v82
 v_exp_f32 v85,v85
 N a[32:47],a[200:203],v[0:3],a[32:47]
 ds_read_b128 a[216:219],v193 offset:6144
 ds_read_b128 a[220:223],v193 offset:7168
 v_cvt_pk_bf16_f32 v81,v82,v83
 v_add_f32 v199,v199,v83
 v_exp_f32 v86,v86
 N a[96:111],a[200:203],v[16:19],a[96:111]
 s_add_u32 m0,s72,147456
 s_add_u32 s68,s3,65536
 buffer_load_dwordx4 v220,s[48:51],s68 offen lds
 v_add_f32 v199,v199,v84
 v_exp_f32 v87,v87
 N a[48:63],a[204:207],v[0:3],a[48:63]
 v_cvt_pk_bf16_f32 v82,v84,v85
 v_add_f32 v199,v199,v85
 v_exp_f32 v88,v88
 v_add_f32 v199,v199,v86
 N a[112:127],a[204:207],v[16:19],a[112:127]
 W 2
 v_exp_f32 v89,v89
 v_cvt_pk_bf16_f32 v83,v86,v87
 v_add_f32 v199,v199,v87
 v_exp_f32 v90,v90
 N a[0:15],a[208:211],v[8:11],a[0:15]
 ds_read_b128 a[224:227],v193 offset:8192
 ds_read_b128 a[228:231],v193 offset:9216
 s_add_u32 m0,s72,151552
 s_add_u32 s68,s3,65664
 buffer_load_dwordx4 v220,s[48:51],s68 offen lds
 N a[64:79],a[208:211],v[24:27],a[64:79]
 v_add_f32 v199,v199,v88
 v_exp_f32 v91,v91
 v_add_f32 v199,v199,v89
 v_cvt_pk_bf16_f32 v88,v88,v89
 N a[16:31],a[212:215],v[8:11],a[16:31]
 v_exp_f32 v92,v92
 v_add_f32 v199,v199,v90
 v_exp_f32 v93,v93
 v_cvt_pk_bf16_f32 v89,v90,v91
 N a[80:95],a[212:215],v[24:27],a[80:95]
 W 2
 s_add_u32 m0,s72,155648
 s_add_u32 s68,s3,98304
 buffer_load_dwordx4 v220,s[48:51],s68 offen lds
 v_add_f32 v199,v199,v91
 N a[32:47],a[216:219],v[8:11],a[32:47]
 ds_read_b128 a[232:235],v193 offset:10240
 ds_read_b128 a[236:239],v193 offset:11264
 v_exp_f32 v94,v94
 v_add_f32 v199,v199,v92
 N a[96:111],a[216:219],v[24:27],a[96:111]
 v_exp_f32 v95,v95
 v_cvt_pk_bf16_f32 v90,v92,v93
 v_add_f32 v199,v199,v93
 v_add_f32 v199,v199,v94
 v_cvt_pk_bf16_f32 v91,v94,v95
 N a[48:63],a[220:223],v[8:11],a[48:63]
 s_add_u32 m0,s72,159744
 s_add_u32 s68,s3,98432
 buffer_load_dwordx4 v220,s[48:51],s68 offen lds
 v_add_f32 v199,v199,v95
 N a[112:127],a[220:223],v[24:27],a[112:127]
 W 2
 N a[0:15],a[224:227],v[32:35],a[0:15]
 ds_read_b128 a[240:243],v193 offset:12288
 ds_read_b128 a[244:247],v193 offset:13312
 N a[64:79],a[224:227],v[48:51],a[64:79]
 N a[16:31],a[228:231],v[32:35],a[16:31]
 N a[80:95],a[228:231],v[48:51],a[80:95]
 W 2
 N a[32:47],a[232:235],v[32:35],a[32:47]
 ds_read_b128 a[248:251],v193 offset:14336
 ds_read_b128 a[252:255],v193 offset:15360
 N a[96:111],a[232:235],v[48:51],a[96:111]
 N a[48:63],a[236:239],v[32:35],a[48:63]
 v_add_u32 v192,s76,v224
 s_add_u32 s76,s76,32768
 s_and_b32 s76,s76,0xffff
 N a[112:127],a[236:239],v[48:51],a[112:127]
 W 2
 s_waitcnt vmcnt(16) lgkmcnt(0)
 s_barrier
 N a[0:15],a[240:243],v[40:43],a[0:15]
 ds_read_b128 a[192:195],v192 offset:0
 ds_read_b128 a[196:199],v192 offset:1024
 N a[64:79],a[240:243],v[56:59],a[64:79]
 ds_read_b128 a[200:203],v192 offset:2048
 ds_read_b128 a[204:207],v192 offset:3072
 N a[16:31],a[244:247],v[40:43],a[16:31]
 N a[80:95],a[244:247],v[56:59],a[80:95]
 ds_read_b128 a[208:211],v192 offset:4096
 ds_read_b128 a[212:215],v192 offset:5120
 N a[32:47],a[248:251],v[40:43],a[32:47]
 N a[96:111],a[248:251],v[56:59],a[96:111]
 ds_read_b128 a[216:219],v192 offset:6144
 ds_read_b128 a[220:223],v192 offset:7168
 N a[48:63],a[252:255],v[40:43],a[48:63]
 N a[112:127],a[252:255],v[56:59],a[112:127]
 s_cmp_eq_u32 s66, 7
 s_cbranch_scc1 F_AC1
 W 7
 N v[0:15],a[192:195],a[160:163],v[144:159]
 ds_read_b128 a[224:227],v192 offset:8192
 ds_read_b128 a[228:231],v192 offset:9216
 v_exp_f32 v112,v112
 v_exp_f32 v113,v113
 W 8
 N v[0:15],a[196:199],a[164:167],v[0:15]
 W 6
 s_mov_b32 m0,s92
 s_mov_b32 s69,s91
 s_add_u32 s91,s91,17408
 s_add_u32 s92,s92,0x4000
 s_and_b32 s92,s92,0xffff
 buffer_load_dwordx4 v243,s[36:39],s69 offen offset:0 sc1 lds
 N v[0:15],a[200:203],a[168:171],v[0:15]
 ds_read_b128 a[232:235],v192 offset:10240
 ds_read_b128 a[236:239],v192 offset:11264
 v_exp_f32 v114,v114
 v_add_f32 v199,v199,v112
 N v[0:15],a[204:207],a[172:175],v[0:15]
 W 6
 v_add_u32 v211,1,v211
 buffer_store_dword v211,v210,s[8:11],s73 offen sc0 sc1
 buffer_load_dwordx4 v243,s[36:39],s69 offen offset:1024 sc1 lds
 v_exp_f32 v115,v115
 N v[0:15],a[208:211],a[176:179],v[0:15]
 ds_read_b128 a[240:243],v192 offset:12288
 ds_read_b128 a[244:247],v192 offset:13312
 v_add_f32 v199,v199,v113
 v_cvt_pk_bf16_f32 v112,v112,v113
 v_exp_f32 v116,v116
 N v[0:15],a[212:215],a[180:183],v[0:15]
 W 6
 buffer_load_dwordx4 v243,s[36:39],s69 offen offset:2048 sc1 lds
 v_add_f32 v199,v199,v114
 v_exp_f32 v117,v117
 v_cvt_pk_bf16_f32 v113,v114,v115
 N v[0:15],a[216:219],a[184:187],v[0:15]
 ds_read_b128 a[248:251],v192 offset:14336
 ds_read_b128 a[252:255],v192 offset:15360
 v_add_f32 v199,v199,v115
 v_exp_f32 v118,v118
 v_add_f32 v199,v199,v116
 N v[0:15],a[220:223],a[188:191],v[0:15]
 W 6
 buffer_load_dwordx4 v243,s[36:39],s69 offen offset:3072 sc1 lds
 v_exp_f32 v119,v119
 v_cvt_pk_bf16_f32 v114,v116,v117
 v_add_f32 v199,v199,v117
 N v[16:31],a[224:227],a[160:163],v[144:159]
 ds_read_b128 a[192:195],v192 offset:16384
 ds_read_b128 a[196:199],v192 offset:17408
 v_exp_f32 v120,v120
 v_add_f32 v199,v199,v118
 N v[16:31],a[228:231],a[164:167],v[16:31]
 W 6
 v_exp_f32 v121,v121
 v_cvt_pk_bf16_f32 v115,v118,v119
 v_add_f32 v199,v199,v119
 v_exp_f32 v122,v122
 N v[16:31],a[232:235],a[168:171],v[16:31]
 ds_read_b128 a[200:203],v192 offset:18432
 ds_read_b128 a[204:207],v192 offset:19456
 v_add_f32 v199,v199,v120
 v_exp_f32 v123,v123
 v_add_f32 v199,v199,v121
 N v[16:31],a[236:239],a[172:175],v[16:31]
 W 6
 v_cvt_pk_bf16_f32 v120,v120,v121
 v_exp_f32 v124,v124
 v_add_f32 v199,v199,v122
 v_exp_f32 v125,v125
 N v[16:31],a[240:243],a[176:179],v[16:31]
 ds_read_b128 a[208:211],v192 offset:20480
 ds_read_b128 a[212:215],v192 offset:21504
 v_cvt_pk_bf16_f32 v121,v122,v123
 v_add_f32 v199,v199,v123
 v_exp_f32 v126,v126
 N v[16:31],a[244:247],a[180:183],v[16:31]
 W 6
 v_add_f32 v199,v199,v124
 v_exp_f32 v127,v127
 v_cvt_pk_bf16_f32 v122,v124,v125
 v_add_f32 v199,v199,v125
 v_add_f32 v199,v199,v126
 N v[16:31],a[248:251],a[184:187],v[16:31]
 ds_read_b128 a[216:219],v192 offset:22528
 ds_read_b128 a[220:223],v192 offset:23552
 v_cvt_pk_bf16_f32 v123,v126,v127
 v_add_f32 v199,v199,v127
 N v[16:31],a[252:255],a[188:191],v[16:31]
 W 6
 N v[32:47],a[192:195],a[160:163],v[144:159]
 ds_read_b128 a[224:227],v192 offset:24576
 ds_read_b128 a[228:231],v192 offset:25600
 N v[32:47],a[196:199],a[164:167],v[32:47]
 W 6
 N v[32:47],a[200:203],a[168:171],v[32:47]
 ds_read_b128 a[232:235],v192 offset:26624
 ds_read_b128 a[236:239],v192 offset:27648
 N v[32:47],a[204:207],a[172:175],v[32:47]
 W 6
 N v[32:47],a[208:211],a[176:179],v[32:47]
 ds_read_b128 a[240:243],v192 offset:28672
 ds_read_b128 a[244:247],v192 offset:29696
 N v[32:47],a[212:215],a[180:183],v[32:47]
 W 6
 N v[32:47],a[216:219],a[184:187],v[32:47]
 ds_read_b128 a[248:251],v192 offset:30720
 ds_read_b128 a[252:255],v192 offset:31744
 N v[32:47],a[220:223],a[188:191],v[32:47]
 W 6
 v_add_u32 v193,s77,v194
 s_add_u32 s77,s77,16384
 s_and_b32 s77,s77,0xffff
 N v[48:63],a[224:227],a[160:163],v[144:159]
 N v[48:63],a[228:231],a[164:167],v[48:63]
 W 4
 W 0
 s_barrier
 N v[48:63],a[232:235],a[168:171],v[48:63]
 ds_read_b128 a[192:195],v193 offset:0
 ds_read_b128 a[196:199],v193 offset:1024
 N v[48:63],a[236:239],a[172:175],v[48:63]
 s_add_u32 m0,s92,0x0
 N v[48:63],a[240:243],a[176:179],v[48:63]
 ds_read_b128 a[200:203],v193 offset:2048
 ds_read_b128 a[204:207],v193 offset:3072
 buffer_load_dwordx4 v243,s[36:39],s91 offen offset:0 sc1 lds
 N v[48:63],a[244:247],a[180:183],v[48:63]
 N v[48:63],a[248:251],a[184:187],v[48:63]
 buffer_load_dwordx4 v243,s[36:39],s91 offen offset:1024 sc1 lds
 N v[48:63],a[252:255],a[188:191],v[48:63]
 W 2
 v_cmp_lt_f32 vcc,s78,v199
 s_cbranch_vccz F_c22
 s_call_b64 s[82:83],F_XAB1
F_c22:
 v_add_f32 v198,v198,v199
 s_add_u32 s75,s75,64
 ds_read_b128 a[208:211],v193 offset:4096
 ds_read_b128 a[212:215],v193 offset:5120
 buffer_load_dwordx4 v243,s[36:39],s91 offen offset:2048 sc1 lds
 v_exp_f32 v0,v0
 N a[64:79],a[192:195],v[80:83],a[64:79]
 v_exp_f32 v1,v1
 v_exp_f32 v2,v2
 v_add_f32 v199,v0,v1
 buffer_load_dwordx4 v243,s[36:39],s91 offen offset:3072 sc1 lds
 v_exp_f32 v3,v3
 v_cvt_pk_bf16_f32 v0,v0,v1
 v_exp_f32 v4,v4
 N a[80:95],a[196:199],v[80:83],a[80:95]
 W 2
 v_add_f32 v199,v199,v2
 v_exp_f32 v5,v5
 v_cvt_pk_bf16_f32 v1,v2,v3
 v_add_f32 v199,v199,v3
 ds_read_b128 a[216:219],v193 offset:6144
 ds_read_b128 a[220:223],v193 offset:7168
 s_add_u32 m0,s92,0x4000
 s_add_u32 s69,s91,17408
 s_add_u32 s91,s91,34816
 s_xor_b32 s92,s92,0x8000
 buffer_load_dwordx4 v243,s[36:39],s69 offen offset:0 sc1 lds
 N a[96:111],a[200:203],v[80:83],a[96:111]
 v_exp_f32 v6,v6
 v_add_f32 v199,v199,v4
 v_exp_f32 v7,v7
 v_cvt_pk_bf16_f32 v2,v4,v5
 buffer_load_dwordx4 v243,s[36:39],s69 offen offset:1024 sc1 lds
 v_add_f32 v199,v199,v5
 v_exp_f32 v8,v8
 v_add_f32 v199,v199,v6
 N a[112:127],a[204:207],v[80:83],a[112:127]
 W 2
 v_exp_f32 v9,v9
 v_cvt_pk_bf16_f32 v3,v6,v7
 v_add_f32 v199,v199,v7
 v_exp_f32 v10,v10
 ds_read_b128 a[224:227],v193 offset:8192
 ds_read_b128 a[228:231],v193 offset:9216
 buffer_load_dwordx4 v243,s[36:39],s69 offen offset:2048 sc1 lds
 v_add_f32 v199,v199,v8
 N a[64:79],a[208:211],v[88:91],a[64:79]
 v_exp_f32 v11,v11
 v_add_f32 v199,v199,v9
 v_cvt_pk_bf16_f32 v8,v8,v9
 v_exp_f32 v12,v12
 buffer_load_dwordx4 v243,s[36:39],s69 offen offset:3072 sc1 lds
 v_add_f32 v199,v199,v10
 v_exp_f32 v13,v13
 v_cvt_pk_bf16_f32 v9,v10,v11
 v_add_f32 v199,v199,v11
 N a[80:95],a[212:215],v[88:91],a[80:95]
 W 2
 v_exp_f32 v14,v14
 v_add_f32 v199,v199,v12
 v_exp_f32 v15,v15
 v_cvt_pk_bf16_f32 v10,v12,v13
 ds_read_b128 a[232:235],v193 offset:10240
 ds_read_b128 a[236:239],v193 offset:11264
 v_add_f32 v199,v199,v13
 v_add_f32 v199,v199,v14
 v_cvt_pk_bf16_f32 v11,v14,v15
 v_add_f32 v199,v199,v15
 N a[96:111],a[216:219],v[88:91],a[96:111]
 buffer_load_dword v207,v208,s[8:11],0 offen sc1
 v_exp_f32 v16,v16
 v_exp_f32 v17,v17
 v_exp_f32 v18,v18
 v_add_f32 v199,v199,v16
 v_exp_f32 v19,v19
 v_add_f32 v199,v199,v17
 N a[112:127],a[220:223],v[88:91],a[112:127]
 W 2
 v_cvt_pk_bf16_f32 v16,v16,v17
 v_exp_f32 v20,v20
 v_add_f32 v199,v199,v18
 v_exp_f32 v21,v21
 ds_read_b128 a[240:243],v193 offset:12288
 ds_read_b128 a[244:247],v193 offset:13312
 v_cvt_pk_bf16_f32 v17,v18,v19
 v_add_f32 v199,v199,v19
 v_exp_f32 v22,v22
 N a[64:79],a[224:227],v[112:115],a[64:79]
 v_add_f32 v199,v199,v20
 v_exp_f32 v23,v23
 v_cvt_pk_bf16_f32 v18,v20,v21
 v_add_f32 v199,v199,v21
 v_exp_f32 v24,v24
 v_add_f32 v199,v199,v22
 v_exp_f32 v25,v25
 v_cvt_pk_bf16_f32 v19,v22,v23
 N a[80:95],a[228:231],v[112:115],a[80:95]
 W 2
 v_add_f32 v199,v199,v23
 v_exp_f32 v26,v26
 v_add_f32 v199,v199,v24
 v_exp_f32 v27,v27
 ds_read_b128 a[248:251],v193 offset:14336
 ds_read_b128 a[252:255],v193 offset:15360
 v_add_f32 v199,v199,v25
 v_cvt_pk_bf16_f32 v24,v24,v25
 v_exp_f32 v28,v28
 N a[96:111],a[232:235],v[112:115],a[96:111]
 v_add_f32 v199,v199,v26
 v_exp_f32 v29,v29
 v_cvt_pk_bf16_f32 v25,v26,v27
 v_add_f32 v199,v199,v27
 v_add_u32 v192,s76,v224
 s_add_u32 s76,s76,32768
 s_and_b32 s76,s76,0xffff
 v_exp_f32 v30,v30
 v_add_f32 v199,v199,v28
 N a[112:127],a[236:239],v[112:115],a[112:127]
 W 2
 s_waitcnt vmcnt(8) lgkmcnt(0)
 s_barrier
 v_exp_f32 v31,v31
 v_cvt_pk_bf16_f32 v26,v28,v29
 v_add_f32 v199,v199,v29
 ds_read_b128 a[192:195],v192 offset:0
 ds_read_b128 a[196:199],v192 offset:1024
 v_add_f32 v199,v199,v30
 v_cvt_pk_bf16_f32 v27,v30,v31
 v_add_f32 v199,v199,v31
 N a[64:79],a[240:243],v[120:123],a[64:79]
 ds_read_b128 a[200:203],v192 offset:2048
 ds_read_b128 a[204:207],v192 offset:3072
 N a[80:95],a[244:247],v[120:123],a[80:95]
 ds_read_b128 a[208:211],v192 offset:4096
 ds_read_b128 a[212:215],v192 offset:5120
 N a[96:111],a[248:251],v[120:123],a[96:111]
 ds_read_b128 a[216:219],v192 offset:6144
 ds_read_b128 a[220:223],v192 offset:7168
 N a[112:127],a[252:255],v[120:123],a[112:127]
 s_branch F_FINL
F_AAmo2:
 W 7
 N v[0:15],a[192:195],a[128:131],v[128:143]
 v_exp_f32 v96,v96
 v_exp_f32 v97,v97
 v_exp_f32 v98,v98
 N v[16:31],a[192:195],a[160:163],v[144:159]
 s_mov_b32 m0,s92
 s_mov_b32 s69,s91
 s_add_u32 s91,s91,17408
 s_add_u32 s92,s92,0x4000
 s_and_b32 s92,s92,0xffff
 buffer_load_dwordx4 v243,s[36:39],s69 offen offset:0 sc1 lds
 W 6
 N v[0:15],a[196:199],a[132:135],v[0:15]
 v_add_f32 v197,v197,v96
 v_exp_f32 v99,v99
 v_add_f32 v197,v197,v97
 v_cvt_pk_bf16_f32 v96,v96,v97
 N v[16:31],a[196:199],a[164:167],v[16:31]
 W 4
 v_exp_f32 v100,v100
 v_add_f32 v197,v197,v98
 v_exp_f32 v101,v101
 v_cvt_pk_bf16_f32 v97,v98,v99
 N v[0:15],a[200:203],a[136:139],v[0:15]
 v_add_f32 v197,v197,v99
 v_exp_f32 v102,v102
 v_add_f32 v197,v197,v100
 v_exp_f32 v103,v103
 N v[16:31],a[200:203],a[168:171],v[16:31]
 buffer_load_dwordx4 v243,s[36:39],s69 offen offset:1024 sc1 lds
 v_cvt_pk_bf16_f32 v98,v100,v101
 v_add_f32 v197,v197,v101
 v_exp_f32 v104,v104
 v_add_f32 v197,v197,v102
 N v[0:15],a[204:207],a[140:143],v[0:15]
 v_exp_f32 v105,v105
 v_cvt_pk_bf16_f32 v99,v102,v103
 v_add_f32 v197,v197,v103
 v_exp_f32 v106,v106
 N v[16:31],a[204:207],a[172:175],v[16:31]
 W 2
 v_add_f32 v197,v197,v104
 v_exp_f32 v107,v107
 v_add_f32 v197,v197,v105
 v_cvt_pk_bf16_f32 v104,v104,v105
 N v[0:15],a[208:211],a[144:147],v[0:15]
 ds_read_b128 a[224:227],v192 offset:8192
 ds_read_b128 a[228:231],v192 offset:9216
 v_exp_f32 v108,v108
 v_add_f32 v197,v197,v106
 N v[16:31],a[208:211],a[176:179],v[16:31]
 buffer_load_dwordx4 v243,s[36:39],s69 offen offset:2048 sc1 lds
 v_exp_f32 v109,v109
 v_cvt_pk_bf16_f32 v105,v106,v107
 v_add_f32 v197,v197,v107
 N v[0:15],a[212:215],a[148:151],v[0:15]
 v_exp_f32 v110,v110
 v_add_f32 v197,v197,v108
 v_exp_f32 v111,v111
 v_cvt_pk_bf16_f32 v106,v108,v109
 N v[16:31],a[212:215],a[180:183],v[16:31]
 W 2
 v_add_f32 v197,v197,v109
 v_add_f32 v197,v197,v110
 v_cvt_pk_bf16_f32 v107,v110,v111
 v_add_f32 v197,v197,v111
 v_exp_f32 v112,v112
 N v[0:15],a[216:219],a[152:155],v[0:15]
 ds_read_b128 a[232:235],v192 offset:10240
 ds_read_b128 a[236:239],v192 offset:11264
 v_exp_f32 v113,v113
 v_exp_f32 v114,v114
 N v[16:31],a[216:219],a[184:187],v[16:31]
 buffer_load_dwordx4 v243,s[36:39],s69 offen offset:3072 sc1 lds
 v_add_f32 v199,v199,v112
 v_exp_f32 v115,v115
 v_add_f32 v199,v199,v113
 v_cvt_pk_bf16_f32 v112,v112,v113
 N v[0:15],a[220:223],a[156:159],v[0:15]
 v_exp_f32 v116,v116
 v_add_f32 v199,v199,v114
 v_exp_f32 v117,v117
 v_cvt_pk_bf16_f32 v113,v114,v115
 N v[16:31],a[220:223],a[188:191],v[16:31]
 W 2
 v_add_f32 v199,v199,v115
 v_exp_f32 v118,v118
 v_add_f32 v199,v199,v116
 v_exp_f32 v119,v119
 N v[32:47],a[224:227],a[128:131],v[128:143]
 ds_read_b128 a[240:243],v192 offset:12288
 ds_read_b128 a[244:247],v192 offset:13312
 v_cvt_pk_bf16_f32 v114,v116,v117
 v_add_f32 v199,v199,v117
 v_exp_f32 v120,v120
 N v[48:63],a[224:227],a[160:163],v[144:159]
 s_add_u32 m0,s94,0x10000
 s_mov_b32 s69,s93
 s_add_u32 s93,s93,17408
 s_add_u32 s94,s94,0x4000
 s_and_b32 s94,s94,0xffff
 buffer_load_dwordx4 v243,s[40:43],s69 offen offset:0 sc1 lds
 N v[32:47],a[228:231],a[132:135],v[32:47]
 v_add_f32 v199,v199,v118
 v_exp_f32 v121,v121
 v_cvt_pk_bf16_f32 v115,v118,v119
 v_add_f32 v199,v199,v119
 N v[48:63],a[228:231],a[164:167],v[48:63]
 W 2
 v_exp_f32 v122,v122
 v_add_f32 v199,v199,v120
 v_exp_f32 v123,v123
 v_add_f32 v199,v199,v121
 N v[32:47],a[232:235],a[136:139],v[32:47]
 ds_read_b128 a[248:251],v192 offset:14336
 ds_read_b128 a[252:255],v192 offset:15360
 v_cvt_pk_bf16_f32 v120,v120,v121
 v_exp_f32 v124,v124
 v_add_f32 v199,v199,v122
 N v[48:63],a[232:235],a[168:171],v[48:63]
 v_add_u32 v193,s77,v194
 s_add_u32 s77,s77,16384
 s_and_b32 s77,s77,0xffff
 buffer_load_dwordx4 v243,s[40:43],s69 offen offset:1024 sc1 lds
 v_exp_f32 v125,v125
 N v[32:47],a[236:239],a[140:143],v[32:47]
 v_cvt_pk_bf16_f32 v121,v122,v123
 v_add_f32 v199,v199,v123
 v_exp_f32 v126,v126
 v_add_f32 v199,v199,v124
 N v[48:63],a[236:239],a[172:175],v[48:63]
 W 2
 v_exp_f32 v127,v127
 v_cvt_pk_bf16_f32 v122,v124,v125
 v_add_f32 v199,v199,v125
 v_add_f32 v199,v199,v126
 v_cvt_pk_bf16_f32 v123,v126,v127
 N v[32:47],a[240:243],a[144:147],v[32:47]
 ds_read_b128 a[192:195],v193 offset:0
 ds_read_b128 a[196:199],v193 offset:1024
 v_add_f32 v199,v199,v127
 v_max_f32 v200,v197,v199
 N v[48:63],a[240:243],a[176:179],v[48:63]
 buffer_load_dwordx4 v243,s[40:43],s69 offen offset:2048 sc1 lds
 N v[32:47],a[244:247],a[148:151],v[32:47]
 N v[48:63],a[244:247],a[180:183],v[48:63]
 W 2
 N v[32:47],a[248:251],a[152:155],v[32:47]
 ds_read_b128 a[200:203],v193 offset:2048
 ds_read_b128 a[204:207],v193 offset:3072
 N v[48:63],a[248:251],a[184:187],v[48:63]
 buffer_load_dwordx4 v243,s[40:43],s69 offen offset:3072 sc1 lds
 N v[32:47],a[252:255],a[156:159],v[32:47]
 N v[48:63],a[252:255],a[188:191],v[48:63]
 W 2
 v_cmp_lt_f32 vcc,s78,v200
 s_cbranch_vccz F_c25
 s_call_b64 s[82:83],F_XAA1
F_c25:
 v_add_f32 v196,v196,v197
 v_add_f32 v198,v198,v199
 s_add_u32 s75,s75,64
 N a[0:15],a[192:195],v[64:67],a[0:15]
 ds_read_b128 a[208:211],v193 offset:4096
 ds_read_b128 a[212:215],v193 offset:5120
 v_exp_f32 v0,v0
 v_exp_f32 v1,v1
 N a[64:79],a[192:195],v[80:83],a[64:79]
 v_exp_f32 v2,v2
 v_add_f32 v197,v0,v1
 v_exp_f32 v3,v3
 v_cvt_pk_bf16_f32 v0,v0,v1
 N a[16:31],a[196:199],v[64:67],a[16:31]
 v_exp_f32 v4,v4
 v_add_f32 v197,v197,v2
 v_exp_f32 v5,v5
 v_cvt_pk_bf16_f32 v1,v2,v3
 N a[80:95],a[196:199],v[80:83],a[80:95]
 W 2
 v_add_f32 v197,v197,v3
 v_exp_f32 v6,v6
 v_add_f32 v197,v197,v4
 v_exp_f32 v7,v7
 N a[32:47],a[200:203],v[64:67],a[32:47]
 ds_read_b128 a[216:219],v193 offset:6144
 ds_read_b128 a[220:223],v193 offset:7168
 v_cvt_pk_bf16_f32 v2,v4,v5
 v_add_f32 v197,v197,v5
 v_exp_f32 v8,v8
 N a[96:111],a[200:203],v[80:83],a[96:111]
 v_add_f32 v197,v197,v6
 v_exp_f32 v9,v9
 v_cvt_pk_bf16_f32 v3,v6,v7
 v_add_f32 v197,v197,v7
 N a[48:63],a[204:207],v[64:67],a[48:63]
 v_exp_f32 v10,v10
 v_add_f32 v197,v197,v8
 v_exp_f32 v11,v11
 v_add_f32 v197,v197,v9
 N a[112:127],a[204:207],v[80:83],a[112:127]
 W 2
 v_cvt_pk_bf16_f32 v8,v8,v9
 v_exp_f32 v12,v12
 v_add_f32 v197,v197,v10
 v_exp_f32 v13,v13
 N a[0:15],a[208:211],v[72:75],a[0:15]
 ds_read_b128 a[224:227],v193 offset:8192
 ds_read_b128 a[228:231],v193 offset:9216
 v_cvt_pk_bf16_f32 v9,v10,v11
 v_add_f32 v197,v197,v11
 v_exp_f32 v14,v14
 N a[64:79],a[208:211],v[88:91],a[64:79]
 v_add_f32 v197,v197,v12
 v_exp_f32 v15,v15
 v_cvt_pk_bf16_f32 v10,v12,v13
 v_add_f32 v197,v197,v13
 v_add_f32 v197,v197,v14
 N a[16:31],a[212:215],v[72:75],a[16:31]
 v_cvt_pk_bf16_f32 v11,v14,v15
 v_add_f32 v197,v197,v15
 v_exp_f32 v16,v16
 v_exp_f32 v17,v17
 N a[80:95],a[212:215],v[88:91],a[80:95]
 W 2
 v_exp_f32 v18,v18
 v_add_f32 v199,v16,v17
 v_exp_f32 v19,v19
 v_cvt_pk_bf16_f32 v16,v16,v17
 N a[32:47],a[216:219],v[72:75],a[32:47]
 ds_read_b128 a[232:235],v193 offset:10240
 ds_read_b128 a[236:239],v193 offset:11264
 v_exp_f32 v20,v20
 v_add_f32 v199,v199,v18
 N a[96:111],a[216:219],v[88:91],a[96:111]
 v_exp_f32 v21,v21
 v_cvt_pk_bf16_f32 v17,v18,v19
 v_add_f32 v199,v199,v19
 v_exp_f32 v22,v22
 N a[48:63],a[220:223],v[72:75],a[48:63]
 v_add_f32 v199,v199,v20
 v_exp_f32 v23,v23
 v_cvt_pk_bf16_f32 v18,v20,v21
 v_add_f32 v199,v199,v21
 N a[112:127],a[220:223],v[88:91],a[112:127]
 W 2
 v_exp_f32 v24,v24
 v_add_f32 v199,v199,v22
 v_exp_f32 v25,v25
 v_cvt_pk_bf16_f32 v19,v22,v23
 N a[0:15],a[224:227],v[96:99],a[0:15]
 ds_read_b128 a[240:243],v193 offset:12288
 ds_read_b128 a[244:247],v193 offset:13312
 v_add_f32 v199,v199,v23
 v_exp_f32 v26,v26
 v_add_f32 v199,v199,v24
 N a[64:79],a[224:227],v[112:115],a[64:79]
 v_exp_f32 v27,v27
 v_add_f32 v199,v199,v25
 v_cvt_pk_bf16_f32 v24,v24,v25
 v_exp_f32 v28,v28
 N a[16:31],a[228:231],v[96:99],a[16:31]
 v_add_f32 v199,v199,v26
 v_exp_f32 v29,v29
 v_cvt_pk_bf16_f32 v25,v26,v27
 v_add_f32 v199,v199,v27
 N a[80:95],a[228:231],v[112:115],a[80:95]
 W 2
 v_exp_f32 v30,v30
 v_add_f32 v199,v199,v28
 v_exp_f32 v31,v31
 v_cvt_pk_bf16_f32 v26,v28,v29
 N a[32:47],a[232:235],v[96:99],a[32:47]
 ds_read_b128 a[248:251],v193 offset:14336
 ds_read_b128 a[252:255],v193 offset:15360
 v_add_f32 v199,v199,v29
 v_add_f32 v199,v199,v30
 v_cvt_pk_bf16_f32 v27,v30,v31
 v_add_f32 v199,v199,v31
 N a[96:111],a[232:235],v[112:115],a[96:111]
 N a[48:63],a[236:239],v[96:99],a[48:63]
 v_add_u32 v192,s76,v224
 s_add_u32 s76,s76,16384
 s_and_b32 s76,s76,0xffff
 N a[112:127],a[236:239],v[112:115],a[112:127]
 W 2
 s_waitcnt vmcnt(16) lgkmcnt(0)
 s_barrier
 N a[0:15],a[240:243],v[104:107],a[0:15]
 ds_read_b128 a[192:195],v192 offset:0
 ds_read_b128 a[196:199],v192 offset:1024
 N a[64:79],a[240:243],v[120:123],a[64:79]
 ds_read_b128 a[200:203],v192 offset:2048
 ds_read_b128 a[204:207],v192 offset:3072
 N a[16:31],a[244:247],v[104:107],a[16:31]
 N a[80:95],a[244:247],v[120:123],a[80:95]
 ds_read_b128 a[208:211],v192 offset:4096
 ds_read_b128 a[212:215],v192 offset:5120
 N a[32:47],a[248:251],v[104:107],a[32:47]
 N a[96:111],a[248:251],v[120:123],a[96:111]
 ds_read_b128 a[216:219],v192 offset:6144
 ds_read_b128 a[220:223],v192 offset:7168
 N a[48:63],a[252:255],v[104:107],a[48:63]
 N a[112:127],a[252:255],v[120:123],a[112:127]
F_AAme2:
 W 7
 N v[64:79],a[192:195],a[128:131],v[128:143]
 v_exp_f32 v32,v32
 v_exp_f32 v33,v33
 v_exp_f32 v34,v34
 N v[80:95],a[192:195],a[160:163],v[144:159]
 s_mov_b32 m0,s92
 s_mov_b32 s69,s91
 s_add_u32 s91,s91,17408
 s_add_u32 s92,s92,0x4000
 s_and_b32 s92,s92,0xffff
 buffer_load_dwordx4 v243,s[36:39],s69 offen offset:0 sc1 lds
 W 6
 N v[64:79],a[196:199],a[132:135],v[64:79]
 v_add_f32 v197,v197,v32
 v_exp_f32 v35,v35
 v_add_f32 v197,v197,v33
 v_cvt_pk_bf16_f32 v32,v32,v33
 N v[80:95],a[196:199],a[164:167],v[80:95]
 W 4
 v_exp_f32 v36,v36
 v_add_f32 v197,v197,v34
 v_exp_f32 v37,v37
 v_cvt_pk_bf16_f32 v33,v34,v35
 N v[64:79],a[200:203],a[136:139],v[64:79]
 buffer_load_dwordx4 v243,s[36:39],s69 offen offset:1024 sc1 lds
 v_add_f32 v197,v197,v35
 v_exp_f32 v38,v38
 v_add_f32 v197,v197,v36
 N v[80:95],a[200:203],a[168:171],v[80:95]
 v_exp_f32 v39,v39
 v_cvt_pk_bf16_f32 v34,v36,v37
 v_add_f32 v197,v197,v37
 v_exp_f32 v40,v40
 N v[64:79],a[204:207],a[140:143],v[64:79]
 v_add_f32 v197,v197,v38
 v_exp_f32 v41,v41
 v_cvt_pk_bf16_f32 v35,v38,v39
 v_add_f32 v197,v197,v39
 N v[80:95],a[204:207],a[172:175],v[80:95]
 W 2
 buffer_load_dwordx4 v243,s[36:39],s69 offen offset:2048 sc1 lds
 v_exp_f32 v42,v42
 v_add_f32 v197,v197,v40
 N v[64:79],a[208:211],a[144:147],v[64:79]
 ds_read_b128 a[224:227],v192 offset:8192
 ds_read_b128 a[228:231],v192 offset:9216
 v_exp_f32 v43,v43
 v_add_f32 v197,v197,v41
 v_cvt_pk_bf16_f32 v40,v40,v41
 N v[80:95],a[208:211],a[176:179],v[80:95]
 v_exp_f32 v44,v44
 v_add_f32 v197,v197,v42
 v_exp_f32 v45,v45
 v_cvt_pk_bf16_f32 v41,v42,v43
 N v[64:79],a[212:215],a[148:151],v[64:79]
 buffer_load_dwordx4 v243,s[36:39],s69 offen offset:3072 sc1 lds
 v_add_f32 v197,v197,v43
 v_exp_f32 v46,v46
 v_add_f32 v197,v197,v44
 N v[80:95],a[212:215],a[180:183],v[80:95]
 W 2
 v_exp_f32 v47,v47
 v_cvt_pk_bf16_f32 v42,v44,v45
 v_add_f32 v197,v197,v45
 v_add_f32 v197,v197,v46
 v_cvt_pk_bf16_f32 v43,v46,v47
 N v[64:79],a[216:219],a[152:155],v[64:79]
 ds_read_b128 a[232:235],v192 offset:10240
 ds_read_b128 a[236:239],v192 offset:11264
 v_add_f32 v197,v197,v47
 v_exp_f32 v48,v48
 N v[80:95],a[216:219],a[184:187],v[80:95]
 s_add_u32 m0,s94,0x10000
 s_mov_b32 s69,s93
 s_add_u32 s93,s93,17408
 s_add_u32 s94,s94,0x4000
 s_and_b32 s94,s94,0xffff
 buffer_load_dwordx4 v243,s[40:43],s69 offen offset:0 sc1 lds
 N v[64:79],a[220:223],a[156:159],v[64:79]
 v_exp_f32 v49,v49
 v_exp_f32 v50,v50
 v_add_f32 v199,v199,v48
 N v[80:95],a[220:223],a[188:191],v[80:95]
 W 2
 v_exp_f32 v51,v51
 v_add_f32 v199,v199,v49
 v_cvt_pk_bf16_f32 v48,v48,v49
 v_exp_f32 v52,v52
 ds_read_b128 a[240:243],v192 offset:12288
 ds_read_b128 a[244:247],v192 offset:13312
 buffer_load_dwordx4 v243,s[40:43],s69 offen offset:1024 sc1 lds
 v_add_f32 v199,v199,v50
 N v[112:127],a[224:227],a[160:163],v[144:159]
 v_exp_f32 v53,v53
 v_cvt_pk_bf16_f32 v49,v50,v51
 v_add_f32 v199,v199,v51
 v_exp_f32 v54,v54
 v_add_f32 v199,v199,v52
 v_exp_f32 v55,v55
 v_cvt_pk_bf16_f32 v50,v52,v53
 v_add_f32 v199,v199,v53
 N v[112:127],a[228:231],a[164:167],v[112:127]
 W 2
 buffer_load_dwordx4 v243,s[40:43],s69 offen offset:2048 sc1 lds
 v_exp_f32 v56,v56
 v_add_f32 v199,v199,v54
 ds_read_b128 a[248:251],v192 offset:14336
 ds_read_b128 a[252:255],v192 offset:15360
 v_exp_f32 v57,v57
 v_cvt_pk_bf16_f32 v51,v54,v55
 v_add_f32 v199,v199,v55
 N v[112:127],a[232:235],a[168:171],v[112:127]
 v_add_u32 v193,s77,v194
 s_add_u32 s77,s77,16384
 s_and_b32 s77,s77,0xffff
 v_exp_f32 v58,v58
 v_add_f32 v199,v199,v56
 buffer_load_dwordx4 v243,s[40:43],s69 offen offset:3072 sc1 lds
 v_exp_f32 v59,v59
 v_add_f32 v199,v199,v57
 v_cvt_pk_bf16_f32 v56,v56,v57
 N v[112:127],a[236:239],a[172:175],v[112:127]
 W 2
 v_exp_f32 v60,v60
 v_add_f32 v199,v199,v58
 v_exp_f32 v61,v61
 v_cvt_pk_bf16_f32 v57,v58,v59
 ds_read_b128 a[192:195],v193 offset:0
 ds_read_b128 a[196:199],v193 offset:1024
 v_add_f32 v199,v199,v59
 v_exp_f32 v62,v62
 v_add_f32 v199,v199,v60
 N v[112:127],a[240:243],a[176:179],v[112:127]
 s_add_u32 m0,s72,131072
 s_add_u32 s68,s3,0
 buffer_load_dwordx4 v220,s[48:51],s68 offen lds
 v_exp_f32 v63,v63
 v_cvt_pk_bf16_f32 v58,v60,v61
 v_add_f32 v199,v199,v61
 v_add_f32 v199,v199,v62
 v_cvt_pk_bf16_f32 v59,v62,v63
 v_add_f32 v199,v199,v63
 v_subrev_u32 v206,64,v204
 v_cmp_le_i32 s[84:85],0,v206
 N v[112:127],a[244:247],a[180:183],v[112:127]
 W 2
 v_cmp_le_i32 s[86:87],1,v206
 v_cmp_le_i32 s[88:89],2,v206
 v_cmp_le_i32 s[98:99],3,v206
 v_cndmask_b32 v64,v205,v64,s[84:85]
 v_cndmask_b32 v65,v205,v65,s[86:87]
 v_cndmask_b32 v66,v205,v66,s[88:89]
 ds_read_b128 a[200:203],v193 offset:2048
 ds_read_b128 a[204:207],v193 offset:3072
 s_add_u32 m0,s72,135168
 s_add_u32 s68,s3,128
 buffer_load_dwordx4 v220,s[48:51],s68 offen lds
 N v[112:127],a[248:251],a[184:187],v[112:127]
 v_cndmask_b32 v67,v205,v67,s[98:99]
 v_cmp_le_i32 s[84:85],8,v206
 v_cmp_le_i32 s[86:87],9,v206
 v_cmp_le_i32 s[88:89],10,v206
 v_cmp_le_i32 s[98:99],11,v206
 v_cndmask_b32 v68,v205,v68,s[84:85]
 v_cndmask_b32 v69,v205,v69,s[86:87]
 v_cndmask_b32 v70,v205,v70,s[88:89]
 v_cndmask_b32 v71,v205,v71,s[98:99]
 v_cmp_le_i32 s[84:85],16,v206
 v_cmp_le_i32 s[86:87],17,v206
 v_cmp_le_i32 s[88:89],18,v206
 N v[112:127],a[252:255],a[188:191],v[112:127]
 W 2
 s_add_u32 m0,s72,139264
 s_add_u32 s68,s3,32768
 buffer_load_dwordx4 v220,s[48:51],s68 offen lds
 v_cmp_le_i32 s[98:99],19,v206
 v_cndmask_b32 v72,v205,v72,s[84:85]
 v_cndmask_b32 v73,v205,v73,s[86:87]
 v_cndmask_b32 v74,v205,v74,s[88:89]
 v_cndmask_b32 v75,v205,v75,s[98:99]
 v_cmp_le_i32 s[84:85],24,v206
 v_cmp_le_i32 s[86:87],25,v206
 v_cmp_le_i32 s[88:89],26,v206
 v_cmp_le_i32 s[98:99],27,v206
 v_cndmask_b32 v76,v205,v76,s[84:85]
 v_cndmask_b32 v77,v205,v77,s[86:87]
 v_cndmask_b32 v78,v205,v78,s[88:89]
 v_cndmask_b32 v79,v205,v79,s[98:99]
 v_max_f32 v200,v197,v199
 v_cmp_lt_f32 vcc,s78,v200
 s_cbranch_vccz F_c26
 s_call_b64 s[82:83],F_XAA0
F_c26:
 N a[0:15],a[192:195],v[0:3],a[0:15]
 ds_read_b128 a[208:211],v193 offset:4096
 ds_read_b128 a[212:215],v193 offset:5120
 v_add_f32 v196,v196,v197
 v_add_f32 v198,v198,v199
 s_add_u32 s75,s75,64
 N a[64:79],a[192:195],v[16:19],a[64:79]
 v_exp_f32 v64,v64
 v_exp_f32 v65,v65
 v_exp_f32 v66,v66
 N a[16:31],a[196:199],v[0:3],a[16:31]
 s_add_u32 m0,s72,143360
 s_add_u32 s68,s3,32896
 buffer_load_dwordx4 v220,s[48:51],s68 offen lds
 v_add_f32 v197,v64,v65
 v_exp_f32 v67,v67
 N a[80:95],a[196:199],v[16:19],a[80:95]
 W 2
 v_cvt_pk_bf16_f32 v64,v64,v65
 v_exp_f32 v68,v68
 v_add_f32 v197,v197,v66
 v_exp_f32 v69,v69
 N a[32:47],a[200:203],v[0:3],a[32:47]
 ds_read_b128 a[216:219],v193 offset:6144
 ds_read_b128 a[220:223],v193 offset:7168
 v_cvt_pk_bf16_f32 v65,v66,v67
 v_add_f32 v197,v197,v67
 v_exp_f32 v70,v70
 N a[96:111],a[200:203],v[16:19],a[96:111]
 s_add_u32 m0,s72,147456
 s_add_u32 s68,s3,65536
 buffer_load_dwordx4 v220,s[48:51],s68 offen lds
 v_add_f32 v197,v197,v68
 v_exp_f32 v71,v71
 N a[48:63],a[204:207],v[0:3],a[48:63]
 v_cvt_pk_bf16_f32 v66,v68,v69
 v_add_f32 v197,v197,v69
 v_exp_f32 v72,v72
 v_add_f32 v197,v197,v70
 N a[112:127],a[204:207],v[16:19],a[112:127]
 W 2
 v_exp_f32 v73,v73
 v_cvt_pk_bf16_f32 v67,v70,v71
 v_add_f32 v197,v197,v71
 v_exp_f32 v74,v74
 N a[0:15],a[208:211],v[8:11],a[0:15]
 ds_read_b128 a[224:227],v193 offset:8192
 ds_read_b128 a[228:231],v193 offset:9216
 s_add_u32 m0,s72,151552
 s_add_u32 s68,s3,65664
 buffer_load_dwordx4 v220,s[48:51],s68 offen lds
 N a[64:79],a[208:211],v[24:27],a[64:79]
 v_add_f32 v197,v197,v72
 v_exp_f32 v75,v75
 v_add_f32 v197,v197,v73
 v_cvt_pk_bf16_f32 v72,v72,v73
 N a[16:31],a[212:215],v[8:11],a[16:31]
 v_exp_f32 v76,v76
 v_add_f32 v197,v197,v74
 v_exp_f32 v77,v77
 v_cvt_pk_bf16_f32 v73,v74,v75
 N a[80:95],a[212:215],v[24:27],a[80:95]
 W 2
 s_add_u32 m0,s72,155648
 s_add_u32 s68,s3,98304
 buffer_load_dwordx4 v220,s[48:51],s68 offen lds
 v_add_f32 v197,v197,v75
 N a[32:47],a[216:219],v[8:11],a[32:47]
 ds_read_b128 a[232:235],v193 offset:10240
 ds_read_b128 a[236:239],v193 offset:11264
 v_exp_f32 v78,v78
 v_add_f32 v197,v197,v76
 N a[96:111],a[216:219],v[24:27],a[96:111]
 v_exp_f32 v79,v79
 v_cvt_pk_bf16_f32 v74,v76,v77
 v_add_f32 v197,v197,v77
 v_add_f32 v197,v197,v78
 v_cvt_pk_bf16_f32 v75,v78,v79
 N a[48:63],a[220:223],v[8:11],a[48:63]
 s_add_u32 m0,s72,159744
 s_add_u32 s68,s3,98432
 buffer_load_dwordx4 v220,s[48:51],s68 offen lds
 v_add_f32 v197,v197,v79
 v_exp_f32 v80,v80
 N a[112:127],a[220:223],v[24:27],a[112:127]
 W 2
 v_exp_f32 v81,v81
 v_exp_f32 v82,v82
 v_add_f32 v199,v80,v81
 N a[0:15],a[224:227],v[32:35],a[0:15]
 ds_read_b128 a[240:243],v193 offset:12288
 ds_read_b128 a[244:247],v193 offset:13312
 v_exp_f32 v83,v83
 v_cvt_pk_bf16_f32 v80,v80,v81
 N a[64:79],a[224:227],v[48:51],a[64:79]
 v_exp_f32 v84,v84
 v_add_f32 v199,v199,v82
 v_exp_f32 v85,v85
 v_cvt_pk_bf16_f32 v81,v82,v83
 N a[16:31],a[228:231],v[32:35],a[16:31]
 v_add_f32 v199,v199,v83
 v_exp_f32 v86,v86
 v_add_f32 v199,v199,v84
 v_exp_f32 v87,v87
 N a[80:95],a[228:231],v[48:51],a[80:95]
 W 2
 v_cvt_pk_bf16_f32 v82,v84,v85
 v_add_f32 v199,v199,v85
 v_exp_f32 v88,v88
 v_add_f32 v199,v199,v86
 N a[32:47],a[232:235],v[32:35],a[32:47]
 ds_read_b128 a[248:251],v193 offset:14336
 ds_read_b128 a[252:255],v193 offset:15360
 v_exp_f32 v89,v89
 v_cvt_pk_bf16_f32 v83,v86,v87
 v_add_f32 v199,v199,v87
 N a[96:111],a[232:235],v[48:51],a[96:111]
 v_exp_f32 v90,v90
 v_add_f32 v199,v199,v88
 v_exp_f32 v91,v91
 v_add_f32 v199,v199,v89
 N a[48:63],a[236:239],v[32:35],a[48:63]
 v_add_u32 v192,s76,v224
 s_add_u32 s76,s76,32768
 s_and_b32 s76,s76,0xffff
 v_cvt_pk_bf16_f32 v88,v88,v89
 v_exp_f32 v92,v92
 v_add_f32 v199,v199,v90
 N a[112:127],a[236:239],v[48:51],a[112:127]
 W 2
 s_waitcnt vmcnt(16) lgkmcnt(0)
 s_barrier
 v_exp_f32 v93,v93
 v_cvt_pk_bf16_f32 v89,v90,v91
 v_add_f32 v199,v199,v91
 N a[0:15],a[240:243],v[40:43],a[0:15]
 ds_read_b128 a[192:195],v192 offset:0
 ds_read_b128 a[196:199],v192 offset:1024
 v_exp_f32 v94,v94
 v_add_f32 v199,v199,v92
 N a[64:79],a[240:243],v[56:59],a[64:79]
 ds_read_b128 a[200:203],v192 offset:2048
 ds_read_b128 a[204:207],v192 offset:3072
 v_exp_f32 v95,v95
 v_cvt_pk_bf16_f32 v90,v92,v93
 v_add_f32 v199,v199,v93
 N a[16:31],a[244:247],v[40:43],a[16:31]
 v_add_f32 v199,v199,v94
 v_cvt_pk_bf16_f32 v91,v94,v95
 v_add_f32 v199,v199,v95
 N a[80:95],a[244:247],v[56:59],a[80:95]
 ds_read_b128 a[208:211],v192 offset:4096
 ds_read_b128 a[212:215],v192 offset:5120
 N a[32:47],a[248:251],v[40:43],a[32:47]
 N a[96:111],a[248:251],v[56:59],a[96:111]
 ds_read_b128 a[216:219],v192 offset:6144
 ds_read_b128 a[220:223],v192 offset:7168
 N a[48:63],a[252:255],v[40:43],a[48:63]
 N a[112:127],a[252:255],v[56:59],a[112:127]
 s_cmp_eq_u32 s66, 7
 s_cbranch_scc1 F_AC2
 W 7
 N v[0:15],a[192:195],a[160:163],v[144:159]
 ds_read_b128 a[224:227],v192 offset:8192
 ds_read_b128 a[228:231],v192 offset:9216
 v_exp_f32 v112,v112
 v_exp_f32 v113,v113
 W 8
 N v[0:15],a[196:199],a[164:167],v[0:15]
 W 6
 s_mov_b32 m0,s92
 s_mov_b32 s69,s91
 s_add_u32 s91,s91,17408
 s_add_u32 s92,s92,0x4000
 s_and_b32 s92,s92,0xffff
 buffer_load_dwordx4 v243,s[36:39],s69 offen offset:0 sc1 lds
 N v[0:15],a[200:203],a[168:171],v[0:15]
 ds_read_b128 a[232:235],v192 offset:10240
 ds_read_b128 a[236:239],v192 offset:11264
 v_exp_f32 v114,v114
 v_add_f32 v199,v199,v112
 N v[0:15],a[204:207],a[172:175],v[0:15]
 W 6
 v_add_u32 v211,1,v211
 buffer_store_dword v211,v210,s[8:11],s73 offen sc0 sc1
 buffer_load_dwordx4 v243,s[36:39],s69 offen offset:1024 sc1 lds
 v_exp_f32 v115,v115
 N v[0:15],a[208:211],a[176:179],v[0:15]
 ds_read_b128 a[240:243],v192 offset:12288
 ds_read_b128 a[244:247],v192 offset:13312
 v_add_f32 v199,v199,v113
 v_cvt_pk_bf16_f32 v112,v112,v113
 v_exp_f32 v116,v116
 N v[0:15],a[212:215],a[180:183],v[0:15]
 W 6
 buffer_load_dwordx4 v243,s[36:39],s69 offen offset:2048 sc1 lds
 v_add_f32 v199,v199,v114
 v_exp_f32 v117,v117
 v_cvt_pk_bf16_f32 v113,v114,v115
 N v[0:15],a[216:219],a[184:187],v[0:15]
 ds_read_b128 a[248:251],v192 offset:14336
 ds_read_b128 a[252:255],v192 offset:15360
 v_add_f32 v199,v199,v115
 v_exp_f32 v118,v118
 v_add_f32 v199,v199,v116
 N v[0:15],a[220:223],a[188:191],v[0:15]
 W 6
 buffer_load_dwordx4 v243,s[36:39],s69 offen offset:3072 sc1 lds
 v_exp_f32 v119,v119
 v_cvt_pk_bf16_f32 v114,v116,v117
 v_add_f32 v199,v199,v117
 N v[16:31],a[224:227],a[160:163],v[144:159]
 ds_read_b128 a[192:195],v192 offset:16384
 ds_read_b128 a[196:199],v192 offset:17408
 v_exp_f32 v120,v120
 v_add_f32 v199,v199,v118
 N v[16:31],a[228:231],a[164:167],v[16:31]
 W 6
 v_exp_f32 v121,v121
 v_cvt_pk_bf16_f32 v115,v118,v119
 v_add_f32 v199,v199,v119
 v_exp_f32 v122,v122
 N v[16:31],a[232:235],a[168:171],v[16:31]
 ds_read_b128 a[200:203],v192 offset:18432
 ds_read_b128 a[204:207],v192 offset:19456
 v_add_f32 v199,v199,v120
 v_exp_f32 v123,v123
 v_add_f32 v199,v199,v121
 N v[16:31],a[236:239],a[172:175],v[16:31]
 W 6
 v_cvt_pk_bf16_f32 v120,v120,v121
 v_exp_f32 v124,v124
 v_add_f32 v199,v199,v122
 v_exp_f32 v125,v125
 N v[16:31],a[240:243],a[176:179],v[16:31]
 ds_read_b128 a[208:211],v192 offset:20480
 ds_read_b128 a[212:215],v192 offset:21504
 v_cvt_pk_bf16_f32 v121,v122,v123
 v_add_f32 v199,v199,v123
 v_exp_f32 v126,v126
 N v[16:31],a[244:247],a[180:183],v[16:31]
 W 6
 v_add_f32 v199,v199,v124
 v_exp_f32 v127,v127
 v_cvt_pk_bf16_f32 v122,v124,v125
 v_add_f32 v199,v199,v125
 v_add_f32 v199,v199,v126
 N v[16:31],a[248:251],a[184:187],v[16:31]
 ds_read_b128 a[216:219],v192 offset:22528
 ds_read_b128 a[220:223],v192 offset:23552
 v_cvt_pk_bf16_f32 v123,v126,v127
 v_add_f32 v199,v199,v127
 v_max_f32 v200,v197,v199
 N v[16:31],a[252:255],a[188:191],v[16:31]
 W 6
 N v[32:47],a[192:195],a[160:163],v[144:159]
 ds_read_b128 a[224:227],v192 offset:24576
 ds_read_b128 a[228:231],v192 offset:25600
 N v[32:47],a[196:199],a[164:167],v[32:47]
 W 6
 N v[32:47],a[200:203],a[168:171],v[32:47]
 ds_read_b128 a[232:235],v192 offset:26624
 ds_read_b128 a[236:239],v192 offset:27648
 N v[32:47],a[204:207],a[172:175],v[32:47]
 W 6
 N v[32:47],a[208:211],a[176:179],v[32:47]
 ds_read_b128 a[240:243],v192 offset:28672
 ds_read_b128 a[244:247],v192 offset:29696
 N v[32:47],a[212:215],a[180:183],v[32:47]
 W 6
 N v[32:47],a[216:219],a[184:187],v[32:47]
 ds_read_b128 a[248:251],v192 offset:30720
 ds_read_b128 a[252:255],v192 offset:31744
 N v[32:47],a[220:223],a[188:191],v[32:47]
 W 6
 v_add_u32 v193,s77,v194
 s_add_u32 s77,s77,16384
 s_and_b32 s77,s77,0xffff
 N v[48:63],a[224:227],a[160:163],v[144:159]
 N v[48:63],a[228:231],a[164:167],v[48:63]
 W 4
 W 0
 s_barrier
 N v[48:63],a[232:235],a[168:171],v[48:63]
 ds_read_b128 a[192:195],v193 offset:0
 ds_read_b128 a[196:199],v193 offset:1024
 N v[48:63],a[236:239],a[172:175],v[48:63]
 s_add_u32 m0,s92,0x0
 N v[48:63],a[240:243],a[176:179],v[48:63]
 ds_read_b128 a[200:203],v193 offset:2048
 ds_read_b128 a[204:207],v193 offset:3072
 buffer_load_dwordx4 v243,s[36:39],s91 offen offset:0 sc1 lds
 N v[48:63],a[244:247],a[180:183],v[48:63]
 N v[48:63],a[248:251],a[184:187],v[48:63]
 buffer_load_dwordx4 v243,s[36:39],s91 offen offset:1024 sc1 lds
 N v[48:63],a[252:255],a[188:191],v[48:63]
 W 2
 v_cmp_lt_f32 vcc,s78,v200
 s_cbranch_vccz F_c27
 s_call_b64 s[82:83],F_XAB1
F_c27:
 v_add_f32 v196,v196,v197
 v_add_f32 v198,v198,v199
 s_add_u32 s75,s75,64
 N a[0:15],a[192:195],v[64:67],a[0:15]
 ds_read_b128 a[208:211],v193 offset:4096
 ds_read_b128 a[212:215],v193 offset:5120
 buffer_load_dwordx4 v243,s[36:39],s91 offen offset:2048 sc1 lds
 v_exp_f32 v0,v0
 N a[64:79],a[192:195],v[80:83],a[64:79]
 v_exp_f32 v1,v1
 v_exp_f32 v2,v2
 v_add_f32 v199,v0,v1
 N a[16:31],a[196:199],v[64:67],a[16:31]
 buffer_load_dwordx4 v243,s[36:39],s91 offen offset:3072 sc1 lds
 v_exp_f32 v3,v3
 v_cvt_pk_bf16_f32 v0,v0,v1
 v_exp_f32 v4,v4
 N a[80:95],a[196:199],v[80:83],a[80:95]
 W 2
 v_add_f32 v199,v199,v2
 v_exp_f32 v5,v5
 v_cvt_pk_bf16_f32 v1,v2,v3
 v_add_f32 v199,v199,v3
 N a[32:47],a[200:203],v[64:67],a[32:47]
 ds_read_b128 a[216:219],v193 offset:6144
 ds_read_b128 a[220:223],v193 offset:7168
 s_add_u32 m0,s92,0x4000
 s_add_u32 s69,s91,17408
 s_add_u32 s91,s91,34816
 s_xor_b32 s92,s92,0x8000
 buffer_load_dwordx4 v243,s[36:39],s69 offen offset:0 sc1 lds
 N a[96:111],a[200:203],v[80:83],a[96:111]
 v_exp_f32 v6,v6
 v_add_f32 v199,v199,v4
 v_exp_f32 v7,v7
 v_cvt_pk_bf16_f32 v2,v4,v5
 N a[48:63],a[204:207],v[64:67],a[48:63]
 buffer_load_dwordx4 v243,s[36:39],s69 offen offset:1024 sc1 lds
 v_add_f32 v199,v199,v5
 v_exp_f32 v8,v8
 v_add_f32 v199,v199,v6
 N a[112:127],a[204:207],v[80:83],a[112:127]
 W 2
 v_exp_f32 v9,v9
 v_cvt_pk_bf16_f32 v3,v6,v7
 v_add_f32 v199,v199,v7
 v_exp_f32 v10,v10
 N a[0:15],a[208:211],v[72:75],a[0:15]
 ds_read_b128 a[224:227],v193 offset:8192
 ds_read_b128 a[228:231],v193 offset:9216
 buffer_load_dwordx4 v243,s[36:39],s69 offen offset:2048 sc1 lds
 v_add_f32 v199,v199,v8
 N a[64:79],a[208:211],v[88:91],a[64:79]
 v_exp_f32 v11,v11
 v_add_f32 v199,v199,v9
 v_cvt_pk_bf16_f32 v8,v8,v9
 v_exp_f32 v12,v12
 N a[16:31],a[212:215],v[72:75],a[16:31]
 buffer_load_dwordx4 v243,s[36:39],s69 offen offset:3072 sc1 lds
 v_add_f32 v199,v199,v10
 v_exp_f32 v13,v13
 v_cvt_pk_bf16_f32 v9,v10,v11
 v_add_f32 v199,v199,v11
 N a[80:95],a[212:215],v[88:91],a[80:95]
 W 2
 v_exp_f32 v14,v14
 v_add_f32 v199,v199,v12
 v_exp_f32 v15,v15
 v_cvt_pk_bf16_f32 v10,v12,v13
 N a[32:47],a[216:219],v[72:75],a[32:47]
 ds_read_b128 a[232:235],v193 offset:10240
 ds_read_b128 a[236:239],v193 offset:11264
 v_add_f32 v199,v199,v13
 v_add_f32 v199,v199,v14
 v_cvt_pk_bf16_f32 v11,v14,v15
 v_add_f32 v199,v199,v15
 N a[96:111],a[216:219],v[88:91],a[96:111]
 buffer_load_dword v207,v208,s[8:11],0 offen sc1
 v_exp_f32 v16,v16
 v_exp_f32 v17,v17
 N a[48:63],a[220:223],v[72:75],a[48:63]
 v_exp_f32 v18,v18
 v_add_f32 v199,v199,v16
 v_exp_f32 v19,v19
 v_add_f32 v199,v199,v17
 N a[112:127],a[220:223],v[88:91],a[112:127]
 W 2
 v_cvt_pk_bf16_f32 v16,v16,v17
 v_exp_f32 v20,v20
 v_add_f32 v199,v199,v18
 v_exp_f32 v21,v21
 ds_read_b128 a[240:243],v193 offset:12288
 ds_read_b128 a[244:247],v193 offset:13312
 v_cvt_pk_bf16_f32 v17,v18,v19
 v_add_f32 v199,v199,v19
 v_exp_f32 v22,v22
 N a[64:79],a[224:227],v[112:115],a[64:79]
 v_add_f32 v199,v199,v20
 v_exp_f32 v23,v23
 v_cvt_pk_bf16_f32 v18,v20,v21
 v_add_f32 v199,v199,v21
 v_exp_f32 v24,v24
 v_add_f32 v199,v199,v22
 v_exp_f32 v25,v25
 v_cvt_pk_bf16_f32 v19,v22,v23
 N a[80:95],a[228:231],v[112:115],a[80:95]
 W 2
 v_add_f32 v199,v199,v23
 v_exp_f32 v26,v26
 v_add_f32 v199,v199,v24
 v_exp_f32 v27,v27
 ds_read_b128 a[248:251],v193 offset:14336
 ds_read_b128 a[252:255],v193 offset:15360
 v_add_f32 v199,v199,v25
 v_cvt_pk_bf16_f32 v24,v24,v25
 v_exp_f32 v28,v28
 N a[96:111],a[232:235],v[112:115],a[96:111]
 v_add_f32 v199,v199,v26
 v_exp_f32 v29,v29
 v_cvt_pk_bf16_f32 v25,v26,v27
 v_add_f32 v199,v199,v27
 v_add_u32 v192,s76,v224
 s_add_u32 s76,s76,32768
 s_and_b32 s76,s76,0xffff
 v_exp_f32 v30,v30
 v_add_f32 v199,v199,v28
 N a[112:127],a[236:239],v[112:115],a[112:127]
 W 2
 s_waitcnt vmcnt(8) lgkmcnt(0)
 s_barrier
 v_exp_f32 v31,v31
 v_cvt_pk_bf16_f32 v26,v28,v29
 v_add_f32 v199,v199,v29
 ds_read_b128 a[192:195],v192 offset:0
 ds_read_b128 a[196:199],v192 offset:1024
 v_add_f32 v199,v199,v30
 v_cvt_pk_bf16_f32 v27,v30,v31
 v_add_f32 v199,v199,v31
 N a[64:79],a[240:243],v[120:123],a[64:79]
 ds_read_b128 a[200:203],v192 offset:2048
 ds_read_b128 a[204:207],v192 offset:3072
 N a[80:95],a[244:247],v[120:123],a[80:95]
 ds_read_b128 a[208:211],v192 offset:4096
 ds_read_b128 a[212:215],v192 offset:5120
 N a[96:111],a[248:251],v[120:123],a[96:111]
 ds_read_b128 a[216:219],v192 offset:6144
 ds_read_b128 a[220:223],v192 offset:7168
 N a[112:127],a[252:255],v[120:123],a[112:127]
 s_branch F_FINL
F_AAmo3:
 W 7
 N v[0:15],a[192:195],a[128:131],v[128:143]
 v_exp_f32 v96,v96
 v_exp_f32 v97,v97
 v_exp_f32 v98,v98
 N v[16:31],a[192:195],a[160:163],v[144:159]
 s_mov_b32 m0,s92
 s_mov_b32 s69,s91
 s_add_u32 s91,s91,17408
 s_add_u32 s92,s92,0x4000
 s_and_b32 s92,s92,0xffff
 buffer_load_dwordx4 v243,s[36:39],s69 offen offset:0 sc1 lds
 W 6
 N v[0:15],a[196:199],a[132:135],v[0:15]
 v_add_f32 v197,v197,v96
 v_exp_f32 v99,v99
 v_add_f32 v197,v197,v97
 v_cvt_pk_bf16_f32 v96,v96,v97
 N v[16:31],a[196:199],a[164:167],v[16:31]
 W 4
 v_exp_f32 v100,v100
 v_add_f32 v197,v197,v98
 v_exp_f32 v101,v101
 v_cvt_pk_bf16_f32 v97,v98,v99
 N v[0:15],a[200:203],a[136:139],v[0:15]
 v_add_f32 v197,v197,v99
 v_exp_f32 v102,v102
 v_add_f32 v197,v197,v100
 v_exp_f32 v103,v103
 N v[16:31],a[200:203],a[168:171],v[16:31]
 buffer_load_dwordx4 v243,s[36:39],s69 offen offset:1024 sc1 lds
 v_cvt_pk_bf16_f32 v98,v100,v101
 v_add_f32 v197,v197,v101
 v_exp_f32 v104,v104
 v_add_f32 v197,v197,v102
 N v[0:15],a[204:207],a[140:143],v[0:15]
 v_exp_f32 v105,v105
 v_cvt_pk_bf16_f32 v99,v102,v103
 v_add_f32 v197,v197,v103
 v_exp_f32 v106,v106
 N v[16:31],a[204:207],a[172:175],v[16:31]
 W 2
 v_add_f32 v197,v197,v104
 v_exp_f32 v107,v107
 v_add_f32 v197,v197,v105
 v_cvt_pk_bf16_f32 v104,v104,v105
 N v[0:15],a[208:211],a[144:147],v[0:15]
 ds_read_b128 a[224:227],v192 offset:8192
 ds_read_b128 a[228:231],v192 offset:9216
 v_exp_f32 v108,v108
 v_add_f32 v197,v197,v106
 N v[16:31],a[208:211],a[176:179],v[16:31]
 buffer_load_dwordx4 v243,s[36:39],s69 offen offset:2048 sc1 lds
 v_exp_f32 v109,v109
 v_cvt_pk_bf16_f32 v105,v106,v107
 v_add_f32 v197,v197,v107
 N v[0:15],a[212:215],a[148:151],v[0:15]
 v_exp_f32 v110,v110
 v_add_f32 v197,v197,v108
 v_exp_f32 v111,v111
 v_cvt_pk_bf16_f32 v106,v108,v109
 N v[16:31],a[212:215],a[180:183],v[16:31]
 W 2
 v_add_f32 v197,v197,v109
 v_add_f32 v197,v197,v110
 v_cvt_pk_bf16_f32 v107,v110,v111
 v_add_f32 v197,v197,v111
 v_exp_f32 v112,v112
 N v[0:15],a[216:219],a[152:155],v[0:15]
 ds_read_b128 a[232:235],v192 offset:10240
 ds_read_b128 a[236:239],v192 offset:11264
 v_exp_f32 v113,v113
 v_exp_f32 v114,v114
 N v[16:31],a[216:219],a[184:187],v[16:31]
 buffer_load_dwordx4 v243,s[36:39],s69 offen offset:3072 sc1 lds
 v_add_f32 v199,v199,v112
 v_exp_f32 v115,v115
 v_add_f32 v199,v199,v113
 v_cvt_pk_bf16_f32 v112,v112,v113
 N v[0:15],a[220:223],a[156:159],v[0:15]
 v_exp_f32 v116,v116
 v_add_f32 v199,v199,v114
 v_exp_f32 v117,v117
 v_cvt_pk_bf16_f32 v113,v114,v115
 N v[16:31],a[220:223],a[188:191],v[16:31]
 W 2
 v_add_f32 v199,v199,v115
 v_exp_f32 v118,v118
 v_add_f32 v199,v199,v116
 v_exp_f32 v119,v119
 N v[32:47],a[224:227],a[128:131],v[128:143]
 ds_read_b128 a[240:243],v192 offset:12288
 ds_read_b128 a[244:247],v192 offset:13312
 v_cvt_pk_bf16_f32 v114,v116,v117
 v_add_f32 v199,v199,v117
 v_exp_f32 v120,v120
 N v[48:63],a[224:227],a[160:163],v[144:159]
 s_add_u32 m0,s94,0x10000
 s_mov_b32 s69,s93
 s_add_u32 s93,s93,17408
 s_add_u32 s94,s94,0x4000
 s_and_b32 s94,s94,0xffff
 buffer_load_dwordx4 v243,s[40:43],s69 offen offset:0 sc1 lds
 N v[32:47],a[228:231],a[132:135],v[32:47]
 v_add_f32 v199,v199,v118
 v_exp_f32 v121,v121
 v_cvt_pk_bf16_f32 v115,v118,v119
 v_add_f32 v199,v199,v119
 N v[48:63],a[228:231],a[164:167],v[48:63]
 W 2
 v_exp_f32 v122,v122
 v_add_f32 v199,v199,v120
 v_exp_f32 v123,v123
 v_add_f32 v199,v199,v121
 N v[32:47],a[232:235],a[136:139],v[32:47]
 ds_read_b128 a[248:251],v192 offset:14336
 ds_read_b128 a[252:255],v192 offset:15360
 v_cvt_pk_bf16_f32 v120,v120,v121
 v_exp_f32 v124,v124
 v_add_f32 v199,v199,v122
 N v[48:63],a[232:235],a[168:171],v[48:63]
 v_add_u32 v193,s77,v194
 s_add_u32 s77,s77,16384
 s_and_b32 s77,s77,0xffff
 buffer_load_dwordx4 v243,s[40:43],s69 offen offset:1024 sc1 lds
 v_exp_f32 v125,v125
 N v[32:47],a[236:239],a[140:143],v[32:47]
 v_cvt_pk_bf16_f32 v121,v122,v123
 v_add_f32 v199,v199,v123
 v_exp_f32 v126,v126
 v_add_f32 v199,v199,v124
 N v[48:63],a[236:239],a[172:175],v[48:63]
 W 2
 v_exp_f32 v127,v127
 v_cvt_pk_bf16_f32 v122,v124,v125
 v_add_f32 v199,v199,v125
 v_add_f32 v199,v199,v126
 v_cvt_pk_bf16_f32 v123,v126,v127
 N v[32:47],a[240:243],a[144:147],v[32:47]
 ds_read_b128 a[192:195],v193 offset:0
 ds_read_b128 a[196:199],v193 offset:1024
 v_add_f32 v199,v199,v127
 v_max_f32 v200,v197,v199
 N v[48:63],a[240:243],a[176:179],v[48:63]
 buffer_load_dwordx4 v243,s[40:43],s69 offen offset:2048 sc1 lds
 N v[32:47],a[244:247],a[148:151],v[32:47]
 N v[48:63],a[244:247],a[180:183],v[48:63]
 W 2
 N v[32:47],a[248:251],a[152:155],v[32:47]
 ds_read_b128 a[200:203],v193 offset:2048
 ds_read_b128 a[204:207],v193 offset:3072
 N v[48:63],a[248:251],a[184:187],v[48:63]
 buffer_load_dwordx4 v243,s[40:43],s69 offen offset:3072 sc1 lds
 N v[32:47],a[252:255],a[156:159],v[32:47]
 N v[48:63],a[252:255],a[188:191],v[48:63]
 W 2
 v_cmp_lt_f32 vcc,s78,v200
 s_cbranch_vccz F_c30
 s_call_b64 s[82:83],F_XAA1
F_c30:
 v_add_f32 v196,v196,v197
 v_add_f32 v198,v198,v199
 s_add_u32 s75,s75,64
 N a[0:15],a[192:195],v[64:67],a[0:15]
 ds_read_b128 a[208:211],v193 offset:4096
 ds_read_b128 a[212:215],v193 offset:5120
 v_exp_f32 v0,v0
 v_exp_f32 v1,v1
 N a[64:79],a[192:195],v[80:83],a[64:79]
 v_exp_f32 v2,v2
 v_add_f32 v197,v0,v1
 v_exp_f32 v3,v3
 v_cvt_pk_bf16_f32 v0,v0,v1
 N a[16:31],a[196:199],v[64:67],a[16:31]
 v_exp_f32 v4,v4
 v_add_f32 v197,v197,v2
 v_exp_f32 v5,v5
 v_cvt_pk_bf16_f32 v1,v2,v3
 N a[80:95],a[196:199],v[80:83],a[80:95]
 W 2
 v_add_f32 v197,v197,v3
 v_exp_f32 v6,v6
 v_add_f32 v197,v197,v4
 v_exp_f32 v7,v7
 N a[32:47],a[200:203],v[64:67],a[32:47]
 ds_read_b128 a[216:219],v193 offset:6144
 ds_read_b128 a[220:223],v193 offset:7168
 v_cvt_pk_bf16_f32 v2,v4,v5
 v_add_f32 v197,v197,v5
 v_exp_f32 v8,v8
 N a[96:111],a[200:203],v[80:83],a[96:111]
 v_add_f32 v197,v197,v6
 v_exp_f32 v9,v9
 v_cvt_pk_bf16_f32 v3,v6,v7
 v_add_f32 v197,v197,v7
 N a[48:63],a[204:207],v[64:67],a[48:63]
 v_exp_f32 v10,v10
 v_add_f32 v197,v197,v8
 v_exp_f32 v11,v11
 v_add_f32 v197,v197,v9
 N a[112:127],a[204:207],v[80:83],a[112:127]
 W 2
 v_cvt_pk_bf16_f32 v8,v8,v9
 v_exp_f32 v12,v12
 v_add_f32 v197,v197,v10
 v_exp_f32 v13,v13
 N a[0:15],a[208:211],v[72:75],a[0:15]
 ds_read_b128 a[224:227],v193 offset:8192
 ds_read_b128 a[228:231],v193 offset:9216
 v_cvt_pk_bf16_f32 v9,v10,v11
 v_add_f32 v197,v197,v11
 v_exp_f32 v14,v14
 N a[64:79],a[208:211],v[88:91],a[64:79]
 v_add_f32 v197,v197,v12
 v_exp_f32 v15,v15
 v_cvt_pk_bf16_f32 v10,v12,v13
 v_add_f32 v197,v197,v13
 v_add_f32 v197,v197,v14
 N a[16:31],a[212:215],v[72:75],a[16:31]
 v_cvt_pk_bf16_f32 v11,v14,v15
 v_add_f32 v197,v197,v15
 v_exp_f32 v16,v16
 v_exp_f32 v17,v17
 N a[80:95],a[212:215],v[88:91],a[80:95]
 W 2
 v_exp_f32 v18,v18
 v_add_f32 v199,v16,v17
 v_exp_f32 v19,v19
 v_cvt_pk_bf16_f32 v16,v16,v17
 N a[32:47],a[216:219],v[72:75],a[32:47]
 ds_read_b128 a[232:235],v193 offset:10240
 ds_read_b128 a[236:239],v193 offset:11264
 v_exp_f32 v20,v20
 v_add_f32 v199,v199,v18
 N a[96:111],a[216:219],v[88:91],a[96:111]
 v_exp_f32 v21,v21
 v_cvt_pk_bf16_f32 v17,v18,v19
 v_add_f32 v199,v199,v19
 v_exp_f32 v22,v22
 N a[48:63],a[220:223],v[72:75],a[48:63]
 v_add_f32 v199,v199,v20
 v_exp_f32 v23,v23
 v_cvt_pk_bf16_f32 v18,v20,v21
 v_add_f32 v199,v199,v21
 N a[112:127],a[220:223],v[88:91],a[112:127]
 W 2
 v_exp_f32 v24,v24
 v_add_f32 v199,v199,v22
 v_exp_f32 v25,v25
 v_cvt_pk_bf16_f32 v19,v22,v23
 N a[0:15],a[224:227],v[96:99],a[0:15]
 ds_read_b128 a[240:243],v193 offset:12288
 ds_read_b128 a[244:247],v193 offset:13312
 v_add_f32 v199,v199,v23
 v_exp_f32 v26,v26
 v_add_f32 v199,v199,v24
 N a[64:79],a[224:227],v[112:115],a[64:79]
 v_exp_f32 v27,v27
 v_add_f32 v199,v199,v25
 v_cvt_pk_bf16_f32 v24,v24,v25
 v_exp_f32 v28,v28
 N a[16:31],a[228:231],v[96:99],a[16:31]
 v_add_f32 v199,v199,v26
 v_exp_f32 v29,v29
 v_cvt_pk_bf16_f32 v25,v26,v27
 v_add_f32 v199,v199,v27
 N a[80:95],a[228:231],v[112:115],a[80:95]
 W 2
 v_exp_f32 v30,v30
 v_add_f32 v199,v199,v28
 v_exp_f32 v31,v31
 v_cvt_pk_bf16_f32 v26,v28,v29
 N a[32:47],a[232:235],v[96:99],a[32:47]
 ds_read_b128 a[248:251],v193 offset:14336
 ds_read_b128 a[252:255],v193 offset:15360
 v_add_f32 v199,v199,v29
 v_add_f32 v199,v199,v30
 v_cvt_pk_bf16_f32 v27,v30,v31
 v_add_f32 v199,v199,v31
 N a[96:111],a[232:235],v[112:115],a[96:111]
 N a[48:63],a[236:239],v[96:99],a[48:63]
 v_add_u32 v192,s76,v224
 s_add_u32 s76,s76,16384
 s_and_b32 s76,s76,0xffff
 N a[112:127],a[236:239],v[112:115],a[112:127]
 W 2
 s_waitcnt vmcnt(16) lgkmcnt(0)
 s_barrier
 N a[0:15],a[240:243],v[104:107],a[0:15]
 ds_read_b128 a[192:195],v192 offset:0
 ds_read_b128 a[196:199],v192 offset:1024
 N a[64:79],a[240:243],v[120:123],a[64:79]
 ds_read_b128 a[200:203],v192 offset:2048
 ds_read_b128 a[204:207],v192 offset:3072
 N a[16:31],a[244:247],v[104:107],a[16:31]
 N a[80:95],a[244:247],v[120:123],a[80:95]
 ds_read_b128 a[208:211],v192 offset:4096
 ds_read_b128 a[212:215],v192 offset:5120
 N a[32:47],a[248:251],v[104:107],a[32:47]
 N a[96:111],a[248:251],v[120:123],a[96:111]
 ds_read_b128 a[216:219],v192 offset:6144
 ds_read_b128 a[220:223],v192 offset:7168
 N a[48:63],a[252:255],v[104:107],a[48:63]
 N a[112:127],a[252:255],v[120:123],a[112:127]
F_AAme3:
 W 7
 N v[64:79],a[192:195],a[128:131],v[128:143]
 v_exp_f32 v32,v32
 v_exp_f32 v33,v33
 v_exp_f32 v34,v34
 N v[80:95],a[192:195],a[160:163],v[144:159]
 s_mov_b32 m0,s92
 s_mov_b32 s69,s91
 s_add_u32 s91,s91,17408
 s_add_u32 s92,s92,0x4000
 s_and_b32 s92,s92,0xffff
 buffer_load_dwordx4 v243,s[36:39],s69 offen offset:0 sc1 lds
 W 6
 N v[64:79],a[196:199],a[132:135],v[64:79]
 v_add_f32 v197,v197,v32
 v_exp_f32 v35,v35
 v_add_f32 v197,v197,v33
 v_cvt_pk_bf16_f32 v32,v32,v33
 N v[80:95],a[196:199],a[164:167],v[80:95]
 W 4
 v_exp_f32 v36,v36
 v_add_f32 v197,v197,v34
 v_exp_f32 v37,v37
 v_cvt_pk_bf16_f32 v33,v34,v35
 N v[64:79],a[200:203],a[136:139],v[64:79]
 buffer_load_dwordx4 v243,s[36:39],s69 offen offset:1024 sc1 lds
 v_add_f32 v197,v197,v35
 v_exp_f32 v38,v38
 v_add_f32 v197,v197,v36
 N v[80:95],a[200:203],a[168:171],v[80:95]
 v_exp_f32 v39,v39
 v_cvt_pk_bf16_f32 v34,v36,v37
 v_add_f32 v197,v197,v37
 v_exp_f32 v40,v40
 N v[64:79],a[204:207],a[140:143],v[64:79]
 v_add_f32 v197,v197,v38
 v_exp_f32 v41,v41
 v_cvt_pk_bf16_f32 v35,v38,v39
 v_add_f32 v197,v197,v39
 N v[80:95],a[204:207],a[172:175],v[80:95]
 W 2
 buffer_load_dwordx4 v243,s[36:39],s69 offen offset:2048 sc1 lds
 v_exp_f32 v42,v42
 v_add_f32 v197,v197,v40
 N v[64:79],a[208:211],a[144:147],v[64:79]
 ds_read_b128 a[224:227],v192 offset:8192
 ds_read_b128 a[228:231],v192 offset:9216
 v_exp_f32 v43,v43
 v_add_f32 v197,v197,v41
 v_cvt_pk_bf16_f32 v40,v40,v41
 N v[80:95],a[208:211],a[176:179],v[80:95]
 v_exp_f32 v44,v44
 v_add_f32 v197,v197,v42
 v_exp_f32 v45,v45
 v_cvt_pk_bf16_f32 v41,v42,v43
 N v[64:79],a[212:215],a[148:151],v[64:79]
 buffer_load_dwordx4 v243,s[36:39],s69 offen offset:3072 sc1 lds
 v_add_f32 v197,v197,v43
 v_exp_f32 v46,v46
 v_add_f32 v197,v197,v44
 N v[80:95],a[212:215],a[180:183],v[80:95]
 W 2
 v_exp_f32 v47,v47
 v_cvt_pk_bf16_f32 v42,v44,v45
 v_add_f32 v197,v197,v45
 v_add_f32 v197,v197,v46
 v_cvt_pk_bf16_f32 v43,v46,v47
 N v[64:79],a[216:219],a[152:155],v[64:79]
 ds_read_b128 a[232:235],v192 offset:10240
 ds_read_b128 a[236:239],v192 offset:11264
 v_add_f32 v197,v197,v47
 v_exp_f32 v48,v48
 N v[80:95],a[216:219],a[184:187],v[80:95]
 s_add_u32 m0,s94,0x10000
 s_mov_b32 s69,s93
 s_add_u32 s93,s93,17408
 s_add_u32 s94,s94,0x4000
 s_and_b32 s94,s94,0xffff
 buffer_load_dwordx4 v243,s[40:43],s69 offen offset:0 sc1 lds
 N v[64:79],a[220:223],a[156:159],v[64:79]
 v_exp_f32 v49,v49
 v_exp_f32 v50,v50
 v_add_f32 v199,v199,v48
 N v[80:95],a[220:223],a[188:191],v[80:95]
 W 2
 v_exp_f32 v51,v51
 v_add_f32 v199,v199,v49
 v_cvt_pk_bf16_f32 v48,v48,v49
 v_exp_f32 v52,v52
 N v[96:111],a[224:227],a[128:131],v[128:143]
 ds_read_b128 a[240:243],v192 offset:12288
 ds_read_b128 a[244:247],v192 offset:13312
 buffer_load_dwordx4 v243,s[40:43],s69 offen offset:1024 sc1 lds
 v_add_f32 v199,v199,v50
 N v[112:127],a[224:227],a[160:163],v[144:159]
 v_exp_f32 v53,v53
 v_cvt_pk_bf16_f32 v49,v50,v51
 v_add_f32 v199,v199,v51
 v_exp_f32 v54,v54
 N v[96:111],a[228:231],a[132:135],v[96:111]
 v_add_f32 v199,v199,v52
 v_exp_f32 v55,v55
 v_cvt_pk_bf16_f32 v50,v52,v53
 v_add_f32 v199,v199,v53
 N v[112:127],a[228:231],a[164:167],v[112:127]
 W 2
 buffer_load_dwordx4 v243,s[40:43],s69 offen offset:2048 sc1 lds
 v_exp_f32 v56,v56
 v_add_f32 v199,v199,v54
 N v[96:111],a[232:235],a[136:139],v[96:111]
 ds_read_b128 a[248:251],v192 offset:14336
 ds_read_b128 a[252:255],v192 offset:15360
 v_exp_f32 v57,v57
 v_cvt_pk_bf16_f32 v51,v54,v55
 v_add_f32 v199,v199,v55
 N v[112:127],a[232:235],a[168:171],v[112:127]
 v_add_u32 v193,s77,v194
 s_add_u32 s77,s77,16384
 s_and_b32 s77,s77,0xffff
 v_exp_f32 v58,v58
 v_add_f32 v199,v199,v56
 N v[96:111],a[236:239],a[140:143],v[96:111]
 buffer_load_dwordx4 v243,s[40:43],s69 offen offset:3072 sc1 lds
 v_exp_f32 v59,v59
 v_add_f32 v199,v199,v57
 v_cvt_pk_bf16_f32 v56,v56,v57
 N v[112:127],a[236:239],a[172:175],v[112:127]
 W 2
 v_exp_f32 v60,v60
 v_add_f32 v199,v199,v58
 v_exp_f32 v61,v61
 v_cvt_pk_bf16_f32 v57,v58,v59
 N v[96:111],a[240:243],a[144:147],v[96:111]
 ds_read_b128 a[192:195],v193 offset:0
 ds_read_b128 a[196:199],v193 offset:1024
 v_add_f32 v199,v199,v59
 v_exp_f32 v62,v62
 v_add_f32 v199,v199,v60
 N v[112:127],a[240:243],a[176:179],v[112:127]
 s_add_u32 m0,s72,131072
 s_add_u32 s68,s3,0
 buffer_load_dwordx4 v220,s[48:51],s68 offen lds
 v_exp_f32 v63,v63
 v_cvt_pk_bf16_f32 v58,v60,v61
 N v[96:111],a[244:247],a[148:151],v[96:111]
 v_add_f32 v199,v199,v61
 v_add_f32 v199,v199,v62
 v_cvt_pk_bf16_f32 v59,v62,v63
 v_add_f32 v199,v199,v63
 v_max_f32 v200,v197,v199
 N v[112:127],a[244:247],a[180:183],v[112:127]
 W 2
 N v[96:111],a[248:251],a[152:155],v[96:111]
 ds_read_b128 a[200:203],v193 offset:2048
 ds_read_b128 a[204:207],v193 offset:3072
 s_add_u32 m0,s72,135168
 s_add_u32 s68,s3,128
 buffer_load_dwordx4 v220,s[48:51],s68 offen lds
 N v[112:127],a[248:251],a[184:187],v[112:127]
 N v[96:111],a[252:255],a[156:159],v[96:111]
 N v[112:127],a[252:255],a[188:191],v[112:127]
 W 2
 s_add_u32 m0,s72,139264
 s_add_u32 s68,s3,32768
 buffer_load_dwordx4 v220,s[48:51],s68 offen lds
 v_cmp_lt_f32 vcc,s78,v200
 s_cbranch_vccz F_c31
 s_call_b64 s[82:83],F_XAA0
F_c31:
 N a[0:15],a[192:195],v[0:3],a[0:15]
 ds_read_b128 a[208:211],v193 offset:4096
 ds_read_b128 a[212:215],v193 offset:5120
 v_add_f32 v196,v196,v197
 v_add_f32 v198,v198,v199
 s_add_u32 s75,s75,64
 N a[64:79],a[192:195],v[16:19],a[64:79]
 v_exp_f32 v64,v64
 v_exp_f32 v65,v65
 v_exp_f32 v66,v66
 N a[16:31],a[196:199],v[0:3],a[16:31]
 s_add_u32 m0,s72,143360
 s_add_u32 s68,s3,32896
 buffer_load_dwordx4 v220,s[48:51],s68 offen lds
 v_add_f32 v197,v64,v65
 v_exp_f32 v67,v67
 N a[80:95],a[196:199],v[16:19],a[80:95]
 W 2
 v_cvt_pk_bf16_f32 v64,v64,v65
 v_exp_f32 v68,v68
 v_add_f32 v197,v197,v66
 v_exp_f32 v69,v69
 N a[32:47],a[200:203],v[0:3],a[32:47]
 ds_read_b128 a[216:219],v193 offset:6144
 ds_read_b128 a[220:223],v193 offset:7168
 v_cvt_pk_bf16_f32 v65,v66,v67
 v_add_f32 v197,v197,v67
 v_exp_f32 v70,v70
 N a[96:111],a[200:203],v[16:19],a[96:111]
 s_add_u32 m0,s72,147456
 s_add_u32 s68,s3,65536
 buffer_load_dwordx4 v220,s[48:51],s68 offen lds
 v_add_f32 v197,v197,v68
 v_exp_f32 v71,v71
 N a[48:63],a[204:207],v[0:3],a[48:63]
 v_cvt_pk_bf16_f32 v66,v68,v69
 v_add_f32 v197,v197,v69
 v_exp_f32 v72,v72
 v_add_f32 v197,v197,v70
 N a[112:127],a[204:207],v[16:19],a[112:127]
 W 2
 v_exp_f32 v73,v73
 v_cvt_pk_bf16_f32 v67,v70,v71
 v_add_f32 v197,v197,v71
 v_exp_f32 v74,v74
 N a[0:15],a[208:211],v[8:11],a[0:15]
 ds_read_b128 a[224:227],v193 offset:8192
 ds_read_b128 a[228:231],v193 offset:9216
 s_add_u32 m0,s72,151552
 s_add_u32 s68,s3,65664
 buffer_load_dwordx4 v220,s[48:51],s68 offen lds
 N a[64:79],a[208:211],v[24:27],a[64:79]
 v_add_f32 v197,v197,v72
 v_exp_f32 v75,v75
 v_add_f32 v197,v197,v73
 v_cvt_pk_bf16_f32 v72,v72,v73
 N a[16:31],a[212:215],v[8:11],a[16:31]
 v_exp_f32 v76,v76
 v_add_f32 v197,v197,v74
 v_exp_f32 v77,v77
 v_cvt_pk_bf16_f32 v73,v74,v75
 N a[80:95],a[212:215],v[24:27],a[80:95]
 W 2
 s_add_u32 m0,s72,155648
 s_add_u32 s68,s3,98304
 buffer_load_dwordx4 v220,s[48:51],s68 offen lds
 v_add_f32 v197,v197,v75
 N a[32:47],a[216:219],v[8:11],a[32:47]
 ds_read_b128 a[232:235],v193 offset:10240
 ds_read_b128 a[236:239],v193 offset:11264
 v_exp_f32 v78,v78
 v_add_f32 v197,v197,v76
 N a[96:111],a[216:219],v[24:27],a[96:111]
 v_exp_f32 v79,v79
 v_cvt_pk_bf16_f32 v74,v76,v77
 v_add_f32 v197,v197,v77
 v_add_f32 v197,v197,v78
 v_cvt_pk_bf16_f32 v75,v78,v79
 N a[48:63],a[220:223],v[8:11],a[48:63]
 s_add_u32 m0,s72,159744
 s_add_u32 s68,s3,98432
 buffer_load_dwordx4 v220,s[48:51],s68 offen lds
 v_add_f32 v197,v197,v79
 v_subrev_u32 v206,96,v204
 v_cmp_le_i32 s[84:85],0,v206
 N a[112:127],a[220:223],v[24:27],a[112:127]
 W 2
 v_cmp_le_i32 s[86:87],1,v206
 v_cmp_le_i32 s[88:89],2,v206
 v_cmp_le_i32 s[98:99],3,v206
 v_cndmask_b32 v96,v205,v96,s[84:85]
 v_cndmask_b32 v97,v205,v97,s[86:87]
 v_cndmask_b32 v98,v205,v98,s[88:89]
 N a[0:15],a[224:227],v[32:35],a[0:15]
 ds_read_b128 a[240:243],v193 offset:12288
 ds_read_b128 a[244:247],v193 offset:13312
 v_cndmask_b32 v99,v205,v99,s[98:99]
 v_cmp_le_i32 s[84:85],8,v206
 v_cmp_le_i32 s[86:87],9,v206
 v_cmp_le_i32 s[88:89],10,v206
 N a[64:79],a[224:227],v[48:51],a[64:79]
 v_cmp_le_i32 s[98:99],11,v206
 v_cndmask_b32 v100,v205,v100,s[84:85]
 v_cndmask_b32 v101,v205,v101,s[86:87]
 v_cndmask_b32 v102,v205,v102,s[88:89]
 v_cndmask_b32 v103,v205,v103,s[98:99]
 v_cmp_le_i32 s[84:85],16,v206
 N a[16:31],a[228:231],v[32:35],a[16:31]
 v_cmp_le_i32 s[86:87],17,v206
 v_cmp_le_i32 s[88:89],18,v206
 v_cmp_le_i32 s[98:99],19,v206
 v_cndmask_b32 v104,v205,v104,s[84:85]
 v_cndmask_b32 v105,v205,v105,s[86:87]
 v_cndmask_b32 v106,v205,v106,s[88:89]
 N a[80:95],a[228:231],v[48:51],a[80:95]
 W 2
 v_cndmask_b32 v107,v205,v107,s[98:99]
 v_cmp_le_i32 s[84:85],24,v206
 v_cmp_le_i32 s[86:87],25,v206
 v_cmp_le_i32 s[88:89],26,v206
 v_cmp_le_i32 s[98:99],27,v206
 v_cndmask_b32 v108,v205,v108,s[84:85]
 N a[32:47],a[232:235],v[32:35],a[32:47]
 ds_read_b128 a[248:251],v193 offset:14336
 ds_read_b128 a[252:255],v193 offset:15360
 v_cndmask_b32 v109,v205,v109,s[86:87]
 v_cndmask_b32 v110,v205,v110,s[88:89]
 v_cndmask_b32 v111,v205,v111,s[98:99]
 N a[96:111],a[232:235],v[48:51],a[96:111]
 v_exp_f32 v80,v80
 v_exp_f32 v81,v81
 v_exp_f32 v82,v82
 N a[48:63],a[236:239],v[32:35],a[48:63]
 v_add_u32 v192,s76,v224
 s_add_u32 s76,s76,32768
 s_and_b32 s76,s76,0xffff
 v_add_f32 v199,v80,v81
 v_exp_f32 v83,v83
 v_cvt_pk_bf16_f32 v80,v80,v81
 N a[112:127],a[236:239],v[48:51],a[112:127]
 W 2
 s_waitcnt vmcnt(16) lgkmcnt(0)
 s_barrier
 v_exp_f32 v84,v84
 v_add_f32 v199,v199,v82
 N a[0:15],a[240:243],v[40:43],a[0:15]
 ds_read_b128 a[192:195],v192 offset:0
 ds_read_b128 a[196:199],v192 offset:1024
 v_exp_f32 v85,v85
 v_cvt_pk_bf16_f32 v81,v82,v83
 v_add_f32 v199,v199,v83
 N a[64:79],a[240:243],v[56:59],a[64:79]
 ds_read_b128 a[200:203],v192 offset:2048
 ds_read_b128 a[204:207],v192 offset:3072
 v_exp_f32 v86,v86
 v_add_f32 v199,v199,v84
 N a[16:31],a[244:247],v[40:43],a[16:31]
 v_exp_f32 v87,v87
 v_cvt_pk_bf16_f32 v82,v84,v85
 v_add_f32 v199,v199,v85
 v_exp_f32 v88,v88
 N a[80:95],a[244:247],v[56:59],a[80:95]
 ds_read_b128 a[208:211],v192 offset:4096
 ds_read_b128 a[212:215],v192 offset:5120
 v_add_f32 v199,v199,v86
 v_exp_f32 v89,v89
 N a[32:47],a[248:251],v[40:43],a[32:47]
 v_cvt_pk_bf16_f32 v83,v86,v87
 v_add_f32 v199,v199,v87
 v_exp_f32 v90,v90
 v_add_f32 v199,v199,v88
 N a[96:111],a[248:251],v[56:59],a[96:111]
 ds_read_b128 a[216:219],v192 offset:6144
 ds_read_b128 a[220:223],v192 offset:7168
 v_exp_f32 v91,v91
 v_add_f32 v199,v199,v89
 v_cvt_pk_bf16_f32 v88,v88,v89
 N a[48:63],a[252:255],v[40:43],a[48:63]
 v_exp_f32 v92,v92
 v_add_f32 v199,v199,v90
 v_exp_f32 v93,v93
 v_cvt_pk_bf16_f32 v89,v90,v91
 N a[112:127],a[252:255],v[56:59],a[112:127]
 v_add_f32 v199,v199,v91
 v_exp_f32 v94,v94
 v_add_f32 v199,v199,v92
 v_exp_f32 v95,v95
 v_cvt_pk_bf16_f32 v90,v92,v93
 v_add_f32 v199,v199,v93
 v_add_f32 v199,v199,v94
 v_cvt_pk_bf16_f32 v91,v94,v95
 v_add_f32 v199,v199,v95
 s_cmp_eq_u32 s66, 7
 s_cbranch_scc1 F_AC3
 W 7
 N v[0:15],a[192:195],a[160:163],v[144:159]
 ds_read_b128 a[224:227],v192 offset:8192
 ds_read_b128 a[228:231],v192 offset:9216
 v_exp_f32 v96,v96
 v_exp_f32 v97,v97
 W 8
 N v[0:15],a[196:199],a[164:167],v[0:15]
 W 6
 s_mov_b32 m0,s92
 s_mov_b32 s69,s91
 s_add_u32 s91,s91,17408
 s_add_u32 s92,s92,0x4000
 s_and_b32 s92,s92,0xffff
 buffer_load_dwordx4 v243,s[36:39],s69 offen offset:0 sc1 lds
 N v[0:15],a[200:203],a[168:171],v[0:15]
 ds_read_b128 a[232:235],v192 offset:10240
 ds_read_b128 a[236:239],v192 offset:11264
 v_exp_f32 v98,v98
 v_add_f32 v197,v197,v96
 N v[0:15],a[204:207],a[172:175],v[0:15]
 W 6
 v_add_u32 v211,1,v211
 buffer_store_dword v211,v210,s[8:11],s73 offen sc0 sc1
 buffer_load_dwordx4 v243,s[36:39],s69 offen offset:1024 sc1 lds
 v_exp_f32 v99,v99
 N v[0:15],a[208:211],a[176:179],v[0:15]
 ds_read_b128 a[240:243],v192 offset:12288
 ds_read_b128 a[244:247],v192 offset:13312
 v_add_f32 v197,v197,v97
 v_cvt_pk_bf16_f32 v96,v96,v97
 v_exp_f32 v100,v100
 N v[0:15],a[212:215],a[180:183],v[0:15]
 W 6
 buffer_load_dwordx4 v243,s[36:39],s69 offen offset:2048 sc1 lds
 v_add_f32 v197,v197,v98
 v_exp_f32 v101,v101
 v_cvt_pk_bf16_f32 v97,v98,v99
 N v[0:15],a[216:219],a[184:187],v[0:15]
 ds_read_b128 a[248:251],v192 offset:14336
 ds_read_b128 a[252:255],v192 offset:15360
 v_add_f32 v197,v197,v99
 v_exp_f32 v102,v102
 v_add_f32 v197,v197,v100
 N v[0:15],a[220:223],a[188:191],v[0:15]
 W 6
 buffer_load_dwordx4 v243,s[36:39],s69 offen offset:3072 sc1 lds
 v_exp_f32 v103,v103
 v_cvt_pk_bf16_f32 v98,v100,v101
 v_add_f32 v197,v197,v101
 N v[16:31],a[224:227],a[160:163],v[144:159]
 ds_read_b128 a[192:195],v192 offset:16384
 ds_read_b128 a[196:199],v192 offset:17408
 v_exp_f32 v104,v104
 v_add_f32 v197,v197,v102
 N v[16:31],a[228:231],a[164:167],v[16:31]
 W 6
 v_exp_f32 v105,v105
 v_cvt_pk_bf16_f32 v99,v102,v103
 v_add_f32 v197,v197,v103
 v_exp_f32 v106,v106
 N v[16:31],a[232:235],a[168:171],v[16:31]
 ds_read_b128 a[200:203],v192 offset:18432
 ds_read_b128 a[204:207],v192 offset:19456
 v_add_f32 v197,v197,v104
 v_exp_f32 v107,v107
 v_add_f32 v197,v197,v105
 N v[16:31],a[236:239],a[172:175],v[16:31]
 W 6
 v_cvt_pk_bf16_f32 v104,v104,v105
 v_exp_f32 v108,v108
 v_add_f32 v197,v197,v106
 v_exp_f32 v109,v109
 N v[16:31],a[240:243],a[176:179],v[16:31]
 ds_read_b128 a[208:211],v192 offset:20480
 ds_read_b128 a[212:215],v192 offset:21504
 v_cvt_pk_bf16_f32 v105,v106,v107
 v_add_f32 v197,v197,v107
 v_exp_f32 v110,v110
 N v[16:31],a[244:247],a[180:183],v[16:31]
 W 6
 v_add_f32 v197,v197,v108
 v_exp_f32 v111,v111
 v_cvt_pk_bf16_f32 v106,v108,v109
 v_add_f32 v197,v197,v109
 v_add_f32 v197,v197,v110
 N v[16:31],a[248:251],a[184:187],v[16:31]
 ds_read_b128 a[216:219],v192 offset:22528
 ds_read_b128 a[220:223],v192 offset:23552
 v_cvt_pk_bf16_f32 v107,v110,v111
 v_add_f32 v197,v197,v111
 v_exp_f32 v112,v112
 N v[16:31],a[252:255],a[188:191],v[16:31]
 W 6
 v_exp_f32 v113,v113
 v_exp_f32 v114,v114
 v_add_f32 v199,v199,v112
 N v[32:47],a[192:195],a[160:163],v[144:159]
 ds_read_b128 a[224:227],v192 offset:24576
 ds_read_b128 a[228:231],v192 offset:25600
 v_exp_f32 v115,v115
 v_add_f32 v199,v199,v113
 v_cvt_pk_bf16_f32 v112,v112,v113
 N v[32:47],a[196:199],a[164:167],v[32:47]
 W 6
 v_exp_f32 v116,v116
 v_add_f32 v199,v199,v114
 v_exp_f32 v117,v117
 v_cvt_pk_bf16_f32 v113,v114,v115
 N v[32:47],a[200:203],a[168:171],v[32:47]
 ds_read_b128 a[232:235],v192 offset:26624
 ds_read_b128 a[236:239],v192 offset:27648
 v_add_f32 v199,v199,v115
 v_exp_f32 v118,v118
 v_add_f32 v199,v199,v116
 N v[32:47],a[204:207],a[172:175],v[32:47]
 W 6
 v_exp_f32 v119,v119
 v_cvt_pk_bf16_f32 v114,v116,v117
 v_add_f32 v199,v199,v117
 v_exp_f32 v120,v120
 N v[32:47],a[208:211],a[176:179],v[32:47]
 ds_read_b128 a[240:243],v192 offset:28672
 ds_read_b128 a[244:247],v192 offset:29696
 v_add_f32 v199,v199,v118
 v_exp_f32 v121,v121
 v_cvt_pk_bf16_f32 v115,v118,v119
 N v[32:47],a[212:215],a[180:183],v[32:47]
 W 6
 v_add_f32 v199,v199,v119
 v_exp_f32 v122,v122
 v_add_f32 v199,v199,v120
 v_exp_f32 v123,v123
 N v[32:47],a[216:219],a[184:187],v[32:47]
 ds_read_b128 a[248:251],v192 offset:30720
 ds_read_b128 a[252:255],v192 offset:31744
 v_add_f32 v199,v199,v121
 v_cvt_pk_bf16_f32 v120,v120,v121
 v_exp_f32 v124,v124
 N v[32:47],a[220:223],a[188:191],v[32:47]
 W 6
 v_add_u32 v193,s77,v194
 s_add_u32 s77,s77,16384
 s_and_b32 s77,s77,0xffff
 v_add_f32 v199,v199,v122
 v_exp_f32 v125,v125
 N v[48:63],a[224:227],a[160:163],v[144:159]
 v_cvt_pk_bf16_f32 v121,v122,v123
 v_add_f32 v199,v199,v123
 v_exp_f32 v126,v126
 v_add_f32 v199,v199,v124
 N v[48:63],a[228:231],a[164:167],v[48:63]
 W 4
 W 0
 s_barrier
 v_exp_f32 v127,v127
 v_cvt_pk_bf16_f32 v122,v124,v125
 v_add_f32 v199,v199,v125
 N v[48:63],a[232:235],a[168:171],v[48:63]
 ds_read_b128 a[192:195],v193 offset:0
 ds_read_b128 a[196:199],v193 offset:1024
 v_add_f32 v199,v199,v126
 v_cvt_pk_bf16_f32 v123,v126,v127
 v_add_f32 v199,v199,v127
 v_max_f32 v200,v197,v199
 N v[48:63],a[236:239],a[172:175],v[48:63]
 s_add_u32 m0,s92,0x0
 N v[48:63],a[240:243],a[176:179],v[48:63]
 ds_read_b128 a[200:203],v193 offset:2048
 ds_read_b128 a[204:207],v193 offset:3072
 buffer_load_dwordx4 v243,s[36:39],s91 offen offset:0 sc1 lds
 N v[48:63],a[244:247],a[180:183],v[48:63]
 N v[48:63],a[248:251],a[184:187],v[48:63]
 buffer_load_dwordx4 v243,s[36:39],s91 offen offset:1024 sc1 lds
 N v[48:63],a[252:255],a[188:191],v[48:63]
 W 2
 v_cmp_lt_f32 vcc,s78,v200
 s_cbranch_vccz F_c32
 s_call_b64 s[82:83],F_XAB1
F_c32:
 v_add_f32 v196,v196,v197
 v_add_f32 v198,v198,v199
 s_add_u32 s75,s75,64
 N a[0:15],a[192:195],v[64:67],a[0:15]
 ds_read_b128 a[208:211],v193 offset:4096
 ds_read_b128 a[212:215],v193 offset:5120
 buffer_load_dwordx4 v243,s[36:39],s91 offen offset:2048 sc1 lds
 v_exp_f32 v0,v0
 N a[64:79],a[192:195],v[80:83],a[64:79]
 v_exp_f32 v1,v1
 v_exp_f32 v2,v2
 v_add_f32 v199,v0,v1
 N a[16:31],a[196:199],v[64:67],a[16:31]
 buffer_load_dwordx4 v243,s[36:39],s91 offen offset:3072 sc1 lds
 v_exp_f32 v3,v3
 v_cvt_pk_bf16_f32 v0,v0,v1
 v_exp_f32 v4,v4
 N a[80:95],a[196:199],v[80:83],a[80:95]
 W 2
 v_add_f32 v199,v199,v2
 v_exp_f32 v5,v5
 v_cvt_pk_bf16_f32 v1,v2,v3
 v_add_f32 v199,v199,v3
 N a[32:47],a[200:203],v[64:67],a[32:47]
 ds_read_b128 a[216:219],v193 offset:6144
 ds_read_b128 a[220:223],v193 offset:7168
 s_add_u32 m0,s92,0x4000
 s_add_u32 s69,s91,17408
 s_add_u32 s91,s91,34816
 s_xor_b32 s92,s92,0x8000
 buffer_load_dwordx4 v243,s[36:39],s69 offen offset:0 sc1 lds
 N a[96:111],a[200:203],v[80:83],a[96:111]
 v_exp_f32 v6,v6
 v_add_f32 v199,v199,v4
 v_exp_f32 v7,v7
 v_cvt_pk_bf16_f32 v2,v4,v5
 N a[48:63],a[204:207],v[64:67],a[48:63]
 buffer_load_dwordx4 v243,s[36:39],s69 offen offset:1024 sc1 lds
 v_add_f32 v199,v199,v5
 v_exp_f32 v8,v8
 v_add_f32 v199,v199,v6
 N a[112:127],a[204:207],v[80:83],a[112:127]
 W 2
 v_exp_f32 v9,v9
 v_cvt_pk_bf16_f32 v3,v6,v7
 v_add_f32 v199,v199,v7
 v_exp_f32 v10,v10
 N a[0:15],a[208:211],v[72:75],a[0:15]
 ds_read_b128 a[224:227],v193 offset:8192
 ds_read_b128 a[228:231],v193 offset:9216
 buffer_load_dwordx4 v243,s[36:39],s69 offen offset:2048 sc1 lds
 v_add_f32 v199,v199,v8
 N a[64:79],a[208:211],v[88:91],a[64:79]
 v_exp_f32 v11,v11
 v_add_f32 v199,v199,v9
 v_cvt_pk_bf16_f32 v8,v8,v9
 v_exp_f32 v12,v12
 N a[16:31],a[212:215],v[72:75],a[16:31]
 buffer_load_dwordx4 v243,s[36:39],s69 offen offset:3072 sc1 lds
 v_add_f32 v199,v199,v10
 v_exp_f32 v13,v13
 v_cvt_pk_bf16_f32 v9,v10,v11
 v_add_f32 v199,v199,v11
 N a[80:95],a[212:215],v[88:91],a[80:95]
 W 2
 v_exp_f32 v14,v14
 v_add_f32 v199,v199,v12
 v_exp_f32 v15,v15
 v_cvt_pk_bf16_f32 v10,v12,v13
 N a[32:47],a[216:219],v[72:75],a[32:47]
 ds_read_b128 a[232:235],v193 offset:10240
 ds_read_b128 a[236:239],v193 offset:11264
 v_add_f32 v199,v199,v13
 v_add_f32 v199,v199,v14
 v_cvt_pk_bf16_f32 v11,v14,v15
 v_add_f32 v199,v199,v15
 N a[96:111],a[216:219],v[88:91],a[96:111]
 buffer_load_dword v207,v208,s[8:11],0 offen sc1
 v_exp_f32 v16,v16
 v_exp_f32 v17,v17
 N a[48:63],a[220:223],v[72:75],a[48:63]
 v_exp_f32 v18,v18
 v_add_f32 v199,v199,v16
 v_exp_f32 v19,v19
 v_add_f32 v199,v199,v17
 N a[112:127],a[220:223],v[88:91],a[112:127]
 W 2
 v_cvt_pk_bf16_f32 v16,v16,v17
 v_exp_f32 v20,v20
 v_add_f32 v199,v199,v18
 v_exp_f32 v21,v21
 N a[0:15],a[224:227],v[96:99],a[0:15]
 ds_read_b128 a[240:243],v193 offset:12288
 ds_read_b128 a[244:247],v193 offset:13312
 v_cvt_pk_bf16_f32 v17,v18,v19
 v_add_f32 v199,v199,v19
 v_exp_f32 v22,v22
 N a[64:79],a[224:227],v[112:115],a[64:79]
 v_add_f32 v199,v199,v20
 v_exp_f32 v23,v23
 v_cvt_pk_bf16_f32 v18,v20,v21
 v_add_f32 v199,v199,v21
 N a[16:31],a[228:231],v[96:99],a[16:31]
 v_exp_f32 v24,v24
 v_add_f32 v199,v199,v22
 v_exp_f32 v25,v25
 v_cvt_pk_bf16_f32 v19,v22,v23
 N a[80:95],a[228:231],v[112:115],a[80:95]
 W 2
 v_add_f32 v199,v199,v23
 v_exp_f32 v26,v26
 v_add_f32 v199,v199,v24
 v_exp_f32 v27,v27
 N a[32:47],a[232:235],v[96:99],a[32:47]
 ds_read_b128 a[248:251],v193 offset:14336
 ds_read_b128 a[252:255],v193 offset:15360
 v_add_f32 v199,v199,v25
 v_cvt_pk_bf16_f32 v24,v24,v25
 v_exp_f32 v28,v28
 N a[96:111],a[232:235],v[112:115],a[96:111]
 v_add_f32 v199,v199,v26
 v_exp_f32 v29,v29
 v_cvt_pk_bf16_f32 v25,v26,v27
 v_add_f32 v199,v199,v27
 N a[48:63],a[236:239],v[96:99],a[48:63]
 v_add_u32 v192,s76,v224
 s_add_u32 s76,s76,32768
 s_and_b32 s76,s76,0xffff
 v_exp_f32 v30,v30
 v_add_f32 v199,v199,v28
 N a[112:127],a[236:239],v[112:115],a[112:127]
 W 2
 s_waitcnt vmcnt(8) lgkmcnt(0)
 s_barrier
 v_exp_f32 v31,v31
 v_cvt_pk_bf16_f32 v26,v28,v29
 v_add_f32 v199,v199,v29
 N a[0:15],a[240:243],v[104:107],a[0:15]
 ds_read_b128 a[192:195],v192 offset:0
 ds_read_b128 a[196:199],v192 offset:1024
 v_add_f32 v199,v199,v30
 v_cvt_pk_bf16_f32 v27,v30,v31
 v_add_f32 v199,v199,v31
 N a[64:79],a[240:243],v[120:123],a[64:79]
 ds_read_b128 a[200:203],v192 offset:2048
 ds_read_b128 a[204:207],v192 offset:3072
 N a[16:31],a[244:247],v[104:107],a[16:31]
 N a[80:95],a[244:247],v[120:123],a[80:95]
 ds_read_b128 a[208:211],v192 offset:4096
 ds_read_b128 a[212:215],v192 offset:5120
 N a[32:47],a[248:251],v[104:107],a[32:47]
 N a[96:111],a[248:251],v[120:123],a[96:111]
 ds_read_b128 a[216:219],v192 offset:6144
 ds_read_b128 a[220:223],v192 offset:7168
 N a[48:63],a[252:255],v[104:107],a[48:63]
 N a[112:127],a[252:255],v[120:123],a[112:127]
 s_branch F_FINL
F_AC0:
 W 7
 N v[0:15],a[192:195],a[160:163],v[144:159]
 v_exp_f32 v112,v112
 v_exp_f32 v113,v113
 W 6
 N v[0:15],a[196:199],a[164:167],v[0:15]
 W 4
 s_mov_b32 m0,s92
 s_mov_b32 s69,s91
 s_add_u32 s91,s91,17408
 s_add_u32 s92,s92,0x4000
 s_and_b32 s92,s92,0xffff
 buffer_load_dwordx4 v243,s[36:39],s69 offen offset:0 sc1 lds
 N v[0:15],a[200:203],a[168:171],v[0:15]
 v_exp_f32 v114,v114
 v_add_f32 v199,v199,v112
 N v[0:15],a[204:207],a[172:175],v[0:15]
 W 2
 v_add_u32 v211,1,v211
 buffer_store_dword v211,v210,s[8:11],s73 offen sc0 sc1
 buffer_load_dwordx4 v243,s[36:39],s69 offen offset:1024 sc1 lds
 v_exp_f32 v115,v115
 N v[0:15],a[208:211],a[176:179],v[0:15]
 v_add_f32 v199,v199,v113
 v_cvt_pk_bf16_f32 v112,v112,v113
 v_exp_f32 v116,v116
 N v[0:15],a[212:215],a[180:183],v[0:15]
 W 0
 buffer_load_dwordx4 v243,s[36:39],s69 offen offset:2048 sc1 lds
 v_add_f32 v199,v199,v114
 v_exp_f32 v117,v117
 v_cvt_pk_bf16_f32 v113,v114,v115
 N v[0:15],a[216:219],a[184:187],v[0:15]
 v_add_f32 v199,v199,v115
 v_exp_f32 v118,v118
 v_add_f32 v199,v199,v116
 N v[0:15],a[220:223],a[188:191],v[0:15]
 buffer_load_dwordx4 v243,s[36:39],s69 offen offset:3072 sc1 lds
 v_exp_f32 v119,v119
 v_cvt_pk_bf16_f32 v114,v116,v117
 v_add_f32 v199,v199,v117
 v_exp_f32 v120,v120
 v_add_f32 v199,v199,v118
 v_exp_f32 v121,v121
 v_cvt_pk_bf16_f32 v115,v118,v119
 v_add_f32 v199,v199,v119
 v_exp_f32 v122,v122
 v_add_f32 v199,v199,v120
 v_exp_f32 v123,v123
 v_add_f32 v199,v199,v121
 v_cvt_pk_bf16_f32 v120,v120,v121
 v_exp_f32 v124,v124
 v_add_f32 v199,v199,v122
 v_exp_f32 v125,v125
 v_cvt_pk_bf16_f32 v121,v122,v123
 v_add_f32 v199,v199,v123
 v_exp_f32 v126,v126
 v_add_f32 v199,v199,v124
 v_exp_f32 v127,v127
 v_cvt_pk_bf16_f32 v122,v124,v125
 v_add_f32 v199,v199,v125
 v_add_f32 v199,v199,v126
 v_cvt_pk_bf16_f32 v123,v126,v127
 v_add_f32 v199,v199,v127
 v_cmp_le_i32 s[84:85],0,v204
 v_cmp_le_i32 s[86:87],1,v204
 v_cmp_le_i32 s[88:89],2,v204
 v_cmp_le_i32 s[98:99],3,v204
 v_cndmask_b32 v0,v205,v0,s[84:85]
 v_cndmask_b32 v1,v205,v1,s[86:87]
 v_cndmask_b32 v2,v205,v2,s[88:89]
 v_cndmask_b32 v3,v205,v3,s[98:99]
 v_cmp_le_i32 s[84:85],8,v204
 v_cmp_le_i32 s[86:87],9,v204
 v_cmp_le_i32 s[88:89],10,v204
 v_cmp_le_i32 s[98:99],11,v204
 v_cndmask_b32 v4,v205,v4,s[84:85]
 v_cndmask_b32 v5,v205,v5,s[86:87]
 v_cndmask_b32 v6,v205,v6,s[88:89]
 v_cndmask_b32 v7,v205,v7,s[98:99]
 v_cmp_le_i32 s[84:85],16,v204
 v_cmp_le_i32 s[86:87],17,v204
 v_cmp_le_i32 s[88:89],18,v204
 v_cmp_le_i32 s[98:99],19,v204
 v_cndmask_b32 v8,v205,v8,s[84:85]
 v_cndmask_b32 v9,v205,v9,s[86:87]
 v_cndmask_b32 v10,v205,v10,s[88:89]
 v_cndmask_b32 v11,v205,v11,s[98:99]
 v_cmp_le_i32 s[84:85],24,v204
 v_cmp_le_i32 s[86:87],25,v204
 v_cmp_le_i32 s[88:89],26,v204
 v_cmp_le_i32 s[98:99],27,v204
 v_cndmask_b32 v12,v205,v12,s[84:85]
 v_cndmask_b32 v13,v205,v13,s[86:87]
 v_cndmask_b32 v14,v205,v14,s[88:89]
 v_cndmask_b32 v15,v205,v15,s[98:99]
 v_add_u32 v193,s77,v194
 s_add_u32 s77,s77,16384
 s_and_b32 s77,s77,0xffff
 W 0
 s_barrier
 ds_read_b128 a[192:195],v193 offset:0
 ds_read_b128 a[196:199],v193 offset:1024
 s_add_u32 m0,s92,0x0
 ds_read_b128 a[200:203],v193 offset:2048
 ds_read_b128 a[204:207],v193 offset:3072
 buffer_load_dwordx4 v243,s[36:39],s91 offen offset:0 sc1 lds
 buffer_load_dwordx4 v243,s[36:39],s91 offen offset:1024 sc1 lds
 W 2
 v_cmp_lt_f32 vcc,s78,v199
 s_cbranch_vccz F_c18
 s_call_b64 s[82:83],F_XAB1
F_c18:
 v_add_f32 v198,v198,v199
 s_add_u32 s75,s75,64
 ds_read_b128 a[208:211],v193 offset:4096
 ds_read_b128 a[212:215],v193 offset:5120
 buffer_load_dwordx4 v243,s[36:39],s91 offen offset:2048 sc1 lds
 v_exp_f32 v0,v0
 N a[64:79],a[192:195],v[80:83],a[64:79]
 v_exp_f32 v1,v1
 v_exp_f32 v2,v2
 v_add_f32 v199,v0,v1
 buffer_load_dwordx4 v243,s[36:39],s91 offen offset:3072 sc1 lds
 v_exp_f32 v3,v3
 v_cvt_pk_bf16_f32 v0,v0,v1
 v_exp_f32 v4,v4
 N a[80:95],a[196:199],v[80:83],a[80:95]
 W 2
 v_add_f32 v199,v199,v2
 v_exp_f32 v5,v5
 v_cvt_pk_bf16_f32 v1,v2,v3
 v_add_f32 v199,v199,v3
 ds_read_b128 a[216:219],v193 offset:6144
 ds_read_b128 a[220:223],v193 offset:7168
 s_add_u32 m0,s92,0x4000
 s_add_u32 s69,s91,17408
 s_add_u32 s91,s91,34816
 s_xor_b32 s92,s92,0x8000
 buffer_load_dwordx4 v243,s[36:39],s69 offen offset:0 sc1 lds
 N a[96:111],a[200:203],v[80:83],a[96:111]
 v_exp_f32 v6,v6
 v_add_f32 v199,v199,v4
 v_exp_f32 v7,v7
 v_cvt_pk_bf16_f32 v2,v4,v5
 buffer_load_dwordx4 v243,s[36:39],s69 offen offset:1024 sc1 lds
 v_add_f32 v199,v199,v5
 v_exp_f32 v8,v8
 v_add_f32 v199,v199,v6
 N a[112:127],a[204:207],v[80:83],a[112:127]
 W 2
 v_exp_f32 v9,v9
 v_cvt_pk_bf16_f32 v3,v6,v7
 v_add_f32 v199,v199,v7
 v_exp_f32 v10,v10
 ds_read_b128 a[224:227],v193 offset:8192
 ds_read_b128 a[228:231],v193 offset:9216
 buffer_load_dwordx4 v243,s[36:39],s69 offen offset:2048 sc1 lds
 v_add_f32 v199,v199,v8
 N a[64:79],a[208:211],v[88:91],a[64:79]
 v_exp_f32 v11,v11
 v_add_f32 v199,v199,v9
 v_cvt_pk_bf16_f32 v8,v8,v9
 v_exp_f32 v12,v12
 buffer_load_dwordx4 v243,s[36:39],s69 offen offset:3072 sc1 lds
 v_add_f32 v199,v199,v10
 v_exp_f32 v13,v13
 v_cvt_pk_bf16_f32 v9,v10,v11
 v_add_f32 v199,v199,v11
 N a[80:95],a[212:215],v[88:91],a[80:95]
 W 2
 v_exp_f32 v14,v14
 v_add_f32 v199,v199,v12
 v_exp_f32 v15,v15
 v_cvt_pk_bf16_f32 v10,v12,v13
 ds_read_b128 a[232:235],v193 offset:10240
 ds_read_b128 a[236:239],v193 offset:11264
 v_add_f32 v199,v199,v13
 v_add_f32 v199,v199,v14
 v_cvt_pk_bf16_f32 v11,v14,v15
 v_add_f32 v199,v199,v15
 N a[96:111],a[216:219],v[88:91],a[96:111]
 buffer_load_dword v207,v208,s[8:11],0 offen sc1
 v_mov_b32 v16,0
 v_mov_b32 v17,0
 v_mov_b32 v18,0
 v_mov_b32 v19,0
 v_mov_b32 v24,0
 v_mov_b32 v25,0
 v_mov_b32 v26,0
 v_mov_b32 v27,0
 v_mov_b32 v32,v205
 v_mov_b32 v33,v205
 v_mov_b32 v34,v205
 N a[112:127],a[220:223],v[88:91],a[112:127]
 W 2
 v_mov_b32 v35,v205
 v_mov_b32 v36,v205
 v_mov_b32 v37,v205
 v_mov_b32 v38,v205
 v_mov_b32 v39,v205
 v_mov_b32 v40,v205
 ds_read_b128 a[240:243],v193 offset:12288
 ds_read_b128 a[244:247],v193 offset:13312
 v_mov_b32 v41,v205
 v_mov_b32 v42,v205
 v_mov_b32 v43,v205
 v_mov_b32 v44,v205
 N a[64:79],a[224:227],v[112:115],a[64:79]
 v_mov_b32 v45,v205
 v_mov_b32 v46,v205
 v_mov_b32 v47,v205
 v_mov_b32 v48,v205
 v_mov_b32 v49,v205
 v_mov_b32 v50,v205
 v_mov_b32 v51,v205
 v_mov_b32 v52,v205
 v_mov_b32 v53,v205
 v_mov_b32 v54,v205
 v_mov_b32 v55,v205
 v_mov_b32 v56,v205
 N a[80:95],a[228:231],v[112:115],a[80:95]
 W 2
 v_mov_b32 v57,v205
 v_mov_b32 v58,v205
 v_mov_b32 v59,v205
 v_mov_b32 v60,v205
 v_mov_b32 v61,v205
 v_mov_b32 v62,v205
 ds_read_b128 a[248:251],v193 offset:14336
 ds_read_b128 a[252:255],v193 offset:15360
 v_mov_b32 v63,v205
 N a[96:111],a[232:235],v[112:115],a[96:111]
 v_add_u32 v192,s76,v224
 s_add_u32 s76,s76,32768
 s_and_b32 s76,s76,0xffff
 N a[112:127],a[236:239],v[112:115],a[112:127]
 W 2
 s_waitcnt vmcnt(8) lgkmcnt(0)
 s_barrier
 ds_read_b128 a[192:195],v192 offset:0
 ds_read_b128 a[196:199],v192 offset:1024
 N a[64:79],a[240:243],v[120:123],a[64:79]
 ds_read_b128 a[200:203],v192 offset:2048
 ds_read_b128 a[204:207],v192 offset:3072
 N a[80:95],a[244:247],v[120:123],a[80:95]
 ds_read_b128 a[208:211],v192 offset:4096
 ds_read_b128 a[212:215],v192 offset:5120
 N a[96:111],a[248:251],v[120:123],a[96:111]
 ds_read_b128 a[216:219],v192 offset:6144
 ds_read_b128 a[220:223],v192 offset:7168
 N a[112:127],a[252:255],v[120:123],a[112:127]
 s_branch F_FINL
F_AC1:
 W 7
 N v[0:15],a[192:195],a[160:163],v[144:159]
 ds_read_b128 a[224:227],v192 offset:8192
 ds_read_b128 a[228:231],v192 offset:9216
 v_exp_f32 v112,v112
 v_exp_f32 v113,v113
 W 8
 N v[0:15],a[196:199],a[164:167],v[0:15]
 W 6
 s_mov_b32 m0,s92
 s_mov_b32 s69,s91
 s_add_u32 s91,s91,17408
 s_add_u32 s92,s92,0x4000
 s_and_b32 s92,s92,0xffff
 buffer_load_dwordx4 v243,s[36:39],s69 offen offset:0 sc1 lds
 N v[0:15],a[200:203],a[168:171],v[0:15]
 ds_read_b128 a[232:235],v192 offset:10240
 ds_read_b128 a[236:239],v192 offset:11264
 v_exp_f32 v114,v114
 v_add_f32 v199,v199,v112
 N v[0:15],a[204:207],a[172:175],v[0:15]
 W 6
 v_add_u32 v211,1,v211
 buffer_store_dword v211,v210,s[8:11],s73 offen sc0 sc1
 buffer_load_dwordx4 v243,s[36:39],s69 offen offset:1024 sc1 lds
 v_exp_f32 v115,v115
 N v[0:15],a[208:211],a[176:179],v[0:15]
 ds_read_b128 a[240:243],v192 offset:12288
 ds_read_b128 a[244:247],v192 offset:13312
 v_add_f32 v199,v199,v113
 v_cvt_pk_bf16_f32 v112,v112,v113
 v_exp_f32 v116,v116
 N v[0:15],a[212:215],a[180:183],v[0:15]
 W 6
 buffer_load_dwordx4 v243,s[36:39],s69 offen offset:2048 sc1 lds
 v_add_f32 v199,v199,v114
 v_exp_f32 v117,v117
 v_cvt_pk_bf16_f32 v113,v114,v115
 N v[0:15],a[216:219],a[184:187],v[0:15]
 ds_read_b128 a[248:251],v192 offset:14336
 ds_read_b128 a[252:255],v192 offset:15360
 v_add_f32 v199,v199,v115
 v_exp_f32 v118,v118
 v_add_f32 v199,v199,v116
 N v[0:15],a[220:223],a[188:191],v[0:15]
 W 6
 buffer_load_dwordx4 v243,s[36:39],s69 offen offset:3072 sc1 lds
 v_exp_f32 v119,v119
 v_cvt_pk_bf16_f32 v114,v116,v117
 v_add_f32 v199,v199,v117
 N v[16:31],a[224:227],a[160:163],v[144:159]
 v_exp_f32 v120,v120
 v_add_f32 v199,v199,v118
 N v[16:31],a[228:231],a[164:167],v[16:31]
 W 4
 v_exp_f32 v121,v121
 v_cvt_pk_bf16_f32 v115,v118,v119
 v_add_f32 v199,v199,v119
 v_exp_f32 v122,v122
 N v[16:31],a[232:235],a[168:171],v[16:31]
 v_add_f32 v199,v199,v120
 v_exp_f32 v123,v123
 v_add_f32 v199,v199,v121
 N v[16:31],a[236:239],a[172:175],v[16:31]
 W 2
 v_cvt_pk_bf16_f32 v120,v120,v121
 v_exp_f32 v124,v124
 v_add_f32 v199,v199,v122
 v_exp_f32 v125,v125
 N v[16:31],a[240:243],a[176:179],v[16:31]
 v_cvt_pk_bf16_f32 v121,v122,v123
 v_add_f32 v199,v199,v123
 v_exp_f32 v126,v126
 N v[16:31],a[244:247],a[180:183],v[16:31]
 W 0
 v_add_f32 v199,v199,v124
 v_exp_f32 v127,v127
 v_cvt_pk_bf16_f32 v122,v124,v125
 v_add_f32 v199,v199,v125
 v_add_f32 v199,v199,v126
 N v[16:31],a[248:251],a[184:187],v[16:31]
 v_cvt_pk_bf16_f32 v123,v126,v127
 v_add_f32 v199,v199,v127
 N v[16:31],a[252:255],a[188:191],v[16:31]
 v_subrev_u32 v206,32,v204
 v_cmp_le_i32 s[84:85],0,v206
 v_cmp_le_i32 s[86:87],1,v206
 v_cmp_le_i32 s[88:89],2,v206
 v_cmp_le_i32 s[98:99],3,v206
 s_nop 6
 v_cndmask_b32 v16,v205,v16,s[84:85]
 v_cndmask_b32 v17,v205,v17,s[86:87]
 v_cndmask_b32 v18,v205,v18,s[88:89]
 v_cndmask_b32 v19,v205,v19,s[98:99]
 v_cmp_le_i32 s[84:85],8,v206
 v_cmp_le_i32 s[86:87],9,v206
 v_cmp_le_i32 s[88:89],10,v206
 v_cmp_le_i32 s[98:99],11,v206
 v_cndmask_b32 v20,v205,v20,s[84:85]
 v_cndmask_b32 v21,v205,v21,s[86:87]
 v_cndmask_b32 v22,v205,v22,s[88:89]
 v_cndmask_b32 v23,v205,v23,s[98:99]
 v_cmp_le_i32 s[84:85],16,v206
 v_cmp_le_i32 s[86:87],17,v206
 v_cmp_le_i32 s[88:89],18,v206
 v_cmp_le_i32 s[98:99],19,v206
 v_cndmask_b32 v24,v205,v24,s[84:85]
 v_cndmask_b32 v25,v205,v25,s[86:87]
 v_cndmask_b32 v26,v205,v26,s[88:89]
 v_add_u32 v193,s77,v194
 s_add_u32 s77,s77,16384
 s_and_b32 s77,s77,0xffff
 v_cndmask_b32 v27,v205,v27,s[98:99]
 v_cmp_le_i32 s[84:85],24,v206
 v_cmp_le_i32 s[86:87],25,v206
 v_cmp_le_i32 s[88:89],26,v206
 v_cmp_le_i32 s[98:99],27,v206
 v_cndmask_b32 v28,v205,v28,s[84:85]
 v_cndmask_b32 v29,v205,v29,s[86:87]
 v_cndmask_b32 v30,v205,v30,s[88:89]
 v_cndmask_b32 v31,v205,v31,s[98:99]
 W 0
 s_barrier
 ds_read_b128 a[192:195],v193 offset:0
 ds_read_b128 a[196:199],v193 offset:1024
 s_add_u32 m0,s92,0x0
 ds_read_b128 a[200:203],v193 offset:2048
 ds_read_b128 a[204:207],v193 offset:3072
 buffer_load_dwordx4 v243,s[36:39],s91 offen offset:0 sc1 lds
 buffer_load_dwordx4 v243,s[36:39],s91 offen offset:1024 sc1 lds
 W 2
 v_cmp_lt_f32 vcc,s78,v199
 s_cbranch_vccz F_c23
 s_call_b64 s[82:83],F_XAB1
F_c23:
 v_add_f32 v198,v198,v199
 s_add_u32 s75,s75,64
 ds_read_b128 a[208:211],v193 offset:4096
 ds_read_b128 a[212:215],v193 offset:5120
 buffer_load_dwordx4 v243,s[36:39],s91 offen offset:2048 sc1 lds
 v_exp_f32 v0,v0
 N a[64:79],a[192:195],v[80:83],a[64:79]
 v_exp_f32 v1,v1
 v_exp_f32 v2,v2
 v_add_f32 v199,v0,v1
 buffer_load_dwordx4 v243,s[36:39],s91 offen offset:3072 sc1 lds
 v_exp_f32 v3,v3
 v_cvt_pk_bf16_f32 v0,v0,v1
 v_exp_f32 v4,v4
 N a[80:95],a[196:199],v[80:83],a[80:95]
 W 2
 v_add_f32 v199,v199,v2
 v_exp_f32 v5,v5
 v_cvt_pk_bf16_f32 v1,v2,v3
 v_add_f32 v199,v199,v3
 ds_read_b128 a[216:219],v193 offset:6144
 ds_read_b128 a[220:223],v193 offset:7168
 s_add_u32 m0,s92,0x4000
 s_add_u32 s69,s91,17408
 s_add_u32 s91,s91,34816
 s_xor_b32 s92,s92,0x8000
 buffer_load_dwordx4 v243,s[36:39],s69 offen offset:0 sc1 lds
 N a[96:111],a[200:203],v[80:83],a[96:111]
 v_exp_f32 v6,v6
 v_add_f32 v199,v199,v4
 v_exp_f32 v7,v7
 v_cvt_pk_bf16_f32 v2,v4,v5
 buffer_load_dwordx4 v243,s[36:39],s69 offen offset:1024 sc1 lds
 v_add_f32 v199,v199,v5
 v_exp_f32 v8,v8
 v_add_f32 v199,v199,v6
 N a[112:127],a[204:207],v[80:83],a[112:127]
 W 2
 v_exp_f32 v9,v9
 v_cvt_pk_bf16_f32 v3,v6,v7
 v_add_f32 v199,v199,v7
 v_exp_f32 v10,v10
 ds_read_b128 a[224:227],v193 offset:8192
 ds_read_b128 a[228:231],v193 offset:9216
 buffer_load_dwordx4 v243,s[36:39],s69 offen offset:2048 sc1 lds
 v_add_f32 v199,v199,v8
 N a[64:79],a[208:211],v[88:91],a[64:79]
 v_exp_f32 v11,v11
 v_add_f32 v199,v199,v9
 v_cvt_pk_bf16_f32 v8,v8,v9
 v_exp_f32 v12,v12
 buffer_load_dwordx4 v243,s[36:39],s69 offen offset:3072 sc1 lds
 v_add_f32 v199,v199,v10
 v_exp_f32 v13,v13
 v_cvt_pk_bf16_f32 v9,v10,v11
 v_add_f32 v199,v199,v11
 N a[80:95],a[212:215],v[88:91],a[80:95]
 W 2
 v_exp_f32 v14,v14
 v_add_f32 v199,v199,v12
 v_exp_f32 v15,v15
 v_cvt_pk_bf16_f32 v10,v12,v13
 ds_read_b128 a[232:235],v193 offset:10240
 ds_read_b128 a[236:239],v193 offset:11264
 v_add_f32 v199,v199,v13
 v_add_f32 v199,v199,v14
 v_cvt_pk_bf16_f32 v11,v14,v15
 v_add_f32 v199,v199,v15
 N a[96:111],a[216:219],v[88:91],a[96:111]
 buffer_load_dword v207,v208,s[8:11],0 offen sc1
 v_exp_f32 v16,v16
 v_exp_f32 v17,v17
 v_exp_f32 v18,v18
 v_add_f32 v199,v199,v16
 v_exp_f32 v19,v19
 v_add_f32 v199,v199,v17
 N a[112:127],a[220:223],v[88:91],a[112:127]
 W 2
 v_cvt_pk_bf16_f32 v16,v16,v17
 v_exp_f32 v20,v20
 v_add_f32 v199,v199,v18
 v_exp_f32 v21,v21
 ds_read_b128 a[240:243],v193 offset:12288
 ds_read_b128 a[244:247],v193 offset:13312
 v_cvt_pk_bf16_f32 v17,v18,v19
 v_add_f32 v199,v199,v19
 v_exp_f32 v22,v22
 N a[64:79],a[224:227],v[112:115],a[64:79]
 v_add_f32 v199,v199,v20
 v_exp_f32 v23,v23
 v_cvt_pk_bf16_f32 v18,v20,v21
 v_add_f32 v199,v199,v21
 v_exp_f32 v24,v24
 v_add_f32 v199,v199,v22
 v_exp_f32 v25,v25
 v_cvt_pk_bf16_f32 v19,v22,v23
 N a[80:95],a[228:231],v[112:115],a[80:95]
 W 2
 v_add_f32 v199,v199,v23
 v_exp_f32 v26,v26
 v_add_f32 v199,v199,v24
 v_exp_f32 v27,v27
 ds_read_b128 a[248:251],v193 offset:14336
 ds_read_b128 a[252:255],v193 offset:15360
 v_add_f32 v199,v199,v25
 v_cvt_pk_bf16_f32 v24,v24,v25
 v_exp_f32 v28,v28
 N a[96:111],a[232:235],v[112:115],a[96:111]
 v_add_f32 v199,v199,v26
 v_exp_f32 v29,v29
 v_cvt_pk_bf16_f32 v25,v26,v27
 v_add_f32 v199,v199,v27
 v_add_u32 v192,s76,v224
 s_add_u32 s76,s76,32768
 s_and_b32 s76,s76,0xffff
 v_exp_f32 v30,v30
 v_add_f32 v199,v199,v28
 N a[112:127],a[236:239],v[112:115],a[112:127]
 W 2
 s_waitcnt vmcnt(8) lgkmcnt(0)
 s_barrier
 v_exp_f32 v31,v31
 v_cvt_pk_bf16_f32 v26,v28,v29
 v_add_f32 v199,v199,v29
 ds_read_b128 a[192:195],v192 offset:0
 ds_read_b128 a[196:199],v192 offset:1024
 v_add_f32 v199,v199,v30
 v_cvt_pk_bf16_f32 v27,v30,v31
 v_add_f32 v199,v199,v31
 v_mov_b32 v32,v205
 N a[64:79],a[240:243],v[120:123],a[64:79]
 ds_read_b128 a[200:203],v192 offset:2048
 ds_read_b128 a[204:207],v192 offset:3072
 v_mov_b32 v33,v205
 v_mov_b32 v34,v205
 v_mov_b32 v35,v205
 v_mov_b32 v36,v205
 v_mov_b32 v37,v205
 v_mov_b32 v38,v205
 v_mov_b32 v39,v205
 v_mov_b32 v40,v205
 v_mov_b32 v41,v205
 v_mov_b32 v42,v205
 N a[80:95],a[244:247],v[120:123],a[80:95]
 ds_read_b128 a[208:211],v192 offset:4096
 ds_read_b128 a[212:215],v192 offset:5120
 v_mov_b32 v43,v205
 v_mov_b32 v44,v205
 v_mov_b32 v45,v205
 v_mov_b32 v46,v205
 v_mov_b32 v47,v205
 v_mov_b32 v48,v205
 v_mov_b32 v49,v205
 v_mov_b32 v50,v205
 v_mov_b32 v51,v205
 N a[96:111],a[248:251],v[120:123],a[96:111]
 ds_read_b128 a[216:219],v192 offset:6144
 ds_read_b128 a[220:223],v192 offset:7168
 v_mov_b32 v52,v205
 v_mov_b32 v53,v205
 v_mov_b32 v54,v205
 v_mov_b32 v55,v205
 v_mov_b32 v56,v205
 v_mov_b32 v57,v205
 v_mov_b32 v58,v205
 v_mov_b32 v59,v205
 v_mov_b32 v60,v205
 v_mov_b32 v61,v205
 N a[112:127],a[252:255],v[120:123],a[112:127]
 v_mov_b32 v62,v205
 v_mov_b32 v63,v205
 s_branch F_FINL
F_AC2:
 W 7
 N v[0:15],a[192:195],a[160:163],v[144:159]
 ds_read_b128 a[224:227],v192 offset:8192
 ds_read_b128 a[228:231],v192 offset:9216
 v_exp_f32 v112,v112
 v_exp_f32 v113,v113
 W 8
 N v[0:15],a[196:199],a[164:167],v[0:15]
 W 6
 s_mov_b32 m0,s92
 s_mov_b32 s69,s91
 s_add_u32 s91,s91,17408
 s_add_u32 s92,s92,0x4000
 s_and_b32 s92,s92,0xffff
 buffer_load_dwordx4 v243,s[36:39],s69 offen offset:0 sc1 lds
 N v[0:15],a[200:203],a[168:171],v[0:15]
 ds_read_b128 a[232:235],v192 offset:10240
 ds_read_b128 a[236:239],v192 offset:11264
 v_exp_f32 v114,v114
 v_add_f32 v199,v199,v112
 N v[0:15],a[204:207],a[172:175],v[0:15]
 W 6
 v_add_u32 v211,1,v211
 buffer_store_dword v211,v210,s[8:11],s73 offen sc0 sc1
 buffer_load_dwordx4 v243,s[36:39],s69 offen offset:1024 sc1 lds
 v_exp_f32 v115,v115
 N v[0:15],a[208:211],a[176:179],v[0:15]
 ds_read_b128 a[240:243],v192 offset:12288
 ds_read_b128 a[244:247],v192 offset:13312
 v_add_f32 v199,v199,v113
 v_cvt_pk_bf16_f32 v112,v112,v113
 v_exp_f32 v116,v116
 N v[0:15],a[212:215],a[180:183],v[0:15]
 W 6
 buffer_load_dwordx4 v243,s[36:39],s69 offen offset:2048 sc1 lds
 v_add_f32 v199,v199,v114
 v_exp_f32 v117,v117
 v_cvt_pk_bf16_f32 v113,v114,v115
 N v[0:15],a[216:219],a[184:187],v[0:15]
 ds_read_b128 a[248:251],v192 offset:14336
 ds_read_b128 a[252:255],v192 offset:15360
 v_add_f32 v199,v199,v115
 v_exp_f32 v118,v118
 v_add_f32 v199,v199,v116
 N v[0:15],a[220:223],a[188:191],v[0:15]
 W 6
 buffer_load_dwordx4 v243,s[36:39],s69 offen offset:3072 sc1 lds
 v_exp_f32 v119,v119
 v_cvt_pk_bf16_f32 v114,v116,v117
 v_add_f32 v199,v199,v117
 N v[16:31],a[224:227],a[160:163],v[144:159]
 ds_read_b128 a[192:195],v192 offset:16384
 ds_read_b128 a[196:199],v192 offset:17408
 v_exp_f32 v120,v120
 v_add_f32 v199,v199,v118
 N v[16:31],a[228:231],a[164:167],v[16:31]
 W 6
 v_exp_f32 v121,v121
 v_cvt_pk_bf16_f32 v115,v118,v119
 v_add_f32 v199,v199,v119
 v_exp_f32 v122,v122
 N v[16:31],a[232:235],a[168:171],v[16:31]
 ds_read_b128 a[200:203],v192 offset:18432
 ds_read_b128 a[204:207],v192 offset:19456
 v_add_f32 v199,v199,v120
 v_exp_f32 v123,v123
 v_add_f32 v199,v199,v121
 N v[16:31],a[236:239],a[172:175],v[16:31]
 W 6
 v_cvt_pk_bf16_f32 v120,v120,v121
 v_exp_f32 v124,v124
 v_add_f32 v199,v199,v122
 v_exp_f32 v125,v125
 N v[16:31],a[240:243],a[176:179],v[16:31]
 ds_read_b128 a[208:211],v192 offset:20480
 ds_read_b128 a[212:215],v192 offset:21504
 v_cvt_pk_bf16_f32 v121,v122,v123
 v_add_f32 v199,v199,v123
 v_exp_f32 v126,v126
 N v[16:31],a[244:247],a[180:183],v[16:31]
 W 6
 v_add_f32 v199,v199,v124
 v_exp_f32 v127,v127
 v_cvt_pk_bf16_f32 v122,v124,v125
 v_add_f32 v199,v199,v125
 v_add_f32 v199,v199,v126
 N v[16:31],a[248:251],a[184:187],v[16:31]
 ds_read_b128 a[216:219],v192 offset:22528
 ds_read_b128 a[220:223],v192 offset:23552
 v_cvt_pk_bf16_f32 v123,v126,v127
 v_add_f32 v199,v199,v127
 v_max_f32 v200,v197,v199
 N v[16:31],a[252:255],a[188:191],v[16:31]
 W 6
 N v[32:47],a[192:195],a[160:163],v[144:159]
 N v[32:47],a[196:199],a[164:167],v[32:47]
 W 4
 N v[32:47],a[200:203],a[168:171],v[32:47]
 N v[32:47],a[204:207],a[172:175],v[32:47]
 W 2
 N v[32:47],a[208:211],a[176:179],v[32:47]
 N v[32:47],a[212:215],a[180:183],v[32:47]
 W 0
 N v[32:47],a[216:219],a[184:187],v[32:47]
 N v[32:47],a[220:223],a[188:191],v[32:47]
 v_add_u32 v193,s77,v194
 s_add_u32 s77,s77,16384
 s_and_b32 s77,s77,0xffff
 W 0
 s_barrier
 ds_read_b128 a[192:195],v193 offset:0
 ds_read_b128 a[196:199],v193 offset:1024
 s_add_u32 m0,s92,0x0
 ds_read_b128 a[200:203],v193 offset:2048
 ds_read_b128 a[204:207],v193 offset:3072
 buffer_load_dwordx4 v243,s[36:39],s91 offen offset:0 sc1 lds
 buffer_load_dwordx4 v243,s[36:39],s91 offen offset:1024 sc1 lds
 W 2
 v_cmp_lt_f32 vcc,s78,v200
 s_cbranch_vccz F_c28
 s_call_b64 s[82:83],F_XAB1
F_c28:
 v_add_f32 v196,v196,v197
 v_add_f32 v198,v198,v199
 s_add_u32 s75,s75,64
 N a[0:15],a[192:195],v[64:67],a[0:15]
 ds_read_b128 a[208:211],v193 offset:4096
 ds_read_b128 a[212:215],v193 offset:5120
 buffer_load_dwordx4 v243,s[36:39],s91 offen offset:2048 sc1 lds
 v_exp_f32 v0,v0
 N a[64:79],a[192:195],v[80:83],a[64:79]
 v_exp_f32 v1,v1
 v_exp_f32 v2,v2
 v_add_f32 v199,v0,v1
 N a[16:31],a[196:199],v[64:67],a[16:31]
 buffer_load_dwordx4 v243,s[36:39],s91 offen offset:3072 sc1 lds
 v_exp_f32 v3,v3
 v_cvt_pk_bf16_f32 v0,v0,v1
 v_exp_f32 v4,v4
 N a[80:95],a[196:199],v[80:83],a[80:95]
 W 2
 v_add_f32 v199,v199,v2
 v_exp_f32 v5,v5
 v_cvt_pk_bf16_f32 v1,v2,v3
 v_add_f32 v199,v199,v3
 N a[32:47],a[200:203],v[64:67],a[32:47]
 ds_read_b128 a[216:219],v193 offset:6144
 ds_read_b128 a[220:223],v193 offset:7168
 s_add_u32 m0,s92,0x4000
 s_add_u32 s69,s91,17408
 s_add_u32 s91,s91,34816
 s_xor_b32 s92,s92,0x8000
 buffer_load_dwordx4 v243,s[36:39],s69 offen offset:0 sc1 lds
 N a[96:111],a[200:203],v[80:83],a[96:111]
 v_exp_f32 v6,v6
 v_add_f32 v199,v199,v4
 v_exp_f32 v7,v7
 v_cvt_pk_bf16_f32 v2,v4,v5
 N a[48:63],a[204:207],v[64:67],a[48:63]
 buffer_load_dwordx4 v243,s[36:39],s69 offen offset:1024 sc1 lds
 v_add_f32 v199,v199,v5
 v_exp_f32 v8,v8
 v_add_f32 v199,v199,v6
 N a[112:127],a[204:207],v[80:83],a[112:127]
 W 2
 v_exp_f32 v9,v9
 v_cvt_pk_bf16_f32 v3,v6,v7
 v_add_f32 v199,v199,v7
 v_exp_f32 v10,v10
 N a[0:15],a[208:211],v[72:75],a[0:15]
 ds_read_b128 a[224:227],v193 offset:8192
 ds_read_b128 a[228:231],v193 offset:9216
 buffer_load_dwordx4 v243,s[36:39],s69 offen offset:2048 sc1 lds
 v_add_f32 v199,v199,v8
 N a[64:79],a[208:211],v[88:91],a[64:79]
 v_exp_f32 v11,v11
 v_add_f32 v199,v199,v9
 v_cvt_pk_bf16_f32 v8,v8,v9
 v_exp_f32 v12,v12
 N a[16:31],a[212:215],v[72:75],a[16:31]
 buffer_load_dwordx4 v243,s[36:39],s69 offen offset:3072 sc1 lds
 v_add_f32 v199,v199,v10
 v_exp_f32 v13,v13
 v_cvt_pk_bf16_f32 v9,v10,v11
 v_add_f32 v199,v199,v11
 N a[80:95],a[212:215],v[88:91],a[80:95]
 W 2
 v_exp_f32 v14,v14
 v_add_f32 v199,v199,v12
 v_exp_f32 v15,v15
 v_cvt_pk_bf16_f32 v10,v12,v13
 N a[32:47],a[216:219],v[72:75],a[32:47]
 ds_read_b128 a[232:235],v193 offset:10240
 ds_read_b128 a[236:239],v193 offset:11264
 v_add_f32 v199,v199,v13
 v_add_f32 v199,v199,v14
 v_cvt_pk_bf16_f32 v11,v14,v15
 v_add_f32 v199,v199,v15
 N a[96:111],a[216:219],v[88:91],a[96:111]
 buffer_load_dword v207,v208,s[8:11],0 offen sc1
 v_subrev_u32 v206,64,v204
 v_cmp_le_i32 s[84:85],0,v206
 v_cmp_le_i32 s[86:87],1,v206
 v_cmp_le_i32 s[88:89],2,v206
 v_cmp_le_i32 s[98:99],3,v206
 N a[48:63],a[220:223],v[72:75],a[48:63]
 v_cndmask_b32 v32,v205,v32,s[84:85]
 v_cndmask_b32 v33,v205,v33,s[86:87]
 v_cndmask_b32 v34,v205,v34,s[88:89]
 v_cndmask_b32 v35,v205,v35,s[98:99]
 v_cmp_le_i32 s[84:85],8,v206
 v_cmp_le_i32 s[86:87],9,v206
 N a[112:127],a[220:223],v[88:91],a[112:127]
 W 2
 v_cmp_le_i32 s[88:89],10,v206
 v_cmp_le_i32 s[98:99],11,v206
 v_cndmask_b32 v36,v205,v36,s[84:85]
 v_cndmask_b32 v37,v205,v37,s[86:87]
 v_cndmask_b32 v38,v205,v38,s[88:89]
 v_cndmask_b32 v39,v205,v39,s[98:99]
 ds_read_b128 a[240:243],v193 offset:12288
 ds_read_b128 a[244:247],v193 offset:13312
 v_cmp_le_i32 s[84:85],16,v206
 v_cmp_le_i32 s[86:87],17,v206
 v_cmp_le_i32 s[88:89],18,v206
 v_cmp_le_i32 s[98:99],19,v206
 N a[64:79],a[224:227],v[112:115],a[64:79]
 v_cndmask_b32 v40,v205,v40,s[84:85]
 v_cndmask_b32 v41,v205,v41,s[86:87]
 v_cndmask_b32 v42,v205,v42,s[88:89]
 v_cndmask_b32 v43,v205,v43,s[98:99]
 v_cmp_le_i32 s[84:85],24,v206
 v_cmp_le_i32 s[86:87],25,v206
 v_cmp_le_i32 s[88:89],26,v206
 v_cmp_le_i32 s[98:99],27,v206
 v_cndmask_b32 v44,v205,v44,s[84:85]
 v_cndmask_b32 v45,v205,v45,s[86:87]
 v_cndmask_b32 v46,v205,v46,s[88:89]
 v_cndmask_b32 v47,v205,v47,s[98:99]
 N a[80:95],a[228:231],v[112:115],a[80:95]
 W 2
 v_exp_f32 v16,v16
 v_exp_f32 v17,v17
 v_exp_f32 v18,v18
 ds_read_b128 a[248:251],v193 offset:14336
 ds_read_b128 a[252:255],v193 offset:15360
 v_add_f32 v199,v199,v16
 v_exp_f32 v19,v19
 v_add_f32 v199,v199,v17
 N a[96:111],a[232:235],v[112:115],a[96:111]
 v_cvt_pk_bf16_f32 v16,v16,v17
 v_exp_f32 v20,v20
 v_add_f32 v199,v199,v18
 v_exp_f32 v21,v21
 v_add_u32 v192,s76,v224
 s_add_u32 s76,s76,32768
 s_and_b32 s76,s76,0xffff
 v_cvt_pk_bf16_f32 v17,v18,v19
 v_add_f32 v199,v199,v19
 v_exp_f32 v22,v22
 N a[112:127],a[236:239],v[112:115],a[112:127]
 W 2
 s_waitcnt vmcnt(8) lgkmcnt(0)
 s_barrier
 v_add_f32 v199,v199,v20
 v_exp_f32 v23,v23
 v_cvt_pk_bf16_f32 v18,v20,v21
 ds_read_b128 a[192:195],v192 offset:0
 ds_read_b128 a[196:199],v192 offset:1024
 v_add_f32 v199,v199,v21
 v_exp_f32 v24,v24
 v_add_f32 v199,v199,v22
 N a[64:79],a[240:243],v[120:123],a[64:79]
 ds_read_b128 a[200:203],v192 offset:2048
 ds_read_b128 a[204:207],v192 offset:3072
 v_exp_f32 v25,v25
 v_cvt_pk_bf16_f32 v19,v22,v23
 v_add_f32 v199,v199,v23
 v_exp_f32 v26,v26
 v_add_f32 v199,v199,v24
 v_exp_f32 v27,v27
 v_add_f32 v199,v199,v25
 N a[80:95],a[244:247],v[120:123],a[80:95]
 ds_read_b128 a[208:211],v192 offset:4096
 ds_read_b128 a[212:215],v192 offset:5120
 v_cvt_pk_bf16_f32 v24,v24,v25
 v_exp_f32 v28,v28
 v_add_f32 v199,v199,v26
 v_exp_f32 v29,v29
 v_cvt_pk_bf16_f32 v25,v26,v27
 v_add_f32 v199,v199,v27
 N a[96:111],a[248:251],v[120:123],a[96:111]
 ds_read_b128 a[216:219],v192 offset:6144
 ds_read_b128 a[220:223],v192 offset:7168
 v_exp_f32 v30,v30
 v_add_f32 v199,v199,v28
 v_exp_f32 v31,v31
 v_cvt_pk_bf16_f32 v26,v28,v29
 v_add_f32 v199,v199,v29
 v_add_f32 v199,v199,v30
 v_cvt_pk_bf16_f32 v27,v30,v31
 N a[112:127],a[252:255],v[120:123],a[112:127]
 v_add_f32 v199,v199,v31
 v_mov_b32 v48,v205
 v_mov_b32 v49,v205
 v_mov_b32 v50,v205
 v_mov_b32 v51,v205
 v_mov_b32 v52,v205
 v_mov_b32 v53,v205
 v_mov_b32 v54,v205
 v_mov_b32 v55,v205
 v_mov_b32 v56,v205
 v_mov_b32 v57,v205
 v_mov_b32 v58,v205
 v_mov_b32 v59,v205
 v_mov_b32 v60,v205
 v_mov_b32 v61,v205
 v_mov_b32 v62,v205
 v_mov_b32 v63,v205
 s_branch F_FINL
F_AC3:
 W 7
 N v[0:15],a[192:195],a[160:163],v[144:159]
 ds_read_b128 a[224:227],v192 offset:8192
 ds_read_b128 a[228:231],v192 offset:9216
 v_exp_f32 v96,v96
 v_exp_f32 v97,v97
 W 8
 N v[0:15],a[196:199],a[164:167],v[0:15]
 W 6
 s_mov_b32 m0,s92
 s_mov_b32 s69,s91
 s_add_u32 s91,s91,17408
 s_add_u32 s92,s92,0x4000
 s_and_b32 s92,s92,0xffff
 buffer_load_dwordx4 v243,s[36:39],s69 offen offset:0 sc1 lds
 N v[0:15],a[200:203],a[168:171],v[0:15]
 ds_read_b128 a[232:235],v192 offset:10240
 ds_read_b128 a[236:239],v192 offset:11264
 v_exp_f32 v98,v98
 v_add_f32 v197,v197,v96
 N v[0:15],a[204:207],a[172:175],v[0:15]
 W 6
 v_add_u32 v211,1,v211
 buffer_store_dword v211,v210,s[8:11],s73 offen sc0 sc1
 buffer_load_dwordx4 v243,s[36:39],s69 offen offset:1024 sc1 lds
 v_exp_f32 v99,v99
 N v[0:15],a[208:211],a[176:179],v[0:15]
 ds_read_b128 a[240:243],v192 offset:12288
 ds_read_b128 a[244:247],v192 offset:13312
 v_add_f32 v197,v197,v97
 v_cvt_pk_bf16_f32 v96,v96,v97
 v_exp_f32 v100,v100
 N v[0:15],a[212:215],a[180:183],v[0:15]
 W 6
 buffer_load_dwordx4 v243,s[36:39],s69 offen offset:2048 sc1 lds
 v_add_f32 v197,v197,v98
 v_exp_f32 v101,v101
 v_cvt_pk_bf16_f32 v97,v98,v99
 N v[0:15],a[216:219],a[184:187],v[0:15]
 ds_read_b128 a[248:251],v192 offset:14336
 ds_read_b128 a[252:255],v192 offset:15360
 v_add_f32 v197,v197,v99
 v_exp_f32 v102,v102
 v_add_f32 v197,v197,v100
 N v[0:15],a[220:223],a[188:191],v[0:15]
 W 6
 buffer_load_dwordx4 v243,s[36:39],s69 offen offset:3072 sc1 lds
 v_exp_f32 v103,v103
 v_cvt_pk_bf16_f32 v98,v100,v101
 v_add_f32 v197,v197,v101
 N v[16:31],a[224:227],a[160:163],v[144:159]
 ds_read_b128 a[192:195],v192 offset:16384
 ds_read_b128 a[196:199],v192 offset:17408
 v_exp_f32 v104,v104
 v_add_f32 v197,v197,v102
 N v[16:31],a[228:231],a[164:167],v[16:31]
 W 6
 v_exp_f32 v105,v105
 v_cvt_pk_bf16_f32 v99,v102,v103
 v_add_f32 v197,v197,v103
 v_exp_f32 v106,v106
 N v[16:31],a[232:235],a[168:171],v[16:31]
 ds_read_b128 a[200:203],v192 offset:18432
 ds_read_b128 a[204:207],v192 offset:19456
 v_add_f32 v197,v197,v104
 v_exp_f32 v107,v107
 v_add_f32 v197,v197,v105
 N v[16:31],a[236:239],a[172:175],v[16:31]
 W 6
 v_cvt_pk_bf16_f32 v104,v104,v105
 v_exp_f32 v108,v108
 v_add_f32 v197,v197,v106
 v_exp_f32 v109,v109
 N v[16:31],a[240:243],a[176:179],v[16:31]
 ds_read_b128 a[208:211],v192 offset:20480
 ds_read_b128 a[212:215],v192 offset:21504
 v_cvt_pk_bf16_f32 v105,v106,v107
 v_add_f32 v197,v197,v107
 v_exp_f32 v110,v110
 N v[16:31],a[244:247],a[180:183],v[16:31]
 W 6
 v_add_f32 v197,v197,v108
 v_exp_f32 v111,v111
 v_cvt_pk_bf16_f32 v106,v108,v109
 v_add_f32 v197,v197,v109
 v_add_f32 v197,v197,v110
 N v[16:31],a[248:251],a[184:187],v[16:31]
 ds_read_b128 a[216:219],v192 offset:22528
 ds_read_b128 a[220:223],v192 offset:23552
 v_cvt_pk_bf16_f32 v107,v110,v111
 v_add_f32 v197,v197,v111
 v_exp_f32 v112,v112
 N v[16:31],a[252:255],a[188:191],v[16:31]
 W 6
 v_exp_f32 v113,v113
 v_exp_f32 v114,v114
 v_add_f32 v199,v199,v112
 N v[32:47],a[192:195],a[160:163],v[144:159]
 ds_read_b128 a[224:227],v192 offset:24576
 ds_read_b128 a[228:231],v192 offset:25600
 v_exp_f32 v115,v115
 v_add_f32 v199,v199,v113
 v_cvt_pk_bf16_f32 v112,v112,v113
 N v[32:47],a[196:199],a[164:167],v[32:47]
 W 6
 v_exp_f32 v116,v116
 v_add_f32 v199,v199,v114
 v_exp_f32 v117,v117
 v_cvt_pk_bf16_f32 v113,v114,v115
 N v[32:47],a[200:203],a[168:171],v[32:47]
 ds_read_b128 a[232:235],v192 offset:26624
 ds_read_b128 a[236:239],v192 offset:27648
 v_add_f32 v199,v199,v115
 v_exp_f32 v118,v118
 v_add_f32 v199,v199,v116
 N v[32:47],a[204:207],a[172:175],v[32:47]
 W 6
 v_exp_f32 v119,v119
 v_cvt_pk_bf16_f32 v114,v116,v117
 v_add_f32 v199,v199,v117
 v_exp_f32 v120,v120
 N v[32:47],a[208:211],a[176:179],v[32:47]
 ds_read_b128 a[240:243],v192 offset:28672
 ds_read_b128 a[244:247],v192 offset:29696
 v_add_f32 v199,v199,v118
 v_exp_f32 v121,v121
 v_cvt_pk_bf16_f32 v115,v118,v119
 N v[32:47],a[212:215],a[180:183],v[32:47]
 W 6
 v_add_f32 v199,v199,v119
 v_exp_f32 v122,v122
 v_add_f32 v199,v199,v120
 v_exp_f32 v123,v123
 N v[32:47],a[216:219],a[184:187],v[32:47]
 ds_read_b128 a[248:251],v192 offset:30720
 ds_read_b128 a[252:255],v192 offset:31744
 v_add_f32 v199,v199,v121
 v_cvt_pk_bf16_f32 v120,v120,v121
 v_exp_f32 v124,v124
 N v[32:47],a[220:223],a[188:191],v[32:47]
 W 6
 v_add_u32 v193,s77,v194
 s_add_u32 s77,s77,16384
 s_and_b32 s77,s77,0xffff
 v_add_f32 v199,v199,v122
 v_exp_f32 v125,v125
 N v[48:63],a[224:227],a[160:163],v[144:159]
 v_cvt_pk_bf16_f32 v121,v122,v123
 v_add_f32 v199,v199,v123
 v_exp_f32 v126,v126
 v_add_f32 v199,v199,v124
 N v[48:63],a[228:231],a[164:167],v[48:63]
 W 4
 W 0
 s_barrier
 v_exp_f32 v127,v127
 v_cvt_pk_bf16_f32 v122,v124,v125
 v_add_f32 v199,v199,v125
 N v[48:63],a[232:235],a[168:171],v[48:63]
 ds_read_b128 a[192:195],v193 offset:0
 ds_read_b128 a[196:199],v193 offset:1024
 v_add_f32 v199,v199,v126
 v_cvt_pk_bf16_f32 v123,v126,v127
 v_add_f32 v199,v199,v127
 v_max_f32 v200,v197,v199
 N v[48:63],a[236:239],a[172:175],v[48:63]
 s_add_u32 m0,s92,0x0
 N v[48:63],a[240:243],a[176:179],v[48:63]
 ds_read_b128 a[200:203],v193 offset:2048
 ds_read_b128 a[204:207],v193 offset:3072
 buffer_load_dwordx4 v243,s[36:39],s91 offen offset:0 sc1 lds
 N v[48:63],a[244:247],a[180:183],v[48:63]
 N v[48:63],a[248:251],a[184:187],v[48:63]
 buffer_load_dwordx4 v243,s[36:39],s91 offen offset:1024 sc1 lds
 N v[48:63],a[252:255],a[188:191],v[48:63]
 W 2
 v_cmp_lt_f32 vcc,s78,v200
 s_cbranch_vccz F_c33
 s_call_b64 s[82:83],F_XAB1
F_c33:
 v_add_f32 v196,v196,v197
 v_add_f32 v198,v198,v199
 s_add_u32 s75,s75,64
 N a[0:15],a[192:195],v[64:67],a[0:15]
 ds_read_b128 a[208:211],v193 offset:4096
 ds_read_b128 a[212:215],v193 offset:5120
 buffer_load_dwordx4 v243,s[36:39],s91 offen offset:2048 sc1 lds
 v_exp_f32 v0,v0
 N a[64:79],a[192:195],v[80:83],a[64:79]
 v_exp_f32 v1,v1
 v_exp_f32 v2,v2
 v_add_f32 v199,v0,v1
 N a[16:31],a[196:199],v[64:67],a[16:31]
 buffer_load_dwordx4 v243,s[36:39],s91 offen offset:3072 sc1 lds
 v_exp_f32 v3,v3
 v_cvt_pk_bf16_f32 v0,v0,v1
 v_exp_f32 v4,v4
 N a[80:95],a[196:199],v[80:83],a[80:95]
 W 2
 v_add_f32 v199,v199,v2
 v_exp_f32 v5,v5
 v_cvt_pk_bf16_f32 v1,v2,v3
 v_add_f32 v199,v199,v3
 N a[32:47],a[200:203],v[64:67],a[32:47]
 ds_read_b128 a[216:219],v193 offset:6144
 ds_read_b128 a[220:223],v193 offset:7168
 s_add_u32 m0,s92,0x4000
 s_add_u32 s69,s91,17408
 s_add_u32 s91,s91,34816
 s_xor_b32 s92,s92,0x8000
 buffer_load_dwordx4 v243,s[36:39],s69 offen offset:0 sc1 lds
 N a[96:111],a[200:203],v[80:83],a[96:111]
 v_exp_f32 v6,v6
 v_add_f32 v199,v199,v4
 v_exp_f32 v7,v7
 v_cvt_pk_bf16_f32 v2,v4,v5
 N a[48:63],a[204:207],v[64:67],a[48:63]
 buffer_load_dwordx4 v243,s[36:39],s69 offen offset:1024 sc1 lds
 v_add_f32 v199,v199,v5
 v_exp_f32 v8,v8
 v_add_f32 v199,v199,v6
 N a[112:127],a[204:207],v[80:83],a[112:127]
 W 2
 v_exp_f32 v9,v9
 v_cvt_pk_bf16_f32 v3,v6,v7
 v_add_f32 v199,v199,v7
 v_exp_f32 v10,v10
 N a[0:15],a[208:211],v[72:75],a[0:15]
 ds_read_b128 a[224:227],v193 offset:8192
 ds_read_b128 a[228:231],v193 offset:9216
 buffer_load_dwordx4 v243,s[36:39],s69 offen offset:2048 sc1 lds
 v_add_f32 v199,v199,v8
 N a[64:79],a[208:211],v[88:91],a[64:79]
 v_exp_f32 v11,v11
 v_add_f32 v199,v199,v9
 v_cvt_pk_bf16_f32 v8,v8,v9
 v_exp_f32 v12,v12
 N a[16:31],a[212:215],v[72:75],a[16:31]
 buffer_load_dwordx4 v243,s[36:39],s69 offen offset:3072 sc1 lds
 v_add_f32 v199,v199,v10
 v_exp_f32 v13,v13
 v_cvt_pk_bf16_f32 v9,v10,v11
 v_add_f32 v199,v199,v11
 N a[80:95],a[212:215],v[88:91],a[80:95]
 W 2
 v_exp_f32 v14,v14
 v_add_f32 v199,v199,v12
 v_exp_f32 v15,v15
 v_cvt_pk_bf16_f32 v10,v12,v13
 N a[32:47],a[216:219],v[72:75],a[32:47]
 ds_read_b128 a[232:235],v193 offset:10240
 ds_read_b128 a[236:239],v193 offset:11264
 v_add_f32 v199,v199,v13
 v_add_f32 v199,v199,v14
 v_cvt_pk_bf16_f32 v11,v14,v15
 v_add_f32 v199,v199,v15
 N a[96:111],a[216:219],v[88:91],a[96:111]
 buffer_load_dword v207,v208,s[8:11],0 offen sc1
 v_subrev_u32 v206,96,v204
 v_cmp_le_i32 s[84:85],0,v206
 v_cmp_le_i32 s[86:87],1,v206
 v_cmp_le_i32 s[88:89],2,v206
 v_cmp_le_i32 s[98:99],3,v206
 N a[48:63],a[220:223],v[72:75],a[48:63]
 v_cndmask_b32 v48,v205,v48,s[84:85]
 v_cndmask_b32 v49,v205,v49,s[86:87]
 v_cndmask_b32 v50,v205,v50,s[88:89]
 v_cndmask_b32 v51,v205,v51,s[98:99]
 v_cmp_le_i32 s[84:85],8,v206
 v_cmp_le_i32 s[86:87],9,v206
 N a[112:127],a[220:223],v[88:91],a[112:127]
 W 2
 v_cmp_le_i32 s[88:89],10,v206
 v_cmp_le_i32 s[98:99],11,v206
 v_cndmask_b32 v52,v205,v52,s[84:85]
 v_cndmask_b32 v53,v205,v53,s[86:87]
 v_cndmask_b32 v54,v205,v54,s[88:89]
 v_cndmask_b32 v55,v205,v55,s[98:99]
 N a[0:15],a[224:227],v[96:99],a[0:15]
 ds_read_b128 a[240:243],v193 offset:12288
 ds_read_b128 a[244:247],v193 offset:13312
 v_cmp_le_i32 s[84:85],16,v206
 v_cmp_le_i32 s[86:87],17,v206
 v_cmp_le_i32 s[88:89],18,v206
 v_cmp_le_i32 s[98:99],19,v206
 N a[64:79],a[224:227],v[112:115],a[64:79]
 v_cndmask_b32 v56,v205,v56,s[84:85]
 v_cndmask_b32 v57,v205,v57,s[86:87]
 v_cndmask_b32 v58,v205,v58,s[88:89]
 v_cndmask_b32 v59,v205,v59,s[98:99]
 v_cmp_le_i32 s[84:85],24,v206
 v_cmp_le_i32 s[86:87],25,v206
 N a[16:31],a[228:231],v[96:99],a[16:31]
 v_cmp_le_i32 s[88:89],26,v206
 v_cmp_le_i32 s[98:99],27,v206
 v_cndmask_b32 v60,v205,v60,s[84:85]
 v_cndmask_b32 v61,v205,v61,s[86:87]
 v_cndmask_b32 v62,v205,v62,s[88:89]
 v_cndmask_b32 v63,v205,v63,s[98:99]
 N a[80:95],a[228:231],v[112:115],a[80:95]
 W 2
 v_exp_f32 v16,v16
 v_exp_f32 v17,v17
 v_exp_f32 v18,v18
 N a[32:47],a[232:235],v[96:99],a[32:47]
 ds_read_b128 a[248:251],v193 offset:14336
 ds_read_b128 a[252:255],v193 offset:15360
 v_add_f32 v199,v199,v16
 v_exp_f32 v19,v19
 v_add_f32 v199,v199,v17
 N a[96:111],a[232:235],v[112:115],a[96:111]
 v_cvt_pk_bf16_f32 v16,v16,v17
 v_exp_f32 v20,v20
 v_add_f32 v199,v199,v18
 v_exp_f32 v21,v21
 N a[48:63],a[236:239],v[96:99],a[48:63]
 v_add_u32 v192,s76,v224
 s_add_u32 s76,s76,32768
 s_and_b32 s76,s76,0xffff
 v_cvt_pk_bf16_f32 v17,v18,v19
 v_add_f32 v199,v199,v19
 v_exp_f32 v22,v22
 N a[112:127],a[236:239],v[112:115],a[112:127]
 W 2
 s_waitcnt vmcnt(8) lgkmcnt(0)
 s_barrier
 v_add_f32 v199,v199,v20
 v_exp_f32 v23,v23
 v_cvt_pk_bf16_f32 v18,v20,v21
 N a[0:15],a[240:243],v[104:107],a[0:15]
 ds_read_b128 a[192:195],v192 offset:0
 ds_read_b128 a[196:199],v192 offset:1024
 v_add_f32 v199,v199,v21
 v_exp_f32 v24,v24
 v_add_f32 v199,v199,v22
 N a[64:79],a[240:243],v[120:123],a[64:79]
 ds_read_b128 a[200:203],v192 offset:2048
 ds_read_b128 a[204:207],v192 offset:3072
 v_exp_f32 v25,v25
 v_cvt_pk_bf16_f32 v19,v22,v23
 v_add_f32 v199,v199,v23
 N a[16:31],a[244:247],v[104:107],a[16:31]
 v_exp_f32 v26,v26
 v_add_f32 v199,v199,v24
 v_exp_f32 v27,v27
 v_add_f32 v199,v199,v25
 N a[80:95],a[244:247],v[120:123],a[80:95]
 ds_read_b128 a[208:211],v192 offset:4096
 ds_read_b128 a[212:215],v192 offset:5120
 v_cvt_pk_bf16_f32 v24,v24,v25
 v_exp_f32 v28,v28
 N a[32:47],a[248:251],v[104:107],a[32:47]
 v_add_f32 v199,v199,v26
 v_exp_f32 v29,v29
 v_cvt_pk_bf16_f32 v25,v26,v27
 v_add_f32 v199,v199,v27
 N a[96:111],a[248:251],v[120:123],a[96:111]
 ds_read_b128 a[216:219],v192 offset:6144
 ds_read_b128 a[220:223],v192 offset:7168
 v_exp_f32 v30,v30
 v_add_f32 v199,v199,v28
 N a[48:63],a[252:255],v[104:107],a[48:63]
 v_exp_f32 v31,v31
 v_cvt_pk_bf16_f32 v26,v28,v29
 v_add_f32 v199,v199,v29
 v_add_f32 v199,v199,v30
 v_cvt_pk_bf16_f32 v27,v30,v31
 N a[112:127],a[252:255],v[120:123],a[112:127]
 v_add_f32 v199,v199,v31
F_FINL:
 v_add_u32 v195,57344,v224
 s_and_b32 s90,s65,1
 s_mul_i32 s90,s90,3
 s_mul_i32 s81,s65,7
 s_add_u32 s81,s81,s90
 s_sub_u32 s4,s95,0x3000000
 s_lshr_b32 s4,s4,17
 s_mul_i32 s4,s4,56
 s_add_u32 s4,s4,s81
 s_lshl_b32 s4,s4,10
 s_add_u32 s4,s4,0x2700000
 s_sub_u32 s5,s96,0x3000000
 s_lshr_b32 s5,s5,17
 s_mul_i32 s5,s5,56
 s_add_u32 s5,s5,s81
 s_lshl_b32 s5,s5,10
 s_add_u32 s5,s5,0x2700000
 s_waitcnt vmcnt(0)
 s_barrier
 s_add_u32 s63,s62,1
 v_subrev_u32 v207,s63,v207
 v_cmp_le_u32 vcc,8,v207
 s_cbranch_vccz PL_ok9
 s_mov_b32 s69,0x100000
PL_sp9:
 s_sleep 2
 buffer_load_dword v207,v208,s[8:11],0 offen sc1
 s_waitcnt vmcnt(0)
 v_subrev_u32 v207,s63,v207
 v_cmp_le_u32 vcc,8,v207
 s_cbranch_vccz PL_ok9
 s_sub_u32 s69,s69,1
 s_cbranch_scc0 PL_sp9
PL_ok9:
 s_mov_b32 s81,s4
 s_mov_b32 s90,s5
 v_lshlrev_b32 v250,3,v224
 v_lshl_add_u32 v250,s64,13,v250
 v_add_u32 v250,F_Bend-F_pc+0,v250
 s_and_b32 s79,s65,1
 s_mul_i32 s79,s79,F_Bodd-F_Bend
 v_add_u32 v250,s79,v250
 v_min_u32 v250,F_RA0-F_pc,v250
 v_lshlrev_b32 v251,3,v224
 v_lshl_add_u32 v251,s64,13,v251
 v_add_u32 v251,F_P4-F_pc+0,v251
 v_min_u32 v251,F_RA0-F_pc,v251
 global_load_dword v252,v250,s[6:7]
 global_load_dword v252,v251,s[6:7]
 v_mov_b32 v206,v196
 s_nop 1
 v_permlane32_swap_b32 v196,v206
 v_add_f32 v196,v196,v206
 v_rcp_f32 v196,v196
 s_add_u32 s97,s95,0x20000
 v_accvgpr_read_b32 v160,a0
 v_accvgpr_read_b32 v161,a1
 v_accvgpr_read_b32 v162,a2
 v_accvgpr_read_b32 v163,a3
 buffer_load_dwordx4 a[128:131],v224,s[8:11],s81 offen offset:2048 sc1
 v_accvgpr_read_b32 v164,a4
 v_accvgpr_read_b32 v165,a5
 v_accvgpr_read_b32 v166,a6
 v_accvgpr_read_b32 v167,a7
 v_accvgpr_read_b32 v168,a8
 v_accvgpr_read_b32 v169,a9
 v_accvgpr_read_b32 v170,a10
 v_accvgpr_read_b32 v171,a11
 buffer_load_dwordx4 a[132:135],v195,s[8:11],s81 offen offset:2048 sc1
 v_accvgpr_read_b32 v172,a12
 v_accvgpr_read_b32 v173,a13
 v_accvgpr_read_b32 v174,a14
 v_accvgpr_read_b32 v175,a15
 v_mul_f32 v160,v160,v196
 v_mul_f32 v161,v161,v196
 v_mul_f32 v162,v162,v196
 v_mul_f32 v163,v163,v196
 buffer_load_dwordx4 a[136:139],v224,s[8:11],s90 offen offset:2048 sc1
 v_mul_f32 v164,v164,v196
 v_mul_f32 v165,v165,v196
 v_mul_f32 v166,v166,v196
 v_mul_f32 v167,v167,v196
 v_mul_f32 v168,v168,v196
 v_mul_f32 v169,v169,v196
 v_mul_f32 v170,v170,v196
 v_mul_f32 v171,v171,v196
 buffer_load_dwordx4 a[140:143],v195,s[8:11],s90 offen offset:2048 sc1
 v_mul_f32 v172,v172,v196
 v_mul_f32 v173,v173,v196
 v_mul_f32 v174,v174,v196
 v_mul_f32 v175,v175,v196
 v_cvt_pk_bf16_f32 v226,v160,v161
 v_cvt_pk_bf16_f32 v227,v162,v163
 v_cvt_pk_bf16_f32 v228,v168,v169
 v_cvt_pk_bf16_f32 v229,v170,v171
 v_cvt_pk_bf16_f32 v230,v164,v165
 v_cvt_pk_bf16_f32 v231,v166,v167
 v_cvt_pk_bf16_f32 v232,v172,v173
 v_cvt_pk_bf16_f32 v233,v174,v175
 v_permlane32_swap_b32 v226,v230
 v_permlane32_swap_b32 v227,v231
 v_permlane32_swap_b32 v228,v232
 v_permlane32_swap_b32 v229,v233
 v_permlane16_swap_b32 v226,v230
 v_permlane16_swap_b32 v227,v231
 v_permlane16_swap_b32 v228,v232
 v_permlane16_swap_b32 v229,v233
 buffer_store_dwordx4 v[226:229],v224,s[8:11],s95 offen offset:0 sc0 sc1
 buffer_store_dwordx4 v[230:233],v224,s[8:11],s97 offen offset:0 sc0 sc1
 v_accvgpr_write_b32 a0,v226
 v_accvgpr_write_b32 a1,v227
 v_accvgpr_write_b32 a2,v228
 v_accvgpr_write_b32 a3,v229
 v_accvgpr_write_b32 a4,v230
 v_accvgpr_write_b32 a5,v231
 v_accvgpr_write_b32 a6,v232
 v_accvgpr_write_b32 a7,v233
 v_accvgpr_read_b32 v176,a16
 v_accvgpr_read_b32 v177,a17
 v_accvgpr_read_b32 v178,a18
 v_accvgpr_read_b32 v179,a19
 buffer_load_dwordx4 a[144:147],v224,s[8:11],s81 offen offset:3072 sc1
 v_accvgpr_read_b32 v180,a20
 v_accvgpr_read_b32 v181,a21
 v_accvgpr_read_b32 v182,a22
 v_accvgpr_read_b32 v183,a23
 v_accvgpr_read_b32 v184,a24
 v_accvgpr_read_b32 v185,a25
 v_accvgpr_read_b32 v186,a26
 v_accvgpr_read_b32 v187,a27
 buffer_load_dwordx4 a[148:151],v195,s[8:11],s81 offen offset:3072 sc1
 v_accvgpr_read_b32 v188,a28
 v_accvgpr_read_b32 v189,a29
 v_accvgpr_read_b32 v190,a30
 v_accvgpr_read_b32 v191,a31
 v_mul_f32 v176,v176,v196
 v_mul_f32 v177,v177,v196
 v_mul_f32 v178,v178,v196
 v_mul_f32 v179,v179,v196
 buffer_load_dwordx4 a[152:155],v224,s[8:11],s90 offen offset:3072 sc1
 v_mul_f32 v180,v180,v196
 v_mul_f32 v181,v181,v196
 v_mul_f32 v182,v182,v196
 v_mul_f32 v183,v183,v196
 v_mul_f32 v184,v184,v196
 v_mul_f32 v185,v185,v196
 v_mul_f32 v186,v186,v196
 v_mul_f32 v187,v187,v196
 buffer_load_dwordx4 a[156:159],v195,s[8:11],s90 offen offset:3072 sc1
 v_mul_f32 v188,v188,v196
 v_mul_f32 v189,v189,v196
 v_mul_f32 v190,v190,v196
 v_mul_f32 v191,v191,v196
 v_cvt_pk_bf16_f32 v234,v176,v177
 v_cvt_pk_bf16_f32 v235,v178,v179
 v_cvt_pk_bf16_f32 v236,v184,v185
 v_cvt_pk_bf16_f32 v237,v186,v187
 v_cvt_pk_bf16_f32 v238,v180,v181
 v_cvt_pk_bf16_f32 v239,v182,v183
 v_cvt_pk_bf16_f32 v240,v188,v189
 v_cvt_pk_bf16_f32 v241,v190,v191
 v_permlane32_swap_b32 v234,v238
 v_permlane32_swap_b32 v235,v239
 v_permlane32_swap_b32 v236,v240
 v_permlane32_swap_b32 v237,v241
 v_permlane16_swap_b32 v234,v238
 v_permlane16_swap_b32 v235,v239
 v_permlane16_swap_b32 v236,v240
 v_permlane16_swap_b32 v237,v241
 buffer_store_dwordx4 v[234:237],v224,s[8:11],s95 offen offset:1024 sc0 sc1
 buffer_store_dwordx4 v[238:241],v224,s[8:11],s97 offen offset:1024 sc0 sc1
 v_accvgpr_write_b32 a16,v234
 v_accvgpr_write_b32 a17,v235
 v_accvgpr_write_b32 a18,v236
 v_accvgpr_write_b32 a19,v237
 v_accvgpr_write_b32 a20,v238
 v_accvgpr_write_b32 a21,v239
 v_accvgpr_write_b32 a22,v240
 v_accvgpr_write_b32 a23,v241
 v_accvgpr_read_b32 v160,a32
 v_accvgpr_read_b32 v161,a33
 v_accvgpr_read_b32 v162,a34
 v_accvgpr_read_b32 v163,a35
 buffer_load_dwordx4 a[8:11],v224,s[8:11],s81 offen offset:0 sc1
 v_accvgpr_read_b32 v164,a36
 v_accvgpr_read_b32 v165,a37
 v_accvgpr_read_b32 v166,a38
 v_accvgpr_read_b32 v167,a39
 v_accvgpr_read_b32 v168,a40
 v_accvgpr_read_b32 v169,a41
 v_accvgpr_read_b32 v170,a42
 v_accvgpr_read_b32 v171,a43
 buffer_load_dwordx4 a[12:15],v195,s[8:11],s81 offen offset:0 sc1
 v_accvgpr_read_b32 v172,a44
 v_accvgpr_read_b32 v173,a45
 v_accvgpr_read_b32 v174,a46
 v_accvgpr_read_b32 v175,a47
 v_mul_f32 v160,v160,v196
 v_mul_f32 v161,v161,v196
 v_mul_f32 v162,v162,v196
 v_mul_f32 v163,v163,v196
 buffer_load_dwordx4 a[24:27],v224,s[8:11],s90 offen offset:0 sc1
 v_mul_f32 v164,v164,v196
 v_mul_f32 v165,v165,v196
 v_mul_f32 v166,v166,v196
 v_mul_f32 v167,v167,v196
 v_mul_f32 v168,v168,v196
 v_mul_f32 v169,v169,v196
 v_mul_f32 v170,v170,v196
 v_mul_f32 v171,v171,v196
 buffer_load_dwordx4 a[28:31],v195,s[8:11],s90 offen offset:0 sc1
 v_mul_f32 v172,v172,v196
 v_mul_f32 v173,v173,v196
 v_mul_f32 v174,v174,v196
 v_mul_f32 v175,v175,v196
 v_cvt_pk_bf16_f32 v226,v160,v161
 v_cvt_pk_bf16_f32 v227,v162,v163
 v_cvt_pk_bf16_f32 v228,v168,v169
 v_cvt_pk_bf16_f32 v229,v170,v171
 v_cvt_pk_bf16_f32 v230,v164,v165
 v_cvt_pk_bf16_f32 v231,v166,v167
 v_cvt_pk_bf16_f32 v232,v172,v173
 v_cvt_pk_bf16_f32 v233,v174,v175
 v_permlane32_swap_b32 v226,v230
 v_permlane32_swap_b32 v227,v231
 v_permlane32_swap_b32 v228,v232
 v_permlane32_swap_b32 v229,v233
 v_permlane16_swap_b32 v226,v230
 v_permlane16_swap_b32 v227,v231
 v_permlane16_swap_b32 v228,v232
 v_permlane16_swap_b32 v229,v233
 buffer_store_dwordx4 v[226:229],v224,s[8:11],s95 offen offset:2048 sc0 sc1
 buffer_store_dwordx4 v[230:233],v224,s[8:11],s97 offen offset:2048 sc0 sc1
 v_accvgpr_write_b32 a32,v226
 v_accvgpr_write_b32 a33,v227
 v_accvgpr_write_b32 a34,v228
 v_accvgpr_write_b32 a35,v229
 v_accvgpr_write_b32 a36,v230
 v_accvgpr_write_b32 a37,v231
 v_accvgpr_write_b32 a38,v232
 v_accvgpr_write_b32 a39,v233
 v_accvgpr_read_b32 v176,a48
 v_accvgpr_read_b32 v177,a49
 v_accvgpr_read_b32 v178,a50
 v_accvgpr_read_b32 v179,a51
 v_accvgpr_read_b32 v180,a52
 v_accvgpr_read_b32 v181,a53
 v_accvgpr_read_b32 v182,a54
 v_accvgpr_read_b32 v183,a55
 buffer_load_dwordx4 a[40:43],v224,s[8:11],s81 offen offset:1024 sc1
 v_accvgpr_read_b32 v184,a56
 v_accvgpr_read_b32 v185,a57
 v_accvgpr_read_b32 v186,a58
 v_accvgpr_read_b32 v187,a59
 v_accvgpr_read_b32 v188,a60
 v_accvgpr_read_b32 v189,a61
 v_accvgpr_read_b32 v190,a62
 v_accvgpr_read_b32 v191,a63
 buffer_load_dwordx4 a[44:47],v195,s[8:11],s81 offen offset:1024 sc1
 v_mul_f32 v176,v176,v196
 v_mul_f32 v177,v177,v196
 v_mul_f32 v178,v178,v196
 v_mul_f32 v179,v179,v196
 v_mul_f32 v180,v180,v196
 v_mul_f32 v181,v181,v196
 v_mul_f32 v182,v182,v196
 v_mul_f32 v183,v183,v196
 v_mul_f32 v184,v184,v196
 v_mul_f32 v185,v185,v196
 v_mul_f32 v186,v186,v196
 v_mul_f32 v187,v187,v196
 v_mul_f32 v188,v188,v196
 v_mul_f32 v189,v189,v196
 v_mul_f32 v190,v190,v196
 v_mul_f32 v191,v191,v196
 v_cvt_pk_bf16_f32 v234,v176,v177
 v_cvt_pk_bf16_f32 v235,v178,v179
 v_cvt_pk_bf16_f32 v236,v184,v185
 v_cvt_pk_bf16_f32 v237,v186,v187
 v_cvt_pk_bf16_f32 v238,v180,v181
 v_cvt_pk_bf16_f32 v239,v182,v183
 v_cvt_pk_bf16_f32 v240,v188,v189
 v_cvt_pk_bf16_f32 v241,v190,v191
 v_permlane32_swap_b32 v234,v238
 v_permlane32_swap_b32 v235,v239
 v_permlane32_swap_b32 v236,v240
 v_permlane32_swap_b32 v237,v241
 v_permlane16_swap_b32 v234,v238
 v_permlane16_swap_b32 v235,v239
 v_permlane16_swap_b32 v236,v240
 v_permlane16_swap_b32 v237,v241
 buffer_store_dwordx4 v[234:237],v224,s[8:11],s95 offen offset:3072 sc0 sc1
 buffer_store_dwordx4 v[238:241],v224,s[8:11],s97 offen offset:3072 sc0 sc1
 v_accvgpr_write_b32 a48,v234
 v_accvgpr_write_b32 a49,v235
 v_accvgpr_write_b32 a50,v236
 v_accvgpr_write_b32 a51,v237
 v_accvgpr_write_b32 a52,v238
 v_accvgpr_write_b32 a53,v239
 v_accvgpr_write_b32 a54,v240
 v_accvgpr_write_b32 a55,v241
 buffer_load_dwordx4 a[56:59],v224,s[8:11],s90 offen offset:1024 sc1
 buffer_load_dwordx4 a[60:63],v195,s[8:11],s90 offen offset:1024 sc1
 s_sub_u32 s74,6,s66
 s_cbranch_scc1 F_Bend
.p2align 3
F_BBe:
 W 7
 N v[64:79],a[192:195],a[160:163],v[144:159]
 ds_read_b128 a[224:227],v192 offset:8192
 ds_read_b128 a[228:231],v192 offset:9216
 s_add_u32 m0,s94,0x10000
 v_exp_f32 v32,v32
 W 8
 N v[64:79],a[196:199],a[164:167],v[64:79]
 W 6
 buffer_load_dwordx4 v243,s[40:43],s93 offen offset:0 sc1 lds
 v_exp_f32 v33,v33
 v_exp_f32 v34,v34
 N v[64:79],a[200:203],a[168:171],v[64:79]
 ds_read_b128 a[232:235],v192 offset:10240
 ds_read_b128 a[236:239],v192 offset:11264
 v_add_f32 v199,v199,v32
 v_exp_f32 v35,v35
 v_add_f32 v199,v199,v33
 N v[64:79],a[204:207],a[172:175],v[64:79]
 W 6
 buffer_load_dwordx4 v243,s[40:43],s93 offen offset:1024 sc1 lds
 v_cvt_pk_bf16_f32 v32,v32,v33
 v_exp_f32 v36,v36
 v_add_f32 v199,v199,v34
 N v[64:79],a[208:211],a[176:179],v[64:79]
 ds_read_b128 a[240:243],v192 offset:12288
 ds_read_b128 a[244:247],v192 offset:13312
 v_exp_f32 v37,v37
 v_cvt_pk_bf16_f32 v33,v34,v35
 v_add_f32 v199,v199,v35
 N v[64:79],a[212:215],a[180:183],v[64:79]
 W 6
 buffer_load_dwordx4 v243,s[40:43],s93 offen offset:2048 sc1 lds
 v_exp_f32 v38,v38
 v_add_f32 v199,v199,v36
 N v[64:79],a[216:219],a[184:187],v[64:79]
 ds_read_b128 a[248:251],v192 offset:14336
 ds_read_b128 a[252:255],v192 offset:15360
 v_exp_f32 v39,v39
 v_cvt_pk_bf16_f32 v34,v36,v37
 v_add_f32 v199,v199,v37
 N v[64:79],a[220:223],a[188:191],v[64:79]
 W 6
 buffer_load_dwordx4 v243,s[40:43],s93 offen offset:3072 sc1 lds
 v_exp_f32 v40,v40
 v_add_f32 v199,v199,v38
 N v[80:95],a[224:227],a[160:163],v[144:159]
 ds_read_b128 a[192:195],v192 offset:16384
 ds_read_b128 a[196:199],v192 offset:17408
 v_exp_f32 v41,v41
 v_cvt_pk_bf16_f32 v35,v38,v39
 v_add_f32 v199,v199,v39
 N v[80:95],a[228:231],a[164:167],v[80:95]
 W 6
 s_add_u32 m0,s94,0x14000
 s_add_u32 s69,s93,17408
 s_add_u32 s93,s93,34816
 s_xor_b32 s94,s94,0x8000
 buffer_load_dwordx4 v243,s[40:43],s69 offen offset:0 sc1 lds
 N v[80:95],a[232:235],a[168:171],v[80:95]
 ds_read_b128 a[200:203],v192 offset:18432
 ds_read_b128 a[204:207],v192 offset:19456
 v_exp_f32 v42,v42
 v_add_f32 v199,v199,v40
 N v[80:95],a[236:239],a[172:175],v[80:95]
 W 6
 buffer_load_dwordx4 v243,s[40:43],s69 offen offset:1024 sc1 lds
 v_exp_f32 v43,v43
 v_add_f32 v199,v199,v41
 v_cvt_pk_bf16_f32 v40,v40,v41
 N v[80:95],a[240:243],a[176:179],v[80:95]
 ds_read_b128 a[208:211],v192 offset:20480
 ds_read_b128 a[212:215],v192 offset:21504
 v_exp_f32 v44,v44
 v_add_f32 v199,v199,v42
 N v[80:95],a[244:247],a[180:183],v[80:95]
 W 6
 buffer_load_dwordx4 v243,s[40:43],s69 offen offset:2048 sc1 lds
 v_exp_f32 v45,v45
 v_cvt_pk_bf16_f32 v41,v42,v43
 v_add_f32 v199,v199,v43
 N v[80:95],a[248:251],a[184:187],v[80:95]
 ds_read_b128 a[216:219],v192 offset:22528
 ds_read_b128 a[220:223],v192 offset:23552
 v_exp_f32 v46,v46
 v_add_f32 v199,v199,v44
 N v[80:95],a[252:255],a[188:191],v[80:95]
 W 6
 buffer_load_dwordx4 v243,s[40:43],s69 offen offset:3072 sc1 lds
 v_exp_f32 v47,v47
 v_cvt_pk_bf16_f32 v42,v44,v45
 v_add_f32 v199,v199,v45
 N v[96:111],a[192:195],a[160:163],v[144:159]
 ds_read_b128 a[224:227],v192 offset:24576
 ds_read_b128 a[228:231],v192 offset:25600
 v_add_f32 v199,v199,v46
 v_cvt_pk_bf16_f32 v43,v46,v47
 v_add_f32 v199,v199,v47
 N v[96:111],a[196:199],a[164:167],v[96:111]
 W 6
 v_exp_f32 v48,v48
 v_exp_f32 v49,v49
 v_exp_f32 v50,v50
 N v[96:111],a[200:203],a[168:171],v[96:111]
 ds_read_b128 a[232:235],v192 offset:26624
 ds_read_b128 a[236:239],v192 offset:27648
 v_add_f32 v199,v199,v48
 v_exp_f32 v51,v51
 v_add_f32 v199,v199,v49
 N v[96:111],a[204:207],a[172:175],v[96:111]
 W 6
 v_cvt_pk_bf16_f32 v48,v48,v49
 v_exp_f32 v52,v52
 v_add_f32 v199,v199,v50
 v_exp_f32 v53,v53
 N v[96:111],a[208:211],a[176:179],v[96:111]
 ds_read_b128 a[240:243],v192 offset:28672
 ds_read_b128 a[244:247],v192 offset:29696
 v_cvt_pk_bf16_f32 v49,v50,v51
 v_add_f32 v199,v199,v51
 v_exp_f32 v54,v54
 N v[96:111],a[212:215],a[180:183],v[96:111]
 W 6
 v_add_f32 v199,v199,v52
 v_exp_f32 v55,v55
 v_cvt_pk_bf16_f32 v50,v52,v53
 v_add_f32 v199,v199,v53
 N v[96:111],a[216:219],a[184:187],v[96:111]
 ds_read_b128 a[248:251],v192 offset:30720
 ds_read_b128 a[252:255],v192 offset:31744
 v_exp_f32 v56,v56
 v_add_f32 v199,v199,v54
 N v[96:111],a[220:223],a[188:191],v[96:111]
 W 6
 v_add_u32 v193,s77,v194
 s_add_u32 s77,s77,32768
 s_and_b32 s77,s77,0xffff
 v_exp_f32 v57,v57
 v_cvt_pk_bf16_f32 v51,v54,v55
 N v[112:127],a[224:227],a[160:163],v[144:159]
 v_add_f32 v199,v199,v55
 v_exp_f32 v58,v58
 v_add_f32 v199,v199,v56
 v_exp_f32 v59,v59
 N v[112:127],a[228:231],a[164:167],v[112:127]
 W 4
 s_waitcnt vmcnt(16) lgkmcnt(0)
 s_barrier
 v_add_f32 v199,v199,v57
 v_cvt_pk_bf16_f32 v56,v56,v57
 v_exp_f32 v60,v60
 N v[112:127],a[232:235],a[168:171],v[112:127]
 ds_read_b128 a[192:195],v193 offset:0
 ds_read_b128 a[196:199],v193 offset:1024
 v_add_f32 v199,v199,v58
 v_exp_f32 v61,v61
 v_cvt_pk_bf16_f32 v57,v58,v59
 N v[112:127],a[236:239],a[172:175],v[112:127]
 ds_read_b128 a[200:203],v193 offset:2048
 ds_read_b128 a[204:207],v193 offset:3072
 v_add_f32 v199,v199,v59
 v_exp_f32 v62,v62
 N v[112:127],a[240:243],a[176:179],v[112:127]
 ds_read_b128 a[208:211],v193 offset:4096
 ds_read_b128 a[212:215],v193 offset:5120
 s_add_u32 m0,s92,0x0
 v_add_f32 v199,v199,v60
 v_exp_f32 v63,v63
 N v[112:127],a[244:247],a[180:183],v[112:127]
 buffer_load_dwordx4 v243,s[36:39],s91 offen offset:0 sc1 lds
 v_cvt_pk_bf16_f32 v58,v60,v61
 v_add_f32 v199,v199,v61
 v_add_f32 v199,v199,v62
 v_cvt_pk_bf16_f32 v59,v62,v63
 N v[112:127],a[248:251],a[184:187],v[112:127]
 ds_read_b128 a[216:219],v193 offset:6144
 ds_read_b128 a[220:223],v193 offset:7168
 v_add_f32 v199,v199,v63
 N v[112:127],a[252:255],a[188:191],v[112:127]
 W 6
 buffer_load_dwordx4 v243,s[36:39],s91 offen offset:1024 sc1 lds
 v_cmp_lt_f32 vcc,s78,v199
 s_cbranch_vccz F_c6
 s_call_b64 s[82:83],F_XBB0
F_c6:
 v_add_f32 v198,v198,v199
 N a[64:79],a[192:195],v[0:3],a[64:79]
 ds_read_b128 a[224:227],v193 offset:8192
 ds_read_b128 a[228:231],v193 offset:9216
 s_add_u32 s75,s75,128
 v_exp_f32 v64,v64
 N a[80:95],a[196:199],v[0:3],a[80:95]
 W 6
 buffer_load_dwordx4 v243,s[36:39],s91 offen offset:2048 sc1 lds
 v_exp_f32 v65,v65
 v_exp_f32 v66,v66
 N a[96:111],a[200:203],v[0:3],a[96:111]
 ds_read_b128 a[232:235],v193 offset:10240
 ds_read_b128 a[236:239],v193 offset:11264
 v_add_f32 v199,v64,v65
 v_exp_f32 v67,v67
 v_cvt_pk_bf16_f32 v64,v64,v65
 N a[112:127],a[204:207],v[0:3],a[112:127]
 W 6
 buffer_load_dwordx4 v243,s[36:39],s91 offen offset:3072 sc1 lds
 v_exp_f32 v68,v68
 v_add_f32 v199,v199,v66
 N a[64:79],a[208:211],v[8:11],a[64:79]
 ds_read_b128 a[240:243],v193 offset:12288
 ds_read_b128 a[244:247],v193 offset:13312
 v_exp_f32 v69,v69
 v_cvt_pk_bf16_f32 v65,v66,v67
 v_add_f32 v199,v199,v67
 N a[80:95],a[212:215],v[8:11],a[80:95]
 W 6
 s_add_u32 m0,s92,0x4000
 s_add_u32 s69,s91,17408
 s_add_u32 s91,s91,34816
 s_xor_b32 s92,s92,0x8000
 buffer_load_dwordx4 v243,s[36:39],s69 offen offset:0 sc1 lds
 N a[96:111],a[216:219],v[8:11],a[96:111]
 ds_read_b128 a[248:251],v193 offset:14336
 ds_read_b128 a[252:255],v193 offset:15360
 v_exp_f32 v70,v70
 v_add_f32 v199,v199,v68
 N a[112:127],a[220:223],v[8:11],a[112:127]
 W 6
 buffer_load_dwordx4 v243,s[36:39],s69 offen offset:1024 sc1 lds
 v_exp_f32 v71,v71
 v_cvt_pk_bf16_f32 v66,v68,v69
 v_add_f32 v199,v199,v69
 N a[64:79],a[224:227],v[16:19],a[64:79]
 ds_read_b128 a[192:195],v193 offset:16384
 ds_read_b128 a[196:199],v193 offset:17408
 v_exp_f32 v72,v72
 v_add_f32 v199,v199,v70
 N a[80:95],a[228:231],v[16:19],a[80:95]
 W 6
 buffer_load_dwordx4 v243,s[36:39],s69 offen offset:2048 sc1 lds
 v_exp_f32 v73,v73
 v_cvt_pk_bf16_f32 v67,v70,v71
 v_add_f32 v199,v199,v71
 N a[96:111],a[232:235],v[16:19],a[96:111]
 ds_read_b128 a[200:203],v193 offset:18432
 ds_read_b128 a[204:207],v193 offset:19456
 v_exp_f32 v74,v74
 v_add_f32 v199,v199,v72
 N a[112:127],a[236:239],v[16:19],a[112:127]
 W 6
 buffer_load_dwordx4 v243,s[36:39],s69 offen offset:3072 sc1 lds
 v_exp_f32 v75,v75
 v_add_f32 v199,v199,v73
 v_cvt_pk_bf16_f32 v72,v72,v73
 N a[64:79],a[240:243],v[24:27],a[64:79]
 ds_read_b128 a[208:211],v193 offset:20480
 ds_read_b128 a[212:215],v193 offset:21504
 v_exp_f32 v76,v76
 v_add_f32 v199,v199,v74
 N a[80:95],a[244:247],v[24:27],a[80:95]
 W 6
 v_exp_f32 v77,v77
 v_cvt_pk_bf16_f32 v73,v74,v75
 v_add_f32 v199,v199,v75
 v_exp_f32 v78,v78
 N a[96:111],a[248:251],v[24:27],a[96:111]
 ds_read_b128 a[216:219],v193 offset:22528
 ds_read_b128 a[220:223],v193 offset:23552
 v_add_f32 v199,v199,v76
 v_exp_f32 v79,v79
 v_cvt_pk_bf16_f32 v74,v76,v77
 N a[112:127],a[252:255],v[24:27],a[112:127]
 W 6
 v_add_f32 v199,v199,v77
 v_add_f32 v199,v199,v78
 v_cvt_pk_bf16_f32 v75,v78,v79
 v_add_f32 v199,v199,v79
 v_exp_f32 v80,v80
 N a[64:79],a[192:195],v[32:35],a[64:79]
 ds_read_b128 a[224:227],v193 offset:24576
 ds_read_b128 a[228:231],v193 offset:25600
 v_exp_f32 v81,v81
 v_exp_f32 v82,v82
 N a[80:95],a[196:199],v[32:35],a[80:95]
 W 6
 v_add_f32 v199,v199,v80
 v_exp_f32 v83,v83
 v_add_f32 v199,v199,v81
 v_cvt_pk_bf16_f32 v80,v80,v81
 N a[96:111],a[200:203],v[32:35],a[96:111]
 ds_read_b128 a[232:235],v193 offset:26624
 ds_read_b128 a[236:239],v193 offset:27648
 v_exp_f32 v84,v84
 v_add_f32 v199,v199,v82
 N a[112:127],a[204:207],v[32:35],a[112:127]
 W 6
 v_exp_f32 v85,v85
 v_cvt_pk_bf16_f32 v81,v82,v83
 v_add_f32 v199,v199,v83
 v_exp_f32 v86,v86
 N a[64:79],a[208:211],v[40:43],a[64:79]
 ds_read_b128 a[240:243],v193 offset:28672
 ds_read_b128 a[244:247],v193 offset:29696
 v_add_f32 v199,v199,v84
 v_exp_f32 v87,v87
 v_cvt_pk_bf16_f32 v82,v84,v85
 N a[80:95],a[212:215],v[40:43],a[80:95]
 W 6
 v_add_f32 v199,v199,v85
 v_exp_f32 v88,v88
 v_add_f32 v199,v199,v86
 v_exp_f32 v89,v89
 N a[96:111],a[216:219],v[40:43],a[96:111]
 ds_read_b128 a[248:251],v193 offset:30720
 ds_read_b128 a[252:255],v193 offset:31744
 v_cvt_pk_bf16_f32 v83,v86,v87
 v_add_f32 v199,v199,v87
 v_exp_f32 v90,v90
 N a[112:127],a[220:223],v[40:43],a[112:127]
 W 6
 v_add_f32 v199,v199,v88
 v_exp_f32 v91,v91
 v_add_f32 v199,v199,v89
 v_cvt_pk_bf16_f32 v88,v88,v89
 N a[64:79],a[224:227],v[48:51],a[64:79]
 v_add_u32 v192,s76,v224
 s_add_u32 s76,s76,32768
 s_and_b32 s76,s76,0xffff
 v_exp_f32 v92,v92
 v_add_f32 v199,v199,v90
 N a[80:95],a[228:231],v[48:51],a[80:95]
 W 4
 s_waitcnt vmcnt(16) lgkmcnt(0)
 s_barrier
 v_exp_f32 v93,v93
 v_cvt_pk_bf16_f32 v89,v90,v91
 v_add_f32 v199,v199,v91
 N a[96:111],a[232:235],v[48:51],a[96:111]
 ds_read_b128 a[192:195],v192 offset:0
 ds_read_b128 a[196:199],v192 offset:1024
 v_exp_f32 v94,v94
 v_add_f32 v199,v199,v92
 N a[112:127],a[236:239],v[48:51],a[112:127]
 ds_read_b128 a[200:203],v192 offset:2048
 ds_read_b128 a[204:207],v192 offset:3072
 v_exp_f32 v95,v95
 v_cvt_pk_bf16_f32 v90,v92,v93
 N a[64:79],a[240:243],v[56:59],a[64:79]
 v_add_f32 v199,v199,v93
 v_add_f32 v199,v199,v94
 v_cvt_pk_bf16_f32 v91,v94,v95
 v_add_f32 v199,v199,v95
 N a[80:95],a[244:247],v[56:59],a[80:95]
 ds_read_b128 a[208:211],v192 offset:4096
 ds_read_b128 a[212:215],v192 offset:5120
 N a[96:111],a[248:251],v[56:59],a[96:111]
 N a[112:127],a[252:255],v[56:59],a[112:127]
 ds_read_b128 a[216:219],v192 offset:6144
 ds_read_b128 a[220:223],v192 offset:7168
 s_sub_u32 s74, s74, 1
 s_cbranch_scc1 F_BBm
 W 7
 N v[0:15],a[192:195],a[160:163],v[144:159]
 ds_read_b128 a[224:227],v192 offset:8192
 ds_read_b128 a[228:231],v192 offset:9216
 s_add_u32 m0,s94,0x10000
 v_exp_f32 v96,v96
 W 8
 N v[0:15],a[196:199],a[164:167],v[0:15]
 W 6
 buffer_load_dwordx4 v243,s[40:43],s93 offen offset:0 sc1 lds
 v_exp_f32 v97,v97
 v_exp_f32 v98,v98
 N v[0:15],a[200:203],a[168:171],v[0:15]
 ds_read_b128 a[232:235],v192 offset:10240
 ds_read_b128 a[236:239],v192 offset:11264
 v_add_f32 v199,v199,v96
 v_exp_f32 v99,v99
 v_add_f32 v199,v199,v97
 N v[0:15],a[204:207],a[172:175],v[0:15]
 W 6
 buffer_load_dwordx4 v243,s[40:43],s93 offen offset:1024 sc1 lds
 v_cvt_pk_bf16_f32 v96,v96,v97
 v_exp_f32 v100,v100
 v_add_f32 v199,v199,v98
 N v[0:15],a[208:211],a[176:179],v[0:15]
 ds_read_b128 a[240:243],v192 offset:12288
 ds_read_b128 a[244:247],v192 offset:13312
 v_exp_f32 v101,v101
 v_cvt_pk_bf16_f32 v97,v98,v99
 v_add_f32 v199,v199,v99
 N v[0:15],a[212:215],a[180:183],v[0:15]
 W 6
 buffer_load_dwordx4 v243,s[40:43],s93 offen offset:2048 sc1 lds
 v_exp_f32 v102,v102
 v_add_f32 v199,v199,v100
 N v[0:15],a[216:219],a[184:187],v[0:15]
 ds_read_b128 a[248:251],v192 offset:14336
 ds_read_b128 a[252:255],v192 offset:15360
 v_exp_f32 v103,v103
 v_cvt_pk_bf16_f32 v98,v100,v101
 v_add_f32 v199,v199,v101
 N v[0:15],a[220:223],a[188:191],v[0:15]
 W 6
 buffer_load_dwordx4 v243,s[40:43],s93 offen offset:3072 sc1 lds
 v_exp_f32 v104,v104
 v_add_f32 v199,v199,v102
 N v[16:31],a[224:227],a[160:163],v[144:159]
 ds_read_b128 a[192:195],v192 offset:16384
 ds_read_b128 a[196:199],v192 offset:17408
 v_exp_f32 v105,v105
 v_cvt_pk_bf16_f32 v99,v102,v103
 v_add_f32 v199,v199,v103
 N v[16:31],a[228:231],a[164:167],v[16:31]
 W 6
 s_add_u32 m0,s94,0x14000
 s_add_u32 s69,s93,17408
 s_add_u32 s93,s93,34816
 s_xor_b32 s94,s94,0x8000
 buffer_load_dwordx4 v243,s[40:43],s69 offen offset:0 sc1 lds
 N v[16:31],a[232:235],a[168:171],v[16:31]
 ds_read_b128 a[200:203],v192 offset:18432
 ds_read_b128 a[204:207],v192 offset:19456
 v_exp_f32 v106,v106
 v_add_f32 v199,v199,v104
 N v[16:31],a[236:239],a[172:175],v[16:31]
 W 6
 buffer_load_dwordx4 v243,s[40:43],s69 offen offset:1024 sc1 lds
 v_exp_f32 v107,v107
 v_add_f32 v199,v199,v105
 v_cvt_pk_bf16_f32 v104,v104,v105
 N v[16:31],a[240:243],a[176:179],v[16:31]
 ds_read_b128 a[208:211],v192 offset:20480
 ds_read_b128 a[212:215],v192 offset:21504
 v_exp_f32 v108,v108
 v_add_f32 v199,v199,v106
 N v[16:31],a[244:247],a[180:183],v[16:31]
 W 6
 buffer_load_dwordx4 v243,s[40:43],s69 offen offset:2048 sc1 lds
 v_exp_f32 v109,v109
 v_cvt_pk_bf16_f32 v105,v106,v107
 v_add_f32 v199,v199,v107
 N v[16:31],a[248:251],a[184:187],v[16:31]
 ds_read_b128 a[216:219],v192 offset:22528
 ds_read_b128 a[220:223],v192 offset:23552
 v_exp_f32 v110,v110
 v_add_f32 v199,v199,v108
 N v[16:31],a[252:255],a[188:191],v[16:31]
 W 6
 buffer_load_dwordx4 v243,s[40:43],s69 offen offset:3072 sc1 lds
 v_exp_f32 v111,v111
 v_cvt_pk_bf16_f32 v106,v108,v109
 v_add_f32 v199,v199,v109
 N v[32:47],a[192:195],a[160:163],v[144:159]
 ds_read_b128 a[224:227],v192 offset:24576
 ds_read_b128 a[228:231],v192 offset:25600
 v_add_f32 v199,v199,v110
 v_cvt_pk_bf16_f32 v107,v110,v111
 v_add_f32 v199,v199,v111
 N v[32:47],a[196:199],a[164:167],v[32:47]
 W 6
 v_exp_f32 v112,v112
 v_exp_f32 v113,v113
 v_exp_f32 v114,v114
 N v[32:47],a[200:203],a[168:171],v[32:47]
 ds_read_b128 a[232:235],v192 offset:26624
 ds_read_b128 a[236:239],v192 offset:27648
 v_add_f32 v199,v199,v112
 v_exp_f32 v115,v115
 v_add_f32 v199,v199,v113
 N v[32:47],a[204:207],a[172:175],v[32:47]
 W 6
 v_cvt_pk_bf16_f32 v112,v112,v113
 v_exp_f32 v116,v116
 v_add_f32 v199,v199,v114
 v_exp_f32 v117,v117
 N v[32:47],a[208:211],a[176:179],v[32:47]
 ds_read_b128 a[240:243],v192 offset:28672
 ds_read_b128 a[244:247],v192 offset:29696
 v_cvt_pk_bf16_f32 v113,v114,v115
 v_add_f32 v199,v199,v115
 v_exp_f32 v118,v118
 N v[32:47],a[212:215],a[180:183],v[32:47]
 W 6
 v_add_f32 v199,v199,v116
 v_exp_f32 v119,v119
 v_cvt_pk_bf16_f32 v114,v116,v117
 v_add_f32 v199,v199,v117
 N v[32:47],a[216:219],a[184:187],v[32:47]
 ds_read_b128 a[248:251],v192 offset:30720
 ds_read_b128 a[252:255],v192 offset:31744
 v_exp_f32 v120,v120
 v_add_f32 v199,v199,v118
 N v[32:47],a[220:223],a[188:191],v[32:47]
 W 6
 v_add_u32 v193,s77,v194
 s_add_u32 s77,s77,32768
 s_and_b32 s77,s77,0xffff
 v_exp_f32 v121,v121
 v_cvt_pk_bf16_f32 v115,v118,v119
 N v[48:63],a[224:227],a[160:163],v[144:159]
 v_add_f32 v199,v199,v119
 v_exp_f32 v122,v122
 v_add_f32 v199,v199,v120
 v_exp_f32 v123,v123
 N v[48:63],a[228:231],a[164:167],v[48:63]
 W 4
 s_waitcnt vmcnt(16) lgkmcnt(0)
 s_barrier
 v_add_f32 v199,v199,v121
 v_cvt_pk_bf16_f32 v120,v120,v121
 v_exp_f32 v124,v124
 N v[48:63],a[232:235],a[168:171],v[48:63]
 ds_read_b128 a[192:195],v193 offset:0
 ds_read_b128 a[196:199],v193 offset:1024
 v_add_f32 v199,v199,v122
 v_exp_f32 v125,v125
 v_cvt_pk_bf16_f32 v121,v122,v123
 N v[48:63],a[236:239],a[172:175],v[48:63]
 ds_read_b128 a[200:203],v193 offset:2048
 ds_read_b128 a[204:207],v193 offset:3072
 v_add_f32 v199,v199,v123
 v_exp_f32 v126,v126
 N v[48:63],a[240:243],a[176:179],v[48:63]
 ds_read_b128 a[208:211],v193 offset:4096
 ds_read_b128 a[212:215],v193 offset:5120
 s_add_u32 m0,s92,0x0
 v_add_f32 v199,v199,v124
 v_exp_f32 v127,v127
 N v[48:63],a[244:247],a[180:183],v[48:63]
 buffer_load_dwordx4 v243,s[36:39],s91 offen offset:0 sc1 lds
 v_cvt_pk_bf16_f32 v122,v124,v125
 v_add_f32 v199,v199,v125
 v_add_f32 v199,v199,v126
 v_cvt_pk_bf16_f32 v123,v126,v127
 N v[48:63],a[248:251],a[184:187],v[48:63]
 ds_read_b128 a[216:219],v193 offset:6144
 ds_read_b128 a[220:223],v193 offset:7168
 v_add_f32 v199,v199,v127
 N v[48:63],a[252:255],a[188:191],v[48:63]
 W 6
 buffer_load_dwordx4 v243,s[36:39],s91 offen offset:1024 sc1 lds
 v_cmp_lt_f32 vcc,s78,v199
 s_cbranch_vccz F_c7
 s_call_b64 s[82:83],F_XBB1
F_c7:
 v_add_f32 v198,v198,v199
 N a[64:79],a[192:195],v[64:67],a[64:79]
 ds_read_b128 a[224:227],v193 offset:8192
 ds_read_b128 a[228:231],v193 offset:9216
 s_add_u32 s75,s75,128
 v_exp_f32 v0,v0
 N a[80:95],a[196:199],v[64:67],a[80:95]
 W 6
 buffer_load_dwordx4 v243,s[36:39],s91 offen offset:2048 sc1 lds
 v_exp_f32 v1,v1
 v_exp_f32 v2,v2
 N a[96:111],a[200:203],v[64:67],a[96:111]
 ds_read_b128 a[232:235],v193 offset:10240
 ds_read_b128 a[236:239],v193 offset:11264
 v_add_f32 v199,v0,v1
 v_exp_f32 v3,v3
 v_cvt_pk_bf16_f32 v0,v0,v1
 N a[112:127],a[204:207],v[64:67],a[112:127]
 W 6
 buffer_load_dwordx4 v243,s[36:39],s91 offen offset:3072 sc1 lds
 v_exp_f32 v4,v4
 v_add_f32 v199,v199,v2
 N a[64:79],a[208:211],v[72:75],a[64:79]
 ds_read_b128 a[240:243],v193 offset:12288
 ds_read_b128 a[244:247],v193 offset:13312
 v_exp_f32 v5,v5
 v_cvt_pk_bf16_f32 v1,v2,v3
 v_add_f32 v199,v199,v3
 N a[80:95],a[212:215],v[72:75],a[80:95]
 W 6
 s_add_u32 m0,s92,0x4000
 s_add_u32 s69,s91,17408
 s_add_u32 s91,s91,34816
 s_xor_b32 s92,s92,0x8000
 buffer_load_dwordx4 v243,s[36:39],s69 offen offset:0 sc1 lds
 N a[96:111],a[216:219],v[72:75],a[96:111]
 ds_read_b128 a[248:251],v193 offset:14336
 ds_read_b128 a[252:255],v193 offset:15360
 v_exp_f32 v6,v6
 v_add_f32 v199,v199,v4
 N a[112:127],a[220:223],v[72:75],a[112:127]
 W 6
 buffer_load_dwordx4 v243,s[36:39],s69 offen offset:1024 sc1 lds
 v_exp_f32 v7,v7
 v_cvt_pk_bf16_f32 v2,v4,v5
 v_add_f32 v199,v199,v5
 N a[64:79],a[224:227],v[80:83],a[64:79]
 ds_read_b128 a[192:195],v193 offset:16384
 ds_read_b128 a[196:199],v193 offset:17408
 v_exp_f32 v8,v8
 v_add_f32 v199,v199,v6
 N a[80:95],a[228:231],v[80:83],a[80:95]
 W 6
 buffer_load_dwordx4 v243,s[36:39],s69 offen offset:2048 sc1 lds
 v_exp_f32 v9,v9
 v_cvt_pk_bf16_f32 v3,v6,v7
 v_add_f32 v199,v199,v7
 N a[96:111],a[232:235],v[80:83],a[96:111]
 ds_read_b128 a[200:203],v193 offset:18432
 ds_read_b128 a[204:207],v193 offset:19456
 v_exp_f32 v10,v10
 v_add_f32 v199,v199,v8
 N a[112:127],a[236:239],v[80:83],a[112:127]
 W 6
 buffer_load_dwordx4 v243,s[36:39],s69 offen offset:3072 sc1 lds
 v_exp_f32 v11,v11
 v_add_f32 v199,v199,v9
 v_cvt_pk_bf16_f32 v8,v8,v9
 N a[64:79],a[240:243],v[88:91],a[64:79]
 ds_read_b128 a[208:211],v193 offset:20480
 ds_read_b128 a[212:215],v193 offset:21504
 v_exp_f32 v12,v12
 v_add_f32 v199,v199,v10
 N a[80:95],a[244:247],v[88:91],a[80:95]
 W 6
 v_exp_f32 v13,v13
 v_cvt_pk_bf16_f32 v9,v10,v11
 v_add_f32 v199,v199,v11
 v_exp_f32 v14,v14
 N a[96:111],a[248:251],v[88:91],a[96:111]
 ds_read_b128 a[216:219],v193 offset:22528
 ds_read_b128 a[220:223],v193 offset:23552
 v_add_f32 v199,v199,v12
 v_exp_f32 v15,v15
 v_cvt_pk_bf16_f32 v10,v12,v13
 N a[112:127],a[252:255],v[88:91],a[112:127]
 W 6
 v_add_f32 v199,v199,v13
 v_add_f32 v199,v199,v14
 v_cvt_pk_bf16_f32 v11,v14,v15
 v_add_f32 v199,v199,v15
 v_exp_f32 v16,v16
 N a[64:79],a[192:195],v[96:99],a[64:79]
 ds_read_b128 a[224:227],v193 offset:24576
 ds_read_b128 a[228:231],v193 offset:25600
 v_exp_f32 v17,v17
 v_exp_f32 v18,v18
 N a[80:95],a[196:199],v[96:99],a[80:95]
 W 6
 v_add_f32 v199,v199,v16
 v_exp_f32 v19,v19
 v_add_f32 v199,v199,v17
 v_cvt_pk_bf16_f32 v16,v16,v17
 N a[96:111],a[200:203],v[96:99],a[96:111]
 ds_read_b128 a[232:235],v193 offset:26624
 ds_read_b128 a[236:239],v193 offset:27648
 v_exp_f32 v20,v20
 v_add_f32 v199,v199,v18
 N a[112:127],a[204:207],v[96:99],a[112:127]
 W 6
 v_exp_f32 v21,v21
 v_cvt_pk_bf16_f32 v17,v18,v19
 v_add_f32 v199,v199,v19
 v_exp_f32 v22,v22
 N a[64:79],a[208:211],v[104:107],a[64:79]
 ds_read_b128 a[240:243],v193 offset:28672
 ds_read_b128 a[244:247],v193 offset:29696
 v_add_f32 v199,v199,v20
 v_exp_f32 v23,v23
 v_cvt_pk_bf16_f32 v18,v20,v21
 N a[80:95],a[212:215],v[104:107],a[80:95]
 W 6
 v_add_f32 v199,v199,v21
 v_exp_f32 v24,v24
 v_add_f32 v199,v199,v22
 v_exp_f32 v25,v25
 N a[96:111],a[216:219],v[104:107],a[96:111]
 ds_read_b128 a[248:251],v193 offset:30720
 ds_read_b128 a[252:255],v193 offset:31744
 v_cvt_pk_bf16_f32 v19,v22,v23
 v_add_f32 v199,v199,v23
 v_exp_f32 v26,v26
 N a[112:127],a[220:223],v[104:107],a[112:127]
 W 6
 v_add_f32 v199,v199,v24
 v_exp_f32 v27,v27
 v_add_f32 v199,v199,v25
 v_cvt_pk_bf16_f32 v24,v24,v25
 N a[64:79],a[224:227],v[112:115],a[64:79]
 v_add_u32 v192,s76,v224
 s_add_u32 s76,s76,32768
 s_and_b32 s76,s76,0xffff
 v_exp_f32 v28,v28
 v_add_f32 v199,v199,v26
 N a[80:95],a[228:231],v[112:115],a[80:95]
 W 4
 s_waitcnt vmcnt(16) lgkmcnt(0)
 s_barrier
 v_exp_f32 v29,v29
 v_cvt_pk_bf16_f32 v25,v26,v27
 v_add_f32 v199,v199,v27
 N a[96:111],a[232:235],v[112:115],a[96:111]
 ds_read_b128 a[192:195],v192 offset:0
 ds_read_b128 a[196:199],v192 offset:1024
 v_exp_f32 v30,v30
 v_add_f32 v199,v199,v28
 N a[112:127],a[236:239],v[112:115],a[112:127]
 ds_read_b128 a[200:203],v192 offset:2048
 ds_read_b128 a[204:207],v192 offset:3072
 v_exp_f32 v31,v31
 v_cvt_pk_bf16_f32 v26,v28,v29
 N a[64:79],a[240:243],v[120:123],a[64:79]
 v_add_f32 v199,v199,v29
 v_add_f32 v199,v199,v30
 v_cvt_pk_bf16_f32 v27,v30,v31
 v_add_f32 v199,v199,v31
 N a[80:95],a[244:247],v[120:123],a[80:95]
 ds_read_b128 a[208:211],v192 offset:4096
 ds_read_b128 a[212:215],v192 offset:5120
 N a[96:111],a[248:251],v[120:123],a[96:111]
 N a[112:127],a[252:255],v[120:123],a[112:127]
 ds_read_b128 a[216:219],v192 offset:6144
 ds_read_b128 a[220:223],v192 offset:7168
 s_branch F_BBe
F_BBm:
 s_cmp_eq_u32 s64, 0
 s_cbranch_scc1 F_BBm0
 s_cmp_eq_u32 s64, 1
 s_cbranch_scc1 F_BBm1
 s_cmp_eq_u32 s64, 2
 s_cbranch_scc1 F_BBm2
 s_branch F_BBm3
F_BBm0:
 W 7
 N v[0:15],a[192:195],a[160:163],v[144:159]
 s_add_u32 m0,s94,0x10000
 v_exp_f32 v96,v96
 W 6
 N v[0:15],a[196:199],a[164:167],v[0:15]
 W 4
 buffer_load_dwordx4 v243,s[40:43],s93 offen offset:0 sc1 lds
 v_exp_f32 v97,v97
 v_exp_f32 v98,v98
 N v[0:15],a[200:203],a[168:171],v[0:15]
 global_load_dword v252,v250,s[6:7]
 v_add_f32 v199,v199,v96
 N v[0:15],a[204:207],a[172:175],v[0:15]
 W 2
 buffer_load_dwordx4 v243,s[40:43],s93 offen offset:1024 sc1 lds
 v_exp_f32 v99,v99
 v_add_f32 v199,v199,v97
 v_cvt_pk_bf16_f32 v96,v96,v97
 N v[0:15],a[208:211],a[176:179],v[0:15]
 global_load_dword v252,v251,s[6:7]
 v_exp_f32 v100,v100
 N v[0:15],a[212:215],a[180:183],v[0:15]
 W 0
 buffer_load_dwordx4 v243,s[40:43],s93 offen offset:2048 sc1 lds
 v_add_f32 v199,v199,v98
 v_exp_f32 v101,v101
 v_cvt_pk_bf16_f32 v97,v98,v99
 N v[0:15],a[216:219],a[184:187],v[0:15]
 v_add_f32 v199,v199,v99
 v_exp_f32 v102,v102
 v_add_f32 v199,v199,v100
 N v[0:15],a[220:223],a[188:191],v[0:15]
 buffer_load_dwordx4 v243,s[40:43],s93 offen offset:3072 sc1 lds
 v_exp_f32 v103,v103
 v_cvt_pk_bf16_f32 v98,v100,v101
 v_add_f32 v199,v199,v101
 v_exp_f32 v104,v104
 v_add_f32 v199,v199,v102
 s_add_u32 m0,s94,0x14000
 s_add_u32 s69,s93,17408
 s_add_u32 s93,s93,34816
 s_xor_b32 s94,s94,0x8000
 buffer_load_dwordx4 v243,s[40:43],s69 offen offset:0 sc1 lds
 v_exp_f32 v105,v105
 v_cvt_pk_bf16_f32 v99,v102,v103
 v_add_f32 v199,v199,v103
 buffer_load_dwordx4 v243,s[40:43],s69 offen offset:1024 sc1 lds
 v_exp_f32 v106,v106
 v_add_f32 v199,v199,v104
 v_exp_f32 v107,v107
 v_add_f32 v199,v199,v105
 v_cvt_pk_bf16_f32 v104,v104,v105
 buffer_load_dwordx4 v243,s[40:43],s69 offen offset:2048 sc1 lds
 v_exp_f32 v108,v108
 v_add_f32 v199,v199,v106
 v_exp_f32 v109,v109
 v_cvt_pk_bf16_f32 v105,v106,v107
 v_add_f32 v199,v199,v107
 buffer_load_dwordx4 v243,s[40:43],s69 offen offset:3072 sc1 lds
 v_exp_f32 v110,v110
 v_add_f32 v199,v199,v108
 v_exp_f32 v111,v111
 v_cvt_pk_bf16_f32 v106,v108,v109
 v_add_f32 v199,v199,v109
 v_add_f32 v199,v199,v110
 v_cvt_pk_bf16_f32 v107,v110,v111
 v_add_f32 v199,v199,v111
 v_exp_f32 v112,v112
 v_exp_f32 v113,v113
 v_exp_f32 v114,v114
 v_add_f32 v199,v199,v112
 v_exp_f32 v115,v115
 v_add_f32 v199,v199,v113
 v_cvt_pk_bf16_f32 v112,v112,v113
 v_exp_f32 v116,v116
 v_add_f32 v199,v199,v114
 v_exp_f32 v117,v117
 v_cvt_pk_bf16_f32 v113,v114,v115
 v_add_f32 v199,v199,v115
 v_exp_f32 v118,v118
 v_add_f32 v199,v199,v116
 v_exp_f32 v119,v119
 v_cvt_pk_bf16_f32 v114,v116,v117
 v_add_u32 v193,s77,v194
 s_add_u32 s77,s77,32768
 s_and_b32 s77,s77,0xffff
 v_add_f32 v199,v199,v117
 v_exp_f32 v120,v120
 v_add_f32 v199,v199,v118
 v_exp_f32 v121,v121
 v_cvt_pk_bf16_f32 v115,v118,v119
 v_add_f32 v199,v199,v119
 s_waitcnt vmcnt(16) lgkmcnt(0)
 s_barrier
 v_exp_f32 v122,v122
 v_add_f32 v199,v199,v120
 ds_read_b128 a[192:195],v193 offset:0
 ds_read_b128 a[196:199],v193 offset:1024
 v_exp_f32 v123,v123
 v_add_f32 v199,v199,v121
 v_cvt_pk_bf16_f32 v120,v120,v121
 ds_read_b128 a[200:203],v193 offset:2048
 ds_read_b128 a[204:207],v193 offset:3072
 v_exp_f32 v124,v124
 v_add_f32 v199,v199,v122
 ds_read_b128 a[208:211],v193 offset:4096
 ds_read_b128 a[212:215],v193 offset:5120
 v_exp_f32 v125,v125
 v_cvt_pk_bf16_f32 v121,v122,v123
 v_add_f32 v199,v199,v123
 v_exp_f32 v126,v126
 v_add_f32 v199,v199,v124
 v_exp_f32 v127,v127
 v_cvt_pk_bf16_f32 v122,v124,v125
 ds_read_b128 a[216:219],v193 offset:6144
 ds_read_b128 a[220:223],v193 offset:7168
 v_add_f32 v199,v199,v125
 v_add_f32 v199,v199,v126
 v_cvt_pk_bf16_f32 v123,v126,v127
 v_add_f32 v199,v199,v127
 W 6
 v_cmp_le_i32 s[84:85],0,v204
 v_cmp_le_i32 s[86:87],1,v204
 v_cmp_le_i32 s[88:89],2,v204
 v_cmp_le_i32 s[98:99],3,v204
 v_cndmask_b32 v0,v205,v0,s[84:85]
 v_cndmask_b32 v1,v205,v1,s[86:87]
 v_cndmask_b32 v2,v205,v2,s[88:89]
 v_cndmask_b32 v3,v205,v3,s[98:99]
 v_cmp_le_i32 s[84:85],8,v204
 v_cmp_le_i32 s[86:87],9,v204
 v_cmp_le_i32 s[88:89],10,v204
 v_cmp_le_i32 s[98:99],11,v204
 v_cndmask_b32 v4,v205,v4,s[84:85]
 v_cndmask_b32 v5,v205,v5,s[86:87]
 v_cndmask_b32 v6,v205,v6,s[88:89]
 v_cndmask_b32 v7,v205,v7,s[98:99]
 v_cmp_le_i32 s[84:85],16,v204
 v_cmp_le_i32 s[86:87],17,v204
 v_cmp_le_i32 s[88:89],18,v204
 v_cmp_le_i32 s[98:99],19,v204
 v_cndmask_b32 v8,v205,v8,s[84:85]
 v_cndmask_b32 v9,v205,v9,s[86:87]
 v_cndmask_b32 v10,v205,v10,s[88:89]
 v_cndmask_b32 v11,v205,v11,s[98:99]
 v_cmp_le_i32 s[84:85],24,v204
 v_cmp_le_i32 s[86:87],25,v204
 v_cmp_le_i32 s[88:89],26,v204
 v_cmp_le_i32 s[98:99],27,v204
 v_cndmask_b32 v12,v205,v12,s[84:85]
 v_cndmask_b32 v13,v205,v13,s[86:87]
 v_cndmask_b32 v14,v205,v14,s[88:89]
 v_cndmask_b32 v15,v205,v15,s[98:99]
 v_cmp_lt_f32 vcc,s78,v199
 s_cbranch_vccz F_c19
 s_call_b64 s[82:83],F_XBB1
F_c19:
 N a[64:79],a[192:195],v[64:67],a[64:79]
 ds_read_b128 a[224:227],v193 offset:8192
 ds_read_b128 a[228:231],v193 offset:9216
 v_add_f32 v198,v198,v199
 s_add_u32 s75,s75,128
 v_exp_f32 v0,v0
 N a[80:95],a[196:199],v[64:67],a[80:95]
 W 6
 v_exp_f32 v1,v1
 v_exp_f32 v2,v2
 v_add_f32 v199,v0,v1
 N a[96:111],a[200:203],v[64:67],a[96:111]
 ds_read_b128 a[232:235],v193 offset:10240
 ds_read_b128 a[236:239],v193 offset:11264
 v_exp_f32 v3,v3
 v_cvt_pk_bf16_f32 v0,v0,v1
 N a[112:127],a[204:207],v[64:67],a[112:127]
 W 6
 v_exp_f32 v4,v4
 v_add_f32 v199,v199,v2
 v_exp_f32 v5,v5
 v_cvt_pk_bf16_f32 v1,v2,v3
 N a[64:79],a[208:211],v[72:75],a[64:79]
 ds_read_b128 a[240:243],v193 offset:12288
 ds_read_b128 a[244:247],v193 offset:13312
 v_add_f32 v199,v199,v3
 v_exp_f32 v6,v6
 v_add_f32 v199,v199,v4
 N a[80:95],a[212:215],v[72:75],a[80:95]
 W 6
 v_exp_f32 v7,v7
 v_cvt_pk_bf16_f32 v2,v4,v5
 v_add_f32 v199,v199,v5
 v_exp_f32 v8,v8
 N a[96:111],a[216:219],v[72:75],a[96:111]
 ds_read_b128 a[248:251],v193 offset:14336
 ds_read_b128 a[252:255],v193 offset:15360
 v_add_f32 v199,v199,v6
 v_exp_f32 v9,v9
 v_cvt_pk_bf16_f32 v3,v6,v7
 N a[112:127],a[220:223],v[72:75],a[112:127]
 W 6
 v_add_f32 v199,v199,v7
 v_exp_f32 v10,v10
 v_add_f32 v199,v199,v8
 v_exp_f32 v11,v11
 N a[64:79],a[224:227],v[80:83],a[64:79]
 ds_read_b128 a[192:195],v193 offset:16384
 ds_read_b128 a[196:199],v193 offset:17408
 v_add_f32 v199,v199,v9
 v_cvt_pk_bf16_f32 v8,v8,v9
 v_exp_f32 v12,v12
 N a[80:95],a[228:231],v[80:83],a[80:95]
 W 6
 v_add_f32 v199,v199,v10
 v_exp_f32 v13,v13
 v_cvt_pk_bf16_f32 v9,v10,v11
 v_add_f32 v199,v199,v11
 N a[96:111],a[232:235],v[80:83],a[96:111]
 ds_read_b128 a[200:203],v193 offset:18432
 ds_read_b128 a[204:207],v193 offset:19456
 v_exp_f32 v14,v14
 v_add_f32 v199,v199,v12
 N a[112:127],a[236:239],v[80:83],a[112:127]
 W 6
 v_exp_f32 v15,v15
 v_cvt_pk_bf16_f32 v10,v12,v13
 v_add_f32 v199,v199,v13
 v_add_f32 v199,v199,v14
 v_cvt_pk_bf16_f32 v11,v14,v15
 N a[64:79],a[240:243],v[88:91],a[64:79]
 ds_read_b128 a[208:211],v193 offset:20480
 ds_read_b128 a[212:215],v193 offset:21504
 v_add_f32 v199,v199,v15
 v_mov_b32 v16,0
 v_mov_b32 v17,0
 v_mov_b32 v18,0
 N a[80:95],a[244:247],v[88:91],a[80:95]
 W 6
 v_mov_b32 v19,0
 v_mov_b32 v24,0
 v_mov_b32 v25,0
 v_mov_b32 v26,0
 v_mov_b32 v27,0
 v_mov_b32 v32,v205
 N a[96:111],a[248:251],v[88:91],a[96:111]
 ds_read_b128 a[216:219],v193 offset:22528
 ds_read_b128 a[220:223],v193 offset:23552
 v_mov_b32 v33,v205
 v_mov_b32 v34,v205
 v_mov_b32 v35,v205
 v_mov_b32 v36,v205
 N a[112:127],a[252:255],v[88:91],a[112:127]
 W 6
 v_mov_b32 v37,v205
 v_mov_b32 v38,v205
 v_mov_b32 v39,v205
 v_mov_b32 v40,v205
 v_mov_b32 v41,v205
 v_mov_b32 v42,v205
 N a[64:79],a[192:195],v[96:99],a[64:79]
 ds_read_b128 a[224:227],v193 offset:24576
 ds_read_b128 a[228:231],v193 offset:25600
 v_mov_b32 v43,v205
 v_mov_b32 v44,v205
 v_mov_b32 v45,v205
 v_mov_b32 v46,v205
 N a[80:95],a[196:199],v[96:99],a[80:95]
 W 6
 v_mov_b32 v47,v205
 v_mov_b32 v48,v205
 v_mov_b32 v49,v205
 v_mov_b32 v50,v205
 v_mov_b32 v51,v205
 v_mov_b32 v52,v205
 N a[96:111],a[200:203],v[96:99],a[96:111]
 ds_read_b128 a[232:235],v193 offset:26624
 ds_read_b128 a[236:239],v193 offset:27648
 v_mov_b32 v53,v205
 v_mov_b32 v54,v205
 v_mov_b32 v55,v205
 v_mov_b32 v56,v205
 N a[112:127],a[204:207],v[96:99],a[112:127]
 W 6
 v_mov_b32 v57,v205
 v_mov_b32 v58,v205
 v_mov_b32 v59,v205
 v_mov_b32 v60,v205
 v_mov_b32 v61,v205
 v_mov_b32 v62,v205
 N a[64:79],a[208:211],v[104:107],a[64:79]
 ds_read_b128 a[240:243],v193 offset:28672
 ds_read_b128 a[244:247],v193 offset:29696
 v_mov_b32 v63,v205
 N a[80:95],a[212:215],v[104:107],a[80:95]
 W 6
 N a[96:111],a[216:219],v[104:107],a[96:111]
 ds_read_b128 a[248:251],v193 offset:30720
 ds_read_b128 a[252:255],v193 offset:31744
 N a[112:127],a[220:223],v[104:107],a[112:127]
 W 6
 N a[64:79],a[224:227],v[112:115],a[64:79]
 v_add_u32 v192,s76,v224
 N a[80:95],a[228:231],v[112:115],a[80:95]
 W 4
 s_waitcnt vmcnt(0) lgkmcnt(0)
 s_barrier
 N a[96:111],a[232:235],v[112:115],a[96:111]
 ds_read_b128 a[192:195],v192 offset:0
 ds_read_b128 a[196:199],v192 offset:1024
 N a[112:127],a[236:239],v[112:115],a[112:127]
 ds_read_b128 a[200:203],v192 offset:2048
 ds_read_b128 a[204:207],v192 offset:3072
 N a[64:79],a[240:243],v[120:123],a[64:79]
 N a[80:95],a[244:247],v[120:123],a[80:95]
 ds_read_b128 a[208:211],v192 offset:4096
 ds_read_b128 a[212:215],v192 offset:5120
 N a[96:111],a[248:251],v[120:123],a[96:111]
 N a[112:127],a[252:255],v[120:123],a[112:127]
 ds_read_b128 a[216:219],v192 offset:6144
 ds_read_b128 a[220:223],v192 offset:7168
 s_branch F_Bend
F_BBm1:
 W 7
 N v[0:15],a[192:195],a[160:163],v[144:159]
 ds_read_b128 a[224:227],v192 offset:8192
 ds_read_b128 a[228:231],v192 offset:9216
 s_add_u32 m0,s94,0x10000
 v_exp_f32 v96,v96
 W 8
 N v[0:15],a[196:199],a[164:167],v[0:15]
 W 6
 buffer_load_dwordx4 v243,s[40:43],s93 offen offset:0 sc1 lds
 v_exp_f32 v97,v97
 v_exp_f32 v98,v98
 N v[0:15],a[200:203],a[168:171],v[0:15]
 ds_read_b128 a[232:235],v192 offset:10240
 ds_read_b128 a[236:239],v192 offset:11264
 global_load_dword v252,v250,s[6:7]
 v_add_f32 v199,v199,v96
 N v[0:15],a[204:207],a[172:175],v[0:15]
 W 6
 buffer_load_dwordx4 v243,s[40:43],s93 offen offset:1024 sc1 lds
 v_exp_f32 v99,v99
 v_add_f32 v199,v199,v97
 v_cvt_pk_bf16_f32 v96,v96,v97
 N v[0:15],a[208:211],a[176:179],v[0:15]
 ds_read_b128 a[240:243],v192 offset:12288
 ds_read_b128 a[244:247],v192 offset:13312
 global_load_dword v252,v251,s[6:7]
 v_exp_f32 v100,v100
 N v[0:15],a[212:215],a[180:183],v[0:15]
 W 6
 buffer_load_dwordx4 v243,s[40:43],s93 offen offset:2048 sc1 lds
 v_add_f32 v199,v199,v98
 v_exp_f32 v101,v101
 v_cvt_pk_bf16_f32 v97,v98,v99
 N v[0:15],a[216:219],a[184:187],v[0:15]
 ds_read_b128 a[248:251],v192 offset:14336
 ds_read_b128 a[252:255],v192 offset:15360
 v_add_f32 v199,v199,v99
 v_exp_f32 v102,v102
 v_add_f32 v199,v199,v100
 N v[0:15],a[220:223],a[188:191],v[0:15]
 W 6
 buffer_load_dwordx4 v243,s[40:43],s93 offen offset:3072 sc1 lds
 v_exp_f32 v103,v103
 v_cvt_pk_bf16_f32 v98,v100,v101
 v_add_f32 v199,v199,v101
 N v[16:31],a[224:227],a[160:163],v[144:159]
 v_exp_f32 v104,v104
 v_add_f32 v199,v199,v102
 N v[16:31],a[228:231],a[164:167],v[16:31]
 W 4
 s_add_u32 m0,s94,0x14000
 s_add_u32 s69,s93,17408
 s_add_u32 s93,s93,34816
 s_xor_b32 s94,s94,0x8000
 buffer_load_dwordx4 v243,s[40:43],s69 offen offset:0 sc1 lds
 N v[16:31],a[232:235],a[168:171],v[16:31]
 v_exp_f32 v105,v105
 v_cvt_pk_bf16_f32 v99,v102,v103
 v_add_f32 v199,v199,v103
 N v[16:31],a[236:239],a[172:175],v[16:31]
 W 2
 buffer_load_dwordx4 v243,s[40:43],s69 offen offset:1024 sc1 lds
 v_exp_f32 v106,v106
 v_add_f32 v199,v199,v104
 N v[16:31],a[240:243],a[176:179],v[16:31]
 v_exp_f32 v107,v107
 v_add_f32 v199,v199,v105
 v_cvt_pk_bf16_f32 v104,v104,v105
 N v[16:31],a[244:247],a[180:183],v[16:31]
 W 0
 buffer_load_dwordx4 v243,s[40:43],s69 offen offset:2048 sc1 lds
 v_exp_f32 v108,v108
 v_add_f32 v199,v199,v106
 N v[16:31],a[248:251],a[184:187],v[16:31]
 v_exp_f32 v109,v109
 v_cvt_pk_bf16_f32 v105,v106,v107
 v_add_f32 v199,v199,v107
 N v[16:31],a[252:255],a[188:191],v[16:31]
 buffer_load_dwordx4 v243,s[40:43],s69 offen offset:3072 sc1 lds
 v_exp_f32 v110,v110
 v_add_f32 v199,v199,v108
 v_exp_f32 v111,v111
 v_cvt_pk_bf16_f32 v106,v108,v109
 v_add_f32 v199,v199,v109
 v_add_f32 v199,v199,v110
 v_cvt_pk_bf16_f32 v107,v110,v111
 v_add_f32 v199,v199,v111
 v_exp_f32 v112,v112
 v_exp_f32 v113,v113
 v_exp_f32 v114,v114
 v_add_f32 v199,v199,v112
 v_exp_f32 v115,v115
 v_add_f32 v199,v199,v113
 v_cvt_pk_bf16_f32 v112,v112,v113
 v_exp_f32 v116,v116
 v_add_f32 v199,v199,v114
 v_exp_f32 v117,v117
 v_cvt_pk_bf16_f32 v113,v114,v115
 v_add_f32 v199,v199,v115
 v_exp_f32 v118,v118
 v_add_f32 v199,v199,v116
 v_exp_f32 v119,v119
 v_cvt_pk_bf16_f32 v114,v116,v117
 v_add_u32 v193,s77,v194
 s_add_u32 s77,s77,32768
 s_and_b32 s77,s77,0xffff
 v_add_f32 v199,v199,v117
 v_exp_f32 v120,v120
 v_add_f32 v199,v199,v118
 v_exp_f32 v121,v121
 v_cvt_pk_bf16_f32 v115,v118,v119
 v_add_f32 v199,v199,v119
 s_waitcnt vmcnt(16) lgkmcnt(0)
 s_barrier
 v_exp_f32 v122,v122
 v_add_f32 v199,v199,v120
 ds_read_b128 a[192:195],v193 offset:0
 ds_read_b128 a[196:199],v193 offset:1024
 v_exp_f32 v123,v123
 v_add_f32 v199,v199,v121
 v_cvt_pk_bf16_f32 v120,v120,v121
 ds_read_b128 a[200:203],v193 offset:2048
 ds_read_b128 a[204:207],v193 offset:3072
 v_exp_f32 v124,v124
 v_add_f32 v199,v199,v122
 ds_read_b128 a[208:211],v193 offset:4096
 ds_read_b128 a[212:215],v193 offset:5120
 v_exp_f32 v125,v125
 v_cvt_pk_bf16_f32 v121,v122,v123
 v_add_f32 v199,v199,v123
 v_exp_f32 v126,v126
 v_add_f32 v199,v199,v124
 v_exp_f32 v127,v127
 v_cvt_pk_bf16_f32 v122,v124,v125
 ds_read_b128 a[216:219],v193 offset:6144
 ds_read_b128 a[220:223],v193 offset:7168
 v_add_f32 v199,v199,v125
 v_add_f32 v199,v199,v126
 v_cvt_pk_bf16_f32 v123,v126,v127
 v_add_f32 v199,v199,v127
 W 6
 v_subrev_u32 v206,32,v204
 v_cmp_le_i32 s[84:85],0,v206
 v_cmp_le_i32 s[86:87],1,v206
 v_cmp_le_i32 s[88:89],2,v206
 v_cmp_le_i32 s[98:99],3,v206
 v_cndmask_b32 v16,v205,v16,s[84:85]
 v_cndmask_b32 v17,v205,v17,s[86:87]
 v_cndmask_b32 v18,v205,v18,s[88:89]
 v_cndmask_b32 v19,v205,v19,s[98:99]
 v_cmp_le_i32 s[84:85],8,v206
 v_cmp_le_i32 s[86:87],9,v206
 v_cmp_le_i32 s[88:89],10,v206
 v_cmp_le_i32 s[98:99],11,v206
 v_cndmask_b32 v20,v205,v20,s[84:85]
 v_cndmask_b32 v21,v205,v21,s[86:87]
 v_cndmask_b32 v22,v205,v22,s[88:89]
 v_cndmask_b32 v23,v205,v23,s[98:99]
 v_cmp_le_i32 s[84:85],16,v206
 v_cmp_le_i32 s[86:87],17,v206
 v_cmp_le_i32 s[88:89],18,v206
 v_cmp_le_i32 s[98:99],19,v206
 v_cndmask_b32 v24,v205,v24,s[84:85]
 v_cndmask_b32 v25,v205,v25,s[86:87]
 v_cndmask_b32 v26,v205,v26,s[88:89]
 v_cndmask_b32 v27,v205,v27,s[98:99]
 v_cmp_le_i32 s[84:85],24,v206
 v_cmp_le_i32 s[86:87],25,v206
 v_cmp_le_i32 s[88:89],26,v206
 v_cmp_le_i32 s[98:99],27,v206
 v_cndmask_b32 v28,v205,v28,s[84:85]
 v_cndmask_b32 v29,v205,v29,s[86:87]
 v_cndmask_b32 v30,v205,v30,s[88:89]
 v_cndmask_b32 v31,v205,v31,s[98:99]
 v_cmp_lt_f32 vcc,s78,v199
 s_cbranch_vccz F_c24
 s_call_b64 s[82:83],F_XBB1
F_c24:
 N a[64:79],a[192:195],v[64:67],a[64:79]
 ds_read_b128 a[224:227],v193 offset:8192
 ds_read_b128 a[228:231],v193 offset:9216
 v_add_f32 v198,v198,v199
 s_add_u32 s75,s75,128
 v_exp_f32 v0,v0
 N a[80:95],a[196:199],v[64:67],a[80:95]
 W 6
 v_exp_f32 v1,v1
 v_exp_f32 v2,v2
 v_add_f32 v199,v0,v1
 N a[96:111],a[200:203],v[64:67],a[96:111]
 ds_read_b128 a[232:235],v193 offset:10240
 ds_read_b128 a[236:239],v193 offset:11264
 v_exp_f32 v3,v3
 v_cvt_pk_bf16_f32 v0,v0,v1
 N a[112:127],a[204:207],v[64:67],a[112:127]
 W 6
 v_exp_f32 v4,v4
 v_add_f32 v199,v199,v2
 v_exp_f32 v5,v5
 v_cvt_pk_bf16_f32 v1,v2,v3
 N a[64:79],a[208:211],v[72:75],a[64:79]
 ds_read_b128 a[240:243],v193 offset:12288
 ds_read_b128 a[244:247],v193 offset:13312
 v_add_f32 v199,v199,v3
 v_exp_f32 v6,v6
 v_add_f32 v199,v199,v4
 N a[80:95],a[212:215],v[72:75],a[80:95]
 W 6
 v_exp_f32 v7,v7
 v_cvt_pk_bf16_f32 v2,v4,v5
 v_add_f32 v199,v199,v5
 v_exp_f32 v8,v8
 N a[96:111],a[216:219],v[72:75],a[96:111]
 ds_read_b128 a[248:251],v193 offset:14336
 ds_read_b128 a[252:255],v193 offset:15360
 v_add_f32 v199,v199,v6
 v_exp_f32 v9,v9
 v_cvt_pk_bf16_f32 v3,v6,v7
 N a[112:127],a[220:223],v[72:75],a[112:127]
 W 6
 v_add_f32 v199,v199,v7
 v_exp_f32 v10,v10
 v_add_f32 v199,v199,v8
 v_exp_f32 v11,v11
 N a[64:79],a[224:227],v[80:83],a[64:79]
 ds_read_b128 a[192:195],v193 offset:16384
 ds_read_b128 a[196:199],v193 offset:17408
 v_add_f32 v199,v199,v9
 v_cvt_pk_bf16_f32 v8,v8,v9
 v_exp_f32 v12,v12
 N a[80:95],a[228:231],v[80:83],a[80:95]
 W 6
 v_add_f32 v199,v199,v10
 v_exp_f32 v13,v13
 v_cvt_pk_bf16_f32 v9,v10,v11
 v_add_f32 v199,v199,v11
 N a[96:111],a[232:235],v[80:83],a[96:111]
 ds_read_b128 a[200:203],v193 offset:18432
 ds_read_b128 a[204:207],v193 offset:19456
 v_exp_f32 v14,v14
 v_add_f32 v199,v199,v12
 N a[112:127],a[236:239],v[80:83],a[112:127]
 W 6
 v_exp_f32 v15,v15
 v_cvt_pk_bf16_f32 v10,v12,v13
 v_add_f32 v199,v199,v13
 v_add_f32 v199,v199,v14
 v_cvt_pk_bf16_f32 v11,v14,v15
 N a[64:79],a[240:243],v[88:91],a[64:79]
 ds_read_b128 a[208:211],v193 offset:20480
 ds_read_b128 a[212:215],v193 offset:21504
 v_add_f32 v199,v199,v15
 v_exp_f32 v16,v16
 N a[80:95],a[244:247],v[88:91],a[80:95]
 W 6
 v_exp_f32 v17,v17
 v_exp_f32 v18,v18
 v_add_f32 v199,v199,v16
 N a[96:111],a[248:251],v[88:91],a[96:111]
 ds_read_b128 a[216:219],v193 offset:22528
 ds_read_b128 a[220:223],v193 offset:23552
 v_exp_f32 v19,v19
 v_add_f32 v199,v199,v17
 v_cvt_pk_bf16_f32 v16,v16,v17
 N a[112:127],a[252:255],v[88:91],a[112:127]
 W 6
 v_exp_f32 v20,v20
 v_add_f32 v199,v199,v18
 v_exp_f32 v21,v21
 v_cvt_pk_bf16_f32 v17,v18,v19
 N a[64:79],a[192:195],v[96:99],a[64:79]
 ds_read_b128 a[224:227],v193 offset:24576
 ds_read_b128 a[228:231],v193 offset:25600
 v_add_f32 v199,v199,v19
 v_exp_f32 v22,v22
 v_add_f32 v199,v199,v20
 N a[80:95],a[196:199],v[96:99],a[80:95]
 W 6
 v_exp_f32 v23,v23
 v_cvt_pk_bf16_f32 v18,v20,v21
 v_add_f32 v199,v199,v21
 v_exp_f32 v24,v24
 N a[96:111],a[200:203],v[96:99],a[96:111]
 ds_read_b128 a[232:235],v193 offset:26624
 ds_read_b128 a[236:239],v193 offset:27648
 v_add_f32 v199,v199,v22
 v_exp_f32 v25,v25
 v_cvt_pk_bf16_f32 v19,v22,v23
 N a[112:127],a[204:207],v[96:99],a[112:127]
 W 6
 v_add_f32 v199,v199,v23
 v_exp_f32 v26,v26
 v_add_f32 v199,v199,v24
 v_exp_f32 v27,v27
 N a[64:79],a[208:211],v[104:107],a[64:79]
 ds_read_b128 a[240:243],v193 offset:28672
 ds_read_b128 a[244:247],v193 offset:29696
 v_add_f32 v199,v199,v25
 v_cvt_pk_bf16_f32 v24,v24,v25
 v_exp_f32 v28,v28
 N a[80:95],a[212:215],v[104:107],a[80:95]
 W 6
 v_add_f32 v199,v199,v26
 v_exp_f32 v29,v29
 v_cvt_pk_bf16_f32 v25,v26,v27
 v_add_f32 v199,v199,v27
 N a[96:111],a[216:219],v[104:107],a[96:111]
 ds_read_b128 a[248:251],v193 offset:30720
 ds_read_b128 a[252:255],v193 offset:31744
 v_exp_f32 v30,v30
 v_add_f32 v199,v199,v28
 N a[112:127],a[220:223],v[104:107],a[112:127]
 W 6
 v_exp_f32 v31,v31
 v_cvt_pk_bf16_f32 v26,v28,v29
 v_add_f32 v199,v199,v29
 v_add_f32 v199,v199,v30
 v_cvt_pk_bf16_f32 v27,v30,v31
 N a[64:79],a[224:227],v[112:115],a[64:79]
 v_add_u32 v192,s76,v224
 v_add_f32 v199,v199,v31
 v_mov_b32 v32,v205
 v_mov_b32 v33,v205
 v_mov_b32 v34,v205
 v_mov_b32 v35,v205
 v_mov_b32 v36,v205
 N a[80:95],a[228:231],v[112:115],a[80:95]
 W 4
 s_waitcnt vmcnt(0) lgkmcnt(0)
 s_barrier
 v_mov_b32 v37,v205
 v_mov_b32 v38,v205
 v_mov_b32 v39,v205
 v_mov_b32 v40,v205
 N a[96:111],a[232:235],v[112:115],a[96:111]
 ds_read_b128 a[192:195],v192 offset:0
 ds_read_b128 a[196:199],v192 offset:1024
 v_mov_b32 v41,v205
 v_mov_b32 v42,v205
 v_mov_b32 v43,v205
 v_mov_b32 v44,v205
 N a[112:127],a[236:239],v[112:115],a[112:127]
 ds_read_b128 a[200:203],v192 offset:2048
 ds_read_b128 a[204:207],v192 offset:3072
 v_mov_b32 v45,v205
 v_mov_b32 v46,v205
 v_mov_b32 v47,v205
 N a[64:79],a[240:243],v[120:123],a[64:79]
 v_mov_b32 v48,v205
 v_mov_b32 v49,v205
 v_mov_b32 v50,v205
 v_mov_b32 v51,v205
 v_mov_b32 v52,v205
 v_mov_b32 v53,v205
 N a[80:95],a[244:247],v[120:123],a[80:95]
 ds_read_b128 a[208:211],v192 offset:4096
 ds_read_b128 a[212:215],v192 offset:5120
 v_mov_b32 v54,v205
 v_mov_b32 v55,v205
 v_mov_b32 v56,v205
 N a[96:111],a[248:251],v[120:123],a[96:111]
 v_mov_b32 v57,v205
 v_mov_b32 v58,v205
 v_mov_b32 v59,v205
 v_mov_b32 v60,v205
 v_mov_b32 v61,v205
 v_mov_b32 v62,v205
 N a[112:127],a[252:255],v[120:123],a[112:127]
 ds_read_b128 a[216:219],v192 offset:6144
 ds_read_b128 a[220:223],v192 offset:7168
 v_mov_b32 v63,v205
 s_branch F_Bend
F_BBm2:
 W 7
 N v[0:15],a[192:195],a[160:163],v[144:159]
 ds_read_b128 a[224:227],v192 offset:8192
 ds_read_b128 a[228:231],v192 offset:9216
 s_add_u32 m0,s94,0x10000
 v_exp_f32 v96,v96
 W 8
 N v[0:15],a[196:199],a[164:167],v[0:15]
 W 6
 buffer_load_dwordx4 v243,s[40:43],s93 offen offset:0 sc1 lds
 v_exp_f32 v97,v97
 v_exp_f32 v98,v98
 N v[0:15],a[200:203],a[168:171],v[0:15]
 ds_read_b128 a[232:235],v192 offset:10240
 ds_read_b128 a[236:239],v192 offset:11264
 global_load_dword v252,v250,s[6:7]
 v_add_f32 v199,v199,v96
 N v[0:15],a[204:207],a[172:175],v[0:15]
 W 6
 buffer_load_dwordx4 v243,s[40:43],s93 offen offset:1024 sc1 lds
 v_exp_f32 v99,v99
 v_add_f32 v199,v199,v97
 v_cvt_pk_bf16_f32 v96,v96,v97
 N v[0:15],a[208:211],a[176:179],v[0:15]
 ds_read_b128 a[240:243],v192 offset:12288
 ds_read_b128 a[244:247],v192 offset:13312
 global_load_dword v252,v251,s[6:7]
 v_exp_f32 v100,v100
 N v[0:15],a[212:215],a[180:183],v[0:15]
 W 6
 buffer_load_dwordx4 v243,s[40:43],s93 offen offset:2048 sc1 lds
 v_add_f32 v199,v199,v98
 v_exp_f32 v101,v101
 v_cvt_pk_bf16_f32 v97,v98,v99
 N v[0:15],a[216:219],a[184:187],v[0:15]
 ds_read_b128 a[248:251],v192 offset:14336
 ds_read_b128 a[252:255],v192 offset:15360
 v_add_f32 v199,v199,v99
 v_exp_f32 v102,v102
 v_add_f32 v199,v199,v100
 N v[0:15],a[220:223],a[188:191],v[0:15]
 W 6
 buffer_load_dwordx4 v243,s[40:43],s93 offen offset:3072 sc1 lds
 v_exp_f32 v103,v103
 v_cvt_pk_bf16_f32 v98,v100,v101
 v_add_f32 v199,v199,v101
 N v[16:31],a[224:227],a[160:163],v[144:159]
 ds_read_b128 a[192:195],v192 offset:16384
 ds_read_b128 a[196:199],v192 offset:17408
 v_exp_f32 v104,v104
 v_add_f32 v199,v199,v102
 N v[16:31],a[228:231],a[164:167],v[16:31]
 W 6
 s_add_u32 m0,s94,0x14000
 s_add_u32 s69,s93,17408
 s_add_u32 s93,s93,34816
 s_xor_b32 s94,s94,0x8000
 buffer_load_dwordx4 v243,s[40:43],s69 offen offset:0 sc1 lds
 N v[16:31],a[232:235],a[168:171],v[16:31]
 ds_read_b128 a[200:203],v192 offset:18432
 ds_read_b128 a[204:207],v192 offset:19456
 v_exp_f32 v105,v105
 v_cvt_pk_bf16_f32 v99,v102,v103
 v_add_f32 v199,v199,v103
 N v[16:31],a[236:239],a[172:175],v[16:31]
 W 6
 buffer_load_dwordx4 v243,s[40:43],s69 offen offset:1024 sc1 lds
 v_exp_f32 v106,v106
 v_add_f32 v199,v199,v104
 N v[16:31],a[240:243],a[176:179],v[16:31]
 ds_read_b128 a[208:211],v192 offset:20480
 ds_read_b128 a[212:215],v192 offset:21504
 v_exp_f32 v107,v107
 v_add_f32 v199,v199,v105
 v_cvt_pk_bf16_f32 v104,v104,v105
 N v[16:31],a[244:247],a[180:183],v[16:31]
 W 6
 buffer_load_dwordx4 v243,s[40:43],s69 offen offset:2048 sc1 lds
 v_exp_f32 v108,v108
 v_add_f32 v199,v199,v106
 N v[16:31],a[248:251],a[184:187],v[16:31]
 ds_read_b128 a[216:219],v192 offset:22528
 ds_read_b128 a[220:223],v192 offset:23552
 v_exp_f32 v109,v109
 v_cvt_pk_bf16_f32 v105,v106,v107
 v_add_f32 v199,v199,v107
 N v[16:31],a[252:255],a[188:191],v[16:31]
 W 6
 buffer_load_dwordx4 v243,s[40:43],s69 offen offset:3072 sc1 lds
 v_exp_f32 v110,v110
 v_add_f32 v199,v199,v108
 N v[32:47],a[192:195],a[160:163],v[144:159]
 v_exp_f32 v111,v111
 v_cvt_pk_bf16_f32 v106,v108,v109
 v_add_f32 v199,v199,v109
 N v[32:47],a[196:199],a[164:167],v[32:47]
 W 4
 v_add_f32 v199,v199,v110
 v_cvt_pk_bf16_f32 v107,v110,v111
 v_add_f32 v199,v199,v111
 v_exp_f32 v112,v112
 N v[32:47],a[200:203],a[168:171],v[32:47]
 v_exp_f32 v113,v113
 v_exp_f32 v114,v114
 N v[32:47],a[204:207],a[172:175],v[32:47]
 W 2
 v_add_f32 v199,v199,v112
 v_exp_f32 v115,v115
 v_add_f32 v199,v199,v113
 v_cvt_pk_bf16_f32 v112,v112,v113
 N v[32:47],a[208:211],a[176:179],v[32:47]
 v_exp_f32 v116,v116
 v_add_f32 v199,v199,v114
 N v[32:47],a[212:215],a[180:183],v[32:47]
 W 0
 v_exp_f32 v117,v117
 v_cvt_pk_bf16_f32 v113,v114,v115
 v_add_f32 v199,v199,v115
 v_exp_f32 v118,v118
 N v[32:47],a[216:219],a[184:187],v[32:47]
 v_add_f32 v199,v199,v116
 v_exp_f32 v119,v119
 v_cvt_pk_bf16_f32 v114,v116,v117
 N v[32:47],a[220:223],a[188:191],v[32:47]
 v_add_u32 v193,s77,v194
 s_add_u32 s77,s77,32768
 s_and_b32 s77,s77,0xffff
 v_add_f32 v199,v199,v117
 v_exp_f32 v120,v120
 v_add_f32 v199,v199,v118
 v_exp_f32 v121,v121
 v_cvt_pk_bf16_f32 v115,v118,v119
 v_add_f32 v199,v199,v119
 s_waitcnt vmcnt(16) lgkmcnt(0)
 s_barrier
 v_exp_f32 v122,v122
 v_add_f32 v199,v199,v120
 ds_read_b128 a[192:195],v193 offset:0
 ds_read_b128 a[196:199],v193 offset:1024
 v_exp_f32 v123,v123
 v_add_f32 v199,v199,v121
 v_cvt_pk_bf16_f32 v120,v120,v121
 ds_read_b128 a[200:203],v193 offset:2048
 ds_read_b128 a[204:207],v193 offset:3072
 v_exp_f32 v124,v124
 v_add_f32 v199,v199,v122
 ds_read_b128 a[208:211],v193 offset:4096
 ds_read_b128 a[212:215],v193 offset:5120
 v_exp_f32 v125,v125
 v_cvt_pk_bf16_f32 v121,v122,v123
 v_add_f32 v199,v199,v123
 v_exp_f32 v126,v126
 v_add_f32 v199,v199,v124
 v_exp_f32 v127,v127
 v_cvt_pk_bf16_f32 v122,v124,v125
 ds_read_b128 a[216:219],v193 offset:6144
 ds_read_b128 a[220:223],v193 offset:7168
 v_add_f32 v199,v199,v125
 v_add_f32 v199,v199,v126
 v_cvt_pk_bf16_f32 v123,v126,v127
 v_add_f32 v199,v199,v127
 W 6
 v_cmp_lt_f32 vcc,s78,v199
 s_cbranch_vccz F_c29
 s_call_b64 s[82:83],F_XBB1
F_c29:
 v_add_f32 v198,v198,v199
 s_add_u32 s75,s75,128
 N a[64:79],a[192:195],v[64:67],a[64:79]
 ds_read_b128 a[224:227],v193 offset:8192
 ds_read_b128 a[228:231],v193 offset:9216
 v_exp_f32 v0,v0
 v_exp_f32 v1,v1
 N a[80:95],a[196:199],v[64:67],a[80:95]
 W 6
 v_exp_f32 v2,v2
 v_add_f32 v199,v0,v1
 v_exp_f32 v3,v3
 v_cvt_pk_bf16_f32 v0,v0,v1
 N a[96:111],a[200:203],v[64:67],a[96:111]
 ds_read_b128 a[232:235],v193 offset:10240
 ds_read_b128 a[236:239],v193 offset:11264
 v_exp_f32 v4,v4
 v_add_f32 v199,v199,v2
 N a[112:127],a[204:207],v[64:67],a[112:127]
 W 6
 v_exp_f32 v5,v5
 v_cvt_pk_bf16_f32 v1,v2,v3
 v_add_f32 v199,v199,v3
 v_exp_f32 v6,v6
 N a[64:79],a[208:211],v[72:75],a[64:79]
 ds_read_b128 a[240:243],v193 offset:12288
 ds_read_b128 a[244:247],v193 offset:13312
 v_add_f32 v199,v199,v4
 v_exp_f32 v7,v7
 v_cvt_pk_bf16_f32 v2,v4,v5
 N a[80:95],a[212:215],v[72:75],a[80:95]
 W 6
 v_add_f32 v199,v199,v5
 v_exp_f32 v8,v8
 v_add_f32 v199,v199,v6
 v_exp_f32 v9,v9
 N a[96:111],a[216:219],v[72:75],a[96:111]
 ds_read_b128 a[248:251],v193 offset:14336
 ds_read_b128 a[252:255],v193 offset:15360
 v_cvt_pk_bf16_f32 v3,v6,v7
 v_add_f32 v199,v199,v7
 v_exp_f32 v10,v10
 N a[112:127],a[220:223],v[72:75],a[112:127]
 W 6
 v_add_f32 v199,v199,v8
 v_exp_f32 v11,v11
 v_add_f32 v199,v199,v9
 v_cvt_pk_bf16_f32 v8,v8,v9
 N a[64:79],a[224:227],v[80:83],a[64:79]
 ds_read_b128 a[192:195],v193 offset:16384
 ds_read_b128 a[196:199],v193 offset:17408
 v_exp_f32 v12,v12
 v_add_f32 v199,v199,v10
 N a[80:95],a[228:231],v[80:83],a[80:95]
 W 6
 v_exp_f32 v13,v13
 v_cvt_pk_bf16_f32 v9,v10,v11
 v_add_f32 v199,v199,v11
 v_exp_f32 v14,v14
 N a[96:111],a[232:235],v[80:83],a[96:111]
 ds_read_b128 a[200:203],v193 offset:18432
 ds_read_b128 a[204:207],v193 offset:19456
 v_add_f32 v199,v199,v12
 v_exp_f32 v15,v15
 v_cvt_pk_bf16_f32 v10,v12,v13
 N a[112:127],a[236:239],v[80:83],a[112:127]
 W 6
 v_add_f32 v199,v199,v13
 v_add_f32 v199,v199,v14
 v_cvt_pk_bf16_f32 v11,v14,v15
 v_add_f32 v199,v199,v15
 v_subrev_u32 v206,64,v204
 v_cmp_le_i32 s[84:85],0,v206
 N a[64:79],a[240:243],v[88:91],a[64:79]
 ds_read_b128 a[208:211],v193 offset:20480
 ds_read_b128 a[212:215],v193 offset:21504
 v_cmp_le_i32 s[86:87],1,v206
 v_cmp_le_i32 s[88:89],2,v206
 v_cmp_le_i32 s[98:99],3,v206
 v_cndmask_b32 v32,v205,v32,s[84:85]
 N a[80:95],a[244:247],v[88:91],a[80:95]
 W 6
 v_cndmask_b32 v33,v205,v33,s[86:87]
 v_cndmask_b32 v34,v205,v34,s[88:89]
 v_cndmask_b32 v35,v205,v35,s[98:99]
 v_cmp_le_i32 s[84:85],8,v206
 v_cmp_le_i32 s[86:87],9,v206
 v_cmp_le_i32 s[88:89],10,v206
 N a[96:111],a[248:251],v[88:91],a[96:111]
 ds_read_b128 a[216:219],v193 offset:22528
 ds_read_b128 a[220:223],v193 offset:23552
 v_cmp_le_i32 s[98:99],11,v206
 v_cndmask_b32 v36,v205,v36,s[84:85]
 v_cndmask_b32 v37,v205,v37,s[86:87]
 v_cndmask_b32 v38,v205,v38,s[88:89]
 N a[112:127],a[252:255],v[88:91],a[112:127]
 W 6
 v_cndmask_b32 v39,v205,v39,s[98:99]
 v_cmp_le_i32 s[84:85],16,v206
 v_cmp_le_i32 s[86:87],17,v206
 v_cmp_le_i32 s[88:89],18,v206
 v_cmp_le_i32 s[98:99],19,v206
 v_cndmask_b32 v40,v205,v40,s[84:85]
 N a[64:79],a[192:195],v[96:99],a[64:79]
 ds_read_b128 a[224:227],v193 offset:24576
 ds_read_b128 a[228:231],v193 offset:25600
 v_cndmask_b32 v41,v205,v41,s[86:87]
 v_cndmask_b32 v42,v205,v42,s[88:89]
 v_cndmask_b32 v43,v205,v43,s[98:99]
 v_cmp_le_i32 s[84:85],24,v206
 N a[80:95],a[196:199],v[96:99],a[80:95]
 W 6
 v_cmp_le_i32 s[86:87],25,v206
 v_cmp_le_i32 s[88:89],26,v206
 v_cmp_le_i32 s[98:99],27,v206
 v_cndmask_b32 v44,v205,v44,s[84:85]
 v_cndmask_b32 v45,v205,v45,s[86:87]
 v_cndmask_b32 v46,v205,v46,s[88:89]
 N a[96:111],a[200:203],v[96:99],a[96:111]
 ds_read_b128 a[232:235],v193 offset:26624
 ds_read_b128 a[236:239],v193 offset:27648
 v_cndmask_b32 v47,v205,v47,s[98:99]
 v_exp_f32 v16,v16
 N a[112:127],a[204:207],v[96:99],a[112:127]
 W 6
 v_exp_f32 v17,v17
 v_exp_f32 v18,v18
 v_add_f32 v199,v199,v16
 N a[64:79],a[208:211],v[104:107],a[64:79]
 ds_read_b128 a[240:243],v193 offset:28672
 ds_read_b128 a[244:247],v193 offset:29696
 v_exp_f32 v19,v19
 v_add_f32 v199,v199,v17
 v_cvt_pk_bf16_f32 v16,v16,v17
 N a[80:95],a[212:215],v[104:107],a[80:95]
 W 6
 v_exp_f32 v20,v20
 v_add_f32 v199,v199,v18
 v_exp_f32 v21,v21
 v_cvt_pk_bf16_f32 v17,v18,v19
 N a[96:111],a[216:219],v[104:107],a[96:111]
 ds_read_b128 a[248:251],v193 offset:30720
 ds_read_b128 a[252:255],v193 offset:31744
 v_add_f32 v199,v199,v19
 v_exp_f32 v22,v22
 v_add_f32 v199,v199,v20
 N a[112:127],a[220:223],v[104:107],a[112:127]
 W 6
 v_exp_f32 v23,v23
 v_cvt_pk_bf16_f32 v18,v20,v21
 v_add_f32 v199,v199,v21
 v_exp_f32 v24,v24
 N a[64:79],a[224:227],v[112:115],a[64:79]
 v_add_u32 v192,s76,v224
 v_add_f32 v199,v199,v22
 v_exp_f32 v25,v25
 v_cvt_pk_bf16_f32 v19,v22,v23
 v_add_f32 v199,v199,v23
 N a[80:95],a[228:231],v[112:115],a[80:95]
 W 4
 s_waitcnt vmcnt(0) lgkmcnt(0)
 s_barrier
 v_exp_f32 v26,v26
 v_add_f32 v199,v199,v24
 N a[96:111],a[232:235],v[112:115],a[96:111]
 ds_read_b128 a[192:195],v192 offset:0
 ds_read_b128 a[196:199],v192 offset:1024
 v_exp_f32 v27,v27
 v_add_f32 v199,v199,v25
 v_cvt_pk_bf16_f32 v24,v24,v25
 N a[112:127],a[236:239],v[112:115],a[112:127]
 ds_read_b128 a[200:203],v192 offset:2048
 ds_read_b128 a[204:207],v192 offset:3072
 v_exp_f32 v28,v28
 v_add_f32 v199,v199,v26
 N a[64:79],a[240:243],v[120:123],a[64:79]
 v_exp_f32 v29,v29
 v_cvt_pk_bf16_f32 v25,v26,v27
 v_add_f32 v199,v199,v27
 v_exp_f32 v30,v30
 N a[80:95],a[244:247],v[120:123],a[80:95]
 ds_read_b128 a[208:211],v192 offset:4096
 ds_read_b128 a[212:215],v192 offset:5120
 v_add_f32 v199,v199,v28
 v_exp_f32 v31,v31
 N a[96:111],a[248:251],v[120:123],a[96:111]
 v_cvt_pk_bf16_f32 v26,v28,v29
 v_add_f32 v199,v199,v29
 v_add_f32 v199,v199,v30
 v_cvt_pk_bf16_f32 v27,v30,v31
 v_add_f32 v199,v199,v31
 v_mov_b32 v48,v205
 N a[112:127],a[252:255],v[120:123],a[112:127]
 ds_read_b128 a[216:219],v192 offset:6144
 ds_read_b128 a[220:223],v192 offset:7168
 v_mov_b32 v49,v205
 v_mov_b32 v50,v205
 v_mov_b32 v51,v205
 v_mov_b32 v52,v205
 v_mov_b32 v53,v205
 v_mov_b32 v54,v205
 v_mov_b32 v55,v205
 v_mov_b32 v56,v205
 v_mov_b32 v57,v205
 v_mov_b32 v58,v205
 v_mov_b32 v59,v205
 v_mov_b32 v60,v205
 v_mov_b32 v61,v205
 v_mov_b32 v62,v205
 v_mov_b32 v63,v205
 s_branch F_Bend
F_BBm3:
 W 7
 N v[0:15],a[192:195],a[160:163],v[144:159]
 ds_read_b128 a[224:227],v192 offset:8192
 ds_read_b128 a[228:231],v192 offset:9216
 s_add_u32 m0,s94,0x10000
 v_exp_f32 v96,v96
 W 8
 N v[0:15],a[196:199],a[164:167],v[0:15]
 W 6
 buffer_load_dwordx4 v243,s[40:43],s93 offen offset:0 sc1 lds
 v_exp_f32 v97,v97
 v_exp_f32 v98,v98
 N v[0:15],a[200:203],a[168:171],v[0:15]
 ds_read_b128 a[232:235],v192 offset:10240
 ds_read_b128 a[236:239],v192 offset:11264
 global_load_dword v252,v250,s[6:7]
 v_add_f32 v199,v199,v96
 N v[0:15],a[204:207],a[172:175],v[0:15]
 W 6
 buffer_load_dwordx4 v243,s[40:43],s93 offen offset:1024 sc1 lds
 v_exp_f32 v99,v99
 v_add_f32 v199,v199,v97
 v_cvt_pk_bf16_f32 v96,v96,v97
 N v[0:15],a[208:211],a[176:179],v[0:15]
 ds_read_b128 a[240:243],v192 offset:12288
 ds_read_b128 a[244:247],v192 offset:13312
 global_load_dword v252,v251,s[6:7]
 v_exp_f32 v100,v100
 N v[0:15],a[212:215],a[180:183],v[0:15]
 W 6
 buffer_load_dwordx4 v243,s[40:43],s93 offen offset:2048 sc1 lds
 v_add_f32 v199,v199,v98
 v_exp_f32 v101,v101
 v_cvt_pk_bf16_f32 v97,v98,v99
 N v[0:15],a[216:219],a[184:187],v[0:15]
 ds_read_b128 a[248:251],v192 offset:14336
 ds_read_b128 a[252:255],v192 offset:15360
 v_add_f32 v199,v199,v99
 v_exp_f32 v102,v102
 v_add_f32 v199,v199,v100
 N v[0:15],a[220:223],a[188:191],v[0:15]
 W 6
 buffer_load_dwordx4 v243,s[40:43],s93 offen offset:3072 sc1 lds
 v_exp_f32 v103,v103
 v_cvt_pk_bf16_f32 v98,v100,v101
 v_add_f32 v199,v199,v101
 N v[16:31],a[224:227],a[160:163],v[144:159]
 ds_read_b128 a[192:195],v192 offset:16384
 ds_read_b128 a[196:199],v192 offset:17408
 v_exp_f32 v104,v104
 v_add_f32 v199,v199,v102
 N v[16:31],a[228:231],a[164:167],v[16:31]
 W 6
 s_add_u32 m0,s94,0x14000
 s_add_u32 s69,s93,17408
 s_add_u32 s93,s93,34816
 s_xor_b32 s94,s94,0x8000
 buffer_load_dwordx4 v243,s[40:43],s69 offen offset:0 sc1 lds
 N v[16:31],a[232:235],a[168:171],v[16:31]
 ds_read_b128 a[200:203],v192 offset:18432
 ds_read_b128 a[204:207],v192 offset:19456
 v_exp_f32 v105,v105
 v_cvt_pk_bf16_f32 v99,v102,v103
 v_add_f32 v199,v199,v103
 N v[16:31],a[236:239],a[172:175],v[16:31]
 W 6
 buffer_load_dwordx4 v243,s[40:43],s69 offen offset:1024 sc1 lds
 v_exp_f32 v106,v106
 v_add_f32 v199,v199,v104
 N v[16:31],a[240:243],a[176:179],v[16:31]
 ds_read_b128 a[208:211],v192 offset:20480
 ds_read_b128 a[212:215],v192 offset:21504
 v_exp_f32 v107,v107
 v_add_f32 v199,v199,v105
 v_cvt_pk_bf16_f32 v104,v104,v105
 N v[16:31],a[244:247],a[180:183],v[16:31]
 W 6
 buffer_load_dwordx4 v243,s[40:43],s69 offen offset:2048 sc1 lds
 v_exp_f32 v108,v108
 v_add_f32 v199,v199,v106
 N v[16:31],a[248:251],a[184:187],v[16:31]
 ds_read_b128 a[216:219],v192 offset:22528
 ds_read_b128 a[220:223],v192 offset:23552
 v_exp_f32 v109,v109
 v_cvt_pk_bf16_f32 v105,v106,v107
 v_add_f32 v199,v199,v107
 N v[16:31],a[252:255],a[188:191],v[16:31]
 W 6
 buffer_load_dwordx4 v243,s[40:43],s69 offen offset:3072 sc1 lds
 v_exp_f32 v110,v110
 v_add_f32 v199,v199,v108
 N v[32:47],a[192:195],a[160:163],v[144:159]
 ds_read_b128 a[224:227],v192 offset:24576
 ds_read_b128 a[228:231],v192 offset:25600
 v_exp_f32 v111,v111
 v_cvt_pk_bf16_f32 v106,v108,v109
 v_add_f32 v199,v199,v109
 N v[32:47],a[196:199],a[164:167],v[32:47]
 W 6
 v_add_f32 v199,v199,v110
 v_cvt_pk_bf16_f32 v107,v110,v111
 v_add_f32 v199,v199,v111
 v_exp_f32 v112,v112
 N v[32:47],a[200:203],a[168:171],v[32:47]
 ds_read_b128 a[232:235],v192 offset:26624
 ds_read_b128 a[236:239],v192 offset:27648
 v_exp_f32 v113,v113
 v_exp_f32 v114,v114
 N v[32:47],a[204:207],a[172:175],v[32:47]
 W 6
 v_add_f32 v199,v199,v112
 v_exp_f32 v115,v115
 v_add_f32 v199,v199,v113
 v_cvt_pk_bf16_f32 v112,v112,v113
 N v[32:47],a[208:211],a[176:179],v[32:47]
 ds_read_b128 a[240:243],v192 offset:28672
 ds_read_b128 a[244:247],v192 offset:29696
 v_exp_f32 v116,v116
 v_add_f32 v199,v199,v114
 N v[32:47],a[212:215],a[180:183],v[32:47]
 W 6
 v_exp_f32 v117,v117
 v_cvt_pk_bf16_f32 v113,v114,v115
 v_add_f32 v199,v199,v115
 v_exp_f32 v118,v118
 N v[32:47],a[216:219],a[184:187],v[32:47]
 ds_read_b128 a[248:251],v192 offset:30720
 ds_read_b128 a[252:255],v192 offset:31744
 v_add_f32 v199,v199,v116
 v_exp_f32 v119,v119
 v_cvt_pk_bf16_f32 v114,v116,v117
 N v[32:47],a[220:223],a[188:191],v[32:47]
 W 6
 v_add_u32 v193,s77,v194
 s_add_u32 s77,s77,32768
 s_and_b32 s77,s77,0xffff
 v_add_f32 v199,v199,v117
 v_exp_f32 v120,v120
 N v[48:63],a[224:227],a[160:163],v[144:159]
 v_add_f32 v199,v199,v118
 v_exp_f32 v121,v121
 v_cvt_pk_bf16_f32 v115,v118,v119
 v_add_f32 v199,v199,v119
 N v[48:63],a[228:231],a[164:167],v[48:63]
 W 4
 s_waitcnt vmcnt(16) lgkmcnt(0)
 s_barrier
 v_exp_f32 v122,v122
 v_add_f32 v199,v199,v120
 N v[48:63],a[232:235],a[168:171],v[48:63]
 ds_read_b128 a[192:195],v193 offset:0
 ds_read_b128 a[196:199],v193 offset:1024
 v_exp_f32 v123,v123
 v_add_f32 v199,v199,v121
 v_cvt_pk_bf16_f32 v120,v120,v121
 N v[48:63],a[236:239],a[172:175],v[48:63]
 ds_read_b128 a[200:203],v193 offset:2048
 ds_read_b128 a[204:207],v193 offset:3072
 v_exp_f32 v124,v124
 v_add_f32 v199,v199,v122
 N v[48:63],a[240:243],a[176:179],v[48:63]
 ds_read_b128 a[208:211],v193 offset:4096
 ds_read_b128 a[212:215],v193 offset:5120
 v_exp_f32 v125,v125
 v_cvt_pk_bf16_f32 v121,v122,v123
 v_add_f32 v199,v199,v123
 N v[48:63],a[244:247],a[180:183],v[48:63]
 v_exp_f32 v126,v126
 v_add_f32 v199,v199,v124
 v_exp_f32 v127,v127
 v_cvt_pk_bf16_f32 v122,v124,v125
 N v[48:63],a[248:251],a[184:187],v[48:63]
 ds_read_b128 a[216:219],v193 offset:6144
 ds_read_b128 a[220:223],v193 offset:7168
 v_add_f32 v199,v199,v125
 v_add_f32 v199,v199,v126
 v_cvt_pk_bf16_f32 v123,v126,v127
 v_add_f32 v199,v199,v127
 N v[48:63],a[252:255],a[188:191],v[48:63]
 W 6
 v_cmp_lt_f32 vcc,s78,v199
 s_cbranch_vccz F_c34
 s_call_b64 s[82:83],F_XBB1
F_c34:
 v_add_f32 v198,v198,v199
 s_add_u32 s75,s75,128
 N a[64:79],a[192:195],v[64:67],a[64:79]
 ds_read_b128 a[224:227],v193 offset:8192
 ds_read_b128 a[228:231],v193 offset:9216
 v_exp_f32 v0,v0
 v_exp_f32 v1,v1
 N a[80:95],a[196:199],v[64:67],a[80:95]
 W 6
 v_exp_f32 v2,v2
 v_add_f32 v199,v0,v1
 v_exp_f32 v3,v3
 v_cvt_pk_bf16_f32 v0,v0,v1
 N a[96:111],a[200:203],v[64:67],a[96:111]
 ds_read_b128 a[232:235],v193 offset:10240
 ds_read_b128 a[236:239],v193 offset:11264
 v_exp_f32 v4,v4
 v_add_f32 v199,v199,v2
 N a[112:127],a[204:207],v[64:67],a[112:127]
 W 6
 v_exp_f32 v5,v5
 v_cvt_pk_bf16_f32 v1,v2,v3
 v_add_f32 v199,v199,v3
 v_exp_f32 v6,v6
 N a[64:79],a[208:211],v[72:75],a[64:79]
 ds_read_b128 a[240:243],v193 offset:12288
 ds_read_b128 a[244:247],v193 offset:13312
 v_add_f32 v199,v199,v4
 v_exp_f32 v7,v7
 v_cvt_pk_bf16_f32 v2,v4,v5
 N a[80:95],a[212:215],v[72:75],a[80:95]
 W 6
 v_add_f32 v199,v199,v5
 v_exp_f32 v8,v8
 v_add_f32 v199,v199,v6
 v_exp_f32 v9,v9
 N a[96:111],a[216:219],v[72:75],a[96:111]
 ds_read_b128 a[248:251],v193 offset:14336
 ds_read_b128 a[252:255],v193 offset:15360
 v_cvt_pk_bf16_f32 v3,v6,v7
 v_add_f32 v199,v199,v7
 v_exp_f32 v10,v10
 N a[112:127],a[220:223],v[72:75],a[112:127]
 W 6
 v_add_f32 v199,v199,v8
 v_exp_f32 v11,v11
 v_add_f32 v199,v199,v9
 v_cvt_pk_bf16_f32 v8,v8,v9
 N a[64:79],a[224:227],v[80:83],a[64:79]
 ds_read_b128 a[192:195],v193 offset:16384
 ds_read_b128 a[196:199],v193 offset:17408
 v_exp_f32 v12,v12
 v_add_f32 v199,v199,v10
 N a[80:95],a[228:231],v[80:83],a[80:95]
 W 6
 v_exp_f32 v13,v13
 v_cvt_pk_bf16_f32 v9,v10,v11
 v_add_f32 v199,v199,v11
 v_exp_f32 v14,v14
 N a[96:111],a[232:235],v[80:83],a[96:111]
 ds_read_b128 a[200:203],v193 offset:18432
 ds_read_b128 a[204:207],v193 offset:19456
 v_add_f32 v199,v199,v12
 v_exp_f32 v15,v15
 v_cvt_pk_bf16_f32 v10,v12,v13
 N a[112:127],a[236:239],v[80:83],a[112:127]
 W 6
 v_add_f32 v199,v199,v13
 v_add_f32 v199,v199,v14
 v_cvt_pk_bf16_f32 v11,v14,v15
 v_add_f32 v199,v199,v15
 v_subrev_u32 v206,96,v204
 v_cmp_le_i32 s[84:85],0,v206
 N a[64:79],a[240:243],v[88:91],a[64:79]
 ds_read_b128 a[208:211],v193 offset:20480
 ds_read_b128 a[212:215],v193 offset:21504
 v_cmp_le_i32 s[86:87],1,v206
 v_cmp_le_i32 s[88:89],2,v206
 v_cmp_le_i32 s[98:99],3,v206
 v_cndmask_b32 v48,v205,v48,s[84:85]
 N a[80:95],a[244:247],v[88:91],a[80:95]
 W 6
 v_cndmask_b32 v49,v205,v49,s[86:87]
 v_cndmask_b32 v50,v205,v50,s[88:89]
 v_cndmask_b32 v51,v205,v51,s[98:99]
 v_cmp_le_i32 s[84:85],8,v206
 v_cmp_le_i32 s[86:87],9,v206
 v_cmp_le_i32 s[88:89],10,v206
 N a[96:111],a[248:251],v[88:91],a[96:111]
 ds_read_b128 a[216:219],v193 offset:22528
 ds_read_b128 a[220:223],v193 offset:23552
 v_cmp_le_i32 s[98:99],11,v206
 v_cndmask_b32 v52,v205,v52,s[84:85]
 v_cndmask_b32 v53,v205,v53,s[86:87]
 v_cndmask_b32 v54,v205,v54,s[88:89]
 N a[112:127],a[252:255],v[88:91],a[112:127]
 W 6
 v_cndmask_b32 v55,v205,v55,s[98:99]
 v_cmp_le_i32 s[84:85],16,v206
 v_cmp_le_i32 s[86:87],17,v206
 v_cmp_le_i32 s[88:89],18,v206
 v_cmp_le_i32 s[98:99],19,v206
 v_cndmask_b32 v56,v205,v56,s[84:85]
 N a[64:79],a[192:195],v[96:99],a[64:79]
 ds_read_b128 a[224:227],v193 offset:24576
 ds_read_b128 a[228:231],v193 offset:25600
 v_cndmask_b32 v57,v205,v57,s[86:87]
 v_cndmask_b32 v58,v205,v58,s[88:89]
 v_cndmask_b32 v59,v205,v59,s[98:99]
 v_cmp_le_i32 s[84:85],24,v206
 N a[80:95],a[196:199],v[96:99],a[80:95]
 W 6
 v_cmp_le_i32 s[86:87],25,v206
 v_cmp_le_i32 s[88:89],26,v206
 v_cmp_le_i32 s[98:99],27,v206
 v_cndmask_b32 v60,v205,v60,s[84:85]
 v_cndmask_b32 v61,v205,v61,s[86:87]
 v_cndmask_b32 v62,v205,v62,s[88:89]
 N a[96:111],a[200:203],v[96:99],a[96:111]
 ds_read_b128 a[232:235],v193 offset:26624
 ds_read_b128 a[236:239],v193 offset:27648
 v_cndmask_b32 v63,v205,v63,s[98:99]
 v_exp_f32 v16,v16
 N a[112:127],a[204:207],v[96:99],a[112:127]
 W 6
 v_exp_f32 v17,v17
 v_exp_f32 v18,v18
 v_add_f32 v199,v199,v16
 N a[64:79],a[208:211],v[104:107],a[64:79]
 ds_read_b128 a[240:243],v193 offset:28672
 ds_read_b128 a[244:247],v193 offset:29696
 v_exp_f32 v19,v19
 v_add_f32 v199,v199,v17
 v_cvt_pk_bf16_f32 v16,v16,v17
 N a[80:95],a[212:215],v[104:107],a[80:95]
 W 6
 v_exp_f32 v20,v20
 v_add_f32 v199,v199,v18
 v_exp_f32 v21,v21
 v_cvt_pk_bf16_f32 v17,v18,v19
 N a[96:111],a[216:219],v[104:107],a[96:111]
 ds_read_b128 a[248:251],v193 offset:30720
 ds_read_b128 a[252:255],v193 offset:31744
 v_add_f32 v199,v199,v19
 v_exp_f32 v22,v22
 v_add_f32 v199,v199,v20
 N a[112:127],a[220:223],v[104:107],a[112:127]
 W 6
 v_exp_f32 v23,v23
 v_cvt_pk_bf16_f32 v18,v20,v21
 v_add_f32 v199,v199,v21
 v_exp_f32 v24,v24
 N a[64:79],a[224:227],v[112:115],a[64:79]
 v_add_u32 v192,s76,v224
 v_add_f32 v199,v199,v22
 v_exp_f32 v25,v25
 v_cvt_pk_bf16_f32 v19,v22,v23
 v_add_f32 v199,v199,v23
 N a[80:95],a[228:231],v[112:115],a[80:95]
 W 4
 s_waitcnt vmcnt(0) lgkmcnt(0)
 s_barrier
 v_exp_f32 v26,v26
 v_add_f32 v199,v199,v24
 N a[96:111],a[232:235],v[112:115],a[96:111]
 ds_read_b128 a[192:195],v192 offset:0
 ds_read_b128 a[196:199],v192 offset:1024
 v_exp_f32 v27,v27
 v_add_f32 v199,v199,v25
 v_cvt_pk_bf16_f32 v24,v24,v25
 N a[112:127],a[236:239],v[112:115],a[112:127]
 ds_read_b128 a[200:203],v192 offset:2048
 ds_read_b128 a[204:207],v192 offset:3072
 v_exp_f32 v28,v28
 v_add_f32 v199,v199,v26
 N a[64:79],a[240:243],v[120:123],a[64:79]
 v_exp_f32 v29,v29
 v_cvt_pk_bf16_f32 v25,v26,v27
 v_add_f32 v199,v199,v27
 v_exp_f32 v30,v30
 N a[80:95],a[244:247],v[120:123],a[80:95]
 ds_read_b128 a[208:211],v192 offset:4096
 ds_read_b128 a[212:215],v192 offset:5120
 v_add_f32 v199,v199,v28
 v_exp_f32 v31,v31
 N a[96:111],a[248:251],v[120:123],a[96:111]
 v_cvt_pk_bf16_f32 v26,v28,v29
 v_add_f32 v199,v199,v29
 v_add_f32 v199,v199,v30
 v_cvt_pk_bf16_f32 v27,v30,v31
 v_add_f32 v199,v199,v31
 N a[112:127],a[252:255],v[120:123],a[112:127]
 ds_read_b128 a[216:219],v192 offset:6144
 ds_read_b128 a[220:223],v192 offset:7168
F_Bend:
 s_bitcmp1_b32 s65, 0
 s_cbranch_scc1 F_Bodd
 v_add_u32 v193,s77,v194
 W 7
 ds_read_b128 a[192:195],v193 offset:0
 W 7
 ds_read_b128 a[196:199],v193 offset:1024
 W 7
 ds_read_b128 a[200:203],v193 offset:2048
 W 7
 ds_read_b128 a[204:207],v193 offset:3072
 W 7
 ds_read_b128 a[208:211],v193 offset:4096
 W 7
 ds_read_b128 a[212:215],v193 offset:5120
 W 7
 ds_read_b128 a[216:219],v193 offset:6144
 W 7
 ds_read_b128 a[220:223],v193 offset:7168
 v_exp_f32 v32,v32
 v_exp_f32 v33,v33
 v_exp_f32 v34,v34
 v_add_f32 v199,v199,v32
 v_exp_f32 v35,v35
 v_add_f32 v199,v199,v33
 v_cvt_pk_bf16_f32 v32,v32,v33
 v_exp_f32 v36,v36
 v_add_f32 v199,v199,v34
 v_exp_f32 v37,v37
 v_cvt_pk_bf16_f32 v33,v34,v35
 v_add_f32 v199,v199,v35
 v_exp_f32 v38,v38
 v_add_f32 v199,v199,v36
 v_exp_f32 v39,v39
 v_cvt_pk_bf16_f32 v34,v36,v37
 v_add_f32 v199,v199,v37
 v_exp_f32 v40,v40
 v_add_f32 v199,v199,v38
 v_exp_f32 v41,v41
 v_cvt_pk_bf16_f32 v35,v38,v39
 v_add_f32 v199,v199,v39
 v_exp_f32 v42,v42
 v_add_f32 v199,v199,v40
 v_exp_f32 v43,v43
 v_add_f32 v199,v199,v41
 v_cvt_pk_bf16_f32 v40,v40,v41
 v_exp_f32 v44,v44
 v_add_f32 v199,v199,v42
 v_exp_f32 v45,v45
 v_cvt_pk_bf16_f32 v41,v42,v43
 v_add_f32 v199,v199,v43
 v_exp_f32 v46,v46
 v_add_f32 v199,v199,v44
 v_exp_f32 v47,v47
 v_cvt_pk_bf16_f32 v42,v44,v45
 v_add_f32 v199,v199,v45
 v_add_f32 v199,v199,v46
 v_cvt_pk_bf16_f32 v43,v46,v47
 v_add_f32 v199,v199,v47
 v_exp_f32 v48,v48
 v_exp_f32 v49,v49
 v_exp_f32 v50,v50
 v_add_f32 v199,v199,v48
 v_exp_f32 v51,v51
 v_add_f32 v199,v199,v49
 v_cvt_pk_bf16_f32 v48,v48,v49
 v_exp_f32 v52,v52
 v_add_f32 v199,v199,v50
 v_exp_f32 v53,v53
 v_cvt_pk_bf16_f32 v49,v50,v51
 v_add_f32 v199,v199,v51
 v_exp_f32 v54,v54
 v_add_f32 v199,v199,v52
 v_exp_f32 v55,v55
 v_cvt_pk_bf16_f32 v50,v52,v53
 v_add_f32 v199,v199,v53
 v_exp_f32 v56,v56
 v_add_f32 v199,v199,v54
 v_exp_f32 v57,v57
 v_cvt_pk_bf16_f32 v51,v54,v55
 v_add_f32 v199,v199,v55
 v_exp_f32 v58,v58
 v_add_f32 v199,v199,v56
 v_exp_f32 v59,v59
 v_add_f32 v199,v199,v57
 v_cvt_pk_bf16_f32 v56,v56,v57
 v_exp_f32 v60,v60
 v_add_f32 v199,v199,v58
 v_exp_f32 v61,v61
 v_cvt_pk_bf16_f32 v57,v58,v59
 v_add_f32 v199,v199,v59
 v_exp_f32 v62,v62
 v_add_f32 v199,v199,v60
 v_exp_f32 v63,v63
 v_cvt_pk_bf16_f32 v58,v60,v61
 v_add_f32 v199,v199,v61
 v_add_f32 v199,v199,v62
 v_cvt_pk_bf16_f32 v59,v62,v63
 v_add_f32 v199,v199,v63
 v_cmp_lt_f32 vcc,s78,v199
 s_cbranch_vccz F_c35
 s_call_b64 s[82:83],F_XBn0
F_c35:
 s_lshl_b32 s68,s64,13
 s_lshl_b32 s69,s67,8
 s_add_u32 s70,s68,s69
 s_lshl_b32 s68,s65,19
 s_add_u32 s68,s68,s70
 s_lshl_b32 s69,s67,17
 s_add_u32 s76,s68,s69
 s_add_u32 s69,s67,1
 s_and_b32 s69,s69,3
 s_lshl_b32 s87,s69,17
 s_add_u32 s87,s87,s68
 s_sub_u32 s69,s69,s67
 s_lshl_b32 s84,s69,12
 s_add_u32 s69,s67,2
 s_and_b32 s69,s69,3
 s_lshl_b32 s88,s69,17
 s_add_u32 s88,s88,s68
 s_sub_u32 s69,s69,s67
 s_lshl_b32 s85,s69,12
 s_add_u32 s69,s67,3
 s_and_b32 s69,s69,3
 s_lshl_b32 s89,s69,17
 s_add_u32 s89,s89,s68
 s_sub_u32 s69,s69,s67
 s_lshl_b32 s86,s69,12
 W 7
 N a[64:79],a[192:195],v[0:3],a[64:79]
 ds_read_b128 a[224:227],v193 offset:8192
 ds_read_b128 a[228:231],v193 offset:9216
 v_add_f32 v198,v198,v199
 v_lshrrev_b32 v164,4,v224
 v_lshrrev_b32 v160,4,v164
 v_bfe_u32 v161,v164,2,2
 W 8
 N a[80:95],a[196:199],v[0:3],a[80:95]
 W 6
 s_add_u32 m0,s72,0
 s_add_u32 s68,s3,131072
 buffer_load_dwordx4 v220,s[48:51],s68 offen lds
 v_and_b32 v162,1,v160
 v_lshl_add_u32 v161,v162,2,v161
 N a[96:111],a[200:203],v[0:3],a[96:111]
 ds_read_b128 a[232:235],v193 offset:10240
 ds_read_b128 a[236:239],v193 offset:11264
 v_lshrrev_b32 v160,1,v160
 v_lshlrev_b32 v160,10,v160
 v_lshl_add_u32 v160,v161,7,v160
 v_and_b32 v162,1,v164
 N a[112:127],a[204:207],v[0:3],a[112:127]
 W 6
 s_add_u32 m0,s72,4096
 s_add_u32 s68,s3,131200
 buffer_load_dwordx4 v220,s[48:51],s68 offen lds
 v_lshl_add_u32 v160,v162,3,v160
 v_bfe_u32 v162,v164,1,1
 N a[64:79],a[208:211],v[8:11],a[64:79]
 ds_read_b128 a[240:243],v193 offset:12288
 ds_read_b128 a[244:247],v193 offset:13312
 v_lshl_add_u32 v160,v162,4,v160
 v_and_b32 v161,6,v161
 v_xor_b32 v162,0,v161
 v_lshl_add_u32 v216,v162,4,v160
 N a[80:95],a[212:215],v[8:11],a[80:95]
 W 6
 s_add_u32 m0,s72,8192
 s_add_u32 s68,s3,163840
 buffer_load_dwordx4 v220,s[48:51],s68 offen lds
 v_xor_b32 v162,2,v161
 v_lshl_add_u32 v217,v162,4,v160
 N a[96:111],a[216:219],v[8:11],a[96:111]
 ds_read_b128 a[248:251],v193 offset:14336
 ds_read_b128 a[252:255],v193 offset:15360
 v_xor_b32 v162,4,v161
 v_lshl_add_u32 v218,v162,4,v160
 v_xor_b32 v162,6,v161
 v_lshl_add_u32 v219,v162,4,v160
 N a[112:127],a[220:223],v[8:11],a[112:127]
 W 6
 s_add_u32 m0,s72,12288
 s_add_u32 s68,s3,163968
 buffer_load_dwordx4 v220,s[48:51],s68 offen lds
 v_add_u32 v212,131072,v216
 v_add_u32 v213,131072,v217
 N a[64:79],a[224:227],v[16:19],a[64:79]
 ds_read_b128 a[192:195],v193 offset:16384
 ds_read_b128 a[196:199],v193 offset:17408
 v_add_u32 v214,131072,v218
 v_add_u32 v215,131072,v219
 v_add_u32 v221,0x20000,v224
 s_lshr_b32 s70,s2,3
 N a[80:95],a[228:231],v[16:19],a[80:95]
 W 6
 s_add_u32 m0,s72,16384
 s_add_u32 s68,s3,196608
 buffer_load_dwordx4 v220,s[48:51],s68 offen lds
 s_lshl_b32 s70,s70,2
 s_lshr_b32 s80,s65,1
 N a[96:111],a[232:235],v[16:19],a[96:111]
 ds_read_b128 a[200:203],v193 offset:18432
 ds_read_b128 a[204:207],v193 offset:19456
 s_add_u32 s80,s70,s80
 s_lshl_b32 s80,s80,10
 s_add_u32 s80,s80,0x6030000
 v_and_b32 v160,7,v164
 N a[112:127],a[236:239],v[16:19],a[112:127]
 W 6
 s_add_u32 m0,s72,20480
 s_add_u32 s68,s3,196736
 buffer_load_dwordx4 v220,s[48:51],s68 offen lds
 v_lshlrev_b32 v160,7,v160
 v_add_u32 v209,s80,v160
 N a[64:79],a[240:243],v[24:27],a[64:79]
 ds_read_b128 a[208:211],v193 offset:20480
 ds_read_b128 a[212:215],v193 offset:21504
 s_add_u32 s70,s70,s64
 s_lshl_b32 s70,s70,3
 s_add_u32 s70,s70,s65
 s_lshl_b32 s70,s70,7
 N a[80:95],a[244:247],v[24:27],a[80:95]
 W 6
 s_add_u32 m0,s72,24576
 s_add_u32 s68,s3,229376
 buffer_load_dwordx4 v220,s[48:51],s68 offen lds
 s_add_u32 s1,s70,0x6030000
 s_mov_b32 s80,s2
 N a[96:111],a[248:251],v[24:27],a[96:111]
 ds_read_b128 a[216:219],v193 offset:22528
 ds_read_b128 a[220:223],v193 offset:23552
 s_mul_i32 s80,s80,73728
 s_mul_i32 s70,s64,18432
 s_add_u32 s80,s80,s70
 s_add_u32 s80,s80,0x4000000
 N a[112:127],a[252:255],v[24:27],a[112:127]
 W 6
 s_add_u32 m0,s72,28672
 s_add_u32 s68,s3,229504
 buffer_load_dwordx4 v220,s[48:51],s68 offen lds
 N a[64:79],a[192:195],v[32:35],a[64:79]
 ds_read_b128 a[224:227],v193 offset:24576
 ds_read_b128 a[228:231],v193 offset:25600
 N a[80:95],a[196:199],v[32:35],a[80:95]
 W 6
 s_add_u32 m0,s72,32768
 s_add_u32 s68,s3,262144
 buffer_load_dwordx4 v220,s[48:51],s68 offen lds
 N a[96:111],a[200:203],v[32:35],a[96:111]
 ds_read_b128 a[232:235],v193 offset:26624
 ds_read_b128 a[236:239],v193 offset:27648
 N a[112:127],a[204:207],v[32:35],a[112:127]
 W 6
 s_add_u32 m0,s72,36864
 s_add_u32 s68,s3,262272
 buffer_load_dwordx4 v220,s[48:51],s68 offen lds
 N a[64:79],a[208:211],v[40:43],a[64:79]
 ds_read_b128 a[240:243],v193 offset:28672
 ds_read_b128 a[244:247],v193 offset:29696
 N a[80:95],a[212:215],v[40:43],a[80:95]
 W 6
 s_add_u32 m0,s72,40960
 s_add_u32 s68,s3,294912
 buffer_load_dwordx4 v220,s[48:51],s68 offen lds
 N a[96:111],a[216:219],v[40:43],a[96:111]
 ds_read_b128 a[248:251],v193 offset:30720
 ds_read_b128 a[252:255],v193 offset:31744
 N a[112:127],a[220:223],v[40:43],a[112:127]
 W 6
 s_add_u32 m0,s72,45056
 s_add_u32 s68,s3,295040
 buffer_load_dwordx4 v220,s[48:51],s68 offen lds
 N a[64:79],a[224:227],v[48:51],a[64:79]
 N a[80:95],a[228:231],v[48:51],a[80:95]
 W 4
 s_add_u32 m0,s72,49152
 s_add_u32 s68,s76,0
 buffer_load_dwordx4 v220,s[44:47],s68 offen lds
 N a[96:111],a[232:235],v[48:51],a[96:111]
 s_waitcnt vmcnt(15)
 v_add_u32 v211,1,v211
 buffer_store_dword v211,v210,s[8:11],s73 offen sc0 sc1
 N a[112:127],a[236:239],v[48:51],a[112:127]
 W 2
 s_add_u32 m0,s72,53248
 s_add_u32 s68,s76,128
 buffer_load_dwordx4 v220,s[44:47],s68 offen lds
 N a[64:79],a[240:243],v[56:59],a[64:79]
 N a[80:95],a[244:247],v[56:59],a[80:95]
 W 0
 s_movk_i32 s90,2048
 buffer_load_dword v200,v208,s[8:11],s90 offen sc1
 N a[96:111],a[248:251],v[56:59],a[96:111]
 N a[112:127],a[252:255],v[56:59],a[112:127]
 W 0
 s_waitcnt vmcnt(8)
 s_barrier
 T v[128:129],v212,0
 T v[130:131],v212,2048
 T v[132:133],v213,0
 T v[134:135],v213,2048
 T v[136:137],v214,0
 T v[138:139],v214,2048
 T v[140:141],v215,0
 T v[142:143],v215,2048
 W 6
 M v[0:3],v[128:131],a[8:11],0
 T v[144:145],v212,4096
 T v[146:147],v212,6144
 M v[4:7],v[128:131],a[12:15],0
 s_add_u32 s81,s4,4096
 s_add_u32 s90,s5,4096
 buffer_load_dwordx4 a[160:163],v224,s[8:11],s81 offen offset:0 sc1
 M v[8:11],v[128:131],a[24:27],0
 v_mov_b32 v206,v198
 M v[12:15],v[128:131],a[28:31],0
 W 6
 v_permlane32_swap_b32 v198,v206
 M v[16:19],v[132:135],a[8:11],0
 T v[148:149],v213,4096
 T v[150:151],v213,6144
 M v[20:23],v[132:135],a[12:15],0
 buffer_load_dwordx4 a[164:167],v195,s[8:11],s81 offen offset:0 sc1
 v_add_f32 v198,v198,v206
 M v[24:27],v[132:135],a[24:27],0
 v_rcp_f32 v198,v198
 M v[28:31],v[132:135],a[28:31],0
 W 6
 s_add_u32 s97,s96,0x20000
 v_accvgpr_read_b32 v160,a64
 M v[32:35],v[136:139],a[8:11],0
 T v[152:153],v214,4096
 T v[154:155],v214,6144
 M v[36:39],v[136:139],a[12:15],0
 buffer_load_dwordx4 a[168:171],v224,s[8:11],s90 offen offset:0 sc1
 v_accvgpr_read_b32 v161,a65
 M v[40:43],v[136:139],a[24:27],0
 v_accvgpr_read_b32 v162,a66
 v_accvgpr_read_b32 v163,a67
 M v[44:47],v[136:139],a[28:31],0
 W 6
 v_accvgpr_read_b32 v164,a68
 v_accvgpr_read_b32 v165,a69
 M v[48:51],v[140:143],a[8:11],0
 T v[156:157],v215,4096
 T v[158:159],v215,6144
 M v[52:55],v[140:143],a[12:15],0
 buffer_load_dwordx4 a[172:175],v195,s[8:11],s90 offen offset:0 sc1
 v_accvgpr_read_b32 v166,a70
 M v[56:59],v[140:143],a[24:27],0
 v_accvgpr_read_b32 v167,a71
 v_accvgpr_read_b32 v168,a72
 M v[60:63],v[140:143],a[28:31],0
 W 6
 v_accvgpr_read_b32 v169,a73
 v_accvgpr_read_b32 v170,a74
 M v[64:67],v[144:147],a[8:11],0
 T v[128:129],v212,8192
 T v[130:131],v212,10240
 M v[68:71],v[144:147],a[12:15],0
 buffer_load_dwordx4 a[176:179],v224,s[8:11],s81 offen offset:1024 sc1
 v_accvgpr_read_b32 v171,a75
 M v[72:75],v[144:147],a[24:27],0
 v_accvgpr_read_b32 v172,a76
 v_accvgpr_read_b32 v173,a77
 M v[76:79],v[144:147],a[28:31],0
 W 6
 v_accvgpr_read_b32 v174,a78
 v_accvgpr_read_b32 v175,a79
 M v[80:83],v[148:151],a[8:11],0
 T v[132:133],v213,8192
 T v[134:135],v213,10240
 M v[84:87],v[148:151],a[12:15],0
 buffer_load_dwordx4 a[180:183],v195,s[8:11],s81 offen offset:1024 sc1
 v_mul_f32 v160,v160,v198
 M v[88:91],v[148:151],a[24:27],0
 v_mul_f32 v161,v161,v198
 v_mul_f32 v162,v162,v198
 M v[92:95],v[148:151],a[28:31],0
 W 6
 v_mul_f32 v163,v163,v198
 v_mul_f32 v164,v164,v198
 M v[96:99],v[152:155],a[8:11],0
 T v[136:137],v214,8192
 T v[138:139],v214,10240
 M v[100:103],v[152:155],a[12:15],0
 buffer_load_dwordx4 a[184:187],v224,s[8:11],s90 offen offset:1024 sc1
 v_mul_f32 v165,v165,v198
 M v[104:107],v[152:155],a[24:27],0
 v_mul_f32 v166,v166,v198
 v_mul_f32 v167,v167,v198
 M v[108:111],v[152:155],a[28:31],0
 W 6
 v_mul_f32 v168,v168,v198
 v_mul_f32 v169,v169,v198
 M v[112:115],v[156:159],a[8:11],0
 T v[140:141],v215,8192
 T v[142:143],v215,10240
 M v[116:119],v[156:159],a[12:15],0
 buffer_load_dwordx4 a[188:191],v195,s[8:11],s90 offen offset:1024 sc1
 v_mul_f32 v170,v170,v198
 M v[120:123],v[156:159],a[24:27],0
 v_mul_f32 v171,v171,v198
 v_mul_f32 v172,v172,v198
 M v[124:127],v[156:159],a[28:31],0
 W 6
 v_mul_f32 v173,v173,v198
 v_mul_f32 v174,v174,v198
 M v[0:3],v[128:131],a[40:43],v[0:3]
 T v[144:145],v212,12288
 T v[146:147],v212,14336
 M v[4:7],v[128:131],a[44:47],v[4:7]
 buffer_load_dwordx4 a[192:195],v224,s[8:11],s81 offen offset:2048 sc1
 v_mul_f32 v175,v175,v198
 M v[8:11],v[128:131],a[56:59],v[8:11]
 v_cvt_pk_bf16_f32 v226,v160,v161
 v_cvt_pk_bf16_f32 v227,v162,v163
 M v[12:15],v[128:131],a[60:63],v[12:15]
 W 6
 v_cvt_pk_bf16_f32 v228,v168,v169
 v_cvt_pk_bf16_f32 v229,v170,v171
 M v[16:19],v[132:135],a[40:43],v[16:19]
 T v[148:149],v213,12288
 T v[150:151],v213,14336
 M v[20:23],v[132:135],a[44:47],v[20:23]
 buffer_load_dwordx4 a[196:199],v195,s[8:11],s81 offen offset:2048 sc1
 v_cvt_pk_bf16_f32 v230,v164,v165
 M v[24:27],v[132:135],a[56:59],v[24:27]
 v_cvt_pk_bf16_f32 v231,v166,v167
 v_cvt_pk_bf16_f32 v232,v172,v173
 M v[28:31],v[132:135],a[60:63],v[28:31]
 W 6
 v_cvt_pk_bf16_f32 v233,v174,v175
 M v[32:35],v[136:139],a[40:43],v[32:35]
 T v[152:153],v214,12288
 T v[154:155],v214,14336
 M v[36:39],v[136:139],a[44:47],v[36:39]
 buffer_load_dwordx4 a[200:203],v224,s[8:11],s90 offen offset:2048 sc1
 M v[40:43],v[136:139],a[56:59],v[40:43]
 v_permlane32_swap_b32 v226,v230
 M v[44:47],v[136:139],a[60:63],v[44:47]
 W 6
 v_permlane32_swap_b32 v227,v231
 M v[48:51],v[140:143],a[40:43],v[48:51]
 T v[156:157],v215,12288
 T v[158:159],v215,14336
 M v[52:55],v[140:143],a[44:47],v[52:55]
 s_movk_i32 s70,2048
 s_add_u32 s63,s62,1
 s_waitcnt vmcnt(11)
 v_subrev_u32 v200,s63,v200
 v_cmp_le_u32 vcc,8,v200
 s_cbranch_vccz PL_ok12
 s_mov_b32 s69,0x100000
PL_sp12:
 s_sleep 2
 buffer_load_dword v200,v208,s[8:11],s70 offen sc1
 s_waitcnt vmcnt(0)
 v_subrev_u32 v200,s63,v200
 v_cmp_le_u32 vcc,8,v200
 s_cbranch_vccz PL_ok12
 s_sub_u32 s69,s69,1
 s_cbranch_scc0 PL_sp12
PL_ok12:
 buffer_load_dwordx4 a[204:207],v195,s[8:11],s90 offen offset:2048 sc1
 M v[56:59],v[140:143],a[56:59],v[56:59]
 v_permlane32_swap_b32 v228,v232
 M v[60:63],v[140:143],a[60:63],v[60:63]
 W 6
 v_permlane32_swap_b32 v229,v233
 M v[64:67],v[144:147],a[40:43],v[64:67]
 T v[128:129],v212,16384
 T v[130:131],v212,18432
 M v[68:71],v[144:147],a[44:47],v[68:71]
 buffer_load_dwordx4 a[208:211],v224,s[8:11],s81 offen offset:3072 sc1
 M v[72:75],v[144:147],a[56:59],v[72:75]
 v_permlane16_swap_b32 v226,v230
 M v[76:79],v[144:147],a[60:63],v[76:79]
 W 6
 v_permlane16_swap_b32 v227,v231
 M v[80:83],v[148:151],a[40:43],v[80:83]
 T v[132:133],v213,16384
 T v[134:135],v213,18432
 M v[84:87],v[148:151],a[44:47],v[84:87]
 buffer_load_dwordx4 a[212:215],v195,s[8:11],s81 offen offset:3072 sc1
 M v[88:91],v[148:151],a[56:59],v[88:91]
 v_permlane16_swap_b32 v228,v232
 M v[92:95],v[148:151],a[60:63],v[92:95]
 W 6
 v_permlane16_swap_b32 v229,v233
 M v[96:99],v[152:155],a[40:43],v[96:99]
 T v[136:137],v214,16384
 T v[138:139],v214,18432
 M v[100:103],v[152:155],a[44:47],v[100:103]
 buffer_load_dwordx4 a[216:219],v224,s[8:11],s90 offen offset:3072 sc1
 buffer_store_dwordx4 v[226:229],v224,s[8:11],s96 offen offset:0 sc0 sc1
 M v[104:107],v[152:155],a[56:59],v[104:107]
 buffer_store_dwordx4 v[230:233],v224,s[8:11],s97 offen offset:0 sc0 sc1
 v_accvgpr_write_b32 a8,v226
 M v[108:111],v[152:155],a[60:63],v[108:111]
 W 6
 v_accvgpr_write_b32 a9,v227
 v_accvgpr_write_b32 a10,v228
 M v[112:115],v[156:159],a[40:43],v[112:115]
 T v[140:141],v215,16384
 T v[142:143],v215,18432
 M v[116:119],v[156:159],a[44:47],v[116:119]
 buffer_load_dwordx4 a[220:223],v195,s[8:11],s90 offen offset:3072 sc1
 v_accvgpr_write_b32 a11,v229
 M v[120:123],v[156:159],a[56:59],v[120:123]
 v_accvgpr_write_b32 a12,v230
 v_accvgpr_write_b32 a13,v231
 M v[124:127],v[156:159],a[60:63],v[124:127]
 W 6
 v_accvgpr_write_b32 a14,v232
 v_accvgpr_write_b32 a15,v233
 M v[0:3],v[128:131],a[128:131],v[0:3]
 T v[144:145],v212,20480
 T v[146:147],v212,22528
 M v[4:7],v[128:131],a[132:135],v[4:7]
 s_add_u32 s81,s4,8192
 s_add_u32 s90,s5,8192
 buffer_load_dwordx4 a[224:227],v224,s[8:11],s81 offen offset:0 sc1
 M v[8:11],v[128:131],a[136:139],v[8:11]
 v_accvgpr_read_b32 v176,a80
 v_accvgpr_read_b32 v177,a81
 M v[12:15],v[128:131],a[140:143],v[12:15]
 W 6
 v_accvgpr_read_b32 v178,a82
 v_accvgpr_read_b32 v179,a83
 M v[16:19],v[132:135],a[128:131],v[16:19]
 T v[148:149],v213,20480
 T v[150:151],v213,22528
 M v[20:23],v[132:135],a[132:135],v[20:23]
 buffer_load_dwordx4 a[228:231],v195,s[8:11],s81 offen offset:0 sc1
 v_accvgpr_read_b32 v180,a84
 M v[24:27],v[132:135],a[136:139],v[24:27]
 v_accvgpr_read_b32 v181,a85
 v_accvgpr_read_b32 v182,a86
 M v[28:31],v[132:135],a[140:143],v[28:31]
 W 6
 v_accvgpr_read_b32 v183,a87
 v_accvgpr_read_b32 v184,a88
 M v[32:35],v[136:139],a[128:131],v[32:35]
 T v[152:153],v214,20480
 T v[154:155],v214,22528
 M v[36:39],v[136:139],a[132:135],v[36:39]
 buffer_load_dwordx4 a[232:235],v224,s[8:11],s90 offen offset:0 sc1
 v_accvgpr_read_b32 v185,a89
 M v[40:43],v[136:139],a[136:139],v[40:43]
 v_accvgpr_read_b32 v186,a90
 v_accvgpr_read_b32 v187,a91
 M v[44:47],v[136:139],a[140:143],v[44:47]
 W 6
 v_accvgpr_read_b32 v188,a92
 v_accvgpr_read_b32 v189,a93
 M v[48:51],v[140:143],a[128:131],v[48:51]
 T v[156:157],v215,20480
 T v[158:159],v215,22528
 M v[52:55],v[140:143],a[132:135],v[52:55]
 buffer_load_dwordx4 a[236:239],v195,s[8:11],s90 offen offset:0 sc1
 v_accvgpr_read_b32 v190,a94
 M v[56:59],v[140:143],a[136:139],v[56:59]
 v_accvgpr_read_b32 v191,a95
 v_mul_f32 v176,v176,v198
 M v[60:63],v[140:143],a[140:143],v[60:63]
 W 6
 v_mul_f32 v177,v177,v198
 v_mul_f32 v178,v178,v198
 M v[64:67],v[144:147],a[128:131],v[64:67]
 T v[128:129],v212,24576
 T v[130:131],v212,26624
 M v[68:71],v[144:147],a[132:135],v[68:71]
 buffer_load_dwordx4 a[240:243],v224,s[8:11],s81 offen offset:1024 sc1
 v_mul_f32 v179,v179,v198
 M v[72:75],v[144:147],a[136:139],v[72:75]
 v_mul_f32 v180,v180,v198
 v_mul_f32 v181,v181,v198
 M v[76:79],v[144:147],a[140:143],v[76:79]
 W 6
 v_mul_f32 v182,v182,v198
 v_mul_f32 v183,v183,v198
 M v[80:83],v[148:151],a[128:131],v[80:83]
 T v[132:133],v213,24576
 T v[134:135],v213,26624
 M v[84:87],v[148:151],a[132:135],v[84:87]
 buffer_load_dwordx4 a[244:247],v195,s[8:11],s81 offen offset:1024 sc1
 v_mul_f32 v184,v184,v198
 M v[88:91],v[148:151],a[136:139],v[88:91]
 v_mul_f32 v185,v185,v198
 v_mul_f32 v186,v186,v198
 M v[92:95],v[148:151],a[140:143],v[92:95]
 W 6
 v_mul_f32 v187,v187,v198
 v_mul_f32 v188,v188,v198
 M v[96:99],v[152:155],a[128:131],v[96:99]
 T v[136:137],v214,24576
 T v[138:139],v214,26624
 M v[100:103],v[152:155],a[132:135],v[100:103]
 buffer_load_dwordx4 a[248:251],v224,s[8:11],s90 offen offset:1024 sc1
 v_mul_f32 v189,v189,v198
 M v[104:107],v[152:155],a[136:139],v[104:107]
 v_mul_f32 v190,v190,v198
 v_mul_f32 v191,v191,v198
 M v[108:111],v[152:155],a[140:143],v[108:111]
 W 6
 v_cvt_pk_bf16_f32 v234,v176,v177
 v_cvt_pk_bf16_f32 v235,v178,v179
 M v[112:115],v[156:159],a[128:131],v[112:115]
 T v[140:141],v215,24576
 T v[142:143],v215,26624
 M v[116:119],v[156:159],a[132:135],v[116:119]
 buffer_load_dwordx4 a[252:255],v195,s[8:11],s90 offen offset:1024 sc1
 v_cvt_pk_bf16_f32 v236,v184,v185
 M v[120:123],v[156:159],a[136:139],v[120:123]
 v_cvt_pk_bf16_f32 v237,v186,v187
 v_cvt_pk_bf16_f32 v238,v180,v181
 M v[124:127],v[156:159],a[140:143],v[124:127]
 W 6
 v_cvt_pk_bf16_f32 v239,v182,v183
 v_cvt_pk_bf16_f32 v240,v188,v189
 M v[0:3],v[128:131],a[144:147],v[0:3]
 T v[144:145],v212,28672
 T v[146:147],v212,30720
 M v[4:7],v[128:131],a[148:151],v[4:7]
 v_cvt_pk_bf16_f32 v241,v190,v191
 M v[8:11],v[128:131],a[152:155],v[8:11]
 v_permlane32_swap_b32 v234,v238
 M v[12:15],v[128:131],a[156:159],v[12:15]
 W 6
 v_permlane32_swap_b32 v235,v239
 M v[16:19],v[132:135],a[144:147],v[16:19]
 T v[148:149],v213,28672
 T v[150:151],v213,30720
 M v[20:23],v[132:135],a[148:151],v[20:23]
 s_add_u32 m0,s72,57344
 s_add_u32 s68,s76,32768
 buffer_load_dwordx4 v220,s[44:47],s68 offen lds
 M v[24:27],v[132:135],a[152:155],v[24:27]
 v_permlane32_swap_b32 v236,v240
 M v[28:31],v[132:135],a[156:159],v[28:31]
 W 6
 v_permlane32_swap_b32 v237,v241
 M v[32:35],v[136:139],a[144:147],v[32:35]
 T v[152:153],v214,28672
 T v[154:155],v214,30720
 M v[36:39],v[136:139],a[148:151],v[36:39]
 s_add_u32 m0,s72,61440
 s_add_u32 s68,s76,32896
 buffer_load_dwordx4 v220,s[44:47],s68 offen lds
 M v[40:43],v[136:139],a[152:155],v[40:43]
 v_permlane16_swap_b32 v234,v238
 M v[44:47],v[136:139],a[156:159],v[44:47]
 W 6
 v_permlane16_swap_b32 v235,v239
 M v[48:51],v[140:143],a[144:147],v[48:51]
 T v[156:157],v215,28672
 T v[158:159],v215,30720
 M v[52:55],v[140:143],a[148:151],v[52:55]
 s_add_u32 m0,s72,65536
 s_add_u32 s68,s87,0
 buffer_load_dwordx4 v220,s[44:47],s68 offen lds
 M v[56:59],v[140:143],a[152:155],v[56:59]
 v_permlane16_swap_b32 v236,v240
 M v[60:63],v[140:143],a[156:159],v[60:63]
 W 6
 v_permlane16_swap_b32 v237,v241
 M v[64:67],v[144:147],a[144:147],v[64:67]
 T v[128:129],v216,0
 T v[130:131],v216,2048
 M v[68:71],v[144:147],a[148:151],v[68:71]
 s_add_u32 m0,s72,69632
 s_add_u32 s68,s87,128
 buffer_load_dwordx4 v220,s[44:47],s68 offen lds
 M v[72:75],v[144:147],a[152:155],v[72:75]
 buffer_store_dwordx4 v[234:237],v224,s[8:11],s96 offen offset:1024 sc0 sc1
 buffer_store_dwordx4 v[238:241],v224,s[8:11],s97 offen offset:1024 sc0 sc1
 M v[76:79],v[144:147],a[156:159],v[76:79]
 W 6
 v_accvgpr_write_b32 a24,v234
 v_accvgpr_write_b32 a25,v235
 M v[80:83],v[148:151],a[144:147],v[80:83]
 T v[132:133],v217,0
 T v[134:135],v217,2048
 M v[84:87],v[148:151],a[148:151],v[84:87]
 s_add_u32 m0,s72,73728
 s_add_u32 s68,s87,32768
 buffer_load_dwordx4 v220,s[44:47],s68 offen lds
 M v[88:91],v[148:151],a[152:155],v[88:91]
 v_accvgpr_write_b32 a26,v236
 v_accvgpr_write_b32 a27,v237
 M v[92:95],v[148:151],a[156:159],v[92:95]
 W 6
 v_accvgpr_write_b32 a28,v238
 v_accvgpr_write_b32 a29,v239
 M v[96:99],v[152:155],a[144:147],v[96:99]
 T v[136:137],v218,0
 T v[138:139],v218,2048
 M v[100:103],v[152:155],a[148:151],v[100:103]
 s_add_u32 m0,s72,77824
 s_add_u32 s68,s87,32896
 buffer_load_dwordx4 v220,s[44:47],s68 offen lds
 M v[104:107],v[152:155],a[152:155],v[104:107]
 v_accvgpr_write_b32 a30,v240
 v_accvgpr_write_b32 a31,v241
 M v[108:111],v[152:155],a[156:159],v[108:111]
 W 6
 v_accvgpr_read_b32 v160,a96
 v_accvgpr_read_b32 v161,a97
 M v[112:115],v[156:159],a[144:147],v[112:115]
 T v[140:141],v219,0
 T v[142:143],v219,2048
 M v[116:119],v[156:159],a[148:151],v[116:119]
 s_add_u32 m0,s72,81920
 s_add_u32 s68,s87,65536
 buffer_load_dwordx4 v220,s[44:47],s68 offen lds
 M v[120:123],v[156:159],a[152:155],v[120:123]
 v_accvgpr_read_b32 v162,a98
 v_accvgpr_read_b32 v163,a99
 M v[124:127],v[156:159],a[156:159],v[124:127]
 W 6
 v_accvgpr_read_b32 v164,a100
 v_accvgpr_read_b32 v165,a101
 s_waitcnt vmcnt(34)
 M v[0:3],v[128:131],a[160:163],v[0:3]
 T v[144:145],v216,4096
 T v[146:147],v216,6144
 s_waitcnt vmcnt(33)
 M v[4:7],v[128:131],a[164:167],v[4:7]
 s_add_u32 m0,s72,86016
 s_add_u32 s68,s87,65664
 buffer_load_dwordx4 v220,s[44:47],s68 offen lds
 s_waitcnt vmcnt(33)
 M v[8:11],v[128:131],a[168:171],v[8:11]
 v_accvgpr_read_b32 v166,a102
 v_accvgpr_read_b32 v167,a103
 s_waitcnt vmcnt(32)
 M v[12:15],v[128:131],a[172:175],v[12:15]
 W 6
 v_accvgpr_read_b32 v168,a104
 v_accvgpr_read_b32 v169,a105
 M v[16:19],v[132:135],a[160:163],v[16:19]
 T v[148:149],v217,4096
 T v[150:151],v217,6144
 M v[20:23],v[132:135],a[164:167],v[20:23]
 s_add_u32 m0,s72,90112
 s_add_u32 s68,s87,98304
 buffer_load_dwordx4 v220,s[44:47],s68 offen lds
 M v[24:27],v[132:135],a[168:171],v[24:27]
 v_accvgpr_read_b32 v170,a106
 v_accvgpr_read_b32 v171,a107
 M v[28:31],v[132:135],a[172:175],v[28:31]
 W 6
 v_accvgpr_read_b32 v172,a108
 v_accvgpr_read_b32 v173,a109
 M v[32:35],v[136:139],a[160:163],v[32:35]
 T v[152:153],v218,4096
 T v[154:155],v218,6144
 M v[36:39],v[136:139],a[164:167],v[36:39]
 s_add_u32 m0,s72,94208
 s_add_u32 s68,s87,98432
 buffer_load_dwordx4 v220,s[44:47],s68 offen lds
 M v[40:43],v[136:139],a[168:171],v[40:43]
 v_accvgpr_read_b32 v174,a110
 v_accvgpr_read_b32 v175,a111
 M v[44:47],v[136:139],a[172:175],v[44:47]
 W 6
 v_mul_f32 v160,v160,v198
 v_mul_f32 v161,v161,v198
 M v[48:51],v[140:143],a[160:163],v[48:51]
 T v[156:157],v219,4096
 T v[158:159],v219,6144
 M v[52:55],v[140:143],a[164:167],v[52:55]
 s_add_u32 m0,s72,98304
 s_add_u32 s68,s88,0
 buffer_load_dwordx4 v220,s[44:47],s68 offen lds
 M v[56:59],v[140:143],a[168:171],v[56:59]
 v_mul_f32 v162,v162,v198
 v_mul_f32 v163,v163,v198
 M v[60:63],v[140:143],a[172:175],v[60:63]
 W 6
 v_mul_f32 v164,v164,v198
 v_mul_f32 v165,v165,v198
 M v[64:67],v[144:147],a[160:163],v[64:67]
 T v[128:129],v216,8192
 T v[130:131],v216,10240
 M v[68:71],v[144:147],a[164:167],v[68:71]
 s_add_u32 m0,s72,102400
 s_add_u32 s68,s88,128
 buffer_load_dwordx4 v220,s[44:47],s68 offen lds
 M v[72:75],v[144:147],a[168:171],v[72:75]
 v_mul_f32 v166,v166,v198
 v_mul_f32 v167,v167,v198
 M v[76:79],v[144:147],a[172:175],v[76:79]
 W 6
 v_mul_f32 v168,v168,v198
 v_mul_f32 v169,v169,v198
 M v[80:83],v[148:151],a[160:163],v[80:83]
 T v[132:133],v217,8192
 T v[134:135],v217,10240
 M v[84:87],v[148:151],a[164:167],v[84:87]
 s_add_u32 m0,s72,106496
 s_add_u32 s68,s88,32768
 buffer_load_dwordx4 v220,s[44:47],s68 offen lds
 M v[88:91],v[148:151],a[168:171],v[88:91]
 v_mul_f32 v170,v170,v198
 v_mul_f32 v171,v171,v198
 M v[92:95],v[148:151],a[172:175],v[92:95]
 W 6
 v_mul_f32 v172,v172,v198
 v_mul_f32 v173,v173,v198
 M v[96:99],v[152:155],a[160:163],v[96:99]
 T v[136:137],v218,8192
 T v[138:139],v218,10240
 M v[100:103],v[152:155],a[164:167],v[100:103]
 s_add_u32 m0,s72,110592
 s_add_u32 s68,s88,32896
 buffer_load_dwordx4 v220,s[44:47],s68 offen lds
 M v[104:107],v[152:155],a[168:171],v[104:107]
 v_mul_f32 v174,v174,v198
 v_mul_f32 v175,v175,v198
 M v[108:111],v[152:155],a[172:175],v[108:111]
 W 6
 v_cvt_pk_bf16_f32 v226,v160,v161
 v_cvt_pk_bf16_f32 v227,v162,v163
 M v[112:115],v[156:159],a[160:163],v[112:115]
 T v[140:141],v219,8192
 T v[142:143],v219,10240
 M v[116:119],v[156:159],a[164:167],v[116:119]
 s_add_u32 m0,s72,114688
 s_add_u32 s68,s88,65536
 buffer_load_dwordx4 v220,s[44:47],s68 offen lds
 M v[120:123],v[156:159],a[168:171],v[120:123]
 v_cvt_pk_bf16_f32 v228,v168,v169
 v_cvt_pk_bf16_f32 v229,v170,v171
 M v[124:127],v[156:159],a[172:175],v[124:127]
 W 6
 v_cvt_pk_bf16_f32 v230,v164,v165
 v_cvt_pk_bf16_f32 v231,v166,v167
 s_waitcnt vmcnt(38)
 M v[0:3],v[128:131],a[176:179],v[0:3]
 T v[144:145],v216,12288
 T v[146:147],v216,14336
 s_waitcnt vmcnt(37)
 M v[4:7],v[128:131],a[180:183],v[4:7]
 s_add_u32 m0,s72,118784
 s_add_u32 s68,s88,65664
 buffer_load_dwordx4 v220,s[44:47],s68 offen lds
 s_waitcnt vmcnt(37)
 M v[8:11],v[128:131],a[184:187],v[8:11]
 v_cvt_pk_bf16_f32 v232,v172,v173
 v_cvt_pk_bf16_f32 v233,v174,v175
 s_waitcnt vmcnt(36)
 M v[12:15],v[128:131],a[188:191],v[12:15]
 W 6
 v_permlane32_swap_b32 v226,v230
 M v[16:19],v[132:135],a[176:179],v[16:19]
 T v[148:149],v217,12288
 T v[150:151],v217,14336
 M v[20:23],v[132:135],a[180:183],v[20:23]
 s_add_u32 m0,s72,122880
 s_add_u32 s68,s88,98304
 buffer_load_dwordx4 v220,s[44:47],s68 offen lds
 M v[24:27],v[132:135],a[184:187],v[24:27]
 v_permlane32_swap_b32 v227,v231
 M v[28:31],v[132:135],a[188:191],v[28:31]
 W 6
 v_permlane32_swap_b32 v228,v232
 M v[32:35],v[136:139],a[176:179],v[32:35]
 T v[152:153],v218,12288
 T v[154:155],v218,14336
 M v[36:39],v[136:139],a[180:183],v[36:39]
 s_add_u32 m0,s72,126976
 s_add_u32 s68,s88,98432
 buffer_load_dwordx4 v220,s[44:47],s68 offen lds
 M v[40:43],v[136:139],a[184:187],v[40:43]
 v_permlane32_swap_b32 v229,v233
 M v[44:47],v[136:139],a[188:191],v[44:47]
 W 6
 v_permlane16_swap_b32 v226,v230
 M v[48:51],v[140:143],a[176:179],v[48:51]
 T v[156:157],v219,12288
 T v[158:159],v219,14336
 M v[52:55],v[140:143],a[180:183],v[52:55]
 v_permlane16_swap_b32 v227,v231
 M v[56:59],v[140:143],a[184:187],v[56:59]
 v_permlane16_swap_b32 v228,v232
 M v[60:63],v[140:143],a[188:191],v[60:63]
 W 6
 v_permlane16_swap_b32 v229,v233
 M v[64:67],v[144:147],a[176:179],v[64:67]
 T v[128:129],v216,16384
 T v[130:131],v216,18432
 M v[68:71],v[144:147],a[180:183],v[68:71]
 buffer_store_dwordx4 v[226:229],v224,s[8:11],s96 offen offset:2048 sc0 sc1
 buffer_store_dwordx4 v[230:233],v224,s[8:11],s97 offen offset:2048 sc0 sc1
 M v[72:75],v[144:147],a[184:187],v[72:75]
 v_accvgpr_write_b32 a40,v226
 v_accvgpr_write_b32 a41,v227
 M v[76:79],v[144:147],a[188:191],v[76:79]
 W 6
 v_accvgpr_write_b32 a42,v228
 v_accvgpr_write_b32 a43,v229
 M v[80:83],v[148:151],a[176:179],v[80:83]
 T v[132:133],v217,16384
 T v[134:135],v217,18432
 M v[84:87],v[148:151],a[180:183],v[84:87]
 v_accvgpr_write_b32 a44,v230
 v_accvgpr_write_b32 a45,v231
 M v[88:91],v[148:151],a[184:187],v[88:91]
 v_accvgpr_write_b32 a46,v232
 v_accvgpr_write_b32 a47,v233
 M v[92:95],v[148:151],a[188:191],v[92:95]
 W 6
 v_accvgpr_read_b32 v176,a112
 v_accvgpr_read_b32 v177,a113
 M v[96:99],v[152:155],a[176:179],v[96:99]
 T v[136:137],v218,16384
 T v[138:139],v218,18432
 M v[100:103],v[152:155],a[180:183],v[100:103]
 v_accvgpr_read_b32 v178,a114
 v_accvgpr_read_b32 v179,a115
 M v[104:107],v[152:155],a[184:187],v[104:107]
 v_accvgpr_read_b32 v180,a116
 v_accvgpr_read_b32 v181,a117
 M v[108:111],v[152:155],a[188:191],v[108:111]
 W 6
 v_accvgpr_read_b32 v182,a118
 v_accvgpr_read_b32 v183,a119
 M v[112:115],v[156:159],a[176:179],v[112:115]
 T v[140:141],v219,16384
 T v[142:143],v219,18432
 M v[116:119],v[156:159],a[180:183],v[116:119]
 v_accvgpr_read_b32 v184,a120
 v_accvgpr_read_b32 v185,a121
 M v[120:123],v[156:159],a[184:187],v[120:123]
 v_accvgpr_read_b32 v186,a122
 v_accvgpr_read_b32 v187,a123
 M v[124:127],v[156:159],a[188:191],v[124:127]
 W 6
 v_accvgpr_read_b32 v188,a124
 v_accvgpr_read_b32 v189,a125
 s_waitcnt vmcnt(39)
 M v[0:3],v[128:131],a[192:195],v[0:3]
 T v[144:145],v216,20480
 T v[146:147],v216,22528
 s_waitcnt vmcnt(38)
 M v[4:7],v[128:131],a[196:199],v[4:7]
 v_accvgpr_read_b32 v190,a126
 v_accvgpr_read_b32 v191,a127
 s_waitcnt vmcnt(37)
 M v[8:11],v[128:131],a[200:203],v[8:11]
 v_mul_f32 v176,v176,v198
 v_mul_f32 v177,v177,v198
 s_waitcnt vmcnt(36)
 M v[12:15],v[128:131],a[204:207],v[12:15]
 W 6
 v_mul_f32 v178,v178,v198
 v_mul_f32 v179,v179,v198
 M v[16:19],v[132:135],a[192:195],v[16:19]
 T v[148:149],v217,20480
 T v[150:151],v217,22528
 M v[20:23],v[132:135],a[196:199],v[20:23]
 v_mul_f32 v180,v180,v198
 v_mul_f32 v181,v181,v198
 M v[24:27],v[132:135],a[200:203],v[24:27]
 v_mul_f32 v182,v182,v198
 v_mul_f32 v183,v183,v198
 M v[28:31],v[132:135],a[204:207],v[28:31]
 W 6
 v_mul_f32 v184,v184,v198
 v_mul_f32 v185,v185,v198
 M v[32:35],v[136:139],a[192:195],v[32:35]
 T v[152:153],v218,20480
 T v[154:155],v218,22528
 M v[36:39],v[136:139],a[196:199],v[36:39]
 v_mul_f32 v186,v186,v198
 v_mul_f32 v187,v187,v198
 M v[40:43],v[136:139],a[200:203],v[40:43]
 v_mul_f32 v188,v188,v198
 v_mul_f32 v189,v189,v198
 M v[44:47],v[136:139],a[204:207],v[44:47]
 W 6
 v_mul_f32 v190,v190,v198
 v_mul_f32 v191,v191,v198
 M v[48:51],v[140:143],a[192:195],v[48:51]
 T v[156:157],v219,20480
 T v[158:159],v219,22528
 M v[52:55],v[140:143],a[196:199],v[52:55]
 v_cvt_pk_bf16_f32 v234,v176,v177
 v_cvt_pk_bf16_f32 v235,v178,v179
 M v[56:59],v[140:143],a[200:203],v[56:59]
 v_cvt_pk_bf16_f32 v236,v184,v185
 v_cvt_pk_bf16_f32 v237,v186,v187
 M v[60:63],v[140:143],a[204:207],v[60:63]
 W 6
 v_cvt_pk_bf16_f32 v238,v180,v181
 v_cvt_pk_bf16_f32 v239,v182,v183
 M v[64:67],v[144:147],a[192:195],v[64:67]
 T v[128:129],v216,24576
 T v[130:131],v216,26624
 M v[68:71],v[144:147],a[196:199],v[68:71]
 v_cvt_pk_bf16_f32 v240,v188,v189
 v_cvt_pk_bf16_f32 v241,v190,v191
 M v[72:75],v[144:147],a[200:203],v[72:75]
 v_permlane32_swap_b32 v234,v238
 M v[76:79],v[144:147],a[204:207],v[76:79]
 W 6
 v_permlane32_swap_b32 v235,v239
 M v[80:83],v[148:151],a[192:195],v[80:83]
 T v[132:133],v217,24576
 T v[134:135],v217,26624
 M v[84:87],v[148:151],a[196:199],v[84:87]
 v_permlane32_swap_b32 v236,v240
 M v[88:91],v[148:151],a[200:203],v[88:91]
 v_permlane32_swap_b32 v237,v241
 M v[92:95],v[148:151],a[204:207],v[92:95]
 W 6
 v_permlane16_swap_b32 v234,v238
 M v[96:99],v[152:155],a[192:195],v[96:99]
 T v[136:137],v218,24576
 T v[138:139],v218,26624
 M v[100:103],v[152:155],a[196:199],v[100:103]
 buffer_load_dword v207,v208,s[8:11],0 offen sc1
 M v[104:107],v[152:155],a[200:203],v[104:107]
 v_permlane16_swap_b32 v235,v239
 M v[108:111],v[152:155],a[204:207],v[108:111]
 W 6
 v_permlane16_swap_b32 v236,v240
 M v[112:115],v[156:159],a[192:195],v[112:115]
 T v[140:141],v219,24576
 T v[142:143],v219,26624
 M v[116:119],v[156:159],a[196:199],v[116:119]
 v_permlane16_swap_b32 v237,v241
 M v[120:123],v[156:159],a[200:203],v[120:123]
 buffer_store_dwordx4 v[234:237],v224,s[8:11],s96 offen offset:3072 sc0 sc1
 buffer_store_dwordx4 v[238:241],v224,s[8:11],s97 offen offset:3072 sc0 sc1
 M v[124:127],v[156:159],a[204:207],v[124:127]
 W 6
 v_accvgpr_write_b32 a56,v234
 v_accvgpr_write_b32 a57,v235
 s_waitcnt vmcnt(38)
 M v[0:3],v[128:131],a[208:211],v[0:3]
 T v[144:145],v216,28672
 T v[146:147],v216,30720
 s_waitcnt vmcnt(37)
 M v[4:7],v[128:131],a[212:215],v[4:7]
 v_accvgpr_write_b32 a58,v236
 v_accvgpr_write_b32 a59,v237
 s_waitcnt vmcnt(36)
 M v[8:11],v[128:131],a[216:219],v[8:11]
 v_accvgpr_write_b32 a60,v238
 v_accvgpr_write_b32 a61,v239
 s_waitcnt vmcnt(33)
 M v[12:15],v[128:131],a[220:223],v[12:15]
 W 6
 v_accvgpr_write_b32 a62,v240
 v_accvgpr_write_b32 a63,v241
 M v[16:19],v[132:135],a[208:211],v[16:19]
 T v[148:149],v217,28672
 T v[150:151],v217,30720
 M v[20:23],v[132:135],a[212:215],v[20:23]
 M v[24:27],v[132:135],a[216:219],v[24:27]
 M v[28:31],v[132:135],a[220:223],v[28:31]
 W 6
 M v[32:35],v[136:139],a[208:211],v[32:35]
 T v[152:153],v218,28672
 T v[154:155],v218,30720
 M v[36:39],v[136:139],a[212:215],v[36:39]
 M v[40:43],v[136:139],a[216:219],v[40:43]
 M v[44:47],v[136:139],a[220:223],v[44:47]
 W 6
 M v[48:51],v[140:143],a[208:211],v[48:51]
 T v[156:157],v219,28672
 T v[158:159],v219,30720
 M v[52:55],v[140:143],a[212:215],v[52:55]
 M v[56:59],v[140:143],a[216:219],v[56:59]
 M v[60:63],v[140:143],a[220:223],v[60:63]
 W 6
 s_barrier
 M v[64:67],v[144:147],a[208:211],v[64:67]
 T v[128:129],v216,32768
 T v[130:131],v216,34816
 M v[68:71],v[144:147],a[212:215],v[68:71]
 s_add_u32 m0,s72,0
 s_add_u32 s68,s76,65536
 buffer_load_dwordx4 v220,s[44:47],s68 offen lds
 M v[72:75],v[144:147],a[216:219],v[72:75]
 M v[76:79],v[144:147],a[220:223],v[76:79]
 W 6
 M v[80:83],v[148:151],a[208:211],v[80:83]
 T v[132:133],v217,32768
 T v[134:135],v217,34816
 M v[84:87],v[148:151],a[212:215],v[84:87]
 s_add_u32 m0,s72,4096
 s_add_u32 s68,s76,65664
 buffer_load_dwordx4 v220,s[44:47],s68 offen lds
 M v[88:91],v[148:151],a[216:219],v[88:91]
 M v[92:95],v[148:151],a[220:223],v[92:95]
 W 6
 M v[96:99],v[152:155],a[208:211],v[96:99]
 T v[136:137],v218,32768
 T v[138:139],v218,34816
 M v[100:103],v[152:155],a[212:215],v[100:103]
 s_add_u32 m0,s72,8192
 s_add_u32 s68,s76,98304
 buffer_load_dwordx4 v220,s[44:47],s68 offen lds
 M v[104:107],v[152:155],a[216:219],v[104:107]
 M v[108:111],v[152:155],a[220:223],v[108:111]
 W 6
 M v[112:115],v[156:159],a[208:211],v[112:115]
 T v[140:141],v219,32768
 T v[142:143],v219,34816
 M v[116:119],v[156:159],a[212:215],v[116:119]
 s_add_u32 m0,s72,12288
 s_add_u32 s68,s76,98432
 buffer_load_dwordx4 v220,s[44:47],s68 offen lds
 M v[120:123],v[156:159],a[216:219],v[120:123]
 M v[124:127],v[156:159],a[220:223],v[124:127]
 W 6
 s_waitcnt vmcnt(36)
 M v[0:3],v[128:131],a[224:227],v[0:3]
 T v[144:145],v216,36864
 T v[146:147],v216,38912
 s_waitcnt vmcnt(35)
 M v[4:7],v[128:131],a[228:231],v[4:7]
 s_add_u32 m0,s72,131072
 s_add_u32 s68,s89,0
 buffer_load_dwordx4 v220,s[44:47],s68 offen lds
 s_waitcnt vmcnt(35)
 M v[8:11],v[128:131],a[232:235],v[8:11]
 s_waitcnt vmcnt(34)
 M v[12:15],v[128:131],a[236:239],v[12:15]
 W 6
 M v[16:19],v[132:135],a[224:227],v[16:19]
 T v[148:149],v217,36864
 T v[150:151],v217,38912
 M v[20:23],v[132:135],a[228:231],v[20:23]
 s_add_u32 m0,s72,135168
 s_add_u32 s68,s89,128
 buffer_load_dwordx4 v220,s[44:47],s68 offen lds
 M v[24:27],v[132:135],a[232:235],v[24:27]
 M v[28:31],v[132:135],a[236:239],v[28:31]
 W 6
 M v[32:35],v[136:139],a[224:227],v[32:35]
 T v[152:153],v218,36864
 T v[154:155],v218,38912
 M v[36:39],v[136:139],a[228:231],v[36:39]
 s_add_u32 s63,s62,2
 s_waitcnt vmcnt(8)
 v_subrev_u32 v207,s63,v207
 v_cmp_le_u32 vcc,8,v207
 s_cbranch_vccz PL_ok13
 s_mov_b32 s69,0x100000
PL_sp13:
 s_sleep 2
 buffer_load_dword v207,v208,s[8:11],0 offen sc1
 s_waitcnt vmcnt(0)
 v_subrev_u32 v207,s63,v207
 v_cmp_le_u32 vcc,8,v207
 s_cbranch_vccz PL_ok13
 s_sub_u32 s69,s69,1
 s_cbranch_scc0 PL_sp13
PL_ok13:
 s_add_u32 m0,s72,139264
 s_add_u32 s68,s89,32768
 buffer_load_dwordx4 v220,s[44:47],s68 offen lds
 M v[40:43],v[136:139],a[232:235],v[40:43]
 M v[44:47],v[136:139],a[236:239],v[44:47]
 W 6
 M v[48:51],v[140:143],a[224:227],v[48:51]
 T v[156:157],v219,36864
 T v[158:159],v219,38912
 M v[52:55],v[140:143],a[228:231],v[52:55]
 s_add_u32 m0,s72,143360
 s_add_u32 s68,s89,32896
 buffer_load_dwordx4 v220,s[44:47],s68 offen lds
 M v[56:59],v[140:143],a[232:235],v[56:59]
 M v[60:63],v[140:143],a[236:239],v[60:63]
 W 6
 M v[64:67],v[144:147],a[224:227],v[64:67]
 T v[128:129],v216,40960
 T v[130:131],v216,43008
 M v[68:71],v[144:147],a[228:231],v[68:71]
 s_add_u32 m0,s72,147456
 s_add_u32 s68,s89,65536
 buffer_load_dwordx4 v220,s[44:47],s68 offen lds
 M v[72:75],v[144:147],a[232:235],v[72:75]
 s_waitcnt vmcnt(9)
 v_add_u32 v211,1,v211
 buffer_store_dword v211,v210,s[8:11],s73 offen sc0 sc1
 M v[76:79],v[144:147],a[236:239],v[76:79]
 W 6
 M v[80:83],v[148:151],a[224:227],v[80:83]
 T v[132:133],v217,40960
 T v[134:135],v217,43008
 M v[84:87],v[148:151],a[228:231],v[84:87]
 s_add_u32 m0,s72,151552
 s_add_u32 s68,s89,65664
 buffer_load_dwordx4 v220,s[44:47],s68 offen lds
 M v[88:91],v[148:151],a[232:235],v[88:91]
 M v[92:95],v[148:151],a[236:239],v[92:95]
 W 6
 M v[96:99],v[152:155],a[224:227],v[96:99]
 T v[136:137],v218,40960
 T v[138:139],v218,43008
 M v[100:103],v[152:155],a[228:231],v[100:103]
 s_add_u32 m0,s72,155648
 s_add_u32 s68,s89,98304
 buffer_load_dwordx4 v220,s[44:47],s68 offen lds
 M v[104:107],v[152:155],a[232:235],v[104:107]
 M v[108:111],v[152:155],a[236:239],v[108:111]
 W 6
 M v[112:115],v[156:159],a[224:227],v[112:115]
 T v[140:141],v219,40960
 T v[142:143],v219,43008
 M v[116:119],v[156:159],a[228:231],v[116:119]
 s_add_u32 m0,s72,159744
 s_add_u32 s68,s89,98432
 buffer_load_dwordx4 v220,s[44:47],s68 offen lds
 M v[120:123],v[156:159],a[232:235],v[120:123]
 M v[124:127],v[156:159],a[236:239],v[124:127]
 W 6
 M v[0:3],v[128:131],a[240:243],v[0:3]
 T v[144:145],v216,45056
 T v[146:147],v216,47104
 M v[4:7],v[128:131],a[244:247],v[4:7]
 s_add_u32 s81,s95,s84
 buffer_load_dwordx4 a[128:131],v224,s[8:11],s81 offen offset:0 sc1
 M v[8:11],v[128:131],a[248:251],v[8:11]
 M v[12:15],v[128:131],a[252:255],v[12:15]
 W 6
 M v[16:19],v[132:135],a[240:243],v[16:19]
 T v[148:149],v217,45056
 T v[150:151],v217,47104
 M v[20:23],v[132:135],a[244:247],v[20:23]
 buffer_load_dwordx4 a[132:135],v221,s[8:11],s81 offen offset:0 sc1
 M v[24:27],v[132:135],a[248:251],v[24:27]
 M v[28:31],v[132:135],a[252:255],v[28:31]
 W 6
 M v[32:35],v[136:139],a[240:243],v[32:35]
 T v[152:153],v218,45056
 T v[154:155],v218,47104
 M v[36:39],v[136:139],a[244:247],v[36:39]
 buffer_load_dwordx4 a[136:139],v224,s[8:11],s81 offen offset:1024 sc1
 M v[40:43],v[136:139],a[248:251],v[40:43]
 M v[44:47],v[136:139],a[252:255],v[44:47]
 W 6
 M v[48:51],v[140:143],a[240:243],v[48:51]
 T v[156:157],v219,45056
 T v[158:159],v219,47104
 M v[52:55],v[140:143],a[244:247],v[52:55]
 buffer_load_dwordx4 a[140:143],v221,s[8:11],s81 offen offset:1024 sc1
 M v[56:59],v[140:143],a[248:251],v[56:59]
 M v[60:63],v[140:143],a[252:255],v[60:63]
 W 6
 s_waitcnt vmcnt(13)
 s_barrier
 M v[64:67],v[144:147],a[240:243],v[64:67]
 T v[128:129],v216,49152
 T v[130:131],v216,51200
 M v[68:71],v[144:147],a[244:247],v[68:71]
 buffer_load_dwordx4 a[144:147],v224,s[8:11],s81 offen offset:2048 sc1
 M v[72:75],v[144:147],a[248:251],v[72:75]
 M v[76:79],v[144:147],a[252:255],v[76:79]
 W 6
 M v[80:83],v[148:151],a[240:243],v[80:83]
 T v[132:133],v217,49152
 T v[134:135],v217,51200
 M v[84:87],v[148:151],a[244:247],v[84:87]
 buffer_load_dwordx4 a[148:151],v221,s[8:11],s81 offen offset:2048 sc1
 M v[88:91],v[148:151],a[248:251],v[88:91]
 M v[92:95],v[148:151],a[252:255],v[92:95]
 W 6
 M v[96:99],v[152:155],a[240:243],v[96:99]
 T v[136:137],v218,49152
 T v[138:139],v218,51200
 M v[100:103],v[152:155],a[244:247],v[100:103]
 buffer_load_dwordx4 a[152:155],v224,s[8:11],s81 offen offset:3072 sc1
 M v[104:107],v[152:155],a[248:251],v[104:107]
 M v[108:111],v[152:155],a[252:255],v[108:111]
 W 6
 M v[112:115],v[156:159],a[240:243],v[112:115]
 T v[140:141],v219,49152
 T v[142:143],v219,51200
 M v[116:119],v[156:159],a[244:247],v[116:119]
 buffer_load_dwordx4 a[156:159],v221,s[8:11],s81 offen offset:3072 sc1
 M v[120:123],v[156:159],a[248:251],v[120:123]
 M v[124:127],v[156:159],a[252:255],v[124:127]
 W 6
 M v[0:3],v[128:131],a[0:3],v[0:3]
 T v[144:145],v216,53248
 T v[146:147],v216,55296
 M v[4:7],v[128:131],a[4:7],v[4:7]
 s_add_u32 s81,s95,s85
 buffer_load_dwordx4 a[160:163],v224,s[8:11],s81 offen offset:0 sc1
 M v[8:11],v[128:131],a[8:11],v[8:11]
 M v[12:15],v[128:131],a[12:15],v[12:15]
 W 6
 M v[16:19],v[132:135],a[0:3],v[16:19]
 T v[148:149],v217,53248
 T v[150:151],v217,55296
 M v[20:23],v[132:135],a[4:7],v[20:23]
 buffer_load_dwordx4 a[164:167],v221,s[8:11],s81 offen offset:0 sc1
 M v[24:27],v[132:135],a[8:11],v[24:27]
 M v[28:31],v[132:135],a[12:15],v[28:31]
 W 6
 M v[32:35],v[136:139],a[0:3],v[32:35]
 T v[152:153],v218,53248
 T v[154:155],v218,55296
 M v[36:39],v[136:139],a[4:7],v[36:39]
 buffer_load_dwordx4 a[168:171],v224,s[8:11],s81 offen offset:1024 sc1
 M v[40:43],v[136:139],a[8:11],v[40:43]
 M v[44:47],v[136:139],a[12:15],v[44:47]
 W 6
 M v[48:51],v[140:143],a[0:3],v[48:51]
 T v[156:157],v219,53248
 T v[158:159],v219,55296
 M v[52:55],v[140:143],a[4:7],v[52:55]
 buffer_load_dwordx4 a[172:175],v221,s[8:11],s81 offen offset:1024 sc1
 M v[56:59],v[140:143],a[8:11],v[56:59]
 M v[60:63],v[140:143],a[12:15],v[60:63]
 W 6
 M v[64:67],v[144:147],a[0:3],v[64:67]
 T v[128:129],v216,57344
 T v[130:131],v216,59392
 M v[68:71],v[144:147],a[4:7],v[68:71]
 buffer_load_dwordx4 a[176:179],v224,s[8:11],s81 offen offset:2048 sc1
 M v[72:75],v[144:147],a[8:11],v[72:75]
 M v[76:79],v[144:147],a[12:15],v[76:79]
 W 6
 M v[80:83],v[148:151],a[0:3],v[80:83]
 T v[132:133],v217,57344
 T v[134:135],v217,59392
 M v[84:87],v[148:151],a[4:7],v[84:87]
 buffer_load_dwordx4 a[180:183],v221,s[8:11],s81 offen offset:2048 sc1
 M v[88:91],v[148:151],a[8:11],v[88:91]
 M v[92:95],v[148:151],a[12:15],v[92:95]
 W 6
 M v[96:99],v[152:155],a[0:3],v[96:99]
 T v[136:137],v218,57344
 T v[138:139],v218,59392
 M v[100:103],v[152:155],a[4:7],v[100:103]
 buffer_load_dwordx4 a[184:187],v224,s[8:11],s81 offen offset:3072 sc1
 M v[104:107],v[152:155],a[8:11],v[104:107]
 M v[108:111],v[152:155],a[12:15],v[108:111]
 W 6
 M v[112:115],v[156:159],a[0:3],v[112:115]
 T v[140:141],v219,57344
 T v[142:143],v219,59392
 M v[116:119],v[156:159],a[4:7],v[116:119]
 buffer_load_dwordx4 a[188:191],v221,s[8:11],s81 offen offset:3072 sc1
 M v[120:123],v[156:159],a[8:11],v[120:123]
 M v[124:127],v[156:159],a[12:15],v[124:127]
 W 6
 M v[0:3],v[128:131],a[16:19],v[0:3]
 T v[144:145],v216,61440
 T v[146:147],v216,63488
 M v[4:7],v[128:131],a[20:23],v[4:7]
 s_add_u32 s81,s95,s86
 buffer_load_dwordx4 a[192:195],v224,s[8:11],s81 offen offset:0 sc1
 M v[8:11],v[128:131],a[24:27],v[8:11]
 M v[12:15],v[128:131],a[28:31],v[12:15]
 W 6
 M v[16:19],v[132:135],a[16:19],v[16:19]
 T v[148:149],v217,61440
 T v[150:151],v217,63488
 M v[20:23],v[132:135],a[20:23],v[20:23]
 buffer_load_dwordx4 a[196:199],v221,s[8:11],s81 offen offset:0 sc1
 M v[24:27],v[132:135],a[24:27],v[24:27]
 M v[28:31],v[132:135],a[28:31],v[28:31]
 W 6
 M v[32:35],v[136:139],a[16:19],v[32:35]
 T v[152:153],v218,61440
 T v[154:155],v218,63488
 M v[36:39],v[136:139],a[20:23],v[36:39]
 buffer_load_dwordx4 a[200:203],v224,s[8:11],s81 offen offset:1024 sc1
 M v[40:43],v[136:139],a[24:27],v[40:43]
 M v[44:47],v[136:139],a[28:31],v[44:47]
 W 6
 M v[48:51],v[140:143],a[16:19],v[48:51]
 T v[156:157],v219,61440
 T v[158:159],v219,63488
 M v[52:55],v[140:143],a[20:23],v[52:55]
 buffer_load_dwordx4 a[204:207],v221,s[8:11],s81 offen offset:1024 sc1
 M v[56:59],v[140:143],a[24:27],v[56:59]
 M v[60:63],v[140:143],a[28:31],v[60:63]
 W 6
 M v[64:67],v[144:147],a[16:19],v[64:67]
 T v[128:129],v216,0
 T v[130:131],v216,2048
 M v[68:71],v[144:147],a[20:23],v[68:71]
 buffer_load_dwordx4 a[208:211],v224,s[8:11],s81 offen offset:2048 sc1
 M v[72:75],v[144:147],a[24:27],v[72:75]
 M v[76:79],v[144:147],a[28:31],v[76:79]
 W 6
 M v[80:83],v[148:151],a[16:19],v[80:83]
 T v[132:133],v217,0
 T v[134:135],v217,2048
 M v[84:87],v[148:151],a[20:23],v[84:87]
 buffer_load_dwordx4 a[212:215],v221,s[8:11],s81 offen offset:2048 sc1
 M v[88:91],v[148:151],a[24:27],v[88:91]
 M v[92:95],v[148:151],a[28:31],v[92:95]
 W 6
 M v[96:99],v[152:155],a[16:19],v[96:99]
 T v[136:137],v218,0
 T v[138:139],v218,2048
 M v[100:103],v[152:155],a[20:23],v[100:103]
 buffer_load_dwordx4 a[216:219],v224,s[8:11],s81 offen offset:3072 sc1
 M v[104:107],v[152:155],a[24:27],v[104:107]
 M v[108:111],v[152:155],a[28:31],v[108:111]
 W 6
 M v[112:115],v[156:159],a[16:19],v[112:115]
 T v[140:141],v219,0
 T v[142:143],v219,2048
 M v[116:119],v[156:159],a[20:23],v[116:119]
 buffer_load_dwordx4 a[220:223],v221,s[8:11],s81 offen offset:3072 sc1
 M v[120:123],v[156:159],a[24:27],v[120:123]
 M v[124:127],v[156:159],a[28:31],v[124:127]
 W 6
 M v[0:3],v[128:131],a[32:35],v[0:3]
 T v[144:145],v216,4096
 T v[146:147],v216,6144
 M v[4:7],v[128:131],a[36:39],v[4:7]
 M v[8:11],v[128:131],a[40:43],v[8:11]
 M v[12:15],v[128:131],a[44:47],v[12:15]
 W 6
 M v[16:19],v[132:135],a[32:35],v[16:19]
 T v[148:149],v217,4096
 T v[150:151],v217,6144
 M v[20:23],v[132:135],a[36:39],v[20:23]
 M v[24:27],v[132:135],a[40:43],v[24:27]
 M v[28:31],v[132:135],a[44:47],v[28:31]
 W 6
 M v[32:35],v[136:139],a[32:35],v[32:35]
 T v[152:153],v218,4096
 T v[154:155],v218,6144
 M v[36:39],v[136:139],a[36:39],v[36:39]
 M v[40:43],v[136:139],a[40:43],v[40:43]
 M v[44:47],v[136:139],a[44:47],v[44:47]
 W 6
 M v[48:51],v[140:143],a[32:35],v[48:51]
 T v[156:157],v219,4096
 T v[158:159],v219,6144
 M v[52:55],v[140:143],a[36:39],v[52:55]
 M v[56:59],v[140:143],a[40:43],v[56:59]
 M v[60:63],v[140:143],a[44:47],v[60:63]
 W 6
 M v[64:67],v[144:147],a[32:35],v[64:67]
 T v[128:129],v216,8192
 T v[130:131],v216,10240
 M v[68:71],v[144:147],a[36:39],v[68:71]
 M v[72:75],v[144:147],a[40:43],v[72:75]
 M v[76:79],v[144:147],a[44:47],v[76:79]
 W 6
 M v[80:83],v[148:151],a[32:35],v[80:83]
 T v[132:133],v217,8192
 T v[134:135],v217,10240
 M v[84:87],v[148:151],a[36:39],v[84:87]
 M v[88:91],v[148:151],a[40:43],v[88:91]
 M v[92:95],v[148:151],a[44:47],v[92:95]
 W 6
 M v[96:99],v[152:155],a[32:35],v[96:99]
 T v[136:137],v218,8192
 T v[138:139],v218,10240
 M v[100:103],v[152:155],a[36:39],v[100:103]
 M v[104:107],v[152:155],a[40:43],v[104:107]
 M v[108:111],v[152:155],a[44:47],v[108:111]
 W 6
 M v[112:115],v[156:159],a[32:35],v[112:115]
 T v[140:141],v219,8192
 T v[142:143],v219,10240
 M v[116:119],v[156:159],a[36:39],v[116:119]
 M v[120:123],v[156:159],a[40:43],v[120:123]
 M v[124:127],v[156:159],a[44:47],v[124:127]
 W 6
 M v[0:3],v[128:131],a[48:51],v[0:3]
 T v[144:145],v216,12288
 T v[146:147],v216,14336
 M v[4:7],v[128:131],a[52:55],v[4:7]
 buffer_load_dword v207,v208,s[8:11],0 offen sc1
 M v[8:11],v[128:131],a[56:59],v[8:11]
 M v[12:15],v[128:131],a[60:63],v[12:15]
 W 6
 M v[16:19],v[132:135],a[48:51],v[16:19]
 T v[148:149],v217,12288
 T v[150:151],v217,14336
 M v[20:23],v[132:135],a[52:55],v[20:23]
 M v[24:27],v[132:135],a[56:59],v[24:27]
 M v[28:31],v[132:135],a[60:63],v[28:31]
 W 6
 M v[32:35],v[136:139],a[48:51],v[32:35]
 T v[152:153],v218,12288
 T v[154:155],v218,14336
 M v[36:39],v[136:139],a[52:55],v[36:39]
 M v[40:43],v[136:139],a[56:59],v[40:43]
 M v[44:47],v[136:139],a[60:63],v[44:47]
 W 6
 M v[48:51],v[140:143],a[48:51],v[48:51]
 T v[156:157],v219,12288
 T v[158:159],v219,14336
 M v[52:55],v[140:143],a[52:55],v[52:55]
 v_add_u32 v216,65536,v216
 v_add_u32 v217,65536,v217
 M v[56:59],v[140:143],a[56:59],v[56:59]
 v_add_u32 v218,65536,v218
 v_add_u32 v219,65536,v219
 M v[60:63],v[140:143],a[60:63],v[60:63]
 W 6
 s_barrier
 M v[64:67],v[144:147],a[48:51],v[64:67]
 T v[128:129],v216,0
 T v[130:131],v216,2048
 M v[68:71],v[144:147],a[52:55],v[68:71]
 M v[72:75],v[144:147],a[56:59],v[72:75]
 M v[76:79],v[144:147],a[60:63],v[76:79]
 W 6
 M v[80:83],v[148:151],a[48:51],v[80:83]
 T v[132:133],v217,0
 T v[134:135],v217,2048
 T v[136:137],v218,0
 T v[138:139],v218,2048
 M v[84:87],v[148:151],a[52:55],v[84:87]
 M v[88:91],v[148:151],a[56:59],v[88:91]
 M v[92:95],v[148:151],a[60:63],v[92:95]
 W 8
 M v[96:99],v[152:155],a[48:51],v[96:99]
 T v[140:141],v219,0
 T v[142:143],v219,2048
 T v[144:145],v216,4096
 T v[146:147],v216,6144
 M v[100:103],v[152:155],a[52:55],v[100:103]
 M v[104:107],v[152:155],a[56:59],v[104:107]
 M v[108:111],v[152:155],a[60:63],v[108:111]
 W 10
 M v[112:115],v[156:159],a[48:51],v[112:115]
 T v[148:149],v217,4096
 T v[150:151],v217,6144
 M v[116:119],v[156:159],a[52:55],v[116:119]
 M v[120:123],v[156:159],a[56:59],v[120:123]
 M v[124:127],v[156:159],a[60:63],v[124:127]
 W 10
 s_waitcnt vmcnt(24)
 M v[0:3],v[128:131],a[128:131],v[0:3]
 T v[152:153],v218,4096
 T v[154:155],v218,6144
 s_waitcnt vmcnt(23)
 M v[4:7],v[128:131],a[132:135],v[4:7]
 W 10
 M v[16:19],v[132:135],a[128:131],v[16:19]
 T v[156:157],v219,4096
 T v[158:159],v219,6144
 M v[20:23],v[132:135],a[132:135],v[20:23]
 W 10
 M v[32:35],v[136:139],a[128:131],v[32:35]
 T v[128:129],v216,8192
 T v[130:131],v216,10240
 M v[36:39],v[136:139],a[132:135],v[36:39]
 W 10
 M v[48:51],v[140:143],a[128:131],v[48:51]
 T v[132:133],v217,8192
 T v[134:135],v217,10240
 M v[52:55],v[140:143],a[132:135],v[52:55]
 W 10
 M v[64:67],v[144:147],a[128:131],v[64:67]
 T v[136:137],v218,8192
 T v[138:139],v218,10240
 M v[68:71],v[144:147],a[132:135],v[68:71]
 W 10
 M v[80:83],v[148:151],a[128:131],v[80:83]
 T v[140:141],v219,8192
 T v[142:143],v219,10240
 M v[84:87],v[148:151],a[132:135],v[84:87]
 W 10
 M v[96:99],v[152:155],a[128:131],v[96:99]
 T v[144:145],v216,12288
 T v[146:147],v216,14336
 M v[100:103],v[152:155],a[132:135],v[100:103]
 W 10
 M v[112:115],v[156:159],a[128:131],v[112:115]
 T v[148:149],v217,12288
 T v[150:151],v217,14336
 M v[116:119],v[156:159],a[132:135],v[116:119]
 W 10
 s_waitcnt vmcnt(22)
 M v[0:3],v[128:131],a[136:139],v[0:3]
 T v[152:153],v218,12288
 T v[154:155],v218,14336
 s_waitcnt vmcnt(21)
 M v[4:7],v[128:131],a[140:143],v[4:7]
 W 10
 s_add_u32 s63,s62,3
 s_waitcnt vmcnt(0)
 v_subrev_u32 v207,s63,v207
 v_cmp_le_u32 vcc,8,v207
 s_cbranch_vccz PL_ok14
 s_mov_b32 s69,0x100000
PL_sp14:
 s_sleep 2
 buffer_load_dword v207,v208,s[8:11],0 offen sc1
 s_waitcnt vmcnt(0)
 v_subrev_u32 v207,s63,v207
 v_cmp_le_u32 vcc,8,v207
 s_cbranch_vccz PL_ok14
 s_sub_u32 s69,s69,1
 s_cbranch_scc0 PL_sp14
PL_ok14:
 M v[16:19],v[132:135],a[136:139],v[16:19]
 T v[156:157],v219,12288
 T v[158:159],v219,14336
 M v[20:23],v[132:135],a[140:143],v[20:23]
 W 10
 s_add_u32 s81,s96,s84
 buffer_load_dwordx4 a[64:67],v224,s[8:11],s81 offen offset:0 sc1
 M v[32:35],v[136:139],a[136:139],v[32:35]
 T v[128:129],v216,16384
 T v[130:131],v216,18432
 M v[36:39],v[136:139],a[140:143],v[36:39]
 W 10
 M v[48:51],v[140:143],a[136:139],v[48:51]
 T v[132:133],v217,16384
 T v[134:135],v217,18432
 M v[52:55],v[140:143],a[140:143],v[52:55]
 W 10
 buffer_load_dwordx4 a[68:71],v221,s[8:11],s81 offen offset:0 sc1
 M v[64:67],v[144:147],a[136:139],v[64:67]
 T v[136:137],v218,16384
 T v[138:139],v218,18432
 M v[68:71],v[144:147],a[140:143],v[68:71]
 W 10
 M v[80:83],v[148:151],a[136:139],v[80:83]
 T v[140:141],v219,16384
 T v[142:143],v219,18432
 M v[84:87],v[148:151],a[140:143],v[84:87]
 W 10
 buffer_load_dwordx4 a[72:75],v224,s[8:11],s81 offen offset:1024 sc1
 M v[96:99],v[152:155],a[136:139],v[96:99]
 T v[144:145],v216,20480
 T v[146:147],v216,22528
 M v[100:103],v[152:155],a[140:143],v[100:103]
 W 10
 M v[112:115],v[156:159],a[136:139],v[112:115]
 T v[148:149],v217,20480
 T v[150:151],v217,22528
 M v[116:119],v[156:159],a[140:143],v[116:119]
 W 10
 buffer_load_dwordx4 a[76:79],v221,s[8:11],s81 offen offset:1024 sc1
 M v[0:3],v[128:131],a[144:147],v[0:3]
 T v[152:153],v218,20480
 T v[154:155],v218,22528
 M v[4:7],v[128:131],a[148:151],v[4:7]
 W 10
 M v[16:19],v[132:135],a[144:147],v[16:19]
 T v[156:157],v219,20480
 T v[158:159],v219,22528
 M v[20:23],v[132:135],a[148:151],v[20:23]
 W 10
 buffer_load_dwordx4 a[80:83],v224,s[8:11],s81 offen offset:2048 sc1
 M v[32:35],v[136:139],a[144:147],v[32:35]
 T v[128:129],v216,24576
 T v[130:131],v216,26624
 M v[36:39],v[136:139],a[148:151],v[36:39]
 W 10
 M v[48:51],v[140:143],a[144:147],v[48:51]
 T v[132:133],v217,24576
 T v[134:135],v217,26624
 M v[52:55],v[140:143],a[148:151],v[52:55]
 W 10
 buffer_load_dwordx4 a[84:87],v221,s[8:11],s81 offen offset:2048 sc1
 M v[64:67],v[144:147],a[144:147],v[64:67]
 T v[136:137],v218,24576
 T v[138:139],v218,26624
 M v[68:71],v[144:147],a[148:151],v[68:71]
 W 10
 M v[80:83],v[148:151],a[144:147],v[80:83]
 T v[140:141],v219,24576
 T v[142:143],v219,26624
 M v[84:87],v[148:151],a[148:151],v[84:87]
 W 10
 buffer_load_dwordx4 a[88:91],v224,s[8:11],s81 offen offset:3072 sc1
 M v[96:99],v[152:155],a[144:147],v[96:99]
 T v[144:145],v216,28672
 T v[146:147],v216,30720
 M v[100:103],v[152:155],a[148:151],v[100:103]
 W 10
 M v[112:115],v[156:159],a[144:147],v[112:115]
 T v[148:149],v217,28672
 T v[150:151],v217,30720
 M v[116:119],v[156:159],a[148:151],v[116:119]
 W 10
 buffer_load_dwordx4 a[92:95],v221,s[8:11],s81 offen offset:3072 sc1
 M v[0:3],v[128:131],a[152:155],v[0:3]
 T v[152:153],v218,28672
 T v[154:155],v218,30720
 M v[4:7],v[128:131],a[156:159],v[4:7]
 W 10
 M v[16:19],v[132:135],a[152:155],v[16:19]
 T v[156:157],v219,28672
 T v[158:159],v219,30720
 M v[20:23],v[132:135],a[156:159],v[20:23]
 W 10
 s_add_u32 s81,s96,s85
 buffer_load_dwordx4 a[96:99],v224,s[8:11],s81 offen offset:0 sc1
 M v[32:35],v[136:139],a[152:155],v[32:35]
 T v[128:129],v216,32768
 T v[130:131],v216,34816
 M v[36:39],v[136:139],a[156:159],v[36:39]
 W 10
 M v[48:51],v[140:143],a[152:155],v[48:51]
 T v[132:133],v217,32768
 T v[134:135],v217,34816
 M v[52:55],v[140:143],a[156:159],v[52:55]
 W 10
 buffer_load_dwordx4 a[100:103],v221,s[8:11],s81 offen offset:0 sc1
 M v[64:67],v[144:147],a[152:155],v[64:67]
 T v[136:137],v218,32768
 T v[138:139],v218,34816
 M v[68:71],v[144:147],a[156:159],v[68:71]
 W 10
 M v[80:83],v[148:151],a[152:155],v[80:83]
 T v[140:141],v219,32768
 T v[142:143],v219,34816
 M v[84:87],v[148:151],a[156:159],v[84:87]
 W 10
 buffer_load_dwordx4 a[104:107],v224,s[8:11],s81 offen offset:1024 sc1
 M v[96:99],v[152:155],a[152:155],v[96:99]
 T v[144:145],v216,36864
 T v[146:147],v216,38912
 M v[100:103],v[152:155],a[156:159],v[100:103]
 W 10
 M v[112:115],v[156:159],a[152:155],v[112:115]
 T v[148:149],v217,36864
 T v[150:151],v217,38912
 M v[116:119],v[156:159],a[156:159],v[116:119]
 W 10
 buffer_load_dwordx4 a[108:111],v221,s[8:11],s81 offen offset:1024 sc1
 M v[0:3],v[128:131],a[160:163],v[0:3]
 T v[152:153],v218,36864
 T v[154:155],v218,38912
 M v[4:7],v[128:131],a[164:167],v[4:7]
 W 10
 M v[16:19],v[132:135],a[160:163],v[16:19]
 T v[156:157],v219,36864
 T v[158:159],v219,38912
 M v[20:23],v[132:135],a[164:167],v[20:23]
 W 10
 buffer_load_dwordx4 a[112:115],v224,s[8:11],s81 offen offset:2048 sc1
 M v[32:35],v[136:139],a[160:163],v[32:35]
 T v[128:129],v216,40960
 T v[130:131],v216,43008
 M v[36:39],v[136:139],a[164:167],v[36:39]
 W 10
 M v[48:51],v[140:143],a[160:163],v[48:51]
 T v[132:133],v217,40960
 T v[134:135],v217,43008
 M v[52:55],v[140:143],a[164:167],v[52:55]
 W 10
 buffer_load_dwordx4 a[116:119],v221,s[8:11],s81 offen offset:2048 sc1
 M v[64:67],v[144:147],a[160:163],v[64:67]
 T v[136:137],v218,40960
 T v[138:139],v218,43008
 M v[68:71],v[144:147],a[164:167],v[68:71]
 W 10
 M v[80:83],v[148:151],a[160:163],v[80:83]
 T v[140:141],v219,40960
 T v[142:143],v219,43008
 M v[84:87],v[148:151],a[164:167],v[84:87]
 W 10
 buffer_load_dwordx4 a[120:123],v224,s[8:11],s81 offen offset:3072 sc1
 M v[96:99],v[152:155],a[160:163],v[96:99]
 T v[144:145],v216,45056
 T v[146:147],v216,47104
 M v[100:103],v[152:155],a[164:167],v[100:103]
 W 10
 M v[112:115],v[156:159],a[160:163],v[112:115]
 T v[148:149],v217,45056
 T v[150:151],v217,47104
 M v[116:119],v[156:159],a[164:167],v[116:119]
 W 10
 buffer_load_dwordx4 a[124:127],v221,s[8:11],s81 offen offset:3072 sc1
 M v[0:3],v[128:131],a[168:171],v[0:3]
 T v[152:153],v218,45056
 T v[154:155],v218,47104
 M v[4:7],v[128:131],a[172:175],v[4:7]
 W 10
 M v[16:19],v[132:135],a[168:171],v[16:19]
 T v[156:157],v219,45056
 T v[158:159],v219,47104
 M v[20:23],v[132:135],a[172:175],v[20:23]
 W 10
 s_barrier
 s_add_u32 s81,s96,s86
 buffer_load_dwordx4 a[224:227],v224,s[8:11],s81 offen offset:0 sc1
 M v[32:35],v[136:139],a[168:171],v[32:35]
 T v[128:129],v216,49152
 T v[130:131],v216,51200
 M v[36:39],v[136:139],a[172:175],v[36:39]
 W 10
 M v[48:51],v[140:143],a[168:171],v[48:51]
 T v[132:133],v217,49152
 T v[134:135],v217,51200
 M v[52:55],v[140:143],a[172:175],v[52:55]
 W 10
 buffer_load_dwordx4 a[228:231],v221,s[8:11],s81 offen offset:0 sc1
 M v[64:67],v[144:147],a[168:171],v[64:67]
 T v[136:137],v218,49152
 T v[138:139],v218,51200
 M v[68:71],v[144:147],a[172:175],v[68:71]
 W 10
 M v[80:83],v[148:151],a[168:171],v[80:83]
 T v[140:141],v219,49152
 T v[142:143],v219,51200
 M v[84:87],v[148:151],a[172:175],v[84:87]
 W 10
 buffer_load_dwordx4 a[232:235],v224,s[8:11],s81 offen offset:1024 sc1
 M v[96:99],v[152:155],a[168:171],v[96:99]
 T v[144:145],v216,53248
 T v[146:147],v216,55296
 M v[100:103],v[152:155],a[172:175],v[100:103]
 W 10
 M v[112:115],v[156:159],a[168:171],v[112:115]
 T v[148:149],v217,53248
 T v[150:151],v217,55296
 M v[116:119],v[156:159],a[172:175],v[116:119]
 W 10
 buffer_load_dwordx4 a[236:239],v221,s[8:11],s81 offen offset:1024 sc1
 M v[0:3],v[128:131],a[176:179],v[0:3]
 T v[152:153],v218,53248
 T v[154:155],v218,55296
 M v[4:7],v[128:131],a[180:183],v[4:7]
 W 10
 M v[16:19],v[132:135],a[176:179],v[16:19]
 T v[156:157],v219,53248
 T v[158:159],v219,55296
 M v[20:23],v[132:135],a[180:183],v[20:23]
 W 10
 buffer_load_dwordx4 a[240:243],v224,s[8:11],s81 offen offset:2048 sc1
 M v[32:35],v[136:139],a[176:179],v[32:35]
 T v[128:129],v216,57344
 T v[130:131],v216,59392
 M v[36:39],v[136:139],a[180:183],v[36:39]
 W 10
 M v[48:51],v[140:143],a[176:179],v[48:51]
 T v[132:133],v217,57344
 T v[134:135],v217,59392
 M v[52:55],v[140:143],a[180:183],v[52:55]
 W 10
 buffer_load_dwordx4 a[244:247],v221,s[8:11],s81 offen offset:2048 sc1
 M v[64:67],v[144:147],a[176:179],v[64:67]
 T v[136:137],v218,57344
 T v[138:139],v218,59392
 M v[68:71],v[144:147],a[180:183],v[68:71]
 W 10
 M v[80:83],v[148:151],a[176:179],v[80:83]
 T v[140:141],v219,57344
 T v[142:143],v219,59392
 M v[84:87],v[148:151],a[180:183],v[84:87]
 W 10
 buffer_load_dwordx4 a[248:251],v224,s[8:11],s81 offen offset:3072 sc1
 M v[96:99],v[152:155],a[176:179],v[96:99]
 T v[144:145],v216,61440
 T v[146:147],v216,63488
 M v[100:103],v[152:155],a[180:183],v[100:103]
 W 10
 M v[112:115],v[156:159],a[176:179],v[112:115]
 T v[148:149],v217,61440
 T v[150:151],v217,63488
 M v[116:119],v[156:159],a[180:183],v[116:119]
 W 10
 buffer_load_dwordx4 a[252:255],v221,s[8:11],s81 offen offset:3072 sc1
 M v[0:3],v[128:131],a[184:187],v[0:3]
 T v[152:153],v218,61440
 T v[154:155],v218,63488
 M v[4:7],v[128:131],a[188:191],v[4:7]
 W 10
 M v[16:19],v[132:135],a[184:187],v[16:19]
 T v[156:157],v219,61440
 T v[158:159],v219,63488
 M v[20:23],v[132:135],a[188:191],v[20:23]
 W 10
 M v[32:35],v[136:139],a[184:187],v[32:35]
 T v[128:129],v212,0
 T v[130:131],v212,2048
 M v[36:39],v[136:139],a[188:191],v[36:39]
 W 10
 M v[48:51],v[140:143],a[184:187],v[48:51]
 T v[132:133],v213,0
 T v[134:135],v213,2048
 M v[52:55],v[140:143],a[188:191],v[52:55]
 W 10
 M v[64:67],v[144:147],a[184:187],v[64:67]
 T v[136:137],v214,0
 T v[138:139],v214,2048
 M v[68:71],v[144:147],a[188:191],v[68:71]
 W 10
 M v[80:83],v[148:151],a[184:187],v[80:83]
 T v[140:141],v215,0
 T v[142:143],v215,2048
 M v[84:87],v[148:151],a[188:191],v[84:87]
 W 10
 M v[96:99],v[152:155],a[184:187],v[96:99]
 T v[144:145],v212,4096
 T v[146:147],v212,6144
 M v[100:103],v[152:155],a[188:191],v[100:103]
 W 10
 M v[112:115],v[156:159],a[184:187],v[112:115]
 T v[148:149],v213,4096
 T v[150:151],v213,6144
 M v[116:119],v[156:159],a[188:191],v[116:119]
 W 10
 M v[0:3],v[128:131],a[192:195],v[0:3]
 T v[152:153],v214,4096
 T v[154:155],v214,6144
 M v[4:7],v[128:131],a[196:199],v[4:7]
 W 10
 M v[16:19],v[132:135],a[192:195],v[16:19]
 T v[156:157],v215,4096
 T v[158:159],v215,6144
 M v[20:23],v[132:135],a[196:199],v[20:23]
 W 10
 M v[32:35],v[136:139],a[192:195],v[32:35]
 T v[128:129],v212,8192
 T v[130:131],v212,10240
 M v[36:39],v[136:139],a[196:199],v[36:39]
 W 10
 M v[48:51],v[140:143],a[192:195],v[48:51]
 T v[132:133],v213,8192
 T v[134:135],v213,10240
 M v[52:55],v[140:143],a[196:199],v[52:55]
 W 10
 M v[64:67],v[144:147],a[192:195],v[64:67]
 T v[136:137],v214,8192
 T v[138:139],v214,10240
 M v[68:71],v[144:147],a[196:199],v[68:71]
 W 10
 M v[80:83],v[148:151],a[192:195],v[80:83]
 T v[140:141],v215,8192
 T v[142:143],v215,10240
 M v[84:87],v[148:151],a[196:199],v[84:87]
 W 10
 M v[96:99],v[152:155],a[192:195],v[96:99]
 T v[144:145],v212,12288
 T v[146:147],v212,14336
 M v[100:103],v[152:155],a[196:199],v[100:103]
 W 10
 v_bfe_u32 v222,v224,4,5
 M v[112:115],v[156:159],a[192:195],v[112:115]
 T v[148:149],v213,12288
 T v[150:151],v213,14336
 M v[116:119],v[156:159],a[196:199],v[116:119]
 W 10
 v_lshlrev_b32 v222,10,v222
 M v[0:3],v[128:131],a[200:203],v[0:3]
 T v[152:153],v214,12288
 T v[154:155],v214,14336
 M v[4:7],v[128:131],a[204:207],v[4:7]
 W 10
 v_lshrrev_b32 v223,9,v224
 M v[16:19],v[132:135],a[200:203],v[16:19]
 T v[156:157],v215,12288
 T v[158:159],v215,14336
 M v[20:23],v[132:135],a[204:207],v[20:23]
 W 10
 v_lshlrev_b32 v223,4,v223
 M v[32:35],v[136:139],a[200:203],v[32:35]
 T v[128:129],v212,16384
 T v[130:131],v212,18432
 M v[36:39],v[136:139],a[204:207],v[36:39]
 W 10
 v_add_u32 v222,v222,v223
 M v[48:51],v[140:143],a[200:203],v[48:51]
 T v[132:133],v213,16384
 T v[134:135],v213,18432
 M v[52:55],v[140:143],a[204:207],v[52:55]
 W 10
 M v[64:67],v[144:147],a[200:203],v[64:67]
 T v[136:137],v214,16384
 T v[138:139],v214,18432
 M v[68:71],v[144:147],a[204:207],v[68:71]
 W 10
 s_lshr_b32 s68,s65,1
 s_lshl_b32 s68,s68,5
 s_sub_u32 s69,15,s66
 s_bitcmp1_b32 s65,0
 s_cselect_b32 s69,s69,s66
 s_lshl_b32 s69,s69,7
 s_add_u32 s68,s68,s69
 s_lshl_b32 s74,s68,10
 s_lshl_b32 s75,s67,8
 s_lshl_b32 s68,s64,6
 s_add_u32 s75,s75,s68
 s_add_u32 s74,s74,s75
 buffer_load_dwordx4 v[226:229],v222,s[12:15],s74 offen offset:0
 M v[80:83],v[148:151],a[200:203],v[80:83]
 T v[140:141],v215,16384
 T v[142:143],v215,18432
 M v[84:87],v[148:151],a[204:207],v[84:87]
 W 10
 M v[96:99],v[152:155],a[200:203],v[96:99]
 T v[144:145],v212,20480
 T v[146:147],v212,22528
 M v[100:103],v[152:155],a[204:207],v[100:103]
 W 10
 buffer_load_dwordx4 v[234:237],v222,s[12:15],s74 offen offset:32
 M v[112:115],v[156:159],a[200:203],v[112:115]
 T v[148:149],v213,20480
 T v[150:151],v213,22528
 M v[116:119],v[156:159],a[204:207],v[116:119]
 W 10
 M v[0:3],v[128:131],a[208:211],v[0:3]
 T v[152:153],v214,20480
 T v[154:155],v214,22528
 M v[4:7],v[128:131],a[212:215],v[4:7]
 W 10
 buffer_load_dwordx4 v[230:233],v223,s[52:55],s75 offen offset:0
 M v[16:19],v[132:135],a[208:211],v[16:19]
 T v[156:157],v215,20480
 T v[158:159],v215,22528
 M v[20:23],v[132:135],a[212:215],v[20:23]
 W 10
 M v[32:35],v[136:139],a[208:211],v[32:35]
 T v[128:129],v212,24576
 T v[130:131],v212,26624
 M v[36:39],v[136:139],a[212:215],v[36:39]
 W 10
 buffer_load_dwordx4 v[238:241],v223,s[52:55],s75 offen offset:32
 M v[48:51],v[140:143],a[208:211],v[48:51]
 T v[132:133],v213,24576
 T v[134:135],v213,26624
 M v[52:55],v[140:143],a[212:215],v[52:55]
 W 10
 M v[64:67],v[144:147],a[208:211],v[64:67]
 T v[136:137],v214,24576
 T v[138:139],v214,26624
 M v[68:71],v[144:147],a[212:215],v[68:71]
 W 10
 M v[80:83],v[148:151],a[208:211],v[80:83]
 T v[140:141],v215,24576
 T v[142:143],v215,26624
 M v[84:87],v[148:151],a[212:215],v[84:87]
 W 10
 M v[96:99],v[152:155],a[208:211],v[96:99]
 T v[144:145],v212,28672
 T v[146:147],v212,30720
 M v[100:103],v[152:155],a[212:215],v[100:103]
 W 10
 M v[112:115],v[156:159],a[208:211],v[112:115]
 T v[148:149],v213,28672
 T v[150:151],v213,30720
 M v[116:119],v[156:159],a[212:215],v[116:119]
 W 10
 M v[0:3],v[128:131],a[216:219],v[0:3]
 T v[152:153],v214,28672
 T v[154:155],v214,30720
 M v[4:7],v[128:131],a[220:223],v[4:7]
 W 10
 M v[16:19],v[132:135],a[216:219],v[16:19]
 T v[156:157],v215,28672
 T v[158:159],v215,30720
 M v[20:23],v[132:135],a[220:223],v[20:23]
 W 10
 M v[32:35],v[136:139],a[216:219],v[32:35]
 T v[128:129],v216,0
 T v[130:131],v216,2048
 M v[36:39],v[136:139],a[220:223],v[36:39]
 W 10
 M v[48:51],v[140:143],a[216:219],v[48:51]
 T v[132:133],v216,8192
 T v[134:135],v216,10240
 M v[52:55],v[140:143],a[220:223],v[52:55]
 W 10
 M v[64:67],v[144:147],a[216:219],v[64:67]
 T v[136:137],v216,16384
 T v[138:139],v216,18432
 M v[68:71],v[144:147],a[220:223],v[68:71]
 W 10
 M v[80:83],v[148:151],a[216:219],v[80:83]
 T v[140:141],v216,24576
 T v[142:143],v216,26624
 M v[84:87],v[148:151],a[220:223],v[84:87]
 W 10
 M v[96:99],v[152:155],a[216:219],v[96:99]
 T v[144:145],v216,32768
 T v[146:147],v216,34816
 M v[100:103],v[152:155],a[220:223],v[100:103]
 W 10
 M v[112:115],v[156:159],a[216:219],v[112:115]
 T v[148:149],v216,40960
 T v[150:151],v216,43008
 M v[116:119],v[156:159],a[220:223],v[116:119]
 W 10
 s_waitcnt vmcnt(27)
 M v[8:11],v[128:131],a[64:67],v[8:11]
 T v[152:153],v216,49152
 T v[154:155],v216,51200
 s_waitcnt vmcnt(26)
 M v[12:15],v[128:131],a[68:71],v[12:15]
 W 10
 s_waitcnt vmcnt(25)
 M v[8:11],v[132:135],a[72:75],v[8:11]
 T v[156:157],v216,57344
 T v[158:159],v216,59392
 s_waitcnt vmcnt(24)
 M v[12:15],v[132:135],a[76:79],v[12:15]
 W 10
 v_cvt_pk_bf16_f32 v160,v0,v1
 v_cvt_pk_bf16_f32 v162,v4,v5
 s_waitcnt vmcnt(23)
 M v[8:11],v[136:139],a[80:83],v[8:11]
 T v[128:129],v212,0
 T v[130:131],v212,2048
 s_waitcnt vmcnt(22)
 M v[12:15],v[136:139],a[84:87],v[12:15]
 W 10
 v_cvt_pk_bf16_f32 v161,v2,v3
 v_cvt_pk_bf16_f32 v163,v6,v7
 s_waitcnt vmcnt(21)
 M v[8:11],v[140:143],a[88:91],v[8:11]
 T v[132:133],v212,8192
 T v[134:135],v212,10240
 s_waitcnt vmcnt(20)
 M v[12:15],v[140:143],a[92:95],v[12:15]
 W 10
 s_add_u32 s70,s80,0
 s_waitcnt vmcnt(19)
 M v[8:11],v[144:147],a[96:99],v[8:11]
 T v[136:137],v212,16384
 T v[138:139],v212,18432
 s_waitcnt vmcnt(18)
 M v[12:15],v[144:147],a[100:103],v[12:15]
 W 10
 v_permlane16_swap_b32 v160,v162
 s_waitcnt vmcnt(17)
 M v[8:11],v[148:151],a[104:107],v[8:11]
 T v[140:141],v212,24576
 T v[142:143],v212,26624
 s_waitcnt vmcnt(16)
 M v[12:15],v[148:151],a[108:111],v[12:15]
 W 10
 v_permlane16_swap_b32 v161,v163
 s_waitcnt vmcnt(15)
 M v[8:11],v[152:155],a[112:115],v[8:11]
 T v[144:145],v217,0
 T v[146:147],v217,2048
 s_waitcnt vmcnt(14)
 M v[12:15],v[152:155],a[116:119],v[12:15]
 W 10
 buffer_store_dwordx4 v[160:163],v224,s[8:11],s70 offen offset:0 sc0 sc1
 v_cvt_pk_bf16_f32 v164,v16,v17
 s_waitcnt vmcnt(14)
 M v[8:11],v[156:159],a[120:123],v[8:11]
 T v[148:149],v217,8192
 T v[150:151],v217,10240
 s_waitcnt vmcnt(13)
 M v[12:15],v[156:159],a[124:127],v[12:15]
 W 10
 v_cvt_pk_bf16_f32 v166,v20,v21
 v_cvt_pk_bf16_f32 v165,v18,v19
 s_waitcnt vmcnt(12)
 M v[8:11],v[128:131],a[224:227],v[8:11]
 T v[152:153],v217,16384
 T v[154:155],v217,18432
 s_waitcnt vmcnt(11)
 M v[12:15],v[128:131],a[228:231],v[12:15]
 W 10
 v_cvt_pk_bf16_f32 v167,v22,v23
 s_add_u32 s70,s80,0
 s_waitcnt vmcnt(10)
 M v[8:11],v[132:135],a[232:235],v[8:11]
 T v[156:157],v217,24576
 T v[158:159],v217,26624
 s_waitcnt vmcnt(9)
 M v[12:15],v[132:135],a[236:239],v[12:15]
 W 10
 v_permlane16_swap_b32 v164,v166
 s_waitcnt vmcnt(8)
 M v[8:11],v[136:139],a[240:243],v[8:11]
 T v[128:129],v217,32768
 T v[130:131],v217,34816
 s_waitcnt vmcnt(7)
 M v[12:15],v[136:139],a[244:247],v[12:15]
 W 10
 v_permlane16_swap_b32 v165,v167
 s_waitcnt vmcnt(6)
 M v[8:11],v[140:143],a[248:251],v[8:11]
 T v[132:133],v217,40960
 T v[134:135],v217,43008
 s_waitcnt vmcnt(5)
 M v[12:15],v[140:143],a[252:255],v[12:15]
 W 10
 buffer_store_dwordx4 v[164:167],v224,s[8:11],s70 offen offset:1024 sc0 sc1
 v_cvt_pk_bf16_f32 v168,v32,v33
 M v[24:27],v[144:147],a[64:67],v[24:27]
 T v[136:137],v217,49152
 T v[138:139],v217,51200
 M v[28:31],v[144:147],a[68:71],v[28:31]
 W 10
 v_cvt_pk_bf16_f32 v170,v36,v37
 v_cvt_pk_bf16_f32 v169,v34,v35
 M v[24:27],v[148:151],a[72:75],v[24:27]
 T v[140:141],v217,57344
 T v[142:143],v217,59392
 M v[28:31],v[148:151],a[76:79],v[28:31]
 W 10
 v_cvt_pk_bf16_f32 v171,v38,v39
 s_add_u32 s70,s80,0
 M v[24:27],v[152:155],a[80:83],v[24:27]
 T v[144:145],v213,0
 T v[146:147],v213,2048
 M v[28:31],v[152:155],a[84:87],v[28:31]
 W 10
 v_permlane16_swap_b32 v168,v170
 M v[24:27],v[156:159],a[88:91],v[24:27]
 T v[148:149],v213,8192
 T v[150:151],v213,10240
 M v[28:31],v[156:159],a[92:95],v[28:31]
 W 10
 v_permlane16_swap_b32 v169,v171
 M v[24:27],v[128:131],a[96:99],v[24:27]
 T v[152:153],v213,16384
 T v[154:155],v213,18432
 M v[28:31],v[128:131],a[100:103],v[28:31]
 W 10
 buffer_store_dwordx4 v[168:171],v224,s[8:11],s70 offen offset:2048 sc0 sc1
 v_cvt_pk_bf16_f32 v172,v8,v9
 M v[24:27],v[132:135],a[104:107],v[24:27]
 T v[156:157],v213,24576
 T v[158:159],v213,26624
 M v[28:31],v[132:135],a[108:111],v[28:31]
 W 10
 v_cvt_pk_bf16_f32 v174,v12,v13
 v_cvt_pk_bf16_f32 v173,v10,v11
 M v[24:27],v[136:139],a[112:115],v[24:27]
 T v[128:129],v218,0
 T v[130:131],v218,2048
 M v[28:31],v[136:139],a[116:119],v[28:31]
 W 10
 v_cvt_pk_bf16_f32 v175,v14,v15
 s_add_u32 s70,s80,9216
 M v[24:27],v[140:143],a[120:123],v[24:27]
 T v[132:133],v218,8192
 T v[134:135],v218,10240
 M v[28:31],v[140:143],a[124:127],v[28:31]
 W 10
 v_permlane16_swap_b32 v172,v174
 M v[24:27],v[144:147],a[224:227],v[24:27]
 T v[136:137],v218,16384
 T v[138:139],v218,18432
 M v[28:31],v[144:147],a[228:231],v[28:31]
 W 10
 v_permlane16_swap_b32 v173,v175
 M v[24:27],v[148:151],a[232:235],v[24:27]
 T v[140:141],v218,24576
 T v[142:143],v218,26624
 M v[28:31],v[148:151],a[236:239],v[28:31]
 W 10
 buffer_store_dwordx4 v[172:175],v224,s[8:11],s70 offen offset:0 sc0 sc1
 v_cvt_pk_bf16_f32 v176,v48,v49
 M v[24:27],v[152:155],a[240:243],v[24:27]
 T v[144:145],v218,32768
 T v[146:147],v218,34816
 M v[28:31],v[152:155],a[244:247],v[28:31]
 W 10
 v_cvt_pk_bf16_f32 v178,v52,v53
 v_cvt_pk_bf16_f32 v177,v50,v51
 M v[24:27],v[156:159],a[248:251],v[24:27]
 T v[148:149],v218,40960
 T v[150:151],v218,43008
 M v[28:31],v[156:159],a[252:255],v[28:31]
 W 10
 v_cvt_pk_bf16_f32 v179,v54,v55
 s_add_u32 s70,s80,0
 M v[40:43],v[128:131],a[64:67],v[40:43]
 T v[152:153],v218,49152
 T v[154:155],v218,51200
 M v[44:47],v[128:131],a[68:71],v[44:47]
 W 10
 v_permlane16_swap_b32 v176,v178
 M v[40:43],v[132:135],a[72:75],v[40:43]
 T v[156:157],v218,57344
 T v[158:159],v218,59392
 M v[44:47],v[132:135],a[76:79],v[44:47]
 W 10
 v_permlane16_swap_b32 v177,v179
 M v[40:43],v[136:139],a[80:83],v[40:43]
 T v[128:129],v214,0
 T v[130:131],v214,2048
 M v[44:47],v[136:139],a[84:87],v[44:47]
 W 10
 buffer_store_dwordx4 v[176:179],v224,s[8:11],s70 offen offset:3072 sc0 sc1
 v_cvt_pk_bf16_f32 v180,v64,v65
 M v[40:43],v[140:143],a[88:91],v[40:43]
 T v[132:133],v214,8192
 T v[134:135],v214,10240
 M v[44:47],v[140:143],a[92:95],v[44:47]
 W 10
 v_cvt_pk_bf16_f32 v182,v68,v69
 v_cvt_pk_bf16_f32 v181,v66,v67
 M v[40:43],v[144:147],a[96:99],v[40:43]
 T v[136:137],v214,16384
 T v[138:139],v214,18432
 M v[44:47],v[144:147],a[100:103],v[44:47]
 W 10
 v_cvt_pk_bf16_f32 v183,v70,v71
 s_add_u32 s70,s80,4096
 M v[40:43],v[148:151],a[104:107],v[40:43]
 T v[140:141],v214,24576
 T v[142:143],v214,26624
 M v[44:47],v[148:151],a[108:111],v[44:47]
 W 10
 v_permlane16_swap_b32 v180,v182
 M v[40:43],v[152:155],a[112:115],v[40:43]
 T v[144:145],v219,0
 T v[146:147],v219,2048
 M v[44:47],v[152:155],a[116:119],v[44:47]
 W 10
 v_permlane16_swap_b32 v181,v183
 M v[40:43],v[156:159],a[120:123],v[40:43]
 T v[148:149],v219,8192
 T v[150:151],v219,10240
 M v[44:47],v[156:159],a[124:127],v[44:47]
 W 10
 buffer_store_dwordx4 v[180:183],v224,s[8:11],s70 offen offset:0 sc0 sc1
 v_cvt_pk_bf16_f32 v184,v24,v25
 M v[40:43],v[128:131],a[224:227],v[40:43]
 T v[152:153],v219,16384
 T v[154:155],v219,18432
 M v[44:47],v[128:131],a[228:231],v[44:47]
 W 10
 v_cvt_pk_bf16_f32 v186,v28,v29
 v_cvt_pk_bf16_f32 v185,v26,v27
 M v[40:43],v[132:135],a[232:235],v[40:43]
 T v[156:157],v219,24576
 T v[158:159],v219,26624
 M v[44:47],v[132:135],a[236:239],v[44:47]
 W 10
 v_cvt_pk_bf16_f32 v187,v30,v31
 s_add_u32 s70,s80,9216
 M v[40:43],v[136:139],a[240:243],v[40:43]
 T v[128:129],v219,32768
 T v[130:131],v219,34816
 M v[44:47],v[136:139],a[244:247],v[44:47]
 W 10
 v_permlane16_swap_b32 v184,v186
 M v[40:43],v[140:143],a[248:251],v[40:43]
 T v[132:133],v219,40960
 T v[134:135],v219,43008
 M v[44:47],v[140:143],a[252:255],v[44:47]
 W 10
 v_permlane16_swap_b32 v185,v187
 M v[56:59],v[144:147],a[64:67],v[56:59]
 T v[136:137],v219,49152
 T v[138:139],v219,51200
 M v[60:63],v[144:147],a[68:71],v[60:63]
 W 10
 buffer_store_dwordx4 v[184:187],v224,s[8:11],s70 offen offset:1024 sc0 sc1
 v_cvt_pk_bf16_f32 v188,v80,v81
 M v[56:59],v[148:151],a[72:75],v[56:59]
 T v[140:141],v219,57344
 T v[142:143],v219,59392
 M v[60:63],v[148:151],a[76:79],v[60:63]
 W 10
 v_cvt_pk_bf16_f32 v190,v84,v85
 v_cvt_pk_bf16_f32 v189,v82,v83
 M v[56:59],v[152:155],a[80:83],v[56:59]
 T v[144:145],v215,0
 T v[146:147],v215,2048
 M v[60:63],v[152:155],a[84:87],v[60:63]
 W 10
 v_cvt_pk_bf16_f32 v191,v86,v87
 s_add_u32 s70,s80,4096
 M v[56:59],v[156:159],a[88:91],v[56:59]
 T v[148:149],v215,8192
 T v[150:151],v215,10240
 M v[60:63],v[156:159],a[92:95],v[60:63]
 W 10
 v_permlane16_swap_b32 v188,v190
 M v[56:59],v[128:131],a[96:99],v[56:59]
 T v[152:153],v215,16384
 T v[154:155],v215,18432
 M v[60:63],v[128:131],a[100:103],v[60:63]
 W 10
 v_permlane16_swap_b32 v189,v191
 M v[56:59],v[132:135],a[104:107],v[56:59]
 T v[156:157],v215,24576
 T v[158:159],v215,26624
 M v[60:63],v[132:135],a[108:111],v[60:63]
 W 10
 buffer_store_dwordx4 v[188:191],v224,s[8:11],s70 offen offset:1024 sc0 sc1
 v_cvt_pk_bf16_f32 v160,v96,v97
 M v[56:59],v[136:139],a[112:115],v[56:59]
 T v[128:129],v216,4096
 T v[130:131],v216,6144
 M v[60:63],v[136:139],a[116:119],v[60:63]
 W 10
 v_cvt_pk_bf16_f32 v162,v100,v101
 v_cvt_pk_bf16_f32 v161,v98,v99
 M v[56:59],v[140:143],a[120:123],v[56:59]
 T v[132:133],v216,12288
 T v[134:135],v216,14336
 M v[60:63],v[140:143],a[124:127],v[60:63]
 W 10
 v_cvt_pk_bf16_f32 v163,v102,v103
 s_add_u32 s70,s80,4096
 M v[56:59],v[144:147],a[224:227],v[56:59]
 T v[136:137],v216,20480
 T v[138:139],v216,22528
 M v[60:63],v[144:147],a[228:231],v[60:63]
 W 10
 v_permlane16_swap_b32 v160,v162
 M v[56:59],v[148:151],a[232:235],v[56:59]
 T v[140:141],v216,28672
 T v[142:143],v216,30720
 M v[60:63],v[148:151],a[236:239],v[60:63]
 W 10
 v_permlane16_swap_b32 v161,v163
 M v[56:59],v[152:155],a[240:243],v[56:59]
 T v[144:145],v216,36864
 T v[146:147],v216,38912
 M v[60:63],v[152:155],a[244:247],v[60:63]
 W 10
 buffer_store_dwordx4 v[160:163],v224,s[8:11],s70 offen offset:2048 sc0 sc1
 v_cvt_pk_bf16_f32 v164,v40,v41
 M v[56:59],v[156:159],a[248:251],v[56:59]
 T v[148:149],v216,45056
 T v[150:151],v216,47104
 M v[60:63],v[156:159],a[252:255],v[60:63]
 W 10
 v_cvt_pk_bf16_f32 v166,v44,v45
 v_cvt_pk_bf16_f32 v165,v42,v43
 M v[72:75],v[128:131],a[64:67],v[72:75]
 T v[152:153],v216,53248
 T v[154:155],v216,55296
 M v[76:79],v[128:131],a[68:71],v[76:79]
 W 10
 v_cvt_pk_bf16_f32 v167,v46,v47
 s_add_u32 s70,s80,9216
 M v[72:75],v[132:135],a[72:75],v[72:75]
 T v[156:157],v216,61440
 T v[158:159],v216,63488
 M v[76:79],v[132:135],a[76:79],v[76:79]
 W 10
 v_permlane16_swap_b32 v164,v166
 M v[72:75],v[136:139],a[80:83],v[72:75]
 T v[128:129],v212,4096
 T v[130:131],v212,6144
 M v[76:79],v[136:139],a[84:87],v[76:79]
 W 10
 v_permlane16_swap_b32 v165,v167
 M v[72:75],v[140:143],a[88:91],v[72:75]
 T v[132:133],v212,12288
 T v[134:135],v212,14336
 M v[76:79],v[140:143],a[92:95],v[76:79]
 W 10
 buffer_store_dwordx4 v[164:167],v224,s[8:11],s70 offen offset:2048 sc0 sc1
 v_cvt_pk_bf16_f32 v168,v112,v113
 M v[72:75],v[144:147],a[96:99],v[72:75]
 T v[136:137],v212,20480
 T v[138:139],v212,22528
 M v[76:79],v[144:147],a[100:103],v[76:79]
 W 10
 v_cvt_pk_bf16_f32 v170,v116,v117
 v_cvt_pk_bf16_f32 v169,v114,v115
 M v[72:75],v[148:151],a[104:107],v[72:75]
 T v[140:141],v212,28672
 T v[142:143],v212,30720
 M v[76:79],v[148:151],a[108:111],v[76:79]
 W 10
 v_cvt_pk_bf16_f32 v171,v118,v119
 s_add_u32 s70,s80,4096
 M v[72:75],v[152:155],a[112:115],v[72:75]
 T v[144:145],v217,4096
 T v[146:147],v217,6144
 M v[76:79],v[152:155],a[116:119],v[76:79]
 W 10
 v_permlane16_swap_b32 v168,v170
 M v[72:75],v[156:159],a[120:123],v[72:75]
 T v[148:149],v217,12288
 T v[150:151],v217,14336
 M v[76:79],v[156:159],a[124:127],v[76:79]
 W 10
 v_permlane16_swap_b32 v169,v171
 M v[72:75],v[128:131],a[224:227],v[72:75]
 T v[152:153],v217,20480
 T v[154:155],v217,22528
 M v[76:79],v[128:131],a[228:231],v[76:79]
 W 10
 buffer_store_dwordx4 v[168:171],v224,s[8:11],s70 offen offset:3072 sc0 sc1
 v_cvt_pk_bf16_f32 v172,v56,v57
 M v[72:75],v[132:135],a[232:235],v[72:75]
 T v[156:157],v217,28672
 T v[158:159],v217,30720
 M v[76:79],v[132:135],a[236:239],v[76:79]
 W 10
 v_cvt_pk_bf16_f32 v174,v60,v61
 v_cvt_pk_bf16_f32 v173,v58,v59
 M v[72:75],v[136:139],a[240:243],v[72:75]
 T v[128:129],v217,36864
 T v[130:131],v217,38912
 M v[76:79],v[136:139],a[244:247],v[76:79]
 W 10
 v_cvt_pk_bf16_f32 v175,v62,v63
 s_add_u32 s70,s80,9216
 M v[72:75],v[140:143],a[248:251],v[72:75]
 T v[132:133],v217,45056
 T v[134:135],v217,47104
 M v[76:79],v[140:143],a[252:255],v[76:79]
 W 10
 v_permlane16_swap_b32 v172,v174
 M v[88:91],v[144:147],a[64:67],v[88:91]
 T v[136:137],v217,53248
 T v[138:139],v217,55296
 M v[92:95],v[144:147],a[68:71],v[92:95]
 W 10
 v_permlane16_swap_b32 v173,v175
 M v[88:91],v[148:151],a[72:75],v[88:91]
 T v[140:141],v217,61440
 T v[142:143],v217,63488
 M v[92:95],v[148:151],a[76:79],v[92:95]
 W 10
 buffer_store_dwordx4 v[172:175],v224,s[8:11],s70 offen offset:3072 sc0 sc1
 v_cvt_pk_bf16_f32 v176,v72,v73
 M v[88:91],v[152:155],a[80:83],v[88:91]
 T v[144:145],v213,4096
 T v[146:147],v213,6144
 M v[92:95],v[152:155],a[84:87],v[92:95]
 W 10
 v_cvt_pk_bf16_f32 v178,v76,v77
 v_cvt_pk_bf16_f32 v177,v74,v75
 M v[88:91],v[156:159],a[88:91],v[88:91]
 T v[148:149],v213,12288
 T v[150:151],v213,14336
 M v[92:95],v[156:159],a[92:95],v[92:95]
 W 10
 v_cvt_pk_bf16_f32 v179,v78,v79
 s_add_u32 s70,s80,13312
 M v[88:91],v[128:131],a[96:99],v[88:91]
 T v[152:153],v213,20480
 T v[154:155],v213,22528
 M v[92:95],v[128:131],a[100:103],v[92:95]
 W 10
 v_permlane16_swap_b32 v176,v178
 M v[88:91],v[132:135],a[104:107],v[88:91]
 T v[156:157],v213,28672
 T v[158:159],v213,30720
 M v[92:95],v[132:135],a[108:111],v[92:95]
 W 10
 v_permlane16_swap_b32 v177,v179
 M v[88:91],v[136:139],a[112:115],v[88:91]
 T v[128:129],v218,4096
 T v[130:131],v218,6144
 M v[92:95],v[136:139],a[116:119],v[92:95]
 W 10
 buffer_store_dwordx4 v[176:179],v224,s[8:11],s70 offen offset:0 sc0 sc1
 M v[88:91],v[140:143],a[120:123],v[88:91]
 T v[132:133],v218,12288
 T v[134:135],v218,14336
 M v[92:95],v[140:143],a[124:127],v[92:95]
 W 10
 M v[88:91],v[144:147],a[224:227],v[88:91]
 T v[136:137],v218,20480
 T v[138:139],v218,22528
 M v[92:95],v[144:147],a[228:231],v[92:95]
 W 10
 M v[88:91],v[148:151],a[232:235],v[88:91]
 T v[140:141],v218,28672
 T v[142:143],v218,30720
 M v[92:95],v[148:151],a[236:239],v[92:95]
 W 10
 M v[88:91],v[152:155],a[240:243],v[88:91]
 T v[144:145],v218,36864
 T v[146:147],v218,38912
 M v[92:95],v[152:155],a[244:247],v[92:95]
 W 10
 M v[88:91],v[156:159],a[248:251],v[88:91]
 T v[148:149],v218,45056
 T v[150:151],v218,47104
 M v[92:95],v[156:159],a[252:255],v[92:95]
 W 10
 M v[104:107],v[128:131],a[64:67],v[104:107]
 T v[152:153],v218,53248
 T v[154:155],v218,55296
 M v[108:111],v[128:131],a[68:71],v[108:111]
 W 10
 M v[104:107],v[132:135],a[72:75],v[104:107]
 T v[156:157],v218,61440
 T v[158:159],v218,63488
 M v[108:111],v[132:135],a[76:79],v[108:111]
 W 10
 v_cvt_pk_bf16_f32 v180,v88,v89
 v_cvt_pk_bf16_f32 v182,v92,v93
 M v[104:107],v[136:139],a[80:83],v[104:107]
 T v[128:129],v214,4096
 T v[130:131],v214,6144
 M v[108:111],v[136:139],a[84:87],v[108:111]
 W 10
 v_cvt_pk_bf16_f32 v181,v90,v91
 v_cvt_pk_bf16_f32 v183,v94,v95
 M v[104:107],v[140:143],a[88:91],v[104:107]
 T v[132:133],v214,12288
 T v[134:135],v214,14336
 M v[108:111],v[140:143],a[92:95],v[108:111]
 W 10
 s_add_u32 s70,s80,13312
 M v[104:107],v[144:147],a[96:99],v[104:107]
 T v[136:137],v214,20480
 T v[138:139],v214,22528
 M v[108:111],v[144:147],a[100:103],v[108:111]
 W 10
 v_permlane16_swap_b32 v180,v182
 M v[104:107],v[148:151],a[104:107],v[104:107]
 T v[140:141],v214,28672
 T v[142:143],v214,30720
 M v[108:111],v[148:151],a[108:111],v[108:111]
 W 10
 v_permlane16_swap_b32 v181,v183
 M v[104:107],v[152:155],a[112:115],v[104:107]
 T v[144:145],v219,4096
 T v[146:147],v219,6144
 M v[108:111],v[152:155],a[116:119],v[108:111]
 W 10
 buffer_store_dwordx4 v[180:183],v224,s[8:11],s70 offen offset:1024 sc0 sc1
 M v[104:107],v[156:159],a[120:123],v[104:107]
 T v[148:149],v219,12288
 T v[150:151],v219,14336
 M v[108:111],v[156:159],a[124:127],v[108:111]
 W 10
 M v[104:107],v[128:131],a[224:227],v[104:107]
 T v[152:153],v219,20480
 T v[154:155],v219,22528
 M v[108:111],v[128:131],a[228:231],v[108:111]
 W 10
 M v[104:107],v[132:135],a[232:235],v[104:107]
 T v[156:157],v219,28672
 T v[158:159],v219,30720
 M v[108:111],v[132:135],a[236:239],v[108:111]
 W 10
 M v[104:107],v[136:139],a[240:243],v[104:107]
 T v[128:129],v219,36864
 T v[130:131],v219,38912
 M v[108:111],v[136:139],a[244:247],v[108:111]
 W 10
 M v[104:107],v[140:143],a[248:251],v[104:107]
 T v[132:133],v219,45056
 T v[134:135],v219,47104
 M v[108:111],v[140:143],a[252:255],v[108:111]
 W 10
 M v[120:123],v[144:147],a[64:67],v[120:123]
 T v[136:137],v219,53248
 T v[138:139],v219,55296
 M v[124:127],v[144:147],a[68:71],v[124:127]
 W 10
 M v[120:123],v[148:151],a[72:75],v[120:123]
 T v[140:141],v219,61440
 T v[142:143],v219,63488
 M v[124:127],v[148:151],a[76:79],v[124:127]
 W 10
 v_cvt_pk_bf16_f32 v184,v104,v105
 v_cvt_pk_bf16_f32 v186,v108,v109
 M v[120:123],v[152:155],a[80:83],v[120:123]
 T v[144:145],v215,4096
 T v[146:147],v215,6144
 M v[124:127],v[152:155],a[84:87],v[124:127]
 W 10
 v_cvt_pk_bf16_f32 v185,v106,v107
 v_cvt_pk_bf16_f32 v187,v110,v111
 M v[120:123],v[156:159],a[88:91],v[120:123]
 T v[148:149],v215,12288
 T v[150:151],v215,14336
 M v[124:127],v[156:159],a[92:95],v[124:127]
 W 10
 s_add_u32 s70,s80,13312
 M v[120:123],v[128:131],a[96:99],v[120:123]
 T v[152:153],v215,20480
 T v[154:155],v215,22528
 M v[124:127],v[128:131],a[100:103],v[124:127]
 W 10
 v_permlane16_swap_b32 v184,v186
 M v[120:123],v[132:135],a[104:107],v[120:123]
 T v[156:157],v215,28672
 T v[158:159],v215,30720
 M v[124:127],v[132:135],a[108:111],v[124:127]
 W 10
 v_permlane16_swap_b32 v185,v187
 M v[120:123],v[136:139],a[112:115],v[120:123]
 buffer_store_dwordx4 v[184:187],v224,s[8:11],s70 offen offset:2048 sc0 sc1
 M v[124:127],v[136:139],a[116:119],v[124:127]
 W 8
 M v[120:123],v[140:143],a[120:123],v[120:123]
 M v[124:127],v[140:143],a[124:127],v[124:127]
 W 6
 M v[120:123],v[144:147],a[224:227],v[120:123]
 M v[124:127],v[144:147],a[228:231],v[124:127]
 W 4
 M v[120:123],v[148:151],a[232:235],v[120:123]
 M v[124:127],v[148:151],a[236:239],v[124:127]
 W 2
 M v[120:123],v[152:155],a[240:243],v[120:123]
 M v[124:127],v[152:155],a[244:247],v[124:127]
 W 0
 M v[120:123],v[156:159],a[248:251],v[120:123]
 M v[124:127],v[156:159],a[252:255],v[124:127]
 s_nop 6
 v_cvt_pk_bf16_f32 v188,v120,v121
 v_cvt_pk_bf16_f32 v190,v124,v125
 v_cvt_pk_bf16_f32 v189,v122,v123
 v_cvt_pk_bf16_f32 v191,v126,v127
 s_add_u32 s70,s80,13312
 v_permlane16_swap_b32 v188,v190
 v_permlane16_swap_b32 v189,v191
 buffer_store_dwordx4 v[188:191],v224,s[8:11],s70 offen offset:3072 sc0 sc1
 s_branch F_P4
F_Bodd:
 v_add_u32 v193,s77,v194
 W 7
 ds_read_b128 a[192:195],v193 offset:0
 W 7
 ds_read_b128 a[196:199],v193 offset:1024
 W 7
 ds_read_b128 a[200:203],v193 offset:2048
 W 7
 ds_read_b128 a[204:207],v193 offset:3072
 W 7
 ds_read_b128 a[208:211],v193 offset:4096
 W 7
 ds_read_b128 a[212:215],v193 offset:5120
 W 7
 ds_read_b128 a[216:219],v193 offset:6144
 W 7
 ds_read_b128 a[220:223],v193 offset:7168
 v_exp_f32 v32,v32
 v_exp_f32 v33,v33
 v_exp_f32 v34,v34
 v_add_f32 v199,v199,v32
 v_exp_f32 v35,v35
 v_add_f32 v199,v199,v33
 v_cvt_pk_bf16_f32 v32,v32,v33
 v_exp_f32 v36,v36
 v_add_f32 v199,v199,v34
 v_exp_f32 v37,v37
 v_cvt_pk_bf16_f32 v33,v34,v35
 v_add_f32 v199,v199,v35
 v_exp_f32 v38,v38
 v_add_f32 v199,v199,v36
 v_exp_f32 v39,v39
 v_cvt_pk_bf16_f32 v34,v36,v37
 v_add_f32 v199,v199,v37
 v_exp_f32 v40,v40
 v_add_f32 v199,v199,v38
 v_exp_f32 v41,v41
 v_cvt_pk_bf16_f32 v35,v38,v39
 v_add_f32 v199,v199,v39
 v_exp_f32 v42,v42
 v_add_f32 v199,v199,v40
 v_exp_f32 v43,v43
 v_add_f32 v199,v199,v41
 v_cvt_pk_bf16_f32 v40,v40,v41
 v_exp_f32 v44,v44
 v_add_f32 v199,v199,v42
 v_exp_f32 v45,v45
 v_cvt_pk_bf16_f32 v41,v42,v43
 v_add_f32 v199,v199,v43
 v_exp_f32 v46,v46
 v_add_f32 v199,v199,v44
 v_exp_f32 v47,v47
 v_cvt_pk_bf16_f32 v42,v44,v45
 v_add_f32 v199,v199,v45
 v_add_f32 v199,v199,v46
 v_cvt_pk_bf16_f32 v43,v46,v47
 v_add_f32 v199,v199,v47
 v_exp_f32 v48,v48
 v_exp_f32 v49,v49
 v_exp_f32 v50,v50
 v_add_f32 v199,v199,v48
 v_exp_f32 v51,v51
 v_add_f32 v199,v199,v49
 v_cvt_pk_bf16_f32 v48,v48,v49
 v_exp_f32 v52,v52
 v_add_f32 v199,v199,v50
 v_exp_f32 v53,v53
 v_cvt_pk_bf16_f32 v49,v50,v51
 v_add_f32 v199,v199,v51
 v_exp_f32 v54,v54
 v_add_f32 v199,v199,v52
 v_exp_f32 v55,v55
 v_cvt_pk_bf16_f32 v50,v52,v53
 v_add_f32 v199,v199,v53
 v_exp_f32 v56,v56
 v_add_f32 v199,v199,v54
 v_exp_f32 v57,v57
 v_cvt_pk_bf16_f32 v51,v54,v55
 v_add_f32 v199,v199,v55
 v_exp_f32 v58,v58
 v_add_f32 v199,v199,v56
 v_exp_f32 v59,v59
 v_add_f32 v199,v199,v57
 v_cvt_pk_bf16_f32 v56,v56,v57
 v_exp_f32 v60,v60
 v_add_f32 v199,v199,v58
 v_exp_f32 v61,v61
 v_cvt_pk_bf16_f32 v57,v58,v59
 v_add_f32 v199,v199,v59
 v_exp_f32 v62,v62
 v_add_f32 v199,v199,v60
 v_exp_f32 v63,v63
 v_cvt_pk_bf16_f32 v58,v60,v61
 v_add_f32 v199,v199,v61
 v_add_f32 v199,v199,v62
 v_cvt_pk_bf16_f32 v59,v62,v63
 v_add_f32 v199,v199,v63
 v_cmp_lt_f32 vcc,s78,v199
 s_cbranch_vccz F_c36
 s_call_b64 s[82:83],F_XBn0
F_c36:
 s_lshl_b32 s68,s64,13
 s_lshl_b32 s69,s67,8
 s_add_u32 s70,s68,s69
 s_lshl_b32 s68,s65,19
 s_add_u32 s68,s68,s70
 s_lshl_b32 s69,s67,17
 s_add_u32 s76,s68,s69
 s_add_u32 s69,s67,1
 s_and_b32 s69,s69,3
 s_lshl_b32 s87,s69,17
 s_add_u32 s87,s87,s68
 s_sub_u32 s69,s69,s67
 s_lshl_b32 s84,s69,12
 s_add_u32 s69,s67,2
 s_and_b32 s69,s69,3
 s_lshl_b32 s88,s69,17
 s_add_u32 s88,s88,s68
 s_sub_u32 s69,s69,s67
 s_lshl_b32 s85,s69,12
 s_add_u32 s69,s67,3
 s_and_b32 s69,s69,3
 s_lshl_b32 s89,s69,17
 s_add_u32 s89,s89,s68
 s_sub_u32 s69,s69,s67
 s_lshl_b32 s86,s69,12
 W 7
 N a[64:79],a[192:195],v[0:3],a[64:79]
 ds_read_b128 a[224:227],v193 offset:8192
 ds_read_b128 a[228:231],v193 offset:9216
 v_add_f32 v198,v198,v199
 v_lshrrev_b32 v164,4,v224
 v_lshrrev_b32 v160,4,v164
 v_bfe_u32 v161,v164,2,2
 W 8
 N a[80:95],a[196:199],v[0:3],a[80:95]
 W 6
 s_add_u32 m0,s72,49152
 s_add_u32 s68,s76,0
 buffer_load_dwordx4 v220,s[44:47],s68 offen lds
 v_and_b32 v162,1,v160
 v_lshl_add_u32 v161,v162,2,v161
 N a[96:111],a[200:203],v[0:3],a[96:111]
 ds_read_b128 a[232:235],v193 offset:10240
 ds_read_b128 a[236:239],v193 offset:11264
 v_lshrrev_b32 v160,1,v160
 v_lshlrev_b32 v160,10,v160
 v_lshl_add_u32 v160,v161,7,v160
 v_and_b32 v162,1,v164
 N a[112:127],a[204:207],v[0:3],a[112:127]
 W 6
 s_add_u32 m0,s72,53248
 s_add_u32 s68,s76,128
 buffer_load_dwordx4 v220,s[44:47],s68 offen lds
 v_lshl_add_u32 v160,v162,3,v160
 v_bfe_u32 v162,v164,1,1
 N a[64:79],a[208:211],v[8:11],a[64:79]
 ds_read_b128 a[240:243],v193 offset:12288
 ds_read_b128 a[244:247],v193 offset:13312
 v_lshl_add_u32 v160,v162,4,v160
 v_and_b32 v161,6,v161
 v_xor_b32 v162,0,v161
 v_lshl_add_u32 v216,v162,4,v160
 N a[80:95],a[212:215],v[8:11],a[80:95]
 W 6
 s_add_u32 m0,s72,57344
 s_add_u32 s68,s76,32768
 buffer_load_dwordx4 v220,s[44:47],s68 offen lds
 v_xor_b32 v162,2,v161
 v_lshl_add_u32 v217,v162,4,v160
 N a[96:111],a[216:219],v[8:11],a[96:111]
 ds_read_b128 a[248:251],v193 offset:14336
 ds_read_b128 a[252:255],v193 offset:15360
 v_xor_b32 v162,4,v161
 v_lshl_add_u32 v218,v162,4,v160
 v_xor_b32 v162,6,v161
 v_lshl_add_u32 v219,v162,4,v160
 N a[112:127],a[220:223],v[8:11],a[112:127]
 W 6
 s_add_u32 m0,s72,61440
 s_add_u32 s68,s76,32896
 buffer_load_dwordx4 v220,s[44:47],s68 offen lds
 v_add_u32 v212,131072,v216
 v_add_u32 v213,131072,v217
 N a[64:79],a[224:227],v[16:19],a[64:79]
 ds_read_b128 a[192:195],v193 offset:16384
 ds_read_b128 a[196:199],v193 offset:17408
 v_add_u32 v214,131072,v218
 v_add_u32 v215,131072,v219
 v_add_u32 v221,0x20000,v224
 s_lshr_b32 s70,s2,3
 N a[80:95],a[228:231],v[16:19],a[80:95]
 W 6
 s_add_u32 m0,s72,0
 s_add_u32 s68,s76,65536
 buffer_load_dwordx4 v220,s[44:47],s68 offen lds
 s_lshl_b32 s70,s70,2
 s_lshr_b32 s80,s65,1
 N a[96:111],a[232:235],v[16:19],a[96:111]
 ds_read_b128 a[200:203],v193 offset:18432
 ds_read_b128 a[204:207],v193 offset:19456
 s_add_u32 s80,s70,s80
 s_lshl_b32 s80,s80,10
 s_add_u32 s80,s80,0x6030000
 v_and_b32 v160,7,v164
 N a[112:127],a[236:239],v[16:19],a[112:127]
 W 6
 s_add_u32 m0,s72,4096
 s_add_u32 s68,s76,65664
 buffer_load_dwordx4 v220,s[44:47],s68 offen lds
 v_lshlrev_b32 v160,7,v160
 v_add_u32 v209,s80,v160
 N a[64:79],a[240:243],v[24:27],a[64:79]
 ds_read_b128 a[208:211],v193 offset:20480
 ds_read_b128 a[212:215],v193 offset:21504
 s_add_u32 s70,s70,s64
 s_lshl_b32 s70,s70,3
 s_add_u32 s70,s70,s65
 s_lshl_b32 s70,s70,7
 N a[80:95],a[244:247],v[24:27],a[80:95]
 W 6
 s_add_u32 m0,s72,8192
 s_add_u32 s68,s76,98304
 buffer_load_dwordx4 v220,s[44:47],s68 offen lds
 s_add_u32 s1,s70,0x6030000
 s_mov_b32 s80,s2
 N a[96:111],a[248:251],v[24:27],a[96:111]
 ds_read_b128 a[216:219],v193 offset:22528
 ds_read_b128 a[220:223],v193 offset:23552
 s_mul_i32 s80,s80,73728
 s_mul_i32 s70,s64,18432
 s_add_u32 s80,s80,s70
 s_add_u32 s80,s80,0x4000000
 N a[112:127],a[252:255],v[24:27],a[112:127]
 W 6
 s_add_u32 m0,s72,12288
 s_add_u32 s68,s76,98432
 buffer_load_dwordx4 v220,s[44:47],s68 offen lds
 N a[64:79],a[192:195],v[32:35],a[64:79]
 ds_read_b128 a[224:227],v193 offset:24576
 ds_read_b128 a[228:231],v193 offset:25600
 N a[80:95],a[196:199],v[32:35],a[80:95]
 W 6
 N a[96:111],a[200:203],v[32:35],a[96:111]
 ds_read_b128 a[232:235],v193 offset:26624
 ds_read_b128 a[236:239],v193 offset:27648
 N a[112:127],a[204:207],v[32:35],a[112:127]
 W 6
 N a[64:79],a[208:211],v[40:43],a[64:79]
 ds_read_b128 a[240:243],v193 offset:28672
 ds_read_b128 a[244:247],v193 offset:29696
 N a[80:95],a[212:215],v[40:43],a[80:95]
 W 6
 N a[96:111],a[216:219],v[40:43],a[96:111]
 ds_read_b128 a[248:251],v193 offset:30720
 ds_read_b128 a[252:255],v193 offset:31744
 N a[112:127],a[220:223],v[40:43],a[112:127]
 W 6
 N a[64:79],a[224:227],v[48:51],a[64:79]
 N a[80:95],a[228:231],v[48:51],a[80:95]
 W 4
 N a[96:111],a[232:235],v[48:51],a[96:111]
 s_waitcnt vmcnt(10)
 v_add_u32 v211,1,v211
 buffer_store_dword v211,v210,s[8:11],s73 offen sc0 sc1
 N a[112:127],a[236:239],v[48:51],a[112:127]
 W 2
 N a[64:79],a[240:243],v[56:59],a[64:79]
 N a[80:95],a[244:247],v[56:59],a[80:95]
 W 0
 N a[96:111],a[248:251],v[56:59],a[96:111]
 N a[112:127],a[252:255],v[56:59],a[112:127]
 W 0
 s_barrier
 T v[128:129],v212,0
 T v[130:131],v212,2048
 T v[132:133],v213,0
 T v[134:135],v213,2048
 T v[136:137],v214,0
 T v[138:139],v214,2048
 T v[140:141],v215,0
 T v[142:143],v215,2048
 W 6
 M v[0:3],v[128:131],a[8:11],0
 T v[144:145],v212,4096
 T v[146:147],v212,6144
 M v[4:7],v[128:131],a[12:15],0
 s_add_u32 m0,s72,65536
 s_add_u32 s68,s87,0
 buffer_load_dwordx4 v220,s[44:47],s68 offen lds
 M v[8:11],v[128:131],a[24:27],0
 v_mov_b32 v206,v198
 s_nop 1
 v_permlane32_swap_b32 v198,v206
 M v[12:15],v[128:131],a[28:31],0
 W 6
 v_add_f32 v198,v198,v206
 v_rcp_f32 v198,v198
 M v[16:19],v[132:135],a[8:11],0
 T v[148:149],v213,4096
 T v[150:151],v213,6144
 M v[20:23],v[132:135],a[12:15],0
 s_add_u32 m0,s72,69632
 s_add_u32 s68,s87,128
 buffer_load_dwordx4 v220,s[44:47],s68 offen lds
 M v[24:27],v[132:135],a[24:27],0
 s_add_u32 s97,s96,0x20000
 v_accvgpr_read_b32 v160,a64
 v_accvgpr_read_b32 v161,a65
 M v[28:31],v[132:135],a[28:31],0
 W 6
 v_accvgpr_read_b32 v162,a66
 v_accvgpr_read_b32 v163,a67
 v_accvgpr_read_b32 v164,a68
 M v[32:35],v[136:139],a[8:11],0
 T v[152:153],v214,4096
 T v[154:155],v214,6144
 M v[36:39],v[136:139],a[12:15],0
 s_add_u32 m0,s72,73728
 s_add_u32 s68,s87,32768
 buffer_load_dwordx4 v220,s[44:47],s68 offen lds
 M v[40:43],v[136:139],a[24:27],0
 v_accvgpr_read_b32 v165,a69
 v_accvgpr_read_b32 v166,a70
 v_accvgpr_read_b32 v167,a71
 M v[44:47],v[136:139],a[28:31],0
 W 6
 v_accvgpr_read_b32 v168,a72
 v_accvgpr_read_b32 v169,a73
 v_accvgpr_read_b32 v170,a74
 M v[48:51],v[140:143],a[8:11],0
 T v[156:157],v215,4096
 T v[158:159],v215,6144
 M v[52:55],v[140:143],a[12:15],0
 s_add_u32 m0,s72,77824
 s_add_u32 s68,s87,32896
 buffer_load_dwordx4 v220,s[44:47],s68 offen lds
 M v[56:59],v[140:143],a[24:27],0
 v_accvgpr_read_b32 v171,a75
 v_accvgpr_read_b32 v172,a76
 v_accvgpr_read_b32 v173,a77
 M v[60:63],v[140:143],a[28:31],0
 W 6
 v_accvgpr_read_b32 v174,a78
 v_accvgpr_read_b32 v175,a79
 v_mul_f32 v160,v160,v198
 M v[64:67],v[144:147],a[8:11],0
 T v[128:129],v212,8192
 T v[130:131],v212,10240
 M v[68:71],v[144:147],a[12:15],0
 s_add_u32 m0,s72,81920
 s_add_u32 s68,s87,65536
 buffer_load_dwordx4 v220,s[44:47],s68 offen lds
 M v[72:75],v[144:147],a[24:27],0
 v_mul_f32 v161,v161,v198
 v_mul_f32 v162,v162,v198
 v_mul_f32 v163,v163,v198
 M v[76:79],v[144:147],a[28:31],0
 W 6
 v_mul_f32 v164,v164,v198
 v_mul_f32 v165,v165,v198
 v_mul_f32 v166,v166,v198
 M v[80:83],v[148:151],a[8:11],0
 T v[132:133],v213,8192
 T v[134:135],v213,10240
 M v[84:87],v[148:151],a[12:15],0
 s_add_u32 m0,s72,86016
 s_add_u32 s68,s87,65664
 buffer_load_dwordx4 v220,s[44:47],s68 offen lds
 M v[88:91],v[148:151],a[24:27],0
 v_mul_f32 v167,v167,v198
 v_mul_f32 v168,v168,v198
 v_mul_f32 v169,v169,v198
 M v[92:95],v[148:151],a[28:31],0
 W 6
 v_mul_f32 v170,v170,v198
 v_mul_f32 v171,v171,v198
 v_mul_f32 v172,v172,v198
 M v[96:99],v[152:155],a[8:11],0
 T v[136:137],v214,8192
 T v[138:139],v214,10240
 M v[100:103],v[152:155],a[12:15],0
 s_add_u32 m0,s72,90112
 s_add_u32 s68,s87,98304
 buffer_load_dwordx4 v220,s[44:47],s68 offen lds
 M v[104:107],v[152:155],a[24:27],0
 v_mul_f32 v173,v173,v198
 v_mul_f32 v174,v174,v198
 v_mul_f32 v175,v175,v198
 M v[108:111],v[152:155],a[28:31],0
 W 6
 v_cvt_pk_bf16_f32 v226,v160,v161
 v_cvt_pk_bf16_f32 v227,v162,v163
 v_cvt_pk_bf16_f32 v228,v168,v169
 M v[112:115],v[156:159],a[8:11],0
 T v[140:141],v215,8192
 T v[142:143],v215,10240
 M v[116:119],v[156:159],a[12:15],0
 s_add_u32 m0,s72,94208
 s_add_u32 s68,s87,98432
 buffer_load_dwordx4 v220,s[44:47],s68 offen lds
 M v[120:123],v[156:159],a[24:27],0
 v_cvt_pk_bf16_f32 v229,v170,v171
 v_cvt_pk_bf16_f32 v230,v164,v165
 v_cvt_pk_bf16_f32 v231,v166,v167
 M v[124:127],v[156:159],a[28:31],0
 W 6
 v_cvt_pk_bf16_f32 v232,v172,v173
 v_cvt_pk_bf16_f32 v233,v174,v175
 M v[0:3],v[128:131],a[40:43],v[0:3]
 T v[144:145],v212,12288
 T v[146:147],v212,14336
 M v[4:7],v[128:131],a[44:47],v[4:7]
 s_add_u32 m0,s72,98304
 s_add_u32 s68,s88,0
 buffer_load_dwordx4 v220,s[44:47],s68 offen lds
 s_waitcnt vmcnt(19)
 M v[8:11],v[128:131],a[56:59],v[8:11]
 v_permlane32_swap_b32 v226,v230
 s_waitcnt vmcnt(18)
 M v[12:15],v[128:131],a[60:63],v[12:15]
 W 6
 v_permlane32_swap_b32 v227,v231
 M v[16:19],v[132:135],a[40:43],v[16:19]
 T v[148:149],v213,12288
 T v[150:151],v213,14336
 M v[20:23],v[132:135],a[44:47],v[20:23]
 s_add_u32 m0,s72,102400
 s_add_u32 s68,s88,128
 buffer_load_dwordx4 v220,s[44:47],s68 offen lds
 M v[24:27],v[132:135],a[56:59],v[24:27]
 v_permlane32_swap_b32 v228,v232
 M v[28:31],v[132:135],a[60:63],v[28:31]
 W 6
 v_permlane32_swap_b32 v229,v233
 M v[32:35],v[136:139],a[40:43],v[32:35]
 T v[152:153],v214,12288
 T v[154:155],v214,14336
 M v[36:39],v[136:139],a[44:47],v[36:39]
 s_add_u32 m0,s72,106496
 s_add_u32 s68,s88,32768
 buffer_load_dwordx4 v220,s[44:47],s68 offen lds
 M v[40:43],v[136:139],a[56:59],v[40:43]
 v_permlane16_swap_b32 v226,v230
 M v[44:47],v[136:139],a[60:63],v[44:47]
 W 6
 v_permlane16_swap_b32 v227,v231
 M v[48:51],v[140:143],a[40:43],v[48:51]
 T v[156:157],v215,12288
 T v[158:159],v215,14336
 M v[52:55],v[140:143],a[44:47],v[52:55]
 s_add_u32 m0,s72,110592
 s_add_u32 s68,s88,32896
 buffer_load_dwordx4 v220,s[44:47],s68 offen lds
 M v[56:59],v[140:143],a[56:59],v[56:59]
 v_permlane16_swap_b32 v228,v232
 M v[60:63],v[140:143],a[60:63],v[60:63]
 W 6
 v_permlane16_swap_b32 v229,v233
 buffer_store_dwordx4 v[226:229],v224,s[8:11],s96 offen offset:0 sc0 sc1
 M v[64:67],v[144:147],a[40:43],v[64:67]
 T v[128:129],v212,16384
 T v[130:131],v212,18432
 M v[68:71],v[144:147],a[44:47],v[68:71]
 s_add_u32 m0,s72,114688
 s_add_u32 s68,s88,65536
 buffer_load_dwordx4 v220,s[44:47],s68 offen lds
 M v[72:75],v[144:147],a[56:59],v[72:75]
 buffer_store_dwordx4 v[230:233],v224,s[8:11],s97 offen offset:0 sc0 sc1
 v_accvgpr_write_b32 a8,v226
 v_accvgpr_write_b32 a9,v227
 M v[76:79],v[144:147],a[60:63],v[76:79]
 W 6
 v_accvgpr_write_b32 a10,v228
 v_accvgpr_write_b32 a11,v229
 v_accvgpr_write_b32 a12,v230
 M v[80:83],v[148:151],a[40:43],v[80:83]
 T v[132:133],v213,16384
 T v[134:135],v213,18432
 M v[84:87],v[148:151],a[44:47],v[84:87]
 s_add_u32 m0,s72,118784
 s_add_u32 s68,s88,65664
 buffer_load_dwordx4 v220,s[44:47],s68 offen lds
 M v[88:91],v[148:151],a[56:59],v[88:91]
 v_accvgpr_write_b32 a13,v231
 v_accvgpr_write_b32 a14,v232
 v_accvgpr_write_b32 a15,v233
 M v[92:95],v[148:151],a[60:63],v[92:95]
 W 6
 v_accvgpr_read_b32 v176,a80
 v_accvgpr_read_b32 v177,a81
 v_accvgpr_read_b32 v178,a82
 M v[96:99],v[152:155],a[40:43],v[96:99]
 T v[136:137],v214,16384
 T v[138:139],v214,18432
 M v[100:103],v[152:155],a[44:47],v[100:103]
 buffer_load_dword v207,v208,s[8:11],0 offen sc1
 v_accvgpr_read_b32 v179,a83
 v_accvgpr_read_b32 v180,a84
 M v[104:107],v[152:155],a[56:59],v[104:107]
 v_accvgpr_read_b32 v181,a85
 v_accvgpr_read_b32 v182,a86
 v_accvgpr_read_b32 v183,a87
 M v[108:111],v[152:155],a[60:63],v[108:111]
 W 6
 v_accvgpr_read_b32 v184,a88
 v_accvgpr_read_b32 v185,a89
 v_accvgpr_read_b32 v186,a90
 M v[112:115],v[156:159],a[40:43],v[112:115]
 T v[140:141],v215,16384
 T v[142:143],v215,18432
 M v[116:119],v[156:159],a[44:47],v[116:119]
 s_add_u32 m0,s72,122880
 s_add_u32 s68,s88,98304
 buffer_load_dwordx4 v220,s[44:47],s68 offen lds
 M v[120:123],v[156:159],a[56:59],v[120:123]
 v_accvgpr_read_b32 v187,a91
 v_accvgpr_read_b32 v188,a92
 v_accvgpr_read_b32 v189,a93
 M v[124:127],v[156:159],a[60:63],v[124:127]
 W 6
 v_accvgpr_read_b32 v190,a94
 v_accvgpr_read_b32 v191,a95
 v_mul_f32 v176,v176,v198
 M v[0:3],v[128:131],a[128:131],v[0:3]
 T v[144:145],v212,20480
 T v[146:147],v212,22528
 M v[4:7],v[128:131],a[132:135],v[4:7]
 s_add_u32 m0,s72,126976
 s_add_u32 s68,s88,98432
 buffer_load_dwordx4 v220,s[44:47],s68 offen lds
 M v[8:11],v[128:131],a[136:139],v[8:11]
 v_mul_f32 v177,v177,v198
 v_mul_f32 v178,v178,v198
 v_mul_f32 v179,v179,v198
 M v[12:15],v[128:131],a[140:143],v[12:15]
 W 6
 v_mul_f32 v180,v180,v198
 v_mul_f32 v181,v181,v198
 v_mul_f32 v182,v182,v198
 M v[16:19],v[132:135],a[128:131],v[16:19]
 T v[148:149],v213,20480
 T v[150:151],v213,22528
 M v[20:23],v[132:135],a[132:135],v[20:23]
 v_mul_f32 v183,v183,v198
 v_mul_f32 v184,v184,v198
 v_mul_f32 v185,v185,v198
 M v[24:27],v[132:135],a[136:139],v[24:27]
 v_mul_f32 v186,v186,v198
 v_mul_f32 v187,v187,v198
 v_mul_f32 v188,v188,v198
 M v[28:31],v[132:135],a[140:143],v[28:31]
 W 6
 v_mul_f32 v189,v189,v198
 v_mul_f32 v190,v190,v198
 v_mul_f32 v191,v191,v198
 M v[32:35],v[136:139],a[128:131],v[32:35]
 T v[152:153],v214,20480
 T v[154:155],v214,22528
 M v[36:39],v[136:139],a[132:135],v[36:39]
 v_cvt_pk_bf16_f32 v234,v176,v177
 v_cvt_pk_bf16_f32 v235,v178,v179
 v_cvt_pk_bf16_f32 v236,v184,v185
 M v[40:43],v[136:139],a[136:139],v[40:43]
 v_cvt_pk_bf16_f32 v237,v186,v187
 v_cvt_pk_bf16_f32 v238,v180,v181
 v_cvt_pk_bf16_f32 v239,v182,v183
 M v[44:47],v[136:139],a[140:143],v[44:47]
 W 6
 v_cvt_pk_bf16_f32 v240,v188,v189
 v_cvt_pk_bf16_f32 v241,v190,v191
 M v[48:51],v[140:143],a[128:131],v[48:51]
 T v[156:157],v215,20480
 T v[158:159],v215,22528
 M v[52:55],v[140:143],a[132:135],v[52:55]
 v_permlane32_swap_b32 v234,v238
 M v[56:59],v[140:143],a[136:139],v[56:59]
 v_permlane32_swap_b32 v235,v239
 M v[60:63],v[140:143],a[140:143],v[60:63]
 W 6
 v_permlane32_swap_b32 v236,v240
 M v[64:67],v[144:147],a[128:131],v[64:67]
 T v[128:129],v212,24576
 T v[130:131],v212,26624
 M v[68:71],v[144:147],a[132:135],v[68:71]
 v_permlane32_swap_b32 v237,v241
 M v[72:75],v[144:147],a[136:139],v[72:75]
 v_permlane16_swap_b32 v234,v238
 M v[76:79],v[144:147],a[140:143],v[76:79]
 W 6
 v_permlane16_swap_b32 v235,v239
 M v[80:83],v[148:151],a[128:131],v[80:83]
 T v[132:133],v213,24576
 T v[134:135],v213,26624
 M v[84:87],v[148:151],a[132:135],v[84:87]
 v_permlane16_swap_b32 v236,v240
 M v[88:91],v[148:151],a[136:139],v[88:91]
 v_permlane16_swap_b32 v237,v241
 buffer_store_dwordx4 v[234:237],v224,s[8:11],s96 offen offset:1024 sc0 sc1
 M v[92:95],v[148:151],a[140:143],v[92:95]
 W 6
 buffer_store_dwordx4 v[238:241],v224,s[8:11],s97 offen offset:1024 sc0 sc1
 v_accvgpr_write_b32 a24,v234
 v_accvgpr_write_b32 a25,v235
 M v[96:99],v[152:155],a[128:131],v[96:99]
 T v[136:137],v214,24576
 T v[138:139],v214,26624
 M v[100:103],v[152:155],a[132:135],v[100:103]
 v_accvgpr_write_b32 a26,v236
 v_accvgpr_write_b32 a27,v237
 v_accvgpr_write_b32 a28,v238
 M v[104:107],v[152:155],a[136:139],v[104:107]
 v_accvgpr_write_b32 a29,v239
 v_accvgpr_write_b32 a30,v240
 v_accvgpr_write_b32 a31,v241
 M v[108:111],v[152:155],a[140:143],v[108:111]
 W 6
 v_accvgpr_read_b32 v160,a96
 v_accvgpr_read_b32 v161,a97
 v_accvgpr_read_b32 v162,a98
 M v[112:115],v[156:159],a[128:131],v[112:115]
 T v[140:141],v215,24576
 T v[142:143],v215,26624
 M v[116:119],v[156:159],a[132:135],v[116:119]
 v_accvgpr_read_b32 v163,a99
 v_accvgpr_read_b32 v164,a100
 v_accvgpr_read_b32 v165,a101
 M v[120:123],v[156:159],a[136:139],v[120:123]
 v_accvgpr_read_b32 v166,a102
 v_accvgpr_read_b32 v167,a103
 v_accvgpr_read_b32 v168,a104
 M v[124:127],v[156:159],a[140:143],v[124:127]
 W 6
 v_accvgpr_read_b32 v169,a105
 v_accvgpr_read_b32 v170,a106
 v_accvgpr_read_b32 v171,a107
 M v[0:3],v[128:131],a[144:147],v[0:3]
 T v[144:145],v212,28672
 T v[146:147],v212,30720
 M v[4:7],v[128:131],a[148:151],v[4:7]
 v_accvgpr_read_b32 v172,a108
 v_accvgpr_read_b32 v173,a109
 v_accvgpr_read_b32 v174,a110
 M v[8:11],v[128:131],a[152:155],v[8:11]
 v_accvgpr_read_b32 v175,a111
 v_mul_f32 v160,v160,v198
 v_mul_f32 v161,v161,v198
 M v[12:15],v[128:131],a[156:159],v[12:15]
 W 6
 v_mul_f32 v162,v162,v198
 v_mul_f32 v163,v163,v198
 v_mul_f32 v164,v164,v198
 M v[16:19],v[132:135],a[144:147],v[16:19]
 T v[148:149],v213,28672
 T v[150:151],v213,30720
 M v[20:23],v[132:135],a[148:151],v[20:23]
 v_mul_f32 v165,v165,v198
 v_mul_f32 v166,v166,v198
 v_mul_f32 v167,v167,v198
 M v[24:27],v[132:135],a[152:155],v[24:27]
 v_mul_f32 v168,v168,v198
 v_mul_f32 v169,v169,v198
 v_mul_f32 v170,v170,v198
 M v[28:31],v[132:135],a[156:159],v[28:31]
 W 6
 v_mul_f32 v171,v171,v198
 v_mul_f32 v172,v172,v198
 v_mul_f32 v173,v173,v198
 M v[32:35],v[136:139],a[144:147],v[32:35]
 T v[152:153],v214,28672
 T v[154:155],v214,30720
 M v[36:39],v[136:139],a[148:151],v[36:39]
 s_add_u32 s63,s62,2
 s_waitcnt vmcnt(4)
 v_subrev_u32 v207,s63,v207
 v_cmp_le_u32 vcc,8,v207
 s_cbranch_vccz PL_ok15
 s_mov_b32 s69,0x100000
PL_sp15:
 s_sleep 2
 buffer_load_dword v207,v208,s[8:11],0 offen sc1
 s_waitcnt vmcnt(0)
 v_subrev_u32 v207,s63,v207
 v_cmp_le_u32 vcc,8,v207
 s_cbranch_vccz PL_ok15
 s_sub_u32 s69,s69,1
 s_cbranch_scc0 PL_sp15
PL_ok15:
 M v[40:43],v[136:139],a[152:155],v[40:43]
 s_add_u32 s81,s95,s85
 buffer_load_dwordx4 a[160:163],v224,s[8:11],s81 offen offset:0 sc1
 v_mul_f32 v174,v174,v198
 M v[44:47],v[136:139],a[156:159],v[44:47]
 W 6
 v_mul_f32 v175,v175,v198
 v_cvt_pk_bf16_f32 v226,v160,v161
 v_cvt_pk_bf16_f32 v227,v162,v163
 M v[48:51],v[140:143],a[144:147],v[48:51]
 T v[156:157],v215,28672
 T v[158:159],v215,30720
 M v[52:55],v[140:143],a[148:151],v[52:55]
 v_cvt_pk_bf16_f32 v228,v168,v169
 v_cvt_pk_bf16_f32 v229,v170,v171
 v_cvt_pk_bf16_f32 v230,v164,v165
 M v[56:59],v[140:143],a[152:155],v[56:59]
 buffer_load_dwordx4 a[164:167],v221,s[8:11],s81 offen offset:0 sc1
 v_cvt_pk_bf16_f32 v231,v166,v167
 v_cvt_pk_bf16_f32 v232,v172,v173
 M v[60:63],v[140:143],a[156:159],v[60:63]
 W 6
 s_barrier
 v_cvt_pk_bf16_f32 v233,v174,v175
 M v[64:67],v[144:147],a[144:147],v[64:67]
 T v[128:129],v216,49152
 T v[130:131],v216,51200
 M v[68:71],v[144:147],a[148:151],v[68:71]
 v_permlane32_swap_b32 v226,v230
 M v[72:75],v[144:147],a[152:155],v[72:75]
 buffer_load_dwordx4 a[168:171],v224,s[8:11],s81 offen offset:1024 sc1
 v_permlane32_swap_b32 v227,v231
 M v[76:79],v[144:147],a[156:159],v[76:79]
 W 6
 v_permlane32_swap_b32 v228,v232
 M v[80:83],v[148:151],a[144:147],v[80:83]
 T v[132:133],v217,49152
 T v[134:135],v217,51200
 M v[84:87],v[148:151],a[148:151],v[84:87]
 v_permlane32_swap_b32 v229,v233
 M v[88:91],v[148:151],a[152:155],v[88:91]
 buffer_load_dwordx4 a[172:175],v221,s[8:11],s81 offen offset:1024 sc1
 v_permlane16_swap_b32 v226,v230
 M v[92:95],v[148:151],a[156:159],v[92:95]
 W 6
 v_permlane16_swap_b32 v227,v231
 M v[96:99],v[152:155],a[144:147],v[96:99]
 T v[136:137],v218,49152
 T v[138:139],v218,51200
 M v[100:103],v[152:155],a[148:151],v[100:103]
 v_permlane16_swap_b32 v228,v232
 M v[104:107],v[152:155],a[152:155],v[104:107]
 buffer_load_dwordx4 a[176:179],v224,s[8:11],s81 offen offset:2048 sc1
 v_permlane16_swap_b32 v229,v233
 M v[108:111],v[152:155],a[156:159],v[108:111]
 W 6
 buffer_store_dwordx4 v[226:229],v224,s[8:11],s96 offen offset:2048 sc0 sc1
 buffer_store_dwordx4 v[230:233],v224,s[8:11],s97 offen offset:2048 sc0 sc1
 v_accvgpr_write_b32 a40,v226
 M v[112:115],v[156:159],a[144:147],v[112:115]
 T v[140:141],v219,49152
 T v[142:143],v219,51200
 M v[116:119],v[156:159],a[148:151],v[116:119]
 v_accvgpr_write_b32 a41,v227
 v_accvgpr_write_b32 a42,v228
 v_accvgpr_write_b32 a43,v229
 M v[120:123],v[156:159],a[152:155],v[120:123]
 buffer_load_dwordx4 a[180:183],v221,s[8:11],s81 offen offset:2048 sc1
 v_accvgpr_write_b32 a44,v230
 v_accvgpr_write_b32 a45,v231
 M v[124:127],v[156:159],a[156:159],v[124:127]
 W 6
 v_accvgpr_write_b32 a46,v232
 v_accvgpr_write_b32 a47,v233
 v_accvgpr_read_b32 v176,a112
 M v[0:3],v[128:131],a[0:3],v[0:3]
 T v[144:145],v216,53248
 T v[146:147],v216,55296
 M v[4:7],v[128:131],a[4:7],v[4:7]
 v_accvgpr_read_b32 v177,a113
 v_accvgpr_read_b32 v178,a114
 v_accvgpr_read_b32 v179,a115
 M v[8:11],v[128:131],a[8:11],v[8:11]
 buffer_load_dwordx4 a[184:187],v224,s[8:11],s81 offen offset:3072 sc1
 v_accvgpr_read_b32 v180,a116
 v_accvgpr_read_b32 v181,a117
 M v[12:15],v[128:131],a[12:15],v[12:15]
 W 6
 v_accvgpr_read_b32 v182,a118
 v_accvgpr_read_b32 v183,a119
 v_accvgpr_read_b32 v184,a120
 M v[16:19],v[132:135],a[0:3],v[16:19]
 T v[148:149],v217,53248
 T v[150:151],v217,55296
 M v[20:23],v[132:135],a[4:7],v[20:23]
 v_accvgpr_read_b32 v185,a121
 v_accvgpr_read_b32 v186,a122
 v_accvgpr_read_b32 v187,a123
 M v[24:27],v[132:135],a[8:11],v[24:27]
 buffer_load_dwordx4 a[188:191],v221,s[8:11],s81 offen offset:3072 sc1
 v_accvgpr_read_b32 v188,a124
 v_accvgpr_read_b32 v189,a125
 M v[28:31],v[132:135],a[12:15],v[28:31]
 W 6
 v_accvgpr_read_b32 v190,a126
 v_accvgpr_read_b32 v191,a127
 v_mul_f32 v176,v176,v198
 M v[32:35],v[136:139],a[0:3],v[32:35]
 T v[152:153],v218,53248
 T v[154:155],v218,55296
 M v[36:39],v[136:139],a[4:7],v[36:39]
 v_mul_f32 v177,v177,v198
 v_mul_f32 v178,v178,v198
 v_mul_f32 v179,v179,v198
 M v[40:43],v[136:139],a[8:11],v[40:43]
 s_add_u32 s81,s95,s86
 buffer_load_dwordx4 a[192:195],v224,s[8:11],s81 offen offset:0 sc1
 v_mul_f32 v180,v180,v198
 M v[44:47],v[136:139],a[12:15],v[44:47]
 W 6
 v_mul_f32 v181,v181,v198
 v_mul_f32 v182,v182,v198
 v_mul_f32 v183,v183,v198
 M v[48:51],v[140:143],a[0:3],v[48:51]
 T v[156:157],v219,53248
 T v[158:159],v219,55296
 M v[52:55],v[140:143],a[4:7],v[52:55]
 v_mul_f32 v184,v184,v198
 v_mul_f32 v185,v185,v198
 v_mul_f32 v186,v186,v198
 M v[56:59],v[140:143],a[8:11],v[56:59]
 buffer_load_dwordx4 a[196:199],v221,s[8:11],s81 offen offset:0 sc1
 v_mul_f32 v187,v187,v198
 v_mul_f32 v188,v188,v198
 M v[60:63],v[140:143],a[12:15],v[60:63]
 W 6
 v_mul_f32 v189,v189,v198
 v_mul_f32 v190,v190,v198
 v_mul_f32 v191,v191,v198
 M v[64:67],v[144:147],a[0:3],v[64:67]
 T v[128:129],v216,57344
 T v[130:131],v216,59392
 M v[68:71],v[144:147],a[4:7],v[68:71]
 v_cvt_pk_bf16_f32 v234,v176,v177
 v_cvt_pk_bf16_f32 v235,v178,v179
 v_cvt_pk_bf16_f32 v236,v184,v185
 M v[72:75],v[144:147],a[8:11],v[72:75]
 buffer_load_dwordx4 a[200:203],v224,s[8:11],s81 offen offset:1024 sc1
 v_cvt_pk_bf16_f32 v237,v186,v187
 v_cvt_pk_bf16_f32 v238,v180,v181
 M v[76:79],v[144:147],a[12:15],v[76:79]
 W 6
 v_cvt_pk_bf16_f32 v239,v182,v183
 v_cvt_pk_bf16_f32 v240,v188,v189
 v_cvt_pk_bf16_f32 v241,v190,v191
 M v[80:83],v[148:151],a[0:3],v[80:83]
 T v[132:133],v217,57344
 T v[134:135],v217,59392
 M v[84:87],v[148:151],a[4:7],v[84:87]
 v_permlane32_swap_b32 v234,v238
 M v[88:91],v[148:151],a[8:11],v[88:91]
 buffer_load_dwordx4 a[204:207],v221,s[8:11],s81 offen offset:1024 sc1
 v_permlane32_swap_b32 v235,v239
 M v[92:95],v[148:151],a[12:15],v[92:95]
 W 6
 v_permlane32_swap_b32 v236,v240
 M v[96:99],v[152:155],a[0:3],v[96:99]
 T v[136:137],v218,57344
 T v[138:139],v218,59392
 M v[100:103],v[152:155],a[4:7],v[100:103]
 v_permlane32_swap_b32 v237,v241
 M v[104:107],v[152:155],a[8:11],v[104:107]
 buffer_load_dwordx4 a[208:211],v224,s[8:11],s81 offen offset:2048 sc1
 v_permlane16_swap_b32 v234,v238
 M v[108:111],v[152:155],a[12:15],v[108:111]
 W 6
 v_permlane16_swap_b32 v235,v239
 M v[112:115],v[156:159],a[0:3],v[112:115]
 T v[140:141],v219,57344
 T v[142:143],v219,59392
 M v[116:119],v[156:159],a[4:7],v[116:119]
 v_permlane16_swap_b32 v236,v240
 M v[120:123],v[156:159],a[8:11],v[120:123]
 buffer_load_dwordx4 a[212:215],v221,s[8:11],s81 offen offset:2048 sc1
 v_permlane16_swap_b32 v237,v241
 M v[124:127],v[156:159],a[12:15],v[124:127]
 W 6
 buffer_store_dwordx4 v[234:237],v224,s[8:11],s96 offen offset:3072 sc0 sc1
 buffer_store_dwordx4 v[238:241],v224,s[8:11],s97 offen offset:3072 sc0 sc1
 v_accvgpr_write_b32 a56,v234
 M v[0:3],v[128:131],a[16:19],v[0:3]
 T v[144:145],v216,61440
 T v[146:147],v216,63488
 M v[4:7],v[128:131],a[20:23],v[4:7]
 v_accvgpr_write_b32 a57,v235
 v_accvgpr_write_b32 a58,v236
 M v[8:11],v[128:131],a[24:27],v[8:11]
 buffer_load_dwordx4 a[216:219],v224,s[8:11],s81 offen offset:3072 sc1
 v_accvgpr_write_b32 a59,v237
 M v[12:15],v[128:131],a[28:31],v[12:15]
 W 6
 v_accvgpr_write_b32 a60,v238
 v_accvgpr_write_b32 a61,v239
 M v[16:19],v[132:135],a[16:19],v[16:19]
 T v[148:149],v217,61440
 T v[150:151],v217,63488
 M v[20:23],v[132:135],a[20:23],v[20:23]
 v_accvgpr_write_b32 a62,v240
 v_accvgpr_write_b32 a63,v241
 M v[24:27],v[132:135],a[24:27],v[24:27]
 buffer_load_dwordx4 a[220:223],v221,s[8:11],s81 offen offset:3072 sc1
 M v[28:31],v[132:135],a[28:31],v[28:31]
 W 6
 M v[32:35],v[136:139],a[16:19],v[32:35]
 T v[152:153],v218,61440
 T v[154:155],v218,63488
 M v[36:39],v[136:139],a[20:23],v[36:39]
 M v[40:43],v[136:139],a[24:27],v[40:43]
 s_add_u32 s81,s95,s84
 buffer_load_dwordx4 a[128:131],v224,s[8:11],s81 offen offset:0 sc1
 M v[44:47],v[136:139],a[28:31],v[44:47]
 W 6
 M v[48:51],v[140:143],a[16:19],v[48:51]
 T v[156:157],v219,61440
 T v[158:159],v219,63488
 M v[52:55],v[140:143],a[20:23],v[52:55]
 M v[56:59],v[140:143],a[24:27],v[56:59]
 buffer_load_dwordx4 a[132:135],v221,s[8:11],s81 offen offset:0 sc1
 M v[60:63],v[140:143],a[28:31],v[60:63]
 W 6
 M v[64:67],v[144:147],a[16:19],v[64:67]
 T v[128:129],v216,0
 T v[130:131],v216,2048
 M v[68:71],v[144:147],a[20:23],v[68:71]
 M v[72:75],v[144:147],a[24:27],v[72:75]
 buffer_load_dwordx4 a[136:139],v224,s[8:11],s81 offen offset:1024 sc1
 M v[76:79],v[144:147],a[28:31],v[76:79]
 W 6
 M v[80:83],v[148:151],a[16:19],v[80:83]
 T v[132:133],v217,0
 T v[134:135],v217,2048
 M v[84:87],v[148:151],a[20:23],v[84:87]
 M v[88:91],v[148:151],a[24:27],v[88:91]
 buffer_load_dwordx4 a[140:143],v221,s[8:11],s81 offen offset:1024 sc1
 M v[92:95],v[148:151],a[28:31],v[92:95]
 W 6
 M v[96:99],v[152:155],a[16:19],v[96:99]
 T v[136:137],v218,0
 T v[138:139],v218,2048
 M v[100:103],v[152:155],a[20:23],v[100:103]
 M v[104:107],v[152:155],a[24:27],v[104:107]
 s_add_u32 m0,s72,131072
 s_add_u32 s68,s89,0
 buffer_load_dwordx4 v220,s[44:47],s68 offen lds
 M v[108:111],v[152:155],a[28:31],v[108:111]
 W 6
 M v[112:115],v[156:159],a[16:19],v[112:115]
 T v[140:141],v219,0
 T v[142:143],v219,2048
 M v[116:119],v[156:159],a[20:23],v[116:119]
 M v[120:123],v[156:159],a[24:27],v[120:123]
 s_add_u32 m0,s72,135168
 s_add_u32 s68,s89,128
 buffer_load_dwordx4 v220,s[44:47],s68 offen lds
 M v[124:127],v[156:159],a[28:31],v[124:127]
 W 6
 M v[0:3],v[128:131],a[32:35],v[0:3]
 T v[144:145],v216,4096
 T v[146:147],v216,6144
 M v[4:7],v[128:131],a[36:39],v[4:7]
 M v[8:11],v[128:131],a[40:43],v[8:11]
 s_add_u32 m0,s72,139264
 s_add_u32 s68,s89,32768
 buffer_load_dwordx4 v220,s[44:47],s68 offen lds
 M v[12:15],v[128:131],a[44:47],v[12:15]
 W 6
 M v[16:19],v[132:135],a[32:35],v[16:19]
 T v[148:149],v217,4096
 T v[150:151],v217,6144
 M v[20:23],v[132:135],a[36:39],v[20:23]
 M v[24:27],v[132:135],a[40:43],v[24:27]
 s_add_u32 m0,s72,143360
 s_add_u32 s68,s89,32896
 buffer_load_dwordx4 v220,s[44:47],s68 offen lds
 M v[28:31],v[132:135],a[44:47],v[28:31]
 W 6
 M v[32:35],v[136:139],a[32:35],v[32:35]
 T v[152:153],v218,4096
 T v[154:155],v218,6144
 M v[36:39],v[136:139],a[36:39],v[36:39]
 M v[40:43],v[136:139],a[40:43],v[40:43]
 s_add_u32 m0,s72,147456
 s_add_u32 s68,s89,65536
 buffer_load_dwordx4 v220,s[44:47],s68 offen lds
 M v[44:47],v[136:139],a[44:47],v[44:47]
 W 6
 M v[48:51],v[140:143],a[32:35],v[48:51]
 T v[156:157],v219,4096
 T v[158:159],v219,6144
 M v[52:55],v[140:143],a[36:39],v[52:55]
 M v[56:59],v[140:143],a[40:43],v[56:59]
 s_add_u32 m0,s72,151552
 s_add_u32 s68,s89,65664
 buffer_load_dwordx4 v220,s[44:47],s68 offen lds
 M v[60:63],v[140:143],a[44:47],v[60:63]
 W 6
 M v[64:67],v[144:147],a[32:35],v[64:67]
 T v[128:129],v216,8192
 T v[130:131],v216,10240
 M v[68:71],v[144:147],a[36:39],v[68:71]
 s_waitcnt vmcnt(12)
 v_add_u32 v211,1,v211
 buffer_store_dword v211,v210,s[8:11],s73 offen sc0 sc1
 M v[72:75],v[144:147],a[40:43],v[72:75]
 buffer_load_dwordx4 a[144:147],v224,s[8:11],s81 offen offset:2048 sc1
 M v[76:79],v[144:147],a[44:47],v[76:79]
 W 6
 M v[80:83],v[148:151],a[32:35],v[80:83]
 T v[132:133],v217,8192
 T v[134:135],v217,10240
 M v[84:87],v[148:151],a[36:39],v[84:87]
 M v[88:91],v[148:151],a[40:43],v[88:91]
 buffer_load_dwordx4 a[148:151],v221,s[8:11],s81 offen offset:2048 sc1
 M v[92:95],v[148:151],a[44:47],v[92:95]
 W 6
 M v[96:99],v[152:155],a[32:35],v[96:99]
 T v[136:137],v218,8192
 T v[138:139],v218,10240
 M v[100:103],v[152:155],a[36:39],v[100:103]
 M v[104:107],v[152:155],a[40:43],v[104:107]
 buffer_load_dwordx4 a[152:155],v224,s[8:11],s81 offen offset:3072 sc1
 M v[108:111],v[152:155],a[44:47],v[108:111]
 W 6
 M v[112:115],v[156:159],a[32:35],v[112:115]
 T v[140:141],v219,8192
 T v[142:143],v219,10240
 M v[116:119],v[156:159],a[36:39],v[116:119]
 M v[120:123],v[156:159],a[40:43],v[120:123]
 buffer_load_dwordx4 a[156:159],v221,s[8:11],s81 offen offset:3072 sc1
 M v[124:127],v[156:159],a[44:47],v[124:127]
 W 6
 M v[0:3],v[128:131],a[48:51],v[0:3]
 T v[144:145],v216,12288
 T v[146:147],v216,14336
 M v[4:7],v[128:131],a[52:55],v[4:7]
 M v[8:11],v[128:131],a[56:59],v[8:11]
 M v[12:15],v[128:131],a[60:63],v[12:15]
 W 6
 M v[16:19],v[132:135],a[48:51],v[16:19]
 T v[148:149],v217,12288
 T v[150:151],v217,14336
 M v[20:23],v[132:135],a[52:55],v[20:23]
 M v[24:27],v[132:135],a[56:59],v[24:27]
 M v[28:31],v[132:135],a[60:63],v[28:31]
 W 6
 M v[32:35],v[136:139],a[48:51],v[32:35]
 T v[152:153],v218,12288
 T v[154:155],v218,14336
 M v[36:39],v[136:139],a[52:55],v[36:39]
 M v[40:43],v[136:139],a[56:59],v[40:43]
 M v[44:47],v[136:139],a[60:63],v[44:47]
 W 6
 M v[48:51],v[140:143],a[48:51],v[48:51]
 T v[156:157],v219,12288
 T v[158:159],v219,14336
 M v[52:55],v[140:143],a[52:55],v[52:55]
 v_add_u32 v216,65536,v216
 v_add_u32 v217,65536,v217
 M v[56:59],v[140:143],a[56:59],v[56:59]
 v_add_u32 v218,65536,v218
 v_add_u32 v219,65536,v219
 M v[60:63],v[140:143],a[60:63],v[60:63]
 W 6
 s_barrier
 M v[64:67],v[144:147],a[48:51],v[64:67]
 T v[128:129],v216,0
 T v[130:131],v216,2048
 M v[68:71],v[144:147],a[52:55],v[68:71]
 s_add_u32 m0,s72,155648
 s_add_u32 s68,s89,98304
 buffer_load_dwordx4 v220,s[44:47],s68 offen lds
 M v[72:75],v[144:147],a[56:59],v[72:75]
 M v[76:79],v[144:147],a[60:63],v[76:79]
 W 6
 M v[80:83],v[148:151],a[48:51],v[80:83]
 T v[132:133],v217,0
 T v[134:135],v217,2048
 T v[136:137],v218,0
 T v[138:139],v218,2048
 M v[84:87],v[148:151],a[52:55],v[84:87]
 s_add_u32 m0,s72,159744
 s_add_u32 s68,s89,98432
 buffer_load_dwordx4 v220,s[44:47],s68 offen lds
 M v[88:91],v[148:151],a[56:59],v[88:91]
 M v[92:95],v[148:151],a[60:63],v[92:95]
 W 8
 M v[96:99],v[152:155],a[48:51],v[96:99]
 T v[140:141],v219,0
 T v[142:143],v219,2048
 T v[144:145],v216,4096
 T v[146:147],v216,6144
 M v[100:103],v[152:155],a[52:55],v[100:103]
 M v[104:107],v[152:155],a[56:59],v[104:107]
 M v[108:111],v[152:155],a[60:63],v[108:111]
 W 10
 M v[112:115],v[156:159],a[48:51],v[112:115]
 T v[148:149],v217,4096
 T v[150:151],v217,6144
 M v[116:119],v[156:159],a[52:55],v[116:119]
 M v[120:123],v[156:159],a[56:59],v[120:123]
 M v[124:127],v[156:159],a[60:63],v[124:127]
 W 10
 s_waitcnt vmcnt(16)
 M v[0:3],v[128:131],a[128:131],v[0:3]
 T v[152:153],v218,4096
 T v[154:155],v218,6144
 s_waitcnt vmcnt(15)
 M v[4:7],v[128:131],a[132:135],v[4:7]
 W 10
 buffer_load_dword v207,v208,s[8:11],0 offen sc1
 M v[16:19],v[132:135],a[128:131],v[16:19]
 T v[156:157],v219,4096
 T v[158:159],v219,6144
 M v[20:23],v[132:135],a[132:135],v[20:23]
 W 10
 M v[32:35],v[136:139],a[128:131],v[32:35]
 T v[128:129],v216,8192
 T v[130:131],v216,10240
 M v[36:39],v[136:139],a[132:135],v[36:39]
 W 10
 M v[48:51],v[140:143],a[128:131],v[48:51]
 T v[132:133],v217,8192
 T v[134:135],v217,10240
 M v[52:55],v[140:143],a[132:135],v[52:55]
 W 10
 M v[64:67],v[144:147],a[128:131],v[64:67]
 T v[136:137],v218,8192
 T v[138:139],v218,10240
 M v[68:71],v[144:147],a[132:135],v[68:71]
 W 10
 M v[80:83],v[148:151],a[128:131],v[80:83]
 T v[140:141],v219,8192
 T v[142:143],v219,10240
 M v[84:87],v[148:151],a[132:135],v[84:87]
 W 10
 M v[96:99],v[152:155],a[128:131],v[96:99]
 T v[144:145],v216,12288
 T v[146:147],v216,14336
 M v[100:103],v[152:155],a[132:135],v[100:103]
 W 10
 M v[112:115],v[156:159],a[128:131],v[112:115]
 T v[148:149],v217,12288
 T v[150:151],v217,14336
 M v[116:119],v[156:159],a[132:135],v[116:119]
 W 10
 s_waitcnt vmcnt(15)
 M v[0:3],v[128:131],a[136:139],v[0:3]
 T v[152:153],v218,12288
 T v[154:155],v218,14336
 s_waitcnt vmcnt(14)
 M v[4:7],v[128:131],a[140:143],v[4:7]
 W 10
 M v[16:19],v[132:135],a[136:139],v[16:19]
 T v[156:157],v219,12288
 T v[158:159],v219,14336
 M v[20:23],v[132:135],a[140:143],v[20:23]
 W 10
 M v[32:35],v[136:139],a[136:139],v[32:35]
 T v[128:129],v216,16384
 T v[130:131],v216,18432
 M v[36:39],v[136:139],a[140:143],v[36:39]
 W 10
 M v[48:51],v[140:143],a[136:139],v[48:51]
 T v[132:133],v217,16384
 T v[134:135],v217,18432
 M v[52:55],v[140:143],a[140:143],v[52:55]
 W 10
 M v[64:67],v[144:147],a[136:139],v[64:67]
 T v[136:137],v218,16384
 T v[138:139],v218,18432
 M v[68:71],v[144:147],a[140:143],v[68:71]
 W 10
 M v[80:83],v[148:151],a[136:139],v[80:83]
 T v[140:141],v219,16384
 T v[142:143],v219,18432
 M v[84:87],v[148:151],a[140:143],v[84:87]
 W 10
 M v[96:99],v[152:155],a[136:139],v[96:99]
 T v[144:145],v216,20480
 T v[146:147],v216,22528
 M v[100:103],v[152:155],a[140:143],v[100:103]
 W 10
 M v[112:115],v[156:159],a[136:139],v[112:115]
 T v[148:149],v217,20480
 T v[150:151],v217,22528
 M v[116:119],v[156:159],a[140:143],v[116:119]
 W 10
 s_waitcnt vmcnt(6)
 M v[0:3],v[128:131],a[144:147],v[0:3]
 T v[152:153],v218,20480
 T v[154:155],v218,22528
 s_waitcnt vmcnt(5)
 M v[4:7],v[128:131],a[148:151],v[4:7]
 W 10
 M v[16:19],v[132:135],a[144:147],v[16:19]
 T v[156:157],v219,20480
 T v[158:159],v219,22528
 M v[20:23],v[132:135],a[148:151],v[20:23]
 W 10
 M v[32:35],v[136:139],a[144:147],v[32:35]
 T v[128:129],v216,24576
 T v[130:131],v216,26624
 M v[36:39],v[136:139],a[148:151],v[36:39]
 W 10
 M v[48:51],v[140:143],a[144:147],v[48:51]
 T v[132:133],v217,24576
 T v[134:135],v217,26624
 M v[52:55],v[140:143],a[148:151],v[52:55]
 W 10
 M v[64:67],v[144:147],a[144:147],v[64:67]
 T v[136:137],v218,24576
 T v[138:139],v218,26624
 M v[68:71],v[144:147],a[148:151],v[68:71]
 W 10
 M v[80:83],v[148:151],a[144:147],v[80:83]
 T v[140:141],v219,24576
 T v[142:143],v219,26624
 M v[84:87],v[148:151],a[148:151],v[84:87]
 W 10
 M v[96:99],v[152:155],a[144:147],v[96:99]
 T v[144:145],v216,28672
 T v[146:147],v216,30720
 M v[100:103],v[152:155],a[148:151],v[100:103]
 W 10
 M v[112:115],v[156:159],a[144:147],v[112:115]
 T v[148:149],v217,28672
 T v[150:151],v217,30720
 M v[116:119],v[156:159],a[148:151],v[116:119]
 W 10
 s_waitcnt vmcnt(4)
 M v[0:3],v[128:131],a[152:155],v[0:3]
 T v[152:153],v218,28672
 T v[154:155],v218,30720
 s_waitcnt vmcnt(3)
 M v[4:7],v[128:131],a[156:159],v[4:7]
 W 10
 s_add_u32 s63,s62,3
 s_waitcnt vmcnt(0)
 v_subrev_u32 v207,s63,v207
 v_cmp_le_u32 vcc,8,v207
 s_cbranch_vccz PL_ok16
 s_mov_b32 s69,0x100000
PL_sp16:
 s_sleep 2
 buffer_load_dword v207,v208,s[8:11],0 offen sc1
 s_waitcnt vmcnt(0)
 v_subrev_u32 v207,s63,v207
 v_cmp_le_u32 vcc,8,v207
 s_cbranch_vccz PL_ok16
 s_sub_u32 s69,s69,1
 s_cbranch_scc0 PL_sp16
PL_ok16:
 M v[16:19],v[132:135],a[152:155],v[16:19]
 T v[156:157],v219,28672
 T v[158:159],v219,30720
 M v[20:23],v[132:135],a[156:159],v[20:23]
 W 10
 s_add_u32 s81,s96,s84
 buffer_load_dwordx4 a[64:67],v224,s[8:11],s81 offen offset:0 sc1
 M v[32:35],v[136:139],a[152:155],v[32:35]
 T v[128:129],v216,32768
 T v[130:131],v216,34816
 M v[36:39],v[136:139],a[156:159],v[36:39]
 W 10
 M v[48:51],v[140:143],a[152:155],v[48:51]
 T v[132:133],v217,32768
 T v[134:135],v217,34816
 M v[52:55],v[140:143],a[156:159],v[52:55]
 W 10
 buffer_load_dwordx4 a[68:71],v221,s[8:11],s81 offen offset:0 sc1
 M v[64:67],v[144:147],a[152:155],v[64:67]
 T v[136:137],v218,32768
 T v[138:139],v218,34816
 M v[68:71],v[144:147],a[156:159],v[68:71]
 W 10
 M v[80:83],v[148:151],a[152:155],v[80:83]
 T v[140:141],v219,32768
 T v[142:143],v219,34816
 M v[84:87],v[148:151],a[156:159],v[84:87]
 W 10
 buffer_load_dwordx4 a[72:75],v224,s[8:11],s81 offen offset:1024 sc1
 M v[96:99],v[152:155],a[152:155],v[96:99]
 T v[144:145],v216,36864
 T v[146:147],v216,38912
 M v[100:103],v[152:155],a[156:159],v[100:103]
 W 10
 M v[112:115],v[156:159],a[152:155],v[112:115]
 T v[148:149],v217,36864
 T v[150:151],v217,38912
 M v[116:119],v[156:159],a[156:159],v[116:119]
 W 10
 buffer_load_dwordx4 a[76:79],v221,s[8:11],s81 offen offset:1024 sc1
 M v[0:3],v[128:131],a[160:163],v[0:3]
 T v[152:153],v218,36864
 T v[154:155],v218,38912
 M v[4:7],v[128:131],a[164:167],v[4:7]
 W 10
 M v[16:19],v[132:135],a[160:163],v[16:19]
 T v[156:157],v219,36864
 T v[158:159],v219,38912
 M v[20:23],v[132:135],a[164:167],v[20:23]
 W 10
 buffer_load_dwordx4 a[80:83],v224,s[8:11],s81 offen offset:2048 sc1
 M v[32:35],v[136:139],a[160:163],v[32:35]
 T v[128:129],v216,40960
 T v[130:131],v216,43008
 M v[36:39],v[136:139],a[164:167],v[36:39]
 W 10
 M v[48:51],v[140:143],a[160:163],v[48:51]
 T v[132:133],v217,40960
 T v[134:135],v217,43008
 M v[52:55],v[140:143],a[164:167],v[52:55]
 W 10
 buffer_load_dwordx4 a[84:87],v221,s[8:11],s81 offen offset:2048 sc1
 M v[64:67],v[144:147],a[160:163],v[64:67]
 T v[136:137],v218,40960
 T v[138:139],v218,43008
 M v[68:71],v[144:147],a[164:167],v[68:71]
 W 10
 M v[80:83],v[148:151],a[160:163],v[80:83]
 T v[140:141],v219,40960
 T v[142:143],v219,43008
 M v[84:87],v[148:151],a[164:167],v[84:87]
 W 10
 buffer_load_dwordx4 a[88:91],v224,s[8:11],s81 offen offset:3072 sc1
 M v[96:99],v[152:155],a[160:163],v[96:99]
 T v[144:145],v216,45056
 T v[146:147],v216,47104
 M v[100:103],v[152:155],a[164:167],v[100:103]
 W 10
 M v[112:115],v[156:159],a[160:163],v[112:115]
 T v[148:149],v217,45056
 T v[150:151],v217,47104
 M v[116:119],v[156:159],a[164:167],v[116:119]
 W 10
 buffer_load_dwordx4 a[92:95],v221,s[8:11],s81 offen offset:3072 sc1
 M v[0:3],v[128:131],a[168:171],v[0:3]
 T v[152:153],v218,45056
 T v[154:155],v218,47104
 M v[4:7],v[128:131],a[172:175],v[4:7]
 W 10
 M v[16:19],v[132:135],a[168:171],v[16:19]
 T v[156:157],v219,45056
 T v[158:159],v219,47104
 M v[20:23],v[132:135],a[172:175],v[20:23]
 W 10
 s_barrier
 s_add_u32 s81,s96,s85
 buffer_load_dwordx4 a[96:99],v224,s[8:11],s81 offen offset:0 sc1
 M v[32:35],v[136:139],a[168:171],v[32:35]
 T v[128:129],v216,49152
 T v[130:131],v216,51200
 M v[36:39],v[136:139],a[172:175],v[36:39]
 W 10
 M v[48:51],v[140:143],a[168:171],v[48:51]
 T v[132:133],v217,49152
 T v[134:135],v217,51200
 M v[52:55],v[140:143],a[172:175],v[52:55]
 W 10
 buffer_load_dwordx4 a[100:103],v221,s[8:11],s81 offen offset:0 sc1
 M v[64:67],v[144:147],a[168:171],v[64:67]
 T v[136:137],v218,49152
 T v[138:139],v218,51200
 M v[68:71],v[144:147],a[172:175],v[68:71]
 W 10
 M v[80:83],v[148:151],a[168:171],v[80:83]
 T v[140:141],v219,49152
 T v[142:143],v219,51200
 M v[84:87],v[148:151],a[172:175],v[84:87]
 W 10
 buffer_load_dwordx4 a[104:107],v224,s[8:11],s81 offen offset:1024 sc1
 M v[96:99],v[152:155],a[168:171],v[96:99]
 T v[144:145],v216,53248
 T v[146:147],v216,55296
 M v[100:103],v[152:155],a[172:175],v[100:103]
 W 10
 M v[112:115],v[156:159],a[168:171],v[112:115]
 T v[148:149],v217,53248
 T v[150:151],v217,55296
 M v[116:119],v[156:159],a[172:175],v[116:119]
 W 10
 buffer_load_dwordx4 a[108:111],v221,s[8:11],s81 offen offset:1024 sc1
 M v[0:3],v[128:131],a[176:179],v[0:3]
 T v[152:153],v218,53248
 T v[154:155],v218,55296
 M v[4:7],v[128:131],a[180:183],v[4:7]
 W 10
 M v[16:19],v[132:135],a[176:179],v[16:19]
 T v[156:157],v219,53248
 T v[158:159],v219,55296
 M v[20:23],v[132:135],a[180:183],v[20:23]
 W 10
 buffer_load_dwordx4 a[112:115],v224,s[8:11],s81 offen offset:2048 sc1
 M v[32:35],v[136:139],a[176:179],v[32:35]
 T v[128:129],v216,57344
 T v[130:131],v216,59392
 M v[36:39],v[136:139],a[180:183],v[36:39]
 W 10
 M v[48:51],v[140:143],a[176:179],v[48:51]
 T v[132:133],v217,57344
 T v[134:135],v217,59392
 M v[52:55],v[140:143],a[180:183],v[52:55]
 W 10
 buffer_load_dwordx4 a[116:119],v221,s[8:11],s81 offen offset:2048 sc1
 M v[64:67],v[144:147],a[176:179],v[64:67]
 T v[136:137],v218,57344
 T v[138:139],v218,59392
 M v[68:71],v[144:147],a[180:183],v[68:71]
 W 10
 M v[80:83],v[148:151],a[176:179],v[80:83]
 T v[140:141],v219,57344
 T v[142:143],v219,59392
 M v[84:87],v[148:151],a[180:183],v[84:87]
 W 10
 buffer_load_dwordx4 a[120:123],v224,s[8:11],s81 offen offset:3072 sc1
 M v[96:99],v[152:155],a[176:179],v[96:99]
 T v[144:145],v216,61440
 T v[146:147],v216,63488
 M v[100:103],v[152:155],a[180:183],v[100:103]
 W 10
 M v[112:115],v[156:159],a[176:179],v[112:115]
 T v[148:149],v217,61440
 T v[150:151],v217,63488
 M v[116:119],v[156:159],a[180:183],v[116:119]
 W 10
 buffer_load_dwordx4 a[124:127],v221,s[8:11],s81 offen offset:3072 sc1
 M v[0:3],v[128:131],a[184:187],v[0:3]
 T v[152:153],v218,61440
 T v[154:155],v218,63488
 M v[4:7],v[128:131],a[188:191],v[4:7]
 W 10
 M v[16:19],v[132:135],a[184:187],v[16:19]
 T v[156:157],v219,61440
 T v[158:159],v219,63488
 M v[20:23],v[132:135],a[188:191],v[20:23]
 W 10
 s_add_u32 s81,s96,s86
 buffer_load_dwordx4 a[224:227],v224,s[8:11],s81 offen offset:0 sc1
 M v[32:35],v[136:139],a[184:187],v[32:35]
 T v[128:129],v212,0
 T v[130:131],v212,2048
 M v[36:39],v[136:139],a[188:191],v[36:39]
 W 10
 M v[48:51],v[140:143],a[184:187],v[48:51]
 T v[132:133],v213,0
 T v[134:135],v213,2048
 M v[52:55],v[140:143],a[188:191],v[52:55]
 W 10
 buffer_load_dwordx4 a[228:231],v221,s[8:11],s81 offen offset:0 sc1
 M v[64:67],v[144:147],a[184:187],v[64:67]
 T v[136:137],v214,0
 T v[138:139],v214,2048
 M v[68:71],v[144:147],a[188:191],v[68:71]
 W 10
 M v[80:83],v[148:151],a[184:187],v[80:83]
 T v[140:141],v215,0
 T v[142:143],v215,2048
 M v[84:87],v[148:151],a[188:191],v[84:87]
 W 10
 buffer_load_dwordx4 a[232:235],v224,s[8:11],s81 offen offset:1024 sc1
 M v[96:99],v[152:155],a[184:187],v[96:99]
 T v[144:145],v212,4096
 T v[146:147],v212,6144
 M v[100:103],v[152:155],a[188:191],v[100:103]
 W 10
 M v[112:115],v[156:159],a[184:187],v[112:115]
 T v[148:149],v213,4096
 T v[150:151],v213,6144
 M v[116:119],v[156:159],a[188:191],v[116:119]
 W 10
 buffer_load_dwordx4 a[236:239],v221,s[8:11],s81 offen offset:1024 sc1
 M v[0:3],v[128:131],a[192:195],v[0:3]
 T v[152:153],v214,4096
 T v[154:155],v214,6144
 M v[4:7],v[128:131],a[196:199],v[4:7]
 W 10
 M v[16:19],v[132:135],a[192:195],v[16:19]
 T v[156:157],v215,4096
 T v[158:159],v215,6144
 M v[20:23],v[132:135],a[196:199],v[20:23]
 W 10
 buffer_load_dwordx4 a[240:243],v224,s[8:11],s81 offen offset:2048 sc1
 M v[32:35],v[136:139],a[192:195],v[32:35]
 T v[128:129],v212,8192
 T v[130:131],v212,10240
 M v[36:39],v[136:139],a[196:199],v[36:39]
 W 10
 M v[48:51],v[140:143],a[192:195],v[48:51]
 T v[132:133],v213,8192
 T v[134:135],v213,10240
 M v[52:55],v[140:143],a[196:199],v[52:55]
 W 10
 buffer_load_dwordx4 a[244:247],v221,s[8:11],s81 offen offset:2048 sc1
 M v[64:67],v[144:147],a[192:195],v[64:67]
 T v[136:137],v214,8192
 T v[138:139],v214,10240
 M v[68:71],v[144:147],a[196:199],v[68:71]
 W 10
 M v[80:83],v[148:151],a[192:195],v[80:83]
 T v[140:141],v215,8192
 T v[142:143],v215,10240
 M v[84:87],v[148:151],a[196:199],v[84:87]
 W 10
 buffer_load_dwordx4 a[248:251],v224,s[8:11],s81 offen offset:3072 sc1
 M v[96:99],v[152:155],a[192:195],v[96:99]
 T v[144:145],v212,12288
 T v[146:147],v212,14336
 M v[100:103],v[152:155],a[196:199],v[100:103]
 W 10
 v_bfe_u32 v222,v224,4,5
 M v[112:115],v[156:159],a[192:195],v[112:115]
 T v[148:149],v213,12288
 T v[150:151],v213,14336
 M v[116:119],v[156:159],a[196:199],v[116:119]
 W 10
 v_lshlrev_b32 v222,10,v222
 buffer_load_dwordx4 a[252:255],v221,s[8:11],s81 offen offset:3072 sc1
 M v[0:3],v[128:131],a[200:203],v[0:3]
 T v[152:153],v214,12288
 T v[154:155],v214,14336
 M v[4:7],v[128:131],a[204:207],v[4:7]
 W 10
 v_lshrrev_b32 v223,9,v224
 M v[16:19],v[132:135],a[200:203],v[16:19]
 T v[156:157],v215,12288
 T v[158:159],v215,14336
 M v[20:23],v[132:135],a[204:207],v[20:23]
 W 10
 v_lshlrev_b32 v223,4,v223
 M v[32:35],v[136:139],a[200:203],v[32:35]
 T v[128:129],v212,16384
 T v[130:131],v212,18432
 M v[36:39],v[136:139],a[204:207],v[36:39]
 W 10
 v_add_u32 v222,v222,v223
 M v[48:51],v[140:143],a[200:203],v[48:51]
 T v[132:133],v213,16384
 T v[134:135],v213,18432
 M v[52:55],v[140:143],a[204:207],v[52:55]
 W 10
 M v[64:67],v[144:147],a[200:203],v[64:67]
 T v[136:137],v214,16384
 T v[138:139],v214,18432
 M v[68:71],v[144:147],a[204:207],v[68:71]
 W 10
 s_lshr_b32 s68,s65,1
 s_lshl_b32 s68,s68,5
 s_sub_u32 s69,15,s66
 s_bitcmp1_b32 s65,0
 s_cselect_b32 s69,s69,s66
 s_lshl_b32 s69,s69,7
 s_add_u32 s68,s68,s69
 s_lshl_b32 s74,s68,10
 s_lshl_b32 s75,s67,8
 s_lshl_b32 s68,s64,6
 s_add_u32 s75,s75,s68
 s_add_u32 s74,s74,s75
 buffer_load_dwordx4 v[226:229],v222,s[12:15],s74 offen offset:0
 M v[80:83],v[148:151],a[200:203],v[80:83]
 T v[140:141],v215,16384
 T v[142:143],v215,18432
 M v[84:87],v[148:151],a[204:207],v[84:87]
 W 10
 M v[96:99],v[152:155],a[200:203],v[96:99]
 T v[144:145],v212,20480
 T v[146:147],v212,22528
 M v[100:103],v[152:155],a[204:207],v[100:103]
 W 10
 buffer_load_dwordx4 v[234:237],v222,s[12:15],s74 offen offset:32
 M v[112:115],v[156:159],a[200:203],v[112:115]
 T v[148:149],v213,20480
 T v[150:151],v213,22528
 M v[116:119],v[156:159],a[204:207],v[116:119]
 W 10
 M v[0:3],v[128:131],a[208:211],v[0:3]
 T v[152:153],v214,20480
 T v[154:155],v214,22528
 M v[4:7],v[128:131],a[212:215],v[4:7]
 W 10
 buffer_load_dwordx4 v[230:233],v223,s[52:55],s75 offen offset:0
 M v[16:19],v[132:135],a[208:211],v[16:19]
 T v[156:157],v215,20480
 T v[158:159],v215,22528
 M v[20:23],v[132:135],a[212:215],v[20:23]
 W 10
 M v[32:35],v[136:139],a[208:211],v[32:35]
 T v[128:129],v212,24576
 T v[130:131],v212,26624
 M v[36:39],v[136:139],a[212:215],v[36:39]
 W 10
 buffer_load_dwordx4 v[238:241],v223,s[52:55],s75 offen offset:32
 M v[48:51],v[140:143],a[208:211],v[48:51]
 T v[132:133],v213,24576
 T v[134:135],v213,26624
 M v[52:55],v[140:143],a[212:215],v[52:55]
 W 10
 M v[64:67],v[144:147],a[208:211],v[64:67]
 T v[136:137],v214,24576
 T v[138:139],v214,26624
 M v[68:71],v[144:147],a[212:215],v[68:71]
 W 10
 M v[80:83],v[148:151],a[208:211],v[80:83]
 T v[140:141],v215,24576
 T v[142:143],v215,26624
 M v[84:87],v[148:151],a[212:215],v[84:87]
 W 10
 M v[96:99],v[152:155],a[208:211],v[96:99]
 T v[144:145],v212,28672
 T v[146:147],v212,30720
 M v[100:103],v[152:155],a[212:215],v[100:103]
 W 10
 M v[112:115],v[156:159],a[208:211],v[112:115]
 T v[148:149],v213,28672
 T v[150:151],v213,30720
 M v[116:119],v[156:159],a[212:215],v[116:119]
 W 10
 M v[0:3],v[128:131],a[216:219],v[0:3]
 T v[152:153],v214,28672
 T v[154:155],v214,30720
 M v[4:7],v[128:131],a[220:223],v[4:7]
 W 10
 M v[16:19],v[132:135],a[216:219],v[16:19]
 T v[156:157],v215,28672
 T v[158:159],v215,30720
 M v[20:23],v[132:135],a[220:223],v[20:23]
 W 10
 M v[32:35],v[136:139],a[216:219],v[32:35]
 T v[128:129],v216,0
 T v[130:131],v216,2048
 M v[36:39],v[136:139],a[220:223],v[36:39]
 W 10
 M v[48:51],v[140:143],a[216:219],v[48:51]
 T v[132:133],v216,8192
 T v[134:135],v216,10240
 M v[52:55],v[140:143],a[220:223],v[52:55]
 W 10
 M v[64:67],v[144:147],a[216:219],v[64:67]
 T v[136:137],v216,16384
 T v[138:139],v216,18432
 M v[68:71],v[144:147],a[220:223],v[68:71]
 W 10
 M v[80:83],v[148:151],a[216:219],v[80:83]
 T v[140:141],v216,24576
 T v[142:143],v216,26624
 M v[84:87],v[148:151],a[220:223],v[84:87]
 W 10
 M v[96:99],v[152:155],a[216:219],v[96:99]
 T v[144:145],v216,32768
 T v[146:147],v216,34816
 M v[100:103],v[152:155],a[220:223],v[100:103]
 W 10
 M v[112:115],v[156:159],a[216:219],v[112:115]
 T v[148:149],v216,40960
 T v[150:151],v216,43008
 M v[116:119],v[156:159],a[220:223],v[116:119]
 W 10
 s_waitcnt vmcnt(27)
 M v[8:11],v[128:131],a[64:67],v[8:11]
 T v[152:153],v216,49152
 T v[154:155],v216,51200
 s_waitcnt vmcnt(26)
 M v[12:15],v[128:131],a[68:71],v[12:15]
 W 10
 s_waitcnt vmcnt(25)
 M v[8:11],v[132:135],a[72:75],v[8:11]
 T v[156:157],v216,57344
 T v[158:159],v216,59392
 s_waitcnt vmcnt(24)
 M v[12:15],v[132:135],a[76:79],v[12:15]
 W 10
 v_cvt_pk_bf16_f32 v160,v0,v1
 v_cvt_pk_bf16_f32 v162,v4,v5
 s_waitcnt vmcnt(23)
 M v[8:11],v[136:139],a[80:83],v[8:11]
 T v[128:129],v212,0
 T v[130:131],v212,2048
 s_waitcnt vmcnt(22)
 M v[12:15],v[136:139],a[84:87],v[12:15]
 W 10
 v_cvt_pk_bf16_f32 v161,v2,v3
 v_cvt_pk_bf16_f32 v163,v6,v7
 s_waitcnt vmcnt(21)
 M v[8:11],v[140:143],a[88:91],v[8:11]
 T v[132:133],v212,8192
 T v[134:135],v212,10240
 s_waitcnt vmcnt(20)
 M v[12:15],v[140:143],a[92:95],v[12:15]
 W 10
 s_add_u32 s70,s80,0
 s_waitcnt vmcnt(19)
 M v[8:11],v[144:147],a[96:99],v[8:11]
 T v[136:137],v212,16384
 T v[138:139],v212,18432
 s_waitcnt vmcnt(18)
 M v[12:15],v[144:147],a[100:103],v[12:15]
 W 10
 v_permlane16_swap_b32 v160,v162
 s_waitcnt vmcnt(17)
 M v[8:11],v[148:151],a[104:107],v[8:11]
 T v[140:141],v212,24576
 T v[142:143],v212,26624
 s_waitcnt vmcnt(16)
 M v[12:15],v[148:151],a[108:111],v[12:15]
 W 10
 v_permlane16_swap_b32 v161,v163
 s_waitcnt vmcnt(15)
 M v[8:11],v[152:155],a[112:115],v[8:11]
 T v[144:145],v217,0
 T v[146:147],v217,2048
 s_waitcnt vmcnt(14)
 M v[12:15],v[152:155],a[116:119],v[12:15]
 W 10
 buffer_store_dwordx4 v[160:163],v224,s[8:11],s70 offen offset:0 sc0 sc1
 v_cvt_pk_bf16_f32 v164,v16,v17
 s_waitcnt vmcnt(14)
 M v[8:11],v[156:159],a[120:123],v[8:11]
 T v[148:149],v217,8192
 T v[150:151],v217,10240
 s_waitcnt vmcnt(13)
 M v[12:15],v[156:159],a[124:127],v[12:15]
 W 10
 v_cvt_pk_bf16_f32 v166,v20,v21
 v_cvt_pk_bf16_f32 v165,v18,v19
 s_waitcnt vmcnt(12)
 M v[8:11],v[128:131],a[224:227],v[8:11]
 T v[152:153],v217,16384
 T v[154:155],v217,18432
 s_waitcnt vmcnt(11)
 M v[12:15],v[128:131],a[228:231],v[12:15]
 W 10
 v_cvt_pk_bf16_f32 v167,v22,v23
 s_add_u32 s70,s80,0
 s_waitcnt vmcnt(10)
 M v[8:11],v[132:135],a[232:235],v[8:11]
 T v[156:157],v217,24576
 T v[158:159],v217,26624
 s_waitcnt vmcnt(9)
 M v[12:15],v[132:135],a[236:239],v[12:15]
 W 10
 v_permlane16_swap_b32 v164,v166
 s_waitcnt vmcnt(8)
 M v[8:11],v[136:139],a[240:243],v[8:11]
 T v[128:129],v217,32768
 T v[130:131],v217,34816
 s_waitcnt vmcnt(7)
 M v[12:15],v[136:139],a[244:247],v[12:15]
 W 10
 v_permlane16_swap_b32 v165,v167
 s_waitcnt vmcnt(6)
 M v[8:11],v[140:143],a[248:251],v[8:11]
 T v[132:133],v217,40960
 T v[134:135],v217,43008
 s_waitcnt vmcnt(5)
 M v[12:15],v[140:143],a[252:255],v[12:15]
 W 10
 buffer_store_dwordx4 v[164:167],v224,s[8:11],s70 offen offset:1024 sc0 sc1
 v_cvt_pk_bf16_f32 v168,v32,v33
 M v[24:27],v[144:147],a[64:67],v[24:27]
 T v[136:137],v217,49152
 T v[138:139],v217,51200
 M v[28:31],v[144:147],a[68:71],v[28:31]
 W 10
 v_cvt_pk_bf16_f32 v170,v36,v37
 v_cvt_pk_bf16_f32 v169,v34,v35
 M v[24:27],v[148:151],a[72:75],v[24:27]
 T v[140:141],v217,57344
 T v[142:143],v217,59392
 M v[28:31],v[148:151],a[76:79],v[28:31]
 W 10
 v_cvt_pk_bf16_f32 v171,v38,v39
 s_add_u32 s70,s80,0
 M v[24:27],v[152:155],a[80:83],v[24:27]
 T v[144:145],v213,0
 T v[146:147],v213,2048
 M v[28:31],v[152:155],a[84:87],v[28:31]
 W 10
 v_permlane16_swap_b32 v168,v170
 M v[24:27],v[156:159],a[88:91],v[24:27]
 T v[148:149],v213,8192
 T v[150:151],v213,10240
 M v[28:31],v[156:159],a[92:95],v[28:31]
 W 10
 v_permlane16_swap_b32 v169,v171
 M v[24:27],v[128:131],a[96:99],v[24:27]
 T v[152:153],v213,16384
 T v[154:155],v213,18432
 M v[28:31],v[128:131],a[100:103],v[28:31]
 W 10
 buffer_store_dwordx4 v[168:171],v224,s[8:11],s70 offen offset:2048 sc0 sc1
 v_cvt_pk_bf16_f32 v172,v8,v9
 M v[24:27],v[132:135],a[104:107],v[24:27]
 T v[156:157],v213,24576
 T v[158:159],v213,26624
 M v[28:31],v[132:135],a[108:111],v[28:31]
 W 10
 v_cvt_pk_bf16_f32 v174,v12,v13
 v_cvt_pk_bf16_f32 v173,v10,v11
 M v[24:27],v[136:139],a[112:115],v[24:27]
 T v[128:129],v218,0
 T v[130:131],v218,2048
 M v[28:31],v[136:139],a[116:119],v[28:31]
 W 10
 v_cvt_pk_bf16_f32 v175,v14,v15
 s_add_u32 s70,s80,9216
 M v[24:27],v[140:143],a[120:123],v[24:27]
 T v[132:133],v218,8192
 T v[134:135],v218,10240
 M v[28:31],v[140:143],a[124:127],v[28:31]
 W 10
 v_permlane16_swap_b32 v172,v174
 M v[24:27],v[144:147],a[224:227],v[24:27]
 T v[136:137],v218,16384
 T v[138:139],v218,18432
 M v[28:31],v[144:147],a[228:231],v[28:31]
 W 10
 v_permlane16_swap_b32 v173,v175
 M v[24:27],v[148:151],a[232:235],v[24:27]
 T v[140:141],v218,24576
 T v[142:143],v218,26624
 M v[28:31],v[148:151],a[236:239],v[28:31]
 W 10
 buffer_store_dwordx4 v[172:175],v224,s[8:11],s70 offen offset:0 sc0 sc1
 v_cvt_pk_bf16_f32 v176,v48,v49
 M v[24:27],v[152:155],a[240:243],v[24:27]
 T v[144:145],v218,32768
 T v[146:147],v218,34816
 M v[28:31],v[152:155],a[244:247],v[28:31]
 W 10
 v_cvt_pk_bf16_f32 v178,v52,v53
 v_cvt_pk_bf16_f32 v177,v50,v51
 M v[24:27],v[156:159],a[248:251],v[24:27]
 T v[148:149],v218,40960
 T v[150:151],v218,43008
 M v[28:31],v[156:159],a[252:255],v[28:31]
 W 10
 v_cvt_pk_bf16_f32 v179,v54,v55
 s_add_u32 s70,s80,0
 M v[40:43],v[128:131],a[64:67],v[40:43]
 T v[152:153],v218,49152
 T v[154:155],v218,51200
 M v[44:47],v[128:131],a[68:71],v[44:47]
 W 10
 v_permlane16_swap_b32 v176,v178
 M v[40:43],v[132:135],a[72:75],v[40:43]
 T v[156:157],v218,57344
 T v[158:159],v218,59392
 M v[44:47],v[132:135],a[76:79],v[44:47]
 W 10
 v_permlane16_swap_b32 v177,v179
 M v[40:43],v[136:139],a[80:83],v[40:43]
 T v[128:129],v214,0
 T v[130:131],v214,2048
 M v[44:47],v[136:139],a[84:87],v[44:47]
 W 10
 buffer_store_dwordx4 v[176:179],v224,s[8:11],s70 offen offset:3072 sc0 sc1
 v_cvt_pk_bf16_f32 v180,v64,v65
 M v[40:43],v[140:143],a[88:91],v[40:43]
 T v[132:133],v214,8192
 T v[134:135],v214,10240
 M v[44:47],v[140:143],a[92:95],v[44:47]
 W 10
 v_cvt_pk_bf16_f32 v182,v68,v69
 v_cvt_pk_bf16_f32 v181,v66,v67
 M v[40:43],v[144:147],a[96:99],v[40:43]
 T v[136:137],v214,16384
 T v[138:139],v214,18432
 M v[44:47],v[144:147],a[100:103],v[44:47]
 W 10
 v_cvt_pk_bf16_f32 v183,v70,v71
 s_add_u32 s70,s80,4096
 M v[40:43],v[148:151],a[104:107],v[40:43]
 T v[140:141],v214,24576
 T v[142:143],v214,26624
 M v[44:47],v[148:151],a[108:111],v[44:47]
 W 10
 v_permlane16_swap_b32 v180,v182
 M v[40:43],v[152:155],a[112:115],v[40:43]
 T v[144:145],v219,0
 T v[146:147],v219,2048
 M v[44:47],v[152:155],a[116:119],v[44:47]
 W 10
 v_permlane16_swap_b32 v181,v183
 M v[40:43],v[156:159],a[120:123],v[40:43]
 T v[148:149],v219,8192
 T v[150:151],v219,10240
 M v[44:47],v[156:159],a[124:127],v[44:47]
 W 10
 buffer_store_dwordx4 v[180:183],v224,s[8:11],s70 offen offset:0 sc0 sc1
 v_cvt_pk_bf16_f32 v184,v24,v25
 M v[40:43],v[128:131],a[224:227],v[40:43]
 T v[152:153],v219,16384
 T v[154:155],v219,18432
 M v[44:47],v[128:131],a[228:231],v[44:47]
 W 10
 v_cvt_pk_bf16_f32 v186,v28,v29
 v_cvt_pk_bf16_f32 v185,v26,v27
 M v[40:43],v[132:135],a[232:235],v[40:43]
 T v[156:157],v219,24576
 T v[158:159],v219,26624
 M v[44:47],v[132:135],a[236:239],v[44:47]
 W 10
 v_cvt_pk_bf16_f32 v187,v30,v31
 s_add_u32 s70,s80,9216
 M v[40:43],v[136:139],a[240:243],v[40:43]
 T v[128:129],v219,32768
 T v[130:131],v219,34816
 M v[44:47],v[136:139],a[244:247],v[44:47]
 W 10
 v_permlane16_swap_b32 v184,v186
 M v[40:43],v[140:143],a[248:251],v[40:43]
 T v[132:133],v219,40960
 T v[134:135],v219,43008
 M v[44:47],v[140:143],a[252:255],v[44:47]
 W 10
 v_permlane16_swap_b32 v185,v187
 M v[56:59],v[144:147],a[64:67],v[56:59]
 T v[136:137],v219,49152
 T v[138:139],v219,51200
 M v[60:63],v[144:147],a[68:71],v[60:63]
 W 10
 buffer_store_dwordx4 v[184:187],v224,s[8:11],s70 offen offset:1024 sc0 sc1
 v_cvt_pk_bf16_f32 v188,v80,v81
 M v[56:59],v[148:151],a[72:75],v[56:59]
 T v[140:141],v219,57344
 T v[142:143],v219,59392
 M v[60:63],v[148:151],a[76:79],v[60:63]
 W 10
 v_cvt_pk_bf16_f32 v190,v84,v85
 v_cvt_pk_bf16_f32 v189,v82,v83
 M v[56:59],v[152:155],a[80:83],v[56:59]
 T v[144:145],v215,0
 T v[146:147],v215,2048
 M v[60:63],v[152:155],a[84:87],v[60:63]
 W 10
 v_cvt_pk_bf16_f32 v191,v86,v87
 s_add_u32 s70,s80,4096
 M v[56:59],v[156:159],a[88:91],v[56:59]
 T v[148:149],v215,8192
 T v[150:151],v215,10240
 M v[60:63],v[156:159],a[92:95],v[60:63]
 W 10
 v_permlane16_swap_b32 v188,v190
 M v[56:59],v[128:131],a[96:99],v[56:59]
 T v[152:153],v215,16384
 T v[154:155],v215,18432
 M v[60:63],v[128:131],a[100:103],v[60:63]
 W 10
 v_permlane16_swap_b32 v189,v191
 M v[56:59],v[132:135],a[104:107],v[56:59]
 T v[156:157],v215,24576
 T v[158:159],v215,26624
 M v[60:63],v[132:135],a[108:111],v[60:63]
 W 10
 buffer_store_dwordx4 v[188:191],v224,s[8:11],s70 offen offset:1024 sc0 sc1
 v_cvt_pk_bf16_f32 v160,v96,v97
 M v[56:59],v[136:139],a[112:115],v[56:59]
 T v[128:129],v216,4096
 T v[130:131],v216,6144
 M v[60:63],v[136:139],a[116:119],v[60:63]
 W 10
 v_cvt_pk_bf16_f32 v162,v100,v101
 v_cvt_pk_bf16_f32 v161,v98,v99
 M v[56:59],v[140:143],a[120:123],v[56:59]
 T v[132:133],v216,12288
 T v[134:135],v216,14336
 M v[60:63],v[140:143],a[124:127],v[60:63]
 W 10
 v_cvt_pk_bf16_f32 v163,v102,v103
 s_add_u32 s70,s80,4096
 M v[56:59],v[144:147],a[224:227],v[56:59]
 T v[136:137],v216,20480
 T v[138:139],v216,22528
 M v[60:63],v[144:147],a[228:231],v[60:63]
 W 10
 v_permlane16_swap_b32 v160,v162
 M v[56:59],v[148:151],a[232:235],v[56:59]
 T v[140:141],v216,28672
 T v[142:143],v216,30720
 M v[60:63],v[148:151],a[236:239],v[60:63]
 W 10
 v_permlane16_swap_b32 v161,v163
 M v[56:59],v[152:155],a[240:243],v[56:59]
 T v[144:145],v216,36864
 T v[146:147],v216,38912
 M v[60:63],v[152:155],a[244:247],v[60:63]
 W 10
 buffer_store_dwordx4 v[160:163],v224,s[8:11],s70 offen offset:2048 sc0 sc1
 v_cvt_pk_bf16_f32 v164,v40,v41
 M v[56:59],v[156:159],a[248:251],v[56:59]
 T v[148:149],v216,45056
 T v[150:151],v216,47104
 M v[60:63],v[156:159],a[252:255],v[60:63]
 W 10
 v_cvt_pk_bf16_f32 v166,v44,v45
 v_cvt_pk_bf16_f32 v165,v42,v43
 M v[72:75],v[128:131],a[64:67],v[72:75]
 T v[152:153],v216,53248
 T v[154:155],v216,55296
 M v[76:79],v[128:131],a[68:71],v[76:79]
 W 10
 v_cvt_pk_bf16_f32 v167,v46,v47
 s_add_u32 s70,s80,9216
 M v[72:75],v[132:135],a[72:75],v[72:75]
 T v[156:157],v216,61440
 T v[158:159],v216,63488
 M v[76:79],v[132:135],a[76:79],v[76:79]
 W 10
 v_permlane16_swap_b32 v164,v166
 M v[72:75],v[136:139],a[80:83],v[72:75]
 T v[128:129],v212,4096
 T v[130:131],v212,6144
 M v[76:79],v[136:139],a[84:87],v[76:79]
 W 10
 v_permlane16_swap_b32 v165,v167
 M v[72:75],v[140:143],a[88:91],v[72:75]
 T v[132:133],v212,12288
 T v[134:135],v212,14336
 M v[76:79],v[140:143],a[92:95],v[76:79]
 W 10
 buffer_store_dwordx4 v[164:167],v224,s[8:11],s70 offen offset:2048 sc0 sc1
 v_cvt_pk_bf16_f32 v168,v112,v113
 M v[72:75],v[144:147],a[96:99],v[72:75]
 T v[136:137],v212,20480
 T v[138:139],v212,22528
 M v[76:79],v[144:147],a[100:103],v[76:79]
 W 10
 v_cvt_pk_bf16_f32 v170,v116,v117
 v_cvt_pk_bf16_f32 v169,v114,v115
 M v[72:75],v[148:151],a[104:107],v[72:75]
 T v[140:141],v212,28672
 T v[142:143],v212,30720
 M v[76:79],v[148:151],a[108:111],v[76:79]
 W 10
 v_cvt_pk_bf16_f32 v171,v118,v119
 s_add_u32 s70,s80,4096
 M v[72:75],v[152:155],a[112:115],v[72:75]
 T v[144:145],v217,4096
 T v[146:147],v217,6144
 M v[76:79],v[152:155],a[116:119],v[76:79]
 W 10
 v_permlane16_swap_b32 v168,v170
 M v[72:75],v[156:159],a[120:123],v[72:75]
 T v[148:149],v217,12288
 T v[150:151],v217,14336
 M v[76:79],v[156:159],a[124:127],v[76:79]
 W 10
 v_permlane16_swap_b32 v169,v171
 M v[72:75],v[128:131],a[224:227],v[72:75]
 T v[152:153],v217,20480
 T v[154:155],v217,22528
 M v[76:79],v[128:131],a[228:231],v[76:79]
 W 10
 buffer_store_dwordx4 v[168:171],v224,s[8:11],s70 offen offset:3072 sc0 sc1
 v_cvt_pk_bf16_f32 v172,v56,v57
 M v[72:75],v[132:135],a[232:235],v[72:75]
 T v[156:157],v217,28672
 T v[158:159],v217,30720
 M v[76:79],v[132:135],a[236:239],v[76:79]
 W 10
 v_cvt_pk_bf16_f32 v174,v60,v61
 v_cvt_pk_bf16_f32 v173,v58,v59
 M v[72:75],v[136:139],a[240:243],v[72:75]
 T v[128:129],v217,36864
 T v[130:131],v217,38912
 M v[76:79],v[136:139],a[244:247],v[76:79]
 W 10
 v_cvt_pk_bf16_f32 v175,v62,v63
 s_add_u32 s70,s80,9216
 M v[72:75],v[140:143],a[248:251],v[72:75]
 T v[132:133],v217,45056
 T v[134:135],v217,47104
 M v[76:79],v[140:143],a[252:255],v[76:79]
 W 10
 v_permlane16_swap_b32 v172,v174
 M v[88:91],v[144:147],a[64:67],v[88:91]
 T v[136:137],v217,53248
 T v[138:139],v217,55296
 M v[92:95],v[144:147],a[68:71],v[92:95]
 W 10
 v_permlane16_swap_b32 v173,v175
 M v[88:91],v[148:151],a[72:75],v[88:91]
 T v[140:141],v217,61440
 T v[142:143],v217,63488
 M v[92:95],v[148:151],a[76:79],v[92:95]
 W 10
 buffer_store_dwordx4 v[172:175],v224,s[8:11],s70 offen offset:3072 sc0 sc1
 v_cvt_pk_bf16_f32 v176,v72,v73
 M v[88:91],v[152:155],a[80:83],v[88:91]
 T v[144:145],v213,4096
 T v[146:147],v213,6144
 M v[92:95],v[152:155],a[84:87],v[92:95]
 W 10
 v_cvt_pk_bf16_f32 v178,v76,v77
 v_cvt_pk_bf16_f32 v177,v74,v75
 M v[88:91],v[156:159],a[88:91],v[88:91]
 T v[148:149],v213,12288
 T v[150:151],v213,14336
 M v[92:95],v[156:159],a[92:95],v[92:95]
 W 10
 v_cvt_pk_bf16_f32 v179,v78,v79
 s_add_u32 s70,s80,13312
 M v[88:91],v[128:131],a[96:99],v[88:91]
 T v[152:153],v213,20480
 T v[154:155],v213,22528
 M v[92:95],v[128:131],a[100:103],v[92:95]
 W 10
 v_permlane16_swap_b32 v176,v178
 M v[88:91],v[132:135],a[104:107],v[88:91]
 T v[156:157],v213,28672
 T v[158:159],v213,30720
 M v[92:95],v[132:135],a[108:111],v[92:95]
 W 10
 v_permlane16_swap_b32 v177,v179
 M v[88:91],v[136:139],a[112:115],v[88:91]
 T v[128:129],v218,4096
 T v[130:131],v218,6144
 M v[92:95],v[136:139],a[116:119],v[92:95]
 W 10
 buffer_store_dwordx4 v[176:179],v224,s[8:11],s70 offen offset:0 sc0 sc1
 M v[88:91],v[140:143],a[120:123],v[88:91]
 T v[132:133],v218,12288
 T v[134:135],v218,14336
 M v[92:95],v[140:143],a[124:127],v[92:95]
 W 10
 M v[88:91],v[144:147],a[224:227],v[88:91]
 T v[136:137],v218,20480
 T v[138:139],v218,22528
 M v[92:95],v[144:147],a[228:231],v[92:95]
 W 10
 M v[88:91],v[148:151],a[232:235],v[88:91]
 T v[140:141],v218,28672
 T v[142:143],v218,30720
 M v[92:95],v[148:151],a[236:239],v[92:95]
 W 10
 M v[88:91],v[152:155],a[240:243],v[88:91]
 T v[144:145],v218,36864
 T v[146:147],v218,38912
 M v[92:95],v[152:155],a[244:247],v[92:95]
 W 10
 M v[88:91],v[156:159],a[248:251],v[88:91]
 T v[148:149],v218,45056
 T v[150:151],v218,47104
 M v[92:95],v[156:159],a[252:255],v[92:95]
 W 10
 M v[104:107],v[128:131],a[64:67],v[104:107]
 T v[152:153],v218,53248
 T v[154:155],v218,55296
 M v[108:111],v[128:131],a[68:71],v[108:111]
 W 10
 M v[104:107],v[132:135],a[72:75],v[104:107]
 T v[156:157],v218,61440
 T v[158:159],v218,63488
 M v[108:111],v[132:135],a[76:79],v[108:111]
 W 10
 v_cvt_pk_bf16_f32 v180,v88,v89
 v_cvt_pk_bf16_f32 v182,v92,v93
 M v[104:107],v[136:139],a[80:83],v[104:107]
 T v[128:129],v214,4096
 T v[130:131],v214,6144
 M v[108:111],v[136:139],a[84:87],v[108:111]
 W 10
 v_cvt_pk_bf16_f32 v181,v90,v91
 v_cvt_pk_bf16_f32 v183,v94,v95
 M v[104:107],v[140:143],a[88:91],v[104:107]
 T v[132:133],v214,12288
 T v[134:135],v214,14336
 M v[108:111],v[140:143],a[92:95],v[108:111]
 W 10
 s_add_u32 s70,s80,13312
 M v[104:107],v[144:147],a[96:99],v[104:107]
 T v[136:137],v214,20480
 T v[138:139],v214,22528
 M v[108:111],v[144:147],a[100:103],v[108:111]
 W 10
 v_permlane16_swap_b32 v180,v182
 M v[104:107],v[148:151],a[104:107],v[104:107]
 T v[140:141],v214,28672
 T v[142:143],v214,30720
 M v[108:111],v[148:151],a[108:111],v[108:111]
 W 10
 v_permlane16_swap_b32 v181,v183
 M v[104:107],v[152:155],a[112:115],v[104:107]
 T v[144:145],v219,4096
 T v[146:147],v219,6144
 M v[108:111],v[152:155],a[116:119],v[108:111]
 W 10
 buffer_store_dwordx4 v[180:183],v224,s[8:11],s70 offen offset:1024 sc0 sc1
 M v[104:107],v[156:159],a[120:123],v[104:107]
 T v[148:149],v219,12288
 T v[150:151],v219,14336
 M v[108:111],v[156:159],a[124:127],v[108:111]
 W 10
 M v[104:107],v[128:131],a[224:227],v[104:107]
 T v[152:153],v219,20480
 T v[154:155],v219,22528
 M v[108:111],v[128:131],a[228:231],v[108:111]
 W 10
 M v[104:107],v[132:135],a[232:235],v[104:107]
 T v[156:157],v219,28672
 T v[158:159],v219,30720
 M v[108:111],v[132:135],a[236:239],v[108:111]
 W 10
 M v[104:107],v[136:139],a[240:243],v[104:107]
 T v[128:129],v219,36864
 T v[130:131],v219,38912
 M v[108:111],v[136:139],a[244:247],v[108:111]
 W 10
 M v[104:107],v[140:143],a[248:251],v[104:107]
 T v[132:133],v219,45056
 T v[134:135],v219,47104
 M v[108:111],v[140:143],a[252:255],v[108:111]
 W 10
 M v[120:123],v[144:147],a[64:67],v[120:123]
 T v[136:137],v219,53248
 T v[138:139],v219,55296
 M v[124:127],v[144:147],a[68:71],v[124:127]
 W 10
 M v[120:123],v[148:151],a[72:75],v[120:123]
 T v[140:141],v219,61440
 T v[142:143],v219,63488
 M v[124:127],v[148:151],a[76:79],v[124:127]
 W 10
 v_cvt_pk_bf16_f32 v184,v104,v105
 v_cvt_pk_bf16_f32 v186,v108,v109
 M v[120:123],v[152:155],a[80:83],v[120:123]
 T v[144:145],v215,4096
 T v[146:147],v215,6144
 M v[124:127],v[152:155],a[84:87],v[124:127]
 W 10
 v_cvt_pk_bf16_f32 v185,v106,v107
 v_cvt_pk_bf16_f32 v187,v110,v111
 M v[120:123],v[156:159],a[88:91],v[120:123]
 T v[148:149],v215,12288
 T v[150:151],v215,14336
 M v[124:127],v[156:159],a[92:95],v[124:127]
 W 10
 s_add_u32 s70,s80,13312
 M v[120:123],v[128:131],a[96:99],v[120:123]
 T v[152:153],v215,20480
 T v[154:155],v215,22528
 M v[124:127],v[128:131],a[100:103],v[124:127]
 W 10
 v_permlane16_swap_b32 v184,v186
 M v[120:123],v[132:135],a[104:107],v[120:123]
 T v[156:157],v215,28672
 T v[158:159],v215,30720
 M v[124:127],v[132:135],a[108:111],v[124:127]
 W 10
 v_permlane16_swap_b32 v185,v187
 M v[120:123],v[136:139],a[112:115],v[120:123]
 buffer_store_dwordx4 v[184:187],v224,s[8:11],s70 offen offset:2048 sc0 sc1
 M v[124:127],v[136:139],a[116:119],v[124:127]
 W 8
 M v[120:123],v[140:143],a[120:123],v[120:123]
 M v[124:127],v[140:143],a[124:127],v[124:127]
 W 6
 M v[120:123],v[144:147],a[224:227],v[120:123]
 M v[124:127],v[144:147],a[228:231],v[124:127]
 W 4
 M v[120:123],v[148:151],a[232:235],v[120:123]
 M v[124:127],v[148:151],a[236:239],v[124:127]
 W 2
 M v[120:123],v[152:155],a[240:243],v[120:123]
 M v[124:127],v[152:155],a[244:247],v[124:127]
 W 0
 M v[120:123],v[156:159],a[248:251],v[120:123]
 M v[124:127],v[156:159],a[252:255],v[124:127]
 s_nop 6
 v_cvt_pk_bf16_f32 v188,v120,v121
 v_cvt_pk_bf16_f32 v190,v124,v125
 v_cvt_pk_bf16_f32 v189,v122,v123
 v_cvt_pk_bf16_f32 v191,v126,v127
 s_add_u32 s70,s80,13312
 v_permlane16_swap_b32 v188,v190
 v_permlane16_swap_b32 v189,v191
 buffer_store_dwordx4 v[188:191],v224,s[8:11],s70 offen offset:3072 sc0 sc1
F_P4:
 s_mov_b32 s73,s1
 s_waitcnt vmcnt(0)
 v_add_u32 v211,1,v211
 buffer_store_dword v211,v210,s[8:11],s73 offen sc0 sc1
 s_lshr_b32 s68,s2,3
 s_mul_i32 s68,s68,589824
 s_mul_i32 s69,s65,9216
 s_add_u32 s68,s68,s69
 s_lshl_b32 s69,s64,11
 s_add_u32 s68,s68,s69
 s_add_u32 s68,s68,0x4000000
 buffer_load_dword v207,v209,s[8:11],0 offen sc1
 v_lshlrev_b32 v64,16,v226
 v_and_b32 v65,0xffff0000,v226
 v_lshlrev_b32 v80,16,v230
 v_and_b32 v81,0xffff0000,v230
 v_add_f32 v64,v64,v80
 v_add_f32 v65,v65,v81
 v_lshlrev_b32 v66,16,v227
 v_and_b32 v67,0xffff0000,v227
 v_lshlrev_b32 v80,16,v231
 v_and_b32 v81,0xffff0000,v231
 v_add_f32 v66,v66,v80
 v_add_f32 v67,v67,v81
 v_lshlrev_b32 v68,16,v228
 v_and_b32 v69,0xffff0000,v228
 v_lshlrev_b32 v80,16,v232
 v_and_b32 v81,0xffff0000,v232
 v_add_f32 v68,v68,v80
 v_add_f32 v69,v69,v81
 v_lshlrev_b32 v70,16,v229
 v_and_b32 v71,0xffff0000,v229
 v_lshlrev_b32 v80,16,v233
 v_and_b32 v81,0xffff0000,v233
 v_add_f32 v70,v70,v80
 v_add_f32 v71,v71,v81
 v_lshlrev_b32 v72,16,v234
 v_and_b32 v73,0xffff0000,v234
 v_lshlrev_b32 v80,16,v238
 v_and_b32 v81,0xffff0000,v238
 v_add_f32 v72,v72,v80
 v_add_f32 v73,v73,v81
 v_lshlrev_b32 v74,16,v235
 v_and_b32 v75,0xffff0000,v235
 v_lshlrev_b32 v80,16,v239
 v_and_b32 v81,0xffff0000,v239
 v_add_f32 v74,v74,v80
 v_add_f32 v75,v75,v81
 v_lshlrev_b32 v76,16,v236
 v_and_b32 v77,0xffff0000,v236
 v_lshlrev_b32 v80,16,v240
 v_and_b32 v81,0xffff0000,v240
 v_add_f32 v76,v76,v80
 v_add_f32 v77,v77,v81
 v_lshlrev_b32 v78,16,v237
 v_and_b32 v79,0xffff0000,v237
 v_lshlrev_b32 v80,16,v241
 v_and_b32 v81,0xffff0000,v241
 v_add_f32 v78,v78,v80
 v_add_f32 v79,v79,v81
 s_add_u32 s63,s62,1
 s_waitcnt vmcnt(0)
 v_subrev_u32 v207,s63,v207
 v_cmp_le_u32 vcc,8,v207
 s_cbranch_vccz PL_ok11
 s_mov_b32 s69,0x100000
PL_sp11:
 s_sleep 2
 buffer_load_dword v207,v209,s[8:11],0 offen sc1
 s_waitcnt vmcnt(0)
 v_subrev_u32 v207,s63,v207
 v_cmp_le_u32 vcc,8,v207
 s_cbranch_vccz PL_ok11
 s_sub_u32 s69,s69,1
 s_cbranch_scc0 PL_sp11
PL_ok11:
 buffer_load_dwordx4 v[0:3],v224,s[8:11],s68 offen offset:0 sc1
 buffer_load_dwordx4 v[32:35],v224,s[8:11],s68 offen offset:1024 sc1
 s_add_u32 s68,s68,0x12000
 buffer_load_dwordx4 v[4:7],v224,s[8:11],s68 offen offset:0 sc1
 buffer_load_dwordx4 v[36:39],v224,s[8:11],s68 offen offset:1024 sc1
 s_add_u32 s68,s68,0x12000
 buffer_load_dwordx4 v[8:11],v224,s[8:11],s68 offen offset:0 sc1
 buffer_load_dwordx4 v[40:43],v224,s[8:11],s68 offen offset:1024 sc1
 s_add_u32 s68,s68,0x12000
 buffer_load_dwordx4 v[12:15],v224,s[8:11],s68 offen offset:0 sc1
 buffer_load_dwordx4 v[44:47],v224,s[8:11],s68 offen offset:1024 sc1
 s_add_u32 s68,s68,0x12000
 buffer_load_dwordx4 v[16:19],v224,s[8:11],s68 offen offset:0 sc1
 buffer_load_dwordx4 v[48:51],v224,s[8:11],s68 offen offset:1024 sc1
 s_add_u32 s68,s68,0x12000
 buffer_load_dwordx4 v[20:23],v224,s[8:11],s68 offen offset:0 sc1
 buffer_load_dwordx4 v[52:55],v224,s[8:11],s68 offen offset:1024 sc1
 s_add_u32 s68,s68,0x12000
 buffer_load_dwordx4 v[24:27],v224,s[8:11],s68 offen offset:0 sc1
 buffer_load_dwordx4 v[56:59],v224,s[8:11],s68 offen offset:1024 sc1
 s_add_u32 s68,s68,0x12000
 buffer_load_dwordx4 v[28:31],v224,s[8:11],s68 offen offset:0 sc1
 buffer_load_dwordx4 v[60:63],v224,s[8:11],s68 offen offset:1024 sc1
 s_waitcnt vmcnt(15)
 v_lshlrev_b32 v80,16,v0
 v_and_b32 v81,0xffff0000,v0
 v_add_f32 v64,v64,v80
 v_add_f32 v65,v65,v81
 v_lshlrev_b32 v80,16,v1
 v_and_b32 v81,0xffff0000,v1
 v_add_f32 v66,v66,v80
 v_add_f32 v67,v67,v81
 v_lshlrev_b32 v80,16,v2
 v_and_b32 v81,0xffff0000,v2
 v_add_f32 v68,v68,v80
 v_add_f32 v69,v69,v81
 v_lshlrev_b32 v80,16,v3
 v_and_b32 v81,0xffff0000,v3
 v_add_f32 v70,v70,v80
 v_add_f32 v71,v71,v81
 s_waitcnt vmcnt(14)
 v_lshlrev_b32 v80,16,v32
 v_and_b32 v81,0xffff0000,v32
 v_add_f32 v72,v72,v80
 v_add_f32 v73,v73,v81
 v_lshlrev_b32 v80,16,v33
 v_and_b32 v81,0xffff0000,v33
 v_add_f32 v74,v74,v80
 v_add_f32 v75,v75,v81
 v_lshlrev_b32 v80,16,v34
 v_and_b32 v81,0xffff0000,v34
 v_add_f32 v76,v76,v80
 v_add_f32 v77,v77,v81
 v_lshlrev_b32 v80,16,v35
 v_and_b32 v81,0xffff0000,v35
 v_add_f32 v78,v78,v80
 v_add_f32 v79,v79,v81
 s_waitcnt vmcnt(13)
 v_lshlrev_b32 v80,16,v4
 v_and_b32 v81,0xffff0000,v4
 v_add_f32 v64,v64,v80
 v_add_f32 v65,v65,v81
 v_lshlrev_b32 v80,16,v5
 v_and_b32 v81,0xffff0000,v5
 v_add_f32 v66,v66,v80
 v_add_f32 v67,v67,v81
 v_lshlrev_b32 v80,16,v6
 v_and_b32 v81,0xffff0000,v6
 v_add_f32 v68,v68,v80
 v_add_f32 v69,v69,v81
 v_lshlrev_b32 v80,16,v7
 v_and_b32 v81,0xffff0000,v7
 v_add_f32 v70,v70,v80
 v_add_f32 v71,v71,v81
 s_waitcnt vmcnt(12)
 v_lshlrev_b32 v80,16,v36
 v_and_b32 v81,0xffff0000,v36
 v_add_f32 v72,v72,v80
 v_add_f32 v73,v73,v81
 v_lshlrev_b32 v80,16,v37
 v_and_b32 v81,0xffff0000,v37
 v_add_f32 v74,v74,v80
 v_add_f32 v75,v75,v81
 v_lshlrev_b32 v80,16,v38
 v_and_b32 v81,0xffff0000,v38
 v_add_f32 v76,v76,v80
 v_add_f32 v77,v77,v81
 v_lshlrev_b32 v80,16,v39
 v_and_b32 v81,0xffff0000,v39
 v_add_f32 v78,v78,v80
 v_add_f32 v79,v79,v81
 s_waitcnt vmcnt(11)
 v_lshlrev_b32 v80,16,v8
 v_and_b32 v81,0xffff0000,v8
 v_add_f32 v64,v64,v80
 v_add_f32 v65,v65,v81
 v_lshlrev_b32 v80,16,v9
 v_and_b32 v81,0xffff0000,v9
 v_add_f32 v66,v66,v80
 v_add_f32 v67,v67,v81
 v_lshlrev_b32 v80,16,v10
 v_and_b32 v81,0xffff0000,v10
 v_add_f32 v68,v68,v80
 v_add_f32 v69,v69,v81
 v_lshlrev_b32 v80,16,v11
 v_and_b32 v81,0xffff0000,v11
 v_add_f32 v70,v70,v80
 v_add_f32 v71,v71,v81
 s_waitcnt vmcnt(10)
 v_lshlrev_b32 v80,16,v40
 v_and_b32 v81,0xffff0000,v40
 v_add_f32 v72,v72,v80
 v_add_f32 v73,v73,v81
 v_lshlrev_b32 v80,16,v41
 v_and_b32 v81,0xffff0000,v41
 v_add_f32 v74,v74,v80
 v_add_f32 v75,v75,v81
 v_lshlrev_b32 v80,16,v42
 v_and_b32 v81,0xffff0000,v42
 v_add_f32 v76,v76,v80
 v_add_f32 v77,v77,v81
 v_lshlrev_b32 v80,16,v43
 v_and_b32 v81,0xffff0000,v43
 v_add_f32 v78,v78,v80
 v_add_f32 v79,v79,v81
 s_waitcnt vmcnt(9)
 v_lshlrev_b32 v80,16,v12
 v_and_b32 v81,0xffff0000,v12
 v_add_f32 v64,v64,v80
 v_add_f32 v65,v65,v81
 v_lshlrev_b32 v80,16,v13
 v_and_b32 v81,0xffff0000,v13
 v_add_f32 v66,v66,v80
 v_add_f32 v67,v67,v81
 v_lshlrev_b32 v80,16,v14
 v_and_b32 v81,0xffff0000,v14
 v_add_f32 v68,v68,v80
 v_add_f32 v69,v69,v81
 v_lshlrev_b32 v80,16,v15
 v_and_b32 v81,0xffff0000,v15
 v_add_f32 v70,v70,v80
 v_add_f32 v71,v71,v81
 s_waitcnt vmcnt(8)
 v_lshlrev_b32 v80,16,v44
 v_and_b32 v81,0xffff0000,v44
 v_add_f32 v72,v72,v80
 v_add_f32 v73,v73,v81
 v_lshlrev_b32 v80,16,v45
 v_and_b32 v81,0xffff0000,v45
 v_add_f32 v74,v74,v80
 v_add_f32 v75,v75,v81
 v_lshlrev_b32 v80,16,v46
 v_and_b32 v81,0xffff0000,v46
 v_add_f32 v76,v76,v80
 v_add_f32 v77,v77,v81
 v_lshlrev_b32 v80,16,v47
 v_and_b32 v81,0xffff0000,v47
 v_add_f32 v78,v78,v80
 v_add_f32 v79,v79,v81
 s_waitcnt vmcnt(7)
 v_lshlrev_b32 v80,16,v16
 v_and_b32 v81,0xffff0000,v16
 v_add_f32 v64,v64,v80
 v_add_f32 v65,v65,v81
 v_lshlrev_b32 v80,16,v17
 v_and_b32 v81,0xffff0000,v17
 v_add_f32 v66,v66,v80
 v_add_f32 v67,v67,v81
 v_lshlrev_b32 v80,16,v18
 v_and_b32 v81,0xffff0000,v18
 v_add_f32 v68,v68,v80
 v_add_f32 v69,v69,v81
 v_lshlrev_b32 v80,16,v19
 v_and_b32 v81,0xffff0000,v19
 v_add_f32 v70,v70,v80
 v_add_f32 v71,v71,v81
 s_waitcnt vmcnt(6)
 v_lshlrev_b32 v80,16,v48
 v_and_b32 v81,0xffff0000,v48
 v_add_f32 v72,v72,v80
 v_add_f32 v73,v73,v81
 v_lshlrev_b32 v80,16,v49
 v_and_b32 v81,0xffff0000,v49
 v_add_f32 v74,v74,v80
 v_add_f32 v75,v75,v81
 v_lshlrev_b32 v80,16,v50
 v_and_b32 v81,0xffff0000,v50
 v_add_f32 v76,v76,v80
 v_add_f32 v77,v77,v81
 v_lshlrev_b32 v80,16,v51
 v_and_b32 v81,0xffff0000,v51
 v_add_f32 v78,v78,v80
 v_add_f32 v79,v79,v81
 s_waitcnt vmcnt(5)
 v_lshlrev_b32 v80,16,v20
 v_and_b32 v81,0xffff0000,v20
 v_add_f32 v64,v64,v80
 v_add_f32 v65,v65,v81
 v_lshlrev_b32 v80,16,v21
 v_and_b32 v81,0xffff0000,v21
 v_add_f32 v66,v66,v80
 v_add_f32 v67,v67,v81
 v_lshlrev_b32 v80,16,v22
 v_and_b32 v81,0xffff0000,v22
 v_add_f32 v68,v68,v80
 v_add_f32 v69,v69,v81
 v_lshlrev_b32 v80,16,v23
 v_and_b32 v81,0xffff0000,v23
 v_add_f32 v70,v70,v80
 v_add_f32 v71,v71,v81
 s_waitcnt vmcnt(4)
 v_lshlrev_b32 v80,16,v52
 v_and_b32 v81,0xffff0000,v52
 v_add_f32 v72,v72,v80
 v_add_f32 v73,v73,v81
 v_lshlrev_b32 v80,16,v53
 v_and_b32 v81,0xffff0000,v53
 v_add_f32 v74,v74,v80
 v_add_f32 v75,v75,v81
 v_lshlrev_b32 v80,16,v54
 v_and_b32 v81,0xffff0000,v54
 v_add_f32 v76,v76,v80
 v_add_f32 v77,v77,v81
 v_lshlrev_b32 v80,16,v55
 v_and_b32 v81,0xffff0000,v55
 v_add_f32 v78,v78,v80
 v_add_f32 v79,v79,v81
 s_waitcnt vmcnt(3)
 v_lshlrev_b32 v80,16,v24
 v_and_b32 v81,0xffff0000,v24
 v_add_f32 v64,v64,v80
 v_add_f32 v65,v65,v81
 v_lshlrev_b32 v80,16,v25
 v_and_b32 v81,0xffff0000,v25
 v_add_f32 v66,v66,v80
 v_add_f32 v67,v67,v81
 v_lshlrev_b32 v80,16,v26
 v_and_b32 v81,0xffff0000,v26
 v_add_f32 v68,v68,v80
 v_add_f32 v69,v69,v81
 v_lshlrev_b32 v80,16,v27
 v_and_b32 v81,0xffff0000,v27
 v_add_f32 v70,v70,v80
 v_add_f32 v71,v71,v81
 s_waitcnt vmcnt(2)
 v_lshlrev_b32 v80,16,v56
 v_and_b32 v81,0xffff0000,v56
 v_add_f32 v72,v72,v80
 v_add_f32 v73,v73,v81
 v_lshlrev_b32 v80,16,v57
 v_and_b32 v81,0xffff0000,v57
 v_add_f32 v74,v74,v80
 v_add_f32 v75,v75,v81
 v_lshlrev_b32 v80,16,v58
 v_and_b32 v81,0xffff0000,v58
 v_add_f32 v76,v76,v80
 v_add_f32 v77,v77,v81
 v_lshlrev_b32 v80,16,v59
 v_and_b32 v81,0xffff0000,v59
 v_add_f32 v78,v78,v80
 v_add_f32 v79,v79,v81
 s_waitcnt vmcnt(1)
 v_lshlrev_b32 v80,16,v28
 v_and_b32 v81,0xffff0000,v28
 v_add_f32 v64,v64,v80
 v_add_f32 v65,v65,v81
 v_lshlrev_b32 v80,16,v29
 v_and_b32 v81,0xffff0000,v29
 v_add_f32 v66,v66,v80
 v_add_f32 v67,v67,v81
 v_lshlrev_b32 v80,16,v30
 v_and_b32 v81,0xffff0000,v30
 v_add_f32 v68,v68,v80
 v_add_f32 v69,v69,v81
 v_lshlrev_b32 v80,16,v31
 v_and_b32 v81,0xffff0000,v31
 v_add_f32 v70,v70,v80
 v_add_f32 v71,v71,v81
 s_waitcnt vmcnt(0)
 v_lshlrev_b32 v80,16,v60
 v_and_b32 v81,0xffff0000,v60
 v_add_f32 v72,v72,v80
 v_add_f32 v73,v73,v81
 v_lshlrev_b32 v80,16,v61
 v_and_b32 v81,0xffff0000,v61
 v_add_f32 v74,v74,v80
 v_add_f32 v75,v75,v81
 v_lshlrev_b32 v80,16,v62
 v_and_b32 v81,0xffff0000,v62
 v_add_f32 v76,v76,v80
 v_add_f32 v77,v77,v81
 v_lshlrev_b32 v80,16,v63
 v_and_b32 v81,0xffff0000,v63
 v_add_f32 v78,v78,v80
 v_add_f32 v79,v79,v81
 v_cvt_pk_bf16_f32 v84,v64,v65
 v_cvt_pk_bf16_f32 v85,v66,v67
 v_cvt_pk_bf16_f32 v86,v68,v69
 v_cvt_pk_bf16_f32 v87,v70,v71
 buffer_store_dwordx4 v[84:87],v222,s[56:59],s74 offen offset:0
 v_cvt_pk_bf16_f32 v88,v72,v73
 v_cvt_pk_bf16_f32 v89,v74,v75
 v_cvt_pk_bf16_f32 v90,v76,v77
 v_cvt_pk_bf16_f32 v91,v78,v79
 buffer_store_dwordx4 v[88:91],v222,s[56:59],s74 offen offset:32
 s_endpgm
F_RA0:
 s_nop 15
 s_mul_i32 s70,s75,272
 s_add_u32 s79,s70,0
 buffer_load_dwordx4 v[176:179],v224,s[36:39],s79 offen offset:0 sc1
 buffer_load_dwordx4 v[180:183],v224,s[36:39],s79 offen offset:1024 sc1
 buffer_load_dwordx4 v[184:187],v224,s[36:39],s79 offen offset:2048 sc1
 buffer_load_dwordx4 v[188:191],v224,s[36:39],s79 offen offset:3072 sc1
 s_waitcnt vmcnt(0)
 N v[0:15],v[176:179],a[128:131],v[128:143]
 N v[16:31],v[176:179],a[160:163],v[144:159]
 N v[0:15],v[180:183],a[132:135],v[0:15]
 N v[16:31],v[180:183],a[164:167],v[16:31]
 N v[0:15],v[184:187],a[136:139],v[0:15]
 N v[16:31],v[184:187],a[168:171],v[16:31]
 N v[0:15],v[188:191],a[140:143],v[0:15]
 N v[16:31],v[188:191],a[172:175],v[16:31]
 s_nop 7
 s_add_u32 s79,s70,4096
 buffer_load_dwordx4 v[176:179],v224,s[36:39],s79 offen offset:0 sc1
 buffer_load_dwordx4 v[180:183],v224,s[36:39],s79 offen offset:1024 sc1
 buffer_load_dwordx4 v[184:187],v224,s[36:39],s79 offen offset:2048 sc1
 buffer_load_dwordx4 v[188:191],v224,s[36:39],s79 offen offset:3072 sc1
 s_waitcnt vmcnt(0)
 N v[0:15],v[176:179],a[144:147],v[0:15]
 N v[16:31],v[176:179],a[176:179],v[16:31]
 N v[0:15],v[180:183],a[148:151],v[0:15]
 N v[16:31],v[180:183],a[180:183],v[16:31]
 N v[0:15],v[184:187],a[152:155],v[0:15]
 N v[16:31],v[184:187],a[184:187],v[16:31]
 N v[0:15],v[188:191],a[156:159],v[0:15]
 N v[16:31],v[188:191],a[188:191],v[16:31]
 s_nop 7
 s_add_u32 s79,s70,8192
 buffer_load_dwordx4 v[176:179],v224,s[36:39],s79 offen offset:0 sc1
 buffer_load_dwordx4 v[180:183],v224,s[36:39],s79 offen offset:1024 sc1
 buffer_load_dwordx4 v[184:187],v224,s[36:39],s79 offen offset:2048 sc1
 buffer_load_dwordx4 v[188:191],v224,s[36:39],s79 offen offset:3072 sc1
 s_waitcnt vmcnt(0)
 N v[32:47],v[176:179],a[128:131],v[128:143]
 N v[48:63],v[176:179],a[160:163],v[144:159]
 N v[32:47],v[180:183],a[132:135],v[32:47]
 N v[48:63],v[180:183],a[164:167],v[48:63]
 N v[32:47],v[184:187],a[136:139],v[32:47]
 N v[48:63],v[184:187],a[168:171],v[48:63]
 N v[32:47],v[188:191],a[140:143],v[32:47]
 N v[48:63],v[188:191],a[172:175],v[48:63]
 s_nop 7
 s_add_u32 s79,s70,12288
 buffer_load_dwordx4 v[176:179],v224,s[36:39],s79 offen offset:0 sc1
 buffer_load_dwordx4 v[180:183],v224,s[36:39],s79 offen offset:1024 sc1
 buffer_load_dwordx4 v[184:187],v224,s[36:39],s79 offen offset:2048 sc1
 buffer_load_dwordx4 v[188:191],v224,s[36:39],s79 offen offset:3072 sc1
 s_waitcnt vmcnt(0)
 N v[32:47],v[176:179],a[144:147],v[32:47]
 N v[48:63],v[176:179],a[176:179],v[48:63]
 N v[32:47],v[180:183],a[148:151],v[32:47]
 N v[48:63],v[180:183],a[180:183],v[48:63]
 N v[32:47],v[184:187],a[152:155],v[32:47]
 N v[48:63],v[184:187],a[184:187],v[48:63]
 N v[32:47],v[188:191],a[156:159],v[32:47]
 N v[48:63],v[188:191],a[188:191],v[48:63]
 s_nop 7
 s_lshl_b32 s79,s66,7
 s_sub_u32 s79,s79,s75
 v_add_u32 v206,s79,v204
 v_cmp_le_i32 s[84:85],0,v206
 v_cmp_le_i32 s[86:87],1,v206
 v_cmp_le_i32 s[88:89],2,v206
 v_cmp_le_i32 s[98:99],3,v206
 v_cndmask_b32 v0,v205,v0,s[84:85]
 v_cndmask_b32 v1,v205,v1,s[86:87]
 v_cndmask_b32 v2,v205,v2,s[88:89]
 v_cndmask_b32 v3,v205,v3,s[98:99]
 v_cmp_le_i32 s[84:85],8,v206
 v_cmp_le_i32 s[86:87],9,v206
 v_cmp_le_i32 s[88:89],10,v206
 v_cmp_le_i32 s[98:99],11,v206
 v_cndmask_b32 v4,v205,v4,s[84:85]
 v_cndmask_b32 v5,v205,v5,s[86:87]
 v_cndmask_b32 v6,v205,v6,s[88:89]
 v_cndmask_b32 v7,v205,v7,s[98:99]
 v_cmp_le_i32 s[84:85],16,v206
 v_cmp_le_i32 s[86:87],17,v206
 v_cmp_le_i32 s[88:89],18,v206
 v_cmp_le_i32 s[98:99],19,v206
 v_cndmask_b32 v8,v205,v8,s[84:85]
 v_cndmask_b32 v9,v205,v9,s[86:87]
 v_cndmask_b32 v10,v205,v10,s[88:89]
 v_cndmask_b32 v11,v205,v11,s[98:99]
 v_cmp_le_i32 s[84:85],24,v206
 v_cmp_le_i32 s[86:87],25,v206
 v_cmp_le_i32 s[88:89],26,v206
 v_cmp_le_i32 s[98:99],27,v206
 v_cndmask_b32 v12,v205,v12,s[84:85]
 v_cndmask_b32 v13,v205,v13,s[86:87]
 v_cndmask_b32 v14,v205,v14,s[88:89]
 v_cndmask_b32 v15,v205,v15,s[98:99]
 v_add_u32 v206,s79,v204
 v_subrev_u32 v206,32,v206
 v_cmp_le_i32 s[84:85],0,v206
 v_cmp_le_i32 s[86:87],1,v206
 v_cmp_le_i32 s[88:89],2,v206
 v_cmp_le_i32 s[98:99],3,v206
 v_cndmask_b32 v32,v205,v32,s[84:85]
 v_cndmask_b32 v33,v205,v33,s[86:87]
 v_cndmask_b32 v34,v205,v34,s[88:89]
 v_cndmask_b32 v35,v205,v35,s[98:99]
 v_cmp_le_i32 s[84:85],8,v206
 v_cmp_le_i32 s[86:87],9,v206
 v_cmp_le_i32 s[88:89],10,v206
 v_cmp_le_i32 s[98:99],11,v206
 v_cndmask_b32 v36,v205,v36,s[84:85]
 v_cndmask_b32 v37,v205,v37,s[86:87]
 v_cndmask_b32 v38,v205,v38,s[88:89]
 v_cndmask_b32 v39,v205,v39,s[98:99]
 v_cmp_le_i32 s[84:85],16,v206
 v_cmp_le_i32 s[86:87],17,v206
 v_cmp_le_i32 s[88:89],18,v206
 v_cmp_le_i32 s[98:99],19,v206
 v_cndmask_b32 v40,v205,v40,s[84:85]
 v_cndmask_b32 v41,v205,v41,s[86:87]
 v_cndmask_b32 v42,v205,v42,s[88:89]
 v_cndmask_b32 v43,v205,v43,s[98:99]
 v_cmp_le_i32 s[84:85],24,v206
 v_cmp_le_i32 s[86:87],25,v206
 v_cmp_le_i32 s[88:89],26,v206
 v_cmp_le_i32 s[98:99],27,v206
 v_cndmask_b32 v44,v205,v44,s[84:85]
 v_cndmask_b32 v45,v205,v45,s[86:87]
 v_cndmask_b32 v46,v205,v46,s[88:89]
 v_cndmask_b32 v47,v205,v47,s[98:99]
 v_max3_f32 v200,v0,v1,v2
 v_max3_f32 v200,v200,v3,v4
 v_max3_f32 v200,v200,v5,v6
 v_max3_f32 v200,v200,v7,v8
 v_max3_f32 v200,v200,v9,v10
 v_max3_f32 v200,v200,v11,v12
 v_max3_f32 v200,v200,v13,v14
 v_max_f32 v200,v200,v15
 v_max3_f32 v200,v200,v32,v33
 v_max3_f32 v200,v200,v34,v35
 v_max3_f32 v200,v200,v36,v37
 v_max3_f32 v200,v200,v38,v39
 v_max3_f32 v200,v200,v40,v41
 v_max3_f32 v200,v200,v42,v43
 v_max3_f32 v200,v200,v44,v45
 v_max3_f32 v200,v200,v46,v47
 v_mov_b32 v206,v200
 s_nop 1
 v_permlane32_swap_b32 v200,v206
 v_max_f32 v200,v200,v206
 v_max_f32 v200,0,v200
 v_exp_f32 v202,-v200
 v_sub_f32 v0,v0,v200
 v_sub_f32 v1,v1,v200
 v_sub_f32 v2,v2,v200
 v_sub_f32 v3,v3,v200
 v_sub_f32 v4,v4,v200
 v_sub_f32 v5,v5,v200
 v_sub_f32 v6,v6,v200
 v_sub_f32 v7,v7,v200
 v_sub_f32 v8,v8,v200
 v_sub_f32 v9,v9,v200
 v_sub_f32 v10,v10,v200
 v_sub_f32 v11,v11,v200
 v_sub_f32 v12,v12,v200
 v_sub_f32 v13,v13,v200
 v_sub_f32 v14,v14,v200
 v_sub_f32 v15,v15,v200
 v_sub_f32 v32,v32,v200
 v_sub_f32 v33,v33,v200
 v_sub_f32 v34,v34,v200
 v_sub_f32 v35,v35,v200
 v_sub_f32 v36,v36,v200
 v_sub_f32 v37,v37,v200
 v_sub_f32 v38,v38,v200
 v_sub_f32 v39,v39,v200
 v_sub_f32 v40,v40,v200
 v_sub_f32 v41,v41,v200
 v_sub_f32 v42,v42,v200
 v_sub_f32 v43,v43,v200
 v_sub_f32 v44,v44,v200
 v_sub_f32 v45,v45,v200
 v_sub_f32 v46,v46,v200
 v_sub_f32 v47,v47,v200
 v_sub_f32 v128,v128,v200
 v_sub_f32 v129,v129,v200
 v_sub_f32 v130,v130,v200
 v_sub_f32 v131,v131,v200
 v_sub_f32 v132,v132,v200
 v_sub_f32 v133,v133,v200
 v_sub_f32 v134,v134,v200
 v_sub_f32 v135,v135,v200
 v_sub_f32 v136,v136,v200
 v_sub_f32 v137,v137,v200
 v_sub_f32 v138,v138,v200
 v_sub_f32 v139,v139,v200
 v_sub_f32 v140,v140,v200
 v_sub_f32 v141,v141,v200
 v_sub_f32 v142,v142,v200
 v_sub_f32 v143,v143,v200
 v_mul_f32 v196,v196,v202
 v_exp_f32 v0,v0
 v_exp_f32 v1,v1
 v_exp_f32 v2,v2
 v_add_f32 v197,v0,v1
 v_exp_f32 v3,v3
 v_cvt_pk_bf16_f32 v0,v0,v1
 v_exp_f32 v4,v4
 v_add_f32 v197,v197,v2
 v_exp_f32 v5,v5
 v_cvt_pk_bf16_f32 v1,v2,v3
 v_add_f32 v197,v197,v3
 v_exp_f32 v6,v6
 v_add_f32 v197,v197,v4
 v_exp_f32 v7,v7
 v_cvt_pk_bf16_f32 v2,v4,v5
 v_add_f32 v197,v197,v5
 v_exp_f32 v8,v8
 v_add_f32 v197,v197,v6
 v_exp_f32 v9,v9
 v_cvt_pk_bf16_f32 v3,v6,v7
 v_add_f32 v197,v197,v7
 v_exp_f32 v10,v10
 v_add_f32 v197,v197,v8
 v_exp_f32 v11,v11
 v_add_f32 v197,v197,v9
 v_cvt_pk_bf16_f32 v8,v8,v9
 v_exp_f32 v12,v12
 v_add_f32 v197,v197,v10
 v_exp_f32 v13,v13
 v_cvt_pk_bf16_f32 v9,v10,v11
 v_add_f32 v197,v197,v11
 v_exp_f32 v14,v14
 v_add_f32 v197,v197,v12
 v_exp_f32 v15,v15
 v_cvt_pk_bf16_f32 v10,v12,v13
 v_add_f32 v197,v197,v13
 v_add_f32 v197,v197,v14
 v_cvt_pk_bf16_f32 v11,v14,v15
 v_add_f32 v197,v197,v15
 v_exp_f32 v32,v32
 v_exp_f32 v33,v33
 v_exp_f32 v34,v34
 v_add_f32 v197,v197,v32
 v_exp_f32 v35,v35
 v_add_f32 v197,v197,v33
 v_cvt_pk_bf16_f32 v32,v32,v33
 v_exp_f32 v36,v36
 v_add_f32 v197,v197,v34
 v_exp_f32 v37,v37
 v_cvt_pk_bf16_f32 v33,v34,v35
 v_add_f32 v197,v197,v35
 v_exp_f32 v38,v38
 v_add_f32 v197,v197,v36
 v_exp_f32 v39,v39
 v_cvt_pk_bf16_f32 v34,v36,v37
 v_add_f32 v197,v197,v37
 v_exp_f32 v40,v40
 v_add_f32 v197,v197,v38
 v_exp_f32 v41,v41
 v_cvt_pk_bf16_f32 v35,v38,v39
 v_add_f32 v197,v197,v39
 v_exp_f32 v42,v42
 v_add_f32 v197,v197,v40
 v_exp_f32 v43,v43
 v_add_f32 v197,v197,v41
 v_cvt_pk_bf16_f32 v40,v40,v41
 v_exp_f32 v44,v44
 v_add_f32 v197,v197,v42
 v_exp_f32 v45,v45
 v_cvt_pk_bf16_f32 v41,v42,v43
 v_add_f32 v197,v197,v43
 v_exp_f32 v46,v46
 v_add_f32 v197,v197,v44
 v_exp_f32 v47,v47
 v_cvt_pk_bf16_f32 v42,v44,v45
 v_add_f32 v197,v197,v45
 v_add_f32 v197,v197,v46
 v_cvt_pk_bf16_f32 v43,v46,v47
 v_add_f32 v197,v197,v47
 v_accvgpr_read_b32 v176,a0
 v_accvgpr_read_b32 v177,a1
 v_accvgpr_read_b32 v178,a2
 v_accvgpr_read_b32 v179,a3
 v_accvgpr_read_b32 v180,a4
 v_accvgpr_read_b32 v181,a5
 v_accvgpr_read_b32 v182,a6
 v_accvgpr_read_b32 v183,a7
 v_mul_f32 v176,v176,v202
 v_mul_f32 v177,v177,v202
 v_mul_f32 v178,v178,v202
 v_mul_f32 v179,v179,v202
 v_mul_f32 v180,v180,v202
 v_mul_f32 v181,v181,v202
 v_mul_f32 v182,v182,v202
 v_mul_f32 v183,v183,v202
 v_accvgpr_write_b32 a0,v176
 v_accvgpr_write_b32 a1,v177
 v_accvgpr_write_b32 a2,v178
 v_accvgpr_write_b32 a3,v179
 v_accvgpr_write_b32 a4,v180
 v_accvgpr_write_b32 a5,v181
 v_accvgpr_write_b32 a6,v182
 v_accvgpr_write_b32 a7,v183
 v_accvgpr_read_b32 v176,a8
 v_accvgpr_read_b32 v177,a9
 v_accvgpr_read_b32 v178,a10
 v_accvgpr_read_b32 v179,a11
 v_accvgpr_read_b32 v180,a12
 v_accvgpr_read_b32 v181,a13
 v_accvgpr_read_b32 v182,a14
 v_accvgpr_read_b32 v183,a15
 v_mul_f32 v176,v176,v202
 v_mul_f32 v177,v177,v202
 v_mul_f32 v178,v178,v202
 v_mul_f32 v179,v179,v202
 v_mul_f32 v180,v180,v202
 v_mul_f32 v181,v181,v202
 v_mul_f32 v182,v182,v202
 v_mul_f32 v183,v183,v202
 v_accvgpr_write_b32 a8,v176
 v_accvgpr_write_b32 a9,v177
 v_accvgpr_write_b32 a10,v178
 v_accvgpr_write_b32 a11,v179
 v_accvgpr_write_b32 a12,v180
 v_accvgpr_write_b32 a13,v181
 v_accvgpr_write_b32 a14,v182
 v_accvgpr_write_b32 a15,v183
 v_accvgpr_read_b32 v176,a16
 v_accvgpr_read_b32 v177,a17
 v_accvgpr_read_b32 v178,a18
 v_accvgpr_read_b32 v179,a19
 v_accvgpr_read_b32 v180,a20
 v_accvgpr_read_b32 v181,a21
 v_accvgpr_read_b32 v182,a22
 v_accvgpr_read_b32 v183,a23
 v_mul_f32 v176,v176,v202
 v_mul_f32 v177,v177,v202
 v_mul_f32 v178,v178,v202
 v_mul_f32 v179,v179,v202
 v_mul_f32 v180,v180,v202
 v_mul_f32 v181,v181,v202
 v_mul_f32 v182,v182,v202
 v_mul_f32 v183,v183,v202
 v_accvgpr_write_b32 a16,v176
 v_accvgpr_write_b32 a17,v177
 v_accvgpr_write_b32 a18,v178
 v_accvgpr_write_b32 a19,v179
 v_accvgpr_write_b32 a20,v180
 v_accvgpr_write_b32 a21,v181
 v_accvgpr_write_b32 a22,v182
 v_accvgpr_write_b32 a23,v183
 v_accvgpr_read_b32 v176,a24
 v_accvgpr_read_b32 v177,a25
 v_accvgpr_read_b32 v178,a26
 v_accvgpr_read_b32 v179,a27
 v_accvgpr_read_b32 v180,a28
 v_accvgpr_read_b32 v181,a29
 v_accvgpr_read_b32 v182,a30
 v_accvgpr_read_b32 v183,a31
 v_mul_f32 v176,v176,v202
 v_mul_f32 v177,v177,v202
 v_mul_f32 v178,v178,v202
 v_mul_f32 v179,v179,v202
 v_mul_f32 v180,v180,v202
 v_mul_f32 v181,v181,v202
 v_mul_f32 v182,v182,v202
 v_mul_f32 v183,v183,v202
 v_accvgpr_write_b32 a24,v176
 v_accvgpr_write_b32 a25,v177
 v_accvgpr_write_b32 a26,v178
 v_accvgpr_write_b32 a27,v179
 v_accvgpr_write_b32 a28,v180
 v_accvgpr_write_b32 a29,v181
 v_accvgpr_write_b32 a30,v182
 v_accvgpr_write_b32 a31,v183
 v_accvgpr_read_b32 v176,a32
 v_accvgpr_read_b32 v177,a33
 v_accvgpr_read_b32 v178,a34
 v_accvgpr_read_b32 v179,a35
 v_accvgpr_read_b32 v180,a36
 v_accvgpr_read_b32 v181,a37
 v_accvgpr_read_b32 v182,a38
 v_accvgpr_read_b32 v183,a39
 v_mul_f32 v176,v176,v202
 v_mul_f32 v177,v177,v202
 v_mul_f32 v178,v178,v202
 v_mul_f32 v179,v179,v202
 v_mul_f32 v180,v180,v202
 v_mul_f32 v181,v181,v202
 v_mul_f32 v182,v182,v202
 v_mul_f32 v183,v183,v202
 v_accvgpr_write_b32 a32,v176
 v_accvgpr_write_b32 a33,v177
 v_accvgpr_write_b32 a34,v178
 v_accvgpr_write_b32 a35,v179
 v_accvgpr_write_b32 a36,v180
 v_accvgpr_write_b32 a37,v181
 v_accvgpr_write_b32 a38,v182
 v_accvgpr_write_b32 a39,v183
 v_accvgpr_read_b32 v176,a40
 v_accvgpr_read_b32 v177,a41
 v_accvgpr_read_b32 v178,a42
 v_accvgpr_read_b32 v179,a43
 v_accvgpr_read_b32 v180,a44
 v_accvgpr_read_b32 v181,a45
 v_accvgpr_read_b32 v182,a46
 v_accvgpr_read_b32 v183,a47
 v_mul_f32 v176,v176,v202
 v_mul_f32 v177,v177,v202
 v_mul_f32 v178,v178,v202
 v_mul_f32 v179,v179,v202
 v_mul_f32 v180,v180,v202
 v_mul_f32 v181,v181,v202
 v_mul_f32 v182,v182,v202
 v_mul_f32 v183,v183,v202
 v_accvgpr_write_b32 a40,v176
 v_accvgpr_write_b32 a41,v177
 v_accvgpr_write_b32 a42,v178
 v_accvgpr_write_b32 a43,v179
 v_accvgpr_write_b32 a44,v180
 v_accvgpr_write_b32 a45,v181
 v_accvgpr_write_b32 a46,v182
 v_accvgpr_write_b32 a47,v183
 v_accvgpr_read_b32 v176,a48
 v_accvgpr_read_b32 v177,a49
 v_accvgpr_read_b32 v178,a50
 v_accvgpr_read_b32 v179,a51
 v_accvgpr_read_b32 v180,a52
 v_accvgpr_read_b32 v181,a53
 v_accvgpr_read_b32 v182,a54
 v_accvgpr_read_b32 v183,a55
 v_mul_f32 v176,v176,v202
 v_mul_f32 v177,v177,v202
 v_mul_f32 v178,v178,v202
 v_mul_f32 v179,v179,v202
 v_mul_f32 v180,v180,v202
 v_mul_f32 v181,v181,v202
 v_mul_f32 v182,v182,v202
 v_mul_f32 v183,v183,v202
 v_accvgpr_write_b32 a48,v176
 v_accvgpr_write_b32 a49,v177
 v_accvgpr_write_b32 a50,v178
 v_accvgpr_write_b32 a51,v179
 v_accvgpr_write_b32 a52,v180
 v_accvgpr_write_b32 a53,v181
 v_accvgpr_write_b32 a54,v182
 v_accvgpr_write_b32 a55,v183
 v_accvgpr_read_b32 v176,a56
 v_accvgpr_read_b32 v177,a57
 v_accvgpr_read_b32 v178,a58
 v_accvgpr_read_b32 v179,a59
 v_accvgpr_read_b32 v180,a60
 v_accvgpr_read_b32 v181,a61
 v_accvgpr_read_b32 v182,a62
 v_accvgpr_read_b32 v183,a63
 v_mul_f32 v176,v176,v202
 v_mul_f32 v177,v177,v202
 v_mul_f32 v178,v178,v202
 v_mul_f32 v179,v179,v202
 v_mul_f32 v180,v180,v202
 v_mul_f32 v181,v181,v202
 v_mul_f32 v182,v182,v202
 v_mul_f32 v183,v183,v202
 v_accvgpr_write_b32 a56,v176
 v_accvgpr_write_b32 a57,v177
 v_accvgpr_write_b32 a58,v178
 v_accvgpr_write_b32 a59,v179
 v_accvgpr_write_b32 a60,v180
 v_accvgpr_write_b32 a61,v181
 v_accvgpr_write_b32 a62,v182
 v_accvgpr_write_b32 a63,v183
 s_sub_u32 s79,15,s66
 s_lshl_b32 s79,s79,7
 s_sub_u32 s79,s79,s75
 v_add_u32 v206,s79,v204
 v_cmp_le_i32 s[84:85],0,v206
 v_cmp_le_i32 s[86:87],1,v206
 v_cmp_le_i32 s[88:89],2,v206
 v_cmp_le_i32 s[98:99],3,v206
 v_cndmask_b32 v16,v205,v16,s[84:85]
 v_cndmask_b32 v17,v205,v17,s[86:87]
 v_cndmask_b32 v18,v205,v18,s[88:89]
 v_cndmask_b32 v19,v205,v19,s[98:99]
 v_cmp_le_i32 s[84:85],8,v206
 v_cmp_le_i32 s[86:87],9,v206
 v_cmp_le_i32 s[88:89],10,v206
 v_cmp_le_i32 s[98:99],11,v206
 v_cndmask_b32 v20,v205,v20,s[84:85]
 v_cndmask_b32 v21,v205,v21,s[86:87]
 v_cndmask_b32 v22,v205,v22,s[88:89]
 v_cndmask_b32 v23,v205,v23,s[98:99]
 v_cmp_le_i32 s[84:85],16,v206
 v_cmp_le_i32 s[86:87],17,v206
 v_cmp_le_i32 s[88:89],18,v206
 v_cmp_le_i32 s[98:99],19,v206
 v_cndmask_b32 v24,v205,v24,s[84:85]
 v_cndmask_b32 v25,v205,v25,s[86:87]
 v_cndmask_b32 v26,v205,v26,s[88:89]
 v_cndmask_b32 v27,v205,v27,s[98:99]
 v_cmp_le_i32 s[84:85],24,v206
 v_cmp_le_i32 s[86:87],25,v206
 v_cmp_le_i32 s[88:89],26,v206
 v_cmp_le_i32 s[98:99],27,v206
 v_cndmask_b32 v28,v205,v28,s[84:85]
 v_cndmask_b32 v29,v205,v29,s[86:87]
 v_cndmask_b32 v30,v205,v30,s[88:89]
 v_cndmask_b32 v31,v205,v31,s[98:99]
 v_add_u32 v206,s79,v204
 v_subrev_u32 v206,32,v206
 v_cmp_le_i32 s[84:85],0,v206
 v_cmp_le_i32 s[86:87],1,v206
 v_cmp_le_i32 s[88:89],2,v206
 v_cmp_le_i32 s[98:99],3,v206
 v_cndmask_b32 v48,v205,v48,s[84:85]
 v_cndmask_b32 v49,v205,v49,s[86:87]
 v_cndmask_b32 v50,v205,v50,s[88:89]
 v_cndmask_b32 v51,v205,v51,s[98:99]
 v_cmp_le_i32 s[84:85],8,v206
 v_cmp_le_i32 s[86:87],9,v206
 v_cmp_le_i32 s[88:89],10,v206
 v_cmp_le_i32 s[98:99],11,v206
 v_cndmask_b32 v52,v205,v52,s[84:85]
 v_cndmask_b32 v53,v205,v53,s[86:87]
 v_cndmask_b32 v54,v205,v54,s[88:89]
 v_cndmask_b32 v55,v205,v55,s[98:99]
 v_cmp_le_i32 s[84:85],16,v206
 v_cmp_le_i32 s[86:87],17,v206
 v_cmp_le_i32 s[88:89],18,v206
 v_cmp_le_i32 s[98:99],19,v206
 v_cndmask_b32 v56,v205,v56,s[84:85]
 v_cndmask_b32 v57,v205,v57,s[86:87]
 v_cndmask_b32 v58,v205,v58,s[88:89]
 v_cndmask_b32 v59,v205,v59,s[98:99]
 v_cmp_le_i32 s[84:85],24,v206
 v_cmp_le_i32 s[86:87],25,v206
 v_cmp_le_i32 s[88:89],26,v206
 v_cmp_le_i32 s[98:99],27,v206
 v_cndmask_b32 v60,v205,v60,s[84:85]
 v_cndmask_b32 v61,v205,v61,s[86:87]
 v_cndmask_b32 v62,v205,v62,s[88:89]
 v_cndmask_b32 v63,v205,v63,s[98:99]
 v_max3_f32 v201,v16,v17,v18
 v_max3_f32 v201,v201,v19,v20
 v_max3_f32 v201,v201,v21,v22
 v_max3_f32 v201,v201,v23,v24
 v_max3_f32 v201,v201,v25,v26
 v_max3_f32 v201,v201,v27,v28
 v_max3_f32 v201,v201,v29,v30
 v_max_f32 v201,v201,v31
 v_max3_f32 v201,v201,v48,v49
 v_max3_f32 v201,v201,v50,v51
 v_max3_f32 v201,v201,v52,v53
 v_max3_f32 v201,v201,v54,v55
 v_max3_f32 v201,v201,v56,v57
 v_max3_f32 v201,v201,v58,v59
 v_max3_f32 v201,v201,v60,v61
 v_max3_f32 v201,v201,v62,v63
 v_mov_b32 v206,v201
 s_nop 1
 v_permlane32_swap_b32 v201,v206
 v_max_f32 v201,v201,v206
 v_max_f32 v201,0,v201
 v_exp_f32 v203,-v201
 v_sub_f32 v16,v16,v201
 v_sub_f32 v17,v17,v201
 v_sub_f32 v18,v18,v201
 v_sub_f32 v19,v19,v201
 v_sub_f32 v20,v20,v201
 v_sub_f32 v21,v21,v201
 v_sub_f32 v22,v22,v201
 v_sub_f32 v23,v23,v201
 v_sub_f32 v24,v24,v201
 v_sub_f32 v25,v25,v201
 v_sub_f32 v26,v26,v201
 v_sub_f32 v27,v27,v201
 v_sub_f32 v28,v28,v201
 v_sub_f32 v29,v29,v201
 v_sub_f32 v30,v30,v201
 v_sub_f32 v31,v31,v201
 v_sub_f32 v48,v48,v201
 v_sub_f32 v49,v49,v201
 v_sub_f32 v50,v50,v201
 v_sub_f32 v51,v51,v201
 v_sub_f32 v52,v52,v201
 v_sub_f32 v53,v53,v201
 v_sub_f32 v54,v54,v201
 v_sub_f32 v55,v55,v201
 v_sub_f32 v56,v56,v201
 v_sub_f32 v57,v57,v201
 v_sub_f32 v58,v58,v201
 v_sub_f32 v59,v59,v201
 v_sub_f32 v60,v60,v201
 v_sub_f32 v61,v61,v201
 v_sub_f32 v62,v62,v201
 v_sub_f32 v63,v63,v201
 v_sub_f32 v144,v144,v201
 v_sub_f32 v145,v145,v201
 v_sub_f32 v146,v146,v201
 v_sub_f32 v147,v147,v201
 v_sub_f32 v148,v148,v201
 v_sub_f32 v149,v149,v201
 v_sub_f32 v150,v150,v201
 v_sub_f32 v151,v151,v201
 v_sub_f32 v152,v152,v201
 v_sub_f32 v153,v153,v201
 v_sub_f32 v154,v154,v201
 v_sub_f32 v155,v155,v201
 v_sub_f32 v156,v156,v201
 v_sub_f32 v157,v157,v201
 v_sub_f32 v158,v158,v201
 v_sub_f32 v159,v159,v201
 v_mul_f32 v198,v198,v203
 v_exp_f32 v16,v16
 v_exp_f32 v17,v17
 v_exp_f32 v18,v18
 v_add_f32 v199,v16,v17
 v_exp_f32 v19,v19
 v_cvt_pk_bf16_f32 v16,v16,v17
 v_exp_f32 v20,v20
 v_add_f32 v199,v199,v18
 v_exp_f32 v21,v21
 v_cvt_pk_bf16_f32 v17,v18,v19
 v_add_f32 v199,v199,v19
 v_exp_f32 v22,v22
 v_add_f32 v199,v199,v20
 v_exp_f32 v23,v23
 v_cvt_pk_bf16_f32 v18,v20,v21
 v_add_f32 v199,v199,v21
 v_exp_f32 v24,v24
 v_add_f32 v199,v199,v22
 v_exp_f32 v25,v25
 v_cvt_pk_bf16_f32 v19,v22,v23
 v_add_f32 v199,v199,v23
 v_exp_f32 v26,v26
 v_add_f32 v199,v199,v24
 v_exp_f32 v27,v27
 v_add_f32 v199,v199,v25
 v_cvt_pk_bf16_f32 v24,v24,v25
 v_exp_f32 v28,v28
 v_add_f32 v199,v199,v26
 v_exp_f32 v29,v29
 v_cvt_pk_bf16_f32 v25,v26,v27
 v_add_f32 v199,v199,v27
 v_exp_f32 v30,v30
 v_add_f32 v199,v199,v28
 v_exp_f32 v31,v31
 v_cvt_pk_bf16_f32 v26,v28,v29
 v_add_f32 v199,v199,v29
 v_add_f32 v199,v199,v30
 v_cvt_pk_bf16_f32 v27,v30,v31
 v_add_f32 v199,v199,v31
 v_exp_f32 v48,v48
 v_exp_f32 v49,v49
 v_exp_f32 v50,v50
 v_add_f32 v199,v199,v48
 v_exp_f32 v51,v51
 v_add_f32 v199,v199,v49
 v_cvt_pk_bf16_f32 v48,v48,v49
 v_exp_f32 v52,v52
 v_add_f32 v199,v199,v50
 v_exp_f32 v53,v53
 v_cvt_pk_bf16_f32 v49,v50,v51
 v_add_f32 v199,v199,v51
 v_exp_f32 v54,v54
 v_add_f32 v199,v199,v52
 v_exp_f32 v55,v55
 v_cvt_pk_bf16_f32 v50,v52,v53
 v_add_f32 v199,v199,v53
 v_exp_f32 v56,v56
 v_add_f32 v199,v199,v54
 v_exp_f32 v57,v57
 v_cvt_pk_bf16_f32 v51,v54,v55
 v_add_f32 v199,v199,v55
 v_exp_f32 v58,v58
 v_add_f32 v199,v199,v56
 v_exp_f32 v59,v59
 v_add_f32 v199,v199,v57
 v_cvt_pk_bf16_f32 v56,v56,v57
 v_exp_f32 v60,v60
 v_add_f32 v199,v199,v58
 v_exp_f32 v61,v61
 v_cvt_pk_bf16_f32 v57,v58,v59
 v_add_f32 v199,v199,v59
 v_exp_f32 v62,v62
 v_add_f32 v199,v199,v60
 v_exp_f32 v63,v63
 v_cvt_pk_bf16_f32 v58,v60,v61
 v_add_f32 v199,v199,v61
 v_add_f32 v199,v199,v62
 v_cvt_pk_bf16_f32 v59,v62,v63
 v_add_f32 v199,v199,v63
 v_accvgpr_read_b32 v176,a64
 v_accvgpr_read_b32 v177,a65
 v_accvgpr_read_b32 v178,a66
 v_accvgpr_read_b32 v179,a67
 v_accvgpr_read_b32 v180,a68
 v_accvgpr_read_b32 v181,a69
 v_accvgpr_read_b32 v182,a70
 v_accvgpr_read_b32 v183,a71
 v_mul_f32 v176,v176,v203
 v_mul_f32 v177,v177,v203
 v_mul_f32 v178,v178,v203
 v_mul_f32 v179,v179,v203
 v_mul_f32 v180,v180,v203
 v_mul_f32 v181,v181,v203
 v_mul_f32 v182,v182,v203
 v_mul_f32 v183,v183,v203
 v_accvgpr_write_b32 a64,v176
 v_accvgpr_write_b32 a65,v177
 v_accvgpr_write_b32 a66,v178
 v_accvgpr_write_b32 a67,v179
 v_accvgpr_write_b32 a68,v180
 v_accvgpr_write_b32 a69,v181
 v_accvgpr_write_b32 a70,v182
 v_accvgpr_write_b32 a71,v183
 v_accvgpr_read_b32 v176,a72
 v_accvgpr_read_b32 v177,a73
 v_accvgpr_read_b32 v178,a74
 v_accvgpr_read_b32 v179,a75
 v_accvgpr_read_b32 v180,a76
 v_accvgpr_read_b32 v181,a77
 v_accvgpr_read_b32 v182,a78
 v_accvgpr_read_b32 v183,a79
 v_mul_f32 v176,v176,v203
 v_mul_f32 v177,v177,v203
 v_mul_f32 v178,v178,v203
 v_mul_f32 v179,v179,v203
 v_mul_f32 v180,v180,v203
 v_mul_f32 v181,v181,v203
 v_mul_f32 v182,v182,v203
 v_mul_f32 v183,v183,v203
 v_accvgpr_write_b32 a72,v176
 v_accvgpr_write_b32 a73,v177
 v_accvgpr_write_b32 a74,v178
 v_accvgpr_write_b32 a75,v179
 v_accvgpr_write_b32 a76,v180
 v_accvgpr_write_b32 a77,v181
 v_accvgpr_write_b32 a78,v182
 v_accvgpr_write_b32 a79,v183
 v_accvgpr_read_b32 v176,a80
 v_accvgpr_read_b32 v177,a81
 v_accvgpr_read_b32 v178,a82
 v_accvgpr_read_b32 v179,a83
 v_accvgpr_read_b32 v180,a84
 v_accvgpr_read_b32 v181,a85
 v_accvgpr_read_b32 v182,a86
 v_accvgpr_read_b32 v183,a87
 v_mul_f32 v176,v176,v203
 v_mul_f32 v177,v177,v203
 v_mul_f32 v178,v178,v203
 v_mul_f32 v179,v179,v203
 v_mul_f32 v180,v180,v203
 v_mul_f32 v181,v181,v203
 v_mul_f32 v182,v182,v203
 v_mul_f32 v183,v183,v203
 v_accvgpr_write_b32 a80,v176
 v_accvgpr_write_b32 a81,v177
 v_accvgpr_write_b32 a82,v178
 v_accvgpr_write_b32 a83,v179
 v_accvgpr_write_b32 a84,v180
 v_accvgpr_write_b32 a85,v181
 v_accvgpr_write_b32 a86,v182
 v_accvgpr_write_b32 a87,v183
 v_accvgpr_read_b32 v176,a88
 v_accvgpr_read_b32 v177,a89
 v_accvgpr_read_b32 v178,a90
 v_accvgpr_read_b32 v179,a91
 v_accvgpr_read_b32 v180,a92
 v_accvgpr_read_b32 v181,a93
 v_accvgpr_read_b32 v182,a94
 v_accvgpr_read_b32 v183,a95
 v_mul_f32 v176,v176,v203
 v_mul_f32 v177,v177,v203
 v_mul_f32 v178,v178,v203
 v_mul_f32 v179,v179,v203
 v_mul_f32 v180,v180,v203
 v_mul_f32 v181,v181,v203
 v_mul_f32 v182,v182,v203
 v_mul_f32 v183,v183,v203
 v_accvgpr_write_b32 a88,v176
 v_accvgpr_write_b32 a89,v177
 v_accvgpr_write_b32 a90,v178
 v_accvgpr_write_b32 a91,v179
 v_accvgpr_write_b32 a92,v180
 v_accvgpr_write_b32 a93,v181
 v_accvgpr_write_b32 a94,v182
 v_accvgpr_write_b32 a95,v183
 v_accvgpr_read_b32 v176,a96
 v_accvgpr_read_b32 v177,a97
 v_accvgpr_read_b32 v178,a98
 v_accvgpr_read_b32 v179,a99
 v_accvgpr_read_b32 v180,a100
 v_accvgpr_read_b32 v181,a101
 v_accvgpr_read_b32 v182,a102
 v_accvgpr_read_b32 v183,a103
 v_mul_f32 v176,v176,v203
 v_mul_f32 v177,v177,v203
 v_mul_f32 v178,v178,v203
 v_mul_f32 v179,v179,v203
 v_mul_f32 v180,v180,v203
 v_mul_f32 v181,v181,v203
 v_mul_f32 v182,v182,v203
 v_mul_f32 v183,v183,v203
 v_accvgpr_write_b32 a96,v176
 v_accvgpr_write_b32 a97,v177
 v_accvgpr_write_b32 a98,v178
 v_accvgpr_write_b32 a99,v179
 v_accvgpr_write_b32 a100,v180
 v_accvgpr_write_b32 a101,v181
 v_accvgpr_write_b32 a102,v182
 v_accvgpr_write_b32 a103,v183
 v_accvgpr_read_b32 v176,a104
 v_accvgpr_read_b32 v177,a105
 v_accvgpr_read_b32 v178,a106
 v_accvgpr_read_b32 v179,a107
 v_accvgpr_read_b32 v180,a108
 v_accvgpr_read_b32 v181,a109
 v_accvgpr_read_b32 v182,a110
 v_accvgpr_read_b32 v183,a111
 v_mul_f32 v176,v176,v203
 v_mul_f32 v177,v177,v203
 v_mul_f32 v178,v178,v203
 v_mul_f32 v179,v179,v203
 v_mul_f32 v180,v180,v203
 v_mul_f32 v181,v181,v203
 v_mul_f32 v182,v182,v203
 v_mul_f32 v183,v183,v203
 v_accvgpr_write_b32 a104,v176
 v_accvgpr_write_b32 a105,v177
 v_accvgpr_write_b32 a106,v178
 v_accvgpr_write_b32 a107,v179
 v_accvgpr_write_b32 a108,v180
 v_accvgpr_write_b32 a109,v181
 v_accvgpr_write_b32 a110,v182
 v_accvgpr_write_b32 a111,v183
 v_accvgpr_read_b32 v176,a112
 v_accvgpr_read_b32 v177,a113
 v_accvgpr_read_b32 v178,a114
 v_accvgpr_read_b32 v179,a115
 v_accvgpr_read_b32 v180,a116
 v_accvgpr_read_b32 v181,a117
 v_accvgpr_read_b32 v182,a118
 v_accvgpr_read_b32 v183,a119
 v_mul_f32 v176,v176,v203
 v_mul_f32 v177,v177,v203
 v_mul_f32 v178,v178,v203
 v_mul_f32 v179,v179,v203
 v_mul_f32 v180,v180,v203
 v_mul_f32 v181,v181,v203
 v_mul_f32 v182,v182,v203
 v_mul_f32 v183,v183,v203
 v_accvgpr_write_b32 a112,v176
 v_accvgpr_write_b32 a113,v177
 v_accvgpr_write_b32 a114,v178
 v_accvgpr_write_b32 a115,v179
 v_accvgpr_write_b32 a116,v180
 v_accvgpr_write_b32 a117,v181
 v_accvgpr_write_b32 a118,v182
 v_accvgpr_write_b32 a119,v183
 v_accvgpr_read_b32 v176,a120
 v_accvgpr_read_b32 v177,a121
 v_accvgpr_read_b32 v178,a122
 v_accvgpr_read_b32 v179,a123
 v_accvgpr_read_b32 v180,a124
 v_accvgpr_read_b32 v181,a125
 v_accvgpr_read_b32 v182,a126
 v_accvgpr_read_b32 v183,a127
 v_mul_f32 v176,v176,v203
 v_mul_f32 v177,v177,v203
 v_mul_f32 v178,v178,v203
 v_mul_f32 v179,v179,v203
 v_mul_f32 v180,v180,v203
 v_mul_f32 v181,v181,v203
 v_mul_f32 v182,v182,v203
 v_mul_f32 v183,v183,v203
 v_accvgpr_write_b32 a120,v176
 v_accvgpr_write_b32 a121,v177
 v_accvgpr_write_b32 a122,v178
 v_accvgpr_write_b32 a123,v179
 v_accvgpr_write_b32 a124,v180
 v_accvgpr_write_b32 a125,v181
 v_accvgpr_write_b32 a126,v182
 v_accvgpr_write_b32 a127,v183
 s_nop 1
 s_setpc_b64 s[100:101]
F_RA1:
 s_nop 15
 s_mul_i32 s70,s75,272
 s_add_u32 s79,s70,0
 buffer_load_dwordx4 v[176:179],v224,s[36:39],s79 offen offset:0 sc1
 buffer_load_dwordx4 v[180:183],v224,s[36:39],s79 offen offset:1024 sc1
 buffer_load_dwordx4 v[184:187],v224,s[36:39],s79 offen offset:2048 sc1
 buffer_load_dwordx4 v[188:191],v224,s[36:39],s79 offen offset:3072 sc1
 s_waitcnt vmcnt(0)
 N v[64:79],v[176:179],a[128:131],v[128:143]
 N v[80:95],v[176:179],a[160:163],v[144:159]
 N v[64:79],v[180:183],a[132:135],v[64:79]
 N v[80:95],v[180:183],a[164:167],v[80:95]
 N v[64:79],v[184:187],a[136:139],v[64:79]
 N v[80:95],v[184:187],a[168:171],v[80:95]
 N v[64:79],v[188:191],a[140:143],v[64:79]
 N v[80:95],v[188:191],a[172:175],v[80:95]
 s_nop 7
 s_add_u32 s79,s70,4096
 buffer_load_dwordx4 v[176:179],v224,s[36:39],s79 offen offset:0 sc1
 buffer_load_dwordx4 v[180:183],v224,s[36:39],s79 offen offset:1024 sc1
 buffer_load_dwordx4 v[184:187],v224,s[36:39],s79 offen offset:2048 sc1
 buffer_load_dwordx4 v[188:191],v224,s[36:39],s79 offen offset:3072 sc1
 s_waitcnt vmcnt(0)
 N v[64:79],v[176:179],a[144:147],v[64:79]
 N v[80:95],v[176:179],a[176:179],v[80:95]
 N v[64:79],v[180:183],a[148:151],v[64:79]
 N v[80:95],v[180:183],a[180:183],v[80:95]
 N v[64:79],v[184:187],a[152:155],v[64:79]
 N v[80:95],v[184:187],a[184:187],v[80:95]
 N v[64:79],v[188:191],a[156:159],v[64:79]
 N v[80:95],v[188:191],a[188:191],v[80:95]
 s_nop 7
 s_add_u32 s79,s70,8192
 buffer_load_dwordx4 v[176:179],v224,s[36:39],s79 offen offset:0 sc1
 buffer_load_dwordx4 v[180:183],v224,s[36:39],s79 offen offset:1024 sc1
 buffer_load_dwordx4 v[184:187],v224,s[36:39],s79 offen offset:2048 sc1
 buffer_load_dwordx4 v[188:191],v224,s[36:39],s79 offen offset:3072 sc1
 s_waitcnt vmcnt(0)
 N v[96:111],v[176:179],a[128:131],v[128:143]
 N v[112:127],v[176:179],a[160:163],v[144:159]
 N v[96:111],v[180:183],a[132:135],v[96:111]
 N v[112:127],v[180:183],a[164:167],v[112:127]
 N v[96:111],v[184:187],a[136:139],v[96:111]
 N v[112:127],v[184:187],a[168:171],v[112:127]
 N v[96:111],v[188:191],a[140:143],v[96:111]
 N v[112:127],v[188:191],a[172:175],v[112:127]
 s_nop 7
 s_add_u32 s79,s70,12288
 buffer_load_dwordx4 v[176:179],v224,s[36:39],s79 offen offset:0 sc1
 buffer_load_dwordx4 v[180:183],v224,s[36:39],s79 offen offset:1024 sc1
 buffer_load_dwordx4 v[184:187],v224,s[36:39],s79 offen offset:2048 sc1
 buffer_load_dwordx4 v[188:191],v224,s[36:39],s79 offen offset:3072 sc1
 s_waitcnt vmcnt(0)
 N v[96:111],v[176:179],a[144:147],v[96:111]
 N v[112:127],v[176:179],a[176:179],v[112:127]
 N v[96:111],v[180:183],a[148:151],v[96:111]
 N v[112:127],v[180:183],a[180:183],v[112:127]
 N v[96:111],v[184:187],a[152:155],v[96:111]
 N v[112:127],v[184:187],a[184:187],v[112:127]
 N v[96:111],v[188:191],a[156:159],v[96:111]
 N v[112:127],v[188:191],a[188:191],v[112:127]
 s_nop 7
 s_lshl_b32 s79,s66,7
 s_sub_u32 s79,s79,s75
 v_add_u32 v206,s79,v204
 v_cmp_le_i32 s[84:85],0,v206
 v_cmp_le_i32 s[86:87],1,v206
 v_cmp_le_i32 s[88:89],2,v206
 v_cmp_le_i32 s[98:99],3,v206
 v_cndmask_b32 v64,v205,v64,s[84:85]
 v_cndmask_b32 v65,v205,v65,s[86:87]
 v_cndmask_b32 v66,v205,v66,s[88:89]
 v_cndmask_b32 v67,v205,v67,s[98:99]
 v_cmp_le_i32 s[84:85],8,v206
 v_cmp_le_i32 s[86:87],9,v206
 v_cmp_le_i32 s[88:89],10,v206
 v_cmp_le_i32 s[98:99],11,v206
 v_cndmask_b32 v68,v205,v68,s[84:85]
 v_cndmask_b32 v69,v205,v69,s[86:87]
 v_cndmask_b32 v70,v205,v70,s[88:89]
 v_cndmask_b32 v71,v205,v71,s[98:99]
 v_cmp_le_i32 s[84:85],16,v206
 v_cmp_le_i32 s[86:87],17,v206
 v_cmp_le_i32 s[88:89],18,v206
 v_cmp_le_i32 s[98:99],19,v206
 v_cndmask_b32 v72,v205,v72,s[84:85]
 v_cndmask_b32 v73,v205,v73,s[86:87]
 v_cndmask_b32 v74,v205,v74,s[88:89]
 v_cndmask_b32 v75,v205,v75,s[98:99]
 v_cmp_le_i32 s[84:85],24,v206
 v_cmp_le_i32 s[86:87],25,v206
 v_cmp_le_i32 s[88:89],26,v206
 v_cmp_le_i32 s[98:99],27,v206
 v_cndmask_b32 v76,v205,v76,s[84:85]
 v_cndmask_b32 v77,v205,v77,s[86:87]
 v_cndmask_b32 v78,v205,v78,s[88:89]
 v_cndmask_b32 v79,v205,v79,s[98:99]
 v_add_u32 v206,s79,v204
 v_subrev_u32 v206,32,v206
 v_cmp_le_i32 s[84:85],0,v206
 v_cmp_le_i32 s[86:87],1,v206
 v_cmp_le_i32 s[88:89],2,v206
 v_cmp_le_i32 s[98:99],3,v206
 v_cndmask_b32 v96,v205,v96,s[84:85]
 v_cndmask_b32 v97,v205,v97,s[86:87]
 v_cndmask_b32 v98,v205,v98,s[88:89]
 v_cndmask_b32 v99,v205,v99,s[98:99]
 v_cmp_le_i32 s[84:85],8,v206
 v_cmp_le_i32 s[86:87],9,v206
 v_cmp_le_i32 s[88:89],10,v206
 v_cmp_le_i32 s[98:99],11,v206
 v_cndmask_b32 v100,v205,v100,s[84:85]
 v_cndmask_b32 v101,v205,v101,s[86:87]
 v_cndmask_b32 v102,v205,v102,s[88:89]
 v_cndmask_b32 v103,v205,v103,s[98:99]
 v_cmp_le_i32 s[84:85],16,v206
 v_cmp_le_i32 s[86:87],17,v206
 v_cmp_le_i32 s[88:89],18,v206
 v_cmp_le_i32 s[98:99],19,v206
 v_cndmask_b32 v104,v205,v104,s[84:85]
 v_cndmask_b32 v105,v205,v105,s[86:87]
 v_cndmask_b32 v106,v205,v106,s[88:89]
 v_cndmask_b32 v107,v205,v107,s[98:99]
 v_cmp_le_i32 s[84:85],24,v206
 v_cmp_le_i32 s[86:87],25,v206
 v_cmp_le_i32 s[88:89],26,v206
 v_cmp_le_i32 s[98:99],27,v206
 v_cndmask_b32 v108,v205,v108,s[84:85]
 v_cndmask_b32 v109,v205,v109,s[86:87]
 v_cndmask_b32 v110,v205,v110,s[88:89]
 v_cndmask_b32 v111,v205,v111,s[98:99]
 v_max3_f32 v200,v64,v65,v66
 v_max3_f32 v200,v200,v67,v68
 v_max3_f32 v200,v200,v69,v70
 v_max3_f32 v200,v200,v71,v72
 v_max3_f32 v200,v200,v73,v74
 v_max3_f32 v200,v200,v75,v76
 v_max3_f32 v200,v200,v77,v78
 v_max_f32 v200,v200,v79
 v_max3_f32 v200,v200,v96,v97
 v_max3_f32 v200,v200,v98,v99
 v_max3_f32 v200,v200,v100,v101
 v_max3_f32 v200,v200,v102,v103
 v_max3_f32 v200,v200,v104,v105
 v_max3_f32 v200,v200,v106,v107
 v_max3_f32 v200,v200,v108,v109
 v_max3_f32 v200,v200,v110,v111
 v_mov_b32 v206,v200
 s_nop 1
 v_permlane32_swap_b32 v200,v206
 v_max_f32 v200,v200,v206
 v_max_f32 v200,0,v200
 v_exp_f32 v202,-v200
 v_sub_f32 v64,v64,v200
 v_sub_f32 v65,v65,v200
 v_sub_f32 v66,v66,v200
 v_sub_f32 v67,v67,v200
 v_sub_f32 v68,v68,v200
 v_sub_f32 v69,v69,v200
 v_sub_f32 v70,v70,v200
 v_sub_f32 v71,v71,v200
 v_sub_f32 v72,v72,v200
 v_sub_f32 v73,v73,v200
 v_sub_f32 v74,v74,v200
 v_sub_f32 v75,v75,v200
 v_sub_f32 v76,v76,v200
 v_sub_f32 v77,v77,v200
 v_sub_f32 v78,v78,v200
 v_sub_f32 v79,v79,v200
 v_sub_f32 v96,v96,v200
 v_sub_f32 v97,v97,v200
 v_sub_f32 v98,v98,v200
 v_sub_f32 v99,v99,v200
 v_sub_f32 v100,v100,v200
 v_sub_f32 v101,v101,v200
 v_sub_f32 v102,v102,v200
 v_sub_f32 v103,v103,v200
 v_sub_f32 v104,v104,v200
 v_sub_f32 v105,v105,v200
 v_sub_f32 v106,v106,v200
 v_sub_f32 v107,v107,v200
 v_sub_f32 v108,v108,v200
 v_sub_f32 v109,v109,v200
 v_sub_f32 v110,v110,v200
 v_sub_f32 v111,v111,v200
 v_sub_f32 v128,v128,v200
 v_sub_f32 v129,v129,v200
 v_sub_f32 v130,v130,v200
 v_sub_f32 v131,v131,v200
 v_sub_f32 v132,v132,v200
 v_sub_f32 v133,v133,v200
 v_sub_f32 v134,v134,v200
 v_sub_f32 v135,v135,v200
 v_sub_f32 v136,v136,v200
 v_sub_f32 v137,v137,v200
 v_sub_f32 v138,v138,v200
 v_sub_f32 v139,v139,v200
 v_sub_f32 v140,v140,v200
 v_sub_f32 v141,v141,v200
 v_sub_f32 v142,v142,v200
 v_sub_f32 v143,v143,v200
 v_mul_f32 v196,v196,v202
 v_exp_f32 v64,v64
 v_exp_f32 v65,v65
 v_exp_f32 v66,v66
 v_add_f32 v197,v64,v65
 v_exp_f32 v67,v67
 v_cvt_pk_bf16_f32 v64,v64,v65
 v_exp_f32 v68,v68
 v_add_f32 v197,v197,v66
 v_exp_f32 v69,v69
 v_cvt_pk_bf16_f32 v65,v66,v67
 v_add_f32 v197,v197,v67
 v_exp_f32 v70,v70
 v_add_f32 v197,v197,v68
 v_exp_f32 v71,v71
 v_cvt_pk_bf16_f32 v66,v68,v69
 v_add_f32 v197,v197,v69
 v_exp_f32 v72,v72
 v_add_f32 v197,v197,v70
 v_exp_f32 v73,v73
 v_cvt_pk_bf16_f32 v67,v70,v71
 v_add_f32 v197,v197,v71
 v_exp_f32 v74,v74
 v_add_f32 v197,v197,v72
 v_exp_f32 v75,v75
 v_add_f32 v197,v197,v73
 v_cvt_pk_bf16_f32 v72,v72,v73
 v_exp_f32 v76,v76
 v_add_f32 v197,v197,v74
 v_exp_f32 v77,v77
 v_cvt_pk_bf16_f32 v73,v74,v75
 v_add_f32 v197,v197,v75
 v_exp_f32 v78,v78
 v_add_f32 v197,v197,v76
 v_exp_f32 v79,v79
 v_cvt_pk_bf16_f32 v74,v76,v77
 v_add_f32 v197,v197,v77
 v_add_f32 v197,v197,v78
 v_cvt_pk_bf16_f32 v75,v78,v79
 v_add_f32 v197,v197,v79
 v_exp_f32 v96,v96
 v_exp_f32 v97,v97
 v_exp_f32 v98,v98
 v_add_f32 v197,v197,v96
 v_exp_f32 v99,v99
 v_add_f32 v197,v197,v97
 v_cvt_pk_bf16_f32 v96,v96,v97
 v_exp_f32 v100,v100
 v_add_f32 v197,v197,v98
 v_exp_f32 v101,v101
 v_cvt_pk_bf16_f32 v97,v98,v99
 v_add_f32 v197,v197,v99
 v_exp_f32 v102,v102
 v_add_f32 v197,v197,v100
 v_exp_f32 v103,v103
 v_cvt_pk_bf16_f32 v98,v100,v101
 v_add_f32 v197,v197,v101
 v_exp_f32 v104,v104
 v_add_f32 v197,v197,v102
 v_exp_f32 v105,v105
 v_cvt_pk_bf16_f32 v99,v102,v103
 v_add_f32 v197,v197,v103
 v_exp_f32 v106,v106
 v_add_f32 v197,v197,v104
 v_exp_f32 v107,v107
 v_add_f32 v197,v197,v105
 v_cvt_pk_bf16_f32 v104,v104,v105
 v_exp_f32 v108,v108
 v_add_f32 v197,v197,v106
 v_exp_f32 v109,v109
 v_cvt_pk_bf16_f32 v105,v106,v107
 v_add_f32 v197,v197,v107
 v_exp_f32 v110,v110
 v_add_f32 v197,v197,v108
 v_exp_f32 v111,v111
 v_cvt_pk_bf16_f32 v106,v108,v109
 v_add_f32 v197,v197,v109
 v_add_f32 v197,v197,v110
 v_cvt_pk_bf16_f32 v107,v110,v111
 v_add_f32 v197,v197,v111
 v_accvgpr_read_b32 v176,a0
 v_accvgpr_read_b32 v177,a1
 v_accvgpr_read_b32 v178,a2
 v_accvgpr_read_b32 v179,a3
 v_accvgpr_read_b32 v180,a4
 v_accvgpr_read_b32 v181,a5
 v_accvgpr_read_b32 v182,a6
 v_accvgpr_read_b32 v183,a7
 v_mul_f32 v176,v176,v202
 v_mul_f32 v177,v177,v202
 v_mul_f32 v178,v178,v202
 v_mul_f32 v179,v179,v202
 v_mul_f32 v180,v180,v202
 v_mul_f32 v181,v181,v202
 v_mul_f32 v182,v182,v202
 v_mul_f32 v183,v183,v202
 v_accvgpr_write_b32 a0,v176
 v_accvgpr_write_b32 a1,v177
 v_accvgpr_write_b32 a2,v178
 v_accvgpr_write_b32 a3,v179
 v_accvgpr_write_b32 a4,v180
 v_accvgpr_write_b32 a5,v181
 v_accvgpr_write_b32 a6,v182
 v_accvgpr_write_b32 a7,v183
 v_accvgpr_read_b32 v176,a8
 v_accvgpr_read_b32 v177,a9
 v_accvgpr_read_b32 v178,a10
 v_accvgpr_read_b32 v179,a11
 v_accvgpr_read_b32 v180,a12
 v_accvgpr_read_b32 v181,a13
 v_accvgpr_read_b32 v182,a14
 v_accvgpr_read_b32 v183,a15
 v_mul_f32 v176,v176,v202
 v_mul_f32 v177,v177,v202
 v_mul_f32 v178,v178,v202
 v_mul_f32 v179,v179,v202
 v_mul_f32 v180,v180,v202
 v_mul_f32 v181,v181,v202
 v_mul_f32 v182,v182,v202
 v_mul_f32 v183,v183,v202
 v_accvgpr_write_b32 a8,v176
 v_accvgpr_write_b32 a9,v177
 v_accvgpr_write_b32 a10,v178
 v_accvgpr_write_b32 a11,v179
 v_accvgpr_write_b32 a12,v180
 v_accvgpr_write_b32 a13,v181
 v_accvgpr_write_b32 a14,v182
 v_accvgpr_write_b32 a15,v183
 v_accvgpr_read_b32 v176,a16
 v_accvgpr_read_b32 v177,a17
 v_accvgpr_read_b32 v178,a18
 v_accvgpr_read_b32 v179,a19
 v_accvgpr_read_b32 v180,a20
 v_accvgpr_read_b32 v181,a21
 v_accvgpr_read_b32 v182,a22
 v_accvgpr_read_b32 v183,a23
 v_mul_f32 v176,v176,v202
 v_mul_f32 v177,v177,v202
 v_mul_f32 v178,v178,v202
 v_mul_f32 v179,v179,v202
 v_mul_f32 v180,v180,v202
 v_mul_f32 v181,v181,v202
 v_mul_f32 v182,v182,v202
 v_mul_f32 v183,v183,v202
 v_accvgpr_write_b32 a16,v176
 v_accvgpr_write_b32 a17,v177
 v_accvgpr_write_b32 a18,v178
 v_accvgpr_write_b32 a19,v179
 v_accvgpr_write_b32 a20,v180
 v_accvgpr_write_b32 a21,v181
 v_accvgpr_write_b32 a22,v182
 v_accvgpr_write_b32 a23,v183
 v_accvgpr_read_b32 v176,a24
 v_accvgpr_read_b32 v177,a25
 v_accvgpr_read_b32 v178,a26
 v_accvgpr_read_b32 v179,a27
 v_accvgpr_read_b32 v180,a28
 v_accvgpr_read_b32 v181,a29
 v_accvgpr_read_b32 v182,a30
 v_accvgpr_read_b32 v183,a31
 v_mul_f32 v176,v176,v202
 v_mul_f32 v177,v177,v202
 v_mul_f32 v178,v178,v202
 v_mul_f32 v179,v179,v202
 v_mul_f32 v180,v180,v202
 v_mul_f32 v181,v181,v202
 v_mul_f32 v182,v182,v202
 v_mul_f32 v183,v183,v202
 v_accvgpr_write_b32 a24,v176
 v_accvgpr_write_b32 a25,v177
 v_accvgpr_write_b32 a26,v178
 v_accvgpr_write_b32 a27,v179
 v_accvgpr_write_b32 a28,v180
 v_accvgpr_write_b32 a29,v181
 v_accvgpr_write_b32 a30,v182
 v_accvgpr_write_b32 a31,v183
 v_accvgpr_read_b32 v176,a32
 v_accvgpr_read_b32 v177,a33
 v_accvgpr_read_b32 v178,a34
 v_accvgpr_read_b32 v179,a35
 v_accvgpr_read_b32 v180,a36
 v_accvgpr_read_b32 v181,a37
 v_accvgpr_read_b32 v182,a38
 v_accvgpr_read_b32 v183,a39
 v_mul_f32 v176,v176,v202
 v_mul_f32 v177,v177,v202
 v_mul_f32 v178,v178,v202
 v_mul_f32 v179,v179,v202
 v_mul_f32 v180,v180,v202
 v_mul_f32 v181,v181,v202
 v_mul_f32 v182,v182,v202
 v_mul_f32 v183,v183,v202
 v_accvgpr_write_b32 a32,v176
 v_accvgpr_write_b32 a33,v177
 v_accvgpr_write_b32 a34,v178
 v_accvgpr_write_b32 a35,v179
 v_accvgpr_write_b32 a36,v180
 v_accvgpr_write_b32 a37,v181
 v_accvgpr_write_b32 a38,v182
 v_accvgpr_write_b32 a39,v183
 v_accvgpr_read_b32 v176,a40
 v_accvgpr_read_b32 v177,a41
 v_accvgpr_read_b32 v178,a42
 v_accvgpr_read_b32 v179,a43
 v_accvgpr_read_b32 v180,a44
 v_accvgpr_read_b32 v181,a45
 v_accvgpr_read_b32 v182,a46
 v_accvgpr_read_b32 v183,a47
 v_mul_f32 v176,v176,v202
 v_mul_f32 v177,v177,v202
 v_mul_f32 v178,v178,v202
 v_mul_f32 v179,v179,v202
 v_mul_f32 v180,v180,v202
 v_mul_f32 v181,v181,v202
 v_mul_f32 v182,v182,v202
 v_mul_f32 v183,v183,v202
 v_accvgpr_write_b32 a40,v176
 v_accvgpr_write_b32 a41,v177
 v_accvgpr_write_b32 a42,v178
 v_accvgpr_write_b32 a43,v179
 v_accvgpr_write_b32 a44,v180
 v_accvgpr_write_b32 a45,v181
 v_accvgpr_write_b32 a46,v182
 v_accvgpr_write_b32 a47,v183
 v_accvgpr_read_b32 v176,a48
 v_accvgpr_read_b32 v177,a49
 v_accvgpr_read_b32 v178,a50
 v_accvgpr_read_b32 v179,a51
 v_accvgpr_read_b32 v180,a52
 v_accvgpr_read_b32 v181,a53
 v_accvgpr_read_b32 v182,a54
 v_accvgpr_read_b32 v183,a55
 v_mul_f32 v176,v176,v202
 v_mul_f32 v177,v177,v202
 v_mul_f32 v178,v178,v202
 v_mul_f32 v179,v179,v202
 v_mul_f32 v180,v180,v202
 v_mul_f32 v181,v181,v202
 v_mul_f32 v182,v182,v202
 v_mul_f32 v183,v183,v202
 v_accvgpr_write_b32 a48,v176
 v_accvgpr_write_b32 a49,v177
 v_accvgpr_write_b32 a50,v178
 v_accvgpr_write_b32 a51,v179
 v_accvgpr_write_b32 a52,v180
 v_accvgpr_write_b32 a53,v181
 v_accvgpr_write_b32 a54,v182
 v_accvgpr_write_b32 a55,v183
 v_accvgpr_read_b32 v176,a56
 v_accvgpr_read_b32 v177,a57
 v_accvgpr_read_b32 v178,a58
 v_accvgpr_read_b32 v179,a59
 v_accvgpr_read_b32 v180,a60
 v_accvgpr_read_b32 v181,a61
 v_accvgpr_read_b32 v182,a62
 v_accvgpr_read_b32 v183,a63
 v_mul_f32 v176,v176,v202
 v_mul_f32 v177,v177,v202
 v_mul_f32 v178,v178,v202
 v_mul_f32 v179,v179,v202
 v_mul_f32 v180,v180,v202
 v_mul_f32 v181,v181,v202
 v_mul_f32 v182,v182,v202
 v_mul_f32 v183,v183,v202
 v_accvgpr_write_b32 a56,v176
 v_accvgpr_write_b32 a57,v177
 v_accvgpr_write_b32 a58,v178
 v_accvgpr_write_b32 a59,v179
 v_accvgpr_write_b32 a60,v180
 v_accvgpr_write_b32 a61,v181
 v_accvgpr_write_b32 a62,v182
 v_accvgpr_write_b32 a63,v183
 s_sub_u32 s79,15,s66
 s_lshl_b32 s79,s79,7
 s_sub_u32 s79,s79,s75
 v_add_u32 v206,s79,v204
 v_cmp_le_i32 s[84:85],0,v206
 v_cmp_le_i32 s[86:87],1,v206
 v_cmp_le_i32 s[88:89],2,v206
 v_cmp_le_i32 s[98:99],3,v206
 v_cndmask_b32 v80,v205,v80,s[84:85]
 v_cndmask_b32 v81,v205,v81,s[86:87]
 v_cndmask_b32 v82,v205,v82,s[88:89]
 v_cndmask_b32 v83,v205,v83,s[98:99]
 v_cmp_le_i32 s[84:85],8,v206
 v_cmp_le_i32 s[86:87],9,v206
 v_cmp_le_i32 s[88:89],10,v206
 v_cmp_le_i32 s[98:99],11,v206
 v_cndmask_b32 v84,v205,v84,s[84:85]
 v_cndmask_b32 v85,v205,v85,s[86:87]
 v_cndmask_b32 v86,v205,v86,s[88:89]
 v_cndmask_b32 v87,v205,v87,s[98:99]
 v_cmp_le_i32 s[84:85],16,v206
 v_cmp_le_i32 s[86:87],17,v206
 v_cmp_le_i32 s[88:89],18,v206
 v_cmp_le_i32 s[98:99],19,v206
 v_cndmask_b32 v88,v205,v88,s[84:85]
 v_cndmask_b32 v89,v205,v89,s[86:87]
 v_cndmask_b32 v90,v205,v90,s[88:89]
 v_cndmask_b32 v91,v205,v91,s[98:99]
 v_cmp_le_i32 s[84:85],24,v206
 v_cmp_le_i32 s[86:87],25,v206
 v_cmp_le_i32 s[88:89],26,v206
 v_cmp_le_i32 s[98:99],27,v206
 v_cndmask_b32 v92,v205,v92,s[84:85]
 v_cndmask_b32 v93,v205,v93,s[86:87]
 v_cndmask_b32 v94,v205,v94,s[88:89]
 v_cndmask_b32 v95,v205,v95,s[98:99]
 v_add_u32 v206,s79,v204
 v_subrev_u32 v206,32,v206
 v_cmp_le_i32 s[84:85],0,v206
 v_cmp_le_i32 s[86:87],1,v206
 v_cmp_le_i32 s[88:89],2,v206
 v_cmp_le_i32 s[98:99],3,v206
 v_cndmask_b32 v112,v205,v112,s[84:85]
 v_cndmask_b32 v113,v205,v113,s[86:87]
 v_cndmask_b32 v114,v205,v114,s[88:89]
 v_cndmask_b32 v115,v205,v115,s[98:99]
 v_cmp_le_i32 s[84:85],8,v206
 v_cmp_le_i32 s[86:87],9,v206
 v_cmp_le_i32 s[88:89],10,v206
 v_cmp_le_i32 s[98:99],11,v206
 v_cndmask_b32 v116,v205,v116,s[84:85]
 v_cndmask_b32 v117,v205,v117,s[86:87]
 v_cndmask_b32 v118,v205,v118,s[88:89]
 v_cndmask_b32 v119,v205,v119,s[98:99]
 v_cmp_le_i32 s[84:85],16,v206
 v_cmp_le_i32 s[86:87],17,v206
 v_cmp_le_i32 s[88:89],18,v206
 v_cmp_le_i32 s[98:99],19,v206
 v_cndmask_b32 v120,v205,v120,s[84:85]
 v_cndmask_b32 v121,v205,v121,s[86:87]
 v_cndmask_b32 v122,v205,v122,s[88:89]
 v_cndmask_b32 v123,v205,v123,s[98:99]
 v_cmp_le_i32 s[84:85],24,v206
 v_cmp_le_i32 s[86:87],25,v206
 v_cmp_le_i32 s[88:89],26,v206
 v_cmp_le_i32 s[98:99],27,v206
 v_cndmask_b32 v124,v205,v124,s[84:85]
 v_cndmask_b32 v125,v205,v125,s[86:87]
 v_cndmask_b32 v126,v205,v126,s[88:89]
 v_cndmask_b32 v127,v205,v127,s[98:99]
 v_max3_f32 v201,v80,v81,v82
 v_max3_f32 v201,v201,v83,v84
 v_max3_f32 v201,v201,v85,v86
 v_max3_f32 v201,v201,v87,v88
 v_max3_f32 v201,v201,v89,v90
 v_max3_f32 v201,v201,v91,v92
 v_max3_f32 v201,v201,v93,v94
 v_max_f32 v201,v201,v95
 v_max3_f32 v201,v201,v112,v113
 v_max3_f32 v201,v201,v114,v115
 v_max3_f32 v201,v201,v116,v117
 v_max3_f32 v201,v201,v118,v119
 v_max3_f32 v201,v201,v120,v121
 v_max3_f32 v201,v201,v122,v123
 v_max3_f32 v201,v201,v124,v125
 v_max3_f32 v201,v201,v126,v127
 v_mov_b32 v206,v201
 s_nop 1
 v_permlane32_swap_b32 v201,v206
 v_max_f32 v201,v201,v206
 v_max_f32 v201,0,v201
 v_exp_f32 v203,-v201
 v_sub_f32 v80,v80,v201
 v_sub_f32 v81,v81,v201
 v_sub_f32 v82,v82,v201
 v_sub_f32 v83,v83,v201
 v_sub_f32 v84,v84,v201
 v_sub_f32 v85,v85,v201
 v_sub_f32 v86,v86,v201
 v_sub_f32 v87,v87,v201
 v_sub_f32 v88,v88,v201
 v_sub_f32 v89,v89,v201
 v_sub_f32 v90,v90,v201
 v_sub_f32 v91,v91,v201
 v_sub_f32 v92,v92,v201
 v_sub_f32 v93,v93,v201
 v_sub_f32 v94,v94,v201
 v_sub_f32 v95,v95,v201
 v_sub_f32 v112,v112,v201
 v_sub_f32 v113,v113,v201
 v_sub_f32 v114,v114,v201
 v_sub_f32 v115,v115,v201
 v_sub_f32 v116,v116,v201
 v_sub_f32 v117,v117,v201
 v_sub_f32 v118,v118,v201
 v_sub_f32 v119,v119,v201
 v_sub_f32 v120,v120,v201
 v_sub_f32 v121,v121,v201
 v_sub_f32 v122,v122,v201
 v_sub_f32 v123,v123,v201
 v_sub_f32 v124,v124,v201
 v_sub_f32 v125,v125,v201
 v_sub_f32 v126,v126,v201
 v_sub_f32 v127,v127,v201
 v_sub_f32 v144,v144,v201
 v_sub_f32 v145,v145,v201
 v_sub_f32 v146,v146,v201
 v_sub_f32 v147,v147,v201
 v_sub_f32 v148,v148,v201
 v_sub_f32 v149,v149,v201
 v_sub_f32 v150,v150,v201
 v_sub_f32 v151,v151,v201
 v_sub_f32 v152,v152,v201
 v_sub_f32 v153,v153,v201
 v_sub_f32 v154,v154,v201
 v_sub_f32 v155,v155,v201
 v_sub_f32 v156,v156,v201
 v_sub_f32 v157,v157,v201
 v_sub_f32 v158,v158,v201
 v_sub_f32 v159,v159,v201
 v_mul_f32 v198,v198,v203
 v_exp_f32 v80,v80
 v_exp_f32 v81,v81
 v_exp_f32 v82,v82
 v_add_f32 v199,v80,v81
 v_exp_f32 v83,v83
 v_cvt_pk_bf16_f32 v80,v80,v81
 v_exp_f32 v84,v84
 v_add_f32 v199,v199,v82
 v_exp_f32 v85,v85
 v_cvt_pk_bf16_f32 v81,v82,v83
 v_add_f32 v199,v199,v83
 v_exp_f32 v86,v86
 v_add_f32 v199,v199,v84
 v_exp_f32 v87,v87
 v_cvt_pk_bf16_f32 v82,v84,v85
 v_add_f32 v199,v199,v85
 v_exp_f32 v88,v88
 v_add_f32 v199,v199,v86
 v_exp_f32 v89,v89
 v_cvt_pk_bf16_f32 v83,v86,v87
 v_add_f32 v199,v199,v87
 v_exp_f32 v90,v90
 v_add_f32 v199,v199,v88
 v_exp_f32 v91,v91
 v_add_f32 v199,v199,v89
 v_cvt_pk_bf16_f32 v88,v88,v89
 v_exp_f32 v92,v92
 v_add_f32 v199,v199,v90
 v_exp_f32 v93,v93
 v_cvt_pk_bf16_f32 v89,v90,v91
 v_add_f32 v199,v199,v91
 v_exp_f32 v94,v94
 v_add_f32 v199,v199,v92
 v_exp_f32 v95,v95
 v_cvt_pk_bf16_f32 v90,v92,v93
 v_add_f32 v199,v199,v93
 v_add_f32 v199,v199,v94
 v_cvt_pk_bf16_f32 v91,v94,v95
 v_add_f32 v199,v199,v95
 v_exp_f32 v112,v112
 v_exp_f32 v113,v113
 v_exp_f32 v114,v114
 v_add_f32 v199,v199,v112
 v_exp_f32 v115,v115
 v_add_f32 v199,v199,v113
 v_cvt_pk_bf16_f32 v112,v112,v113
 v_exp_f32 v116,v116
 v_add_f32 v199,v199,v114
 v_exp_f32 v117,v117
 v_cvt_pk_bf16_f32 v113,v114,v115
 v_add_f32 v199,v199,v115
 v_exp_f32 v118,v118
 v_add_f32 v199,v199,v116
 v_exp_f32 v119,v119
 v_cvt_pk_bf16_f32 v114,v116,v117
 v_add_f32 v199,v199,v117
 v_exp_f32 v120,v120
 v_add_f32 v199,v199,v118
 v_exp_f32 v121,v121
 v_cvt_pk_bf16_f32 v115,v118,v119
 v_add_f32 v199,v199,v119
 v_exp_f32 v122,v122
 v_add_f32 v199,v199,v120
 v_exp_f32 v123,v123
 v_add_f32 v199,v199,v121
 v_cvt_pk_bf16_f32 v120,v120,v121
 v_exp_f32 v124,v124
 v_add_f32 v199,v199,v122
 v_exp_f32 v125,v125
 v_cvt_pk_bf16_f32 v121,v122,v123
 v_add_f32 v199,v199,v123
 v_exp_f32 v126,v126
 v_add_f32 v199,v199,v124
 v_exp_f32 v127,v127
 v_cvt_pk_bf16_f32 v122,v124,v125
 v_add_f32 v199,v199,v125
 v_add_f32 v199,v199,v126
 v_cvt_pk_bf16_f32 v123,v126,v127
 v_add_f32 v199,v199,v127
 v_accvgpr_read_b32 v176,a64
 v_accvgpr_read_b32 v177,a65
 v_accvgpr_read_b32 v178,a66
 v_accvgpr_read_b32 v179,a67
 v_accvgpr_read_b32 v180,a68
 v_accvgpr_read_b32 v181,a69
 v_accvgpr_read_b32 v182,a70
 v_accvgpr_read_b32 v183,a71
 v_mul_f32 v176,v176,v203
 v_mul_f32 v177,v177,v203
 v_mul_f32 v178,v178,v203
 v_mul_f32 v179,v179,v203
 v_mul_f32 v180,v180,v203
 v_mul_f32 v181,v181,v203
 v_mul_f32 v182,v182,v203
 v_mul_f32 v183,v183,v203
 v_accvgpr_write_b32 a64,v176
 v_accvgpr_write_b32 a65,v177
 v_accvgpr_write_b32 a66,v178
 v_accvgpr_write_b32 a67,v179
 v_accvgpr_write_b32 a68,v180
 v_accvgpr_write_b32 a69,v181
 v_accvgpr_write_b32 a70,v182
 v_accvgpr_write_b32 a71,v183
 v_accvgpr_read_b32 v176,a72
 v_accvgpr_read_b32 v177,a73
 v_accvgpr_read_b32 v178,a74
 v_accvgpr_read_b32 v179,a75
 v_accvgpr_read_b32 v180,a76
 v_accvgpr_read_b32 v181,a77
 v_accvgpr_read_b32 v182,a78
 v_accvgpr_read_b32 v183,a79
 v_mul_f32 v176,v176,v203
 v_mul_f32 v177,v177,v203
 v_mul_f32 v178,v178,v203
 v_mul_f32 v179,v179,v203
 v_mul_f32 v180,v180,v203
 v_mul_f32 v181,v181,v203
 v_mul_f32 v182,v182,v203
 v_mul_f32 v183,v183,v203
 v_accvgpr_write_b32 a72,v176
 v_accvgpr_write_b32 a73,v177
 v_accvgpr_write_b32 a74,v178
 v_accvgpr_write_b32 a75,v179
 v_accvgpr_write_b32 a76,v180
 v_accvgpr_write_b32 a77,v181
 v_accvgpr_write_b32 a78,v182
 v_accvgpr_write_b32 a79,v183
 v_accvgpr_read_b32 v176,a80
 v_accvgpr_read_b32 v177,a81
 v_accvgpr_read_b32 v178,a82
 v_accvgpr_read_b32 v179,a83
 v_accvgpr_read_b32 v180,a84
 v_accvgpr_read_b32 v181,a85
 v_accvgpr_read_b32 v182,a86
 v_accvgpr_read_b32 v183,a87
 v_mul_f32 v176,v176,v203
 v_mul_f32 v177,v177,v203
 v_mul_f32 v178,v178,v203
 v_mul_f32 v179,v179,v203
 v_mul_f32 v180,v180,v203
 v_mul_f32 v181,v181,v203
 v_mul_f32 v182,v182,v203
 v_mul_f32 v183,v183,v203
 v_accvgpr_write_b32 a80,v176
 v_accvgpr_write_b32 a81,v177
 v_accvgpr_write_b32 a82,v178
 v_accvgpr_write_b32 a83,v179
 v_accvgpr_write_b32 a84,v180
 v_accvgpr_write_b32 a85,v181
 v_accvgpr_write_b32 a86,v182
 v_accvgpr_write_b32 a87,v183
 v_accvgpr_read_b32 v176,a88
 v_accvgpr_read_b32 v177,a89
 v_accvgpr_read_b32 v178,a90
 v_accvgpr_read_b32 v179,a91
 v_accvgpr_read_b32 v180,a92
 v_accvgpr_read_b32 v181,a93
 v_accvgpr_read_b32 v182,a94
 v_accvgpr_read_b32 v183,a95
 v_mul_f32 v176,v176,v203
 v_mul_f32 v177,v177,v203
 v_mul_f32 v178,v178,v203
 v_mul_f32 v179,v179,v203
 v_mul_f32 v180,v180,v203
 v_mul_f32 v181,v181,v203
 v_mul_f32 v182,v182,v203
 v_mul_f32 v183,v183,v203
 v_accvgpr_write_b32 a88,v176
 v_accvgpr_write_b32 a89,v177
 v_accvgpr_write_b32 a90,v178
 v_accvgpr_write_b32 a91,v179
 v_accvgpr_write_b32 a92,v180
 v_accvgpr_write_b32 a93,v181
 v_accvgpr_write_b32 a94,v182
 v_accvgpr_write_b32 a95,v183
 v_accvgpr_read_b32 v176,a96
 v_accvgpr_read_b32 v177,a97
 v_accvgpr_read_b32 v178,a98
 v_accvgpr_read_b32 v179,a99
 v_accvgpr_read_b32 v180,a100
 v_accvgpr_read_b32 v181,a101
 v_accvgpr_read_b32 v182,a102
 v_accvgpr_read_b32 v183,a103
 v_mul_f32 v176,v176,v203
 v_mul_f32 v177,v177,v203
 v_mul_f32 v178,v178,v203
 v_mul_f32 v179,v179,v203
 v_mul_f32 v180,v180,v203
 v_mul_f32 v181,v181,v203
 v_mul_f32 v182,v182,v203
 v_mul_f32 v183,v183,v203
 v_accvgpr_write_b32 a96,v176
 v_accvgpr_write_b32 a97,v177
 v_accvgpr_write_b32 a98,v178
 v_accvgpr_write_b32 a99,v179
 v_accvgpr_write_b32 a100,v180
 v_accvgpr_write_b32 a101,v181
 v_accvgpr_write_b32 a102,v182
 v_accvgpr_write_b32 a103,v183
 v_accvgpr_read_b32 v176,a104
 v_accvgpr_read_b32 v177,a105
 v_accvgpr_read_b32 v178,a106
 v_accvgpr_read_b32 v179,a107
 v_accvgpr_read_b32 v180,a108
 v_accvgpr_read_b32 v181,a109
 v_accvgpr_read_b32 v182,a110
 v_accvgpr_read_b32 v183,a111
 v_mul_f32 v176,v176,v203
 v_mul_f32 v177,v177,v203
 v_mul_f32 v178,v178,v203
 v_mul_f32 v179,v179,v203
 v_mul_f32 v180,v180,v203
 v_mul_f32 v181,v181,v203
 v_mul_f32 v182,v182,v203
 v_mul_f32 v183,v183,v203
 v_accvgpr_write_b32 a104,v176
 v_accvgpr_write_b32 a105,v177
 v_accvgpr_write_b32 a106,v178
 v_accvgpr_write_b32 a107,v179
 v_accvgpr_write_b32 a108,v180
 v_accvgpr_write_b32 a109,v181
 v_accvgpr_write_b32 a110,v182
 v_accvgpr_write_b32 a111,v183
 v_accvgpr_read_b32 v176,a112
 v_accvgpr_read_b32 v177,a113
 v_accvgpr_read_b32 v178,a114
 v_accvgpr_read_b32 v179,a115
 v_accvgpr_read_b32 v180,a116
 v_accvgpr_read_b32 v181,a117
 v_accvgpr_read_b32 v182,a118
 v_accvgpr_read_b32 v183,a119
 v_mul_f32 v176,v176,v203
 v_mul_f32 v177,v177,v203
 v_mul_f32 v178,v178,v203
 v_mul_f32 v179,v179,v203
 v_mul_f32 v180,v180,v203
 v_mul_f32 v181,v181,v203
 v_mul_f32 v182,v182,v203
 v_mul_f32 v183,v183,v203
 v_accvgpr_write_b32 a112,v176
 v_accvgpr_write_b32 a113,v177
 v_accvgpr_write_b32 a114,v178
 v_accvgpr_write_b32 a115,v179
 v_accvgpr_write_b32 a116,v180
 v_accvgpr_write_b32 a117,v181
 v_accvgpr_write_b32 a118,v182
 v_accvgpr_write_b32 a119,v183
 v_accvgpr_read_b32 v176,a120
 v_accvgpr_read_b32 v177,a121
 v_accvgpr_read_b32 v178,a122
 v_accvgpr_read_b32 v179,a123
 v_accvgpr_read_b32 v180,a124
 v_accvgpr_read_b32 v181,a125
 v_accvgpr_read_b32 v182,a126
 v_accvgpr_read_b32 v183,a127
 v_mul_f32 v176,v176,v203
 v_mul_f32 v177,v177,v203
 v_mul_f32 v178,v178,v203
 v_mul_f32 v179,v179,v203
 v_mul_f32 v180,v180,v203
 v_mul_f32 v181,v181,v203
 v_mul_f32 v182,v182,v203
 v_mul_f32 v183,v183,v203
 v_accvgpr_write_b32 a120,v176
 v_accvgpr_write_b32 a121,v177
 v_accvgpr_write_b32 a122,v178
 v_accvgpr_write_b32 a123,v179
 v_accvgpr_write_b32 a124,v180
 v_accvgpr_write_b32 a125,v181
 v_accvgpr_write_b32 a126,v182
 v_accvgpr_write_b32 a127,v183
 s_nop 1
 s_setpc_b64 s[100:101]
F_RB0:
 s_nop 15
 s_mul_i32 s70,s75,272
 s_add_u32 s79,s70,0
 buffer_load_dwordx4 v[176:179],v224,s[36:39],s79 offen offset:0 sc1
 buffer_load_dwordx4 v[180:183],v224,s[36:39],s79 offen offset:1024 sc1
 buffer_load_dwordx4 v[184:187],v224,s[36:39],s79 offen offset:2048 sc1
 buffer_load_dwordx4 v[188:191],v224,s[36:39],s79 offen offset:3072 sc1
 s_waitcnt vmcnt(0)
 N v[0:15],v[176:179],a[160:163],v[144:159]
 N v[0:15],v[180:183],a[164:167],v[0:15]
 N v[0:15],v[184:187],a[168:171],v[0:15]
 N v[0:15],v[188:191],a[172:175],v[0:15]
 s_nop 7
 s_add_u32 s79,s70,4096
 buffer_load_dwordx4 v[176:179],v224,s[36:39],s79 offen offset:0 sc1
 buffer_load_dwordx4 v[180:183],v224,s[36:39],s79 offen offset:1024 sc1
 buffer_load_dwordx4 v[184:187],v224,s[36:39],s79 offen offset:2048 sc1
 buffer_load_dwordx4 v[188:191],v224,s[36:39],s79 offen offset:3072 sc1
 s_waitcnt vmcnt(0)
 N v[0:15],v[176:179],a[176:179],v[0:15]
 N v[0:15],v[180:183],a[180:183],v[0:15]
 N v[0:15],v[184:187],a[184:187],v[0:15]
 N v[0:15],v[188:191],a[188:191],v[0:15]
 s_nop 7
 s_add_u32 s79,s70,8192
 buffer_load_dwordx4 v[176:179],v224,s[36:39],s79 offen offset:0 sc1
 buffer_load_dwordx4 v[180:183],v224,s[36:39],s79 offen offset:1024 sc1
 buffer_load_dwordx4 v[184:187],v224,s[36:39],s79 offen offset:2048 sc1
 buffer_load_dwordx4 v[188:191],v224,s[36:39],s79 offen offset:3072 sc1
 s_waitcnt vmcnt(0)
 N v[16:31],v[176:179],a[160:163],v[144:159]
 N v[16:31],v[180:183],a[164:167],v[16:31]
 N v[16:31],v[184:187],a[168:171],v[16:31]
 N v[16:31],v[188:191],a[172:175],v[16:31]
 s_nop 7
 s_add_u32 s79,s70,12288
 buffer_load_dwordx4 v[176:179],v224,s[36:39],s79 offen offset:0 sc1
 buffer_load_dwordx4 v[180:183],v224,s[36:39],s79 offen offset:1024 sc1
 buffer_load_dwordx4 v[184:187],v224,s[36:39],s79 offen offset:2048 sc1
 buffer_load_dwordx4 v[188:191],v224,s[36:39],s79 offen offset:3072 sc1
 s_waitcnt vmcnt(0)
 N v[16:31],v[176:179],a[176:179],v[16:31]
 N v[16:31],v[180:183],a[180:183],v[16:31]
 N v[16:31],v[184:187],a[184:187],v[16:31]
 N v[16:31],v[188:191],a[188:191],v[16:31]
 s_nop 7
 s_add_u32 s79,s70,17408
 buffer_load_dwordx4 v[176:179],v224,s[36:39],s79 offen offset:0 sc1
 buffer_load_dwordx4 v[180:183],v224,s[36:39],s79 offen offset:1024 sc1
 buffer_load_dwordx4 v[184:187],v224,s[36:39],s79 offen offset:2048 sc1
 buffer_load_dwordx4 v[188:191],v224,s[36:39],s79 offen offset:3072 sc1
 s_waitcnt vmcnt(0)
 N v[32:47],v[176:179],a[160:163],v[144:159]
 N v[32:47],v[180:183],a[164:167],v[32:47]
 N v[32:47],v[184:187],a[168:171],v[32:47]
 N v[32:47],v[188:191],a[172:175],v[32:47]
 s_nop 7
 s_add_u32 s79,s70,21504
 buffer_load_dwordx4 v[176:179],v224,s[36:39],s79 offen offset:0 sc1
 buffer_load_dwordx4 v[180:183],v224,s[36:39],s79 offen offset:1024 sc1
 buffer_load_dwordx4 v[184:187],v224,s[36:39],s79 offen offset:2048 sc1
 buffer_load_dwordx4 v[188:191],v224,s[36:39],s79 offen offset:3072 sc1
 s_waitcnt vmcnt(0)
 N v[32:47],v[176:179],a[176:179],v[32:47]
 N v[32:47],v[180:183],a[180:183],v[32:47]
 N v[32:47],v[184:187],a[184:187],v[32:47]
 N v[32:47],v[188:191],a[188:191],v[32:47]
 s_nop 7
 s_add_u32 s79,s70,25600
 buffer_load_dwordx4 v[176:179],v224,s[36:39],s79 offen offset:0 sc1
 buffer_load_dwordx4 v[180:183],v224,s[36:39],s79 offen offset:1024 sc1
 buffer_load_dwordx4 v[184:187],v224,s[36:39],s79 offen offset:2048 sc1
 buffer_load_dwordx4 v[188:191],v224,s[36:39],s79 offen offset:3072 sc1
 s_waitcnt vmcnt(0)
 N v[48:63],v[176:179],a[160:163],v[144:159]
 N v[48:63],v[180:183],a[164:167],v[48:63]
 N v[48:63],v[184:187],a[168:171],v[48:63]
 N v[48:63],v[188:191],a[172:175],v[48:63]
 s_nop 7
 s_add_u32 s79,s70,29696
 buffer_load_dwordx4 v[176:179],v224,s[36:39],s79 offen offset:0 sc1
 buffer_load_dwordx4 v[180:183],v224,s[36:39],s79 offen offset:1024 sc1
 buffer_load_dwordx4 v[184:187],v224,s[36:39],s79 offen offset:2048 sc1
 buffer_load_dwordx4 v[188:191],v224,s[36:39],s79 offen offset:3072 sc1
 s_waitcnt vmcnt(0)
 N v[48:63],v[176:179],a[176:179],v[48:63]
 N v[48:63],v[180:183],a[180:183],v[48:63]
 N v[48:63],v[184:187],a[184:187],v[48:63]
 N v[48:63],v[188:191],a[188:191],v[48:63]
 s_nop 7
 s_sub_u32 s79,15,s66
 s_lshl_b32 s79,s79,7
 s_sub_u32 s79,s79,s75
 v_add_u32 v206,s79,v204
 v_cmp_le_i32 s[84:85],0,v206
 v_cmp_le_i32 s[86:87],1,v206
 v_cmp_le_i32 s[88:89],2,v206
 v_cmp_le_i32 s[98:99],3,v206
 v_cndmask_b32 v0,v205,v0,s[84:85]
 v_cndmask_b32 v1,v205,v1,s[86:87]
 v_cndmask_b32 v2,v205,v2,s[88:89]
 v_cndmask_b32 v3,v205,v3,s[98:99]
 v_cmp_le_i32 s[84:85],8,v206
 v_cmp_le_i32 s[86:87],9,v206
 v_cmp_le_i32 s[88:89],10,v206
 v_cmp_le_i32 s[98:99],11,v206
 v_cndmask_b32 v4,v205,v4,s[84:85]
 v_cndmask_b32 v5,v205,v5,s[86:87]
 v_cndmask_b32 v6,v205,v6,s[88:89]
 v_cndmask_b32 v7,v205,v7,s[98:99]
 v_cmp_le_i32 s[84:85],16,v206
 v_cmp_le_i32 s[86:87],17,v206
 v_cmp_le_i32 s[88:89],18,v206
 v_cmp_le_i32 s[98:99],19,v206
 v_cndmask_b32 v8,v205,v8,s[84:85]
 v_cndmask_b32 v9,v205,v9,s[86:87]
 v_cndmask_b32 v10,v205,v10,s[88:89]
 v_cndmask_b32 v11,v205,v11,s[98:99]
 v_cmp_le_i32 s[84:85],24,v206
 v_cmp_le_i32 s[86:87],25,v206
 v_cmp_le_i32 s[88:89],26,v206
 v_cmp_le_i32 s[98:99],27,v206
 v_cndmask_b32 v12,v205,v12,s[84:85]
 v_cndmask_b32 v13,v205,v13,s[86:87]
 v_cndmask_b32 v14,v205,v14,s[88:89]
 v_cndmask_b32 v15,v205,v15,s[98:99]
 v_add_u32 v206,s79,v204
 v_subrev_u32 v206,32,v206
 v_cmp_le_i32 s[84:85],0,v206
 v_cmp_le_i32 s[86:87],1,v206
 v_cmp_le_i32 s[88:89],2,v206
 v_cmp_le_i32 s[98:99],3,v206
 v_cndmask_b32 v16,v205,v16,s[84:85]
 v_cndmask_b32 v17,v205,v17,s[86:87]
 v_cndmask_b32 v18,v205,v18,s[88:89]
 v_cndmask_b32 v19,v205,v19,s[98:99]
 v_cmp_le_i32 s[84:85],8,v206
 v_cmp_le_i32 s[86:87],9,v206
 v_cmp_le_i32 s[88:89],10,v206
 v_cmp_le_i32 s[98:99],11,v206
 v_cndmask_b32 v20,v205,v20,s[84:85]
 v_cndmask_b32 v21,v205,v21,s[86:87]
 v_cndmask_b32 v22,v205,v22,s[88:89]
 v_cndmask_b32 v23,v205,v23,s[98:99]
 v_cmp_le_i32 s[84:85],16,v206
 v_cmp_le_i32 s[86:87],17,v206
 v_cmp_le_i32 s[88:89],18,v206
 v_cmp_le_i32 s[98:99],19,v206
 v_cndmask_b32 v24,v205,v24,s[84:85]
 v_cndmask_b32 v25,v205,v25,s[86:87]
 v_cndmask_b32 v26,v205,v26,s[88:89]
 v_cndmask_b32 v27,v205,v27,s[98:99]
 v_cmp_le_i32 s[84:85],24,v206
 v_cmp_le_i32 s[86:87],25,v206
 v_cmp_le_i32 s[88:89],26,v206
 v_cmp_le_i32 s[98:99],27,v206
 v_cndmask_b32 v28,v205,v28,s[84:85]
 v_cndmask_b32 v29,v205,v29,s[86:87]
 v_cndmask_b32 v30,v205,v30,s[88:89]
 v_cndmask_b32 v31,v205,v31,s[98:99]
 v_add_u32 v206,s79,v204
 v_subrev_u32 v206,64,v206
 v_cmp_le_i32 s[84:85],0,v206
 v_cmp_le_i32 s[86:87],1,v206
 v_cmp_le_i32 s[88:89],2,v206
 v_cmp_le_i32 s[98:99],3,v206
 v_cndmask_b32 v32,v205,v32,s[84:85]
 v_cndmask_b32 v33,v205,v33,s[86:87]
 v_cndmask_b32 v34,v205,v34,s[88:89]
 v_cndmask_b32 v35,v205,v35,s[98:99]
 v_cmp_le_i32 s[84:85],8,v206
 v_cmp_le_i32 s[86:87],9,v206
 v_cmp_le_i32 s[88:89],10,v206
 v_cmp_le_i32 s[98:99],11,v206
 v_cndmask_b32 v36,v205,v36,s[84:85]
 v_cndmask_b32 v37,v205,v37,s[86:87]
 v_cndmask_b32 v38,v205,v38,s[88:89]
 v_cndmask_b32 v39,v205,v39,s[98:99]
 v_cmp_le_i32 s[84:85],16,v206
 v_cmp_le_i32 s[86:87],17,v206
 v_cmp_le_i32 s[88:89],18,v206
 v_cmp_le_i32 s[98:99],19,v206
 v_cndmask_b32 v40,v205,v40,s[84:85]
 v_cndmask_b32 v41,v205,v41,s[86:87]
 v_cndmask_b32 v42,v205,v42,s[88:89]
 v_cndmask_b32 v43,v205,v43,s[98:99]
 v_cmp_le_i32 s[84:85],24,v206
 v_cmp_le_i32 s[86:87],25,v206
 v_cmp_le_i32 s[88:89],26,v206
 v_cmp_le_i32 s[98:99],27,v206
 v_cndmask_b32 v44,v205,v44,s[84:85]
 v_cndmask_b32 v45,v205,v45,s[86:87]
 v_cndmask_b32 v46,v205,v46,s[88:89]
 v_cndmask_b32 v47,v205,v47,s[98:99]
 v_add_u32 v206,s79,v204
 v_subrev_u32 v206,96,v206
 v_cmp_le_i32 s[84:85],0,v206
 v_cmp_le_i32 s[86:87],1,v206
 v_cmp_le_i32 s[88:89],2,v206
 v_cmp_le_i32 s[98:99],3,v206
 v_cndmask_b32 v48,v205,v48,s[84:85]
 v_cndmask_b32 v49,v205,v49,s[86:87]
 v_cndmask_b32 v50,v205,v50,s[88:89]
 v_cndmask_b32 v51,v205,v51,s[98:99]
 v_cmp_le_i32 s[84:85],8,v206
 v_cmp_le_i32 s[86:87],9,v206
 v_cmp_le_i32 s[88:89],10,v206
 v_cmp_le_i32 s[98:99],11,v206
 v_cndmask_b32 v52,v205,v52,s[84:85]
 v_cndmask_b32 v53,v205,v53,s[86:87]
 v_cndmask_b32 v54,v205,v54,s[88:89]
 v_cndmask_b32 v55,v205,v55,s[98:99]
 v_cmp_le_i32 s[84:85],16,v206
 v_cmp_le_i32 s[86:87],17,v206
 v_cmp_le_i32 s[88:89],18,v206
 v_cmp_le_i32 s[98:99],19,v206
 v_cndmask_b32 v56,v205,v56,s[84:85]
 v_cndmask_b32 v57,v205,v57,s[86:87]
 v_cndmask_b32 v58,v205,v58,s[88:89]
 v_cndmask_b32 v59,v205,v59,s[98:99]
 v_cmp_le_i32 s[84:85],24,v206
 v_cmp_le_i32 s[86:87],25,v206
 v_cmp_le_i32 s[88:89],26,v206
 v_cmp_le_i32 s[98:99],27,v206
 v_cndmask_b32 v60,v205,v60,s[84:85]
 v_cndmask_b32 v61,v205,v61,s[86:87]
 v_cndmask_b32 v62,v205,v62,s[88:89]
 v_cndmask_b32 v63,v205,v63,s[98:99]
 v_max3_f32 v201,v0,v1,v2
 v_max3_f32 v201,v201,v3,v4
 v_max3_f32 v201,v201,v5,v6
 v_max3_f32 v201,v201,v7,v8
 v_max3_f32 v201,v201,v9,v10
 v_max3_f32 v201,v201,v11,v12
 v_max3_f32 v201,v201,v13,v14
 v_max_f32 v201,v201,v15
 v_max3_f32 v201,v201,v16,v17
 v_max3_f32 v201,v201,v18,v19
 v_max3_f32 v201,v201,v20,v21
 v_max3_f32 v201,v201,v22,v23
 v_max3_f32 v201,v201,v24,v25
 v_max3_f32 v201,v201,v26,v27
 v_max3_f32 v201,v201,v28,v29
 v_max3_f32 v201,v201,v30,v31
 v_max3_f32 v201,v201,v32,v33
 v_max3_f32 v201,v201,v34,v35
 v_max3_f32 v201,v201,v36,v37
 v_max3_f32 v201,v201,v38,v39
 v_max3_f32 v201,v201,v40,v41
 v_max3_f32 v201,v201,v42,v43
 v_max3_f32 v201,v201,v44,v45
 v_max3_f32 v201,v201,v46,v47
 v_max3_f32 v201,v201,v48,v49
 v_max3_f32 v201,v201,v50,v51
 v_max3_f32 v201,v201,v52,v53
 v_max3_f32 v201,v201,v54,v55
 v_max3_f32 v201,v201,v56,v57
 v_max3_f32 v201,v201,v58,v59
 v_max3_f32 v201,v201,v60,v61
 v_max3_f32 v201,v201,v62,v63
 v_mov_b32 v206,v201
 s_nop 1
 v_permlane32_swap_b32 v201,v206
 v_max_f32 v201,v201,v206
 v_max_f32 v201,0,v201
 v_exp_f32 v203,-v201
 v_sub_f32 v0,v0,v201
 v_sub_f32 v1,v1,v201
 v_sub_f32 v2,v2,v201
 v_sub_f32 v3,v3,v201
 v_sub_f32 v4,v4,v201
 v_sub_f32 v5,v5,v201
 v_sub_f32 v6,v6,v201
 v_sub_f32 v7,v7,v201
 v_sub_f32 v8,v8,v201
 v_sub_f32 v9,v9,v201
 v_sub_f32 v10,v10,v201
 v_sub_f32 v11,v11,v201
 v_sub_f32 v12,v12,v201
 v_sub_f32 v13,v13,v201
 v_sub_f32 v14,v14,v201
 v_sub_f32 v15,v15,v201
 v_sub_f32 v16,v16,v201
 v_sub_f32 v17,v17,v201
 v_sub_f32 v18,v18,v201
 v_sub_f32 v19,v19,v201
 v_sub_f32 v20,v20,v201
 v_sub_f32 v21,v21,v201
 v_sub_f32 v22,v22,v201
 v_sub_f32 v23,v23,v201
 v_sub_f32 v24,v24,v201
 v_sub_f32 v25,v25,v201
 v_sub_f32 v26,v26,v201
 v_sub_f32 v27,v27,v201
 v_sub_f32 v28,v28,v201
 v_sub_f32 v29,v29,v201
 v_sub_f32 v30,v30,v201
 v_sub_f32 v31,v31,v201
 v_sub_f32 v32,v32,v201
 v_sub_f32 v33,v33,v201
 v_sub_f32 v34,v34,v201
 v_sub_f32 v35,v35,v201
 v_sub_f32 v36,v36,v201
 v_sub_f32 v37,v37,v201
 v_sub_f32 v38,v38,v201
 v_sub_f32 v39,v39,v201
 v_sub_f32 v40,v40,v201
 v_sub_f32 v41,v41,v201
 v_sub_f32 v42,v42,v201
 v_sub_f32 v43,v43,v201
 v_sub_f32 v44,v44,v201
 v_sub_f32 v45,v45,v201
 v_sub_f32 v46,v46,v201
 v_sub_f32 v47,v47,v201
 v_sub_f32 v48,v48,v201
 v_sub_f32 v49,v49,v201
 v_sub_f32 v50,v50,v201
 v_sub_f32 v51,v51,v201
 v_sub_f32 v52,v52,v201
 v_sub_f32 v53,v53,v201
 v_sub_f32 v54,v54,v201
 v_sub_f32 v55,v55,v201
 v_sub_f32 v56,v56,v201
 v_sub_f32 v57,v57,v201
 v_sub_f32 v58,v58,v201
 v_sub_f32 v59,v59,v201
 v_sub_f32 v60,v60,v201
 v_sub_f32 v61,v61,v201
 v_sub_f32 v62,v62,v201
 v_sub_f32 v63,v63,v201
 v_sub_f32 v144,v144,v201
 v_sub_f32 v145,v145,v201
 v_sub_f32 v146,v146,v201
 v_sub_f32 v147,v147,v201
 v_sub_f32 v148,v148,v201
 v_sub_f32 v149,v149,v201
 v_sub_f32 v150,v150,v201
 v_sub_f32 v151,v151,v201
 v_sub_f32 v152,v152,v201
 v_sub_f32 v153,v153,v201
 v_sub_f32 v154,v154,v201
 v_sub_f32 v155,v155,v201
 v_sub_f32 v156,v156,v201
 v_sub_f32 v157,v157,v201
 v_sub_f32 v158,v158,v201
 v_sub_f32 v159,v159,v201
 v_mul_f32 v198,v198,v203
 v_exp_f32 v0,v0
 v_exp_f32 v1,v1
 v_exp_f32 v2,v2
 v_add_f32 v199,v0,v1
 v_exp_f32 v3,v3
 v_cvt_pk_bf16_f32 v0,v0,v1
 v_exp_f32 v4,v4
 v_add_f32 v199,v199,v2
 v_exp_f32 v5,v5
 v_cvt_pk_bf16_f32 v1,v2,v3
 v_add_f32 v199,v199,v3
 v_exp_f32 v6,v6
 v_add_f32 v199,v199,v4
 v_exp_f32 v7,v7
 v_cvt_pk_bf16_f32 v2,v4,v5
 v_add_f32 v199,v199,v5
 v_exp_f32 v8,v8
 v_add_f32 v199,v199,v6
 v_exp_f32 v9,v9
 v_cvt_pk_bf16_f32 v3,v6,v7
 v_add_f32 v199,v199,v7
 v_exp_f32 v10,v10
 v_add_f32 v199,v199,v8
 v_exp_f32 v11,v11
 v_add_f32 v199,v199,v9
 v_cvt_pk_bf16_f32 v8,v8,v9
 v_exp_f32 v12,v12
 v_add_f32 v199,v199,v10
 v_exp_f32 v13,v13
 v_cvt_pk_bf16_f32 v9,v10,v11
 v_add_f32 v199,v199,v11
 v_exp_f32 v14,v14
 v_add_f32 v199,v199,v12
 v_exp_f32 v15,v15
 v_cvt_pk_bf16_f32 v10,v12,v13
 v_add_f32 v199,v199,v13
 v_add_f32 v199,v199,v14
 v_cvt_pk_bf16_f32 v11,v14,v15
 v_add_f32 v199,v199,v15
 v_exp_f32 v16,v16
 v_exp_f32 v17,v17
 v_exp_f32 v18,v18
 v_add_f32 v199,v199,v16
 v_exp_f32 v19,v19
 v_add_f32 v199,v199,v17
 v_cvt_pk_bf16_f32 v16,v16,v17
 v_exp_f32 v20,v20
 v_add_f32 v199,v199,v18
 v_exp_f32 v21,v21
 v_cvt_pk_bf16_f32 v17,v18,v19
 v_add_f32 v199,v199,v19
 v_exp_f32 v22,v22
 v_add_f32 v199,v199,v20
 v_exp_f32 v23,v23
 v_cvt_pk_bf16_f32 v18,v20,v21
 v_add_f32 v199,v199,v21
 v_exp_f32 v24,v24
 v_add_f32 v199,v199,v22
 v_exp_f32 v25,v25
 v_cvt_pk_bf16_f32 v19,v22,v23
 v_add_f32 v199,v199,v23
 v_exp_f32 v26,v26
 v_add_f32 v199,v199,v24
 v_exp_f32 v27,v27
 v_add_f32 v199,v199,v25
 v_cvt_pk_bf16_f32 v24,v24,v25
 v_exp_f32 v28,v28
 v_add_f32 v199,v199,v26
 v_exp_f32 v29,v29
 v_cvt_pk_bf16_f32 v25,v26,v27
 v_add_f32 v199,v199,v27
 v_exp_f32 v30,v30
 v_add_f32 v199,v199,v28
 v_exp_f32 v31,v31
 v_cvt_pk_bf16_f32 v26,v28,v29
 v_add_f32 v199,v199,v29
 v_add_f32 v199,v199,v30
 v_cvt_pk_bf16_f32 v27,v30,v31
 v_add_f32 v199,v199,v31
 v_exp_f32 v32,v32
 v_exp_f32 v33,v33
 v_exp_f32 v34,v34
 v_add_f32 v199,v199,v32
 v_exp_f32 v35,v35
 v_add_f32 v199,v199,v33
 v_cvt_pk_bf16_f32 v32,v32,v33
 v_exp_f32 v36,v36
 v_add_f32 v199,v199,v34
 v_exp_f32 v37,v37
 v_cvt_pk_bf16_f32 v33,v34,v35
 v_add_f32 v199,v199,v35
 v_exp_f32 v38,v38
 v_add_f32 v199,v199,v36
 v_exp_f32 v39,v39
 v_cvt_pk_bf16_f32 v34,v36,v37
 v_add_f32 v199,v199,v37
 v_exp_f32 v40,v40
 v_add_f32 v199,v199,v38
 v_exp_f32 v41,v41
 v_cvt_pk_bf16_f32 v35,v38,v39
 v_add_f32 v199,v199,v39
 v_exp_f32 v42,v42
 v_add_f32 v199,v199,v40
 v_exp_f32 v43,v43
 v_add_f32 v199,v199,v41
 v_cvt_pk_bf16_f32 v40,v40,v41
 v_exp_f32 v44,v44
 v_add_f32 v199,v199,v42
 v_exp_f32 v45,v45
 v_cvt_pk_bf16_f32 v41,v42,v43
 v_add_f32 v199,v199,v43
 v_exp_f32 v46,v46
 v_add_f32 v199,v199,v44
 v_exp_f32 v47,v47
 v_cvt_pk_bf16_f32 v42,v44,v45
 v_add_f32 v199,v199,v45
 v_add_f32 v199,v199,v46
 v_cvt_pk_bf16_f32 v43,v46,v47
 v_add_f32 v199,v199,v47
 v_exp_f32 v48,v48
 v_exp_f32 v49,v49
 v_exp_f32 v50,v50
 v_add_f32 v199,v199,v48
 v_exp_f32 v51,v51
 v_add_f32 v199,v199,v49
 v_cvt_pk_bf16_f32 v48,v48,v49
 v_exp_f32 v52,v52
 v_add_f32 v199,v199,v50
 v_exp_f32 v53,v53
 v_cvt_pk_bf16_f32 v49,v50,v51
 v_add_f32 v199,v199,v51
 v_exp_f32 v54,v54
 v_add_f32 v199,v199,v52
 v_exp_f32 v55,v55
 v_cvt_pk_bf16_f32 v50,v52,v53
 v_add_f32 v199,v199,v53
 v_exp_f32 v56,v56
 v_add_f32 v199,v199,v54
 v_exp_f32 v57,v57
 v_cvt_pk_bf16_f32 v51,v54,v55
 v_add_f32 v199,v199,v55
 v_exp_f32 v58,v58
 v_add_f32 v199,v199,v56
 v_exp_f32 v59,v59
 v_add_f32 v199,v199,v57
 v_cvt_pk_bf16_f32 v56,v56,v57
 v_exp_f32 v60,v60
 v_add_f32 v199,v199,v58
 v_exp_f32 v61,v61
 v_cvt_pk_bf16_f32 v57,v58,v59
 v_add_f32 v199,v199,v59
 v_exp_f32 v62,v62
 v_add_f32 v199,v199,v60
 v_exp_f32 v63,v63
 v_cvt_pk_bf16_f32 v58,v60,v61
 v_add_f32 v199,v199,v61
 v_add_f32 v199,v199,v62
 v_cvt_pk_bf16_f32 v59,v62,v63
 v_add_f32 v199,v199,v63
 v_accvgpr_read_b32 v176,a64
 v_accvgpr_read_b32 v177,a65
 v_accvgpr_read_b32 v178,a66
 v_accvgpr_read_b32 v179,a67
 v_accvgpr_read_b32 v180,a68
 v_accvgpr_read_b32 v181,a69
 v_accvgpr_read_b32 v182,a70
 v_accvgpr_read_b32 v183,a71
 v_mul_f32 v176,v176,v203
 v_mul_f32 v177,v177,v203
 v_mul_f32 v178,v178,v203
 v_mul_f32 v179,v179,v203
 v_mul_f32 v180,v180,v203
 v_mul_f32 v181,v181,v203
 v_mul_f32 v182,v182,v203
 v_mul_f32 v183,v183,v203
 v_accvgpr_write_b32 a64,v176
 v_accvgpr_write_b32 a65,v177
 v_accvgpr_write_b32 a66,v178
 v_accvgpr_write_b32 a67,v179
 v_accvgpr_write_b32 a68,v180
 v_accvgpr_write_b32 a69,v181
 v_accvgpr_write_b32 a70,v182
 v_accvgpr_write_b32 a71,v183
 v_accvgpr_read_b32 v176,a72
 v_accvgpr_read_b32 v177,a73
 v_accvgpr_read_b32 v178,a74
 v_accvgpr_read_b32 v179,a75
 v_accvgpr_read_b32 v180,a76
 v_accvgpr_read_b32 v181,a77
 v_accvgpr_read_b32 v182,a78
 v_accvgpr_read_b32 v183,a79
 v_mul_f32 v176,v176,v203
 v_mul_f32 v177,v177,v203
 v_mul_f32 v178,v178,v203
 v_mul_f32 v179,v179,v203
 v_mul_f32 v180,v180,v203
 v_mul_f32 v181,v181,v203
 v_mul_f32 v182,v182,v203
 v_mul_f32 v183,v183,v203
 v_accvgpr_write_b32 a72,v176
 v_accvgpr_write_b32 a73,v177
 v_accvgpr_write_b32 a74,v178
 v_accvgpr_write_b32 a75,v179
 v_accvgpr_write_b32 a76,v180
 v_accvgpr_write_b32 a77,v181
 v_accvgpr_write_b32 a78,v182
 v_accvgpr_write_b32 a79,v183
 v_accvgpr_read_b32 v176,a80
 v_accvgpr_read_b32 v177,a81
 v_accvgpr_read_b32 v178,a82
 v_accvgpr_read_b32 v179,a83
 v_accvgpr_read_b32 v180,a84
 v_accvgpr_read_b32 v181,a85
 v_accvgpr_read_b32 v182,a86
 v_accvgpr_read_b32 v183,a87
 v_mul_f32 v176,v176,v203
 v_mul_f32 v177,v177,v203
 v_mul_f32 v178,v178,v203
 v_mul_f32 v179,v179,v203
 v_mul_f32 v180,v180,v203
 v_mul_f32 v181,v181,v203
 v_mul_f32 v182,v182,v203
 v_mul_f32 v183,v183,v203
 v_accvgpr_write_b32 a80,v176
 v_accvgpr_write_b32 a81,v177
 v_accvgpr_write_b32 a82,v178
 v_accvgpr_write_b32 a83,v179
 v_accvgpr_write_b32 a84,v180
 v_accvgpr_write_b32 a85,v181
 v_accvgpr_write_b32 a86,v182
 v_accvgpr_write_b32 a87,v183
 v_accvgpr_read_b32 v176,a88
 v_accvgpr_read_b32 v177,a89
 v_accvgpr_read_b32 v178,a90
 v_accvgpr_read_b32 v179,a91
 v_accvgpr_read_b32 v180,a92
 v_accvgpr_read_b32 v181,a93
 v_accvgpr_read_b32 v182,a94
 v_accvgpr_read_b32 v183,a95
 v_mul_f32 v176,v176,v203
 v_mul_f32 v177,v177,v203
 v_mul_f32 v178,v178,v203
 v_mul_f32 v179,v179,v203
 v_mul_f32 v180,v180,v203
 v_mul_f32 v181,v181,v203
 v_mul_f32 v182,v182,v203
 v_mul_f32 v183,v183,v203
 v_accvgpr_write_b32 a88,v176
 v_accvgpr_write_b32 a89,v177
 v_accvgpr_write_b32 a90,v178
 v_accvgpr_write_b32 a91,v179
 v_accvgpr_write_b32 a92,v180
 v_accvgpr_write_b32 a93,v181
 v_accvgpr_write_b32 a94,v182
 v_accvgpr_write_b32 a95,v183
 v_accvgpr_read_b32 v176,a96
 v_accvgpr_read_b32 v177,a97
 v_accvgpr_read_b32 v178,a98
 v_accvgpr_read_b32 v179,a99
 v_accvgpr_read_b32 v180,a100
 v_accvgpr_read_b32 v181,a101
 v_accvgpr_read_b32 v182,a102
 v_accvgpr_read_b32 v183,a103
 v_mul_f32 v176,v176,v203
 v_mul_f32 v177,v177,v203
 v_mul_f32 v178,v178,v203
 v_mul_f32 v179,v179,v203
 v_mul_f32 v180,v180,v203
 v_mul_f32 v181,v181,v203
 v_mul_f32 v182,v182,v203
 v_mul_f32 v183,v183,v203
 v_accvgpr_write_b32 a96,v176
 v_accvgpr_write_b32 a97,v177
 v_accvgpr_write_b32 a98,v178
 v_accvgpr_write_b32 a99,v179
 v_accvgpr_write_b32 a100,v180
 v_accvgpr_write_b32 a101,v181
 v_accvgpr_write_b32 a102,v182
 v_accvgpr_write_b32 a103,v183
 v_accvgpr_read_b32 v176,a104
 v_accvgpr_read_b32 v177,a105
 v_accvgpr_read_b32 v178,a106
 v_accvgpr_read_b32 v179,a107
 v_accvgpr_read_b32 v180,a108
 v_accvgpr_read_b32 v181,a109
 v_accvgpr_read_b32 v182,a110
 v_accvgpr_read_b32 v183,a111
 v_mul_f32 v176,v176,v203
 v_mul_f32 v177,v177,v203
 v_mul_f32 v178,v178,v203
 v_mul_f32 v179,v179,v203
 v_mul_f32 v180,v180,v203
 v_mul_f32 v181,v181,v203
 v_mul_f32 v182,v182,v203
 v_mul_f32 v183,v183,v203
 v_accvgpr_write_b32 a104,v176
 v_accvgpr_write_b32 a105,v177
 v_accvgpr_write_b32 a106,v178
 v_accvgpr_write_b32 a107,v179
 v_accvgpr_write_b32 a108,v180
 v_accvgpr_write_b32 a109,v181
 v_accvgpr_write_b32 a110,v182
 v_accvgpr_write_b32 a111,v183
 v_accvgpr_read_b32 v176,a112
 v_accvgpr_read_b32 v177,a113
 v_accvgpr_read_b32 v178,a114
 v_accvgpr_read_b32 v179,a115
 v_accvgpr_read_b32 v180,a116
 v_accvgpr_read_b32 v181,a117
 v_accvgpr_read_b32 v182,a118
 v_accvgpr_read_b32 v183,a119
 v_mul_f32 v176,v176,v203
 v_mul_f32 v177,v177,v203
 v_mul_f32 v178,v178,v203
 v_mul_f32 v179,v179,v203
 v_mul_f32 v180,v180,v203
 v_mul_f32 v181,v181,v203
 v_mul_f32 v182,v182,v203
 v_mul_f32 v183,v183,v203
 v_accvgpr_write_b32 a112,v176
 v_accvgpr_write_b32 a113,v177
 v_accvgpr_write_b32 a114,v178
 v_accvgpr_write_b32 a115,v179
 v_accvgpr_write_b32 a116,v180
 v_accvgpr_write_b32 a117,v181
 v_accvgpr_write_b32 a118,v182
 v_accvgpr_write_b32 a119,v183
 v_accvgpr_read_b32 v176,a120
 v_accvgpr_read_b32 v177,a121
 v_accvgpr_read_b32 v178,a122
 v_accvgpr_read_b32 v179,a123
 v_accvgpr_read_b32 v180,a124
 v_accvgpr_read_b32 v181,a125
 v_accvgpr_read_b32 v182,a126
 v_accvgpr_read_b32 v183,a127
 v_mul_f32 v176,v176,v203
 v_mul_f32 v177,v177,v203
 v_mul_f32 v178,v178,v203
 v_mul_f32 v179,v179,v203
 v_mul_f32 v180,v180,v203
 v_mul_f32 v181,v181,v203
 v_mul_f32 v182,v182,v203
 v_mul_f32 v183,v183,v203
 v_accvgpr_write_b32 a120,v176
 v_accvgpr_write_b32 a121,v177
 v_accvgpr_write_b32 a122,v178
 v_accvgpr_write_b32 a123,v179
 v_accvgpr_write_b32 a124,v180
 v_accvgpr_write_b32 a125,v181
 v_accvgpr_write_b32 a126,v182
 v_accvgpr_write_b32 a127,v183
 s_nop 1
 s_setpc_b64 s[100:101]
F_RB1:
 s_nop 15
 s_mul_i32 s70,s75,272
 s_add_u32 s79,s70,0
 buffer_load_dwordx4 v[176:179],v224,s[36:39],s79 offen offset:0 sc1
 buffer_load_dwordx4 v[180:183],v224,s[36:39],s79 offen offset:1024 sc1
 buffer_load_dwordx4 v[184:187],v224,s[36:39],s79 offen offset:2048 sc1
 buffer_load_dwordx4 v[188:191],v224,s[36:39],s79 offen offset:3072 sc1
 s_waitcnt vmcnt(0)
 N v[64:79],v[176:179],a[160:163],v[144:159]
 N v[64:79],v[180:183],a[164:167],v[64:79]
 N v[64:79],v[184:187],a[168:171],v[64:79]
 N v[64:79],v[188:191],a[172:175],v[64:79]
 s_nop 7
 s_add_u32 s79,s70,4096
 buffer_load_dwordx4 v[176:179],v224,s[36:39],s79 offen offset:0 sc1
 buffer_load_dwordx4 v[180:183],v224,s[36:39],s79 offen offset:1024 sc1
 buffer_load_dwordx4 v[184:187],v224,s[36:39],s79 offen offset:2048 sc1
 buffer_load_dwordx4 v[188:191],v224,s[36:39],s79 offen offset:3072 sc1
 s_waitcnt vmcnt(0)
 N v[64:79],v[176:179],a[176:179],v[64:79]
 N v[64:79],v[180:183],a[180:183],v[64:79]
 N v[64:79],v[184:187],a[184:187],v[64:79]
 N v[64:79],v[188:191],a[188:191],v[64:79]
 s_nop 7
 s_add_u32 s79,s70,8192
 buffer_load_dwordx4 v[176:179],v224,s[36:39],s79 offen offset:0 sc1
 buffer_load_dwordx4 v[180:183],v224,s[36:39],s79 offen offset:1024 sc1
 buffer_load_dwordx4 v[184:187],v224,s[36:39],s79 offen offset:2048 sc1
 buffer_load_dwordx4 v[188:191],v224,s[36:39],s79 offen offset:3072 sc1
 s_waitcnt vmcnt(0)
 N v[80:95],v[176:179],a[160:163],v[144:159]
 N v[80:95],v[180:183],a[164:167],v[80:95]
 N v[80:95],v[184:187],a[168:171],v[80:95]
 N v[80:95],v[188:191],a[172:175],v[80:95]
 s_nop 7
 s_add_u32 s79,s70,12288
 buffer_load_dwordx4 v[176:179],v224,s[36:39],s79 offen offset:0 sc1
 buffer_load_dwordx4 v[180:183],v224,s[36:39],s79 offen offset:1024 sc1
 buffer_load_dwordx4 v[184:187],v224,s[36:39],s79 offen offset:2048 sc1
 buffer_load_dwordx4 v[188:191],v224,s[36:39],s79 offen offset:3072 sc1
 s_waitcnt vmcnt(0)
 N v[80:95],v[176:179],a[176:179],v[80:95]
 N v[80:95],v[180:183],a[180:183],v[80:95]
 N v[80:95],v[184:187],a[184:187],v[80:95]
 N v[80:95],v[188:191],a[188:191],v[80:95]
 s_nop 7
 s_add_u32 s79,s70,17408
 buffer_load_dwordx4 v[176:179],v224,s[36:39],s79 offen offset:0 sc1
 buffer_load_dwordx4 v[180:183],v224,s[36:39],s79 offen offset:1024 sc1
 buffer_load_dwordx4 v[184:187],v224,s[36:39],s79 offen offset:2048 sc1
 buffer_load_dwordx4 v[188:191],v224,s[36:39],s79 offen offset:3072 sc1
 s_waitcnt vmcnt(0)
 N v[96:111],v[176:179],a[160:163],v[144:159]
 N v[96:111],v[180:183],a[164:167],v[96:111]
 N v[96:111],v[184:187],a[168:171],v[96:111]
 N v[96:111],v[188:191],a[172:175],v[96:111]
 s_nop 7
 s_add_u32 s79,s70,21504
 buffer_load_dwordx4 v[176:179],v224,s[36:39],s79 offen offset:0 sc1
 buffer_load_dwordx4 v[180:183],v224,s[36:39],s79 offen offset:1024 sc1
 buffer_load_dwordx4 v[184:187],v224,s[36:39],s79 offen offset:2048 sc1
 buffer_load_dwordx4 v[188:191],v224,s[36:39],s79 offen offset:3072 sc1
 s_waitcnt vmcnt(0)
 N v[96:111],v[176:179],a[176:179],v[96:111]
 N v[96:111],v[180:183],a[180:183],v[96:111]
 N v[96:111],v[184:187],a[184:187],v[96:111]
 N v[96:111],v[188:191],a[188:191],v[96:111]
 s_nop 7
 s_add_u32 s79,s70,25600
 buffer_load_dwordx4 v[176:179],v224,s[36:39],s79 offen offset:0 sc1
 buffer_load_dwordx4 v[180:183],v224,s[36:39],s79 offen offset:1024 sc1
 buffer_load_dwordx4 v[184:187],v224,s[36:39],s79 offen offset:2048 sc1
 buffer_load_dwordx4 v[188:191],v224,s[36:39],s79 offen offset:3072 sc1
 s_waitcnt vmcnt(0)
 N v[112:127],v[176:179],a[160:163],v[144:159]
 N v[112:127],v[180:183],a[164:167],v[112:127]
 N v[112:127],v[184:187],a[168:171],v[112:127]
 N v[112:127],v[188:191],a[172:175],v[112:127]
 s_nop 7
 s_add_u32 s79,s70,29696
 buffer_load_dwordx4 v[176:179],v224,s[36:39],s79 offen offset:0 sc1
 buffer_load_dwordx4 v[180:183],v224,s[36:39],s79 offen offset:1024 sc1
 buffer_load_dwordx4 v[184:187],v224,s[36:39],s79 offen offset:2048 sc1
 buffer_load_dwordx4 v[188:191],v224,s[36:39],s79 offen offset:3072 sc1
 s_waitcnt vmcnt(0)
 N v[112:127],v[176:179],a[176:179],v[112:127]
 N v[112:127],v[180:183],a[180:183],v[112:127]
 N v[112:127],v[184:187],a[184:187],v[112:127]
 N v[112:127],v[188:191],a[188:191],v[112:127]
 s_nop 7
 s_sub_u32 s79,15,s66
 s_lshl_b32 s79,s79,7
 s_sub_u32 s79,s79,s75
 v_add_u32 v206,s79,v204
 v_cmp_le_i32 s[84:85],0,v206
 v_cmp_le_i32 s[86:87],1,v206
 v_cmp_le_i32 s[88:89],2,v206
 v_cmp_le_i32 s[98:99],3,v206
 v_cndmask_b32 v64,v205,v64,s[84:85]
 v_cndmask_b32 v65,v205,v65,s[86:87]
 v_cndmask_b32 v66,v205,v66,s[88:89]
 v_cndmask_b32 v67,v205,v67,s[98:99]
 v_cmp_le_i32 s[84:85],8,v206
 v_cmp_le_i32 s[86:87],9,v206
 v_cmp_le_i32 s[88:89],10,v206
 v_cmp_le_i32 s[98:99],11,v206
 v_cndmask_b32 v68,v205,v68,s[84:85]
 v_cndmask_b32 v69,v205,v69,s[86:87]
 v_cndmask_b32 v70,v205,v70,s[88:89]
 v_cndmask_b32 v71,v205,v71,s[98:99]
 v_cmp_le_i32 s[84:85],16,v206
 v_cmp_le_i32 s[86:87],17,v206
 v_cmp_le_i32 s[88:89],18,v206
 v_cmp_le_i32 s[98:99],19,v206
 v_cndmask_b32 v72,v205,v72,s[84:85]
 v_cndmask_b32 v73,v205,v73,s[86:87]
 v_cndmask_b32 v74,v205,v74,s[88:89]
 v_cndmask_b32 v75,v205,v75,s[98:99]
 v_cmp_le_i32 s[84:85],24,v206
 v_cmp_le_i32 s[86:87],25,v206
 v_cmp_le_i32 s[88:89],26,v206
 v_cmp_le_i32 s[98:99],27,v206
 v_cndmask_b32 v76,v205,v76,s[84:85]
 v_cndmask_b32 v77,v205,v77,s[86:87]
 v_cndmask_b32 v78,v205,v78,s[88:89]
 v_cndmask_b32 v79,v205,v79,s[98:99]
 v_add_u32 v206,s79,v204
 v_subrev_u32 v206,32,v206
 v_cmp_le_i32 s[84:85],0,v206
 v_cmp_le_i32 s[86:87],1,v206
 v_cmp_le_i32 s[88:89],2,v206
 v_cmp_le_i32 s[98:99],3,v206
 v_cndmask_b32 v80,v205,v80,s[84:85]
 v_cndmask_b32 v81,v205,v81,s[86:87]
 v_cndmask_b32 v82,v205,v82,s[88:89]
 v_cndmask_b32 v83,v205,v83,s[98:99]
 v_cmp_le_i32 s[84:85],8,v206
 v_cmp_le_i32 s[86:87],9,v206
 v_cmp_le_i32 s[88:89],10,v206
 v_cmp_le_i32 s[98:99],11,v206
 v_cndmask_b32 v84,v205,v84,s[84:85]
 v_cndmask_b32 v85,v205,v85,s[86:87]
 v_cndmask_b32 v86,v205,v86,s[88:89]
 v_cndmask_b32 v87,v205,v87,s[98:99]
 v_cmp_le_i32 s[84:85],16,v206
 v_cmp_le_i32 s[86:87],17,v206
 v_cmp_le_i32 s[88:89],18,v206
 v_cmp_le_i32 s[98:99],19,v206
 v_cndmask_b32 v88,v205,v88,s[84:85]
 v_cndmask_b32 v89,v205,v89,s[86:87]
 v_cndmask_b32 v90,v205,v90,s[88:89]
 v_cndmask_b32 v91,v205,v91,s[98:99]
 v_cmp_le_i32 s[84:85],24,v206
 v_cmp_le_i32 s[86:87],25,v206
 v_cmp_le_i32 s[88:89],26,v206
 v_cmp_le_i32 s[98:99],27,v206
 v_cndmask_b32 v92,v205,v92,s[84:85]
 v_cndmask_b32 v93,v205,v93,s[86:87]
 v_cndmask_b32 v94,v205,v94,s[88:89]
 v_cndmask_b32 v95,v205,v95,s[98:99]
 v_add_u32 v206,s79,v204
 v_subrev_u32 v206,64,v206
 v_cmp_le_i32 s[84:85],0,v206
 v_cmp_le_i32 s[86:87],1,v206
 v_cmp_le_i32 s[88:89],2,v206
 v_cmp_le_i32 s[98:99],3,v206
 v_cndmask_b32 v96,v205,v96,s[84:85]
 v_cndmask_b32 v97,v205,v97,s[86:87]
 v_cndmask_b32 v98,v205,v98,s[88:89]
 v_cndmask_b32 v99,v205,v99,s[98:99]
 v_cmp_le_i32 s[84:85],8,v206
 v_cmp_le_i32 s[86:87],9,v206
 v_cmp_le_i32 s[88:89],10,v206
 v_cmp_le_i32 s[98:99],11,v206
 v_cndmask_b32 v100,v205,v100,s[84:85]
 v_cndmask_b32 v101,v205,v101,s[86:87]
 v_cndmask_b32 v102,v205,v102,s[88:89]
 v_cndmask_b32 v103,v205,v103,s[98:99]
 v_cmp_le_i32 s[84:85],16,v206
 v_cmp_le_i32 s[86:87],17,v206
 v_cmp_le_i32 s[88:89],18,v206
 v_cmp_le_i32 s[98:99],19,v206
 v_cndmask_b32 v104,v205,v104,s[84:85]
 v_cndmask_b32 v105,v205,v105,s[86:87]
 v_cndmask_b32 v106,v205,v106,s[88:89]
 v_cndmask_b32 v107,v205,v107,s[98:99]
 v_cmp_le_i32 s[84:85],24,v206
 v_cmp_le_i32 s[86:87],25,v206
 v_cmp_le_i32 s[88:89],26,v206
 v_cmp_le_i32 s[98:99],27,v206
 v_cndmask_b32 v108,v205,v108,s[84:85]
 v_cndmask_b32 v109,v205,v109,s[86:87]
 v_cndmask_b32 v110,v205,v110,s[88:89]
 v_cndmask_b32 v111,v205,v111,s[98:99]
 v_add_u32 v206,s79,v204
 v_subrev_u32 v206,96,v206
 v_cmp_le_i32 s[84:85],0,v206
 v_cmp_le_i32 s[86:87],1,v206
 v_cmp_le_i32 s[88:89],2,v206
 v_cmp_le_i32 s[98:99],3,v206
 v_cndmask_b32 v112,v205,v112,s[84:85]
 v_cndmask_b32 v113,v205,v113,s[86:87]
 v_cndmask_b32 v114,v205,v114,s[88:89]
 v_cndmask_b32 v115,v205,v115,s[98:99]
 v_cmp_le_i32 s[84:85],8,v206
 v_cmp_le_i32 s[86:87],9,v206
 v_cmp_le_i32 s[88:89],10,v206
 v_cmp_le_i32 s[98:99],11,v206
 v_cndmask_b32 v116,v205,v116,s[84:85]
 v_cndmask_b32 v117,v205,v117,s[86:87]
 v_cndmask_b32 v118,v205,v118,s[88:89]
 v_cndmask_b32 v119,v205,v119,s[98:99]
 v_cmp_le_i32 s[84:85],16,v206
 v_cmp_le_i32 s[86:87],17,v206
 v_cmp_le_i32 s[88:89],18,v206
 v_cmp_le_i32 s[98:99],19,v206
 v_cndmask_b32 v120,v205,v120,s[84:85]
 v_cndmask_b32 v121,v205,v121,s[86:87]
 v_cndmask_b32 v122,v205,v122,s[88:89]
 v_cndmask_b32 v123,v205,v123,s[98:99]
 v_cmp_le_i32 s[84:85],24,v206
 v_cmp_le_i32 s[86:87],25,v206
 v_cmp_le_i32 s[88:89],26,v206
 v_cmp_le_i32 s[98:99],27,v206
 v_cndmask_b32 v124,v205,v124,s[84:85]
 v_cndmask_b32 v125,v205,v125,s[86:87]
 v_cndmask_b32 v126,v205,v126,s[88:89]
 v_cndmask_b32 v127,v205,v127,s[98:99]
 v_max3_f32 v201,v64,v65,v66
 v_max3_f32 v201,v201,v67,v68
 v_max3_f32 v201,v201,v69,v70
 v_max3_f32 v201,v201,v71,v72
 v_max3_f32 v201,v201,v73,v74
 v_max3_f32 v201,v201,v75,v76
 v_max3_f32 v201,v201,v77,v78
 v_max_f32 v201,v201,v79
 v_max3_f32 v201,v201,v80,v81
 v_max3_f32 v201,v201,v82,v83
 v_max3_f32 v201,v201,v84,v85
 v_max3_f32 v201,v201,v86,v87
 v_max3_f32 v201,v201,v88,v89
 v_max3_f32 v201,v201,v90,v91
 v_max3_f32 v201,v201,v92,v93
 v_max3_f32 v201,v201,v94,v95
 v_max3_f32 v201,v201,v96,v97
 v_max3_f32 v201,v201,v98,v99
 v_max3_f32 v201,v201,v100,v101
 v_max3_f32 v201,v201,v102,v103
 v_max3_f32 v201,v201,v104,v105
 v_max3_f32 v201,v201,v106,v107
 v_max3_f32 v201,v201,v108,v109
 v_max3_f32 v201,v201,v110,v111
 v_max3_f32 v201,v201,v112,v113
 v_max3_f32 v201,v201,v114,v115
 v_max3_f32 v201,v201,v116,v117
 v_max3_f32 v201,v201,v118,v119
 v_max3_f32 v201,v201,v120,v121
 v_max3_f32 v201,v201,v122,v123
 v_max3_f32 v201,v201,v124,v125
 v_max3_f32 v201,v201,v126,v127
 v_mov_b32 v206,v201
 s_nop 1
 v_permlane32_swap_b32 v201,v206
 v_max_f32 v201,v201,v206
 v_max_f32 v201,0,v201
 v_exp_f32 v203,-v201
 v_sub_f32 v64,v64,v201
 v_sub_f32 v65,v65,v201
 v_sub_f32 v66,v66,v201
 v_sub_f32 v67,v67,v201
 v_sub_f32 v68,v68,v201
 v_sub_f32 v69,v69,v201
 v_sub_f32 v70,v70,v201
 v_sub_f32 v71,v71,v201
 v_sub_f32 v72,v72,v201
 v_sub_f32 v73,v73,v201
 v_sub_f32 v74,v74,v201
 v_sub_f32 v75,v75,v201
 v_sub_f32 v76,v76,v201
 v_sub_f32 v77,v77,v201
 v_sub_f32 v78,v78,v201
 v_sub_f32 v79,v79,v201
 v_sub_f32 v80,v80,v201
 v_sub_f32 v81,v81,v201
 v_sub_f32 v82,v82,v201
 v_sub_f32 v83,v83,v201
 v_sub_f32 v84,v84,v201
 v_sub_f32 v85,v85,v201
 v_sub_f32 v86,v86,v201
 v_sub_f32 v87,v87,v201
 v_sub_f32 v88,v88,v201
 v_sub_f32 v89,v89,v201
 v_sub_f32 v90,v90,v201
 v_sub_f32 v91,v91,v201
 v_sub_f32 v92,v92,v201
 v_sub_f32 v93,v93,v201
 v_sub_f32 v94,v94,v201
 v_sub_f32 v95,v95,v201
 v_sub_f32 v96,v96,v201
 v_sub_f32 v97,v97,v201
 v_sub_f32 v98,v98,v201
 v_sub_f32 v99,v99,v201
 v_sub_f32 v100,v100,v201
 v_sub_f32 v101,v101,v201
 v_sub_f32 v102,v102,v201
 v_sub_f32 v103,v103,v201
 v_sub_f32 v104,v104,v201
 v_sub_f32 v105,v105,v201
 v_sub_f32 v106,v106,v201
 v_sub_f32 v107,v107,v201
 v_sub_f32 v108,v108,v201
 v_sub_f32 v109,v109,v201
 v_sub_f32 v110,v110,v201
 v_sub_f32 v111,v111,v201
 v_sub_f32 v112,v112,v201
 v_sub_f32 v113,v113,v201
 v_sub_f32 v114,v114,v201
 v_sub_f32 v115,v115,v201
 v_sub_f32 v116,v116,v201
 v_sub_f32 v117,v117,v201
 v_sub_f32 v118,v118,v201
 v_sub_f32 v119,v119,v201
 v_sub_f32 v120,v120,v201
 v_sub_f32 v121,v121,v201
 v_sub_f32 v122,v122,v201
 v_sub_f32 v123,v123,v201
 v_sub_f32 v124,v124,v201
 v_sub_f32 v125,v125,v201
 v_sub_f32 v126,v126,v201
 v_sub_f32 v127,v127,v201
 v_sub_f32 v144,v144,v201
 v_sub_f32 v145,v145,v201
 v_sub_f32 v146,v146,v201
 v_sub_f32 v147,v147,v201
 v_sub_f32 v148,v148,v201
 v_sub_f32 v149,v149,v201
 v_sub_f32 v150,v150,v201
 v_sub_f32 v151,v151,v201
 v_sub_f32 v152,v152,v201
 v_sub_f32 v153,v153,v201
 v_sub_f32 v154,v154,v201
 v_sub_f32 v155,v155,v201
 v_sub_f32 v156,v156,v201
 v_sub_f32 v157,v157,v201
 v_sub_f32 v158,v158,v201
 v_sub_f32 v159,v159,v201
 v_mul_f32 v198,v198,v203
 v_exp_f32 v64,v64
 v_exp_f32 v65,v65
 v_exp_f32 v66,v66
 v_add_f32 v199,v64,v65
 v_exp_f32 v67,v67
 v_cvt_pk_bf16_f32 v64,v64,v65
 v_exp_f32 v68,v68
 v_add_f32 v199,v199,v66
 v_exp_f32 v69,v69
 v_cvt_pk_bf16_f32 v65,v66,v67
 v_add_f32 v199,v199,v67
 v_exp_f32 v70,v70
 v_add_f32 v199,v199,v68
 v_exp_f32 v71,v71
 v_cvt_pk_bf16_f32 v66,v68,v69
 v_add_f32 v199,v199,v69
 v_exp_f32 v72,v72
 v_add_f32 v199,v199,v70
 v_exp_f32 v73,v73
 v_cvt_pk_bf16_f32 v67,v70,v71
 v_add_f32 v199,v199,v71
 v_exp_f32 v74,v74
 v_add_f32 v199,v199,v72
 v_exp_f32 v75,v75
 v_add_f32 v199,v199,v73
 v_cvt_pk_bf16_f32 v72,v72,v73
 v_exp_f32 v76,v76
 v_add_f32 v199,v199,v74
 v_exp_f32 v77,v77
 v_cvt_pk_bf16_f32 v73,v74,v75
 v_add_f32 v199,v199,v75
 v_exp_f32 v78,v78
 v_add_f32 v199,v199,v76
 v_exp_f32 v79,v79
 v_cvt_pk_bf16_f32 v74,v76,v77
 v_add_f32 v199,v199,v77
 v_add_f32 v199,v199,v78
 v_cvt_pk_bf16_f32 v75,v78,v79
 v_add_f32 v199,v199,v79
 v_exp_f32 v80,v80
 v_exp_f32 v81,v81
 v_exp_f32 v82,v82
 v_add_f32 v199,v199,v80
 v_exp_f32 v83,v83
 v_add_f32 v199,v199,v81
 v_cvt_pk_bf16_f32 v80,v80,v81
 v_exp_f32 v84,v84
 v_add_f32 v199,v199,v82
 v_exp_f32 v85,v85
 v_cvt_pk_bf16_f32 v81,v82,v83
 v_add_f32 v199,v199,v83
 v_exp_f32 v86,v86
 v_add_f32 v199,v199,v84
 v_exp_f32 v87,v87
 v_cvt_pk_bf16_f32 v82,v84,v85
 v_add_f32 v199,v199,v85
 v_exp_f32 v88,v88
 v_add_f32 v199,v199,v86
 v_exp_f32 v89,v89
 v_cvt_pk_bf16_f32 v83,v86,v87
 v_add_f32 v199,v199,v87
 v_exp_f32 v90,v90
 v_add_f32 v199,v199,v88
 v_exp_f32 v91,v91
 v_add_f32 v199,v199,v89
 v_cvt_pk_bf16_f32 v88,v88,v89
 v_exp_f32 v92,v92
 v_add_f32 v199,v199,v90
 v_exp_f32 v93,v93
 v_cvt_pk_bf16_f32 v89,v90,v91
 v_add_f32 v199,v199,v91
 v_exp_f32 v94,v94
 v_add_f32 v199,v199,v92
 v_exp_f32 v95,v95
 v_cvt_pk_bf16_f32 v90,v92,v93
 v_add_f32 v199,v199,v93
 v_add_f32 v199,v199,v94
 v_cvt_pk_bf16_f32 v91,v94,v95
 v_add_f32 v199,v199,v95
 v_exp_f32 v96,v96
 v_exp_f32 v97,v97
 v_exp_f32 v98,v98
 v_add_f32 v199,v199,v96
 v_exp_f32 v99,v99
 v_add_f32 v199,v199,v97
 v_cvt_pk_bf16_f32 v96,v96,v97
 v_exp_f32 v100,v100
 v_add_f32 v199,v199,v98
 v_exp_f32 v101,v101
 v_cvt_pk_bf16_f32 v97,v98,v99
 v_add_f32 v199,v199,v99
 v_exp_f32 v102,v102
 v_add_f32 v199,v199,v100
 v_exp_f32 v103,v103
 v_cvt_pk_bf16_f32 v98,v100,v101
 v_add_f32 v199,v199,v101
 v_exp_f32 v104,v104
 v_add_f32 v199,v199,v102
 v_exp_f32 v105,v105
 v_cvt_pk_bf16_f32 v99,v102,v103
 v_add_f32 v199,v199,v103
 v_exp_f32 v106,v106
 v_add_f32 v199,v199,v104
 v_exp_f32 v107,v107
 v_add_f32 v199,v199,v105
 v_cvt_pk_bf16_f32 v104,v104,v105
 v_exp_f32 v108,v108
 v_add_f32 v199,v199,v106
 v_exp_f32 v109,v109
 v_cvt_pk_bf16_f32 v105,v106,v107
 v_add_f32 v199,v199,v107
 v_exp_f32 v110,v110
 v_add_f32 v199,v199,v108
 v_exp_f32 v111,v111
 v_cvt_pk_bf16_f32 v106,v108,v109
 v_add_f32 v199,v199,v109
 v_add_f32 v199,v199,v110
 v_cvt_pk_bf16_f32 v107,v110,v111
 v_add_f32 v199,v199,v111
 v_exp_f32 v112,v112
 v_exp_f32 v113,v113
 v_exp_f32 v114,v114
 v_add_f32 v199,v199,v112
 v_exp_f32 v115,v115
 v_add_f32 v199,v199,v113
 v_cvt_pk_bf16_f32 v112,v112,v113
 v_exp_f32 v116,v116
 v_add_f32 v199,v199,v114
 v_exp_f32 v117,v117
 v_cvt_pk_bf16_f32 v113,v114,v115
 v_add_f32 v199,v199,v115
 v_exp_f32 v118,v118
 v_add_f32 v199,v199,v116
 v_exp_f32 v119,v119
 v_cvt_pk_bf16_f32 v114,v116,v117
 v_add_f32 v199,v199,v117
 v_exp_f32 v120,v120
 v_add_f32 v199,v199,v118
 v_exp_f32 v121,v121
 v_cvt_pk_bf16_f32 v115,v118,v119
 v_add_f32 v199,v199,v119
 v_exp_f32 v122,v122
 v_add_f32 v199,v199,v120
 v_exp_f32 v123,v123
 v_add_f32 v199,v199,v121
 v_cvt_pk_bf16_f32 v120,v120,v121
 v_exp_f32 v124,v124
 v_add_f32 v199,v199,v122
 v_exp_f32 v125,v125
 v_cvt_pk_bf16_f32 v121,v122,v123
 v_add_f32 v199,v199,v123
 v_exp_f32 v126,v126
 v_add_f32 v199,v199,v124
 v_exp_f32 v127,v127
 v_cvt_pk_bf16_f32 v122,v124,v125
 v_add_f32 v199,v199,v125
 v_add_f32 v199,v199,v126
 v_cvt_pk_bf16_f32 v123,v126,v127
 v_add_f32 v199,v199,v127
 v_accvgpr_read_b32 v176,a64
 v_accvgpr_read_b32 v177,a65
 v_accvgpr_read_b32 v178,a66
 v_accvgpr_read_b32 v179,a67
 v_accvgpr_read_b32 v180,a68
 v_accvgpr_read_b32 v181,a69
 v_accvgpr_read_b32 v182,a70
 v_accvgpr_read_b32 v183,a71
 v_mul_f32 v176,v176,v203
 v_mul_f32 v177,v177,v203
 v_mul_f32 v178,v178,v203
 v_mul_f32 v179,v179,v203
 v_mul_f32 v180,v180,v203
 v_mul_f32 v181,v181,v203
 v_mul_f32 v182,v182,v203
 v_mul_f32 v183,v183,v203
 v_accvgpr_write_b32 a64,v176
 v_accvgpr_write_b32 a65,v177
 v_accvgpr_write_b32 a66,v178
 v_accvgpr_write_b32 a67,v179
 v_accvgpr_write_b32 a68,v180
 v_accvgpr_write_b32 a69,v181
 v_accvgpr_write_b32 a70,v182
 v_accvgpr_write_b32 a71,v183
 v_accvgpr_read_b32 v176,a72
 v_accvgpr_read_b32 v177,a73
 v_accvgpr_read_b32 v178,a74
 v_accvgpr_read_b32 v179,a75
 v_accvgpr_read_b32 v180,a76
 v_accvgpr_read_b32 v181,a77
 v_accvgpr_read_b32 v182,a78
 v_accvgpr_read_b32 v183,a79
 v_mul_f32 v176,v176,v203
 v_mul_f32 v177,v177,v203
 v_mul_f32 v178,v178,v203
 v_mul_f32 v179,v179,v203
 v_mul_f32 v180,v180,v203
 v_mul_f32 v181,v181,v203
 v_mul_f32 v182,v182,v203
 v_mul_f32 v183,v183,v203
 v_accvgpr_write_b32 a72,v176
 v_accvgpr_write_b32 a73,v177
 v_accvgpr_write_b32 a74,v178
 v_accvgpr_write_b32 a75,v179
 v_accvgpr_write_b32 a76,v180
 v_accvgpr_write_b32 a77,v181
 v_accvgpr_write_b32 a78,v182
 v_accvgpr_write_b32 a79,v183
 v_accvgpr_read_b32 v176,a80
 v_accvgpr_read_b32 v177,a81
 v_accvgpr_read_b32 v178,a82
 v_accvgpr_read_b32 v179,a83
 v_accvgpr_read_b32 v180,a84
 v_accvgpr_read_b32 v181,a85
 v_accvgpr_read_b32 v182,a86
 v_accvgpr_read_b32 v183,a87
 v_mul_f32 v176,v176,v203
 v_mul_f32 v177,v177,v203
 v_mul_f32 v178,v178,v203
 v_mul_f32 v179,v179,v203
 v_mul_f32 v180,v180,v203
 v_mul_f32 v181,v181,v203
 v_mul_f32 v182,v182,v203
 v_mul_f32 v183,v183,v203
 v_accvgpr_write_b32 a80,v176
 v_accvgpr_write_b32 a81,v177
 v_accvgpr_write_b32 a82,v178
 v_accvgpr_write_b32 a83,v179
 v_accvgpr_write_b32 a84,v180
 v_accvgpr_write_b32 a85,v181
 v_accvgpr_write_b32 a86,v182
 v_accvgpr_write_b32 a87,v183
 v_accvgpr_read_b32 v176,a88
 v_accvgpr_read_b32 v177,a89
 v_accvgpr_read_b32 v178,a90
 v_accvgpr_read_b32 v179,a91
 v_accvgpr_read_b32 v180,a92
 v_accvgpr_read_b32 v181,a93
 v_accvgpr_read_b32 v182,a94
 v_accvgpr_read_b32 v183,a95
 v_mul_f32 v176,v176,v203
 v_mul_f32 v177,v177,v203
 v_mul_f32 v178,v178,v203
 v_mul_f32 v179,v179,v203
 v_mul_f32 v180,v180,v203
 v_mul_f32 v181,v181,v203
 v_mul_f32 v182,v182,v203
 v_mul_f32 v183,v183,v203
 v_accvgpr_write_b32 a88,v176
 v_accvgpr_write_b32 a89,v177
 v_accvgpr_write_b32 a90,v178
 v_accvgpr_write_b32 a91,v179
 v_accvgpr_write_b32 a92,v180
 v_accvgpr_write_b32 a93,v181
 v_accvgpr_write_b32 a94,v182
 v_accvgpr_write_b32 a95,v183
 v_accvgpr_read_b32 v176,a96
 v_accvgpr_read_b32 v177,a97
 v_accvgpr_read_b32 v178,a98
 v_accvgpr_read_b32 v179,a99
 v_accvgpr_read_b32 v180,a100
 v_accvgpr_read_b32 v181,a101
 v_accvgpr_read_b32 v182,a102
 v_accvgpr_read_b32 v183,a103
 v_mul_f32 v176,v176,v203
 v_mul_f32 v177,v177,v203
 v_mul_f32 v178,v178,v203
 v_mul_f32 v179,v179,v203
 v_mul_f32 v180,v180,v203
 v_mul_f32 v181,v181,v203
 v_mul_f32 v182,v182,v203
 v_mul_f32 v183,v183,v203
 v_accvgpr_write_b32 a96,v176
 v_accvgpr_write_b32 a97,v177
 v_accvgpr_write_b32 a98,v178
 v_accvgpr_write_b32 a99,v179
 v_accvgpr_write_b32 a100,v180
 v_accvgpr_write_b32 a101,v181
 v_accvgpr_write_b32 a102,v182
 v_accvgpr_write_b32 a103,v183
 v_accvgpr_read_b32 v176,a104
 v_accvgpr_read_b32 v177,a105
 v_accvgpr_read_b32 v178,a106
 v_accvgpr_read_b32 v179,a107
 v_accvgpr_read_b32 v180,a108
 v_accvgpr_read_b32 v181,a109
 v_accvgpr_read_b32 v182,a110
 v_accvgpr_read_b32 v183,a111
 v_mul_f32 v176,v176,v203
 v_mul_f32 v177,v177,v203
 v_mul_f32 v178,v178,v203
 v_mul_f32 v179,v179,v203
 v_mul_f32 v180,v180,v203
 v_mul_f32 v181,v181,v203
 v_mul_f32 v182,v182,v203
 v_mul_f32 v183,v183,v203
 v_accvgpr_write_b32 a104,v176
 v_accvgpr_write_b32 a105,v177
 v_accvgpr_write_b32 a106,v178
 v_accvgpr_write_b32 a107,v179
 v_accvgpr_write_b32 a108,v180
 v_accvgpr_write_b32 a109,v181
 v_accvgpr_write_b32 a110,v182
 v_accvgpr_write_b32 a111,v183
 v_accvgpr_read_b32 v176,a112
 v_accvgpr_read_b32 v177,a113
 v_accvgpr_read_b32 v178,a114
 v_accvgpr_read_b32 v179,a115
 v_accvgpr_read_b32 v180,a116
 v_accvgpr_read_b32 v181,a117
 v_accvgpr_read_b32 v182,a118
 v_accvgpr_read_b32 v183,a119
 v_mul_f32 v176,v176,v203
 v_mul_f32 v177,v177,v203
 v_mul_f32 v178,v178,v203
 v_mul_f32 v179,v179,v203
 v_mul_f32 v180,v180,v203
 v_mul_f32 v181,v181,v203
 v_mul_f32 v182,v182,v203
 v_mul_f32 v183,v183,v203
 v_accvgpr_write_b32 a112,v176
 v_accvgpr_write_b32 a113,v177
 v_accvgpr_write_b32 a114,v178
 v_accvgpr_write_b32 a115,v179
 v_accvgpr_write_b32 a116,v180
 v_accvgpr_write_b32 a117,v181
 v_accvgpr_write_b32 a118,v182
 v_accvgpr_write_b32 a119,v183
 v_accvgpr_read_b32 v176,a120
 v_accvgpr_read_b32 v177,a121
 v_accvgpr_read_b32 v178,a122
 v_accvgpr_read_b32 v179,a123
 v_accvgpr_read_b32 v180,a124
 v_accvgpr_read_b32 v181,a125
 v_accvgpr_read_b32 v182,a126
 v_accvgpr_read_b32 v183,a127
 v_mul_f32 v176,v176,v203
 v_mul_f32 v177,v177,v203
 v_mul_f32 v178,v178,v203
 v_mul_f32 v179,v179,v203
 v_mul_f32 v180,v180,v203
 v_mul_f32 v181,v181,v203
 v_mul_f32 v182,v182,v203
 v_mul_f32 v183,v183,v203
 v_accvgpr_write_b32 a120,v176
 v_accvgpr_write_b32 a121,v177
 v_accvgpr_write_b32 a122,v178
 v_accvgpr_write_b32 a123,v179
 v_accvgpr_write_b32 a124,v180
 v_accvgpr_write_b32 a125,v181
 v_accvgpr_write_b32 a126,v182
 v_accvgpr_write_b32 a127,v183
 s_nop 1
 s_setpc_b64 s[100:101]
F_XAA0:
 s_call_b64 s[100:101],F_RA0
 v_sub_f32 v64,v64,v200
 v_sub_f32 v65,v65,v200
 v_sub_f32 v66,v66,v200
 v_sub_f32 v67,v67,v200
 v_sub_f32 v68,v68,v200
 v_sub_f32 v69,v69,v200
 v_sub_f32 v70,v70,v200
 v_sub_f32 v71,v71,v200
 v_sub_f32 v72,v72,v200
 v_sub_f32 v73,v73,v200
 v_sub_f32 v74,v74,v200
 v_sub_f32 v75,v75,v200
 v_sub_f32 v76,v76,v200
 v_sub_f32 v77,v77,v200
 v_sub_f32 v78,v78,v200
 v_sub_f32 v79,v79,v200
 v_sub_f32 v80,v80,v201
 v_sub_f32 v81,v81,v201
 v_sub_f32 v82,v82,v201
 v_sub_f32 v83,v83,v201
 v_sub_f32 v84,v84,v201
 v_sub_f32 v85,v85,v201
 v_sub_f32 v86,v86,v201
 v_sub_f32 v87,v87,v201
 v_sub_f32 v88,v88,v201
 v_sub_f32 v89,v89,v201
 v_sub_f32 v90,v90,v201
 v_sub_f32 v91,v91,v201
 v_sub_f32 v92,v92,v201
 v_sub_f32 v93,v93,v201
 v_sub_f32 v94,v94,v201
 v_sub_f32 v95,v95,v201
 v_sub_f32 v96,v96,v200
 v_sub_f32 v97,v97,v200
 v_sub_f32 v98,v98,v200
 v_sub_f32 v99,v99,v200
 v_sub_f32 v100,v100,v200
 v_sub_f32 v101,v101,v200
 v_sub_f32 v102,v102,v200
 v_sub_f32 v103,v103,v200
 v_sub_f32 v104,v104,v200
 v_sub_f32 v105,v105,v200
 v_sub_f32 v106,v106,v200
 v_sub_f32 v107,v107,v200
 v_sub_f32 v108,v108,v200
 v_sub_f32 v109,v109,v200
 v_sub_f32 v110,v110,v200
 v_sub_f32 v111,v111,v200
 v_sub_f32 v112,v112,v201
 v_sub_f32 v113,v113,v201
 v_sub_f32 v114,v114,v201
 v_sub_f32 v115,v115,v201
 v_sub_f32 v116,v116,v201
 v_sub_f32 v117,v117,v201
 v_sub_f32 v118,v118,v201
 v_sub_f32 v119,v119,v201
 v_sub_f32 v120,v120,v201
 v_sub_f32 v121,v121,v201
 v_sub_f32 v122,v122,v201
 v_sub_f32 v123,v123,v201
 v_sub_f32 v124,v124,v201
 v_sub_f32 v125,v125,v201
 v_sub_f32 v126,v126,v201
 v_sub_f32 v127,v127,v201
 s_nop 1
 s_setpc_b64 s[82:83]
F_XAA1:
 s_call_b64 s[100:101],F_RA1
 v_sub_f32 v0,v0,v200
 v_sub_f32 v1,v1,v200
 v_sub_f32 v2,v2,v200
 v_sub_f32 v3,v3,v200
 v_sub_f32 v4,v4,v200
 v_sub_f32 v5,v5,v200
 v_sub_f32 v6,v6,v200
 v_sub_f32 v7,v7,v200
 v_sub_f32 v8,v8,v200
 v_sub_f32 v9,v9,v200
 v_sub_f32 v10,v10,v200
 v_sub_f32 v11,v11,v200
 v_sub_f32 v12,v12,v200
 v_sub_f32 v13,v13,v200
 v_sub_f32 v14,v14,v200
 v_sub_f32 v15,v15,v200
 v_sub_f32 v16,v16,v201
 v_sub_f32 v17,v17,v201
 v_sub_f32 v18,v18,v201
 v_sub_f32 v19,v19,v201
 v_sub_f32 v20,v20,v201
 v_sub_f32 v21,v21,v201
 v_sub_f32 v22,v22,v201
 v_sub_f32 v23,v23,v201
 v_sub_f32 v24,v24,v201
 v_sub_f32 v25,v25,v201
 v_sub_f32 v26,v26,v201
 v_sub_f32 v27,v27,v201
 v_sub_f32 v28,v28,v201
 v_sub_f32 v29,v29,v201
 v_sub_f32 v30,v30,v201
 v_sub_f32 v31,v31,v201
 v_sub_f32 v32,v32,v200
 v_sub_f32 v33,v33,v200
 v_sub_f32 v34,v34,v200
 v_sub_f32 v35,v35,v200
 v_sub_f32 v36,v36,v200
 v_sub_f32 v37,v37,v200
 v_sub_f32 v38,v38,v200
 v_sub_f32 v39,v39,v200
 v_sub_f32 v40,v40,v200
 v_sub_f32 v41,v41,v200
 v_sub_f32 v42,v42,v200
 v_sub_f32 v43,v43,v200
 v_sub_f32 v44,v44,v200
 v_sub_f32 v45,v45,v200
 v_sub_f32 v46,v46,v200
 v_sub_f32 v47,v47,v200
 v_sub_f32 v48,v48,v201
 v_sub_f32 v49,v49,v201
 v_sub_f32 v50,v50,v201
 v_sub_f32 v51,v51,v201
 v_sub_f32 v52,v52,v201
 v_sub_f32 v53,v53,v201
 v_sub_f32 v54,v54,v201
 v_sub_f32 v55,v55,v201
 v_sub_f32 v56,v56,v201
 v_sub_f32 v57,v57,v201
 v_sub_f32 v58,v58,v201
 v_sub_f32 v59,v59,v201
 v_sub_f32 v60,v60,v201
 v_sub_f32 v61,v61,v201
 v_sub_f32 v62,v62,v201
 v_sub_f32 v63,v63,v201
 s_nop 1
 s_setpc_b64 s[82:83]
F_XAB1:
 s_call_b64 s[100:101],F_RA1
 v_sub_f32 v0,v0,v201
 v_sub_f32 v1,v1,v201
 v_sub_f32 v2,v2,v201
 v_sub_f32 v3,v3,v201
 v_sub_f32 v4,v4,v201
 v_sub_f32 v5,v5,v201
 v_sub_f32 v6,v6,v201
 v_sub_f32 v7,v7,v201
 v_sub_f32 v8,v8,v201
 v_sub_f32 v9,v9,v201
 v_sub_f32 v10,v10,v201
 v_sub_f32 v11,v11,v201
 v_sub_f32 v12,v12,v201
 v_sub_f32 v13,v13,v201
 v_sub_f32 v14,v14,v201
 v_sub_f32 v15,v15,v201
 v_sub_f32 v16,v16,v201
 v_sub_f32 v17,v17,v201
 v_sub_f32 v18,v18,v201
 v_sub_f32 v19,v19,v201
 v_sub_f32 v20,v20,v201
 v_sub_f32 v21,v21,v201
 v_sub_f32 v22,v22,v201
 v_sub_f32 v23,v23,v201
 v_sub_f32 v24,v24,v201
 v_sub_f32 v25,v25,v201
 v_sub_f32 v26,v26,v201
 v_sub_f32 v27,v27,v201
 v_sub_f32 v28,v28,v201
 v_sub_f32 v29,v29,v201
 v_sub_f32 v30,v30,v201
 v_sub_f32 v31,v31,v201
 v_sub_f32 v32,v32,v201
 v_sub_f32 v33,v33,v201
 v_sub_f32 v34,v34,v201
 v_sub_f32 v35,v35,v201
 v_sub_f32 v36,v36,v201
 v_sub_f32 v37,v37,v201
 v_sub_f32 v38,v38,v201
 v_sub_f32 v39,v39,v201
 v_sub_f32 v40,v40,v201
 v_sub_f32 v41,v41,v201
 v_sub_f32 v42,v42,v201
 v_sub_f32 v43,v43,v201
 v_sub_f32 v44,v44,v201
 v_sub_f32 v45,v45,v201
 v_sub_f32 v46,v46,v201
 v_sub_f32 v47,v47,v201
 v_sub_f32 v48,v48,v201
 v_sub_f32 v49,v49,v201
 v_sub_f32 v50,v50,v201
 v_sub_f32 v51,v51,v201
 v_sub_f32 v52,v52,v201
 v_sub_f32 v53,v53,v201
 v_sub_f32 v54,v54,v201
 v_sub_f32 v55,v55,v201
 v_sub_f32 v56,v56,v201
 v_sub_f32 v57,v57,v201
 v_sub_f32 v58,v58,v201
 v_sub_f32 v59,v59,v201
 v_sub_f32 v60,v60,v201
 v_sub_f32 v61,v61,v201
 v_sub_f32 v62,v62,v201
 v_sub_f32 v63,v63,v201
 s_nop 1
 s_setpc_b64 s[82:83]
F_XBB0:
 s_call_b64 s[100:101],F_RB0
 v_sub_f32 v64,v64,v201
 v_sub_f32 v65,v65,v201
 v_sub_f32 v66,v66,v201
 v_sub_f32 v67,v67,v201
 v_sub_f32 v68,v68,v201
 v_sub_f32 v69,v69,v201
 v_sub_f32 v70,v70,v201
 v_sub_f32 v71,v71,v201
 v_sub_f32 v72,v72,v201
 v_sub_f32 v73,v73,v201
 v_sub_f32 v74,v74,v201
 v_sub_f32 v75,v75,v201
 v_sub_f32 v76,v76,v201
 v_sub_f32 v77,v77,v201
 v_sub_f32 v78,v78,v201
 v_sub_f32 v79,v79,v201
 v_sub_f32 v80,v80,v201
 v_sub_f32 v81,v81,v201
 v_sub_f32 v82,v82,v201
 v_sub_f32 v83,v83,v201
 v_sub_f32 v84,v84,v201
 v_sub_f32 v85,v85,v201
 v_sub_f32 v86,v86,v201
 v_sub_f32 v87,v87,v201
 v_sub_f32 v88,v88,v201
 v_sub_f32 v89,v89,v201
 v_sub_f32 v90,v90,v201
 v_sub_f32 v91,v91,v201
 v_sub_f32 v92,v92,v201
 v_sub_f32 v93,v93,v201
 v_sub_f32 v94,v94,v201
 v_sub_f32 v95,v95,v201
 v_sub_f32 v96,v96,v201
 v_sub_f32 v97,v97,v201
 v_sub_f32 v98,v98,v201
 v_sub_f32 v99,v99,v201
 v_sub_f32 v100,v100,v201
 v_sub_f32 v101,v101,v201
 v_sub_f32 v102,v102,v201
 v_sub_f32 v103,v103,v201
 v_sub_f32 v104,v104,v201
 v_sub_f32 v105,v105,v201
 v_sub_f32 v106,v106,v201
 v_sub_f32 v107,v107,v201
 v_sub_f32 v108,v108,v201
 v_sub_f32 v109,v109,v201
 v_sub_f32 v110,v110,v201
 v_sub_f32 v111,v111,v201
 v_sub_f32 v112,v112,v201
 v_sub_f32 v113,v113,v201
 v_sub_f32 v114,v114,v201
 v_sub_f32 v115,v115,v201
 v_sub_f32 v116,v116,v201
 v_sub_f32 v117,v117,v201
 v_sub_f32 v118,v118,v201
 v_sub_f32 v119,v119,v201
 v_sub_f32 v120,v120,v201
 v_sub_f32 v121,v121,v201
 v_sub_f32 v122,v122,v201
 v_sub_f32 v123,v123,v201
 v_sub_f32 v124,v124,v201
 v_sub_f32 v125,v125,v201
 v_sub_f32 v126,v126,v201
 v_sub_f32 v127,v127,v201
 s_nop 1
 s_setpc_b64 s[82:83]
F_XBB1:
 s_call_b64 s[100:101],F_RB1
 v_sub_f32 v0,v0,v201
 v_sub_f32 v1,v1,v201
 v_sub_f32 v2,v2,v201
 v_sub_f32 v3,v3,v201
 v_sub_f32 v4,v4,v201
 v_sub_f32 v5,v5,v201
 v_sub_f32 v6,v6,v201
 v_sub_f32 v7,v7,v201
 v_sub_f32 v8,v8,v201
 v_sub_f32 v9,v9,v201
 v_sub_f32 v10,v10,v201
 v_sub_f32 v11,v11,v201
 v_sub_f32 v12,v12,v201
 v_sub_f32 v13,v13,v201
 v_sub_f32 v14,v14,v201
 v_sub_f32 v15,v15,v201
 v_sub_f32 v16,v16,v201
 v_sub_f32 v17,v17,v201
 v_sub_f32 v18,v18,v201
 v_sub_f32 v19,v19,v201
 v_sub_f32 v20,v20,v201
 v_sub_f32 v21,v21,v201
 v_sub_f32 v22,v22,v201
 v_sub_f32 v23,v23,v201
 v_sub_f32 v24,v24,v201
 v_sub_f32 v25,v25,v201
 v_sub_f32 v26,v26,v201
 v_sub_f32 v27,v27,v201
 v_sub_f32 v28,v28,v201
 v_sub_f32 v29,v29,v201
 v_sub_f32 v30,v30,v201
 v_sub_f32 v31,v31,v201
 v_sub_f32 v32,v32,v201
 v_sub_f32 v33,v33,v201
 v_sub_f32 v34,v34,v201
 v_sub_f32 v35,v35,v201
 v_sub_f32 v36,v36,v201
 v_sub_f32 v37,v37,v201
 v_sub_f32 v38,v38,v201
 v_sub_f32 v39,v39,v201
 v_sub_f32 v40,v40,v201
 v_sub_f32 v41,v41,v201
 v_sub_f32 v42,v42,v201
 v_sub_f32 v43,v43,v201
 v_sub_f32 v44,v44,v201
 v_sub_f32 v45,v45,v201
 v_sub_f32 v46,v46,v201
 v_sub_f32 v47,v47,v201
 v_sub_f32 v48,v48,v201
 v_sub_f32 v49,v49,v201
 v_sub_f32 v50,v50,v201
 v_sub_f32 v51,v51,v201
 v_sub_f32 v52,v52,v201
 v_sub_f32 v53,v53,v201
 v_sub_f32 v54,v54,v201
 v_sub_f32 v55,v55,v201
 v_sub_f32 v56,v56,v201
 v_sub_f32 v57,v57,v201
 v_sub_f32 v58,v58,v201
 v_sub_f32 v59,v59,v201
 v_sub_f32 v60,v60,v201
 v_sub_f32 v61,v61,v201
 v_sub_f32 v62,v62,v201
 v_sub_f32 v63,v63,v201
 s_nop 1
 s_setpc_b64 s[82:83]
F_XBn0:
 s_call_b64 s[100:101],F_RB0
 s_nop 1
 s_setpc_b64 s[82:83]

.section .rodata,"a"
.p2align 6
.amdhsa_kernel parallel_sum__compressed_kv_cla__dense_activation_gelu__prompt_kernel
  .amdhsa_next_free_vgpr 512
  .amdhsa_next_free_sgpr 102
  .amdhsa_accum_offset 256
  .amdhsa_group_segment_fixed_size 0
  .amdhsa_kernarg_size 112
  .amdhsa_user_sgpr_count 2
  .amdhsa_user_sgpr_kernarg_segment_ptr 1
  .amdhsa_system_sgpr_workgroup_id_x 1
.end_amdhsa_kernel
```
